```python
import torch

def _softmax(x, axis=-1):
    return torch.softmax(x, dim=axis)

def _gelu(x):
    return torch.nn.functional.gelu(x, approximate='tanh')

def _silu(x):
    return torch.nn.functional.silu(x)

def _sigmoid(x):
    return torch.sigmoid(x)

def _layernorm(x, axis=-1, eps=1e-05):
    m = x.mean(dim=axis, keepdim=True)
    v = x.var(dim=axis, keepdim=True, unbiased=False)
    return (x - m) / torch.sqrt(v + eps)

def _scatter_add(tgt, idx, src, axis=0):
    return tgt.clone().index_add_(axis, idx, src)

def _segment_sum(src, seg, n):
    out = torch.zeros((n,) + src.shape[1:], dtype=src.dtype)
    return out.index_add_(0, seg, src)

def _pad(x, pw):
    flat = tuple((v for pair in reversed(pw) for v in pair))
    return torch.nn.functional.pad(x, flat)
kernel_name = 'gated_mix__sliding_local_dilated__memory_aug_recurrent_mem_tr__prompt'

def setup_inputs():

    _w = lambda a: (lambda t: t.to(torch.bfloat16) if t.is_floating_point() else t)(torch.as_tensor(a))

    def _A_setup():
        B, S, D = (1, 2048, 576)
        return {'x': _w((lambda *s: torch.randn(*s, dtype=torch.bfloat16) * 0.05)(B, S, D)), 'wqkv': _w((lambda *s: torch.randn(*s, dtype=torch.bfloat16) * 0.8)(D, 3 * D)), 'wo': _w((lambda *s: torch.randn(*s, dtype=torch.bfloat16) * 0.05)(D, D))}
    _A_in = _A_setup()

    def _B_setup():
        B, S, Dm = (1, 2048, 576)
        H, Dh = (32, 128)
        M, seg = (8, 32)
        seg = min(seg, S)
        S = S // seg * seg
        return {'x': _w((lambda *s: torch.randn(*s, dtype=torch.bfloat16) * 0.05)(B, S, Dm)), 'mem0': _w((lambda *s: torch.randn(*s, dtype=torch.bfloat16) * 1.6)(B, M, Dm)), 'Wq': _w((lambda *s: torch.randn(*s, dtype=torch.bfloat16) * 0.8)(Dm, H, Dh) * Dm ** (-0.5)), 'Wk': _w((lambda *s: torch.randn(*s, dtype=torch.bfloat16) * 0.8)(Dm, H, Dh) * Dm ** (-0.5)), 'Wv': _w((lambda *s: torch.randn(*s, dtype=torch.bfloat16) * 1.6)(Dm, H, Dh) * Dm ** (-0.5)), 'Wo': _w((lambda *s: torch.randn(*s, dtype=torch.bfloat16) * 1.6)(H, Dh, Dm) * (H * Dh) ** (-0.5)), 'seg_len': seg}
    _B_in = _B_setup()
    return {'A_x': _A_in['x'], 'A_wqkv': _A_in['wqkv'], 'A_wo': _A_in['wo'], 'B_x': _B_in['x'], 'B_mem0': _B_in['mem0'], 'B_Wq': _B_in['Wq'], 'B_Wk': _B_in['Wk'], 'B_Wv': _B_in['Wv'], 'B_Wo': _B_in['Wo'], 'B_seg_len': _B_in['seg_len'], 'gate_w': _w((lambda *s: torch.randn(*s, dtype=torch.bfloat16) * 0.05)(576) * 16.0)}

def reference(A_x, A_wqkv, A_wo, B_x, B_mem0, B_Wq, B_Wk, B_Wv, B_Wo, B_seg_len, gate_w):

    def _A_ref(x, wqkv, wo):
        B, S, D = x.shape
        H = 32
        Dh = D // H
        W, dil = (8, 2)
        qkv = (lambda x, *d: x.permute(*d))((x @ wqkv).reshape(B, S, 3, H, Dh), 2, 0, 3, 1, 4)
        q, k, v = (qkv[0], qkv[1], qkv[2])
        scale = Dh ** (-0.5)
        pos = torch.arange(S)
        off = torch.arange(W) * dil
        idx = pos[:, None] - off[None, :]
        mask = idx >= 0
        idx_c = torch.where(mask, idx, 0).reshape(-1)
        kg = k[:, :, idx_c, :].reshape(B, H, S, W, Dh)
        vg = v[:, :, idx_c, :].reshape(B, H, S, W, Dh)
        logits = torch.einsum('bhsd,bhswd->bhsw', q, kg) * scale
        logits = torch.where(mask[None, None, :, :], logits, -1000000000.0)
        attn = _softmax(logits, axis=-1)
        o = torch.einsum('bhsw,bhswd->bhsd', attn, vg)
        return (lambda x, *d: x.permute(*d))(o, 0, 2, 1, 3).reshape(B, S, D) @ wo

    def _B_ref(x, mem0, Wq, Wk, Wv, Wo, seg_len):
        B, S, Dm = x.shape
        H, Dh = (Wq.shape[1], Wq.shape[2])
        M = mem0.shape[1]
        scale = Dh ** (-0.5)
        n_seg = S // seg_len
        L = M + seg_len
        idx = torch.arange(L)
        mask = (idx[:, None] < M) | (idx[:, None] >= idx[None, :])
        mem = mem0
        outs = []
        for s in range(n_seg):
            xs = x[:, s * seg_len:(s + 1) * seg_len, :].clone()
            h = torch.concatenate([mem, xs], axis=1)
            q = torch.einsum('btd,dhe->bhte', h, Wq)
            k = torch.einsum('btd,dhe->bhte', h, Wk)
            v = torch.einsum('btd,dhe->bhte', h, Wv)
            scores = torch.einsum('bhqe,bhke->bhqk', q, k) * scale
            scores = torch.where(mask[None, None], scores, -1000000000.0)
            p = _softmax(scores, axis=-1)
            o = torch.einsum('bhqk,bhke->bhqe', p, v)
            o = torch.einsum('bhte,hed->btd', o, Wo)
            mem = o[:, :M, :].clone()
            outs.append(o[:, M:, :])
        return torch.concatenate(outs, axis=1)
    x = A_x
    g = _sigmoid((x * gate_w).sum(-1, keepdims=True))
    a = _A_ref(x, A_wqkv, A_wo)
    b = _B_ref(x, B_mem0, B_Wq, B_Wk, B_Wv, B_Wo, B_seg_len)
    return g * a + (1 - g) * b
```

```asm
; @launch grid=(256,1,1) block=(256,1,1) lds=163840
.amdgcn_target "amdgcn-amd-amdhsa--gfx950"
.text
.globl gated_mix__sliding_local_dilated__memory_aug_recurrent_mem_tr__prompt_kernel
.p2align 8
.type gated_mix__sliding_local_dilated__memory_aug_recurrent_mem_tr__prompt_kernel,@function
gated_mix__sliding_local_dilated__memory_aug_recurrent_mem_tr__prompt_kernel:

s_cmp_ge_u32 s2, 256
s_cbranch_scc1 L_exit_w
s_and_b32 s3, s2, 7
s_lshr_b32 s32, s2, 3
s_cmp_eq_u32 s3, 0
s_cbranch_scc1 L_role_chain
s_cmp_ge_u32 s3, 5
s_cbranch_scc1 L_pre_aw
s_lshr_b32 s33, s32, 3
s_and_b32 s32, s32, 7
s_sub_u32 s3, s3, 1
s_lshl_b32 s3, s3, 3
s_add_u32 s32, s32, s3
s_branch L_role_q
L_pre_aw:
s_sub_u32 s3, s3, 5
s_lshl_b32 s49, s3, 5
s_add_u32 s49, s49, s32
s_lshr_b32 s33, s49, 3
s_and_b32 s32, s32, 7
s_mul_i32 s48, s49, 43
s_lshr_b32 s48, s48, 9
s_mul_i32 s3, s48, 12
s_sub_u32 s49, s49, s3
s_branch L_role_aw
L_exit_w:
s_endpgm
L_role_q:
s_load_dwordx2 s[4:5], s[0:1], 104
s_mov_b32 s6, 268435456
s_mov_b32 s7, 0x20000
s_load_dwordx2 s[8:9], s[0:1], 0
s_mov_b32 s10, 2359296
s_mov_b32 s11, 0x20000
s_load_dwordx2 s[12:13], s[0:1], 40
s_mov_b32 s14, 4718592
s_mov_b32 s15, 0x20000
s_load_dwordx2 s[16:17], s[0:1], 48
s_mov_b32 s18, 4718592
s_mov_b32 s19, 0x20000
s_load_dwordx2 s[20:21], s[0:1], 56
s_mov_b32 s22, 4718592
s_mov_b32 s23, 0x20000
s_load_dwordx2 s[24:25], s[0:1], 96
s_mov_b32 s26, 256
s_mov_b32 s27, 0x20000
v_and_b32 v9, 63, v0
v_and_b32 v10, 15, v0
v_bfe_u32 v11, v0, 4, 2
v_lshrrev_b32 v1, 6, v0
s_nop 0
v_readfirstlane_b32 s34, v1
v_lshrrev_b32 v12, 2, v9
v_mul_u32_u24 v2, 1152, v12
v_lshrrev_b32 v12, 5, v9
v_lshlrev_b32 v12, 1, v12
v_and_b32 v13, 3, v9
v_xor_b32 v12, v12, v13
v_lshl_add_u32 v2, v12, 4, v2
v_lshrrev_b32 v12, 3, v10
v_lshlrev_b32 v12, 1, v12
v_xor_b32 v12, v12, v11
v_lshlrev_b32 v12, 4, v12
v_lshl_add_u32 v3, v10, 6, v12
v_lshrrev_b32 v12, 2, v10
v_lshl_add_u32 v12, v11, 3, v12
v_mul_u32_u24 v7, 64, v12
v_and_b32 v12, 3, v10
v_lshl_add_u32 v7, v12, 3, v7
v_lshlrev_b32 v1, 4, v9
s_mul_i32 s38, s34, 20480
s_add_u32 s38, s38, 73728
v_add_u32 v7, s38, v7
v_lshrrev_b32 v12, 2, v9
v_lshlrev_b32 v12, 13, v12
v_and_b32 v13, 3, v9
v_lshl_add_u32 v6, v13, 4, v12
v_and_b32 v13, 1, v9
v_lshl_add_u32 v5, v13, 4, v12
v_bfe_u32 v13, v9, 1, 1
v_lshl_add_u32 v5, v13, 6, v5
s_lshl_b32 s39, s32, 8
s_lshl_b32 s40, s34, 6
s_add_u32 s40, s40, s39
s_lshr_b32 s41, s34, 1
s_lshl_b32 s41, s41, 7
s_add_u32 s39, s39, s41
s_and_b32 s41, s34, 1
s_lshl_b32 s41, s41, 5
s_add_u32 s39, s39, s41
s_lshl_b32 s43, s33, 1
s_and_b32 s41, s34, 1
s_add_u32 s43, s43, s41
s_mul_i32 s43, s43, 18432
s_lshr_b32 s41, s34, 1
s_lshl_b32 s41, s41, 6
s_add_u32 s43, s43, s41
s_lshl_b32 s44, s34, 10
s_mov_b32 s36, 400000
s_mov_b32 s46, 0x3e0293ee
s_mov_b32 s47, 0x3e0293ee
v_mov_b32 v8, 0
v_lshrrev_b32 v12, 2, v10
v_lshlrev_b32 v4, 12, v12
v_lshl_add_u32 v4, v11, 8, v4
v_and_b32 v12, 3, v10
v_lshl_add_u32 v4, v12, 4, v4
s_waitcnt lgkmcnt(0)
s_add_u32 s37, s39, 0
s_add_u32 m0, s38, 0
s_nop 0
buffer_load_dwordx4 v5, s[12:15], s37 offen lds
s_add_u32 s37, s39, 131072
s_add_u32 m0, s38, 1024
s_nop 0
buffer_load_dwordx4 v5, s[12:15], s37 offen lds
s_add_u32 s37, s39, 262144
s_add_u32 m0, s38, 2048
s_nop 0
buffer_load_dwordx4 v5, s[12:15], s37 offen lds
s_add_u32 s37, s39, 393216
s_add_u32 m0, s38, 3072
s_nop 0
buffer_load_dwordx4 v5, s[12:15], s37 offen lds
s_add_u32 s37, s39, 524288
s_add_u32 m0, s38, 4096
s_nop 0
buffer_load_dwordx4 v5, s[12:15], s37 offen lds
s_add_u32 s37, s39, 655360
s_add_u32 m0, s38, 5120
s_nop 0
buffer_load_dwordx4 v5, s[12:15], s37 offen lds
s_add_u32 s37, s39, 786432
s_add_u32 m0, s38, 6144
s_nop 0
buffer_load_dwordx4 v5, s[12:15], s37 offen lds
s_add_u32 s37, s39, 917504
s_add_u32 m0, s38, 7168
s_nop 0
buffer_load_dwordx4 v5, s[12:15], s37 offen lds
s_add_u32 s37, s39, 1048576
s_add_u32 m0, s38, 8192
s_nop 0
buffer_load_dwordx4 v5, s[12:15], s37 offen lds
s_add_u32 s37, s39, 1179648
s_add_u32 m0, s38, 9216
s_nop 0
buffer_load_dwordx4 v5, s[12:15], s37 offen lds
s_add_u32 s37, s39, 1310720
s_add_u32 m0, s38, 10240
s_nop 0
buffer_load_dwordx4 v5, s[12:15], s37 offen lds
s_add_u32 s37, s39, 1441792
s_add_u32 m0, s38, 11264
s_nop 0
buffer_load_dwordx4 v5, s[12:15], s37 offen lds
s_add_u32 s37, s39, 1572864
s_add_u32 m0, s38, 12288
s_nop 0
buffer_load_dwordx4 v5, s[12:15], s37 offen lds
s_add_u32 s37, s39, 1703936
s_add_u32 m0, s38, 13312
s_nop 0
buffer_load_dwordx4 v5, s[12:15], s37 offen lds
s_add_u32 s37, s39, 1835008
s_add_u32 m0, s38, 14336
s_nop 0
buffer_load_dwordx4 v5, s[12:15], s37 offen lds
s_add_u32 s37, s39, 1966080
s_add_u32 m0, s38, 15360
s_nop 0
buffer_load_dwordx4 v5, s[12:15], s37 offen lds
s_add_u32 s37, s43, 0
s_add_u32 m0, s44, 0
s_nop 0
buffer_load_dwordx4 v2, s[8:11], s37 offen lds
s_add_u32 s37, s43, 128
s_add_u32 m0, s44, 4096
s_nop 0
buffer_load_dwordx4 v2, s[8:11], s37 offen lds
s_add_u32 s37, s43, 256
s_add_u32 m0, s44, 8192
s_nop 0
buffer_load_dwordx4 v2, s[8:11], s37 offen lds
s_add_u32 s37, s43, 384
s_add_u32 m0, s44, 12288
s_nop 0
buffer_load_dwordx4 v2, s[8:11], s37 offen lds
s_add_u32 s37, s43, 512
s_add_u32 m0, s44, 16384
s_nop 0
buffer_load_dwordx4 v2, s[8:11], s37 offen lds
s_add_u32 s37, s43, 640
s_add_u32 m0, s44, 20480
s_nop 0
buffer_load_dwordx4 v2, s[8:11], s37 offen lds
s_add_u32 s37, s43, 768
s_add_u32 m0, s44, 24576
s_nop 0
buffer_load_dwordx4 v2, s[8:11], s37 offen lds
s_add_u32 s37, s43, 896
s_add_u32 m0, s44, 28672
s_nop 0
buffer_load_dwordx4 v2, s[8:11], s37 offen lds
s_add_u32 s37, s43, 1024
s_add_u32 m0, s44, 32768
s_nop 0
buffer_load_dwordx4 v2, s[8:11], s37 offen lds
s_waitcnt vmcnt(21)
ds_read_b64_tr_b16 v[80:81], v7 offset:0
ds_read_b64_tr_b16 v[82:83], v7 offset:256
ds_read_b64_tr_b16 v[84:85], v7 offset:2048
ds_read_b64_tr_b16 v[86:87], v7 offset:2304
ds_read_b64_tr_b16 v[152:153], v7 offset:32
ds_read_b64_tr_b16 v[154:155], v7 offset:288
ds_read_b64_tr_b16 v[156:157], v7 offset:2080
ds_read_b64_tr_b16 v[158:159], v7 offset:2336
s_waitcnt lgkmcnt(0)
s_add_u32 s37, s39, 2097152
s_add_u32 m0, s38, 16384
s_nop 0
buffer_load_dwordx4 v5, s[12:15], s37 offen lds
s_add_u32 s37, s39, 2228224
s_add_u32 m0, s38, 17408
s_nop 0
buffer_load_dwordx4 v5, s[12:15], s37 offen lds
s_add_u32 s37, s39, 2359296
s_add_u32 m0, s38, 18432
s_nop 0
buffer_load_dwordx4 v5, s[12:15], s37 offen lds
s_add_u32 s37, s39, 2490368
s_add_u32 m0, s38, 19456
s_nop 0
buffer_load_dwordx4 v5, s[12:15], s37 offen lds
s_waitcnt vmcnt(21)
ds_read_b64_tr_b16 v[88:89], v7 offset:4096
ds_read_b64_tr_b16 v[90:91], v7 offset:4352
ds_read_b64_tr_b16 v[92:93], v7 offset:6144
ds_read_b64_tr_b16 v[94:95], v7 offset:6400
ds_read_b64_tr_b16 v[160:161], v7 offset:4128
ds_read_b64_tr_b16 v[162:163], v7 offset:4384
ds_read_b64_tr_b16 v[164:165], v7 offset:6176
ds_read_b64_tr_b16 v[166:167], v7 offset:6432
s_waitcnt lgkmcnt(0)
s_add_u32 s37, s39, 2621440
s_add_u32 m0, s38, 0
s_nop 0
buffer_load_dwordx4 v5, s[12:15], s37 offen lds
s_add_u32 s37, s39, 2752512
s_add_u32 m0, s38, 1024
s_nop 0
buffer_load_dwordx4 v5, s[12:15], s37 offen lds
s_add_u32 s37, s39, 2883584
s_add_u32 m0, s38, 2048
s_nop 0
buffer_load_dwordx4 v5, s[12:15], s37 offen lds
s_add_u32 s37, s39, 3014656
s_add_u32 m0, s38, 3072
s_nop 0
buffer_load_dwordx4 v5, s[12:15], s37 offen lds
s_waitcnt vmcnt(21)
ds_read_b64_tr_b16 v[96:97], v7 offset:8192
ds_read_b64_tr_b16 v[98:99], v7 offset:8448
ds_read_b64_tr_b16 v[100:101], v7 offset:10240
ds_read_b64_tr_b16 v[102:103], v7 offset:10496
ds_read_b64_tr_b16 v[168:169], v7 offset:8224
ds_read_b64_tr_b16 v[170:171], v7 offset:8480
ds_read_b64_tr_b16 v[172:173], v7 offset:10272
ds_read_b64_tr_b16 v[174:175], v7 offset:10528
s_waitcnt lgkmcnt(0)
s_add_u32 s37, s39, 3145728
s_add_u32 m0, s38, 4096
s_nop 0
buffer_load_dwordx4 v5, s[12:15], s37 offen lds
s_add_u32 s37, s39, 3276800
s_add_u32 m0, s38, 5120
s_nop 0
buffer_load_dwordx4 v5, s[12:15], s37 offen lds
s_add_u32 s37, s39, 3407872
s_add_u32 m0, s38, 6144
s_nop 0
buffer_load_dwordx4 v5, s[12:15], s37 offen lds
s_add_u32 s37, s39, 3538944
s_add_u32 m0, s38, 7168
s_nop 0
buffer_load_dwordx4 v5, s[12:15], s37 offen lds
s_waitcnt vmcnt(21)
ds_read_b64_tr_b16 v[104:105], v7 offset:12288
ds_read_b64_tr_b16 v[106:107], v7 offset:12544
ds_read_b64_tr_b16 v[108:109], v7 offset:14336
ds_read_b64_tr_b16 v[110:111], v7 offset:14592
ds_read_b64_tr_b16 v[176:177], v7 offset:12320
ds_read_b64_tr_b16 v[178:179], v7 offset:12576
ds_read_b64_tr_b16 v[180:181], v7 offset:14368
ds_read_b64_tr_b16 v[182:183], v7 offset:14624
s_waitcnt lgkmcnt(0)
s_add_u32 s37, s39, 3670016
s_add_u32 m0, s38, 8192
s_nop 0
buffer_load_dwordx4 v5, s[12:15], s37 offen lds
s_add_u32 s37, s39, 3801088
s_add_u32 m0, s38, 9216
s_nop 0
buffer_load_dwordx4 v5, s[12:15], s37 offen lds
s_add_u32 s37, s39, 3932160
s_add_u32 m0, s38, 10240
s_nop 0
buffer_load_dwordx4 v5, s[12:15], s37 offen lds
s_add_u32 s37, s39, 4063232
s_add_u32 m0, s38, 11264
s_nop 0
buffer_load_dwordx4 v5, s[12:15], s37 offen lds
s_waitcnt vmcnt(12)
ds_read_b64_tr_b16 v[112:113], v7 offset:16384
ds_read_b64_tr_b16 v[114:115], v7 offset:16640
ds_read_b64_tr_b16 v[116:117], v7 offset:18432
ds_read_b64_tr_b16 v[118:119], v7 offset:18688
ds_read_b64_tr_b16 v[184:185], v7 offset:16416
ds_read_b64_tr_b16 v[186:187], v7 offset:16672
ds_read_b64_tr_b16 v[188:189], v7 offset:18464
ds_read_b64_tr_b16 v[190:191], v7 offset:18720
s_waitcnt lgkmcnt(0)
s_add_u32 s37, s39, 4194304
s_add_u32 m0, s38, 12288
s_nop 0
buffer_load_dwordx4 v5, s[12:15], s37 offen lds
s_add_u32 s37, s39, 4325376
s_add_u32 m0, s38, 13312
s_nop 0
buffer_load_dwordx4 v5, s[12:15], s37 offen lds
s_add_u32 s37, s39, 4456448
s_add_u32 m0, s38, 14336
s_nop 0
buffer_load_dwordx4 v5, s[12:15], s37 offen lds
s_add_u32 s37, s39, 4587520
s_add_u32 m0, s38, 15360
s_nop 0
buffer_load_dwordx4 v5, s[12:15], s37 offen lds
s_waitcnt vmcnt(12)
ds_read_b64_tr_b16 v[120:121], v7 offset:0
ds_read_b64_tr_b16 v[122:123], v7 offset:256
ds_read_b64_tr_b16 v[124:125], v7 offset:2048
ds_read_b64_tr_b16 v[126:127], v7 offset:2304
ds_read_b64_tr_b16 v[192:193], v7 offset:32
ds_read_b64_tr_b16 v[194:195], v7 offset:288
ds_read_b64_tr_b16 v[196:197], v7 offset:2080
ds_read_b64_tr_b16 v[198:199], v7 offset:2336
s_waitcnt lgkmcnt(0)
s_add_u32 s37, s39, 0
s_add_u32 m0, s38, 16384
s_nop 0
buffer_load_dwordx4 v5, s[16:19], s37 offen lds
s_add_u32 s37, s39, 131072
s_add_u32 m0, s38, 17408
s_nop 0
buffer_load_dwordx4 v5, s[16:19], s37 offen lds
s_add_u32 s37, s39, 262144
s_add_u32 m0, s38, 18432
s_nop 0
buffer_load_dwordx4 v5, s[16:19], s37 offen lds
s_add_u32 s37, s39, 393216
s_add_u32 m0, s38, 19456
s_nop 0
buffer_load_dwordx4 v5, s[16:19], s37 offen lds
s_waitcnt vmcnt(12)
ds_read_b64_tr_b16 v[128:129], v7 offset:4096
ds_read_b64_tr_b16 v[130:131], v7 offset:4352
ds_read_b64_tr_b16 v[132:133], v7 offset:6144
ds_read_b64_tr_b16 v[134:135], v7 offset:6400
ds_read_b64_tr_b16 v[200:201], v7 offset:4128
ds_read_b64_tr_b16 v[202:203], v7 offset:4384
ds_read_b64_tr_b16 v[204:205], v7 offset:6176
ds_read_b64_tr_b16 v[206:207], v7 offset:6432
s_waitcnt lgkmcnt(0)
s_add_u32 s37, s39, 524288
s_add_u32 m0, s38, 0
s_nop 0
buffer_load_dwordx4 v5, s[16:19], s37 offen lds
s_add_u32 s37, s39, 655360
s_add_u32 m0, s38, 1024
s_nop 0
buffer_load_dwordx4 v5, s[16:19], s37 offen lds
s_add_u32 s37, s39, 786432
s_add_u32 m0, s38, 2048
s_nop 0
buffer_load_dwordx4 v5, s[16:19], s37 offen lds
s_add_u32 s37, s39, 917504
s_add_u32 m0, s38, 3072
s_nop 0
buffer_load_dwordx4 v5, s[16:19], s37 offen lds
s_waitcnt vmcnt(12)
ds_read_b64_tr_b16 v[136:137], v7 offset:8192
ds_read_b64_tr_b16 v[138:139], v7 offset:8448
ds_read_b64_tr_b16 v[140:141], v7 offset:10240
ds_read_b64_tr_b16 v[142:143], v7 offset:10496
ds_read_b64_tr_b16 v[208:209], v7 offset:8224
ds_read_b64_tr_b16 v[210:211], v7 offset:8480
ds_read_b64_tr_b16 v[212:213], v7 offset:10272
ds_read_b64_tr_b16 v[214:215], v7 offset:10528
s_waitcnt lgkmcnt(0)
s_add_u32 s37, s39, 1048576
s_add_u32 m0, s38, 4096
s_nop 0
buffer_load_dwordx4 v5, s[16:19], s37 offen lds
s_add_u32 s37, s39, 1179648
s_add_u32 m0, s38, 5120
s_nop 0
buffer_load_dwordx4 v5, s[16:19], s37 offen lds
s_add_u32 s37, s39, 1310720
s_add_u32 m0, s38, 6144
s_nop 0
buffer_load_dwordx4 v5, s[16:19], s37 offen lds
s_add_u32 s37, s39, 1441792
s_add_u32 m0, s38, 7168
s_nop 0
buffer_load_dwordx4 v5, s[16:19], s37 offen lds
s_waitcnt vmcnt(12)
ds_read_b64_tr_b16 v[144:145], v7 offset:12288
ds_read_b64_tr_b16 v[146:147], v7 offset:12544
ds_read_b64_tr_b16 v[148:149], v7 offset:14336
ds_read_b64_tr_b16 v[150:151], v7 offset:14592
ds_read_b64_tr_b16 v[216:217], v7 offset:12320
ds_read_b64_tr_b16 v[218:219], v7 offset:12576
ds_read_b64_tr_b16 v[220:221], v7 offset:14368
ds_read_b64_tr_b16 v[222:223], v7 offset:14624
s_waitcnt lgkmcnt(0)
s_add_u32 s37, s39, 1572864
s_add_u32 m0, s38, 8192
s_nop 0
buffer_load_dwordx4 v5, s[16:19], s37 offen lds
s_add_u32 s37, s39, 1703936
s_add_u32 m0, s38, 9216
s_nop 0
buffer_load_dwordx4 v5, s[16:19], s37 offen lds
s_add_u32 s37, s39, 1835008
s_add_u32 m0, s38, 10240
s_nop 0
buffer_load_dwordx4 v5, s[16:19], s37 offen lds
s_add_u32 s37, s39, 1966080
s_add_u32 m0, s38, 11264
s_nop 0
buffer_load_dwordx4 v5, s[16:19], s37 offen lds
s_waitcnt vmcnt(12)
ds_read_b64_tr_b16 v[224:225], v7 offset:16384
ds_read_b64_tr_b16 v[226:227], v7 offset:16640
ds_read_b64_tr_b16 v[228:229], v7 offset:18432
ds_read_b64_tr_b16 v[230:231], v7 offset:18688
ds_read_b64_tr_b16 a[40:41], v7 offset:16416
ds_read_b64_tr_b16 a[42:43], v7 offset:16672
ds_read_b64_tr_b16 a[44:45], v7 offset:18464
ds_read_b64_tr_b16 a[46:47], v7 offset:18720
s_waitcnt lgkmcnt(0)
s_add_u32 s37, s39, 2097152
s_add_u32 m0, s38, 12288
s_nop 0
buffer_load_dwordx4 v5, s[16:19], s37 offen lds
s_add_u32 s37, s39, 2228224
s_add_u32 m0, s38, 13312
s_nop 0
buffer_load_dwordx4 v5, s[16:19], s37 offen lds
s_add_u32 s37, s39, 2359296
s_add_u32 m0, s38, 14336
s_nop 0
buffer_load_dwordx4 v5, s[16:19], s37 offen lds
s_add_u32 s37, s39, 2490368
s_add_u32 m0, s38, 15360
s_nop 0
buffer_load_dwordx4 v5, s[16:19], s37 offen lds
s_waitcnt vmcnt(12)
ds_read_b64_tr_b16 v[232:233], v7 offset:0
ds_read_b64_tr_b16 v[234:235], v7 offset:256
ds_read_b64_tr_b16 v[236:237], v7 offset:2048
ds_read_b64_tr_b16 v[238:239], v7 offset:2304
ds_read_b64_tr_b16 a[48:49], v7 offset:32
ds_read_b64_tr_b16 a[50:51], v7 offset:288
ds_read_b64_tr_b16 a[52:53], v7 offset:2080
ds_read_b64_tr_b16 a[54:55], v7 offset:2336
s_waitcnt lgkmcnt(0)
s_add_u32 s37, s39, 2621440
s_add_u32 m0, s38, 16384
s_nop 0
buffer_load_dwordx4 v5, s[16:19], s37 offen lds
s_add_u32 s37, s39, 2752512
s_add_u32 m0, s38, 17408
s_nop 0
buffer_load_dwordx4 v5, s[16:19], s37 offen lds
s_add_u32 s37, s39, 2883584
s_add_u32 m0, s38, 18432
s_nop 0
buffer_load_dwordx4 v5, s[16:19], s37 offen lds
s_add_u32 s37, s39, 3014656
s_add_u32 m0, s38, 19456
s_nop 0
buffer_load_dwordx4 v5, s[16:19], s37 offen lds
s_waitcnt vmcnt(12)
ds_read_b64_tr_b16 v[240:241], v7 offset:4096
ds_read_b64_tr_b16 v[242:243], v7 offset:4352
ds_read_b64_tr_b16 v[244:245], v7 offset:6144
ds_read_b64_tr_b16 v[246:247], v7 offset:6400
ds_read_b64_tr_b16 a[56:57], v7 offset:4128
ds_read_b64_tr_b16 a[58:59], v7 offset:4384
ds_read_b64_tr_b16 a[60:61], v7 offset:6176
ds_read_b64_tr_b16 a[62:63], v7 offset:6432
s_waitcnt lgkmcnt(0)
s_add_u32 s37, s39, 3145728
s_add_u32 m0, s38, 0
s_nop 0
buffer_load_dwordx4 v5, s[16:19], s37 offen lds
s_add_u32 s37, s39, 3276800
s_add_u32 m0, s38, 1024
s_nop 0
buffer_load_dwordx4 v5, s[16:19], s37 offen lds
s_add_u32 s37, s39, 3407872
s_add_u32 m0, s38, 2048
s_nop 0
buffer_load_dwordx4 v5, s[16:19], s37 offen lds
s_add_u32 s37, s39, 3538944
s_add_u32 m0, s38, 3072
s_nop 0
buffer_load_dwordx4 v5, s[16:19], s37 offen lds
s_waitcnt vmcnt(12)
ds_read_b64_tr_b16 v[248:249], v7 offset:8192
ds_read_b64_tr_b16 v[250:251], v7 offset:8448
ds_read_b64_tr_b16 v[252:253], v7 offset:10240
ds_read_b64_tr_b16 v[254:255], v7 offset:10496
ds_read_b64_tr_b16 a[64:65], v7 offset:8224
ds_read_b64_tr_b16 a[66:67], v7 offset:8480
ds_read_b64_tr_b16 a[68:69], v7 offset:10272
ds_read_b64_tr_b16 a[70:71], v7 offset:10528
s_waitcnt lgkmcnt(0)
s_add_u32 s37, s39, 3670016
s_add_u32 m0, s38, 4096
s_nop 0
buffer_load_dwordx4 v5, s[16:19], s37 offen lds
s_add_u32 s37, s39, 3801088
s_add_u32 m0, s38, 5120
s_nop 0
buffer_load_dwordx4 v5, s[16:19], s37 offen lds
s_add_u32 s37, s39, 3932160
s_add_u32 m0, s38, 6144
s_nop 0
buffer_load_dwordx4 v5, s[16:19], s37 offen lds
s_add_u32 s37, s39, 4063232
s_add_u32 m0, s38, 7168
s_nop 0
buffer_load_dwordx4 v5, s[16:19], s37 offen lds
s_waitcnt vmcnt(12)
ds_read_b64_tr_b16 a[0:1], v7 offset:12288
ds_read_b64_tr_b16 a[2:3], v7 offset:12544
ds_read_b64_tr_b16 a[4:5], v7 offset:14336
ds_read_b64_tr_b16 a[6:7], v7 offset:14592
ds_read_b64_tr_b16 a[72:73], v7 offset:12320
ds_read_b64_tr_b16 a[74:75], v7 offset:12576
ds_read_b64_tr_b16 a[76:77], v7 offset:14368
ds_read_b64_tr_b16 a[78:79], v7 offset:14624
s_waitcnt lgkmcnt(0)
s_add_u32 s37, s39, 4194304
s_add_u32 m0, s38, 8192
s_nop 0
buffer_load_dwordx4 v5, s[16:19], s37 offen lds
s_add_u32 s37, s39, 4325376
s_add_u32 m0, s38, 9216
s_nop 0
buffer_load_dwordx4 v5, s[16:19], s37 offen lds
s_add_u32 s37, s39, 4456448
s_add_u32 m0, s38, 10240
s_nop 0
buffer_load_dwordx4 v5, s[16:19], s37 offen lds
s_add_u32 s37, s39, 4587520
s_add_u32 m0, s38, 11264
s_nop 0
buffer_load_dwordx4 v5, s[16:19], s37 offen lds
s_waitcnt vmcnt(12)
ds_read_b64_tr_b16 a[8:9], v7 offset:16384
ds_read_b64_tr_b16 a[10:11], v7 offset:16640
ds_read_b64_tr_b16 a[12:13], v7 offset:18432
ds_read_b64_tr_b16 a[14:15], v7 offset:18688
ds_read_b64_tr_b16 a[80:81], v7 offset:16416
ds_read_b64_tr_b16 a[82:83], v7 offset:16672
ds_read_b64_tr_b16 a[84:85], v7 offset:18464
ds_read_b64_tr_b16 a[86:87], v7 offset:18720
s_waitcnt lgkmcnt(0)
s_add_u32 s37, s40, 0
s_add_u32 m0, s38, 12288
s_nop 0
buffer_load_dwordx4 v6, s[20:23], s37 offen lds
s_add_u32 s37, s40, 131072
s_add_u32 m0, s38, 13312
s_nop 0
buffer_load_dwordx4 v6, s[20:23], s37 offen lds
s_add_u32 s37, s40, 262144
s_add_u32 m0, s38, 14336
s_nop 0
buffer_load_dwordx4 v6, s[20:23], s37 offen lds
s_add_u32 s37, s40, 393216
s_add_u32 m0, s38, 15360
s_nop 0
buffer_load_dwordx4 v6, s[20:23], s37 offen lds
s_waitcnt vmcnt(12)
ds_read_b64_tr_b16 a[16:17], v7 offset:0
ds_read_b64_tr_b16 a[18:19], v7 offset:256
ds_read_b64_tr_b16 a[20:21], v7 offset:2048
ds_read_b64_tr_b16 a[22:23], v7 offset:2304
ds_read_b64_tr_b16 a[88:89], v7 offset:32
ds_read_b64_tr_b16 a[90:91], v7 offset:288
ds_read_b64_tr_b16 a[92:93], v7 offset:2080
ds_read_b64_tr_b16 a[94:95], v7 offset:2336
s_waitcnt lgkmcnt(0)
s_add_u32 s37, s40, 524288
s_add_u32 m0, s38, 16384
s_nop 0
buffer_load_dwordx4 v6, s[20:23], s37 offen lds
s_add_u32 s37, s40, 655360
s_add_u32 m0, s38, 17408
s_nop 0
buffer_load_dwordx4 v6, s[20:23], s37 offen lds
s_add_u32 s37, s40, 786432
s_add_u32 m0, s38, 18432
s_nop 0
buffer_load_dwordx4 v6, s[20:23], s37 offen lds
s_add_u32 s37, s40, 917504
s_add_u32 m0, s38, 19456
s_nop 0
buffer_load_dwordx4 v6, s[20:23], s37 offen lds
s_waitcnt vmcnt(12)
ds_read_b64_tr_b16 a[24:25], v7 offset:4096
ds_read_b64_tr_b16 a[26:27], v7 offset:4352
ds_read_b64_tr_b16 a[28:29], v7 offset:6144
ds_read_b64_tr_b16 a[30:31], v7 offset:6400
ds_read_b64_tr_b16 a[96:97], v7 offset:4128
ds_read_b64_tr_b16 a[98:99], v7 offset:4384
ds_read_b64_tr_b16 a[100:101], v7 offset:6176
ds_read_b64_tr_b16 a[102:103], v7 offset:6432
s_waitcnt lgkmcnt(0)
s_add_u32 s37, s40, 1048576
s_add_u32 m0, s38, 0
s_nop 0
buffer_load_dwordx4 v6, s[20:23], s37 offen lds
s_add_u32 s37, s40, 1179648
s_add_u32 m0, s38, 1024
s_nop 0
buffer_load_dwordx4 v6, s[20:23], s37 offen lds
s_add_u32 s37, s40, 1310720
s_add_u32 m0, s38, 2048
s_nop 0
buffer_load_dwordx4 v6, s[20:23], s37 offen lds
s_add_u32 s37, s40, 1441792
s_add_u32 m0, s38, 3072
s_nop 0
buffer_load_dwordx4 v6, s[20:23], s37 offen lds
s_waitcnt vmcnt(12)
ds_read_b64_tr_b16 a[32:33], v7 offset:8192
ds_read_b64_tr_b16 a[34:35], v7 offset:8448
ds_read_b64_tr_b16 a[36:37], v7 offset:10240
ds_read_b64_tr_b16 a[38:39], v7 offset:10496
ds_read_b64_tr_b16 a[104:105], v7 offset:8224
ds_read_b64_tr_b16 a[106:107], v7 offset:8480
ds_read_b64_tr_b16 a[108:109], v7 offset:10272
ds_read_b64_tr_b16 a[110:111], v7 offset:10528
s_waitcnt lgkmcnt(0)
s_add_u32 s37, s40, 1572864
s_add_u32 m0, s38, 4096
s_nop 0
buffer_load_dwordx4 v6, s[20:23], s37 offen lds
s_add_u32 s37, s40, 1703936
s_add_u32 m0, s38, 5120
s_nop 0
buffer_load_dwordx4 v6, s[20:23], s37 offen lds
s_add_u32 s37, s40, 1835008
s_add_u32 m0, s38, 6144
s_nop 0
buffer_load_dwordx4 v6, s[20:23], s37 offen lds
s_add_u32 s37, s40, 1966080
s_add_u32 m0, s38, 7168
s_nop 0
buffer_load_dwordx4 v6, s[20:23], s37 offen lds
s_waitcnt vmcnt(12)
ds_read_b64_tr_b16 a[112:113], v7 offset:12288
ds_read_b64_tr_b16 a[114:115], v7 offset:12544
ds_read_b64_tr_b16 a[116:117], v7 offset:14336
ds_read_b64_tr_b16 a[118:119], v7 offset:14592
ds_read_b64_tr_b16 a[184:185], v7 offset:12320
ds_read_b64_tr_b16 a[186:187], v7 offset:12576
ds_read_b64_tr_b16 a[188:189], v7 offset:14368
ds_read_b64_tr_b16 a[190:191], v7 offset:14624
s_waitcnt lgkmcnt(0)
s_add_u32 s37, s40, 2097152
s_add_u32 m0, s38, 8192
s_nop 0
buffer_load_dwordx4 v6, s[20:23], s37 offen lds
s_add_u32 s37, s40, 2228224
s_add_u32 m0, s38, 9216
s_nop 0
buffer_load_dwordx4 v6, s[20:23], s37 offen lds
s_add_u32 s37, s40, 2359296
s_add_u32 m0, s38, 10240
s_nop 0
buffer_load_dwordx4 v6, s[20:23], s37 offen lds
s_add_u32 s37, s40, 2490368
s_add_u32 m0, s38, 11264
s_nop 0
buffer_load_dwordx4 v6, s[20:23], s37 offen lds
s_waitcnt vmcnt(12)
ds_read_b64_tr_b16 a[120:121], v7 offset:16384
ds_read_b64_tr_b16 a[122:123], v7 offset:16640
ds_read_b64_tr_b16 a[124:125], v7 offset:18432
ds_read_b64_tr_b16 a[126:127], v7 offset:18688
ds_read_b64_tr_b16 a[192:193], v7 offset:16416
ds_read_b64_tr_b16 a[194:195], v7 offset:16672
ds_read_b64_tr_b16 a[196:197], v7 offset:18464
ds_read_b64_tr_b16 a[198:199], v7 offset:18720
s_waitcnt lgkmcnt(0)
s_add_u32 s37, s40, 2621440
s_add_u32 m0, s38, 12288
s_nop 0
buffer_load_dwordx4 v6, s[20:23], s37 offen lds
s_add_u32 s37, s40, 2752512
s_add_u32 m0, s38, 13312
s_nop 0
buffer_load_dwordx4 v6, s[20:23], s37 offen lds
s_add_u32 s37, s40, 2883584
s_add_u32 m0, s38, 14336
s_nop 0
buffer_load_dwordx4 v6, s[20:23], s37 offen lds
s_add_u32 s37, s40, 3014656
s_add_u32 m0, s38, 15360
s_nop 0
buffer_load_dwordx4 v6, s[20:23], s37 offen lds
s_waitcnt vmcnt(12)
ds_read_b64_tr_b16 a[128:129], v7 offset:0
ds_read_b64_tr_b16 a[130:131], v7 offset:256
ds_read_b64_tr_b16 a[132:133], v7 offset:2048
ds_read_b64_tr_b16 a[134:135], v7 offset:2304
ds_read_b64_tr_b16 a[200:201], v7 offset:32
ds_read_b64_tr_b16 a[202:203], v7 offset:288
ds_read_b64_tr_b16 a[204:205], v7 offset:2080
ds_read_b64_tr_b16 a[206:207], v7 offset:2336
s_waitcnt lgkmcnt(0)
s_add_u32 s37, s40, 3145728
s_add_u32 m0, s38, 16384
s_nop 0
buffer_load_dwordx4 v6, s[20:23], s37 offen lds
s_add_u32 s37, s40, 3276800
s_add_u32 m0, s38, 17408
s_nop 0
buffer_load_dwordx4 v6, s[20:23], s37 offen lds
s_add_u32 s37, s40, 3407872
s_add_u32 m0, s38, 18432
s_nop 0
buffer_load_dwordx4 v6, s[20:23], s37 offen lds
s_add_u32 s37, s40, 3538944
s_add_u32 m0, s38, 19456
s_nop 0
buffer_load_dwordx4 v6, s[20:23], s37 offen lds
s_waitcnt vmcnt(12)
ds_read_b64_tr_b16 a[136:137], v7 offset:4096
ds_read_b64_tr_b16 a[138:139], v7 offset:4352
ds_read_b64_tr_b16 a[140:141], v7 offset:6144
ds_read_b64_tr_b16 a[142:143], v7 offset:6400
ds_read_b64_tr_b16 a[208:209], v7 offset:4128
ds_read_b64_tr_b16 a[210:211], v7 offset:4384
ds_read_b64_tr_b16 a[212:213], v7 offset:6176
ds_read_b64_tr_b16 a[214:215], v7 offset:6432
s_waitcnt lgkmcnt(0)
s_add_u32 s37, s40, 3670016
s_add_u32 m0, s38, 0
s_nop 0
buffer_load_dwordx4 v6, s[20:23], s37 offen lds
s_add_u32 s37, s40, 3801088
s_add_u32 m0, s38, 1024
s_nop 0
buffer_load_dwordx4 v6, s[20:23], s37 offen lds
s_add_u32 s37, s40, 3932160
s_add_u32 m0, s38, 2048
s_nop 0
buffer_load_dwordx4 v6, s[20:23], s37 offen lds
s_add_u32 s37, s40, 4063232
s_add_u32 m0, s38, 3072
s_nop 0
buffer_load_dwordx4 v6, s[20:23], s37 offen lds
s_waitcnt vmcnt(12)
ds_read_b64_tr_b16 a[144:145], v7 offset:8192
ds_read_b64_tr_b16 a[146:147], v7 offset:8448
ds_read_b64_tr_b16 a[148:149], v7 offset:10240
ds_read_b64_tr_b16 a[150:151], v7 offset:10496
ds_read_b64_tr_b16 a[216:217], v7 offset:8224
ds_read_b64_tr_b16 a[218:219], v7 offset:8480
ds_read_b64_tr_b16 a[220:221], v7 offset:10272
ds_read_b64_tr_b16 a[222:223], v7 offset:10528
s_waitcnt lgkmcnt(0)
s_add_u32 s37, s40, 4194304
s_add_u32 m0, s38, 4096
s_nop 0
buffer_load_dwordx4 v6, s[20:23], s37 offen lds
s_add_u32 s37, s40, 4325376
s_add_u32 m0, s38, 5120
s_nop 0
buffer_load_dwordx4 v6, s[20:23], s37 offen lds
s_add_u32 s37, s40, 4456448
s_add_u32 m0, s38, 6144
s_nop 0
buffer_load_dwordx4 v6, s[20:23], s37 offen lds
s_add_u32 s37, s40, 4587520
s_add_u32 m0, s38, 7168
s_nop 0
buffer_load_dwordx4 v6, s[20:23], s37 offen lds
s_waitcnt vmcnt(12)
ds_read_b64_tr_b16 a[152:153], v7 offset:12288
ds_read_b64_tr_b16 a[154:155], v7 offset:12544
ds_read_b64_tr_b16 a[156:157], v7 offset:14336
ds_read_b64_tr_b16 a[158:159], v7 offset:14592
ds_read_b64_tr_b16 a[224:225], v7 offset:12320
ds_read_b64_tr_b16 a[226:227], v7 offset:12576
ds_read_b64_tr_b16 a[228:229], v7 offset:14368
ds_read_b64_tr_b16 a[230:231], v7 offset:14624
s_waitcnt lgkmcnt(0)
s_waitcnt vmcnt(8)
ds_read_b64_tr_b16 a[160:161], v7 offset:16384
ds_read_b64_tr_b16 a[162:163], v7 offset:16640
ds_read_b64_tr_b16 a[164:165], v7 offset:18432
ds_read_b64_tr_b16 a[166:167], v7 offset:18688
ds_read_b64_tr_b16 a[232:233], v7 offset:16416
ds_read_b64_tr_b16 a[234:235], v7 offset:16672
ds_read_b64_tr_b16 a[236:237], v7 offset:18464
ds_read_b64_tr_b16 a[238:239], v7 offset:18720
s_waitcnt lgkmcnt(0)
s_waitcnt vmcnt(4)
ds_read_b64_tr_b16 a[168:169], v7 offset:0
ds_read_b64_tr_b16 a[170:171], v7 offset:256
ds_read_b64_tr_b16 a[172:173], v7 offset:2048
ds_read_b64_tr_b16 a[174:175], v7 offset:2304
ds_read_b64_tr_b16 a[240:241], v7 offset:32
ds_read_b64_tr_b16 a[242:243], v7 offset:288
ds_read_b64_tr_b16 a[244:245], v7 offset:2080
ds_read_b64_tr_b16 a[246:247], v7 offset:2336
s_waitcnt lgkmcnt(0)
s_waitcnt vmcnt(0)
ds_read_b64_tr_b16 a[176:177], v7 offset:4096
ds_read_b64_tr_b16 a[178:179], v7 offset:4352
ds_read_b64_tr_b16 a[180:181], v7 offset:6144
ds_read_b64_tr_b16 a[182:183], v7 offset:6400
ds_read_b64_tr_b16 a[248:249], v7 offset:4128
ds_read_b64_tr_b16 a[250:251], v7 offset:4384
ds_read_b64_tr_b16 a[252:253], v7 offset:6176
ds_read_b64_tr_b16 a[254:255], v7 offset:6432
s_waitcnt lgkmcnt(0)
s_lshl_b32 s42, s33, 5
s_add_u32 s42, s42, s32
s_lshl_b32 s39, s42, 13
s_lshl_b32 s37, s34, 11
s_add_u32 s39, s39, s37
s_add_u32 s39, s39, 50331648
s_lshl_b32 s40, s42, 14
s_add_u32 s40, s40, 16777216
s_lshl_b32 s37, s34, 12
s_add_u32 s41, s40, s37
s_lshr_b32 s37, s34, 1
s_lshl_b32 s37, s37, 10
s_add_u32 s40, s40, s37
s_and_b32 s37, s34, 1
s_lshl_b32 s37, s37, 6
s_add_u32 s40, s40, s37
s_mov_b32 s35, 0
s_mov_b32 s48, 36864
s_waitcnt vmcnt(0)
.p2align 6
L_q_loop:
s_waitcnt vmcnt(6)
s_barrier
s_add_u32 s43, s43, 147456
s_add_u32 s44, s44, s48
ds_read_b128 v[64:67], v3 offset:0
ds_read_b128 v[68:71], v3 offset:1024
ds_read_b128 v[72:75], v3 offset:2048
ds_read_b128 v[76:79], v3 offset:3072
s_waitcnt lgkmcnt(2)
v_mfma_f32_16x16x32_bf16 v[16:19], v[80:83], v[64:67], 0
v_mfma_f32_16x16x32_bf16 v[20:23], v[80:83], v[68:71], 0
v_mfma_f32_16x16x32_bf16 v[24:27], v[152:155], v[64:67], 0
v_mfma_f32_16x16x32_bf16 v[28:31], v[152:155], v[68:71], 0
s_add_u32 s37, s43, 0
s_add_u32 m0, s44, 0
s_nop 0
buffer_load_dwordx4 v2, s[8:11], s37 offen lds
v_mfma_f32_16x16x32_bf16 v[32:35], v[224:227], v[64:67], 0
v_mfma_f32_16x16x32_bf16 v[36:39], v[224:227], v[68:71], 0
v_mfma_f32_16x16x32_bf16 v[40:43], a[40:43], v[64:67], 0
v_mfma_f32_16x16x32_bf16 v[44:47], a[40:43], v[68:71], 0
v_mfma_f32_16x16x32_bf16 v[48:51], v[64:67], a[112:115], 0
v_mfma_f32_16x16x32_bf16 v[52:55], v[68:71], a[112:115], 0
v_mfma_f32_16x16x32_bf16 v[56:59], v[64:67], a[184:187], 0
v_mfma_f32_16x16x32_bf16 v[60:63], v[68:71], a[184:187], 0
ds_read_b128 v[64:67], v3 offset:4096
ds_read_b128 v[68:71], v3 offset:5120
s_waitcnt lgkmcnt(2)
v_mfma_f32_16x16x32_bf16 v[16:19], v[84:87], v[72:75], v[16:19]
v_mfma_f32_16x16x32_bf16 v[20:23], v[84:87], v[76:79], v[20:23]
v_mfma_f32_16x16x32_bf16 v[24:27], v[156:159], v[72:75], v[24:27]
v_mfma_f32_16x16x32_bf16 v[28:31], v[156:159], v[76:79], v[28:31]
s_add_u32 s37, s43, 128
s_add_u32 m0, s44, 4096
s_nop 0
buffer_load_dwordx4 v2, s[8:11], s37 offen lds
v_mfma_f32_16x16x32_bf16 v[32:35], v[228:231], v[72:75], v[32:35]
v_mfma_f32_16x16x32_bf16 v[36:39], v[228:231], v[76:79], v[36:39]
v_mfma_f32_16x16x32_bf16 v[40:43], a[44:47], v[72:75], v[40:43]
v_mfma_f32_16x16x32_bf16 v[44:47], a[44:47], v[76:79], v[44:47]
v_mfma_f32_16x16x32_bf16 v[48:51], v[72:75], a[116:119], v[48:51]
v_mfma_f32_16x16x32_bf16 v[52:55], v[76:79], a[116:119], v[52:55]
v_mfma_f32_16x16x32_bf16 v[56:59], v[72:75], a[188:191], v[56:59]
v_mfma_f32_16x16x32_bf16 v[60:63], v[76:79], a[188:191], v[60:63]
ds_read_b128 v[72:75], v3 offset:6144
ds_read_b128 v[76:79], v3 offset:7168
s_waitcnt lgkmcnt(2)
v_mfma_f32_16x16x32_bf16 v[16:19], v[88:91], v[64:67], v[16:19]
v_mfma_f32_16x16x32_bf16 v[20:23], v[88:91], v[68:71], v[20:23]
v_mfma_f32_16x16x32_bf16 v[24:27], v[160:163], v[64:67], v[24:27]
v_mfma_f32_16x16x32_bf16 v[28:31], v[160:163], v[68:71], v[28:31]
s_add_u32 s37, s43, 256
s_add_u32 m0, s44, 8192
s_nop 0
buffer_load_dwordx4 v2, s[8:11], s37 offen lds
v_mfma_f32_16x16x32_bf16 v[32:35], v[232:235], v[64:67], v[32:35]
v_mfma_f32_16x16x32_bf16 v[36:39], v[232:235], v[68:71], v[36:39]
v_mfma_f32_16x16x32_bf16 v[40:43], a[48:51], v[64:67], v[40:43]
v_mfma_f32_16x16x32_bf16 v[44:47], a[48:51], v[68:71], v[44:47]
v_mfma_f32_16x16x32_bf16 v[48:51], v[64:67], a[120:123], v[48:51]
v_mfma_f32_16x16x32_bf16 v[52:55], v[68:71], a[120:123], v[52:55]
v_mfma_f32_16x16x32_bf16 v[56:59], v[64:67], a[192:195], v[56:59]
v_mfma_f32_16x16x32_bf16 v[60:63], v[68:71], a[192:195], v[60:63]
ds_read_b128 v[64:67], v3 offset:8192
ds_read_b128 v[68:71], v3 offset:9216
s_waitcnt lgkmcnt(2)
v_mfma_f32_16x16x32_bf16 v[16:19], v[92:95], v[72:75], v[16:19]
v_mfma_f32_16x16x32_bf16 v[20:23], v[92:95], v[76:79], v[20:23]
v_mfma_f32_16x16x32_bf16 v[24:27], v[164:167], v[72:75], v[24:27]
v_mfma_f32_16x16x32_bf16 v[28:31], v[164:167], v[76:79], v[28:31]
s_add_u32 s37, s43, 384
s_add_u32 m0, s44, 12288
s_nop 0
buffer_load_dwordx4 v2, s[8:11], s37 offen lds
v_mfma_f32_16x16x32_bf16 v[32:35], v[236:239], v[72:75], v[32:35]
v_mfma_f32_16x16x32_bf16 v[36:39], v[236:239], v[76:79], v[36:39]
v_mfma_f32_16x16x32_bf16 v[40:43], a[52:55], v[72:75], v[40:43]
v_mfma_f32_16x16x32_bf16 v[44:47], a[52:55], v[76:79], v[44:47]
v_mfma_f32_16x16x32_bf16 v[48:51], v[72:75], a[124:127], v[48:51]
v_mfma_f32_16x16x32_bf16 v[52:55], v[76:79], a[124:127], v[52:55]
v_mfma_f32_16x16x32_bf16 v[56:59], v[72:75], a[196:199], v[56:59]
v_mfma_f32_16x16x32_bf16 v[60:63], v[76:79], a[196:199], v[60:63]
ds_read_b128 v[72:75], v3 offset:10240
ds_read_b128 v[76:79], v3 offset:11264
s_waitcnt lgkmcnt(2)
v_mfma_f32_16x16x32_bf16 v[16:19], v[96:99], v[64:67], v[16:19]
v_mfma_f32_16x16x32_bf16 v[20:23], v[96:99], v[68:71], v[20:23]
v_mfma_f32_16x16x32_bf16 v[24:27], v[168:171], v[64:67], v[24:27]
v_mfma_f32_16x16x32_bf16 v[28:31], v[168:171], v[68:71], v[28:31]
s_add_u32 s37, s43, 512
s_add_u32 m0, s44, 16384
s_nop 0
buffer_load_dwordx4 v2, s[8:11], s37 offen lds
v_mfma_f32_16x16x32_bf16 v[32:35], v[240:243], v[64:67], v[32:35]
v_mfma_f32_16x16x32_bf16 v[36:39], v[240:243], v[68:71], v[36:39]
v_mfma_f32_16x16x32_bf16 v[40:43], a[56:59], v[64:67], v[40:43]
v_mfma_f32_16x16x32_bf16 v[44:47], a[56:59], v[68:71], v[44:47]
v_mfma_f32_16x16x32_bf16 v[48:51], v[64:67], a[128:131], v[48:51]
v_mfma_f32_16x16x32_bf16 v[52:55], v[68:71], a[128:131], v[52:55]
v_mfma_f32_16x16x32_bf16 v[56:59], v[64:67], a[200:203], v[56:59]
v_mfma_f32_16x16x32_bf16 v[60:63], v[68:71], a[200:203], v[60:63]
ds_read_b128 v[64:67], v3 offset:12288
ds_read_b128 v[68:71], v3 offset:13312
s_waitcnt lgkmcnt(2)
v_mfma_f32_16x16x32_bf16 v[16:19], v[100:103], v[72:75], v[16:19]
v_mfma_f32_16x16x32_bf16 v[20:23], v[100:103], v[76:79], v[20:23]
v_mfma_f32_16x16x32_bf16 v[24:27], v[172:175], v[72:75], v[24:27]
v_mfma_f32_16x16x32_bf16 v[28:31], v[172:175], v[76:79], v[28:31]
s_add_u32 s37, s43, 640
s_add_u32 m0, s44, 20480
s_nop 0
buffer_load_dwordx4 v2, s[8:11], s37 offen lds
v_mfma_f32_16x16x32_bf16 v[32:35], v[244:247], v[72:75], v[32:35]
v_mfma_f32_16x16x32_bf16 v[36:39], v[244:247], v[76:79], v[36:39]
v_mfma_f32_16x16x32_bf16 v[40:43], a[60:63], v[72:75], v[40:43]
v_mfma_f32_16x16x32_bf16 v[44:47], a[60:63], v[76:79], v[44:47]
v_mfma_f32_16x16x32_bf16 v[48:51], v[72:75], a[132:135], v[48:51]
v_mfma_f32_16x16x32_bf16 v[52:55], v[76:79], a[132:135], v[52:55]
v_mfma_f32_16x16x32_bf16 v[56:59], v[72:75], a[204:207], v[56:59]
v_mfma_f32_16x16x32_bf16 v[60:63], v[76:79], a[204:207], v[60:63]
ds_read_b128 v[72:75], v3 offset:14336
ds_read_b128 v[76:79], v3 offset:15360
s_waitcnt lgkmcnt(2)
v_mfma_f32_16x16x32_bf16 v[16:19], v[104:107], v[64:67], v[16:19]
v_mfma_f32_16x16x32_bf16 v[20:23], v[104:107], v[68:71], v[20:23]
v_mfma_f32_16x16x32_bf16 v[24:27], v[176:179], v[64:67], v[24:27]
v_mfma_f32_16x16x32_bf16 v[28:31], v[176:179], v[68:71], v[28:31]
s_add_u32 s37, s43, 768
s_add_u32 m0, s44, 24576
s_nop 0
buffer_load_dwordx4 v2, s[8:11], s37 offen lds
v_mfma_f32_16x16x32_bf16 v[32:35], v[248:251], v[64:67], v[32:35]
v_mfma_f32_16x16x32_bf16 v[36:39], v[248:251], v[68:71], v[36:39]
v_mfma_f32_16x16x32_bf16 v[40:43], a[64:67], v[64:67], v[40:43]
v_mfma_f32_16x16x32_bf16 v[44:47], a[64:67], v[68:71], v[44:47]
v_mfma_f32_16x16x32_bf16 v[48:51], v[64:67], a[136:139], v[48:51]
v_mfma_f32_16x16x32_bf16 v[52:55], v[68:71], a[136:139], v[52:55]
v_mfma_f32_16x16x32_bf16 v[56:59], v[64:67], a[208:211], v[56:59]
v_mfma_f32_16x16x32_bf16 v[60:63], v[68:71], a[208:211], v[60:63]
ds_read_b128 v[64:67], v3 offset:16384
ds_read_b128 v[68:71], v3 offset:17408
s_waitcnt lgkmcnt(2)
v_mfma_f32_16x16x32_bf16 v[16:19], v[108:111], v[72:75], v[16:19]
v_mfma_f32_16x16x32_bf16 v[20:23], v[108:111], v[76:79], v[20:23]
v_mfma_f32_16x16x32_bf16 v[24:27], v[180:183], v[72:75], v[24:27]
v_mfma_f32_16x16x32_bf16 v[28:31], v[180:183], v[76:79], v[28:31]
s_add_u32 s37, s43, 896
s_add_u32 m0, s44, 28672
s_nop 0
buffer_load_dwordx4 v2, s[8:11], s37 offen lds
v_mfma_f32_16x16x32_bf16 v[32:35], v[252:255], v[72:75], v[32:35]
v_mfma_f32_16x16x32_bf16 v[36:39], v[252:255], v[76:79], v[36:39]
v_mfma_f32_16x16x32_bf16 v[40:43], a[68:71], v[72:75], v[40:43]
v_mfma_f32_16x16x32_bf16 v[44:47], a[68:71], v[76:79], v[44:47]
v_mfma_f32_16x16x32_bf16 v[48:51], v[72:75], a[140:143], v[48:51]
v_mfma_f32_16x16x32_bf16 v[52:55], v[76:79], a[140:143], v[52:55]
v_mfma_f32_16x16x32_bf16 v[56:59], v[72:75], a[212:215], v[56:59]
v_mfma_f32_16x16x32_bf16 v[60:63], v[76:79], a[212:215], v[60:63]
ds_read_b128 v[72:75], v3 offset:18432
ds_read_b128 v[76:79], v3 offset:19456
s_waitcnt lgkmcnt(2)
v_mfma_f32_16x16x32_bf16 v[16:19], v[112:115], v[64:67], v[16:19]
v_mfma_f32_16x16x32_bf16 v[20:23], v[112:115], v[68:71], v[20:23]
v_mfma_f32_16x16x32_bf16 v[24:27], v[184:187], v[64:67], v[24:27]
v_mfma_f32_16x16x32_bf16 v[28:31], v[184:187], v[68:71], v[28:31]
s_add_u32 s37, s43, 1024
s_add_u32 m0, s44, 32768
s_nop 0
buffer_load_dwordx4 v2, s[8:11], s37 offen lds
v_mfma_f32_16x16x32_bf16 v[32:35], a[0:3], v[64:67], v[32:35]
v_mfma_f32_16x16x32_bf16 v[36:39], a[0:3], v[68:71], v[36:39]
v_mfma_f32_16x16x32_bf16 v[40:43], a[72:75], v[64:67], v[40:43]
v_mfma_f32_16x16x32_bf16 v[44:47], a[72:75], v[68:71], v[44:47]
v_mfma_f32_16x16x32_bf16 v[48:51], v[64:67], a[144:147], v[48:51]
v_mfma_f32_16x16x32_bf16 v[52:55], v[68:71], a[144:147], v[52:55]
v_mfma_f32_16x16x32_bf16 v[56:59], v[64:67], a[216:219], v[56:59]
v_mfma_f32_16x16x32_bf16 v[60:63], v[68:71], a[216:219], v[60:63]
ds_read_b128 v[64:67], v3 offset:20480
ds_read_b128 v[68:71], v3 offset:21504
s_waitcnt lgkmcnt(2)
v_mfma_f32_16x16x32_bf16 v[16:19], v[116:119], v[72:75], v[16:19]
v_mfma_f32_16x16x32_bf16 v[20:23], v[116:119], v[76:79], v[20:23]
v_mfma_f32_16x16x32_bf16 v[24:27], v[188:191], v[72:75], v[24:27]
v_mfma_f32_16x16x32_bf16 v[28:31], v[188:191], v[76:79], v[28:31]
v_mfma_f32_16x16x32_bf16 v[32:35], a[4:7], v[72:75], v[32:35]
v_mfma_f32_16x16x32_bf16 v[36:39], a[4:7], v[76:79], v[36:39]
v_mfma_f32_16x16x32_bf16 v[40:43], a[76:79], v[72:75], v[40:43]
v_mfma_f32_16x16x32_bf16 v[44:47], a[76:79], v[76:79], v[44:47]
v_mfma_f32_16x16x32_bf16 v[48:51], v[72:75], a[148:151], v[48:51]
v_mfma_f32_16x16x32_bf16 v[52:55], v[76:79], a[148:151], v[52:55]
v_mfma_f32_16x16x32_bf16 v[56:59], v[72:75], a[220:223], v[56:59]
v_mfma_f32_16x16x32_bf16 v[60:63], v[76:79], a[220:223], v[60:63]
ds_read_b128 v[72:75], v3 offset:22528
ds_read_b128 v[76:79], v3 offset:23552
s_waitcnt lgkmcnt(2)
v_mfma_f32_16x16x32_bf16 v[16:19], v[120:123], v[64:67], v[16:19]
v_mfma_f32_16x16x32_bf16 v[20:23], v[120:123], v[68:71], v[20:23]
v_mfma_f32_16x16x32_bf16 v[24:27], v[192:195], v[64:67], v[24:27]
v_mfma_f32_16x16x32_bf16 v[28:31], v[192:195], v[68:71], v[28:31]
v_mfma_f32_16x16x32_bf16 v[32:35], a[8:11], v[64:67], v[32:35]
v_mfma_f32_16x16x32_bf16 v[36:39], a[8:11], v[68:71], v[36:39]
v_mfma_f32_16x16x32_bf16 v[40:43], a[80:83], v[64:67], v[40:43]
v_mfma_f32_16x16x32_bf16 v[44:47], a[80:83], v[68:71], v[44:47]
v_mfma_f32_16x16x32_bf16 v[48:51], v[64:67], a[152:155], v[48:51]
v_mfma_f32_16x16x32_bf16 v[52:55], v[68:71], a[152:155], v[52:55]
v_mfma_f32_16x16x32_bf16 v[56:59], v[64:67], a[224:227], v[56:59]
v_mfma_f32_16x16x32_bf16 v[60:63], v[68:71], a[224:227], v[60:63]
ds_read_b128 v[64:67], v3 offset:24576
ds_read_b128 v[68:71], v3 offset:25600
s_waitcnt lgkmcnt(2)
v_mfma_f32_16x16x32_bf16 v[16:19], v[124:127], v[72:75], v[16:19]
v_mfma_f32_16x16x32_bf16 v[20:23], v[124:127], v[76:79], v[20:23]
v_mfma_f32_16x16x32_bf16 v[24:27], v[196:199], v[72:75], v[24:27]
v_mfma_f32_16x16x32_bf16 v[28:31], v[196:199], v[76:79], v[28:31]
v_mfma_f32_16x16x32_bf16 v[32:35], a[12:15], v[72:75], v[32:35]
v_mfma_f32_16x16x32_bf16 v[36:39], a[12:15], v[76:79], v[36:39]
v_mfma_f32_16x16x32_bf16 v[40:43], a[84:87], v[72:75], v[40:43]
v_mfma_f32_16x16x32_bf16 v[44:47], a[84:87], v[76:79], v[44:47]
v_mfma_f32_16x16x32_bf16 v[48:51], v[72:75], a[156:159], v[48:51]
v_mfma_f32_16x16x32_bf16 v[52:55], v[76:79], a[156:159], v[52:55]
v_mfma_f32_16x16x32_bf16 v[56:59], v[72:75], a[228:231], v[56:59]
v_mfma_f32_16x16x32_bf16 v[60:63], v[76:79], a[228:231], v[60:63]
ds_read_b128 v[72:75], v3 offset:26624
ds_read_b128 v[76:79], v3 offset:27648
s_waitcnt lgkmcnt(2)
v_mfma_f32_16x16x32_bf16 v[16:19], v[128:131], v[64:67], v[16:19]
v_mfma_f32_16x16x32_bf16 v[20:23], v[128:131], v[68:71], v[20:23]
v_mfma_f32_16x16x32_bf16 v[24:27], v[200:203], v[64:67], v[24:27]
v_mfma_f32_16x16x32_bf16 v[28:31], v[200:203], v[68:71], v[28:31]
v_mfma_f32_16x16x32_bf16 v[32:35], a[16:19], v[64:67], v[32:35]
v_mfma_f32_16x16x32_bf16 v[36:39], a[16:19], v[68:71], v[36:39]
v_mfma_f32_16x16x32_bf16 v[40:43], a[88:91], v[64:67], v[40:43]
v_mfma_f32_16x16x32_bf16 v[44:47], a[88:91], v[68:71], v[44:47]
v_mfma_f32_16x16x32_bf16 v[48:51], v[64:67], a[160:163], v[48:51]
v_mfma_f32_16x16x32_bf16 v[52:55], v[68:71], a[160:163], v[52:55]
v_mfma_f32_16x16x32_bf16 v[56:59], v[64:67], a[232:235], v[56:59]
v_mfma_f32_16x16x32_bf16 v[60:63], v[68:71], a[232:235], v[60:63]
ds_read_b128 v[64:67], v3 offset:28672
ds_read_b128 v[68:71], v3 offset:29696
s_waitcnt lgkmcnt(2)
v_mfma_f32_16x16x32_bf16 v[16:19], v[132:135], v[72:75], v[16:19]
v_mfma_f32_16x16x32_bf16 v[20:23], v[132:135], v[76:79], v[20:23]
v_mfma_f32_16x16x32_bf16 v[24:27], v[204:207], v[72:75], v[24:27]
v_mfma_f32_16x16x32_bf16 v[28:31], v[204:207], v[76:79], v[28:31]
v_mfma_f32_16x16x32_bf16 v[32:35], a[20:23], v[72:75], v[32:35]
v_mfma_f32_16x16x32_bf16 v[36:39], a[20:23], v[76:79], v[36:39]
v_mfma_f32_16x16x32_bf16 v[40:43], a[92:95], v[72:75], v[40:43]
v_mfma_f32_16x16x32_bf16 v[44:47], a[92:95], v[76:79], v[44:47]
v_mfma_f32_16x16x32_bf16 v[48:51], v[72:75], a[164:167], v[48:51]
v_mfma_f32_16x16x32_bf16 v[52:55], v[76:79], a[164:167], v[52:55]
v_mfma_f32_16x16x32_bf16 v[56:59], v[72:75], a[236:239], v[56:59]
v_mfma_f32_16x16x32_bf16 v[60:63], v[76:79], a[236:239], v[60:63]
ds_read_b128 v[72:75], v3 offset:30720
ds_read_b128 v[76:79], v3 offset:31744
s_waitcnt lgkmcnt(2)
v_mfma_f32_16x16x32_bf16 v[16:19], v[136:139], v[64:67], v[16:19]
v_mfma_f32_16x16x32_bf16 v[20:23], v[136:139], v[68:71], v[20:23]
v_mfma_f32_16x16x32_bf16 v[24:27], v[208:211], v[64:67], v[24:27]
v_mfma_f32_16x16x32_bf16 v[28:31], v[208:211], v[68:71], v[28:31]
v_mfma_f32_16x16x32_bf16 v[32:35], a[24:27], v[64:67], v[32:35]
v_mfma_f32_16x16x32_bf16 v[36:39], a[24:27], v[68:71], v[36:39]
v_mfma_f32_16x16x32_bf16 v[40:43], a[96:99], v[64:67], v[40:43]
v_mfma_f32_16x16x32_bf16 v[44:47], a[96:99], v[68:71], v[44:47]
v_mfma_f32_16x16x32_bf16 v[48:51], v[64:67], a[168:171], v[48:51]
v_mfma_f32_16x16x32_bf16 v[52:55], v[68:71], a[168:171], v[52:55]
v_mfma_f32_16x16x32_bf16 v[56:59], v[64:67], a[240:243], v[56:59]
v_mfma_f32_16x16x32_bf16 v[60:63], v[68:71], a[240:243], v[60:63]
ds_read_b128 v[64:67], v3 offset:32768
ds_read_b128 v[68:71], v3 offset:33792
s_waitcnt lgkmcnt(2)
v_mfma_f32_16x16x32_bf16 v[16:19], v[140:143], v[72:75], v[16:19]
v_mfma_f32_16x16x32_bf16 v[20:23], v[140:143], v[76:79], v[20:23]
v_mfma_f32_16x16x32_bf16 v[24:27], v[212:215], v[72:75], v[24:27]
v_mfma_f32_16x16x32_bf16 v[28:31], v[212:215], v[76:79], v[28:31]
v_mfma_f32_16x16x32_bf16 v[32:35], a[28:31], v[72:75], v[32:35]
v_mfma_f32_16x16x32_bf16 v[36:39], a[28:31], v[76:79], v[36:39]
v_mfma_f32_16x16x32_bf16 v[40:43], a[100:103], v[72:75], v[40:43]
v_mfma_f32_16x16x32_bf16 v[44:47], a[100:103], v[76:79], v[44:47]
v_mfma_f32_16x16x32_bf16 v[48:51], v[72:75], a[172:175], v[48:51]
v_mfma_f32_16x16x32_bf16 v[52:55], v[76:79], a[172:175], v[52:55]
v_mfma_f32_16x16x32_bf16 v[56:59], v[72:75], a[244:247], v[56:59]
v_mfma_f32_16x16x32_bf16 v[60:63], v[76:79], a[244:247], v[60:63]
ds_read_b128 v[72:75], v3 offset:34816
ds_read_b128 v[76:79], v3 offset:35840
s_waitcnt lgkmcnt(2)
v_mfma_f32_16x16x32_bf16 v[16:19], v[144:147], v[64:67], v[16:19]
v_mfma_f32_16x16x32_bf16 v[20:23], v[144:147], v[68:71], v[20:23]
v_mfma_f32_16x16x32_bf16 v[24:27], v[216:219], v[64:67], v[24:27]
v_mfma_f32_16x16x32_bf16 v[28:31], v[216:219], v[68:71], v[28:31]
v_mfma_f32_16x16x32_bf16 v[32:35], a[32:35], v[64:67], v[32:35]
v_mfma_f32_16x16x32_bf16 v[36:39], a[32:35], v[68:71], v[36:39]
v_mfma_f32_16x16x32_bf16 v[40:43], a[104:107], v[64:67], v[40:43]
v_mfma_f32_16x16x32_bf16 v[44:47], a[104:107], v[68:71], v[44:47]
v_mfma_f32_16x16x32_bf16 v[48:51], v[64:67], a[176:179], v[48:51]
v_mfma_f32_16x16x32_bf16 v[52:55], v[68:71], a[176:179], v[52:55]
v_mfma_f32_16x16x32_bf16 v[56:59], v[64:67], a[248:251], v[56:59]
v_mfma_f32_16x16x32_bf16 v[60:63], v[68:71], a[248:251], v[60:63]
s_waitcnt lgkmcnt(0)
v_mfma_f32_16x16x32_bf16 v[16:19], v[148:151], v[72:75], v[16:19]
v_mfma_f32_16x16x32_bf16 v[20:23], v[148:151], v[76:79], v[20:23]
v_mfma_f32_16x16x32_bf16 v[24:27], v[220:223], v[72:75], v[24:27]
v_mfma_f32_16x16x32_bf16 v[28:31], v[220:223], v[76:79], v[28:31]
v_mfma_f32_16x16x32_bf16 v[32:35], a[36:39], v[72:75], v[32:35]
v_mfma_f32_16x16x32_bf16 v[36:39], a[36:39], v[76:79], v[36:39]
v_mfma_f32_16x16x32_bf16 v[40:43], a[108:111], v[72:75], v[40:43]
v_mfma_f32_16x16x32_bf16 v[44:47], a[108:111], v[76:79], v[44:47]
v_mfma_f32_16x16x32_bf16 v[48:51], v[72:75], a[180:183], v[48:51]
v_mfma_f32_16x16x32_bf16 v[52:55], v[76:79], a[180:183], v[52:55]
v_mfma_f32_16x16x32_bf16 v[56:59], v[72:75], a[252:255], v[56:59]
v_mfma_f32_16x16x32_bf16 v[60:63], v[76:79], a[252:255], v[60:63]
v_add_u32 v3, s48, v3
s_sub_u32 s48, 0, s48
v_cvt_pk_bf16_f32 v64, v16, v17
v_cvt_pk_bf16_f32 v65, v18, v19
v_cvt_pk_bf16_f32 v66, v24, v25
v_cvt_pk_bf16_f32 v67, v26, v27
buffer_store_dwordx4 v[64:67], v1, s[4:7], s39 offen offset:0
v_cvt_pk_bf16_f32 v68, v20, v21
v_cvt_pk_bf16_f32 v69, v22, v23
v_cvt_pk_bf16_f32 v70, v28, v29
v_cvt_pk_bf16_f32 v71, v30, v31
buffer_store_dwordx4 v[68:71], v1, s[4:7], s39 offen offset:1024
v_pk_mul_f32 v[32:33], v[32:33], s[46:47]
v_pk_mul_f32 v[34:35], v[34:35], s[46:47]
v_pk_mul_f32 v[36:37], v[36:37], s[46:47]
v_pk_mul_f32 v[38:39], v[38:39], s[46:47]
v_pk_mul_f32 v[40:41], v[40:41], s[46:47]
v_pk_mul_f32 v[42:43], v[42:43], s[46:47]
v_pk_mul_f32 v[44:45], v[44:45], s[46:47]
v_pk_mul_f32 v[46:47], v[46:47], s[46:47]
v_cvt_pk_bf16_f32 v72, v32, v33
v_cvt_pk_bf16_f32 v73, v34, v35
v_cvt_pk_bf16_f32 v74, v40, v41
v_cvt_pk_bf16_f32 v75, v42, v43
buffer_store_dwordx4 v[72:75], v4, s[4:7], s40 offen offset:0 sc0 sc1
v_cvt_pk_bf16_f32 v76, v36, v37
v_cvt_pk_bf16_f32 v77, v38, v39
v_cvt_pk_bf16_f32 v78, v44, v45
v_cvt_pk_bf16_f32 v79, v46, v47
buffer_store_dwordx4 v[76:79], v4, s[4:7], s40 offen offset:128 sc0 sc1
v_cvt_pk_bf16_f32 v16, v48, v49
v_cvt_pk_bf16_f32 v17, v50, v51
v_cvt_pk_bf16_f32 v18, v52, v53
v_cvt_pk_bf16_f32 v19, v54, v55
buffer_store_dwordx4 v[16:19], v1, s[4:7], s41 offen offset:2048 sc0 sc1
v_cvt_pk_bf16_f32 v20, v56, v57
v_cvt_pk_bf16_f32 v21, v58, v59
v_cvt_pk_bf16_f32 v22, v60, v61
v_cvt_pk_bf16_f32 v23, v62, v63
buffer_store_dwordx4 v[20:23], v1, s[4:7], s41 offen offset:3072 sc0 sc1
s_add_u32 s39, s39, 1048576
s_add_u32 s40, s40, 2097152
s_add_u32 s41, s41, 2097152
s_add_u32 s35, s35, 1
s_cmp_eq_u32 s35, 6
s_cbranch_scc1 L_q_sig
s_cmp_lt_u32 s35, 16
s_cbranch_scc1 L_q_loop
L_q_sig:
s_waitcnt vmcnt(0)
s_barrier
s_cmp_lg_u32 s34, 0
s_cbranch_scc1 L_q_sig2
s_cmp_eq_u32 s35, 6
s_cselect_b32 s37, 1, 256
v_mov_b32 v12, s37
s_lshl_b32 s37, s32, 2
s_mov_b64 exec, 1
buffer_atomic_add v12, v8, s[24:27], s37 offen offset:128 sc1
s_mov_b64 exec, -1
s_waitcnt vmcnt(0)
L_q_sig2:
s_cmp_lt_u32 s35, 16
s_cbranch_scc1 L_q_loop
s_branch L_q_init_in
L_q_init:
s_sleep 4
L_q_init_in:
buffer_load_dword v12, v8, s[24:27], 0 offen offset:0 sc0 sc1
s_sub_u32 s36, s36, 1
s_cbranch_scc1 L_exit_w
s_waitcnt vmcnt(0)
v_readfirstlane_b32 s37, v12
s_nop 0
s_and_b32 s37, s37, 0xff
s_cmp_eq_u32 s37, 32
s_cbranch_scc0 L_q_init
s_lshr_b32 s37, s34, 1
s_and_b32 s38, s34, 1
s_lshl_b32 s50, s42, 13
s_lshl_b32 s39, s37, 10
s_add_u32 s50, s50, s39
s_add_u32 s50, s50, 50331648
s_lshl_b32 s52, s42, 14
s_add_u32 s52, s52, 16777216
s_lshl_b32 s39, s38, 13
s_add_u32 s53, s52, s39
s_lshl_b32 s55, s42, 12
s_lshl_b32 s39, s34, 10
s_add_u32 s55, s55, s39
s_add_u32 s55, s55, 8388608
s_mov_b32 s60, s39
s_lshl_b32 s39, s33, 1
s_add_u32 s39, s39, s37
s_lshl_b32 s56, s39, 6
s_lshl_b32 s40, s32, 1
s_add_u32 s40, s40, s38
s_add_u32 s56, s56, s40
s_lshl_b32 s58, s56, 2
s_add_u32 s58, s58, 331776
s_lshl_b32 s56, s56, 11
s_add_u32 s56, s56, 67108864
s_lshl_b32 s57, s32, 7
s_add_u32 s57, s57, 327680
s_mov_b32 s59, s33
s_mov_b32 s35, 0
s_lshl_b32 s37, s37, 4
v_add_u32 v12, s37, v10
v_lshlrev_b32 v13, 2, v11
v_sub_u32 v12, v12, v13
v_mov_b32 v13, 0xf149f2ca
v_cmp_le_i32 vcc, 0, v12
s_nop 1
v_cndmask_b32 v80, v13, v8, vcc
v_cmp_le_i32 vcc, 1, v12
s_nop 1
v_cndmask_b32 v81, v13, v8, vcc
v_cmp_le_i32 vcc, 2, v12
s_nop 1
v_cndmask_b32 v82, v13, v8, vcc
v_cmp_le_i32 vcc, 3, v12
s_nop 1
v_cndmask_b32 v83, v13, v8, vcc
v_cmp_le_i32 vcc, 16, v12
s_nop 1
v_cndmask_b32 v84, v13, v8, vcc
v_cmp_le_i32 vcc, 17, v12
s_nop 1
v_cndmask_b32 v85, v13, v8, vcc
v_cmp_le_i32 vcc, 18, v12
s_nop 1
v_cndmask_b32 v86, v13, v8, vcc
v_cmp_le_i32 vcc, 19, v12
s_nop 1
v_cndmask_b32 v87, v13, v8, vcc
v_mov_b32 v88, 0x3f803f80
v_mov_b32 v89, 0x3f803f80
v_mov_b32 v90, 0x3f803f80
v_mov_b32 v91, 0x3f803f80
v_mov_b32 v125, 0
v_mov_b32 v126, 0
v_lshrrev_b32 v12, 2, v9
v_and_b32 v14, 3, v10
v_lshl_add_u32 v14, v14, 4, v12
v_lshlrev_b32 v14, 4, v14
s_lshl_b32 s38, s38, 11
v_add_u32 v3, s38, v1
L_at_loop:
s_add_u32 s51, s50, 4096
s_add_u32 s54, s53, 4096
buffer_load_dwordx4 v[16:19], v1, s[4:7], s50 offen offset:0
buffer_load_dwordx4 v[32:35], v4, s[4:7], s52 offen offset:0 sc1
buffer_load_dwordx4 v[48:51], v4, s[4:7], s52 offen offset:128 sc1
buffer_load_dwordx4 v[20:23], v1, s[4:7], s50 offen offset:2048
buffer_load_dwordx4 v[36:39], v4, s[4:7], s52 offen offset:64 sc1
buffer_load_dwordx4 v[52:55], v4, s[4:7], s52 offen offset:192 sc1
buffer_load_dwordx4 v[24:27], v1, s[4:7], s51 offen offset:0
buffer_load_dwordx4 v[40:43], v4, s[4:7], s52 offen offset:1024 sc1
buffer_load_dwordx4 v[56:59], v4, s[4:7], s52 offen offset:1152 sc1
buffer_load_dwordx4 v[28:31], v1, s[4:7], s51 offen offset:2048
buffer_load_dwordx4 v[44:47], v4, s[4:7], s52 offen offset:1088 sc1
buffer_load_dwordx4 v[60:63], v4, s[4:7], s52 offen offset:1216 sc1
buffer_load_dwordx4 v[64:67], v1, s[4:7], s53 offen offset:2048 sc1
buffer_load_dwordx4 v[68:71], v1, s[4:7], s53 offen offset:3072 sc1
buffer_load_dwordx4 v[72:75], v1, s[4:7], s54 offen offset:2048 sc1
buffer_load_dwordx4 v[76:79], v1, s[4:7], s54 offen offset:3072 sc1
s_waitcnt vmcnt(13)
v_mfma_f32_16x16x32_bf16 v[92:95], v[32:35], v[16:19], v[80:83]
v_mfma_f32_16x16x32_bf16 v[96:99], v[48:51], v[16:19], v[84:87]
s_waitcnt vmcnt(10)
v_mfma_f32_16x16x32_bf16 v[92:95], v[36:39], v[20:23], v[92:95]
v_mfma_f32_16x16x32_bf16 v[96:99], v[52:55], v[20:23], v[96:99]
s_waitcnt vmcnt(7)
v_mfma_f32_16x16x32_bf16 v[92:95], v[40:43], v[24:27], v[92:95]
v_mfma_f32_16x16x32_bf16 v[96:99], v[56:59], v[24:27], v[96:99]
s_waitcnt vmcnt(4)
v_mfma_f32_16x16x32_bf16 v[92:95], v[44:47], v[28:31], v[92:95]
v_mfma_f32_16x16x32_bf16 v[96:99], v[60:63], v[28:31], v[96:99]
s_branch L_at_poll_in
L_at_poll:
s_sleep 2
L_at_poll_in:
buffer_load_dword v12, v8, s[4:7], s57 offen offset:0 sc0 sc1
s_sub_u32 s36, s36, 1
s_cbranch_scc1 L_exit_w
s_waitcnt vmcnt(0)
v_readfirstlane_b32 s37, v12
s_nop 0
s_cmp_gt_u32 s37, s59
s_cbranch_scc0 L_at_poll
s_mov_b32 m0, s60
v_max3_f32 v148, v92, v93, v94
buffer_load_dwordx4 v1, s[4:7], s55 offen sc0 sc1 lds
v_max3_f32 v148, v148, v95, v96
v_max3_f32 v148, v148, v97, v98
v_max_f32 v148, v148, v99
s_waitcnt vmcnt(0)
s_barrier
ds_read_b64_tr_b16 v[108:109], v14 offset:0
ds_read_b64_tr_b16 v[110:111], v14 offset:1024
ds_read_b64_tr_b16 v[112:113], v14 offset:2048
ds_read_b64_tr_b16 v[114:115], v14 offset:3072
ds_read_b64 v[116:117], v3 offset:8
ds_read_b64 v[118:119], v3 offset:1032
s_waitcnt lgkmcnt(4)
v_mfma_f32_16x16x32_bf16 v[100:103], v[108:111], v[16:19], 0
v_mfma_f32_16x16x32_bf16 v[104:107], v[108:111], v[20:23], 0
s_waitcnt lgkmcnt(2)
v_mfma_f32_16x16x32_bf16 v[100:103], v[112:115], v[24:27], v[100:103]
v_mfma_f32_16x16x32_bf16 v[104:107], v[112:115], v[28:31], v[104:107]
v_xor_b32 v14, 4096, v14
v_xor_b32 v3, 4096, v3
s_xor_b32 s60, s60, 4096
s_nop 4
v_pk_add_f32 v[100:101], v[100:101], v[106:107]
v_pk_mul_f32 v[100:101], v[100:101], s[46:47]
v_max3_f32 v149, v148, v100, v101
v_max3_f32 v148, v148, v100, v101
s_nop 1
v_permlane16_swap_b32 v148, v149
v_max_f32 v150, v148, v149
v_max_f32 v151, v148, v149
s_nop 1
v_permlane32_swap_b32 v150, v151
v_max_f32 v148, v150, v151
v_pk_add_f32 v[92:93], v[92:93], v[148:149] op_sel_hi:[1,0] neg_lo:[0,1] neg_hi:[0,1]
v_pk_add_f32 v[94:95], v[94:95], v[148:149] op_sel_hi:[1,0] neg_lo:[0,1] neg_hi:[0,1]
v_pk_add_f32 v[96:97], v[96:97], v[148:149] op_sel_hi:[1,0] neg_lo:[0,1] neg_hi:[0,1]
v_pk_add_f32 v[98:99], v[98:99], v[148:149] op_sel_hi:[1,0] neg_lo:[0,1] neg_hi:[0,1]
v_pk_add_f32 v[100:101], v[100:101], v[148:149] op_sel_hi:[1,0] neg_lo:[0,1] neg_hi:[0,1]
v_exp_f32 v92, v92
v_exp_f32 v93, v93
v_exp_f32 v94, v94
v_exp_f32 v95, v95
v_exp_f32 v96, v96
v_exp_f32 v97, v97
v_exp_f32 v98, v98
v_exp_f32 v99, v99
v_exp_f32 v100, v100
v_exp_f32 v101, v101
v_cvt_pk_bf16_f32 v120, v92, v93
v_cvt_pk_bf16_f32 v121, v94, v95
v_cvt_pk_bf16_f32 v122, v96, v97
v_cvt_pk_bf16_f32 v123, v98, v99
v_cvt_pk_bf16_f32 v124, v100, v101
v_cvt_pk_bf16_f32 v127, v100, v101
v_mfma_f32_16x16x32_bf16 v[144:147], v[88:91], v[120:123], 0
v_mfma_f32_16x16x32_bf16 v[128:131], v[64:67], v[120:123], 0
v_mfma_f32_16x16x32_bf16 v[132:135], v[68:71], v[120:123], 0
v_mfma_f32_16x16x32_bf16 v[136:139], v[72:75], v[120:123], 0
v_mfma_f32_16x16x32_bf16 v[140:143], v[76:79], v[120:123], 0
s_waitcnt lgkmcnt(0)
v_mfma_f32_16x16x16_bf16 v[144:147], v[88:89], v[124:125], v[144:147]
v_mfma_f32_16x16x16_bf16 v[128:131], v[116:117], v[124:125], v[128:131]
v_mfma_f32_16x16x16_bf16 v[132:135], v[116:117], v[126:127], v[132:135]
v_mfma_f32_16x16x16_bf16 v[136:139], v[118:119], v[124:125], v[136:139]
v_mfma_f32_16x16x16_bf16 v[140:143], v[118:119], v[126:127], v[140:143]
v_rcp_f32 v144, v144
s_nop 0
v_mul_f32 v128, v128, v144
v_mul_f32 v129, v129, v144
v_mul_f32 v130, v130, v144
v_mul_f32 v131, v131, v144
v_mul_f32 v132, v132, v144
v_mul_f32 v133, v133, v144
v_mul_f32 v134, v134, v144
v_mul_f32 v135, v135, v144
v_cvt_pk_bf16_f32 v128, v128, v129
v_cvt_pk_bf16_f32 v129, v130, v131
v_cvt_pk_bf16_f32 v130, v132, v133
v_cvt_pk_bf16_f32 v131, v134, v135
buffer_store_dwordx4 v[128:131], v1, s[4:7], s56 offen offset:0 sc0 sc1
v_mul_f32 v136, v136, v144
v_mul_f32 v137, v137, v144
v_mul_f32 v138, v138, v144
v_mul_f32 v139, v139, v144
v_mul_f32 v140, v140, v144
v_mul_f32 v141, v141, v144
v_mul_f32 v142, v142, v144
v_mul_f32 v143, v143, v144
v_cvt_pk_bf16_f32 v136, v136, v137
v_cvt_pk_bf16_f32 v137, v138, v139
v_cvt_pk_bf16_f32 v138, v140, v141
v_cvt_pk_bf16_f32 v139, v142, v143
buffer_store_dwordx4 v[136:139], v1, s[4:7], s56 offen offset:1024 sc0 sc1
s_add_u32 s35, s35, 1
v_mov_b32 v13, s35
s_add_u32 s50, s50, 1048576
s_add_u32 s52, s52, 2097152
s_add_u32 s53, s53, 2097152
s_add_u32 s55, s55, 524288
s_add_u32 s56, s56, 1048576
s_add_u32 s59, s59, 4
s_waitcnt vmcnt(0)
s_mov_b64 exec, 1
buffer_store_dword v13, v8, s[4:7], s58 offen sc0 sc1
s_mov_b64 exec, -1
s_cmp_lt_u32 s35, 16
s_cbranch_scc1 L_at_loop
s_waitcnt vmcnt(0)
s_endpgm
L_role_aw:
s_load_dwordx2 s[4:5], s[0:1], 104
s_mov_b32 s6, 268435456
s_mov_b32 s7, 0x20000
s_load_dwordx2 s[8:9], s[0:1], 0
s_mov_b32 s10, 2359296
s_mov_b32 s11, 0x20000
s_load_dwordx2 s[12:13], s[0:1], 8
s_mov_b32 s14, 1990656
s_mov_b32 s15, 0x20000
s_load_dwordx2 s[16:17], s[0:1], 16
s_mov_b32 s18, 663552
s_mov_b32 s19, 0x20000
s_load_dwordx2 s[20:21], s[0:1], 64
s_mov_b32 s22, 4718592
s_mov_b32 s23, 0x20000
s_load_dwordx2 s[24:25], s[0:1], 96
s_mov_b32 s26, 256
s_mov_b32 s27, 0x20000
s_load_dwordx2 s[28:29], s[0:1], 88
s_mov_b32 s30, 2359296
s_mov_b32 s31, 0x20000
s_load_dwordx2 s[64:65], s[0:1], 80
s_mov_b32 s66, 1152
s_mov_b32 s67, 0x20000
v_and_b32 v9, 63, v0
v_and_b32 v10, 15, v0
v_bfe_u32 v11, v0, 4, 2
v_lshrrev_b32 v1, 6, v0
s_nop 0
v_readfirstlane_b32 s34, v1
v_lshrrev_b32 v12, 2, v9
v_mul_u32_u24 v2, 1152, v12
v_lshrrev_b32 v12, 5, v9
v_lshlrev_b32 v12, 1, v12
v_and_b32 v13, 3, v9
v_xor_b32 v12, v12, v13
v_lshl_add_u32 v2, v12, 4, v2
v_lshrrev_b32 v12, 3, v10
v_lshlrev_b32 v12, 1, v12
v_xor_b32 v12, v12, v11
v_lshlrev_b32 v12, 4, v12
v_lshl_add_u32 v3, v10, 6, v12
v_lshrrev_b32 v12, 2, v10
v_lshl_add_u32 v12, v11, 3, v12
v_mul_u32_u24 v7, 64, v12
v_and_b32 v12, 3, v10
v_lshl_add_u32 v7, v12, 3, v7
v_lshlrev_b32 v1, 4, v9
s_mul_i32 s38, s34, 20480
s_add_u32 s38, s38, 73728
v_add_u32 v7, s38, v7
v_mov_b32 v8, 0
s_lshl_b32 s37, s34, 3
s_add_u32 s37, s37, 0
v_and_b32 v12, 3, v9
v_add_u32 v12, s37, v12
v_min_u32 v12, 26, v12
v_mul_u32_u24 v13, 57, v12
v_lshrrev_b32 v13, 9, v13
v_mul_u32_u24 v13, 1008, v13
v_lshl_add_u32 v13, v12, 4, v13
v_lshrrev_b32 v12, 2, v9
v_mul_u32_u24 v12, 3456, v12
v_add_u32 v5, v12, v13
s_lshl_b32 s37, s34, 3
s_add_u32 s37, s37, 4
v_and_b32 v12, 3, v9
v_add_u32 v12, s37, v12
v_min_u32 v12, 26, v12
v_mul_u32_u24 v13, 57, v12
v_lshrrev_b32 v13, 9, v13
v_mul_u32_u24 v13, 1008, v13
v_lshl_add_u32 v13, v12, 4, v13
v_lshrrev_b32 v12, 2, v9
v_mul_u32_u24 v12, 3456, v12
v_add_u32 v6, v12, v13
s_mul_i32 s39, s32, 144
s_mul_i32 s40, s33, 11
s_and_b32 s41, s34, 1
s_add_u32 s40, s40, s41
s_sub_u32 s40, s40, 1
s_max_i32 s41, s40, 0
s_lshr_b32 s42, s34, 1
s_lshl_b32 s42, s42, 6
s_mul_i32 s43, s41, 18432
s_add_u32 s43, s43, s42
s_mul_i32 s40, s40, 18432
s_add_u32 s40, s40, s42
s_lshl_b32 s44, s34, 10
s_mov_b32 s36, 400000
v_mul_u32_u24 v4, 456, v10
v_lshl_add_u32 v4, v11, 3, v4
s_lshl_b32 s37, s34, 7
s_add_u32 s37, s37, 73728
v_add_u32 v4, s37, v4
v_lshlrev_b32 v14, 2, v10
v_add_u32 v14, 161280, v14
s_waitcnt lgkmcnt(0)
s_add_u32 s37, s39, 0
s_add_u32 m0, s38, 0
s_nop 0
buffer_load_dwordx4 v5, s[12:15], s37 offen lds
s_add_u32 s37, s39, 55296
s_add_u32 m0, s38, 1024
s_nop 0
buffer_load_dwordx4 v5, s[12:15], s37 offen lds
s_add_u32 s37, s39, 110592
s_add_u32 m0, s38, 2048
s_nop 0
buffer_load_dwordx4 v5, s[12:15], s37 offen lds
s_add_u32 s37, s39, 165888
s_add_u32 m0, s38, 3072
s_nop 0
buffer_load_dwordx4 v5, s[12:15], s37 offen lds
s_add_u32 s37, s39, 221184
s_add_u32 m0, s38, 4096
s_nop 0
buffer_load_dwordx4 v5, s[12:15], s37 offen lds
s_add_u32 s37, s39, 276480
s_add_u32 m0, s38, 5120
s_nop 0
buffer_load_dwordx4 v5, s[12:15], s37 offen lds
s_add_u32 s37, s39, 331776
s_add_u32 m0, s38, 6144
s_nop 0
buffer_load_dwordx4 v5, s[12:15], s37 offen lds
s_add_u32 s37, s39, 387072
s_add_u32 m0, s38, 7168
s_nop 0
buffer_load_dwordx4 v5, s[12:15], s37 offen lds
s_add_u32 s37, s39, 442368
s_add_u32 m0, s38, 8192
s_nop 0
buffer_load_dwordx4 v5, s[12:15], s37 offen lds
s_add_u32 s37, s39, 497664
s_add_u32 m0, s38, 9216
s_nop 0
buffer_load_dwordx4 v5, s[12:15], s37 offen lds
s_add_u32 s37, s39, 552960
s_add_u32 m0, s38, 10240
s_nop 0
buffer_load_dwordx4 v5, s[12:15], s37 offen lds
s_add_u32 s37, s39, 608256
s_add_u32 m0, s38, 11264
s_nop 0
buffer_load_dwordx4 v5, s[12:15], s37 offen lds
s_add_u32 s37, s39, 663552
s_add_u32 m0, s38, 12288
s_nop 0
buffer_load_dwordx4 v5, s[12:15], s37 offen lds
s_add_u32 s37, s39, 718848
s_add_u32 m0, s38, 13312
s_nop 0
buffer_load_dwordx4 v5, s[12:15], s37 offen lds
s_add_u32 s37, s39, 774144
s_add_u32 m0, s38, 14336
s_nop 0
buffer_load_dwordx4 v5, s[12:15], s37 offen lds
s_add_u32 s37, s39, 829440
s_add_u32 m0, s38, 15360
s_nop 0
buffer_load_dwordx4 v5, s[12:15], s37 offen lds
s_add_u32 s37, s43, 0
s_add_u32 m0, s44, 0
s_nop 0
buffer_load_dwordx4 v2, s[8:11], s37 offen lds
s_add_u32 s37, s43, 128
s_add_u32 m0, s44, 4096
s_nop 0
buffer_load_dwordx4 v2, s[8:11], s37 offen lds
s_add_u32 s37, s43, 256
s_add_u32 m0, s44, 8192
s_nop 0
buffer_load_dwordx4 v2, s[8:11], s37 offen lds
s_add_u32 s37, s43, 384
s_add_u32 m0, s44, 12288
s_nop 0
buffer_load_dwordx4 v2, s[8:11], s37 offen lds
s_add_u32 s37, s43, 512
s_add_u32 m0, s44, 16384
s_nop 0
buffer_load_dwordx4 v2, s[8:11], s37 offen lds
s_add_u32 s37, s43, 640
s_add_u32 m0, s44, 20480
s_nop 0
buffer_load_dwordx4 v2, s[8:11], s37 offen lds
s_add_u32 s37, s43, 768
s_add_u32 m0, s44, 24576
s_nop 0
buffer_load_dwordx4 v2, s[8:11], s37 offen lds
s_add_u32 s37, s43, 896
s_add_u32 m0, s44, 28672
s_nop 0
buffer_load_dwordx4 v2, s[8:11], s37 offen lds
s_add_u32 s37, s43, 1024
s_add_u32 m0, s44, 32768
s_nop 0
buffer_load_dwordx4 v2, s[8:11], s37 offen lds
s_waitcnt vmcnt(21)
ds_read_b64_tr_b16 v[80:81], v7 offset:0
ds_read_b64_tr_b16 v[82:83], v7 offset:256
ds_read_b64_tr_b16 v[84:85], v7 offset:2048
ds_read_b64_tr_b16 v[86:87], v7 offset:2304
ds_read_b64_tr_b16 v[152:153], v7 offset:32
ds_read_b64_tr_b16 v[154:155], v7 offset:288
ds_read_b64_tr_b16 v[156:157], v7 offset:2080
ds_read_b64_tr_b16 v[158:159], v7 offset:2336
s_waitcnt lgkmcnt(0)
s_add_u32 s37, s39, 884736
s_add_u32 m0, s38, 16384
s_nop 0
buffer_load_dwordx4 v5, s[12:15], s37 offen lds
s_add_u32 s37, s39, 940032
s_add_u32 m0, s38, 17408
s_nop 0
buffer_load_dwordx4 v5, s[12:15], s37 offen lds
s_add_u32 s37, s39, 995328
s_add_u32 m0, s38, 18432
s_nop 0
buffer_load_dwordx4 v5, s[12:15], s37 offen lds
s_add_u32 s37, s39, 1050624
s_add_u32 m0, s38, 19456
s_nop 0
buffer_load_dwordx4 v5, s[12:15], s37 offen lds
s_waitcnt vmcnt(21)
ds_read_b64_tr_b16 v[88:89], v7 offset:4096
ds_read_b64_tr_b16 v[90:91], v7 offset:4352
ds_read_b64_tr_b16 v[92:93], v7 offset:6144
ds_read_b64_tr_b16 v[94:95], v7 offset:6400
ds_read_b64_tr_b16 v[160:161], v7 offset:4128
ds_read_b64_tr_b16 v[162:163], v7 offset:4384
ds_read_b64_tr_b16 v[164:165], v7 offset:6176
ds_read_b64_tr_b16 v[166:167], v7 offset:6432
s_waitcnt lgkmcnt(0)
s_add_u32 s37, s39, 1105920
s_add_u32 m0, s38, 0
s_nop 0
buffer_load_dwordx4 v5, s[12:15], s37 offen lds
s_add_u32 s37, s39, 1161216
s_add_u32 m0, s38, 1024
s_nop 0
buffer_load_dwordx4 v5, s[12:15], s37 offen lds
s_add_u32 s37, s39, 1216512
s_add_u32 m0, s38, 2048
s_nop 0
buffer_load_dwordx4 v5, s[12:15], s37 offen lds
s_add_u32 s37, s39, 1271808
s_add_u32 m0, s38, 3072
s_nop 0
buffer_load_dwordx4 v5, s[12:15], s37 offen lds
s_waitcnt vmcnt(21)
ds_read_b64_tr_b16 v[96:97], v7 offset:8192
ds_read_b64_tr_b16 v[98:99], v7 offset:8448
ds_read_b64_tr_b16 v[100:101], v7 offset:10240
ds_read_b64_tr_b16 v[102:103], v7 offset:10496
ds_read_b64_tr_b16 v[168:169], v7 offset:8224
ds_read_b64_tr_b16 v[170:171], v7 offset:8480
ds_read_b64_tr_b16 v[172:173], v7 offset:10272
ds_read_b64_tr_b16 v[174:175], v7 offset:10528
s_waitcnt lgkmcnt(0)
s_add_u32 s37, s39, 1327104
s_add_u32 m0, s38, 4096
s_nop 0
buffer_load_dwordx4 v5, s[12:15], s37 offen lds
s_add_u32 s37, s39, 1382400
s_add_u32 m0, s38, 5120
s_nop 0
buffer_load_dwordx4 v5, s[12:15], s37 offen lds
s_add_u32 s37, s39, 1437696
s_add_u32 m0, s38, 6144
s_nop 0
buffer_load_dwordx4 v5, s[12:15], s37 offen lds
s_add_u32 s37, s39, 1492992
s_add_u32 m0, s38, 7168
s_nop 0
buffer_load_dwordx4 v5, s[12:15], s37 offen lds
s_waitcnt vmcnt(21)
ds_read_b64_tr_b16 v[104:105], v7 offset:12288
ds_read_b64_tr_b16 v[106:107], v7 offset:12544
ds_read_b64_tr_b16 v[108:109], v7 offset:14336
ds_read_b64_tr_b16 v[110:111], v7 offset:14592
ds_read_b64_tr_b16 v[176:177], v7 offset:12320
ds_read_b64_tr_b16 v[178:179], v7 offset:12576
ds_read_b64_tr_b16 v[180:181], v7 offset:14368
ds_read_b64_tr_b16 v[182:183], v7 offset:14624
s_waitcnt lgkmcnt(0)
s_add_u32 s37, s39, 1548288
s_add_u32 m0, s38, 8192
s_nop 0
buffer_load_dwordx4 v5, s[12:15], s37 offen lds
s_add_u32 s37, s39, 1603584
s_add_u32 m0, s38, 9216
s_nop 0
buffer_load_dwordx4 v5, s[12:15], s37 offen lds
s_add_u32 s37, s39, 1658880
s_add_u32 m0, s38, 10240
s_nop 0
buffer_load_dwordx4 v5, s[12:15], s37 offen lds
s_add_u32 s37, s39, 1714176
s_add_u32 m0, s38, 11264
s_nop 0
buffer_load_dwordx4 v5, s[12:15], s37 offen lds
s_waitcnt vmcnt(12)
ds_read_b64_tr_b16 v[112:113], v7 offset:16384
ds_read_b64_tr_b16 v[114:115], v7 offset:16640
ds_read_b64_tr_b16 v[116:117], v7 offset:18432
ds_read_b64_tr_b16 v[118:119], v7 offset:18688
ds_read_b64_tr_b16 v[184:185], v7 offset:16416
ds_read_b64_tr_b16 v[186:187], v7 offset:16672
ds_read_b64_tr_b16 v[188:189], v7 offset:18464
ds_read_b64_tr_b16 v[190:191], v7 offset:18720
s_waitcnt lgkmcnt(0)
s_add_u32 s37, s39, 1769472
s_add_u32 m0, s38, 12288
s_nop 0
buffer_load_dwordx4 v5, s[12:15], s37 offen lds
s_add_u32 s37, s39, 1824768
s_add_u32 m0, s38, 13312
s_nop 0
buffer_load_dwordx4 v5, s[12:15], s37 offen lds
s_add_u32 s37, s39, 1880064
s_add_u32 m0, s38, 14336
s_nop 0
buffer_load_dwordx4 v5, s[12:15], s37 offen lds
s_add_u32 s37, s39, 1935360
s_add_u32 m0, s38, 15360
s_nop 0
buffer_load_dwordx4 v5, s[12:15], s37 offen lds
s_waitcnt vmcnt(12)
ds_read_b64_tr_b16 v[120:121], v7 offset:0
ds_read_b64_tr_b16 v[122:123], v7 offset:256
ds_read_b64_tr_b16 v[124:125], v7 offset:2048
ds_read_b64_tr_b16 v[126:127], v7 offset:2304
ds_read_b64_tr_b16 v[192:193], v7 offset:32
ds_read_b64_tr_b16 v[194:195], v7 offset:288
ds_read_b64_tr_b16 v[196:197], v7 offset:2080
ds_read_b64_tr_b16 v[198:199], v7 offset:2336
s_waitcnt lgkmcnt(0)
s_add_u32 s37, s39, 0
s_add_u32 m0, s38, 16384
s_nop 0
buffer_load_dwordx4 v6, s[12:15], s37 offen lds
s_add_u32 s37, s39, 55296
s_add_u32 m0, s38, 17408
s_nop 0
buffer_load_dwordx4 v6, s[12:15], s37 offen lds
s_add_u32 s37, s39, 110592
s_add_u32 m0, s38, 18432
s_nop 0
buffer_load_dwordx4 v6, s[12:15], s37 offen lds
s_add_u32 s37, s39, 165888
s_add_u32 m0, s38, 19456
s_nop 0
buffer_load_dwordx4 v6, s[12:15], s37 offen lds
s_waitcnt vmcnt(12)
ds_read_b64_tr_b16 v[128:129], v7 offset:4096
ds_read_b64_tr_b16 v[130:131], v7 offset:4352
ds_read_b64_tr_b16 v[132:133], v7 offset:6144
ds_read_b64_tr_b16 v[134:135], v7 offset:6400
ds_read_b64_tr_b16 v[200:201], v7 offset:4128
ds_read_b64_tr_b16 v[202:203], v7 offset:4384
ds_read_b64_tr_b16 v[204:205], v7 offset:6176
ds_read_b64_tr_b16 v[206:207], v7 offset:6432
s_waitcnt lgkmcnt(0)
s_add_u32 s37, s39, 221184
s_add_u32 m0, s38, 0
s_nop 0
buffer_load_dwordx4 v6, s[12:15], s37 offen lds
s_add_u32 s37, s39, 276480
s_add_u32 m0, s38, 1024
s_nop 0
buffer_load_dwordx4 v6, s[12:15], s37 offen lds
s_add_u32 s37, s39, 331776
s_add_u32 m0, s38, 2048
s_nop 0
buffer_load_dwordx4 v6, s[12:15], s37 offen lds
s_add_u32 s37, s39, 387072
s_add_u32 m0, s38, 3072
s_nop 0
buffer_load_dwordx4 v6, s[12:15], s37 offen lds
s_waitcnt vmcnt(12)
ds_read_b64_tr_b16 v[136:137], v7 offset:8192
ds_read_b64_tr_b16 v[138:139], v7 offset:8448
ds_read_b64_tr_b16 v[140:141], v7 offset:10240
ds_read_b64_tr_b16 v[142:143], v7 offset:10496
ds_read_b64_tr_b16 v[208:209], v7 offset:8224
ds_read_b64_tr_b16 v[210:211], v7 offset:8480
ds_read_b64_tr_b16 v[212:213], v7 offset:10272
ds_read_b64_tr_b16 v[214:215], v7 offset:10528
s_waitcnt lgkmcnt(0)
s_add_u32 s37, s39, 442368
s_add_u32 m0, s38, 4096
s_nop 0
buffer_load_dwordx4 v6, s[12:15], s37 offen lds
s_add_u32 s37, s39, 497664
s_add_u32 m0, s38, 5120
s_nop 0
buffer_load_dwordx4 v6, s[12:15], s37 offen lds
s_add_u32 s37, s39, 552960
s_add_u32 m0, s38, 6144
s_nop 0
buffer_load_dwordx4 v6, s[12:15], s37 offen lds
s_add_u32 s37, s39, 608256
s_add_u32 m0, s38, 7168
s_nop 0
buffer_load_dwordx4 v6, s[12:15], s37 offen lds
s_waitcnt vmcnt(12)
ds_read_b64_tr_b16 v[144:145], v7 offset:12288
ds_read_b64_tr_b16 v[146:147], v7 offset:12544
ds_read_b64_tr_b16 v[148:149], v7 offset:14336
ds_read_b64_tr_b16 v[150:151], v7 offset:14592
ds_read_b64_tr_b16 v[216:217], v7 offset:12320
ds_read_b64_tr_b16 v[218:219], v7 offset:12576
ds_read_b64_tr_b16 v[220:221], v7 offset:14368
ds_read_b64_tr_b16 v[222:223], v7 offset:14624
s_waitcnt lgkmcnt(0)
s_add_u32 s37, s39, 663552
s_add_u32 m0, s38, 8192
s_nop 0
buffer_load_dwordx4 v6, s[12:15], s37 offen lds
s_add_u32 s37, s39, 718848
s_add_u32 m0, s38, 9216
s_nop 0
buffer_load_dwordx4 v6, s[12:15], s37 offen lds
s_add_u32 s37, s39, 774144
s_add_u32 m0, s38, 10240
s_nop 0
buffer_load_dwordx4 v6, s[12:15], s37 offen lds
s_add_u32 s37, s39, 829440
s_add_u32 m0, s38, 11264
s_nop 0
buffer_load_dwordx4 v6, s[12:15], s37 offen lds
s_waitcnt vmcnt(12)
ds_read_b64_tr_b16 v[224:225], v7 offset:16384
ds_read_b64_tr_b16 v[226:227], v7 offset:16640
ds_read_b64_tr_b16 v[228:229], v7 offset:18432
ds_read_b64_tr_b16 v[230:231], v7 offset:18688
ds_read_b64_tr_b16 a[40:41], v7 offset:16416
ds_read_b64_tr_b16 a[42:43], v7 offset:16672
ds_read_b64_tr_b16 a[44:45], v7 offset:18464
ds_read_b64_tr_b16 a[46:47], v7 offset:18720
s_waitcnt lgkmcnt(0)
s_add_u32 s37, s39, 884736
s_add_u32 m0, s38, 12288
s_nop 0
buffer_load_dwordx4 v6, s[12:15], s37 offen lds
s_add_u32 s37, s39, 940032
s_add_u32 m0, s38, 13312
s_nop 0
buffer_load_dwordx4 v6, s[12:15], s37 offen lds
s_add_u32 s37, s39, 995328
s_add_u32 m0, s38, 14336
s_nop 0
buffer_load_dwordx4 v6, s[12:15], s37 offen lds
s_add_u32 s37, s39, 1050624
s_add_u32 m0, s38, 15360
s_nop 0
buffer_load_dwordx4 v6, s[12:15], s37 offen lds
s_waitcnt vmcnt(12)
ds_read_b64_tr_b16 v[232:233], v7 offset:0
ds_read_b64_tr_b16 v[234:235], v7 offset:256
ds_read_b64_tr_b16 v[236:237], v7 offset:2048
ds_read_b64_tr_b16 v[238:239], v7 offset:2304
ds_read_b64_tr_b16 a[48:49], v7 offset:32
ds_read_b64_tr_b16 a[50:51], v7 offset:288
ds_read_b64_tr_b16 a[52:53], v7 offset:2080
ds_read_b64_tr_b16 a[54:55], v7 offset:2336
s_waitcnt lgkmcnt(0)
s_add_u32 s37, s39, 1105920
s_add_u32 m0, s38, 16384
s_nop 0
buffer_load_dwordx4 v6, s[12:15], s37 offen lds
s_add_u32 s37, s39, 1161216
s_add_u32 m0, s38, 17408
s_nop 0
buffer_load_dwordx4 v6, s[12:15], s37 offen lds
s_add_u32 s37, s39, 1216512
s_add_u32 m0, s38, 18432
s_nop 0
buffer_load_dwordx4 v6, s[12:15], s37 offen lds
s_add_u32 s37, s39, 1271808
s_add_u32 m0, s38, 19456
s_nop 0
buffer_load_dwordx4 v6, s[12:15], s37 offen lds
s_waitcnt vmcnt(12)
ds_read_b64_tr_b16 v[240:241], v7 offset:4096
ds_read_b64_tr_b16 v[242:243], v7 offset:4352
ds_read_b64_tr_b16 v[244:245], v7 offset:6144
ds_read_b64_tr_b16 v[246:247], v7 offset:6400
ds_read_b64_tr_b16 a[56:57], v7 offset:4128
ds_read_b64_tr_b16 a[58:59], v7 offset:4384
ds_read_b64_tr_b16 a[60:61], v7 offset:6176
ds_read_b64_tr_b16 a[62:63], v7 offset:6432
s_waitcnt lgkmcnt(0)
s_add_u32 s37, s39, 1327104
s_add_u32 m0, s38, 0
s_nop 0
buffer_load_dwordx4 v6, s[12:15], s37 offen lds
s_add_u32 s37, s39, 1382400
s_add_u32 m0, s38, 1024
s_nop 0
buffer_load_dwordx4 v6, s[12:15], s37 offen lds
s_add_u32 s37, s39, 1437696
s_add_u32 m0, s38, 2048
s_nop 0
buffer_load_dwordx4 v6, s[12:15], s37 offen lds
s_add_u32 s37, s39, 1492992
s_add_u32 m0, s38, 3072
s_nop 0
buffer_load_dwordx4 v6, s[12:15], s37 offen lds
s_waitcnt vmcnt(12)
ds_read_b64_tr_b16 v[248:249], v7 offset:8192
ds_read_b64_tr_b16 v[250:251], v7 offset:8448
ds_read_b64_tr_b16 v[252:253], v7 offset:10240
ds_read_b64_tr_b16 v[254:255], v7 offset:10496
ds_read_b64_tr_b16 a[64:65], v7 offset:8224
ds_read_b64_tr_b16 a[66:67], v7 offset:8480
ds_read_b64_tr_b16 a[68:69], v7 offset:10272
ds_read_b64_tr_b16 a[70:71], v7 offset:10528
s_waitcnt lgkmcnt(0)
s_add_u32 s37, s39, 1548288
s_add_u32 m0, s38, 4096
s_nop 0
buffer_load_dwordx4 v6, s[12:15], s37 offen lds
s_add_u32 s37, s39, 1603584
s_add_u32 m0, s38, 5120
s_nop 0
buffer_load_dwordx4 v6, s[12:15], s37 offen lds
s_add_u32 s37, s39, 1658880
s_add_u32 m0, s38, 6144
s_nop 0
buffer_load_dwordx4 v6, s[12:15], s37 offen lds
s_add_u32 s37, s39, 1714176
s_add_u32 m0, s38, 7168
s_nop 0
buffer_load_dwordx4 v6, s[12:15], s37 offen lds
s_waitcnt vmcnt(12)
ds_read_b64_tr_b16 a[0:1], v7 offset:12288
ds_read_b64_tr_b16 a[2:3], v7 offset:12544
ds_read_b64_tr_b16 a[4:5], v7 offset:14336
ds_read_b64_tr_b16 a[6:7], v7 offset:14592
ds_read_b64_tr_b16 a[72:73], v7 offset:12320
ds_read_b64_tr_b16 a[74:75], v7 offset:12576
ds_read_b64_tr_b16 a[76:77], v7 offset:14368
ds_read_b64_tr_b16 a[78:79], v7 offset:14624
s_waitcnt lgkmcnt(0)
s_add_u32 s37, s39, 1769472
s_add_u32 m0, s38, 8192
s_nop 0
buffer_load_dwordx4 v6, s[12:15], s37 offen lds
s_add_u32 s37, s39, 1824768
s_add_u32 m0, s38, 9216
s_nop 0
buffer_load_dwordx4 v6, s[12:15], s37 offen lds
s_add_u32 s37, s39, 1880064
s_add_u32 m0, s38, 10240
s_nop 0
buffer_load_dwordx4 v6, s[12:15], s37 offen lds
s_add_u32 s37, s39, 1935360
s_add_u32 m0, s38, 11264
s_nop 0
buffer_load_dwordx4 v6, s[12:15], s37 offen lds
s_waitcnt vmcnt(12)
ds_read_b64_tr_b16 a[8:9], v7 offset:16384
ds_read_b64_tr_b16 a[10:11], v7 offset:16640
ds_read_b64_tr_b16 a[12:13], v7 offset:18432
ds_read_b64_tr_b16 a[14:15], v7 offset:18688
ds_read_b64_tr_b16 a[80:81], v7 offset:16416
ds_read_b64_tr_b16 a[82:83], v7 offset:16672
ds_read_b64_tr_b16 a[84:85], v7 offset:18464
ds_read_b64_tr_b16 a[86:87], v7 offset:18720
s_waitcnt lgkmcnt(0)
s_waitcnt vmcnt(8)
ds_read_b64_tr_b16 a[16:17], v7 offset:0
ds_read_b64_tr_b16 a[18:19], v7 offset:256
ds_read_b64_tr_b16 a[20:21], v7 offset:2048
ds_read_b64_tr_b16 a[22:23], v7 offset:2304
ds_read_b64_tr_b16 a[88:89], v7 offset:32
ds_read_b64_tr_b16 a[90:91], v7 offset:288
ds_read_b64_tr_b16 a[92:93], v7 offset:2080
ds_read_b64_tr_b16 a[94:95], v7 offset:2336
s_waitcnt lgkmcnt(0)
s_waitcnt vmcnt(4)
ds_read_b64_tr_b16 a[24:25], v7 offset:4096
ds_read_b64_tr_b16 a[26:27], v7 offset:4352
ds_read_b64_tr_b16 a[28:29], v7 offset:6144
ds_read_b64_tr_b16 a[30:31], v7 offset:6400
ds_read_b64_tr_b16 a[96:97], v7 offset:4128
ds_read_b64_tr_b16 a[98:99], v7 offset:4384
ds_read_b64_tr_b16 a[100:101], v7 offset:6176
ds_read_b64_tr_b16 a[102:103], v7 offset:6432
s_waitcnt lgkmcnt(0)
s_waitcnt vmcnt(0)
ds_read_b64_tr_b16 a[32:33], v7 offset:8192
ds_read_b64_tr_b16 a[34:35], v7 offset:8448
ds_read_b64_tr_b16 a[36:37], v7 offset:10240
ds_read_b64_tr_b16 a[38:39], v7 offset:10496
ds_read_b64_tr_b16 a[104:105], v7 offset:8224
ds_read_b64_tr_b16 a[106:107], v7 offset:8480
ds_read_b64_tr_b16 a[108:109], v7 offset:10272
ds_read_b64_tr_b16 a[110:111], v7 offset:10528
s_waitcnt lgkmcnt(0)
s_cmp_lg_u32 s34, 3
s_cbranch_scc1 L_a_nogate
v_lshlrev_b32 v12, 4, v11
buffer_load_dwordx4 v[224:227], v12, s[64:67], 0 offen offset:0
buffer_load_dwordx4 v[228:231], v12, s[64:67], 0 offen offset:64
buffer_load_dwordx4 v[232:235], v12, s[64:67], 0 offen offset:128
buffer_load_dwordx4 v[236:239], v12, s[64:67], 0 offen offset:192
buffer_load_dwordx4 v[240:243], v12, s[64:67], 0 offen offset:256
buffer_load_dwordx4 v[244:247], v12, s[64:67], 0 offen offset:320
buffer_load_dwordx4 v[248:251], v12, s[64:67], 0 offen offset:384
buffer_load_dwordx4 v[252:255], v12, s[64:67], 0 offen offset:448
buffer_load_dwordx4 a[0:3], v12, s[64:67], 0 offen offset:512
buffer_load_dwordx4 a[4:7], v12, s[64:67], 0 offen offset:576
buffer_load_dwordx4 a[8:11], v12, s[64:67], 0 offen offset:640
buffer_load_dwordx4 a[12:15], v12, s[64:67], 0 offen offset:704
buffer_load_dwordx4 a[16:19], v12, s[64:67], 0 offen offset:768
buffer_load_dwordx4 a[20:23], v12, s[64:67], 0 offen offset:832
buffer_load_dwordx4 a[24:27], v12, s[64:67], 0 offen offset:896
buffer_load_dwordx4 a[28:31], v12, s[64:67], 0 offen offset:960
buffer_load_dwordx4 a[32:35], v12, s[64:67], 0 offen offset:1024
buffer_load_dwordx4 a[36:39], v12, s[64:67], 0 offen offset:1088
L_a_nogate:
s_mov_b32 s43, s40
s_mov_b32 s35, 0
s_mov_b32 s50, 36864
.p2align 6
L_a_loop:
s_waitcnt vmcnt(0)
s_barrier
s_add_u32 s43, s43, 36864
s_add_u32 s44, s44, s50
ds_read_b128 v[64:67], v3 offset:0
ds_read_b128 v[68:71], v3 offset:1024
ds_read_b128 v[72:75], v3 offset:2048
ds_read_b128 v[76:79], v3 offset:3072
s_waitcnt lgkmcnt(2)
v_mfma_f32_16x16x32_bf16 v[16:19], v[80:83], v[64:67], 0
v_mfma_f32_16x16x32_bf16 v[20:23], v[80:83], v[68:71], 0
v_mfma_f32_16x16x32_bf16 v[24:27], v[152:155], v[64:67], 0
v_mfma_f32_16x16x32_bf16 v[28:31], v[152:155], v[68:71], 0
s_add_u32 s37, s43, 0
s_add_u32 m0, s44, 0
s_nop 0
buffer_load_dwordx4 v2, s[8:11], s37 offen lds
v_mfma_f32_16x16x32_bf16 v[32:35], v[224:227], v[64:67], 0
v_mfma_f32_16x16x32_bf16 v[36:39], v[224:227], v[68:71], 0
v_mfma_f32_16x16x32_bf16 v[40:43], a[40:43], v[64:67], 0
v_mfma_f32_16x16x32_bf16 v[44:47], a[40:43], v[68:71], 0
ds_read_b128 v[64:67], v3 offset:4096
ds_read_b128 v[68:71], v3 offset:5120
s_waitcnt lgkmcnt(2)
v_mfma_f32_16x16x32_bf16 v[16:19], v[84:87], v[72:75], v[16:19]
v_mfma_f32_16x16x32_bf16 v[20:23], v[84:87], v[76:79], v[20:23]
v_mfma_f32_16x16x32_bf16 v[24:27], v[156:159], v[72:75], v[24:27]
v_mfma_f32_16x16x32_bf16 v[28:31], v[156:159], v[76:79], v[28:31]
s_add_u32 s37, s43, 128
s_add_u32 m0, s44, 4096
s_nop 0
buffer_load_dwordx4 v2, s[8:11], s37 offen lds
v_mfma_f32_16x16x32_bf16 v[32:35], v[228:231], v[72:75], v[32:35]
v_mfma_f32_16x16x32_bf16 v[36:39], v[228:231], v[76:79], v[36:39]
v_mfma_f32_16x16x32_bf16 v[40:43], a[44:47], v[72:75], v[40:43]
v_mfma_f32_16x16x32_bf16 v[44:47], a[44:47], v[76:79], v[44:47]
ds_read_b128 v[72:75], v3 offset:6144
ds_read_b128 v[76:79], v3 offset:7168
s_waitcnt lgkmcnt(2)
v_mfma_f32_16x16x32_bf16 v[16:19], v[88:91], v[64:67], v[16:19]
v_mfma_f32_16x16x32_bf16 v[20:23], v[88:91], v[68:71], v[20:23]
v_mfma_f32_16x16x32_bf16 v[24:27], v[160:163], v[64:67], v[24:27]
v_mfma_f32_16x16x32_bf16 v[28:31], v[160:163], v[68:71], v[28:31]
s_add_u32 s37, s43, 256
s_add_u32 m0, s44, 8192
s_nop 0
buffer_load_dwordx4 v2, s[8:11], s37 offen lds
v_mfma_f32_16x16x32_bf16 v[32:35], v[232:235], v[64:67], v[32:35]
v_mfma_f32_16x16x32_bf16 v[36:39], v[232:235], v[68:71], v[36:39]
v_mfma_f32_16x16x32_bf16 v[40:43], a[48:51], v[64:67], v[40:43]
v_mfma_f32_16x16x32_bf16 v[44:47], a[48:51], v[68:71], v[44:47]
ds_read_b128 v[64:67], v3 offset:8192
ds_read_b128 v[68:71], v3 offset:9216
s_waitcnt lgkmcnt(2)
v_mfma_f32_16x16x32_bf16 v[16:19], v[92:95], v[72:75], v[16:19]
v_mfma_f32_16x16x32_bf16 v[20:23], v[92:95], v[76:79], v[20:23]
v_mfma_f32_16x16x32_bf16 v[24:27], v[164:167], v[72:75], v[24:27]
v_mfma_f32_16x16x32_bf16 v[28:31], v[164:167], v[76:79], v[28:31]
s_add_u32 s37, s43, 384
s_add_u32 m0, s44, 12288
s_nop 0
buffer_load_dwordx4 v2, s[8:11], s37 offen lds
v_mfma_f32_16x16x32_bf16 v[32:35], v[236:239], v[72:75], v[32:35]
v_mfma_f32_16x16x32_bf16 v[36:39], v[236:239], v[76:79], v[36:39]
v_mfma_f32_16x16x32_bf16 v[40:43], a[52:55], v[72:75], v[40:43]
v_mfma_f32_16x16x32_bf16 v[44:47], a[52:55], v[76:79], v[44:47]
ds_read_b128 v[72:75], v3 offset:10240
ds_read_b128 v[76:79], v3 offset:11264
s_waitcnt lgkmcnt(2)
v_mfma_f32_16x16x32_bf16 v[16:19], v[96:99], v[64:67], v[16:19]
v_mfma_f32_16x16x32_bf16 v[20:23], v[96:99], v[68:71], v[20:23]
v_mfma_f32_16x16x32_bf16 v[24:27], v[168:171], v[64:67], v[24:27]
v_mfma_f32_16x16x32_bf16 v[28:31], v[168:171], v[68:71], v[28:31]
s_add_u32 s37, s43, 512
s_add_u32 m0, s44, 16384
s_nop 0
buffer_load_dwordx4 v2, s[8:11], s37 offen lds
v_mfma_f32_16x16x32_bf16 v[32:35], v[240:243], v[64:67], v[32:35]
v_mfma_f32_16x16x32_bf16 v[36:39], v[240:243], v[68:71], v[36:39]
v_mfma_f32_16x16x32_bf16 v[40:43], a[56:59], v[64:67], v[40:43]
v_mfma_f32_16x16x32_bf16 v[44:47], a[56:59], v[68:71], v[44:47]
ds_read_b128 v[64:67], v3 offset:12288
ds_read_b128 v[68:71], v3 offset:13312
s_waitcnt lgkmcnt(2)
v_mfma_f32_16x16x32_bf16 v[16:19], v[100:103], v[72:75], v[16:19]
v_mfma_f32_16x16x32_bf16 v[20:23], v[100:103], v[76:79], v[20:23]
v_mfma_f32_16x16x32_bf16 v[24:27], v[172:175], v[72:75], v[24:27]
v_mfma_f32_16x16x32_bf16 v[28:31], v[172:175], v[76:79], v[28:31]
s_add_u32 s37, s43, 640
s_add_u32 m0, s44, 20480
s_nop 0
buffer_load_dwordx4 v2, s[8:11], s37 offen lds
v_mfma_f32_16x16x32_bf16 v[32:35], v[244:247], v[72:75], v[32:35]
v_mfma_f32_16x16x32_bf16 v[36:39], v[244:247], v[76:79], v[36:39]
v_mfma_f32_16x16x32_bf16 v[40:43], a[60:63], v[72:75], v[40:43]
v_mfma_f32_16x16x32_bf16 v[44:47], a[60:63], v[76:79], v[44:47]
ds_read_b128 v[72:75], v3 offset:14336
ds_read_b128 v[76:79], v3 offset:15360
s_waitcnt lgkmcnt(2)
v_mfma_f32_16x16x32_bf16 v[16:19], v[104:107], v[64:67], v[16:19]
v_mfma_f32_16x16x32_bf16 v[20:23], v[104:107], v[68:71], v[20:23]
v_mfma_f32_16x16x32_bf16 v[24:27], v[176:179], v[64:67], v[24:27]
v_mfma_f32_16x16x32_bf16 v[28:31], v[176:179], v[68:71], v[28:31]
s_add_u32 s37, s43, 768
s_add_u32 m0, s44, 24576
s_nop 0
buffer_load_dwordx4 v2, s[8:11], s37 offen lds
v_mfma_f32_16x16x32_bf16 v[32:35], v[248:251], v[64:67], v[32:35]
v_mfma_f32_16x16x32_bf16 v[36:39], v[248:251], v[68:71], v[36:39]
v_mfma_f32_16x16x32_bf16 v[40:43], a[64:67], v[64:67], v[40:43]
v_mfma_f32_16x16x32_bf16 v[44:47], a[64:67], v[68:71], v[44:47]
ds_read_b128 v[64:67], v3 offset:16384
ds_read_b128 v[68:71], v3 offset:17408
s_waitcnt lgkmcnt(2)
v_mfma_f32_16x16x32_bf16 v[16:19], v[108:111], v[72:75], v[16:19]
v_mfma_f32_16x16x32_bf16 v[20:23], v[108:111], v[76:79], v[20:23]
v_mfma_f32_16x16x32_bf16 v[24:27], v[180:183], v[72:75], v[24:27]
v_mfma_f32_16x16x32_bf16 v[28:31], v[180:183], v[76:79], v[28:31]
s_add_u32 s37, s43, 896
s_add_u32 m0, s44, 28672
s_nop 0
buffer_load_dwordx4 v2, s[8:11], s37 offen lds
v_mfma_f32_16x16x32_bf16 v[32:35], v[252:255], v[72:75], v[32:35]
v_mfma_f32_16x16x32_bf16 v[36:39], v[252:255], v[76:79], v[36:39]
v_mfma_f32_16x16x32_bf16 v[40:43], a[68:71], v[72:75], v[40:43]
v_mfma_f32_16x16x32_bf16 v[44:47], a[68:71], v[76:79], v[44:47]
ds_read_b128 v[72:75], v3 offset:18432
ds_read_b128 v[76:79], v3 offset:19456
s_waitcnt lgkmcnt(2)
v_mfma_f32_16x16x32_bf16 v[16:19], v[112:115], v[64:67], v[16:19]
v_mfma_f32_16x16x32_bf16 v[20:23], v[112:115], v[68:71], v[20:23]
v_mfma_f32_16x16x32_bf16 v[24:27], v[184:187], v[64:67], v[24:27]
v_mfma_f32_16x16x32_bf16 v[28:31], v[184:187], v[68:71], v[28:31]
s_add_u32 s37, s43, 1024
s_add_u32 m0, s44, 32768
s_nop 0
buffer_load_dwordx4 v2, s[8:11], s37 offen lds
v_mfma_f32_16x16x32_bf16 v[32:35], a[0:3], v[64:67], v[32:35]
v_mfma_f32_16x16x32_bf16 v[36:39], a[0:3], v[68:71], v[36:39]
v_mfma_f32_16x16x32_bf16 v[40:43], a[72:75], v[64:67], v[40:43]
v_mfma_f32_16x16x32_bf16 v[44:47], a[72:75], v[68:71], v[44:47]
ds_read_b128 v[64:67], v3 offset:20480
ds_read_b128 v[68:71], v3 offset:21504
s_waitcnt lgkmcnt(2)
v_mfma_f32_16x16x32_bf16 v[16:19], v[116:119], v[72:75], v[16:19]
v_mfma_f32_16x16x32_bf16 v[20:23], v[116:119], v[76:79], v[20:23]
v_mfma_f32_16x16x32_bf16 v[24:27], v[188:191], v[72:75], v[24:27]
v_mfma_f32_16x16x32_bf16 v[28:31], v[188:191], v[76:79], v[28:31]
v_mfma_f32_16x16x32_bf16 v[32:35], a[4:7], v[72:75], v[32:35]
v_mfma_f32_16x16x32_bf16 v[36:39], a[4:7], v[76:79], v[36:39]
v_mfma_f32_16x16x32_bf16 v[40:43], a[76:79], v[72:75], v[40:43]
v_mfma_f32_16x16x32_bf16 v[44:47], a[76:79], v[76:79], v[44:47]
ds_read_b128 v[72:75], v3 offset:22528
ds_read_b128 v[76:79], v3 offset:23552
s_waitcnt lgkmcnt(2)
v_mfma_f32_16x16x32_bf16 v[16:19], v[120:123], v[64:67], v[16:19]
v_mfma_f32_16x16x32_bf16 v[20:23], v[120:123], v[68:71], v[20:23]
v_mfma_f32_16x16x32_bf16 v[24:27], v[192:195], v[64:67], v[24:27]
v_mfma_f32_16x16x32_bf16 v[28:31], v[192:195], v[68:71], v[28:31]
v_mfma_f32_16x16x32_bf16 v[32:35], a[8:11], v[64:67], v[32:35]
v_mfma_f32_16x16x32_bf16 v[36:39], a[8:11], v[68:71], v[36:39]
v_mfma_f32_16x16x32_bf16 v[40:43], a[80:83], v[64:67], v[40:43]
v_mfma_f32_16x16x32_bf16 v[44:47], a[80:83], v[68:71], v[44:47]
ds_read_b128 v[64:67], v3 offset:24576
ds_read_b128 v[68:71], v3 offset:25600
s_waitcnt lgkmcnt(2)
v_mfma_f32_16x16x32_bf16 v[16:19], v[124:127], v[72:75], v[16:19]
v_mfma_f32_16x16x32_bf16 v[20:23], v[124:127], v[76:79], v[20:23]
v_mfma_f32_16x16x32_bf16 v[24:27], v[196:199], v[72:75], v[24:27]
v_mfma_f32_16x16x32_bf16 v[28:31], v[196:199], v[76:79], v[28:31]
v_mfma_f32_16x16x32_bf16 v[32:35], a[12:15], v[72:75], v[32:35]
v_mfma_f32_16x16x32_bf16 v[36:39], a[12:15], v[76:79], v[36:39]
v_mfma_f32_16x16x32_bf16 v[40:43], a[84:87], v[72:75], v[40:43]
v_mfma_f32_16x16x32_bf16 v[44:47], a[84:87], v[76:79], v[44:47]
ds_read_b128 v[72:75], v3 offset:26624
ds_read_b128 v[76:79], v3 offset:27648
s_waitcnt lgkmcnt(2)
v_mfma_f32_16x16x32_bf16 v[16:19], v[128:131], v[64:67], v[16:19]
v_mfma_f32_16x16x32_bf16 v[20:23], v[128:131], v[68:71], v[20:23]
v_mfma_f32_16x16x32_bf16 v[24:27], v[200:203], v[64:67], v[24:27]
v_mfma_f32_16x16x32_bf16 v[28:31], v[200:203], v[68:71], v[28:31]
v_mfma_f32_16x16x32_bf16 v[32:35], a[16:19], v[64:67], v[32:35]
v_mfma_f32_16x16x32_bf16 v[36:39], a[16:19], v[68:71], v[36:39]
v_mfma_f32_16x16x32_bf16 v[40:43], a[88:91], v[64:67], v[40:43]
v_mfma_f32_16x16x32_bf16 v[44:47], a[88:91], v[68:71], v[44:47]
ds_read_b128 v[64:67], v3 offset:28672
ds_read_b128 v[68:71], v3 offset:29696
s_waitcnt lgkmcnt(2)
v_mfma_f32_16x16x32_bf16 v[16:19], v[132:135], v[72:75], v[16:19]
v_mfma_f32_16x16x32_bf16 v[20:23], v[132:135], v[76:79], v[20:23]
v_mfma_f32_16x16x32_bf16 v[24:27], v[204:207], v[72:75], v[24:27]
v_mfma_f32_16x16x32_bf16 v[28:31], v[204:207], v[76:79], v[28:31]
v_mfma_f32_16x16x32_bf16 v[32:35], a[20:23], v[72:75], v[32:35]
v_mfma_f32_16x16x32_bf16 v[36:39], a[20:23], v[76:79], v[36:39]
v_mfma_f32_16x16x32_bf16 v[40:43], a[92:95], v[72:75], v[40:43]
v_mfma_f32_16x16x32_bf16 v[44:47], a[92:95], v[76:79], v[44:47]
ds_read_b128 v[72:75], v3 offset:30720
ds_read_b128 v[76:79], v3 offset:31744
s_waitcnt lgkmcnt(2)
v_mfma_f32_16x16x32_bf16 v[16:19], v[136:139], v[64:67], v[16:19]
v_mfma_f32_16x16x32_bf16 v[20:23], v[136:139], v[68:71], v[20:23]
v_mfma_f32_16x16x32_bf16 v[24:27], v[208:211], v[64:67], v[24:27]
v_mfma_f32_16x16x32_bf16 v[28:31], v[208:211], v[68:71], v[28:31]
v_mfma_f32_16x16x32_bf16 v[32:35], a[24:27], v[64:67], v[32:35]
v_mfma_f32_16x16x32_bf16 v[36:39], a[24:27], v[68:71], v[36:39]
v_mfma_f32_16x16x32_bf16 v[40:43], a[96:99], v[64:67], v[40:43]
v_mfma_f32_16x16x32_bf16 v[44:47], a[96:99], v[68:71], v[44:47]
ds_read_b128 v[64:67], v3 offset:32768
ds_read_b128 v[68:71], v3 offset:33792
s_waitcnt lgkmcnt(2)
v_mfma_f32_16x16x32_bf16 v[16:19], v[140:143], v[72:75], v[16:19]
v_mfma_f32_16x16x32_bf16 v[20:23], v[140:143], v[76:79], v[20:23]
v_mfma_f32_16x16x32_bf16 v[24:27], v[212:215], v[72:75], v[24:27]
v_mfma_f32_16x16x32_bf16 v[28:31], v[212:215], v[76:79], v[28:31]
v_mfma_f32_16x16x32_bf16 v[32:35], a[28:31], v[72:75], v[32:35]
v_mfma_f32_16x16x32_bf16 v[36:39], a[28:31], v[76:79], v[36:39]
v_mfma_f32_16x16x32_bf16 v[40:43], a[100:103], v[72:75], v[40:43]
v_mfma_f32_16x16x32_bf16 v[44:47], a[100:103], v[76:79], v[44:47]
ds_read_b128 v[72:75], v3 offset:34816
ds_read_b128 v[76:79], v3 offset:35840
s_waitcnt lgkmcnt(2)
v_mfma_f32_16x16x32_bf16 v[16:19], v[144:147], v[64:67], v[16:19]
v_mfma_f32_16x16x32_bf16 v[20:23], v[144:147], v[68:71], v[20:23]
v_mfma_f32_16x16x32_bf16 v[24:27], v[216:219], v[64:67], v[24:27]
v_mfma_f32_16x16x32_bf16 v[28:31], v[216:219], v[68:71], v[28:31]
v_mfma_f32_16x16x32_bf16 v[32:35], a[32:35], v[64:67], v[32:35]
v_mfma_f32_16x16x32_bf16 v[36:39], a[32:35], v[68:71], v[36:39]
v_mfma_f32_16x16x32_bf16 v[40:43], a[104:107], v[64:67], v[40:43]
v_mfma_f32_16x16x32_bf16 v[44:47], a[104:107], v[68:71], v[44:47]
s_waitcnt lgkmcnt(0)
v_mfma_f32_16x16x32_bf16 v[16:19], v[148:151], v[72:75], v[16:19]
v_mfma_f32_16x16x32_bf16 v[20:23], v[148:151], v[76:79], v[20:23]
v_mfma_f32_16x16x32_bf16 v[24:27], v[220:223], v[72:75], v[24:27]
v_mfma_f32_16x16x32_bf16 v[28:31], v[220:223], v[76:79], v[28:31]
v_mfma_f32_16x16x32_bf16 v[32:35], a[36:39], v[72:75], v[32:35]
v_mfma_f32_16x16x32_bf16 v[36:39], a[36:39], v[76:79], v[36:39]
v_mfma_f32_16x16x32_bf16 v[40:43], a[108:111], v[72:75], v[40:43]
v_mfma_f32_16x16x32_bf16 v[44:47], a[108:111], v[76:79], v[44:47]
v_add_u32 v3, s50, v3
s_sub_u32 s50, 0, s50
v_cvt_pk_bf16_f32 v16, v16, v17
v_cvt_pk_bf16_f32 v17, v18, v19
ds_write_b64 v4, v[16:17] offset:0
v_cvt_pk_bf16_f32 v20, v20, v21
v_cvt_pk_bf16_f32 v21, v22, v23
ds_write_b64 v4, v[20:21] offset:7296
v_cvt_pk_bf16_f32 v24, v24, v25
v_cvt_pk_bf16_f32 v25, v26, v27
ds_write_b64 v4, v[24:25] offset:32
v_cvt_pk_bf16_f32 v28, v28, v29
v_cvt_pk_bf16_f32 v29, v30, v31
ds_write_b64 v4, v[28:29] offset:7328
s_cmp_eq_u32 s34, 3
s_cbranch_scc1 L_a_gate
v_cvt_pk_bf16_f32 v32, v32, v33
v_cvt_pk_bf16_f32 v33, v34, v35
ds_write_b64 v4, v[32:33] offset:64
v_cvt_pk_bf16_f32 v36, v36, v37
v_cvt_pk_bf16_f32 v37, v38, v39
ds_write_b64 v4, v[36:37] offset:7360
v_cvt_pk_bf16_f32 v40, v40, v41
v_cvt_pk_bf16_f32 v41, v42, v43
ds_write_b64 v4, v[40:41] offset:96
v_cvt_pk_bf16_f32 v44, v44, v45
v_cvt_pk_bf16_f32 v45, v46, v47
ds_write_b64 v4, v[44:45] offset:7392
s_branch L_a_nog2
L_a_gate:
ds_write_b32 v14, v32
ds_write_b32 v14, v36 offset:64
L_a_nog2:
v_add_u32 v4, 14592, v4
v_add_u32 v14, 128, v14
s_add_u32 s35, s35, 1
s_cmp_lt_u32 s35, 6
s_cbranch_scc1 L_a_loop
s_waitcnt vmcnt(0) lgkmcnt(0)
s_barrier
s_mov_b32 s35, 0
s_mul_i32 s39, s34, 36
s_add_u32 s39, s39, 73728
s_mul_i32 s40, s33, 176
s_mov_b32 s41, 0x3eae1a93
s_mov_b32 s42, 0xbfb8aa3b
L_la_loop:
v_add_u32 v12, s35, v9
v_min_u32 v12, 175, v12
v_add_u32 v2, s40, v12
v_add_u32 v12, 16, v12
v_mul_u32_u24 v14, 456, v12
v_add_u32 v14, s39, v14
v_lshlrev_b32 v12, 2, v12
v_add_u32 v12, 161280, v12
ds_read_b32 v3, v12
ds_read2_b32 v[16:17], v14 offset0:0 offset1:1
ds_read2_b32 v[18:19], v14 offset0:2 offset1:3
ds_read2_b32 v[20:21], v14 offset0:4 offset1:5
ds_read2_b32 v[22:23], v14 offset0:6 offset1:7
ds_read_b32 v24, v14 offset:32
v_subrev_u32 v15, 0, v14
ds_read2_b32 v[26:27], v15 offset0:36 offset1:37
ds_read2_b32 v[28:29], v15 offset0:38 offset1:39
ds_read2_b32 v[30:31], v15 offset0:40 offset1:41
ds_read2_b32 v[32:33], v15 offset0:42 offset1:43
ds_read_b32 v34, v15 offset:176
v_subrev_u32 v15, 912, v14
ds_read2_b32 v[36:37], v15 offset0:36 offset1:37
ds_read2_b32 v[38:39], v15 offset0:38 offset1:39
ds_read2_b32 v[40:41], v15 offset0:40 offset1:41
ds_read2_b32 v[42:43], v15 offset0:42 offset1:43
ds_read_b32 v44, v15 offset:176
s_waitcnt lgkmcnt(5)
v_dot2_f32_bf16 v176, v16, v26, 0
v_dot2_f32_bf16 v176, v17, v27, v176
v_dot2_f32_bf16 v176, v18, v28, v176
v_dot2_f32_bf16 v176, v19, v29, v176
v_dot2_f32_bf16 v176, v20, v30, v176
v_dot2_f32_bf16 v176, v21, v31, v176
v_dot2_f32_bf16 v176, v22, v32, v176
v_dot2_f32_bf16 v176, v23, v33, v176
v_dot2_f32_bf16 v176, v24, v34, v176
v_subrev_u32 v15, 1824, v14
ds_read2_b32 v[46:47], v15 offset0:36 offset1:37
ds_read2_b32 v[48:49], v15 offset0:38 offset1:39
ds_read2_b32 v[50:51], v15 offset0:40 offset1:41
ds_read2_b32 v[52:53], v15 offset0:42 offset1:43
ds_read_b32 v54, v15 offset:176
s_waitcnt lgkmcnt(5)
v_dot2_f32_bf16 v177, v16, v36, 0
v_dot2_f32_bf16 v177, v17, v37, v177
v_dot2_f32_bf16 v177, v18, v38, v177
v_dot2_f32_bf16 v177, v19, v39, v177
v_dot2_f32_bf16 v177, v20, v40, v177
v_dot2_f32_bf16 v177, v21, v41, v177
v_dot2_f32_bf16 v177, v22, v42, v177
v_dot2_f32_bf16 v177, v23, v43, v177
v_dot2_f32_bf16 v177, v24, v44, v177
v_subrev_u32 v15, 2736, v14
ds_read2_b32 v[56:57], v15 offset0:36 offset1:37
ds_read2_b32 v[58:59], v15 offset0:38 offset1:39
ds_read2_b32 v[60:61], v15 offset0:40 offset1:41
ds_read2_b32 v[62:63], v15 offset0:42 offset1:43
ds_read_b32 v64, v15 offset:176
s_waitcnt lgkmcnt(5)
v_dot2_f32_bf16 v178, v16, v46, 0
v_dot2_f32_bf16 v178, v17, v47, v178
v_dot2_f32_bf16 v178, v18, v48, v178
v_dot2_f32_bf16 v178, v19, v49, v178
v_dot2_f32_bf16 v178, v20, v50, v178
v_dot2_f32_bf16 v178, v21, v51, v178
v_dot2_f32_bf16 v178, v22, v52, v178
v_dot2_f32_bf16 v178, v23, v53, v178
v_dot2_f32_bf16 v178, v24, v54, v178
v_subrev_u32 v15, 3648, v14
ds_read2_b32 v[26:27], v15 offset0:36 offset1:37
ds_read2_b32 v[28:29], v15 offset0:38 offset1:39
ds_read2_b32 v[30:31], v15 offset0:40 offset1:41
ds_read2_b32 v[32:33], v15 offset0:42 offset1:43
ds_read_b32 v34, v15 offset:176
s_waitcnt lgkmcnt(5)
v_dot2_f32_bf16 v179, v16, v56, 0
v_dot2_f32_bf16 v179, v17, v57, v179
v_dot2_f32_bf16 v179, v18, v58, v179
v_dot2_f32_bf16 v179, v19, v59, v179
v_dot2_f32_bf16 v179, v20, v60, v179
v_dot2_f32_bf16 v179, v21, v61, v179
v_dot2_f32_bf16 v179, v22, v62, v179
v_dot2_f32_bf16 v179, v23, v63, v179
v_dot2_f32_bf16 v179, v24, v64, v179
v_subrev_u32 v15, 4560, v14
ds_read2_b32 v[36:37], v15 offset0:36 offset1:37
ds_read2_b32 v[38:39], v15 offset0:38 offset1:39
ds_read2_b32 v[40:41], v15 offset0:40 offset1:41
ds_read2_b32 v[42:43], v15 offset0:42 offset1:43
ds_read_b32 v44, v15 offset:176
s_waitcnt lgkmcnt(5)
v_dot2_f32_bf16 v180, v16, v26, 0
v_dot2_f32_bf16 v180, v17, v27, v180
v_dot2_f32_bf16 v180, v18, v28, v180
v_dot2_f32_bf16 v180, v19, v29, v180
v_dot2_f32_bf16 v180, v20, v30, v180
v_dot2_f32_bf16 v180, v21, v31, v180
v_dot2_f32_bf16 v180, v22, v32, v180
v_dot2_f32_bf16 v180, v23, v33, v180
v_dot2_f32_bf16 v180, v24, v34, v180
v_subrev_u32 v15, 5472, v14
ds_read2_b32 v[46:47], v15 offset0:36 offset1:37
ds_read2_b32 v[48:49], v15 offset0:38 offset1:39
ds_read2_b32 v[50:51], v15 offset0:40 offset1:41
ds_read2_b32 v[52:53], v15 offset0:42 offset1:43
ds_read_b32 v54, v15 offset:176
s_waitcnt lgkmcnt(5)
v_dot2_f32_bf16 v181, v16, v36, 0
v_dot2_f32_bf16 v181, v17, v37, v181
v_dot2_f32_bf16 v181, v18, v38, v181
v_dot2_f32_bf16 v181, v19, v39, v181
v_dot2_f32_bf16 v181, v20, v40, v181
v_dot2_f32_bf16 v181, v21, v41, v181
v_dot2_f32_bf16 v181, v22, v42, v181
v_dot2_f32_bf16 v181, v23, v43, v181
v_dot2_f32_bf16 v181, v24, v44, v181
v_subrev_u32 v15, 6384, v14
ds_read2_b32 v[56:57], v15 offset0:36 offset1:37
ds_read2_b32 v[58:59], v15 offset0:38 offset1:39
ds_read2_b32 v[60:61], v15 offset0:40 offset1:41
ds_read2_b32 v[62:63], v15 offset0:42 offset1:43
ds_read_b32 v64, v15 offset:176
s_waitcnt lgkmcnt(5)
v_dot2_f32_bf16 v182, v16, v46, 0
v_dot2_f32_bf16 v182, v17, v47, v182
v_dot2_f32_bf16 v182, v18, v48, v182
v_dot2_f32_bf16 v182, v19, v49, v182
v_dot2_f32_bf16 v182, v20, v50, v182
v_dot2_f32_bf16 v182, v21, v51, v182
v_dot2_f32_bf16 v182, v22, v52, v182
v_dot2_f32_bf16 v182, v23, v53, v182
v_dot2_f32_bf16 v182, v24, v54, v182
s_waitcnt lgkmcnt(0)
v_dot2_f32_bf16 v183, v16, v56, 0
v_dot2_f32_bf16 v183, v17, v57, v183
v_dot2_f32_bf16 v183, v18, v58, v183
v_dot2_f32_bf16 v183, v19, v59, v183
v_dot2_f32_bf16 v183, v20, v60, v183
v_dot2_f32_bf16 v183, v21, v61, v183
v_dot2_f32_bf16 v183, v22, v62, v183
v_dot2_f32_bf16 v183, v23, v63, v183
v_dot2_f32_bf16 v183, v24, v64, v183
v_subrev_u32 v15, 0, v14
ds_read2_b32 v[100:101], v15 offset0:72 offset1:73
ds_read2_b32 v[102:103], v15 offset0:74 offset1:75
ds_read2_b32 v[104:105], v15 offset0:76 offset1:77
ds_read2_b32 v[106:107], v15 offset0:78 offset1:79
ds_read_b32 v108, v15 offset:320
v_subrev_u32 v15, 912, v14
ds_read2_b32 v[110:111], v15 offset0:72 offset1:73
ds_read2_b32 v[112:113], v15 offset0:74 offset1:75
ds_read2_b32 v[114:115], v15 offset0:76 offset1:77
ds_read2_b32 v[116:117], v15 offset0:78 offset1:79
ds_read_b32 v118, v15 offset:320
v_mov_b32 v13, 0xf149f2ca
v_mul_f32 v176, s41, v176
v_mul_f32 v177, s41, v177
v_mul_f32 v178, s41, v178
v_mul_f32 v179, s41, v179
v_mul_f32 v180, s41, v180
v_mul_f32 v181, s41, v181
v_mul_f32 v182, s41, v182
v_mul_f32 v183, s41, v183
v_cmp_le_u32 vcc, 2, v2
s_nop 1
v_cndmask_b32 v177, v13, v177, vcc
v_cmp_le_u32 vcc, 4, v2
s_nop 1
v_cndmask_b32 v178, v13, v178, vcc
v_cmp_le_u32 vcc, 6, v2
s_nop 1
v_cndmask_b32 v179, v13, v179, vcc
v_cmp_le_u32 vcc, 8, v2
s_nop 1
v_cndmask_b32 v180, v13, v180, vcc
v_cmp_le_u32 vcc, 10, v2
s_nop 1
v_cndmask_b32 v181, v13, v181, vcc
v_cmp_le_u32 vcc, 12, v2
s_nop 1
v_cndmask_b32 v182, v13, v182, vcc
v_cmp_le_u32 vcc, 14, v2
s_nop 1
v_cndmask_b32 v183, v13, v183, vcc
v_max3_f32 v12, v176, v177, v178
v_max3_f32 v12, v12, v179, v180
v_max3_f32 v12, v12, v181, v182
v_max_f32 v12, v12, v183
v_sub_f32 v176, v176, v12
v_sub_f32 v177, v177, v12
v_sub_f32 v178, v178, v12
v_sub_f32 v179, v179, v12
v_sub_f32 v180, v180, v12
v_sub_f32 v181, v181, v12
v_sub_f32 v182, v182, v12
v_sub_f32 v183, v183, v12
v_exp_f32 v176, v176
v_exp_f32 v177, v177
v_exp_f32 v178, v178
v_exp_f32 v179, v179
v_exp_f32 v180, v180
v_exp_f32 v181, v181
v_exp_f32 v182, v182
v_exp_f32 v183, v183
v_cvt_pk_bf16_f32 v204, v176, v8
v_cvt_pk_bf16_f32 v205, v177, v8
v_cvt_pk_bf16_f32 v206, v178, v8
v_cvt_pk_bf16_f32 v207, v179, v8
v_cvt_pk_bf16_f32 v208, v180, v8
v_cvt_pk_bf16_f32 v209, v181, v8
v_cvt_pk_bf16_f32 v210, v182, v8
v_cvt_pk_bf16_f32 v211, v183, v8
v_lshlrev_b32 v212, 16, v204
v_lshlrev_b32 v213, 16, v205
v_lshlrev_b32 v214, 16, v206
v_lshlrev_b32 v215, 16, v207
v_lshlrev_b32 v216, 16, v208
v_lshlrev_b32 v217, 16, v209
v_lshlrev_b32 v218, 16, v210
v_lshlrev_b32 v219, 16, v211
v_add_f32 v12, v212, v213
v_add_f32 v13, v214, v215
v_add_f32 v12, v12, v216
v_add_f32 v13, v13, v217
v_add_f32 v12, v12, v218
v_add_f32 v13, v13, v219
v_add_f32 v12, v12, v13
v_mul_f32 v13, s42, v3
v_exp_f32 v3, v13
v_exp_f32 v13, -v13
v_add_f32 v3, 1.0, v3
v_add_f32 v13, 1.0, v13
v_mul_f32 v12, v12, v3
v_rcp_f32 v12, v12
v_rcp_f32 v13, v13
v_subrev_u32 v15, 1824, v14
ds_read2_b32 v[120:121], v15 offset0:72 offset1:73
ds_read2_b32 v[122:123], v15 offset0:74 offset1:75
ds_read2_b32 v[124:125], v15 offset0:76 offset1:77
ds_read2_b32 v[126:127], v15 offset0:78 offset1:79
ds_read_b32 v128, v15 offset:320
s_waitcnt lgkmcnt(10)
v_dot2_f32_bf16 v184, v100, v204, 0
v_dot2_f32_bf16 v185, v100, v212, 0
v_dot2_f32_bf16 v186, v101, v204, 0
v_dot2_f32_bf16 v187, v101, v212, 0
v_dot2_f32_bf16 v188, v102, v204, 0
v_dot2_f32_bf16 v189, v102, v212, 0
v_dot2_f32_bf16 v190, v103, v204, 0
v_dot2_f32_bf16 v191, v103, v212, 0
v_dot2_f32_bf16 v192, v104, v204, 0
v_dot2_f32_bf16 v193, v104, v212, 0
v_dot2_f32_bf16 v194, v105, v204, 0
v_dot2_f32_bf16 v195, v105, v212, 0
v_dot2_f32_bf16 v196, v106, v204, 0
v_dot2_f32_bf16 v197, v106, v212, 0
v_dot2_f32_bf16 v198, v107, v204, 0
v_dot2_f32_bf16 v199, v107, v212, 0
v_dot2_f32_bf16 v200, v108, v204, 0
v_dot2_f32_bf16 v201, v108, v212, 0
v_subrev_u32 v15, 2736, v14
ds_read2_b32 v[130:131], v15 offset0:72 offset1:73
ds_read2_b32 v[132:133], v15 offset0:74 offset1:75
ds_read2_b32 v[134:135], v15 offset0:76 offset1:77
ds_read2_b32 v[136:137], v15 offset0:78 offset1:79
ds_read_b32 v138, v15 offset:320
s_waitcnt lgkmcnt(10)
v_dot2_f32_bf16 v184, v110, v205, v184
v_dot2_f32_bf16 v185, v110, v213, v185
v_dot2_f32_bf16 v186, v111, v205, v186
v_dot2_f32_bf16 v187, v111, v213, v187
v_dot2_f32_bf16 v188, v112, v205, v188
v_dot2_f32_bf16 v189, v112, v213, v189
v_dot2_f32_bf16 v190, v113, v205, v190
v_dot2_f32_bf16 v191, v113, v213, v191
v_dot2_f32_bf16 v192, v114, v205, v192
v_dot2_f32_bf16 v193, v114, v213, v193
v_dot2_f32_bf16 v194, v115, v205, v194
v_dot2_f32_bf16 v195, v115, v213, v195
v_dot2_f32_bf16 v196, v116, v205, v196
v_dot2_f32_bf16 v197, v116, v213, v197
v_dot2_f32_bf16 v198, v117, v205, v198
v_dot2_f32_bf16 v199, v117, v213, v199
v_dot2_f32_bf16 v200, v118, v205, v200
v_dot2_f32_bf16 v201, v118, v213, v201
v_subrev_u32 v15, 3648, v14
ds_read2_b32 v[100:101], v15 offset0:72 offset1:73
ds_read2_b32 v[102:103], v15 offset0:74 offset1:75
ds_read2_b32 v[104:105], v15 offset0:76 offset1:77
ds_read2_b32 v[106:107], v15 offset0:78 offset1:79
ds_read_b32 v108, v15 offset:320
s_waitcnt lgkmcnt(10)
v_dot2_f32_bf16 v184, v120, v206, v184
v_dot2_f32_bf16 v185, v120, v214, v185
v_dot2_f32_bf16 v186, v121, v206, v186
v_dot2_f32_bf16 v187, v121, v214, v187
v_dot2_f32_bf16 v188, v122, v206, v188
v_dot2_f32_bf16 v189, v122, v214, v189
v_dot2_f32_bf16 v190, v123, v206, v190
v_dot2_f32_bf16 v191, v123, v214, v191
v_dot2_f32_bf16 v192, v124, v206, v192
v_dot2_f32_bf16 v193, v124, v214, v193
v_dot2_f32_bf16 v194, v125, v206, v194
v_dot2_f32_bf16 v195, v125, v214, v195
v_dot2_f32_bf16 v196, v126, v206, v196
v_dot2_f32_bf16 v197, v126, v214, v197
v_dot2_f32_bf16 v198, v127, v206, v198
v_dot2_f32_bf16 v199, v127, v214, v199
v_dot2_f32_bf16 v200, v128, v206, v200
v_dot2_f32_bf16 v201, v128, v214, v201
v_subrev_u32 v15, 4560, v14
ds_read2_b32 v[110:111], v15 offset0:72 offset1:73
ds_read2_b32 v[112:113], v15 offset0:74 offset1:75
ds_read2_b32 v[114:115], v15 offset0:76 offset1:77
ds_read2_b32 v[116:117], v15 offset0:78 offset1:79
ds_read_b32 v118, v15 offset:320
s_waitcnt lgkmcnt(10)
v_dot2_f32_bf16 v184, v130, v207, v184
v_dot2_f32_bf16 v185, v130, v215, v185
v_dot2_f32_bf16 v186, v131, v207, v186
v_dot2_f32_bf16 v187, v131, v215, v187
v_dot2_f32_bf16 v188, v132, v207, v188
v_dot2_f32_bf16 v189, v132, v215, v189
v_dot2_f32_bf16 v190, v133, v207, v190
v_dot2_f32_bf16 v191, v133, v215, v191
v_dot2_f32_bf16 v192, v134, v207, v192
v_dot2_f32_bf16 v193, v134, v215, v193
v_dot2_f32_bf16 v194, v135, v207, v194
v_dot2_f32_bf16 v195, v135, v215, v195
v_dot2_f32_bf16 v196, v136, v207, v196
v_dot2_f32_bf16 v197, v136, v215, v197
v_dot2_f32_bf16 v198, v137, v207, v198
v_dot2_f32_bf16 v199, v137, v215, v199
v_dot2_f32_bf16 v200, v138, v207, v200
v_dot2_f32_bf16 v201, v138, v215, v201
v_subrev_u32 v15, 5472, v14
ds_read2_b32 v[120:121], v15 offset0:72 offset1:73
ds_read2_b32 v[122:123], v15 offset0:74 offset1:75
ds_read2_b32 v[124:125], v15 offset0:76 offset1:77
ds_read2_b32 v[126:127], v15 offset0:78 offset1:79
ds_read_b32 v128, v15 offset:320
s_waitcnt lgkmcnt(10)
v_dot2_f32_bf16 v184, v100, v208, v184
v_dot2_f32_bf16 v185, v100, v216, v185
v_dot2_f32_bf16 v186, v101, v208, v186
v_dot2_f32_bf16 v187, v101, v216, v187
v_dot2_f32_bf16 v188, v102, v208, v188
v_dot2_f32_bf16 v189, v102, v216, v189
v_dot2_f32_bf16 v190, v103, v208, v190
v_dot2_f32_bf16 v191, v103, v216, v191
v_dot2_f32_bf16 v192, v104, v208, v192
v_dot2_f32_bf16 v193, v104, v216, v193
v_dot2_f32_bf16 v194, v105, v208, v194
v_dot2_f32_bf16 v195, v105, v216, v195
v_dot2_f32_bf16 v196, v106, v208, v196
v_dot2_f32_bf16 v197, v106, v216, v197
v_dot2_f32_bf16 v198, v107, v208, v198
v_dot2_f32_bf16 v199, v107, v216, v199
v_dot2_f32_bf16 v200, v108, v208, v200
v_dot2_f32_bf16 v201, v108, v216, v201
v_subrev_u32 v15, 6384, v14
ds_read2_b32 v[130:131], v15 offset0:72 offset1:73
ds_read2_b32 v[132:133], v15 offset0:74 offset1:75
ds_read2_b32 v[134:135], v15 offset0:76 offset1:77
ds_read2_b32 v[136:137], v15 offset0:78 offset1:79
ds_read_b32 v138, v15 offset:320
s_waitcnt lgkmcnt(10)
v_dot2_f32_bf16 v184, v110, v209, v184
v_dot2_f32_bf16 v185, v110, v217, v185
v_dot2_f32_bf16 v186, v111, v209, v186
v_dot2_f32_bf16 v187, v111, v217, v187
v_dot2_f32_bf16 v188, v112, v209, v188
v_dot2_f32_bf16 v189, v112, v217, v189
v_dot2_f32_bf16 v190, v113, v209, v190
v_dot2_f32_bf16 v191, v113, v217, v191
v_dot2_f32_bf16 v192, v114, v209, v192
v_dot2_f32_bf16 v193, v114, v217, v193
v_dot2_f32_bf16 v194, v115, v209, v194
v_dot2_f32_bf16 v195, v115, v217, v195
v_dot2_f32_bf16 v196, v116, v209, v196
v_dot2_f32_bf16 v197, v116, v217, v197
v_dot2_f32_bf16 v198, v117, v209, v198
v_dot2_f32_bf16 v199, v117, v217, v199
v_dot2_f32_bf16 v200, v118, v209, v200
v_dot2_f32_bf16 v201, v118, v217, v201
s_waitcnt lgkmcnt(5)
v_dot2_f32_bf16 v184, v120, v210, v184
v_dot2_f32_bf16 v185, v120, v218, v185
v_dot2_f32_bf16 v186, v121, v210, v186
v_dot2_f32_bf16 v187, v121, v218, v187
v_dot2_f32_bf16 v188, v122, v210, v188
v_dot2_f32_bf16 v189, v122, v218, v189
v_dot2_f32_bf16 v190, v123, v210, v190
v_dot2_f32_bf16 v191, v123, v218, v191
v_dot2_f32_bf16 v192, v124, v210, v192
v_dot2_f32_bf16 v193, v124, v218, v193
v_dot2_f32_bf16 v194, v125, v210, v194
v_dot2_f32_bf16 v195, v125, v218, v195
v_dot2_f32_bf16 v196, v126, v210, v196
v_dot2_f32_bf16 v197, v126, v218, v197
v_dot2_f32_bf16 v198, v127, v210, v198
v_dot2_f32_bf16 v199, v127, v218, v199
v_dot2_f32_bf16 v200, v128, v210, v200
v_dot2_f32_bf16 v201, v128, v218, v201
s_waitcnt lgkmcnt(0)
v_dot2_f32_bf16 v184, v130, v211, v184
v_dot2_f32_bf16 v185, v130, v219, v185
v_dot2_f32_bf16 v186, v131, v211, v186
v_dot2_f32_bf16 v187, v131, v219, v187
v_dot2_f32_bf16 v188, v132, v211, v188
v_dot2_f32_bf16 v189, v132, v219, v189
v_dot2_f32_bf16 v190, v133, v211, v190
v_dot2_f32_bf16 v191, v133, v219, v191
v_dot2_f32_bf16 v192, v134, v211, v192
v_dot2_f32_bf16 v193, v134, v219, v193
v_dot2_f32_bf16 v194, v135, v211, v194
v_dot2_f32_bf16 v195, v135, v219, v195
v_dot2_f32_bf16 v196, v136, v211, v196
v_dot2_f32_bf16 v197, v136, v219, v197
v_dot2_f32_bf16 v198, v137, v211, v198
v_dot2_f32_bf16 v199, v137, v219, v199
v_dot2_f32_bf16 v200, v138, v211, v200
v_dot2_f32_bf16 v201, v138, v219, v201
s_or_b32 s37, s32, s34
s_cmp_lg_u32 s37, 0
s_cbranch_scc1 L_la_noomg
v_lshlrev_b32 v15, 2, v2
v_min_u32 v15, 8192, v15
s_mov_b32 s37, 87031808
buffer_store_dword v13, v15, s[4:7], s37 offen sc0 sc1
L_la_noomg:
v_mul_f32 v184, v184, v12
v_mul_f32 v185, v185, v12
v_mul_f32 v186, v186, v12
v_mul_f32 v187, v187, v12
v_mul_f32 v188, v188, v12
v_mul_f32 v189, v189, v12
v_mul_f32 v190, v190, v12
v_mul_f32 v191, v191, v12
v_mul_f32 v192, v192, v12
v_mul_f32 v193, v193, v12
v_mul_f32 v194, v194, v12
v_mul_f32 v195, v195, v12
v_mul_f32 v196, v196, v12
v_mul_f32 v197, v197, v12
v_mul_f32 v198, v198, v12
v_mul_f32 v199, v199, v12
v_mul_f32 v200, v200, v12
v_mul_f32 v201, v201, v12
v_cvt_pk_bf16_f32 v184, v184, v185
v_cvt_pk_bf16_f32 v185, v186, v187
v_cvt_pk_bf16_f32 v186, v188, v189
v_cvt_pk_bf16_f32 v187, v190, v191
v_cvt_pk_bf16_f32 v188, v192, v193
v_cvt_pk_bf16_f32 v189, v194, v195
v_cvt_pk_bf16_f32 v190, v196, v197
v_cvt_pk_bf16_f32 v191, v198, v199
v_cvt_pk_bf16_f32 v192, v200, v201
ds_write2_b32 v14, v184, v185 offset0:0 offset1:1
ds_write2_b32 v14, v186, v187 offset0:2 offset1:3
ds_write2_b32 v14, v188, v189 offset0:4 offset1:5
ds_write2_b32 v14, v190, v191 offset0:6 offset1:7
ds_write_b32 v14, v192 offset:32
s_add_u32 s35, s35, 64
s_cmp_lt_u32 s35, 192
s_cbranch_scc1 L_la_loop
s_waitcnt lgkmcnt(0)
s_barrier
v_mul_u32_u24 v14, 456, v10
v_lshl_add_u32 v14, v11, 4, v14
s_add_u32 s37, s34, 1
s_mul_i32 s37, s37, 7296
s_add_u32 s37, s37, 73728
v_add_u32 v14, s37, v14
s_mul_i32 s40, s33, 11
s_add_u32 s40, s40, s34
s_mov_b32 s35, s34
s_mul_i32 s41, s32, 2304
s_add_u32 s41, s41, 83886080
L_oa_loop:
s_cmp_ge_u32 s40, 128
s_cbranch_scc1 L_oa_done
ds_read2_b64 v[16:19], v14 offset0:0 offset1:1
ds_read2_b64 v[20:23], v14 offset0:8 offset1:9
ds_read2_b64 v[24:27], v14 offset0:16 offset1:17
s_mul_i32 s37, s40, 18432
s_add_u32 s37, s37, s41
s_waitcnt lgkmcnt(2)
buffer_store_dwordx4 v[16:19], v1, s[4:7], s37 offen offset:0 sc0 sc1
s_waitcnt lgkmcnt(1)
buffer_store_dwordx4 v[20:23], v1, s[4:7], s37 offen offset:1024 sc0 sc1
s_waitcnt lgkmcnt(0)
s_mov_b64 exec, 0xffff
buffer_store_dwordx4 v[24:27], v1, s[4:7], s37 offen offset:2048 sc0 sc1
s_mov_b64 exec, -1
v_add_u32 v14, 29184, v14
s_add_u32 s40, s40, 4
s_add_u32 s35, s35, 4
s_cmp_lt_u32 s35, 11
s_cbranch_scc1 L_oa_loop
L_oa_done:
s_waitcnt vmcnt(0)
s_barrier
s_cmp_lg_u32 s34, 0
s_cbranch_scc1 L_a_sig
v_mov_b32 v12, 1
s_mov_b64 exec, 1
buffer_atomic_add v12, v8, s[24:27], 0 offen offset:4 sc1
s_mov_b64 exec, -1
L_a_sig:
v_add_u32 v12, 0, v9
v_mul_u32_u24 v13, 171, v12
v_lshrrev_b32 v13, 10, v13
v_mul_u32_u24 v13, 1056, v13
v_lshl_add_u32 v2, v12, 4, v13
v_add_u32 v12, 64, v9
v_mul_u32_u24 v13, 171, v12
v_lshrrev_b32 v13, 10, v13
v_mul_u32_u24 v13, 1056, v13
v_lshl_add_u32 v3, v12, 4, v13
v_add_u32 v12, 128, v9
v_mul_u32_u24 v13, 171, v12
v_lshrrev_b32 v13, 10, v13
v_mul_u32_u24 v13, 1056, v13
v_lshl_add_u32 v4, v12, 4, v13
v_lshrrev_b32 v12, 2, v10
v_lshl_add_u32 v12, v11, 2, v12
v_mul_u32_u24 v5, 96, v12
v_and_b32 v12, 3, v10
v_lshl_add_u32 v5, v12, 3, v5
v_lshrrev_b32 v12, 2, v10
v_lshl_add_u32 v12, v11, 3, v12
v_mul_u32_u24 v6, 96, v12
v_and_b32 v12, 3, v10
v_lshl_add_u32 v6, v12, 3, v6
s_lshl_b32 s50, s34, 15
v_add_u32 v5, s50, v5
v_add_u32 v6, s50, v6
v_add_u32 v7, s50, v1
s_mul_i32 s37, s49, 96
s_mul_i32 s51, s34, 1179648
s_add_u32 s51, s51, s37
s_mul_i32 s52, s34, 184320
s_add_u32 s52, s52, s37
v_mul_u32_u24 v15, 1152, v10
v_lshl_add_u32 v15, v11, 3, v15
s_lshl_b32 s38, s34, 5
s_add_u32 s37, s37, s38
s_mul_i32 s55, s48, 18432
s_add_u32 s54, s55, 83886080
s_add_u32 s55, s55, s37
s_lshl_b32 s53, s48, 17
s_add_u32 s53, s53, s50
s_add_u32 s53, s53, 67108864
s_lshl_b32 s56, s48, 6
s_add_u32 s56, s56, 87031808
s_lshl_b32 s57, s48, 8
s_add_u32 s57, s57, 331776
v_lshlrev_b32 v9, 2, v9
v_lshlrev_b32 v10, 2, v10
v_add_u32 v14, 131072, v1
s_add_u32 s37, s52, 0
s_add_u32 m0, s50, 0
s_nop 0
buffer_load_dwordx4 v2, s[16:19], s37 offen lds
s_add_u32 m0, s50, 1024
s_nop 0
buffer_load_dwordx4 v3, s[16:19], s37 offen lds
s_add_u32 m0, s50, 2048
s_nop 0
buffer_load_dwordx4 v4, s[16:19], s37 offen lds
s_add_u32 s37, s52, 36864
s_add_u32 m0, s50, 3072
s_nop 0
buffer_load_dwordx4 v2, s[16:19], s37 offen lds
s_add_u32 m0, s50, 4096
s_nop 0
buffer_load_dwordx4 v3, s[16:19], s37 offen lds
s_add_u32 m0, s50, 5120
s_nop 0
buffer_load_dwordx4 v4, s[16:19], s37 offen lds
s_add_u32 s37, s52, 73728
s_add_u32 m0, s50, 6144
s_nop 0
buffer_load_dwordx4 v2, s[16:19], s37 offen lds
s_add_u32 m0, s50, 7168
s_nop 0
buffer_load_dwordx4 v3, s[16:19], s37 offen lds
s_add_u32 m0, s50, 8192
s_nop 0
buffer_load_dwordx4 v4, s[16:19], s37 offen lds
s_add_u32 s37, s52, 110592
s_add_u32 m0, s50, 9216
s_nop 0
buffer_load_dwordx4 v2, s[16:19], s37 offen lds
s_add_u32 m0, s50, 10240
s_nop 0
buffer_load_dwordx4 v3, s[16:19], s37 offen lds
s_add_u32 m0, s50, 11264
s_nop 0
buffer_load_dwordx4 v4, s[16:19], s37 offen lds
s_add_u32 s37, s52, 147456
s_add_u32 m0, s50, 12288
s_nop 0
buffer_load_dwordx4 v2, s[16:19], s37 offen lds
s_add_u32 m0, s50, 13312
s_nop 0
buffer_load_dwordx4 v3, s[16:19], s37 offen lds
s_add_u32 m0, s50, 14336
s_nop 0
buffer_load_dwordx4 v4, s[16:19], s37 offen lds
s_add_u32 s37, s51, 0
s_add_u32 m0, s50, 15360
s_nop 0
buffer_load_dwordx4 v2, s[20:23], s37 offen lds
s_add_u32 m0, s50, 16384
s_nop 0
buffer_load_dwordx4 v3, s[20:23], s37 offen lds
s_add_u32 m0, s50, 17408
s_nop 0
buffer_load_dwordx4 v4, s[20:23], s37 offen lds
s_add_u32 s37, s51, 36864
s_add_u32 m0, s50, 18432
s_nop 0
buffer_load_dwordx4 v2, s[20:23], s37 offen lds
s_add_u32 m0, s50, 19456
s_nop 0
buffer_load_dwordx4 v3, s[20:23], s37 offen lds
s_add_u32 m0, s50, 20480
s_nop 0
buffer_load_dwordx4 v4, s[20:23], s37 offen lds
s_add_u32 s37, s51, 73728
s_add_u32 m0, s50, 21504
s_nop 0
buffer_load_dwordx4 v2, s[20:23], s37 offen lds
s_add_u32 m0, s50, 22528
s_nop 0
buffer_load_dwordx4 v3, s[20:23], s37 offen lds
s_add_u32 m0, s50, 23552
s_nop 0
buffer_load_dwordx4 v4, s[20:23], s37 offen lds
s_add_u32 s37, s51, 110592
s_add_u32 m0, s50, 24576
s_nop 0
buffer_load_dwordx4 v2, s[20:23], s37 offen lds
s_add_u32 m0, s50, 25600
s_nop 0
buffer_load_dwordx4 v3, s[20:23], s37 offen lds
s_add_u32 m0, s50, 26624
s_nop 0
buffer_load_dwordx4 v4, s[20:23], s37 offen lds
s_waitcnt vmcnt(24)
ds_read_b64_tr_b16 v[68:69], v6 offset:0
ds_read_b64_tr_b16 v[70:71], v6 offset:384
ds_read_b64_tr_b16 v[72:73], v6 offset:32
ds_read_b64_tr_b16 v[74:75], v6 offset:416
ds_read_b64_tr_b16 v[76:77], v6 offset:64
ds_read_b64_tr_b16 v[78:79], v6 offset:448
s_waitcnt lgkmcnt(0)
s_add_u32 s37, s51, 147456
s_add_u32 m0, s50, 27648
s_nop 0
buffer_load_dwordx4 v2, s[20:23], s37 offen lds
s_add_u32 m0, s50, 28672
s_nop 0
buffer_load_dwordx4 v3, s[20:23], s37 offen lds
s_add_u32 m0, s50, 29696
s_nop 0
buffer_load_dwordx4 v4, s[20:23], s37 offen lds
s_waitcnt vmcnt(24)
ds_read_b64_tr_b16 v[80:81], v6 offset:3072
ds_read_b64_tr_b16 v[82:83], v6 offset:3456
ds_read_b64_tr_b16 v[84:85], v6 offset:3104
ds_read_b64_tr_b16 v[86:87], v6 offset:3488
ds_read_b64_tr_b16 v[88:89], v6 offset:3136
ds_read_b64_tr_b16 v[90:91], v6 offset:3520
s_waitcnt lgkmcnt(0)
s_add_u32 s37, s51, 184320
s_add_u32 m0, s50, 0
s_nop 0
buffer_load_dwordx4 v2, s[20:23], s37 offen lds
s_add_u32 m0, s50, 1024
s_nop 0
buffer_load_dwordx4 v3, s[20:23], s37 offen lds
s_add_u32 m0, s50, 2048
s_nop 0
buffer_load_dwordx4 v4, s[20:23], s37 offen lds
s_waitcnt vmcnt(24)
ds_read_b64_tr_b16 v[92:93], v6 offset:6144
ds_read_b64_tr_b16 v[94:95], v6 offset:6528
ds_read_b64_tr_b16 v[96:97], v6 offset:6176
ds_read_b64_tr_b16 v[98:99], v6 offset:6560
ds_read_b64_tr_b16 v[100:101], v6 offset:6208
ds_read_b64_tr_b16 v[102:103], v6 offset:6592
s_waitcnt lgkmcnt(0)
s_add_u32 s37, s51, 221184
s_add_u32 m0, s50, 3072
s_nop 0
buffer_load_dwordx4 v2, s[20:23], s37 offen lds
s_add_u32 m0, s50, 4096
s_nop 0
buffer_load_dwordx4 v3, s[20:23], s37 offen lds
s_add_u32 m0, s50, 5120
s_nop 0
buffer_load_dwordx4 v4, s[20:23], s37 offen lds
s_waitcnt vmcnt(24)
ds_read_b64_tr_b16 v[104:105], v6 offset:9216
ds_read_b64_tr_b16 v[106:107], v6 offset:9600
ds_read_b64_tr_b16 v[108:109], v6 offset:9248
ds_read_b64_tr_b16 v[110:111], v6 offset:9632
ds_read_b64_tr_b16 v[112:113], v6 offset:9280
ds_read_b64_tr_b16 v[114:115], v6 offset:9664
s_waitcnt lgkmcnt(0)
s_add_u32 s37, s51, 258048
s_add_u32 m0, s50, 6144
s_nop 0
buffer_load_dwordx4 v2, s[20:23], s37 offen lds
s_add_u32 m0, s50, 7168
s_nop 0
buffer_load_dwordx4 v3, s[20:23], s37 offen lds
s_add_u32 m0, s50, 8192
s_nop 0
buffer_load_dwordx4 v4, s[20:23], s37 offen lds
s_waitcnt vmcnt(24)
ds_read_b64_tr_b16 v[116:117], v6 offset:12288
ds_read_b64_tr_b16 v[118:119], v6 offset:12672
ds_read_b64_tr_b16 v[120:121], v6 offset:12320
ds_read_b64_tr_b16 v[122:123], v6 offset:12704
ds_read_b64_tr_b16 v[124:125], v6 offset:12352
ds_read_b64_tr_b16 v[126:127], v6 offset:12736
s_waitcnt lgkmcnt(0)
s_add_u32 s37, s51, 294912
s_add_u32 m0, s50, 9216
s_nop 0
buffer_load_dwordx4 v2, s[20:23], s37 offen lds
s_add_u32 m0, s50, 10240
s_nop 0
buffer_load_dwordx4 v3, s[20:23], s37 offen lds
s_add_u32 m0, s50, 11264
s_nop 0
buffer_load_dwordx4 v4, s[20:23], s37 offen lds
s_waitcnt vmcnt(24)
ds_read_b64_tr_b16 v[128:129], v5 offset:15360
ds_read_b64_tr_b16 v[130:131], v5 offset:16896
ds_read_b64_tr_b16 v[132:133], v5 offset:15392
ds_read_b64_tr_b16 v[134:135], v5 offset:16928
ds_read_b64_tr_b16 v[136:137], v5 offset:15424
ds_read_b64_tr_b16 v[138:139], v5 offset:16960
s_waitcnt lgkmcnt(0)
s_add_u32 s37, s51, 331776
s_add_u32 m0, s50, 12288
s_nop 0
buffer_load_dwordx4 v2, s[20:23], s37 offen lds
s_add_u32 m0, s50, 13312
s_nop 0
buffer_load_dwordx4 v3, s[20:23], s37 offen lds
s_add_u32 m0, s50, 14336
s_nop 0
buffer_load_dwordx4 v4, s[20:23], s37 offen lds
s_waitcnt vmcnt(24)
ds_read_b64_tr_b16 v[140:141], v5 offset:18432
ds_read_b64_tr_b16 v[142:143], v5 offset:19968
ds_read_b64_tr_b16 v[144:145], v5 offset:18464
ds_read_b64_tr_b16 v[146:147], v5 offset:20000
ds_read_b64_tr_b16 v[148:149], v5 offset:18496
ds_read_b64_tr_b16 v[150:151], v5 offset:20032
s_waitcnt lgkmcnt(0)
s_add_u32 s37, s51, 368640
s_add_u32 m0, s50, 15360
s_nop 0
buffer_load_dwordx4 v2, s[20:23], s37 offen lds
s_add_u32 m0, s50, 16384
s_nop 0
buffer_load_dwordx4 v3, s[20:23], s37 offen lds
s_add_u32 m0, s50, 17408
s_nop 0
buffer_load_dwordx4 v4, s[20:23], s37 offen lds
s_waitcnt vmcnt(24)
ds_read_b64_tr_b16 v[152:153], v5 offset:21504
ds_read_b64_tr_b16 v[154:155], v5 offset:23040
ds_read_b64_tr_b16 v[156:157], v5 offset:21536
ds_read_b64_tr_b16 v[158:159], v5 offset:23072
ds_read_b64_tr_b16 v[160:161], v5 offset:21568
ds_read_b64_tr_b16 v[162:163], v5 offset:23104
s_waitcnt lgkmcnt(0)
s_add_u32 s37, s51, 405504
s_add_u32 m0, s50, 18432
s_nop 0
buffer_load_dwordx4 v2, s[20:23], s37 offen lds
s_add_u32 m0, s50, 19456
s_nop 0
buffer_load_dwordx4 v3, s[20:23], s37 offen lds
s_add_u32 m0, s50, 20480
s_nop 0
buffer_load_dwordx4 v4, s[20:23], s37 offen lds
s_waitcnt vmcnt(24)
ds_read_b64_tr_b16 v[164:165], v5 offset:24576
ds_read_b64_tr_b16 v[166:167], v5 offset:26112
ds_read_b64_tr_b16 v[168:169], v5 offset:24608
ds_read_b64_tr_b16 v[170:171], v5 offset:26144
ds_read_b64_tr_b16 v[172:173], v5 offset:24640
ds_read_b64_tr_b16 v[174:175], v5 offset:26176
s_waitcnt lgkmcnt(0)
s_add_u32 s37, s51, 442368
s_add_u32 m0, s50, 21504
s_nop 0
buffer_load_dwordx4 v2, s[20:23], s37 offen lds
s_add_u32 m0, s50, 22528
s_nop 0
buffer_load_dwordx4 v3, s[20:23], s37 offen lds
s_add_u32 m0, s50, 23552
s_nop 0
buffer_load_dwordx4 v4, s[20:23], s37 offen lds
s_waitcnt vmcnt(24)
ds_read_b64_tr_b16 v[176:177], v5 offset:27648
ds_read_b64_tr_b16 v[178:179], v5 offset:29184
ds_read_b64_tr_b16 v[180:181], v5 offset:27680
ds_read_b64_tr_b16 v[182:183], v5 offset:29216
ds_read_b64_tr_b16 v[184:185], v5 offset:27712
ds_read_b64_tr_b16 v[186:187], v5 offset:29248
s_waitcnt lgkmcnt(0)
s_add_u32 s37, s51, 479232
s_add_u32 m0, s50, 24576
s_nop 0
buffer_load_dwordx4 v2, s[20:23], s37 offen lds
s_add_u32 m0, s50, 25600
s_nop 0
buffer_load_dwordx4 v3, s[20:23], s37 offen lds
s_add_u32 m0, s50, 26624
s_nop 0
buffer_load_dwordx4 v4, s[20:23], s37 offen lds
s_waitcnt vmcnt(24)
ds_read_b64_tr_b16 v[188:189], v5 offset:0
ds_read_b64_tr_b16 v[190:191], v5 offset:1536
ds_read_b64_tr_b16 v[192:193], v5 offset:32
ds_read_b64_tr_b16 v[194:195], v5 offset:1568
ds_read_b64_tr_b16 v[196:197], v5 offset:64
ds_read_b64_tr_b16 v[198:199], v5 offset:1600
s_waitcnt lgkmcnt(0)
s_add_u32 s37, s51, 516096
s_add_u32 m0, s50, 27648
s_nop 0
buffer_load_dwordx4 v2, s[20:23], s37 offen lds
s_add_u32 m0, s50, 28672
s_nop 0
buffer_load_dwordx4 v3, s[20:23], s37 offen lds
s_add_u32 m0, s50, 29696
s_nop 0
buffer_load_dwordx4 v4, s[20:23], s37 offen lds
s_waitcnt vmcnt(24)
ds_read_b64_tr_b16 v[200:201], v5 offset:3072
ds_read_b64_tr_b16 v[202:203], v5 offset:4608
ds_read_b64_tr_b16 v[204:205], v5 offset:3104
ds_read_b64_tr_b16 v[206:207], v5 offset:4640
ds_read_b64_tr_b16 v[208:209], v5 offset:3136
ds_read_b64_tr_b16 v[210:211], v5 offset:4672
s_waitcnt lgkmcnt(0)
s_add_u32 s37, s51, 552960
s_add_u32 m0, s50, 0
s_nop 0
buffer_load_dwordx4 v2, s[20:23], s37 offen lds
s_add_u32 m0, s50, 1024
s_nop 0
buffer_load_dwordx4 v3, s[20:23], s37 offen lds
s_add_u32 m0, s50, 2048
s_nop 0
buffer_load_dwordx4 v4, s[20:23], s37 offen lds
s_waitcnt vmcnt(24)
ds_read_b64_tr_b16 v[212:213], v5 offset:6144
ds_read_b64_tr_b16 v[214:215], v5 offset:7680
ds_read_b64_tr_b16 v[216:217], v5 offset:6176
ds_read_b64_tr_b16 v[218:219], v5 offset:7712
ds_read_b64_tr_b16 v[220:221], v5 offset:6208
ds_read_b64_tr_b16 v[222:223], v5 offset:7744
s_waitcnt lgkmcnt(0)
s_add_u32 s37, s51, 589824
s_add_u32 m0, s50, 3072
s_nop 0
buffer_load_dwordx4 v2, s[20:23], s37 offen lds
s_add_u32 m0, s50, 4096
s_nop 0
buffer_load_dwordx4 v3, s[20:23], s37 offen lds
s_add_u32 m0, s50, 5120
s_nop 0
buffer_load_dwordx4 v4, s[20:23], s37 offen lds
s_waitcnt vmcnt(24)
ds_read_b64_tr_b16 v[224:225], v5 offset:9216
ds_read_b64_tr_b16 v[226:227], v5 offset:10752
ds_read_b64_tr_b16 v[228:229], v5 offset:9248
ds_read_b64_tr_b16 v[230:231], v5 offset:10784
ds_read_b64_tr_b16 v[232:233], v5 offset:9280
ds_read_b64_tr_b16 v[234:235], v5 offset:10816
s_waitcnt lgkmcnt(0)
s_add_u32 s37, s51, 626688
s_add_u32 m0, s50, 6144
s_nop 0
buffer_load_dwordx4 v2, s[20:23], s37 offen lds
s_add_u32 m0, s50, 7168
s_nop 0
buffer_load_dwordx4 v3, s[20:23], s37 offen lds
s_add_u32 m0, s50, 8192
s_nop 0
buffer_load_dwordx4 v4, s[20:23], s37 offen lds
s_waitcnt vmcnt(24)
ds_read_b64_tr_b16 v[236:237], v5 offset:12288
ds_read_b64_tr_b16 v[238:239], v5 offset:13824
ds_read_b64_tr_b16 v[240:241], v5 offset:12320
ds_read_b64_tr_b16 v[242:243], v5 offset:13856
ds_read_b64_tr_b16 v[244:245], v5 offset:12352
ds_read_b64_tr_b16 v[246:247], v5 offset:13888
s_waitcnt lgkmcnt(0)
s_add_u32 s37, s51, 663552
s_add_u32 m0, s50, 9216
s_nop 0
buffer_load_dwordx4 v2, s[20:23], s37 offen lds
s_add_u32 m0, s50, 10240
s_nop 0
buffer_load_dwordx4 v3, s[20:23], s37 offen lds
s_add_u32 m0, s50, 11264
s_nop 0
buffer_load_dwordx4 v4, s[20:23], s37 offen lds
s_waitcnt vmcnt(24)
ds_read_b64_tr_b16 v[248:249], v5 offset:15360
ds_read_b64_tr_b16 v[250:251], v5 offset:16896
ds_read_b64_tr_b16 v[252:253], v5 offset:15392
ds_read_b64_tr_b16 v[254:255], v5 offset:16928
ds_read_b64_tr_b16 a[0:1], v5 offset:15424
ds_read_b64_tr_b16 a[2:3], v5 offset:16960
s_waitcnt lgkmcnt(0)
s_add_u32 s37, s51, 700416
s_add_u32 m0, s50, 12288
s_nop 0
buffer_load_dwordx4 v2, s[20:23], s37 offen lds
s_add_u32 m0, s50, 13312
s_nop 0
buffer_load_dwordx4 v3, s[20:23], s37 offen lds
s_add_u32 m0, s50, 14336
s_nop 0
buffer_load_dwordx4 v4, s[20:23], s37 offen lds
s_waitcnt vmcnt(24)
ds_read_b64_tr_b16 a[4:5], v5 offset:18432
ds_read_b64_tr_b16 a[6:7], v5 offset:19968
ds_read_b64_tr_b16 a[8:9], v5 offset:18464
ds_read_b64_tr_b16 a[10:11], v5 offset:20000
ds_read_b64_tr_b16 a[12:13], v5 offset:18496
ds_read_b64_tr_b16 a[14:15], v5 offset:20032
s_waitcnt lgkmcnt(0)
s_add_u32 s37, s51, 737280
s_add_u32 m0, s50, 15360
s_nop 0
buffer_load_dwordx4 v2, s[20:23], s37 offen lds
s_add_u32 m0, s50, 16384
s_nop 0
buffer_load_dwordx4 v3, s[20:23], s37 offen lds
s_add_u32 m0, s50, 17408
s_nop 0
buffer_load_dwordx4 v4, s[20:23], s37 offen lds
s_waitcnt vmcnt(24)
ds_read_b64_tr_b16 a[16:17], v5 offset:21504
ds_read_b64_tr_b16 a[18:19], v5 offset:23040
ds_read_b64_tr_b16 a[20:21], v5 offset:21536
ds_read_b64_tr_b16 a[22:23], v5 offset:23072
ds_read_b64_tr_b16 a[24:25], v5 offset:21568
ds_read_b64_tr_b16 a[26:27], v5 offset:23104
s_waitcnt lgkmcnt(0)
s_add_u32 s37, s51, 774144
s_add_u32 m0, s50, 18432
s_nop 0
buffer_load_dwordx4 v2, s[20:23], s37 offen lds
s_add_u32 m0, s50, 19456
s_nop 0
buffer_load_dwordx4 v3, s[20:23], s37 offen lds
s_add_u32 m0, s50, 20480
s_nop 0
buffer_load_dwordx4 v4, s[20:23], s37 offen lds
s_waitcnt vmcnt(24)
ds_read_b64_tr_b16 a[28:29], v5 offset:24576
ds_read_b64_tr_b16 a[30:31], v5 offset:26112
ds_read_b64_tr_b16 a[32:33], v5 offset:24608
ds_read_b64_tr_b16 a[34:35], v5 offset:26144
ds_read_b64_tr_b16 a[36:37], v5 offset:24640
ds_read_b64_tr_b16 a[38:39], v5 offset:26176
s_waitcnt lgkmcnt(0)
s_add_u32 s37, s51, 811008
s_add_u32 m0, s50, 21504
s_nop 0
buffer_load_dwordx4 v2, s[20:23], s37 offen lds
s_add_u32 m0, s50, 22528
s_nop 0
buffer_load_dwordx4 v3, s[20:23], s37 offen lds
s_add_u32 m0, s50, 23552
s_nop 0
buffer_load_dwordx4 v4, s[20:23], s37 offen lds
s_waitcnt vmcnt(24)
ds_read_b64_tr_b16 a[40:41], v5 offset:27648
ds_read_b64_tr_b16 a[42:43], v5 offset:29184
ds_read_b64_tr_b16 a[44:45], v5 offset:27680
ds_read_b64_tr_b16 a[46:47], v5 offset:29216
ds_read_b64_tr_b16 a[48:49], v5 offset:27712
ds_read_b64_tr_b16 a[50:51], v5 offset:29248
s_waitcnt lgkmcnt(0)
s_add_u32 s37, s51, 847872
s_add_u32 m0, s50, 24576
s_nop 0
buffer_load_dwordx4 v2, s[20:23], s37 offen lds
s_add_u32 m0, s50, 25600
s_nop 0
buffer_load_dwordx4 v3, s[20:23], s37 offen lds
s_add_u32 m0, s50, 26624
s_nop 0
buffer_load_dwordx4 v4, s[20:23], s37 offen lds
s_waitcnt vmcnt(24)
ds_read_b64_tr_b16 a[52:53], v5 offset:0
ds_read_b64_tr_b16 a[54:55], v5 offset:1536
ds_read_b64_tr_b16 a[56:57], v5 offset:32
ds_read_b64_tr_b16 a[58:59], v5 offset:1568
ds_read_b64_tr_b16 a[60:61], v5 offset:64
ds_read_b64_tr_b16 a[62:63], v5 offset:1600
s_waitcnt lgkmcnt(0)
s_add_u32 s37, s51, 884736
s_add_u32 m0, s50, 27648
s_nop 0
buffer_load_dwordx4 v2, s[20:23], s37 offen lds
s_add_u32 m0, s50, 28672
s_nop 0
buffer_load_dwordx4 v3, s[20:23], s37 offen lds
s_add_u32 m0, s50, 29696
s_nop 0
buffer_load_dwordx4 v4, s[20:23], s37 offen lds
s_waitcnt vmcnt(24)
ds_read_b64_tr_b16 a[64:65], v5 offset:3072
ds_read_b64_tr_b16 a[66:67], v5 offset:4608
ds_read_b64_tr_b16 a[68:69], v5 offset:3104
ds_read_b64_tr_b16 a[70:71], v5 offset:4640
ds_read_b64_tr_b16 a[72:73], v5 offset:3136
ds_read_b64_tr_b16 a[74:75], v5 offset:4672
s_waitcnt lgkmcnt(0)
s_add_u32 s37, s51, 921600
s_add_u32 m0, s50, 0
s_nop 0
buffer_load_dwordx4 v2, s[20:23], s37 offen lds
s_add_u32 m0, s50, 1024
s_nop 0
buffer_load_dwordx4 v3, s[20:23], s37 offen lds
s_add_u32 m0, s50, 2048
s_nop 0
buffer_load_dwordx4 v4, s[20:23], s37 offen lds
s_waitcnt vmcnt(24)
ds_read_b64_tr_b16 a[76:77], v5 offset:6144
ds_read_b64_tr_b16 a[78:79], v5 offset:7680
ds_read_b64_tr_b16 a[80:81], v5 offset:6176
ds_read_b64_tr_b16 a[82:83], v5 offset:7712
ds_read_b64_tr_b16 a[84:85], v5 offset:6208
ds_read_b64_tr_b16 a[86:87], v5 offset:7744
s_waitcnt lgkmcnt(0)
s_add_u32 s37, s51, 958464
s_add_u32 m0, s50, 3072
s_nop 0
buffer_load_dwordx4 v2, s[20:23], s37 offen lds
s_add_u32 m0, s50, 4096
s_nop 0
buffer_load_dwordx4 v3, s[20:23], s37 offen lds
s_add_u32 m0, s50, 5120
s_nop 0
buffer_load_dwordx4 v4, s[20:23], s37 offen lds
s_waitcnt vmcnt(24)
ds_read_b64_tr_b16 a[88:89], v5 offset:9216
ds_read_b64_tr_b16 a[90:91], v5 offset:10752
ds_read_b64_tr_b16 a[92:93], v5 offset:9248
ds_read_b64_tr_b16 a[94:95], v5 offset:10784
ds_read_b64_tr_b16 a[96:97], v5 offset:9280
ds_read_b64_tr_b16 a[98:99], v5 offset:10816
s_waitcnt lgkmcnt(0)
s_add_u32 s37, s51, 995328
s_add_u32 m0, s50, 6144
s_nop 0
buffer_load_dwordx4 v2, s[20:23], s37 offen lds
s_add_u32 m0, s50, 7168
s_nop 0
buffer_load_dwordx4 v3, s[20:23], s37 offen lds
s_add_u32 m0, s50, 8192
s_nop 0
buffer_load_dwordx4 v4, s[20:23], s37 offen lds
s_waitcnt vmcnt(24)
ds_read_b64_tr_b16 a[100:101], v5 offset:12288
ds_read_b64_tr_b16 a[102:103], v5 offset:13824
ds_read_b64_tr_b16 a[104:105], v5 offset:12320
ds_read_b64_tr_b16 a[106:107], v5 offset:13856
ds_read_b64_tr_b16 a[108:109], v5 offset:12352
ds_read_b64_tr_b16 a[110:111], v5 offset:13888
s_waitcnt lgkmcnt(0)
s_add_u32 s37, s51, 1032192
s_add_u32 m0, s50, 9216
s_nop 0
buffer_load_dwordx4 v2, s[20:23], s37 offen lds
s_add_u32 m0, s50, 10240
s_nop 0
buffer_load_dwordx4 v3, s[20:23], s37 offen lds
s_add_u32 m0, s50, 11264
s_nop 0
buffer_load_dwordx4 v4, s[20:23], s37 offen lds
s_waitcnt vmcnt(24)
ds_read_b64_tr_b16 a[112:113], v5 offset:15360
ds_read_b64_tr_b16 a[114:115], v5 offset:16896
ds_read_b64_tr_b16 a[116:117], v5 offset:15392
ds_read_b64_tr_b16 a[118:119], v5 offset:16928
ds_read_b64_tr_b16 a[120:121], v5 offset:15424
ds_read_b64_tr_b16 a[122:123], v5 offset:16960
s_waitcnt lgkmcnt(0)
s_add_u32 s37, s51, 1069056
s_add_u32 m0, s50, 12288
s_nop 0
buffer_load_dwordx4 v2, s[20:23], s37 offen lds
s_add_u32 m0, s50, 13312
s_nop 0
buffer_load_dwordx4 v3, s[20:23], s37 offen lds
s_add_u32 m0, s50, 14336
s_nop 0
buffer_load_dwordx4 v4, s[20:23], s37 offen lds
s_waitcnt vmcnt(24)
ds_read_b64_tr_b16 a[124:125], v5 offset:18432
ds_read_b64_tr_b16 a[126:127], v5 offset:19968
ds_read_b64_tr_b16 a[128:129], v5 offset:18464
ds_read_b64_tr_b16 a[130:131], v5 offset:20000
ds_read_b64_tr_b16 a[132:133], v5 offset:18496
ds_read_b64_tr_b16 a[134:135], v5 offset:20032
s_waitcnt lgkmcnt(0)
s_add_u32 s37, s51, 1105920
s_add_u32 m0, s50, 15360
s_nop 0
buffer_load_dwordx4 v2, s[20:23], s37 offen lds
s_add_u32 m0, s50, 16384
s_nop 0
buffer_load_dwordx4 v3, s[20:23], s37 offen lds
s_add_u32 m0, s50, 17408
s_nop 0
buffer_load_dwordx4 v4, s[20:23], s37 offen lds
s_waitcnt vmcnt(24)
ds_read_b64_tr_b16 a[136:137], v5 offset:21504
ds_read_b64_tr_b16 a[138:139], v5 offset:23040
ds_read_b64_tr_b16 a[140:141], v5 offset:21536
ds_read_b64_tr_b16 a[142:143], v5 offset:23072
ds_read_b64_tr_b16 a[144:145], v5 offset:21568
ds_read_b64_tr_b16 a[146:147], v5 offset:23104
s_waitcnt lgkmcnt(0)
s_add_u32 s37, s51, 1142784
s_add_u32 m0, s50, 18432
s_nop 0
buffer_load_dwordx4 v2, s[20:23], s37 offen lds
s_add_u32 m0, s50, 19456
s_nop 0
buffer_load_dwordx4 v3, s[20:23], s37 offen lds
s_add_u32 m0, s50, 20480
s_nop 0
buffer_load_dwordx4 v4, s[20:23], s37 offen lds
s_waitcnt vmcnt(24)
ds_read_b64_tr_b16 a[148:149], v5 offset:24576
ds_read_b64_tr_b16 a[150:151], v5 offset:26112
ds_read_b64_tr_b16 a[152:153], v5 offset:24608
ds_read_b64_tr_b16 a[154:155], v5 offset:26144
ds_read_b64_tr_b16 a[156:157], v5 offset:24640
ds_read_b64_tr_b16 a[158:159], v5 offset:26176
s_waitcnt lgkmcnt(0)
s_waitcnt vmcnt(21)
ds_read_b64_tr_b16 a[160:161], v5 offset:27648
ds_read_b64_tr_b16 a[162:163], v5 offset:29184
ds_read_b64_tr_b16 a[164:165], v5 offset:27680
ds_read_b64_tr_b16 a[166:167], v5 offset:29216
ds_read_b64_tr_b16 a[168:169], v5 offset:27712
ds_read_b64_tr_b16 a[170:171], v5 offset:29248
s_waitcnt lgkmcnt(0)
s_waitcnt vmcnt(18)
ds_read_b64_tr_b16 a[172:173], v5 offset:0
ds_read_b64_tr_b16 a[174:175], v5 offset:1536
ds_read_b64_tr_b16 a[176:177], v5 offset:32
ds_read_b64_tr_b16 a[178:179], v5 offset:1568
ds_read_b64_tr_b16 a[180:181], v5 offset:64
ds_read_b64_tr_b16 a[182:183], v5 offset:1600
s_waitcnt lgkmcnt(0)
s_waitcnt vmcnt(15)
ds_read_b64_tr_b16 a[184:185], v5 offset:3072
ds_read_b64_tr_b16 a[186:187], v5 offset:4608
ds_read_b64_tr_b16 a[188:189], v5 offset:3104
ds_read_b64_tr_b16 a[190:191], v5 offset:4640
ds_read_b64_tr_b16 a[192:193], v5 offset:3136
ds_read_b64_tr_b16 a[194:195], v5 offset:4672
s_waitcnt lgkmcnt(0)
s_waitcnt vmcnt(12)
ds_read_b64_tr_b16 a[196:197], v5 offset:6144
ds_read_b64_tr_b16 a[198:199], v5 offset:7680
ds_read_b64_tr_b16 a[200:201], v5 offset:6176
ds_read_b64_tr_b16 a[202:203], v5 offset:7712
ds_read_b64_tr_b16 a[204:205], v5 offset:6208
ds_read_b64_tr_b16 a[206:207], v5 offset:7744
s_waitcnt lgkmcnt(0)
s_waitcnt vmcnt(9)
ds_read_b64_tr_b16 a[208:209], v5 offset:9216
ds_read_b64_tr_b16 a[210:211], v5 offset:10752
ds_read_b64_tr_b16 a[212:213], v5 offset:9248
ds_read_b64_tr_b16 a[214:215], v5 offset:10784
ds_read_b64_tr_b16 a[216:217], v5 offset:9280
ds_read_b64_tr_b16 a[218:219], v5 offset:10816
s_waitcnt lgkmcnt(0)
s_waitcnt vmcnt(6)
ds_read_b64_tr_b16 a[220:221], v5 offset:12288
ds_read_b64_tr_b16 a[222:223], v5 offset:13824
ds_read_b64_tr_b16 a[224:225], v5 offset:12320
ds_read_b64_tr_b16 a[226:227], v5 offset:13856
ds_read_b64_tr_b16 a[228:229], v5 offset:12352
ds_read_b64_tr_b16 a[230:231], v5 offset:13888
s_waitcnt lgkmcnt(0)
s_waitcnt vmcnt(3)
ds_read_b64_tr_b16 a[232:233], v5 offset:15360
ds_read_b64_tr_b16 a[234:235], v5 offset:16896
ds_read_b64_tr_b16 a[236:237], v5 offset:15392
ds_read_b64_tr_b16 a[238:239], v5 offset:16928
ds_read_b64_tr_b16 a[240:241], v5 offset:15424
ds_read_b64_tr_b16 a[242:243], v5 offset:16960
s_waitcnt lgkmcnt(0)
s_waitcnt vmcnt(0)
ds_read_b64_tr_b16 a[244:245], v5 offset:18432
ds_read_b64_tr_b16 a[246:247], v5 offset:19968
ds_read_b64_tr_b16 a[248:249], v5 offset:18464
ds_read_b64_tr_b16 a[250:251], v5 offset:20000
ds_read_b64_tr_b16 a[252:253], v5 offset:18496
ds_read_b64_tr_b16 a[254:255], v5 offset:20032
s_waitcnt lgkmcnt(0)
s_branch L_w_init_in
L_w_init:
s_sleep 4
L_w_init_in:
buffer_load_dword v12, v8, s[24:27], 0 offen offset:0 sc0 sc1
s_sub_u32 s36, s36, 1
s_cbranch_scc1 L_exit_w
s_waitcnt vmcnt(0)
v_readfirstlane_b32 s37, v12
s_nop 0
s_and_b32 s37, s37, 0xff
s_cmp_eq_u32 s37, 32
s_cbranch_scc0 L_w_init
s_branch L_w_adone_in
L_w_adone:
s_sleep 4
L_w_adone_in:
buffer_load_dword v12, v8, s[24:27], 0 offen offset:4 sc0 sc1
s_sub_u32 s36, s36, 1
s_cbranch_scc1 L_exit_w
s_waitcnt vmcnt(0)
v_readfirstlane_b32 s37, v12
s_nop 0
s_cmp_eq_u32 s37, 96
s_cbranch_scc0 L_w_adone
s_mov_b32 s35, 0
s_mul_i32 s52, s34, 5
s_mul_i32 s58, s34, 3072
v_add_u32 v2, s58, v14
s_lshl_b32 s37, s34, 10
v_add_u32 v14, s37, v14
L_w_loop:
s_add_u32 s37, s52, 0
s_min_u32 s37, s37, 17
s_lshl_b32 s37, s37, 10
s_add_u32 s37, s37, s54
buffer_load_dwordx4 v[40:43], v1, s[4:7], s37 offen sc1
s_add_u32 s37, s52, 1
s_min_u32 s37, s37, 17
s_lshl_b32 s37, s37, 10
s_add_u32 s37, s37, s54
buffer_load_dwordx4 v[44:47], v1, s[4:7], s37 offen sc1
s_add_u32 s37, s52, 2
s_min_u32 s37, s37, 17
s_lshl_b32 s37, s37, 10
s_add_u32 s37, s37, s54
buffer_load_dwordx4 v[48:51], v1, s[4:7], s37 offen sc1
s_add_u32 s37, s52, 3
s_min_u32 s37, s37, 17
s_lshl_b32 s37, s37, 10
s_add_u32 s37, s37, s54
buffer_load_dwordx4 v[52:55], v1, s[4:7], s37 offen sc1
s_add_u32 s37, s52, 4
s_min_u32 s37, s37, 17
s_lshl_b32 s37, s37, 10
s_add_u32 s37, s37, s54
buffer_load_dwordx4 v[56:59], v1, s[4:7], s37 offen sc1
buffer_load_dword v13, v10, s[4:7], s56 offen sc1
s_waitcnt vmcnt(5)
v_mfma_f32_16x16x32_bf16 v[28:31], v[68:71], v[40:43], 0
v_mfma_f32_16x16x32_bf16 v[32:35], v[72:75], v[40:43], 0
v_mfma_f32_16x16x32_bf16 v[36:39], v[76:79], v[40:43], 0
s_waitcnt vmcnt(4)
v_mfma_f32_16x16x32_bf16 v[28:31], v[80:83], v[44:47], v[28:31]
v_mfma_f32_16x16x32_bf16 v[32:35], v[84:87], v[44:47], v[32:35]
v_mfma_f32_16x16x32_bf16 v[36:39], v[88:91], v[44:47], v[36:39]
s_waitcnt vmcnt(3)
v_mfma_f32_16x16x32_bf16 v[28:31], v[92:95], v[48:51], v[28:31]
v_mfma_f32_16x16x32_bf16 v[32:35], v[96:99], v[48:51], v[32:35]
v_mfma_f32_16x16x32_bf16 v[36:39], v[100:103], v[48:51], v[36:39]
s_waitcnt vmcnt(2)
v_mfma_f32_16x16x32_bf16 v[28:31], v[104:107], v[52:55], v[28:31]
v_mfma_f32_16x16x32_bf16 v[32:35], v[108:111], v[52:55], v[32:35]
v_mfma_f32_16x16x32_bf16 v[36:39], v[112:115], v[52:55], v[36:39]
s_waitcnt vmcnt(1)
v_mfma_f32_16x16x32_bf16 v[28:31], v[116:119], v[56:59], v[28:31]
v_mfma_f32_16x16x32_bf16 v[32:35], v[120:123], v[56:59], v[32:35]
v_mfma_f32_16x16x32_bf16 v[36:39], v[124:127], v[56:59], v[36:39]
s_branch L_w_poll_in
L_w_poll:
s_sleep 2
L_w_poll_in:
buffer_load_dword v12, v9, s[4:7], s57 offen offset:0 sc0 sc1
s_sub_u32 s36, s36, 1
s_cbranch_scc1 L_exit_w
s_waitcnt vmcnt(0)
v_cmp_ge_u32 vcc, s35, v12
s_nop 1
s_cmp_eq_u64 vcc, 0
s_cbranch_scc0 L_w_poll
s_add_u32 s37, s53, 0
s_add_u32 m0, s50, 0
s_nop 0
buffer_load_dwordx4 v1, s[4:7], s37 offen offset:0 sc1 lds
buffer_load_dwordx4 v1, s[4:7], s37 offen offset:1024 sc1 lds
buffer_load_dwordx4 v1, s[4:7], s37 offen offset:2048 sc1 lds
buffer_load_dwordx4 v1, s[4:7], s37 offen offset:3072 sc1 lds
s_add_u32 s37, s53, 4096
s_add_u32 m0, s50, 4096
s_nop 0
buffer_load_dwordx4 v1, s[4:7], s37 offen offset:0 sc1 lds
buffer_load_dwordx4 v1, s[4:7], s37 offen offset:1024 sc1 lds
buffer_load_dwordx4 v1, s[4:7], s37 offen offset:2048 sc1 lds
buffer_load_dwordx4 v1, s[4:7], s37 offen offset:3072 sc1 lds
s_add_u32 s37, s53, 8192
s_add_u32 m0, s50, 8192
s_nop 0
buffer_load_dwordx4 v1, s[4:7], s37 offen offset:0 sc1 lds
buffer_load_dwordx4 v1, s[4:7], s37 offen offset:1024 sc1 lds
buffer_load_dwordx4 v1, s[4:7], s37 offen offset:2048 sc1 lds
buffer_load_dwordx4 v1, s[4:7], s37 offen offset:3072 sc1 lds
s_add_u32 s37, s53, 12288
s_add_u32 m0, s50, 12288
s_nop 0
buffer_load_dwordx4 v1, s[4:7], s37 offen offset:0 sc1 lds
buffer_load_dwordx4 v1, s[4:7], s37 offen offset:1024 sc1 lds
buffer_load_dwordx4 v1, s[4:7], s37 offen offset:2048 sc1 lds
buffer_load_dwordx4 v1, s[4:7], s37 offen offset:3072 sc1 lds
s_add_u32 s37, s53, 16384
s_add_u32 m0, s50, 16384
s_nop 0
buffer_load_dwordx4 v1, s[4:7], s37 offen offset:0 sc1 lds
buffer_load_dwordx4 v1, s[4:7], s37 offen offset:1024 sc1 lds
buffer_load_dwordx4 v1, s[4:7], s37 offen offset:2048 sc1 lds
buffer_load_dwordx4 v1, s[4:7], s37 offen offset:3072 sc1 lds
s_add_u32 s37, s53, 20480
s_add_u32 m0, s50, 20480
s_nop 0
buffer_load_dwordx4 v1, s[4:7], s37 offen offset:0 sc1 lds
buffer_load_dwordx4 v1, s[4:7], s37 offen offset:1024 sc1 lds
buffer_load_dwordx4 v1, s[4:7], s37 offen offset:2048 sc1 lds
buffer_load_dwordx4 v1, s[4:7], s37 offen offset:3072 sc1 lds
s_add_u32 s37, s53, 24576
s_add_u32 m0, s50, 24576
s_nop 0
buffer_load_dwordx4 v1, s[4:7], s37 offen offset:0 sc1 lds
buffer_load_dwordx4 v1, s[4:7], s37 offen offset:1024 sc1 lds
buffer_load_dwordx4 v1, s[4:7], s37 offen offset:2048 sc1 lds
buffer_load_dwordx4 v1, s[4:7], s37 offen offset:3072 sc1 lds
s_add_u32 s37, s53, 28672
s_add_u32 m0, s50, 28672
s_nop 0
buffer_load_dwordx4 v1, s[4:7], s37 offen offset:0 sc1 lds
buffer_load_dwordx4 v1, s[4:7], s37 offen offset:1024 sc1 lds
buffer_load_dwordx4 v1, s[4:7], s37 offen offset:2048 sc1 lds
buffer_load_dwordx4 v1, s[4:7], s37 offen offset:3072 sc1 lds
s_waitcnt vmcnt(31)
ds_read_b128 v[40:43], v7 offset:0
s_waitcnt vmcnt(30)
ds_read_b128 v[44:47], v7 offset:1024
s_waitcnt vmcnt(29)
ds_read_b128 v[48:51], v7 offset:2048
s_waitcnt lgkmcnt(2)
v_mfma_f32_16x16x32_bf16 v[16:19], v[128:131], v[40:43], 0
v_mfma_f32_16x16x32_bf16 v[20:23], v[132:135], v[40:43], 0
v_mfma_f32_16x16x32_bf16 v[24:27], v[136:139], v[40:43], 0
s_waitcnt vmcnt(28)
ds_read_b128 v[52:55], v7 offset:3072
s_waitcnt lgkmcnt(2)
v_mfma_f32_16x16x32_bf16 v[16:19], v[140:143], v[44:47], v[16:19]
v_mfma_f32_16x16x32_bf16 v[20:23], v[144:147], v[44:47], v[20:23]
v_mfma_f32_16x16x32_bf16 v[24:27], v[148:151], v[44:47], v[24:27]
s_waitcnt vmcnt(27)
ds_read_b128 v[40:43], v7 offset:4096
s_waitcnt lgkmcnt(2)
v_mfma_f32_16x16x32_bf16 v[16:19], v[152:155], v[48:51], v[16:19]
v_mfma_f32_16x16x32_bf16 v[20:23], v[156:159], v[48:51], v[20:23]
v_mfma_f32_16x16x32_bf16 v[24:27], v[160:163], v[48:51], v[24:27]
s_waitcnt vmcnt(26)
ds_read_b128 v[44:47], v7 offset:5120
s_waitcnt lgkmcnt(2)
v_mfma_f32_16x16x32_bf16 v[16:19], v[164:167], v[52:55], v[16:19]
v_mfma_f32_16x16x32_bf16 v[20:23], v[168:171], v[52:55], v[20:23]
v_mfma_f32_16x16x32_bf16 v[24:27], v[172:175], v[52:55], v[24:27]
s_waitcnt vmcnt(25)
ds_read_b128 v[48:51], v7 offset:6144
s_waitcnt lgkmcnt(2)
v_mfma_f32_16x16x32_bf16 v[16:19], v[176:179], v[40:43], v[16:19]
v_mfma_f32_16x16x32_bf16 v[20:23], v[180:183], v[40:43], v[20:23]
v_mfma_f32_16x16x32_bf16 v[24:27], v[184:187], v[40:43], v[24:27]
s_waitcnt vmcnt(24)
ds_read_b128 v[52:55], v7 offset:7168
s_waitcnt lgkmcnt(2)
v_mfma_f32_16x16x32_bf16 v[16:19], v[188:191], v[44:47], v[16:19]
v_mfma_f32_16x16x32_bf16 v[20:23], v[192:195], v[44:47], v[20:23]
v_mfma_f32_16x16x32_bf16 v[24:27], v[196:199], v[44:47], v[24:27]
s_waitcnt vmcnt(23)
ds_read_b128 v[40:43], v7 offset:8192
s_waitcnt lgkmcnt(2)
v_mfma_f32_16x16x32_bf16 v[16:19], v[200:203], v[48:51], v[16:19]
v_mfma_f32_16x16x32_bf16 v[20:23], v[204:207], v[48:51], v[20:23]
v_mfma_f32_16x16x32_bf16 v[24:27], v[208:211], v[48:51], v[24:27]
s_waitcnt vmcnt(22)
ds_read_b128 v[44:47], v7 offset:9216
s_waitcnt lgkmcnt(2)
v_mfma_f32_16x16x32_bf16 v[16:19], v[212:215], v[52:55], v[16:19]
v_mfma_f32_16x16x32_bf16 v[20:23], v[216:219], v[52:55], v[20:23]
v_mfma_f32_16x16x32_bf16 v[24:27], v[220:223], v[52:55], v[24:27]
s_waitcnt vmcnt(21)
ds_read_b128 v[48:51], v7 offset:10240
s_waitcnt lgkmcnt(2)
v_mfma_f32_16x16x32_bf16 v[16:19], v[224:227], v[40:43], v[16:19]
v_mfma_f32_16x16x32_bf16 v[20:23], v[228:231], v[40:43], v[20:23]
v_mfma_f32_16x16x32_bf16 v[24:27], v[232:235], v[40:43], v[24:27]
s_waitcnt vmcnt(20)
ds_read_b128 v[52:55], v7 offset:11264
s_waitcnt lgkmcnt(2)
v_mfma_f32_16x16x32_bf16 v[16:19], v[236:239], v[44:47], v[16:19]
v_mfma_f32_16x16x32_bf16 v[20:23], v[240:243], v[44:47], v[20:23]
v_mfma_f32_16x16x32_bf16 v[24:27], v[244:247], v[44:47], v[24:27]
s_waitcnt vmcnt(19)
ds_read_b128 v[40:43], v7 offset:12288
s_waitcnt lgkmcnt(2)
v_mfma_f32_16x16x32_bf16 v[16:19], v[248:251], v[48:51], v[16:19]
v_mfma_f32_16x16x32_bf16 v[20:23], v[252:255], v[48:51], v[20:23]
v_mfma_f32_16x16x32_bf16 v[24:27], a[0:3], v[48:51], v[24:27]
s_waitcnt vmcnt(18)
ds_read_b128 v[44:47], v7 offset:13312
s_waitcnt lgkmcnt(2)
v_mfma_f32_16x16x32_bf16 v[16:19], a[4:7], v[52:55], v[16:19]
v_mfma_f32_16x16x32_bf16 v[20:23], a[8:11], v[52:55], v[20:23]
v_mfma_f32_16x16x32_bf16 v[24:27], a[12:15], v[52:55], v[24:27]
s_waitcnt vmcnt(17)
ds_read_b128 v[48:51], v7 offset:14336
s_waitcnt lgkmcnt(2)
v_mfma_f32_16x16x32_bf16 v[16:19], a[16:19], v[40:43], v[16:19]
v_mfma_f32_16x16x32_bf16 v[20:23], a[20:23], v[40:43], v[20:23]
v_mfma_f32_16x16x32_bf16 v[24:27], a[24:27], v[40:43], v[24:27]
s_waitcnt vmcnt(16)
ds_read_b128 v[52:55], v7 offset:15360
s_waitcnt lgkmcnt(2)
v_mfma_f32_16x16x32_bf16 v[16:19], a[28:31], v[44:47], v[16:19]
v_mfma_f32_16x16x32_bf16 v[20:23], a[32:35], v[44:47], v[20:23]
v_mfma_f32_16x16x32_bf16 v[24:27], a[36:39], v[44:47], v[24:27]
s_waitcnt vmcnt(15)
ds_read_b128 v[40:43], v7 offset:16384
s_waitcnt lgkmcnt(2)
v_mfma_f32_16x16x32_bf16 v[16:19], a[40:43], v[48:51], v[16:19]
v_mfma_f32_16x16x32_bf16 v[20:23], a[44:47], v[48:51], v[20:23]
v_mfma_f32_16x16x32_bf16 v[24:27], a[48:51], v[48:51], v[24:27]
s_waitcnt vmcnt(14)
ds_read_b128 v[44:47], v7 offset:17408
s_waitcnt lgkmcnt(2)
v_mfma_f32_16x16x32_bf16 v[16:19], a[52:55], v[52:55], v[16:19]
v_mfma_f32_16x16x32_bf16 v[20:23], a[56:59], v[52:55], v[20:23]
v_mfma_f32_16x16x32_bf16 v[24:27], a[60:63], v[52:55], v[24:27]
s_waitcnt vmcnt(13)
ds_read_b128 v[48:51], v7 offset:18432
s_waitcnt lgkmcnt(2)
v_mfma_f32_16x16x32_bf16 v[16:19], a[64:67], v[40:43], v[16:19]
v_mfma_f32_16x16x32_bf16 v[20:23], a[68:71], v[40:43], v[20:23]
v_mfma_f32_16x16x32_bf16 v[24:27], a[72:75], v[40:43], v[24:27]
s_waitcnt vmcnt(12)
ds_read_b128 v[52:55], v7 offset:19456
s_waitcnt lgkmcnt(2)
v_mfma_f32_16x16x32_bf16 v[16:19], a[76:79], v[44:47], v[16:19]
v_mfma_f32_16x16x32_bf16 v[20:23], a[80:83], v[44:47], v[20:23]
v_mfma_f32_16x16x32_bf16 v[24:27], a[84:87], v[44:47], v[24:27]
s_waitcnt vmcnt(11)
ds_read_b128 v[40:43], v7 offset:20480
s_waitcnt lgkmcnt(2)
v_mfma_f32_16x16x32_bf16 v[16:19], a[88:91], v[48:51], v[16:19]
v_mfma_f32_16x16x32_bf16 v[20:23], a[92:95], v[48:51], v[20:23]
v_mfma_f32_16x16x32_bf16 v[24:27], a[96:99], v[48:51], v[24:27]
s_waitcnt vmcnt(10)
ds_read_b128 v[44:47], v7 offset:21504
s_waitcnt lgkmcnt(2)
v_mfma_f32_16x16x32_bf16 v[16:19], a[100:103], v[52:55], v[16:19]
v_mfma_f32_16x16x32_bf16 v[20:23], a[104:107], v[52:55], v[20:23]
v_mfma_f32_16x16x32_bf16 v[24:27], a[108:111], v[52:55], v[24:27]
s_waitcnt vmcnt(9)
ds_read_b128 v[48:51], v7 offset:22528
s_waitcnt lgkmcnt(2)
v_mfma_f32_16x16x32_bf16 v[16:19], a[112:115], v[40:43], v[16:19]
v_mfma_f32_16x16x32_bf16 v[20:23], a[116:119], v[40:43], v[20:23]
v_mfma_f32_16x16x32_bf16 v[24:27], a[120:123], v[40:43], v[24:27]
s_waitcnt vmcnt(8)
ds_read_b128 v[52:55], v7 offset:23552
s_waitcnt lgkmcnt(2)
v_mfma_f32_16x16x32_bf16 v[16:19], a[124:127], v[44:47], v[16:19]
v_mfma_f32_16x16x32_bf16 v[20:23], a[128:131], v[44:47], v[20:23]
v_mfma_f32_16x16x32_bf16 v[24:27], a[132:135], v[44:47], v[24:27]
s_waitcnt vmcnt(7)
ds_read_b128 v[40:43], v7 offset:24576
s_waitcnt lgkmcnt(2)
v_mfma_f32_16x16x32_bf16 v[16:19], a[136:139], v[48:51], v[16:19]
v_mfma_f32_16x16x32_bf16 v[20:23], a[140:143], v[48:51], v[20:23]
v_mfma_f32_16x16x32_bf16 v[24:27], a[144:147], v[48:51], v[24:27]
s_waitcnt vmcnt(6)
ds_read_b128 v[44:47], v7 offset:25600
s_waitcnt lgkmcnt(2)
v_mfma_f32_16x16x32_bf16 v[16:19], a[148:151], v[52:55], v[16:19]
v_mfma_f32_16x16x32_bf16 v[20:23], a[152:155], v[52:55], v[20:23]
v_mfma_f32_16x16x32_bf16 v[24:27], a[156:159], v[52:55], v[24:27]
s_waitcnt vmcnt(5)
ds_read_b128 v[48:51], v7 offset:26624
s_waitcnt lgkmcnt(2)
v_mfma_f32_16x16x32_bf16 v[16:19], a[160:163], v[40:43], v[16:19]
v_mfma_f32_16x16x32_bf16 v[20:23], a[164:167], v[40:43], v[20:23]
v_mfma_f32_16x16x32_bf16 v[24:27], a[168:171], v[40:43], v[24:27]
s_waitcnt vmcnt(4)
ds_read_b128 v[52:55], v7 offset:27648
s_waitcnt lgkmcnt(2)
v_mfma_f32_16x16x32_bf16 v[16:19], a[172:175], v[44:47], v[16:19]
v_mfma_f32_16x16x32_bf16 v[20:23], a[176:179], v[44:47], v[20:23]
v_mfma_f32_16x16x32_bf16 v[24:27], a[180:183], v[44:47], v[24:27]
s_waitcnt vmcnt(3)
ds_read_b128 v[40:43], v7 offset:28672
s_waitcnt lgkmcnt(2)
v_mfma_f32_16x16x32_bf16 v[16:19], a[184:187], v[48:51], v[16:19]
v_mfma_f32_16x16x32_bf16 v[20:23], a[188:191], v[48:51], v[20:23]
v_mfma_f32_16x16x32_bf16 v[24:27], a[192:195], v[48:51], v[24:27]
s_waitcnt vmcnt(2)
ds_read_b128 v[44:47], v7 offset:29696
s_waitcnt lgkmcnt(2)
v_mfma_f32_16x16x32_bf16 v[16:19], a[196:199], v[52:55], v[16:19]
v_mfma_f32_16x16x32_bf16 v[20:23], a[200:203], v[52:55], v[20:23]
v_mfma_f32_16x16x32_bf16 v[24:27], a[204:207], v[52:55], v[24:27]
s_waitcnt vmcnt(1)
ds_read_b128 v[48:51], v7 offset:30720
s_waitcnt lgkmcnt(2)
v_mfma_f32_16x16x32_bf16 v[16:19], a[208:211], v[40:43], v[16:19]
v_mfma_f32_16x16x32_bf16 v[20:23], a[212:215], v[40:43], v[20:23]
v_mfma_f32_16x16x32_bf16 v[24:27], a[216:219], v[40:43], v[24:27]
s_waitcnt vmcnt(0)
ds_read_b128 v[52:55], v7 offset:31744
s_waitcnt lgkmcnt(2)
v_mfma_f32_16x16x32_bf16 v[16:19], a[220:223], v[44:47], v[16:19]
v_mfma_f32_16x16x32_bf16 v[20:23], a[224:227], v[44:47], v[20:23]
v_mfma_f32_16x16x32_bf16 v[24:27], a[228:231], v[44:47], v[24:27]
s_waitcnt lgkmcnt(1)
v_mfma_f32_16x16x32_bf16 v[16:19], a[232:235], v[48:51], v[16:19]
v_mfma_f32_16x16x32_bf16 v[20:23], a[236:239], v[48:51], v[20:23]
v_mfma_f32_16x16x32_bf16 v[24:27], a[240:243], v[48:51], v[24:27]
s_waitcnt lgkmcnt(0)
v_mfma_f32_16x16x32_bf16 v[16:19], a[244:247], v[52:55], v[16:19]
v_mfma_f32_16x16x32_bf16 v[20:23], a[248:251], v[52:55], v[20:23]
v_mfma_f32_16x16x32_bf16 v[24:27], a[252:255], v[52:55], v[24:27]
v_fma_f32 v16, v16, v13, v28
v_fma_f32 v17, v17, v13, v29
v_fma_f32 v18, v18, v13, v30
v_fma_f32 v19, v19, v13, v31
ds_write_b128 v2, v[16:19] offset:0
v_fma_f32 v20, v20, v13, v32
v_fma_f32 v21, v21, v13, v33
v_fma_f32 v22, v22, v13, v34
v_fma_f32 v23, v23, v13, v35
ds_write_b128 v2, v[20:23] offset:1024
v_fma_f32 v24, v24, v13, v36
v_fma_f32 v25, v25, v13, v37
v_fma_f32 v26, v26, v13, v38
v_fma_f32 v27, v27, v13, v39
ds_write_b128 v2, v[24:27] offset:2048
s_waitcnt lgkmcnt(0)
s_barrier
s_cmp_eq_u32 s34, 3
s_cbranch_scc1 L_w_next
ds_read_b128 v[40:43], v14 offset:0
ds_read_b128 v[44:47], v14 offset:3072
ds_read_b128 v[48:51], v14 offset:6144
ds_read_b128 v[52:55], v14 offset:9216
s_waitcnt lgkmcnt(0)
v_pk_add_f32 v[40:41], v[40:41], v[44:45]
v_pk_add_f32 v[42:43], v[42:43], v[46:47]
v_pk_add_f32 v[48:49], v[48:49], v[52:53]
v_pk_add_f32 v[50:51], v[50:51], v[54:55]
v_pk_add_f32 v[40:41], v[40:41], v[48:49]
v_pk_add_f32 v[42:43], v[42:43], v[50:51]
v_cvt_pk_bf16_f32 v60, v40, v41
v_cvt_pk_bf16_f32 v61, v42, v43
buffer_store_dwordx2 v[60:61], v15, s[28:31], s55 offen
L_w_next:
v_xor_b32 v2, 16384, v2
v_xor_b32 v14, 16384, v14
s_add_u32 s55, s55, 147456
s_add_u32 s54, s54, 147456
s_add_u32 s53, s53, 1048576
s_add_u32 s56, s56, 512
s_add_u32 s35, s35, 1
s_cmp_lt_u32 s35, 16
s_cbranch_scc1 L_w_loop
s_waitcnt vmcnt(0)
s_endpgm
L_role_chain:
s_load_dwordx2 s[24:25], s[0:1], 32
s_load_dwordx2 s[8:9], s[0:1], 40
s_load_dwordx2 s[12:13], s[0:1], 48
s_load_dwordx2 s[16:17], s[0:1], 56
s_load_dwordx2 s[20:21], s[0:1], 64
s_load_dwordx2 s[28:29], s[0:1], 96
s_load_dwordx2 s[4:5], s[0:1], 104
s_mov_b32 s26, 9216
s_mov_b32 s27, 0x20000
s_mov_b32 s10, 4718592
s_mov_b32 s11, 0x20000
s_mov_b32 s14, 4718592
s_mov_b32 s15, 0x20000
s_mov_b32 s18, 4718592
s_mov_b32 s19, 0x20000
s_mov_b32 s22, 4718592
s_mov_b32 s23, 0x20000
s_mov_b32 s30, 256
s_mov_b32 s31, 0x20000
s_mov_b32 s6, 268435456
s_mov_b32 s7, 0x20000
v_lshrrev_b32 v1, 6, v0
s_nop 0
v_readfirstlane_b32 s33, v1
s_nop 0
s_cmp_eq_u32 s33, 0
s_cbranch_scc1 L_pro_w0
s_cmp_eq_u32 s33, 2
s_cbranch_scc1 L_pro_w2r
s_cmp_eq_u32 s33, 3
s_cbranch_scc1 L_pro_w3r
s_cmp_lt_u32 s32, 8
s_cbranch_scc1 L_pro_w1r
s_branch L_pro_w1
L_exit:
s_endpgm
L_pro_w0:
v_and_b32 v20, 63, v0
v_and_b32 v21, 15, v0
v_bfe_u32 v22, v0, 4, 2
v_lshlrev_b32 v1, 4, v20
v_add_u32 v2, 16384, v1
v_bfe_u32 v23, v20, 4, 1
v_lshlrev_b32 v26, 4, v23
v_bfe_u32 v23, v20, 2, 2
v_lshl_add_u32 v26, v23, 1, v26
v_bfe_u32 v23, v20, 5, 1
v_add_u32 v26, v26, v23
v_lshlrev_b32 v26, 13, v26
v_and_b32 v23, 3, v20
v_lshl_add_u32 v26, v23, 4, v26
v_lshrrev_b32 v24, 2, v20
v_mul_u32_u24 v27, 1152, v24
v_lshl_add_u32 v27, v23, 4, v27
v_lshrrev_b32 v24, 2, v21
v_lshl_add_u32 v25, v22, 3, v24
v_lshlrev_b32 v28, 6, v25
v_lshl_add_u32 v28, v23, 3, v28
v_add_u32 v28, 16384, v28
v_and_b32 v25, 1, v22
v_lshlrev_b32 v29, 10, v25
v_lshrrev_b32 v25, 1, v22
v_lshl_add_u32 v29, v25, 8, v29
v_and_b32 v25, 1, v24
v_lshl_add_u32 v29, v25, 6, v29
v_lshrrev_b32 v25, 1, v24
v_lshl_add_u32 v29, v25, 5, v29
v_lshl_add_u32 v29, v23, 3, v29
v_add_u32 v29, 16384, v29
s_lshl_b32 s54, s32, 8
s_add_u32 s54, s54, 0
s_mul_i32 s55, s32, 147456
s_waitcnt lgkmcnt(0)
s_add_u32 s56, s54, 524288
s_mov_b32 m0, 28672
s_nop 0
buffer_load_dwordx4 v26, s[8:11], s56 offen lds
s_add_u32 s56, s54, 589824
s_mov_b32 m0, 29696
s_nop 0
buffer_load_dwordx4 v26, s[8:11], s56 offen lds
s_add_u32 s56, s54, 786432
s_mov_b32 m0, 30720
s_nop 0
buffer_load_dwordx4 v26, s[8:11], s56 offen lds
s_add_u32 s56, s54, 851968
s_mov_b32 m0, 31744
s_nop 0
buffer_load_dwordx4 v26, s[8:11], s56 offen lds
s_add_u32 s56, s54, 1572864
s_mov_b32 m0, 32768
s_nop 0
buffer_load_dwordx4 v26, s[8:11], s56 offen lds
s_add_u32 s56, s54, 1638400
s_mov_b32 m0, 33792
s_nop 0
buffer_load_dwordx4 v26, s[8:11], s56 offen lds
s_add_u32 s56, s54, 1835008
s_mov_b32 m0, 34816
s_nop 0
buffer_load_dwordx4 v26, s[8:11], s56 offen lds
s_add_u32 s56, s54, 1900544
s_mov_b32 m0, 35840
s_nop 0
buffer_load_dwordx4 v26, s[8:11], s56 offen lds
s_add_u32 s56, s54, 2621440
s_mov_b32 m0, 36864
s_nop 0
buffer_load_dwordx4 v26, s[8:11], s56 offen lds
s_add_u32 s56, s54, 2686976
s_mov_b32 m0, 37888
s_nop 0
buffer_load_dwordx4 v26, s[8:11], s56 offen lds
s_add_u32 s56, s54, 2883584
s_mov_b32 m0, 38912
s_nop 0
buffer_load_dwordx4 v26, s[8:11], s56 offen lds
s_add_u32 s56, s54, 2949120
s_mov_b32 m0, 39936
s_nop 0
buffer_load_dwordx4 v26, s[8:11], s56 offen lds
s_add_u32 s56, s54, 3145728
s_mov_b32 m0, 40960
s_nop 0
buffer_load_dwordx4 v26, s[8:11], s56 offen lds
s_add_u32 s56, s54, 3211264
s_mov_b32 m0, 41984
s_nop 0
buffer_load_dwordx4 v26, s[8:11], s56 offen lds
s_add_u32 s56, s54, 3407872
s_mov_b32 m0, 43008
s_nop 0
buffer_load_dwordx4 v26, s[8:11], s56 offen lds
s_add_u32 s56, s54, 3473408
s_mov_b32 m0, 44032
s_nop 0
buffer_load_dwordx4 v26, s[8:11], s56 offen lds
s_add_u32 s56, s54, 3670016
s_mov_b32 m0, 45056
s_nop 0
buffer_load_dwordx4 v26, s[8:11], s56 offen lds
s_add_u32 s56, s54, 3735552
s_mov_b32 m0, 46080
s_nop 0
buffer_load_dwordx4 v26, s[8:11], s56 offen lds
s_add_u32 s56, s54, 3932160
s_mov_b32 m0, 47104
s_nop 0
buffer_load_dwordx4 v26, s[8:11], s56 offen lds
s_add_u32 s56, s54, 3997696
s_mov_b32 m0, 48128
s_nop 0
buffer_load_dwordx4 v26, s[8:11], s56 offen lds
s_add_u32 s56, s54, 4194304
s_mov_b32 m0, 49152
s_nop 0
buffer_load_dwordx4 v26, s[8:11], s56 offen lds
s_add_u32 s56, s54, 4259840
s_mov_b32 m0, 50176
s_nop 0
buffer_load_dwordx4 v26, s[8:11], s56 offen lds
s_add_u32 s56, s54, 4456448
s_mov_b32 m0, 51200
s_nop 0
buffer_load_dwordx4 v26, s[8:11], s56 offen lds
s_add_u32 s56, s54, 4521984
s_mov_b32 m0, 52224
s_nop 0
buffer_load_dwordx4 v26, s[8:11], s56 offen lds
s_add_u32 s56, s54, 0
s_mov_b32 m0, 53248
s_nop 0
buffer_load_dwordx4 v26, s[12:15], s56 offen lds
s_add_u32 s56, s54, 65536
s_mov_b32 m0, 54272
s_nop 0
buffer_load_dwordx4 v26, s[12:15], s56 offen lds
s_add_u32 s56, s54, 262144
s_mov_b32 m0, 55296
s_nop 0
buffer_load_dwordx4 v26, s[12:15], s56 offen lds
s_add_u32 s56, s54, 327680
s_mov_b32 m0, 56320
s_nop 0
buffer_load_dwordx4 v26, s[12:15], s56 offen lds
s_add_u32 s56, s54, 524288
s_mov_b32 m0, 16384
s_nop 0
buffer_load_dwordx4 v26, s[12:15], s56 offen lds
s_add_u32 s56, s54, 589824
s_mov_b32 m0, 17408
s_nop 0
buffer_load_dwordx4 v26, s[12:15], s56 offen lds
s_add_u32 s56, s54, 786432
s_mov_b32 m0, 18432
s_nop 0
buffer_load_dwordx4 v26, s[12:15], s56 offen lds
s_add_u32 s56, s54, 851968
s_mov_b32 m0, 19456
s_nop 0
buffer_load_dwordx4 v26, s[12:15], s56 offen lds
s_add_u32 s56, s54, 1048576
s_mov_b32 m0, 20480
s_nop 0
buffer_load_dwordx4 v26, s[12:15], s56 offen lds
s_add_u32 s56, s54, 1114112
s_mov_b32 m0, 21504
s_nop 0
buffer_load_dwordx4 v26, s[12:15], s56 offen lds
s_add_u32 s56, s54, 1310720
s_mov_b32 m0, 22528
s_nop 0
buffer_load_dwordx4 v26, s[12:15], s56 offen lds
s_add_u32 s56, s54, 1376256
s_mov_b32 m0, 23552
s_nop 0
buffer_load_dwordx4 v26, s[12:15], s56 offen lds
v_bfe_u32 v23, v21, 1, 1
v_and_b32 v24, 1, v21
v_lshl_add_u32 v23, v24, 16, v23
v_mul_u32_u24 v23, 0xaaaa, v23
v_add_u32 v0, 0x44444444, v23
v_lshlrev_b32 v3, 3, v20
v_lshrrev_b32 v25, 5, v20
v_lshlrev_b32 v25, 6, v25
v_xor_b32 v3, v3, v25
v_lshrrev_b32 v25, 2, v20
v_and_b32 v4, 3, v21
v_lshl_add_u32 v4, v4, 4, v25
v_lshlrev_b32 v4, 3, v4
v_bfe_u32 v25, v21, 1, 1
v_lshlrev_b32 v23, 6, v25
v_xor_b32 v4, v4, v23
v_and_b32 v23, 2, v22
v_xor_b32 v5, v21, v23
v_lshlrev_b32 v5, 4, v5
v_lshl_add_u32 v5, v25, 10, v5
v_and_b32 v23, 1, v22
v_lshl_add_u32 v5, v23, 3, v5
v_lshlrev_b32 v9, 8, v22
v_lshl_add_u32 v9, v25, 6, v9
v_bfe_u32 v23, v21, 3, 1
v_lshl_add_u32 v9, v23, 7, v9
v_bfe_u32 v23, v21, 2, 1
v_lshl_add_u32 v9, v23, 5, v9
v_and_b32 v23, 1, v21
v_lshl_add_u32 v9, v23, 4, v9
v_lshrrev_b32 v23, 1, v22
v_and_b32 v24, 1, v22
v_and_b32 v25, 7, v21
v_lshrrev_b32 v7, 3, v21
v_lshl_add_u32 v8, v7, 1, v23
v_lshlrev_b32 v8, 12, v8
v_lshl_add_u32 v8, v24, 7, v8
v_lshl_add_u32 v8, v25, 3, v8
s_lshr_b32 s56, s32, 1
s_lshl_b32 s56, s56, 8
s_and_b32 s57, s32, 1
s_lshl_b32 s57, s57, 6
s_add_u32 s56, s56, s57
s_add_u32 s56, s56, 0
v_add_u32 v8, s56, v8
v_and_b32 v7, 12, v21
v_bfe_u32 v25, v21, 1, 1
v_add_u32 v7, v7, v25
v_lshlrev_b32 v7, 4, v7
v_lshl_add_u32 v7, v22, 8, v7
s_mov_b32 s42, 0
s_mov_b32 s43, 65536
s_mov_b32 s44, 131072
s_mov_b32 s45, 196608
s_mov_b32 s46, 262144
s_mov_b32 s47, 294912
s_mov_b32 s48, 299008
s_mov_b32 s49, 303104
s_mov_b32 s38, 295936
s_mov_b32 s50, 0x3e0293ee
s_mov_b32 s51, 0x3e0293ee
s_mov_b32 s52, 0x3f803f80
s_mov_b32 s53, 0x3f803f80
v_and_b32 v11, 3, v21
v_cmp_eq_u32 vcc, 0, v11
s_nop 1
v_cndmask_b32 v11, 0, 1, vcc
s_mov_b32 s34, 0
s_mov_b32 s35, -1
s_mov_b32 s36, 0
s_mov_b32 s41, 400000
s_lshl_b32 s37, s32, 14
s_add_u32 s39, s37, 17301504
s_add_u32 s37, s37, 16777216
s_lshl_b32 s40, s32, 12
s_add_u32 s40, s40, 8388608
v_mov_b64 v[36:37], 0
v_mov_b64 v[38:39], 0
v_lshlrev_b32 v23, 2, v20
s_lshl_b32 s56, s32, 8
s_add_u32 s56, s56, 327680
buffer_store_dword v36, v23, s[4:7], s56 offen sc0 sc1
s_cmp_ge_u32 s32, 9
s_cbranch_scc1 L_nomem0
v_lshrrev_b32 v23, 2, v21
v_and_b32 v24, 1, v21
v_lshl_add_u32 v23, v23, 1, v24
v_mul_u32_u24 v23, 1152, v23
v_lshrrev_b32 v24, 1, v22
v_lshl_add_u32 v23, v24, 6, v23
v_and_b32 v24, 1, v22
v_lshl_add_u32 v23, v24, 4, v23
v_bfe_u32 v24, v21, 1, 1
v_lshl_add_u32 v23, v24, 3, v23
s_lshl_b32 s56, s32, 7
buffer_load_dwordx2 v[60:61], v23, s[24:27], s56 offen
buffer_load_dwordx2 v[62:63], v23, s[24:27], s56 offen offset:32
s_mov_b32 s56, 0x05040100
s_mov_b32 s57, 0x07060302
s_waitcnt vmcnt(0)
v_perm_b32 v64, v61, v60, s56
v_perm_b32 v65, v63, v62, s56
v_perm_b32 v66, v61, v60, s57
v_perm_b32 v67, v63, v62, s57
v_or_b32 v64, 1, v64
s_lshl_b32 s56, s32, 10
s_add_u32 s56, s56, 294912
buffer_store_dwordx4 v[64:67], v1, s[4:7], s56 offen sc0 sc1
L_nomem0:
s_waitcnt vmcnt(0) lgkmcnt(0)
s_barrier
s_getreg_b32 s56, hwreg(HW_REG_XCC_ID)
s_and_b32 s56, s56, 15
s_mul_i32 s57, s56, s56
s_lshl_b32 s57, s57, 18
s_lshl_b32 s56, s56, 8
s_add_u32 s57, s57, s56
s_add_u32 s58, s57, 1
v_mov_b32 v23, s58
v_mov_b32 v24, 0
s_mov_b64 exec, 1
buffer_atomic_add v23, v24, s[28:31], 0 offen sc1
s_mov_b64 exec, -1
ds_read_b64_tr_b16 v[80:81], v28 offset:12288
ds_read_b64_tr_b16 v[82:83], v28 offset:12544
ds_read_b64_tr_b16 v[84:85], v28 offset:14336
ds_read_b64_tr_b16 v[86:87], v28 offset:14592
ds_read_b64_tr_b16 v[88:89], v28 offset:12320
ds_read_b64_tr_b16 v[90:91], v28 offset:12576
ds_read_b64_tr_b16 v[92:93], v28 offset:14368
ds_read_b64_tr_b16 v[94:95], v28 offset:14624
s_waitcnt lgkmcnt(0)
s_add_u32 s56, s54, 1572864
s_mov_b32 m0, 24576
s_nop 0
buffer_load_dwordx4 v26, s[12:15], s56 offen lds
s_add_u32 s56, s54, 1638400
s_mov_b32 m0, 25600
s_nop 0
buffer_load_dwordx4 v26, s[12:15], s56 offen lds
s_add_u32 s56, s54, 1835008
s_mov_b32 m0, 26624
s_nop 0
buffer_load_dwordx4 v26, s[12:15], s56 offen lds
s_add_u32 s56, s54, 1900544
s_mov_b32 m0, 27648
s_nop 0
buffer_load_dwordx4 v26, s[12:15], s56 offen lds
ds_read_b64_tr_b16 v[96:97], v28 offset:16384
ds_read_b64_tr_b16 v[98:99], v28 offset:16640
ds_read_b64_tr_b16 v[100:101], v28 offset:18432
ds_read_b64_tr_b16 v[102:103], v28 offset:18688
ds_read_b64_tr_b16 v[104:105], v28 offset:16416
ds_read_b64_tr_b16 v[106:107], v28 offset:16672
ds_read_b64_tr_b16 v[108:109], v28 offset:18464
ds_read_b64_tr_b16 v[110:111], v28 offset:18720
s_waitcnt lgkmcnt(0)
s_add_u32 s56, s54, 2097152
s_mov_b32 m0, 28672
s_nop 0
buffer_load_dwordx4 v26, s[12:15], s56 offen lds
s_add_u32 s56, s54, 2162688
s_mov_b32 m0, 29696
s_nop 0
buffer_load_dwordx4 v26, s[12:15], s56 offen lds
s_add_u32 s56, s54, 2359296
s_mov_b32 m0, 30720
s_nop 0
buffer_load_dwordx4 v26, s[12:15], s56 offen lds
s_add_u32 s56, s54, 2424832
s_mov_b32 m0, 31744
s_nop 0
buffer_load_dwordx4 v26, s[12:15], s56 offen lds
ds_read_b64_tr_b16 v[112:113], v28 offset:20480
ds_read_b64_tr_b16 v[114:115], v28 offset:20736
ds_read_b64_tr_b16 v[116:117], v28 offset:22528
ds_read_b64_tr_b16 v[118:119], v28 offset:22784
ds_read_b64_tr_b16 v[120:121], v28 offset:20512
ds_read_b64_tr_b16 v[122:123], v28 offset:20768
ds_read_b64_tr_b16 v[124:125], v28 offset:22560
ds_read_b64_tr_b16 v[126:127], v28 offset:22816
s_waitcnt lgkmcnt(0)
s_add_u32 s56, s54, 3145728
s_mov_b32 m0, 32768
s_nop 0
buffer_load_dwordx4 v26, s[12:15], s56 offen lds
s_add_u32 s56, s54, 3211264
s_mov_b32 m0, 33792
s_nop 0
buffer_load_dwordx4 v26, s[12:15], s56 offen lds
s_add_u32 s56, s54, 3407872
s_mov_b32 m0, 34816
s_nop 0
buffer_load_dwordx4 v26, s[12:15], s56 offen lds
s_add_u32 s56, s54, 3473408
s_mov_b32 m0, 35840
s_nop 0
buffer_load_dwordx4 v26, s[12:15], s56 offen lds
ds_read_b64_tr_b16 v[128:129], v28 offset:24576
ds_read_b64_tr_b16 v[130:131], v28 offset:24832
ds_read_b64_tr_b16 v[132:133], v28 offset:26624
ds_read_b64_tr_b16 v[134:135], v28 offset:26880
ds_read_b64_tr_b16 v[136:137], v28 offset:24608
ds_read_b64_tr_b16 v[138:139], v28 offset:24864
ds_read_b64_tr_b16 v[140:141], v28 offset:26656
ds_read_b64_tr_b16 v[142:143], v28 offset:26912
s_waitcnt lgkmcnt(0)
s_add_u32 s56, s54, 3670016
s_mov_b32 m0, 36864
s_nop 0
buffer_load_dwordx4 v26, s[12:15], s56 offen lds
s_add_u32 s56, s54, 3735552
s_mov_b32 m0, 37888
s_nop 0
buffer_load_dwordx4 v26, s[12:15], s56 offen lds
s_add_u32 s56, s54, 3932160
s_mov_b32 m0, 38912
s_nop 0
buffer_load_dwordx4 v26, s[12:15], s56 offen lds
s_add_u32 s56, s54, 3997696
s_mov_b32 m0, 39936
s_nop 0
buffer_load_dwordx4 v26, s[12:15], s56 offen lds
ds_read_b64_tr_b16 v[144:145], v28 offset:28672
ds_read_b64_tr_b16 v[146:147], v28 offset:28928
ds_read_b64_tr_b16 v[148:149], v28 offset:30720
ds_read_b64_tr_b16 v[150:151], v28 offset:30976
ds_read_b64_tr_b16 v[152:153], v28 offset:28704
ds_read_b64_tr_b16 v[154:155], v28 offset:28960
ds_read_b64_tr_b16 v[156:157], v28 offset:30752
ds_read_b64_tr_b16 v[158:159], v28 offset:31008
s_waitcnt lgkmcnt(0)
s_add_u32 s56, s54, 4194304
s_mov_b32 m0, 40960
s_nop 0
buffer_load_dwordx4 v26, s[12:15], s56 offen lds
s_add_u32 s56, s54, 4259840
s_mov_b32 m0, 41984
s_nop 0
buffer_load_dwordx4 v26, s[12:15], s56 offen lds
s_add_u32 s56, s54, 4456448
s_mov_b32 m0, 43008
s_nop 0
buffer_load_dwordx4 v26, s[12:15], s56 offen lds
s_add_u32 s56, s54, 4521984
s_mov_b32 m0, 44032
s_nop 0
buffer_load_dwordx4 v26, s[12:15], s56 offen lds
ds_read_b64_tr_b16 v[160:161], v28 offset:32768
ds_read_b64_tr_b16 v[162:163], v28 offset:33024
ds_read_b64_tr_b16 v[164:165], v28 offset:34816
ds_read_b64_tr_b16 v[166:167], v28 offset:35072
ds_read_b64_tr_b16 v[168:169], v28 offset:32800
ds_read_b64_tr_b16 v[170:171], v28 offset:33056
ds_read_b64_tr_b16 v[172:173], v28 offset:34848
ds_read_b64_tr_b16 v[174:175], v28 offset:35104
s_waitcnt lgkmcnt(0)
s_add_u32 s56, s54, 0
s_mov_b32 m0, 45056
s_nop 0
buffer_load_dwordx4 v26, s[16:19], s56 offen lds
s_add_u32 s56, s54, 65536
s_mov_b32 m0, 46080
s_nop 0
buffer_load_dwordx4 v26, s[16:19], s56 offen lds
s_add_u32 s56, s54, 262144
s_mov_b32 m0, 47104
s_nop 0
buffer_load_dwordx4 v26, s[16:19], s56 offen lds
s_add_u32 s56, s54, 327680
s_mov_b32 m0, 48128
s_nop 0
buffer_load_dwordx4 v26, s[16:19], s56 offen lds
ds_read_b64_tr_b16 v[176:177], v28 offset:36864
ds_read_b64_tr_b16 v[178:179], v28 offset:37120
ds_read_b64_tr_b16 v[180:181], v28 offset:38912
ds_read_b64_tr_b16 v[182:183], v28 offset:39168
ds_read_b64_tr_b16 v[184:185], v28 offset:36896
ds_read_b64_tr_b16 v[186:187], v28 offset:37152
ds_read_b64_tr_b16 v[188:189], v28 offset:38944
ds_read_b64_tr_b16 v[190:191], v28 offset:39200
s_waitcnt lgkmcnt(0)
s_add_u32 s56, s54, 524288
s_mov_b32 m0, 49152
s_nop 0
buffer_load_dwordx4 v26, s[16:19], s56 offen lds
s_add_u32 s56, s54, 589824
s_mov_b32 m0, 50176
s_nop 0
buffer_load_dwordx4 v26, s[16:19], s56 offen lds
s_add_u32 s56, s54, 786432
s_mov_b32 m0, 51200
s_nop 0
buffer_load_dwordx4 v26, s[16:19], s56 offen lds
s_add_u32 s56, s54, 851968
s_mov_b32 m0, 52224
s_nop 0
buffer_load_dwordx4 v26, s[16:19], s56 offen lds
ds_read_b64_tr_b16 v[192:193], v28 offset:0
ds_read_b64_tr_b16 v[194:195], v28 offset:256
ds_read_b64_tr_b16 v[196:197], v28 offset:2048
ds_read_b64_tr_b16 v[198:199], v28 offset:2304
ds_read_b64_tr_b16 v[200:201], v28 offset:32
ds_read_b64_tr_b16 v[202:203], v28 offset:288
ds_read_b64_tr_b16 v[204:205], v28 offset:2080
ds_read_b64_tr_b16 v[206:207], v28 offset:2336
s_waitcnt lgkmcnt(0)
s_add_u32 s56, s54, 1048576
s_mov_b32 m0, 53248
s_nop 0
buffer_load_dwordx4 v26, s[16:19], s56 offen lds
s_add_u32 s56, s54, 1114112
s_mov_b32 m0, 54272
s_nop 0
buffer_load_dwordx4 v26, s[16:19], s56 offen lds
s_add_u32 s56, s54, 1310720
s_mov_b32 m0, 55296
s_nop 0
buffer_load_dwordx4 v26, s[16:19], s56 offen lds
s_add_u32 s56, s54, 1376256
s_mov_b32 m0, 56320
s_nop 0
buffer_load_dwordx4 v26, s[16:19], s56 offen lds
ds_read_b64_tr_b16 v[208:209], v28 offset:4096
ds_read_b64_tr_b16 v[210:211], v28 offset:4352
ds_read_b64_tr_b16 v[212:213], v28 offset:6144
ds_read_b64_tr_b16 v[214:215], v28 offset:6400
ds_read_b64_tr_b16 v[216:217], v28 offset:4128
ds_read_b64_tr_b16 v[218:219], v28 offset:4384
ds_read_b64_tr_b16 v[220:221], v28 offset:6176
ds_read_b64_tr_b16 v[222:223], v28 offset:6432
s_waitcnt lgkmcnt(0)
s_add_u32 s56, s54, 1572864
s_mov_b32 m0, 16384
s_nop 0
buffer_load_dwordx4 v26, s[16:19], s56 offen lds
s_add_u32 s56, s54, 1638400
s_mov_b32 m0, 17408
s_nop 0
buffer_load_dwordx4 v26, s[16:19], s56 offen lds
s_add_u32 s56, s54, 1835008
s_mov_b32 m0, 18432
s_nop 0
buffer_load_dwordx4 v26, s[16:19], s56 offen lds
s_add_u32 s56, s54, 1900544
s_mov_b32 m0, 19456
s_nop 0
buffer_load_dwordx4 v26, s[16:19], s56 offen lds
s_waitcnt vmcnt(32)
ds_read_b64_tr_b16 v[224:225], v28 offset:8192
ds_read_b64_tr_b16 v[226:227], v28 offset:8448
ds_read_b64_tr_b16 v[228:229], v28 offset:10240
ds_read_b64_tr_b16 v[230:231], v28 offset:10496
ds_read_b64_tr_b16 v[232:233], v28 offset:8224
ds_read_b64_tr_b16 v[234:235], v28 offset:8480
ds_read_b64_tr_b16 v[236:237], v28 offset:10272
ds_read_b64_tr_b16 v[238:239], v28 offset:10528
s_waitcnt lgkmcnt(0)
s_add_u32 s56, s54, 2097152
s_mov_b32 m0, 20480
s_nop 0
buffer_load_dwordx4 v26, s[16:19], s56 offen lds
s_add_u32 s56, s54, 2162688
s_mov_b32 m0, 21504
s_nop 0
buffer_load_dwordx4 v26, s[16:19], s56 offen lds
s_add_u32 s56, s54, 2359296
s_mov_b32 m0, 22528
s_nop 0
buffer_load_dwordx4 v26, s[16:19], s56 offen lds
s_add_u32 s56, s54, 2424832
s_mov_b32 m0, 23552
s_nop 0
buffer_load_dwordx4 v26, s[16:19], s56 offen lds
s_waitcnt vmcnt(32)
ds_read_b64_tr_b16 v[240:241], v28 offset:12288
ds_read_b64_tr_b16 v[242:243], v28 offset:12544
ds_read_b64_tr_b16 v[244:245], v28 offset:14336
ds_read_b64_tr_b16 v[246:247], v28 offset:14592
ds_read_b64_tr_b16 v[248:249], v28 offset:12320
ds_read_b64_tr_b16 v[250:251], v28 offset:12576
ds_read_b64_tr_b16 v[252:253], v28 offset:14368
ds_read_b64_tr_b16 v[254:255], v28 offset:14624
s_waitcnt lgkmcnt(0)
s_add_u32 s56, s54, 2621440
s_mov_b32 m0, 24576
s_nop 0
buffer_load_dwordx4 v26, s[16:19], s56 offen lds
s_add_u32 s56, s54, 2686976
s_mov_b32 m0, 25600
s_nop 0
buffer_load_dwordx4 v26, s[16:19], s56 offen lds
s_add_u32 s56, s54, 2883584
s_mov_b32 m0, 26624
s_nop 0
buffer_load_dwordx4 v26, s[16:19], s56 offen lds
s_add_u32 s56, s54, 2949120
s_mov_b32 m0, 27648
s_nop 0
buffer_load_dwordx4 v26, s[16:19], s56 offen lds
s_waitcnt vmcnt(32)
ds_read_b64_tr_b16 a[0:1], v28 offset:16384
ds_read_b64_tr_b16 a[2:3], v28 offset:16640
ds_read_b64_tr_b16 a[4:5], v28 offset:18432
ds_read_b64_tr_b16 a[6:7], v28 offset:18688
ds_read_b64_tr_b16 a[8:9], v28 offset:16416
ds_read_b64_tr_b16 a[10:11], v28 offset:16672
ds_read_b64_tr_b16 a[12:13], v28 offset:18464
ds_read_b64_tr_b16 a[14:15], v28 offset:18720
s_waitcnt lgkmcnt(0)
s_add_u32 s56, s54, 3145728
s_mov_b32 m0, 28672
s_nop 0
buffer_load_dwordx4 v26, s[16:19], s56 offen lds
s_add_u32 s56, s54, 3211264
s_mov_b32 m0, 29696
s_nop 0
buffer_load_dwordx4 v26, s[16:19], s56 offen lds
s_add_u32 s56, s54, 3407872
s_mov_b32 m0, 30720
s_nop 0
buffer_load_dwordx4 v26, s[16:19], s56 offen lds
s_add_u32 s56, s54, 3473408
s_mov_b32 m0, 31744
s_nop 0
buffer_load_dwordx4 v26, s[16:19], s56 offen lds
s_waitcnt vmcnt(32)
ds_read_b64_tr_b16 a[16:17], v28 offset:20480
ds_read_b64_tr_b16 a[18:19], v28 offset:20736
ds_read_b64_tr_b16 a[20:21], v28 offset:22528
ds_read_b64_tr_b16 a[22:23], v28 offset:22784
ds_read_b64_tr_b16 a[24:25], v28 offset:20512
ds_read_b64_tr_b16 a[26:27], v28 offset:20768
ds_read_b64_tr_b16 a[28:29], v28 offset:22560
ds_read_b64_tr_b16 a[30:31], v28 offset:22816
s_waitcnt lgkmcnt(0)
s_add_u32 s56, s54, 4194304
s_mov_b32 m0, 32768
s_nop 0
buffer_load_dwordx4 v26, s[16:19], s56 offen lds
s_add_u32 s56, s54, 4259840
s_mov_b32 m0, 33792
s_nop 0
buffer_load_dwordx4 v26, s[16:19], s56 offen lds
s_add_u32 s56, s54, 4456448
s_mov_b32 m0, 34816
s_nop 0
buffer_load_dwordx4 v26, s[16:19], s56 offen lds
s_add_u32 s56, s54, 4521984
s_mov_b32 m0, 35840
s_nop 0
buffer_load_dwordx4 v26, s[16:19], s56 offen lds
s_waitcnt vmcnt(32)
ds_read_b64_tr_b16 a[32:33], v28 offset:24576
ds_read_b64_tr_b16 a[34:35], v28 offset:24832
ds_read_b64_tr_b16 a[36:37], v28 offset:26624
ds_read_b64_tr_b16 a[38:39], v28 offset:26880
ds_read_b64_tr_b16 a[40:41], v28 offset:24608
ds_read_b64_tr_b16 a[42:43], v28 offset:24864
ds_read_b64_tr_b16 a[44:45], v28 offset:26656
ds_read_b64_tr_b16 a[46:47], v28 offset:26912
s_waitcnt lgkmcnt(0)
s_add_u32 s56, s55, 36864
s_mov_b32 m0, 36864
s_nop 0
buffer_load_dwordx4 v27, s[20:23], s56 offen lds
s_add_u32 s56, s55, 55296
s_mov_b32 m0, 37888
s_nop 0
buffer_load_dwordx4 v27, s[20:23], s56 offen lds
s_add_u32 s56, s55, 110592
s_mov_b32 m0, 38912
s_nop 0
buffer_load_dwordx4 v27, s[20:23], s56 offen lds
s_add_u32 s56, s55, 129024
s_mov_b32 m0, 39936
s_nop 0
buffer_load_dwordx4 v27, s[20:23], s56 offen lds
s_waitcnt vmcnt(32)
ds_read_b64_tr_b16 a[48:49], v28 offset:28672
ds_read_b64_tr_b16 a[50:51], v28 offset:28928
ds_read_b64_tr_b16 a[52:53], v28 offset:30720
ds_read_b64_tr_b16 a[54:55], v28 offset:30976
ds_read_b64_tr_b16 a[56:57], v28 offset:28704
ds_read_b64_tr_b16 a[58:59], v28 offset:28960
ds_read_b64_tr_b16 a[60:61], v28 offset:30752
ds_read_b64_tr_b16 a[62:63], v28 offset:31008
s_waitcnt lgkmcnt(0)
s_add_u32 s56, s55, 37120
s_mov_b32 m0, 40960
s_nop 0
buffer_load_dwordx4 v27, s[20:23], s56 offen lds
s_add_u32 s56, s55, 55552
s_mov_b32 m0, 41984
s_nop 0
buffer_load_dwordx4 v27, s[20:23], s56 offen lds
s_add_u32 s56, s55, 110848
s_mov_b32 m0, 43008
s_nop 0
buffer_load_dwordx4 v27, s[20:23], s56 offen lds
s_add_u32 s56, s55, 129280
s_mov_b32 m0, 44032
s_nop 0
buffer_load_dwordx4 v27, s[20:23], s56 offen lds
s_waitcnt vmcnt(32)
ds_read_b64_tr_b16 a[64:65], v28 offset:32768
ds_read_b64_tr_b16 a[66:67], v28 offset:33024
ds_read_b64_tr_b16 a[68:69], v28 offset:34816
ds_read_b64_tr_b16 a[70:71], v28 offset:35072
ds_read_b64_tr_b16 a[72:73], v28 offset:32800
ds_read_b64_tr_b16 a[74:75], v28 offset:33056
ds_read_b64_tr_b16 a[76:77], v28 offset:34848
ds_read_b64_tr_b16 a[78:79], v28 offset:35104
s_waitcnt lgkmcnt(0)
s_add_u32 s56, s55, 37376
s_mov_b32 m0, 45056
s_nop 0
buffer_load_dwordx4 v27, s[20:23], s56 offen lds
s_add_u32 s56, s55, 55808
s_mov_b32 m0, 46080
s_nop 0
buffer_load_dwordx4 v27, s[20:23], s56 offen lds
s_add_u32 s56, s55, 111104
s_mov_b32 m0, 47104
s_nop 0
buffer_load_dwordx4 v27, s[20:23], s56 offen lds
s_add_u32 s56, s55, 129536
s_mov_b32 m0, 48128
s_nop 0
buffer_load_dwordx4 v27, s[20:23], s56 offen lds
s_waitcnt vmcnt(32)
ds_read_b64_tr_b16 a[80:81], v28 offset:36864
ds_read_b64_tr_b16 a[82:83], v28 offset:37120
ds_read_b64_tr_b16 a[84:85], v28 offset:38912
ds_read_b64_tr_b16 a[86:87], v28 offset:39168
ds_read_b64_tr_b16 a[88:89], v28 offset:36896
ds_read_b64_tr_b16 a[90:91], v28 offset:37152
ds_read_b64_tr_b16 a[92:93], v28 offset:38944
ds_read_b64_tr_b16 a[94:95], v28 offset:39200
s_waitcnt lgkmcnt(0)
s_add_u32 s56, s55, 37632
s_mov_b32 m0, 49152
s_nop 0
buffer_load_dwordx4 v27, s[20:23], s56 offen lds
s_add_u32 s56, s55, 56064
s_mov_b32 m0, 50176
s_nop 0
buffer_load_dwordx4 v27, s[20:23], s56 offen lds
s_add_u32 s56, s55, 111360
s_mov_b32 m0, 51200
s_nop 0
buffer_load_dwordx4 v27, s[20:23], s56 offen lds
s_add_u32 s56, s55, 129792
s_mov_b32 m0, 52224
s_nop 0
buffer_load_dwordx4 v27, s[20:23], s56 offen lds
s_waitcnt vmcnt(32)
ds_read_b64_tr_b16 a[96:97], v28 offset:0
ds_read_b64_tr_b16 a[98:99], v28 offset:256
ds_read_b64_tr_b16 a[100:101], v28 offset:2048
ds_read_b64_tr_b16 a[102:103], v28 offset:2304
ds_read_b64_tr_b16 a[104:105], v28 offset:32
ds_read_b64_tr_b16 a[106:107], v28 offset:288
ds_read_b64_tr_b16 a[108:109], v28 offset:2080
ds_read_b64_tr_b16 a[110:111], v28 offset:2336
s_waitcnt lgkmcnt(0)
s_add_u32 s56, s55, 37888
s_mov_b32 m0, 53248
s_nop 0
buffer_load_dwordx4 v27, s[20:23], s56 offen lds
s_add_u32 s56, s55, 56320
s_mov_b32 m0, 54272
s_nop 0
buffer_load_dwordx4 v27, s[20:23], s56 offen lds
s_add_u32 s56, s55, 111616
s_mov_b32 m0, 55296
s_nop 0
buffer_load_dwordx4 v27, s[20:23], s56 offen lds
s_add_u32 s56, s55, 130048
s_mov_b32 m0, 56320
s_nop 0
buffer_load_dwordx4 v27, s[20:23], s56 offen lds
s_waitcnt vmcnt(32)
ds_read_b64_tr_b16 a[112:113], v28 offset:4096
ds_read_b64_tr_b16 a[114:115], v28 offset:4352
ds_read_b64_tr_b16 a[116:117], v28 offset:6144
ds_read_b64_tr_b16 a[118:119], v28 offset:6400
ds_read_b64_tr_b16 a[120:121], v28 offset:4128
ds_read_b64_tr_b16 a[122:123], v28 offset:4384
ds_read_b64_tr_b16 a[124:125], v28 offset:6176
ds_read_b64_tr_b16 a[126:127], v28 offset:6432
s_waitcnt lgkmcnt(0)
s_add_u32 s56, s54, 0
s_mov_b32 m0, 16384
s_nop 0
buffer_load_dwordx4 v26, s[8:11], s56 offen lds
s_add_u32 s56, s54, 65536
s_mov_b32 m0, 17408
s_nop 0
buffer_load_dwordx4 v26, s[8:11], s56 offen lds
s_add_u32 s56, s54, 262144
s_mov_b32 m0, 18432
s_nop 0
buffer_load_dwordx4 v26, s[8:11], s56 offen lds
s_add_u32 s56, s54, 327680
s_mov_b32 m0, 19456
s_nop 0
buffer_load_dwordx4 v26, s[8:11], s56 offen lds
s_waitcnt vmcnt(32)
ds_read_b64_tr_b16 a[128:129], v28 offset:8192
ds_read_b64_tr_b16 a[130:131], v28 offset:8448
ds_read_b64_tr_b16 a[132:133], v28 offset:10240
ds_read_b64_tr_b16 a[134:135], v28 offset:10496
ds_read_b64_tr_b16 a[136:137], v28 offset:8224
ds_read_b64_tr_b16 a[138:139], v28 offset:8480
ds_read_b64_tr_b16 a[140:141], v28 offset:10272
ds_read_b64_tr_b16 a[142:143], v28 offset:10528
s_waitcnt lgkmcnt(0)
s_add_u32 s56, s54, 1048576
s_mov_b32 m0, 20480
s_nop 0
buffer_load_dwordx4 v26, s[8:11], s56 offen lds
s_add_u32 s56, s54, 1114112
s_mov_b32 m0, 21504
s_nop 0
buffer_load_dwordx4 v26, s[8:11], s56 offen lds
s_add_u32 s56, s54, 1310720
s_mov_b32 m0, 22528
s_nop 0
buffer_load_dwordx4 v26, s[8:11], s56 offen lds
s_add_u32 s56, s54, 1376256
s_mov_b32 m0, 23552
s_nop 0
buffer_load_dwordx4 v26, s[8:11], s56 offen lds
s_waitcnt vmcnt(32)
ds_read_b64_tr_b16 a[144:145], v28 offset:12288
ds_read_b64_tr_b16 a[146:147], v28 offset:12544
ds_read_b64_tr_b16 a[148:149], v28 offset:14336
ds_read_b64_tr_b16 a[150:151], v28 offset:14592
ds_read_b64_tr_b16 a[152:153], v28 offset:12320
ds_read_b64_tr_b16 a[154:155], v28 offset:12576
ds_read_b64_tr_b16 a[156:157], v28 offset:14368
ds_read_b64_tr_b16 a[158:159], v28 offset:14624
s_waitcnt lgkmcnt(0)
s_add_u32 s56, s54, 2097152
s_mov_b32 m0, 24576
s_nop 0
buffer_load_dwordx4 v26, s[8:11], s56 offen lds
s_add_u32 s56, s54, 2162688
s_mov_b32 m0, 25600
s_nop 0
buffer_load_dwordx4 v26, s[8:11], s56 offen lds
s_add_u32 s56, s54, 2359296
s_mov_b32 m0, 26624
s_nop 0
buffer_load_dwordx4 v26, s[8:11], s56 offen lds
s_add_u32 s56, s54, 2424832
s_mov_b32 m0, 27648
s_nop 0
buffer_load_dwordx4 v26, s[8:11], s56 offen lds
s_waitcnt vmcnt(32)
ds_read_b64_tr_b16 a[160:161], v28 offset:16384
ds_read_b64_tr_b16 a[162:163], v28 offset:16640
ds_read_b64_tr_b16 a[164:165], v28 offset:18432
ds_read_b64_tr_b16 a[166:167], v28 offset:18688
ds_read_b64_tr_b16 a[168:169], v28 offset:16416
ds_read_b64_tr_b16 a[170:171], v28 offset:16672
ds_read_b64_tr_b16 a[172:173], v28 offset:18464
ds_read_b64_tr_b16 a[174:175], v28 offset:18720
s_waitcnt lgkmcnt(0)
s_add_u32 s56, s54, 2621440
s_mov_b32 m0, 28672
s_nop 0
buffer_load_dwordx4 v26, s[12:15], s56 offen lds
s_add_u32 s56, s54, 2686976
s_mov_b32 m0, 29696
s_nop 0
buffer_load_dwordx4 v26, s[12:15], s56 offen lds
s_add_u32 s56, s54, 2883584
s_mov_b32 m0, 30720
s_nop 0
buffer_load_dwordx4 v26, s[12:15], s56 offen lds
s_add_u32 s56, s54, 2949120
s_mov_b32 m0, 31744
s_nop 0
buffer_load_dwordx4 v26, s[12:15], s56 offen lds
s_waitcnt vmcnt(32)
ds_read_b64_tr_b16 a[176:177], v29 offset:20480
ds_read_b64_tr_b16 a[178:179], v29 offset:20608
ds_read_b64_tr_b16 a[180:181], v29 offset:20992
ds_read_b64_tr_b16 a[182:183], v29 offset:21120
ds_read_b64_tr_b16 a[184:185], v29 offset:22528
ds_read_b64_tr_b16 a[186:187], v29 offset:22656
ds_read_b64_tr_b16 a[188:189], v29 offset:23040
ds_read_b64_tr_b16 a[190:191], v29 offset:23168
s_waitcnt lgkmcnt(0)
s_add_u32 s56, s54, 3670016
s_mov_b32 m0, 32768
s_nop 0
buffer_load_dwordx4 v26, s[16:19], s56 offen lds
s_add_u32 s56, s54, 3735552
s_mov_b32 m0, 33792
s_nop 0
buffer_load_dwordx4 v26, s[16:19], s56 offen lds
s_add_u32 s56, s54, 3932160
s_mov_b32 m0, 34816
s_nop 0
buffer_load_dwordx4 v26, s[16:19], s56 offen lds
s_add_u32 s56, s54, 3997696
s_mov_b32 m0, 35840
s_nop 0
buffer_load_dwordx4 v26, s[16:19], s56 offen lds
s_waitcnt vmcnt(32)
ds_read_b64_tr_b16 a[192:193], v29 offset:24576
ds_read_b64_tr_b16 a[194:195], v29 offset:24704
ds_read_b64_tr_b16 a[196:197], v29 offset:25088
ds_read_b64_tr_b16 a[198:199], v29 offset:25216
ds_read_b64_tr_b16 a[200:201], v29 offset:26624
ds_read_b64_tr_b16 a[202:203], v29 offset:26752
ds_read_b64_tr_b16 a[204:205], v29 offset:27136
ds_read_b64_tr_b16 a[206:207], v29 offset:27264
s_waitcnt lgkmcnt(0)
s_add_u32 s56, s55, 0
s_mov_b32 m0, 36864
s_nop 0
buffer_load_dwordx4 v27, s[20:23], s56 offen lds
s_add_u32 s56, s55, 18432
s_mov_b32 m0, 37888
s_nop 0
buffer_load_dwordx4 v27, s[20:23], s56 offen lds
s_add_u32 s56, s55, 256
s_mov_b32 m0, 38912
s_nop 0
buffer_load_dwordx4 v27, s[20:23], s56 offen lds
s_add_u32 s56, s55, 18688
s_mov_b32 m0, 39936
s_nop 0
buffer_load_dwordx4 v27, s[20:23], s56 offen lds
s_waitcnt vmcnt(32)
ds_read_b64_tr_b16 a[208:209], v29 offset:28672
ds_read_b64_tr_b16 a[210:211], v29 offset:28800
ds_read_b64_tr_b16 a[212:213], v29 offset:29184
ds_read_b64_tr_b16 a[214:215], v29 offset:29312
ds_read_b64_tr_b16 a[216:217], v29 offset:30720
ds_read_b64_tr_b16 a[218:219], v29 offset:30848
ds_read_b64_tr_b16 a[220:221], v29 offset:31232
ds_read_b64_tr_b16 a[222:223], v29 offset:31360
s_waitcnt lgkmcnt(0)
s_add_u32 s56, s55, 73728
s_mov_b32 m0, 40960
s_nop 0
buffer_load_dwordx4 v27, s[20:23], s56 offen lds
s_add_u32 s56, s55, 92160
s_mov_b32 m0, 41984
s_nop 0
buffer_load_dwordx4 v27, s[20:23], s56 offen lds
s_add_u32 s56, s55, 73984
s_mov_b32 m0, 43008
s_nop 0
buffer_load_dwordx4 v27, s[20:23], s56 offen lds
s_add_u32 s56, s55, 92416
s_mov_b32 m0, 44032
s_nop 0
buffer_load_dwordx4 v27, s[20:23], s56 offen lds
s_waitcnt vmcnt(32)
ds_read_b64_tr_b16 a[224:225], v29 offset:32768
ds_read_b64_tr_b16 a[226:227], v29 offset:32896
ds_read_b64_tr_b16 a[228:229], v29 offset:33280
ds_read_b64_tr_b16 a[230:231], v29 offset:33408
ds_read_b64_tr_b16 a[232:233], v29 offset:34816
ds_read_b64_tr_b16 a[234:235], v29 offset:34944
ds_read_b64_tr_b16 a[236:237], v29 offset:35328
ds_read_b64_tr_b16 a[238:239], v29 offset:35456
s_waitcnt lgkmcnt(0)
s_add_u32 s56, s55, 512
s_mov_b32 m0, 45056
s_nop 0
buffer_load_dwordx4 v27, s[20:23], s56 offen lds
s_add_u32 s56, s55, 18944
s_mov_b32 m0, 46080
s_nop 0
buffer_load_dwordx4 v27, s[20:23], s56 offen lds
s_add_u32 s56, s55, 74240
s_mov_b32 m0, 47104
s_nop 0
buffer_load_dwordx4 v27, s[20:23], s56 offen lds
s_add_u32 s56, s55, 92672
s_mov_b32 m0, 48128
s_nop 0
buffer_load_dwordx4 v27, s[20:23], s56 offen lds
s_waitcnt vmcnt(32)
ds_read_b64_tr_b16 a[240:241], v29 offset:36864
ds_read_b64_tr_b16 a[242:243], v29 offset:36992
ds_read_b64_tr_b16 a[244:245], v29 offset:37376
ds_read_b64_tr_b16 a[246:247], v29 offset:37504
ds_read_b64_tr_b16 a[248:249], v29 offset:38912
ds_read_b64_tr_b16 a[250:251], v29 offset:39040
ds_read_b64_tr_b16 a[252:253], v29 offset:39424
ds_read_b64_tr_b16 a[254:255], v29 offset:39552
s_waitcnt lgkmcnt(0)
s_add_u32 s56, s55, 768
s_mov_b32 m0, 49152
s_nop 0
buffer_load_dwordx4 v27, s[20:23], s56 offen lds
s_add_u32 s56, s55, 19200
s_mov_b32 m0, 50176
s_nop 0
buffer_load_dwordx4 v27, s[20:23], s56 offen lds
s_add_u32 s56, s55, 74496
s_mov_b32 m0, 51200
s_nop 0
buffer_load_dwordx4 v27, s[20:23], s56 offen lds
s_add_u32 s56, s55, 92928
s_mov_b32 m0, 52224
s_nop 0
buffer_load_dwordx4 v27, s[20:23], s56 offen lds
s_waitcnt vmcnt(32)
ds_read_b64_tr_b16 v[44:45], v28 offset:0
ds_read_b64_tr_b16 v[46:47], v28 offset:256
ds_read_b64_tr_b16 v[48:49], v28 offset:2048
ds_read_b64_tr_b16 v[50:51], v28 offset:2304
ds_read_b64_tr_b16 v[52:53], v28 offset:32
ds_read_b64_tr_b16 v[54:55], v28 offset:288
ds_read_b64_tr_b16 v[56:57], v28 offset:2080
ds_read_b64_tr_b16 v[58:59], v28 offset:2336
s_waitcnt lgkmcnt(0)
ds_write_b128 v2, v[44:47] offset:0
ds_write_b128 v2, v[48:51] offset:1024
ds_write_b128 v2, v[52:55] offset:2048
ds_write_b128 v2, v[56:59] offset:3072
s_waitcnt lgkmcnt(0)
s_add_u32 s56, s55, 1024
s_mov_b32 m0, 53248
s_nop 0
buffer_load_dwordx4 v27, s[20:23], s56 offen lds
s_add_u32 s56, s55, 19456
s_mov_b32 m0, 54272
s_nop 0
buffer_load_dwordx4 v27, s[20:23], s56 offen lds
s_add_u32 s56, s55, 74752
s_mov_b32 m0, 55296
s_nop 0
buffer_load_dwordx4 v27, s[20:23], s56 offen lds
s_add_u32 s56, s55, 93184
s_mov_b32 m0, 56320
s_nop 0
buffer_load_dwordx4 v27, s[20:23], s56 offen lds
s_waitcnt vmcnt(32)
ds_read_b64_tr_b16 v[44:45], v28 offset:4096
ds_read_b64_tr_b16 v[46:47], v28 offset:4352
ds_read_b64_tr_b16 v[48:49], v28 offset:6144
ds_read_b64_tr_b16 v[50:51], v28 offset:6400
ds_read_b64_tr_b16 v[52:53], v28 offset:4128
ds_read_b64_tr_b16 v[54:55], v28 offset:4384
ds_read_b64_tr_b16 v[56:57], v28 offset:6176
ds_read_b64_tr_b16 v[58:59], v28 offset:6432
s_waitcnt lgkmcnt(0)
ds_write_b128 v2, v[44:47] offset:4096
ds_write_b128 v2, v[48:51] offset:5120
ds_write_b128 v2, v[52:55] offset:6144
ds_write_b128 v2, v[56:59] offset:7168
s_waitcnt lgkmcnt(0)
s_waitcnt vmcnt(28)
ds_read_b64_tr_b16 v[44:45], v28 offset:8192
ds_read_b64_tr_b16 v[46:47], v28 offset:8448
ds_read_b64_tr_b16 v[48:49], v28 offset:10240
ds_read_b64_tr_b16 v[50:51], v28 offset:10496
ds_read_b64_tr_b16 v[52:53], v28 offset:8224
ds_read_b64_tr_b16 v[54:55], v28 offset:8480
ds_read_b64_tr_b16 v[56:57], v28 offset:10272
ds_read_b64_tr_b16 v[58:59], v28 offset:10528
s_waitcnt lgkmcnt(0)
ds_write_b128 v2, v[44:47] offset:8192
ds_write_b128 v2, v[48:51] offset:9216
ds_write_b128 v2, v[52:55] offset:10240
ds_write_b128 v2, v[56:59] offset:11264
s_waitcnt lgkmcnt(0)
s_waitcnt vmcnt(24)
ds_read_b64_tr_b16 v[44:45], v28 offset:12288
ds_read_b64_tr_b16 v[46:47], v28 offset:12544
ds_read_b64_tr_b16 v[48:49], v28 offset:14336
ds_read_b64_tr_b16 v[50:51], v28 offset:14592
ds_read_b64_tr_b16 v[52:53], v28 offset:12320
ds_read_b64_tr_b16 v[54:55], v28 offset:12576
ds_read_b64_tr_b16 v[56:57], v28 offset:14368
ds_read_b64_tr_b16 v[58:59], v28 offset:14624
s_waitcnt lgkmcnt(0)
ds_write_b128 v2, v[44:47] offset:12288
ds_write_b128 v2, v[48:51] offset:13312
ds_write_b128 v2, v[52:55] offset:14336
ds_write_b128 v2, v[56:59] offset:15360
s_waitcnt lgkmcnt(0)
s_waitcnt vmcnt(20)
ds_read_b64_tr_b16 v[44:45], v28 offset:16384
ds_read_b64_tr_b16 v[46:47], v28 offset:16640
ds_read_b64_tr_b16 v[48:49], v28 offset:18432
ds_read_b64_tr_b16 v[50:51], v28 offset:18688
ds_read_b64_tr_b16 v[52:53], v28 offset:16416
ds_read_b64_tr_b16 v[54:55], v28 offset:16672
ds_read_b64_tr_b16 v[56:57], v28 offset:18464
ds_read_b64_tr_b16 v[58:59], v28 offset:18720
s_waitcnt lgkmcnt(0)
ds_write_b128 v2, v[44:47] offset:16384
ds_write_b128 v2, v[48:51] offset:17408
ds_write_b128 v2, v[52:55] offset:18432
ds_write_b128 v2, v[56:59] offset:19456
s_waitcnt lgkmcnt(0)
s_waitcnt vmcnt(16)
ds_read_b64_tr_b16 v[44:45], v29 offset:20480
ds_read_b64_tr_b16 v[46:47], v29 offset:20608
ds_read_b64_tr_b16 v[48:49], v29 offset:20992
ds_read_b64_tr_b16 v[50:51], v29 offset:21120
ds_read_b64_tr_b16 v[52:53], v29 offset:22528
ds_read_b64_tr_b16 v[54:55], v29 offset:22656
ds_read_b64_tr_b16 v[56:57], v29 offset:23040
ds_read_b64_tr_b16 v[58:59], v29 offset:23168
s_waitcnt lgkmcnt(0)
ds_write_b128 v2, v[44:47] offset:20480
ds_write_b128 v2, v[48:51] offset:21504
ds_write_b128 v2, v[52:55] offset:22528
ds_write_b128 v2, v[56:59] offset:23552
s_waitcnt lgkmcnt(0)
s_waitcnt vmcnt(12)
ds_read_b64_tr_b16 v[44:45], v29 offset:24576
ds_read_b64_tr_b16 v[46:47], v29 offset:24704
ds_read_b64_tr_b16 v[48:49], v29 offset:25088
ds_read_b64_tr_b16 v[50:51], v29 offset:25216
ds_read_b64_tr_b16 v[52:53], v29 offset:26624
ds_read_b64_tr_b16 v[54:55], v29 offset:26752
ds_read_b64_tr_b16 v[56:57], v29 offset:27136
ds_read_b64_tr_b16 v[58:59], v29 offset:27264
s_waitcnt lgkmcnt(0)
ds_write_b128 v2, v[44:47] offset:24576
ds_write_b128 v2, v[48:51] offset:25600
ds_write_b128 v2, v[52:55] offset:26624
ds_write_b128 v2, v[56:59] offset:27648
s_waitcnt lgkmcnt(0)
s_waitcnt vmcnt(8)
ds_read_b64_tr_b16 v[44:45], v29 offset:28672
ds_read_b64_tr_b16 v[46:47], v29 offset:28800
ds_read_b64_tr_b16 v[48:49], v29 offset:29184
ds_read_b64_tr_b16 v[50:51], v29 offset:29312
ds_read_b64_tr_b16 v[52:53], v29 offset:30720
ds_read_b64_tr_b16 v[54:55], v29 offset:30848
ds_read_b64_tr_b16 v[56:57], v29 offset:31232
ds_read_b64_tr_b16 v[58:59], v29 offset:31360
s_waitcnt lgkmcnt(0)
ds_write_b128 v2, v[44:47] offset:28672
ds_write_b128 v2, v[48:51] offset:29696
ds_write_b128 v2, v[52:55] offset:30720
ds_write_b128 v2, v[56:59] offset:31744
s_waitcnt lgkmcnt(0)
s_waitcnt vmcnt(4)
ds_read_b64_tr_b16 v[44:45], v29 offset:32768
ds_read_b64_tr_b16 v[46:47], v29 offset:32896
ds_read_b64_tr_b16 v[48:49], v29 offset:33280
ds_read_b64_tr_b16 v[50:51], v29 offset:33408
ds_read_b64_tr_b16 v[52:53], v29 offset:34816
ds_read_b64_tr_b16 v[54:55], v29 offset:34944
ds_read_b64_tr_b16 v[56:57], v29 offset:35328
ds_read_b64_tr_b16 v[58:59], v29 offset:35456
s_waitcnt lgkmcnt(0)
ds_write_b128 v2, v[44:47] offset:32768
ds_write_b128 v2, v[48:51] offset:33792
ds_write_b128 v2, v[52:55] offset:34816
ds_write_b128 v2, v[56:59] offset:35840
s_waitcnt lgkmcnt(0)
s_waitcnt vmcnt(0)
ds_read_b64_tr_b16 v[44:45], v29 offset:36864
ds_read_b64_tr_b16 v[46:47], v29 offset:36992
ds_read_b64_tr_b16 v[48:49], v29 offset:37376
ds_read_b64_tr_b16 v[50:51], v29 offset:37504
ds_read_b64_tr_b16 v[52:53], v29 offset:38912
ds_read_b64_tr_b16 v[54:55], v29 offset:39040
ds_read_b64_tr_b16 v[56:57], v29 offset:39424
ds_read_b64_tr_b16 v[58:59], v29 offset:39552
s_waitcnt lgkmcnt(0)
ds_write_b128 v2, v[44:47] offset:36864
ds_write_b128 v2, v[48:51] offset:37888
ds_write_b128 v2, v[52:55] offset:38912
ds_write_b128 v2, v[56:59] offset:39936
s_waitcnt lgkmcnt(0)
v_mov_b32 v24, 0
L_rdv_w0:
buffer_load_dword v23, v24, s[28:31], 0 offen sc0 sc1
s_sub_u32 s41, s41, 1
s_cbranch_scc1 L_exit
s_waitcnt vmcnt(0)
v_readfirstlane_b32 s56, v23
s_nop 0
s_and_b32 s57, s56, 0xff
s_cmp_lg_u32 s57, 32
s_cbranch_scc1 L_rdv_w0
s_lshl_b32 s55, s32, 2
v_mov_b32 v24, 0
L_kvw_w0p:
buffer_load_dword v23, v24, s[28:31], s55 offen offset:128 sc0 sc1
s_sub_u32 s41, s41, 1
s_cbranch_scc1 L_exit
s_waitcnt vmcnt(0)
v_readfirstlane_b32 s54, v23
s_nop 0
s_and_b32 s54, s54, 255
s_cmp_lg_u32 s54, 4
s_cbranch_scc1 L_kvw_w0p
s_mov_b32 m0, 0
s_lshl_b32 s101, s32, 7
s_add_u32 s101, s101, 327680
s_mov_b32 s100, 22
s_lshl_b32 s58, s58, 5
s_cmp_eq_u32 s56, s58
s_cbranch_scc0 L_slow_w0
buffer_load_dwordx4 v[12:15], v9, s[4:7], s37 offen offset:0
buffer_load_dwordx4 v[16:19], v9, s[4:7], s37 offen offset:1024
buffer_load_dwordx4 v[52:55], v1, s[4:7], s37 offen offset:2048
buffer_load_dwordx4 v[56:59], v1, s[4:7], s37 offen offset:3072
v_mov_b64 v[20:21], 0
v_mov_b64 v[22:23], 0
v_mov_b64 v[24:25], 0
v_mov_b64 v[26:27], 0
v_mov_b64 v[28:29], 0
v_mov_b64 v[30:31], 0
v_mov_b64 v[32:33], 0
v_mov_b64 v[34:35], 0
v_mov_b64 v[36:37], 0
v_mov_b64 v[38:39], 0
v_mov_b64 v[40:41], 0
v_mov_b64 v[42:43], 0
v_lshrrev_b32 v6, 2, v1
ds_read_b128 v[44:47], v2 offset:0
ds_read_b128 v[48:51], v2 offset:1024
s_waitcnt vmcnt(0)
buffer_load_dwordx4 v[60:63], v1, s[4:7], s47 offen sc1
buffer_load_dwordx4 v[68:71], v1, s[4:7], s38 offen sc1
s_waitcnt vmcnt(0)
.p2align 6
L_top_w0f:
s_waitcnt vmcnt(1)
L_a0_w0f:
s_waitcnt lgkmcnt(0)
v_smfmac_f32_16x16x64_bf16 v[20:23], v[60:63], v[44:51], v0
ds_write_b128 v1, v[60:63] offset:1024
v_smfmac_f32_16x16x64_bf16 v[28:31], v[60:63], v[176:183], v0
ds_read_b128 v[44:47], v2 offset:2048
buffer_load_dwordx4 v[64:67], v1, s[4:7], s48 offen sc1
v_smfmac_f32_16x16x64_bf16 v[32:35], v[60:63], v[184:191], v0
ds_read_b128 v[48:51], v2 offset:3072
buffer_load_dword v76, v6, s[4:7], s49 offen sc1
v_smfmac_f32_16x16x64_bf16 v[36:39], v[60:63], a[48:55], v0
s_waitcnt vmcnt(2)
v_bitop3_b32 v77, v60, v68, s35 bitop3:0x7e
v_smfmac_f32_16x16x64_bf16 v[40:43], v[60:63], a[56:63], v0
v_and_b32 v77, 1, v77
v_smfmac_f32_16x16x64_bf16 v[20:23], v[68:71], v[80:87], v0
v_cmp_ne_u32 vcc, 0, v77
s_waitcnt lgkmcnt(0)
v_smfmac_f32_16x16x64_bf16 v[24:27], v[60:63], v[44:51], v0
ds_read_b128 v[44:47], v2 offset:4096
v_smfmac_f32_16x16x64_bf16 v[24:27], v[68:71], v[88:95], v0
s_cbranch_vccnz L_ra0_w0f
s_barrier
ds_read_b128 v[72:75], v1 offset:3072
v_smfmac_f32_16x16x64_bf16 v[28:31], v[68:71], v[192:199], v0
ds_read_b128 v[48:51], v2 offset:5120
v_smfmac_f32_16x16x64_bf16 v[32:35], v[68:71], v[200:207], v0
ds_read_b128 v[60:63], v1 offset:4096
v_smfmac_f32_16x16x64_bf16 v[36:39], v[68:71], a[64:71], v0
v_smfmac_f32_16x16x64_bf16 v[40:43], v[68:71], a[72:79], v0
s_waitcnt lgkmcnt(2)
s_waitcnt lgkmcnt(1)
v_smfmac_f32_16x16x64_bf16 v[20:23], v[72:75], v[44:51], v0
ds_read_b128 v[44:47], v2 offset:6144
v_smfmac_f32_16x16x64_bf16 v[28:31], v[72:75], v[208:215], v0
ds_read_b128 v[48:51], v2 offset:7168
v_smfmac_f32_16x16x64_bf16 v[32:35], v[72:75], v[216:223], v0
s_waitcnt vmcnt(0)
ds_write_b128 v1, v[64:67] offset:5120
v_smfmac_f32_16x16x64_bf16 v[36:39], v[72:75], a[80:87], v0
ds_write_addtid_b32 v76 offset:9216
v_bitop3_b32 v77, v64, s35, 1 bitop3:0x28
v_smfmac_f32_16x16x64_bf16 v[40:43], v[72:75], a[88:95], v0
v_bitop3_b32 v78, v76, s35, v11 bitop3:0x28
s_waitcnt lgkmcnt(2)
v_smfmac_f32_16x16x64_bf16 v[24:27], v[72:75], v[44:51], v0
ds_read_b128 v[44:47], v2 offset:8192
v_or_b32 v77, v77, v78
v_smfmac_f32_16x16x64_bf16 v[20:23], v[60:63], v[96:103], v0
ds_read_b128 v[48:51], v2 offset:9216
v_cmp_ne_u32 vcc, 0, v77
v_smfmac_f32_16x16x64_bf16 v[24:27], v[60:63], v[104:111], v0
v_smfmac_f32_16x16x64_bf16 v[36:39], v[60:63], a[96:103], v0
s_cbranch_vccnz L_ra1_w0f
L_a1_w0f:
s_waitcnt lgkmcnt(2)
s_barrier
ds_read_b128 v[68:71], v1 offset:6144
v_smfmac_f32_16x16x64_bf16 v[28:31], v[60:63], v[224:231], v0
ds_read_b128 v[72:75], v1 offset:7168
v_lshlrev_b32 v6, 2, v1
v_smfmac_f32_16x16x64_bf16 v[40:43], v[60:63], a[104:111], v0
ds_read_b128 v[76:79], v1 offset:9216
v_smfmac_f32_16x16x64_bf16 v[32:35], v[60:63], v[232:239], v0
ds_read_b128 v[60:63], v1 offset:8192
s_waitcnt lgkmcnt(4)
v_smfmac_f32_16x16x64_bf16 v[20:23], v[64:67], v[44:51], v0
ds_read_b128 v[44:47], v2 offset:10240
buffer_load_dword v6, s[4:7], s39 offen lds
s_waitcnt lgkmcnt(4)
v_smfmac_f32_16x16x64_bf16 v[20:23], v[68:71], v[112:119], v0
ds_read_b128 v[48:51], v2 offset:11264
v_smfmac_f32_16x16x64_bf16 v[24:27], v[68:71], v[120:127], v0
s_waitcnt lgkmcnt(4)
v_smfmac_f32_16x16x64_bf16 v[20:23], v[72:75], v[128:135], v0
s_waitcnt lgkmcnt(3)
v_smfmac_f32_16x16x64_bf16 v[20:23], v[76:79], v[160:167], v0
s_waitcnt lgkmcnt(2)
v_smfmac_f32_16x16x64_bf16 v[20:23], v[60:63], v[144:151], v0
s_waitcnt lgkmcnt(0)
v_smfmac_f32_16x16x64_bf16 v[24:27], v[64:67], v[44:51], v0
ds_read_b128 v[44:47], v2 offset:12288
v_smfmac_f32_16x16x64_bf16 v[24:27], v[72:75], v[136:143], v0
ds_read_b128 v[48:51], v2 offset:13312
v_add_f32 v20, v20, v22
v_smfmac_f32_16x16x64_bf16 v[24:27], v[76:79], v[168:175], v0
v_add_f32 v21, v21, v23
v_smfmac_f32_16x16x64_bf16 v[24:27], v[60:63], v[152:159], v0
v_cvt_pk_bf16_f32 v22, v20, v21
v_smfmac_f32_16x16x64_bf16 v[28:31], v[64:67], v[240:247], v0
v_smfmac_f32_16x16x64_bf16 v[28:31], v[72:75], a[0:7], v0
v_add_f32 v24, v24, v26
v_add_f32 v25, v25, v27
v_cvt_pk_bf16_f32 v23, v24, v25
s_waitcnt lgkmcnt(0)
v_smfmac_f32_16x16x64_bf16 v[28:31], v[68:71], v[44:51], v0
ds_write_b64 v3, v[22:23] offset:10240
v_smfmac_f32_16x16x64_bf16 v[28:31], v[76:79], a[32:39], v0
ds_read_b128 v[44:47], v2 offset:14336
v_smfmac_f32_16x16x64_bf16 v[28:31], v[60:63], a[16:23], v0
ds_read_b128 v[48:51], v2 offset:15360
v_smfmac_f32_16x16x64_bf16 v[32:35], v[64:67], v[248:255], v0
s_waitcnt lgkmcnt(2)
s_barrier
ds_read_b64_tr_b16 v[20:21], v4 offset:10240
ds_read_b64_tr_b16 v[22:23], v4 offset:10752
v_smfmac_f32_16x16x64_bf16 v[32:35], v[72:75], a[8:15], v0
ds_read_b64_tr_b16 v[24:25], v4 offset:11264
v_add_f32 v28, v28, v30
v_smfmac_f32_16x16x64_bf16 v[32:35], v[76:79], a[40:47], v0
ds_read_b64_tr_b16 v[26:27], v4 offset:11776
v_add_f32 v29, v29, v31
s_waitcnt lgkmcnt(4)
v_smfmac_f32_16x16x64_bf16 v[32:35], v[68:71], v[44:51], v0
ds_read_b128 v[44:47], v2 offset:18432
v_cvt_pk_bf16_f32 v30, v28, v29
v_smfmac_f32_16x16x64_bf16 v[32:35], v[60:63], a[24:31], v0
ds_read_b128 v[48:51], v2 offset:19456
s_waitcnt lgkmcnt(4)
v_mfma_f32_16x16x32_bf16 v[12:15], v[12:15], v[20:23], 0
s_waitcnt lgkmcnt(2)
v_mfma_f32_16x16x32_bf16 v[12:15], v[16:19], v[24:27], v[12:15]
v_add_f32 v32, v32, v34
v_add_f32 v33, v33, v35
v_cvt_pk_bf16_f32 v31, v32, v33
ds_write_b64 v3, v[30:31] offset:12288
v_smfmac_f32_16x16x64_bf16 v[36:39], v[64:67], a[112:119], v0
s_nop 2
v_add_f32_dpp v12, v14, v12 quad_perm:[2,3,0,1] row_mask:0xf bank_mask:0xf
v_add_f32_dpp v13, v15, v13 quad_perm:[2,3,0,1] row_mask:0xf bank_mask:0xf
ds_write_b64 v5, v[12:13] offset:14336
v_smfmac_f32_16x16x64_bf16 v[40:43], v[64:67], a[120:127], v0
s_waitcnt lgkmcnt(1)
s_barrier
ds_read_b64_tr_b16 v[64:65], v4 offset:12288
ds_read_b64_tr_b16 v[66:67], v4 offset:12800
v_smfmac_f32_16x16x64_bf16 v[36:39], v[68:71], a[128:135], v0
ds_read_b64_tr_b16 v[16:17], v4 offset:13312
ds_read_b64_tr_b16 v[18:19], v4 offset:13824
v_smfmac_f32_16x16x64_bf16 v[40:43], v[68:71], a[136:143], v0
s_waitcnt lgkmcnt(4)
s_barrier
ds_read_b128 v[68:71], v1 offset:14336
v_smfmac_f32_16x16x64_bf16 v[40:43], v[60:63], v[44:51], v0
ds_read_b128 v[44:47], v2 offset:16384
s_waitcnt lgkmcnt(4)
v_mfma_f32_16x16x32_bf16 v[64:67], v[64:67], v[20:23], 0
ds_read_b128 v[48:51], v2 offset:17408
s_waitcnt lgkmcnt(3)
v_mfma_f32_16x16x32_bf16 v[64:67], v[16:19], v[24:27], v[64:67]
v_smfmac_f32_16x16x64_bf16 v[40:43], v[72:75], a[152:159], v0
ds_read_b128 v[12:15], v2 offset:22528
s_waitcnt lgkmcnt(3)
v_max3_f32 v25, v68, v69, v70
v_smfmac_f32_16x16x64_bf16 v[40:43], v[76:79], a[168:175], v0
ds_read_b128 v[16:19], v2 offset:23552
v_add_f32_dpp v64, v66, v64 quad_perm:[2,3,0,1] row_mask:0xf bank_mask:0xf
v_add_f32_dpp v65, v67, v65 quad_perm:[2,3,0,1] row_mask:0xf bank_mask:0xf
v_max_f32 v25, v25, v71
v_max_f32 v24, v64, v65
v_mul_f32 v24, s50, v24
v_max_f32_dpp v25, v25, v25 quad_perm:[2,3,0,1] row_mask:0xf bank_mask:0xf
v_smfmac_f32_16x16x64_bf16 v[36:39], v[72:75], a[144:151], v0
s_nop 0
v_max_f32_dpp v26, v24, v25 quad_perm:[0,1,0,1] row_mask:0xf bank_mask:0xf
v_max_f32_dpp v27, v24, v25 quad_perm:[0,1,0,1] row_mask:0xf bank_mask:0xf
v_smfmac_f32_16x16x64_bf16 v[36:39], v[76:79], a[160:167], v0
s_nop 0
v_permlane16_swap_b32 v26, v27
v_max_f32 v28, v26, v27
v_max_f32 v29, v26, v27
s_waitcnt lgkmcnt(2)
v_smfmac_f32_16x16x64_bf16 v[36:39], v[60:63], v[44:51], v0
v_permlane32_swap_b32 v28, v29
v_max_f32 v28, v28, v29
v_sub_f32 v68, v68, v28
v_sub_f32 v69, v69, v28
v_sub_f32 v70, v70, v28
v_sub_f32 v71, v71, v28
v_exp_f32 v68, v68
v_exp_f32 v69, v69
v_exp_f32 v70, v70
v_exp_f32 v71, v71
v_cvt_pk_bf16_f32 v20, v68, v69
v_cvt_pk_bf16_f32 v21, v70, v71
v_pk_add_f32 v[36:37], v[36:37], v[38:39]
v_mov_b32_dpp v22, v20 quad_perm:[2,3,0,1] row_mask:0xf bank_mask:0xf
v_mov_b32_dpp v23, v21 quad_perm:[2,3,0,1] row_mask:0xf bank_mask:0xf
v_pk_fma_f32 v[64:65], v[64:65], s[50:51], v[28:29] op_sel_hi:[1,1,0] neg_lo:[0,0,1] neg_hi:[0,0,1]
v_cvt_pk_bf16_f32 v32, v36, v37
v_pk_add_f32 v[40:41], v[40:41], v[42:43]
v_mfma_f32_16x16x32_bf16 v[36:39], v[52:55], v[20:23], 0
v_mov_b64 v[72:73], s[52:53]
v_mov_b64 v[74:75], s[52:53]
v_cvt_pk_bf16_f32 v33, v40, v41
v_exp_f32 v64, v64
v_mfma_f32_16x16x32_bf16 v[68:71], v[72:75], v[20:23], 0
v_exp_f32 v65, v65
v_mov_b32 v25, 0
v_cvt_pk_bf16_f32 v24, v64, v65
v_mfma_f32_16x16x32_bf16 v[40:43], v[56:59], v[20:23], 0
v_cvt_pk_bf16_f32 v27, v64, v65
v_mov_b32 v26, 0
v_mfma_f32_16x16x16_bf16 v[68:71], v[72:73], v[24:25], v[68:71]
ds_read_b128 v[44:47], v2 offset:20480
v_mfma_f32_16x16x16_bf16 v[36:39], v[32:33], v[24:25], v[36:39]
ds_read_b128 v[48:51], v2 offset:21504
v_mfma_f32_16x16x16_bf16 v[40:43], v[32:33], v[26:27], v[40:43]
v_rcp_f32 v68, v68
v_mov_b64 v[76:77], 0
v_mov_b64 v[78:79], 0
s_nop 0
v_mul_f32 v36, v36, v68
v_mul_f32 v37, v37, v68
v_mul_f32 v38, v38, v68
v_mul_f32 v39, v39, v68
v_pk_mul_f32 v[40:41], v[40:41], v[68:69] op_sel_hi:[1,0]
v_pk_mul_f32 v[42:43], v[42:43], v[68:69] op_sel_hi:[1,0]
v_cvt_pk_bf16_f32 v36, v36, v37
v_cvt_pk_bf16_f32 v37, v38, v39
v_cvt_pk_bf16_f32 v38, v40, v41
v_cvt_pk_bf16_f32 v39, v42, v43
ds_write_b128 v1, v[36:39] offset:5120
ds_read_b128 v[60:63], v7 offset:5120
buffer_store_dwordx4 v[30:33], v1, s[4:7], s40 offen sc0 sc1
ds_read_b128 v[52:55], v2 offset:24576
ds_read_b128 v[56:59], v2 offset:25600
v_mov_b32 v28, s34
s_mov_b64 exec, 1
buffer_store_dword v28, v1, s[4:7], s101 offen sc0 sc1
s_mov_b64 exec, -1
s_cmp_eq_u32 s34, s100
v_mov_b64 v[20:21], 0
v_mov_b64 v[22:23], 0
s_cbranch_scc1 L_ev_w0f
L_evb_w0f:
s_waitcnt lgkmcnt(3)
s_barrier
ds_read_b128 v[64:67], v7 offset:6144
ds_read_b128 v[68:71], v7 offset:7168
ds_read_b128 v[72:75], v7 offset:8192
s_waitcnt lgkmcnt(5)
v_smfmac_f32_16x16x64_bf16 v[76:79], v[60:63], v[44:51], v0 abid:1
ds_read_b128 v[44:47], v2 offset:26624
v_mov_b64 v[24:25], 0
v_smfmac_f32_16x16x64_bf16 v[20:23], v[60:63], v[12:19], v0 abid:1
ds_read_b128 v[48:51], v2 offset:27648
v_mov_b64 v[26:27], 0
s_waitcnt lgkmcnt(4)
v_smfmac_f32_16x16x64_bf16 v[76:79], v[64:67], a[176:183], v0 abid:1
ds_read_b128 v[12:15], v2 offset:28672
v_mov_b64 v[40:41], 0
s_waitcnt lgkmcnt(4)
v_smfmac_f32_16x16x64_bf16 v[76:79], v[68:71], v[52:59], v0 abid:1
ds_read_b128 v[16:19], v2 offset:29696
v_mov_b64 v[42:43], 0
s_waitcnt lgkmcnt(4)
v_smfmac_f32_16x16x64_bf16 v[76:79], v[72:75], a[184:191], v0 abid:1
ds_read_b128 v[52:55], v2 offset:30720
v_mov_b64 v[36:37], 0
v_smfmac_f32_16x16x64_bf16 v[20:23], v[64:67], a[192:199], v0 abid:1
ds_read_b128 v[56:59], v2 offset:31744
v_mov_b64 v[38:39], 0
s_waitcnt lgkmcnt(4)
v_smfmac_f32_16x16x64_bf16 v[20:23], v[68:71], v[44:51], v0 abid:1
ds_read_b128 v[44:47], v2 offset:32768
v_cvt_pk_bf16_f32 v76, v76, v77
v_cvt_pk_bf16_f32 v77, v78, v79
v_bfi_b32 v76, 1, s35, v76
buffer_store_dwordx2 v[76:77], v8, s[4:7], s42 offen
v_smfmac_f32_16x16x64_bf16 v[20:23], v[72:75], a[200:207], v0 abid:1
ds_read_b128 v[48:51], v2 offset:33792
s_waitcnt lgkmcnt(4)
v_smfmac_f32_16x16x64_bf16 v[24:27], v[60:63], v[12:19], v0 abid:1
ds_read_b128 v[12:15], v2 offset:34816
v_smfmac_f32_16x16x64_bf16 v[24:27], v[64:67], a[208:215], v0 abid:1
ds_read_b128 v[16:19], v2 offset:35840
v_cvt_pk_bf16_f32 v20, v20, v21
v_cvt_pk_bf16_f32 v21, v22, v23
v_bfi_b32 v20, 1, s35, v20
buffer_store_dwordx2 v[20:21], v8, s[4:7], s43 offen
s_waitcnt lgkmcnt(4)
v_smfmac_f32_16x16x64_bf16 v[24:27], v[68:71], v[52:59], v0 abid:1
ds_read_b128 v[52:55], v2 offset:36864
v_smfmac_f32_16x16x64_bf16 v[24:27], v[72:75], a[216:223], v0 abid:1
ds_read_b128 v[56:59], v2 offset:37888
s_waitcnt lgkmcnt(4)
v_smfmac_f32_16x16x64_bf16 v[40:43], v[60:63], v[44:51], v0 abid:1
ds_read_b128 v[44:47], v2 offset:38912
v_smfmac_f32_16x16x64_bf16 v[40:43], v[64:67], a[224:231], v0 abid:1
ds_read_b128 v[48:51], v2 offset:39936
v_cvt_pk_bf16_f32 v24, v24, v25
s_waitcnt lgkmcnt(4)
v_smfmac_f32_16x16x64_bf16 v[40:43], v[68:71], v[12:19], v0 abid:1
v_cvt_pk_bf16_f32 v25, v26, v27
v_smfmac_f32_16x16x64_bf16 v[40:43], v[72:75], a[232:239], v0 abid:1
v_bfi_b32 v24, 1, s35, v24
buffer_store_dwordx2 v[24:25], v8, s[4:7], s44 offen
s_waitcnt lgkmcnt(2)
v_smfmac_f32_16x16x64_bf16 v[36:39], v[60:63], v[52:59], v0 abid:1
v_smfmac_f32_16x16x64_bf16 v[36:39], v[64:67], a[240:247], v0 abid:1
v_cvt_pk_bf16_f32 v40, v40, v41
s_waitcnt lgkmcnt(0)
v_smfmac_f32_16x16x64_bf16 v[36:39], v[68:71], v[44:51], v0 abid:1
v_cvt_pk_bf16_f32 v41, v42, v43
v_smfmac_f32_16x16x64_bf16 v[36:39], v[72:75], a[248:255], v0 abid:1
v_bfi_b32 v40, 1, s35, v40
buffer_store_dwordx2 v[40:41], v8, s[4:7], s45 offen
s_nop 5
v_cvt_pk_bf16_f32 v36, v36, v37
v_cvt_pk_bf16_f32 v37, v38, v39
v_bfi_b32 v36, 1, s35, v36
buffer_store_dwordx2 v[36:37], v8, s[4:7], s46 offen
s_add_u32 s34, s34, 1
s_add_u32 s37, s37, 524288
s_add_u32 s39, s39, 524288
v_mov_b64 v[20:21], 0
v_mov_b64 v[22:23], 0
v_mov_b64 v[24:25], 0
v_mov_b64 v[26:27], 0
v_mov_b64 v[28:29], 0
v_mov_b64 v[34:35], 0
v_mov_b64 v[36:37], 0
v_mov_b64 v[38:39], 0
v_mov_b64 v[40:41], 0
v_mov_b64 v[42:43], 0
ds_read_b128 v[44:47], v2 offset:0
ds_read_b128 v[48:51], v2 offset:1024
s_waitcnt vmcnt(0)
buffer_load_dwordx4 v[12:15], v9, s[4:7], s37 offen offset:0
buffer_load_dwordx4 v[16:19], v9, s[4:7], s37 offen offset:1024
buffer_load_dwordx4 v[52:55], v1, s[4:7], s37 offen offset:2048
buffer_load_dwordx4 v[56:59], v1, s[4:7], s37 offen offset:3072
s_not_b32 s35, s35
s_not_b32 s36, s36
v_lshrrev_b32 v6, 2, v1
s_barrier
buffer_load_dwordx4 v[60:63], v1, s[4:7], s47 offen sc1
buffer_load_dwordx4 v[68:71], v1, s[4:7], s38 offen sc1
s_add_u32 s40, s40, 131072
v_mov_b64 v[30:31], 0
v_mov_b64 v[32:33], 0
s_branch L_top_w0f
L_done_w0f:
s_waitcnt vmcnt(0)
s_barrier
v_mov_b32 v28, 64
s_mov_b64 exec, 1
buffer_store_dword v28, v1, s[4:7], s101 offen sc0 sc1
s_mov_b64 exec, -1
s_waitcnt vmcnt(0) lgkmcnt(0)
s_endpgm
L_ra0_w0f:
buffer_load_dwordx4 v[60:63], v1, s[4:7], s47 offen sc1
buffer_load_dwordx4 v[68:71], v1, s[4:7], s38 offen sc1
s_sub_u32 s41, s41, 1
s_cbranch_scc1 L_exit
ds_read_b128 v[44:47], v2 offset:0
ds_read_b128 v[48:51], v2 offset:1024
s_waitcnt vmcnt(0) lgkmcnt(0)
v_mov_b64 v[20:21], 0
v_mov_b64 v[22:23], 0
v_mov_b64 v[24:25], 0
v_mov_b64 v[26:27], 0
v_mov_b64 v[28:29], 0
v_mov_b64 v[30:31], 0
v_mov_b64 v[32:33], 0
v_mov_b64 v[34:35], 0
v_mov_b64 v[36:37], 0
v_mov_b64 v[38:39], 0
v_mov_b64 v[40:41], 0
v_mov_b64 v[42:43], 0
s_nop 0
s_branch L_a0_w0f
L_ra1_w0f:
buffer_load_dwordx4 v[64:67], v1, s[4:7], s48 offen sc1
buffer_load_dword v76, v6, s[4:7], s49 offen sc1
s_sub_u32 s41, s41, 1
s_cbranch_scc1 L_exit
s_waitcnt vmcnt(0)
v_bitop3_b32 v77, v64, s35, 1 bitop3:0x28
v_bitop3_b32 v78, v76, s35, v11 bitop3:0x28
v_or_b32 v77, v77, v78
v_cmp_ne_u32 vcc, 0, v77
s_cbranch_vccnz L_ra1_w0f
ds_write_b128 v1, v[64:67] offset:5120
ds_write_addtid_b32 v76 offset:9216
s_waitcnt lgkmcnt(0)
s_branch L_a1_w0f
L_ev_w0f:
s_cmp_eq_u32 s34, 63
s_cbranch_scc1 L_done_w0f
s_mov_b32 s100, 63

s_lshl_b32 s55, s32, 2
v_mov_b32 v34, 0
L_kvw_w0f:
buffer_load_dword v29, v34, s[28:31], s55 offen offset:128 sc0 sc1
s_sub_u32 s41, s41, 1
s_cbranch_scc1 L_exit
s_waitcnt vmcnt(0)
v_readfirstlane_b32 s54, v29
s_nop 0
s_and_b32 s54, s54, 65280
s_cmp_lg_u32 s54, 1024
s_cbranch_scc1 L_kvw_w0f
s_branch L_evb_w0f
L_slow_w0:
buffer_load_dwordx4 v[12:15], v9, s[4:7], s37 offen offset:0
buffer_load_dwordx4 v[16:19], v9, s[4:7], s37 offen offset:1024
buffer_load_dwordx4 v[52:55], v1, s[4:7], s37 offen offset:2048
buffer_load_dwordx4 v[56:59], v1, s[4:7], s37 offen offset:3072
v_mov_b64 v[20:21], 0
v_mov_b64 v[22:23], 0
v_mov_b64 v[24:25], 0
v_mov_b64 v[26:27], 0
v_mov_b64 v[28:29], 0
v_mov_b64 v[30:31], 0
v_mov_b64 v[32:33], 0
v_mov_b64 v[34:35], 0
v_mov_b64 v[36:37], 0
v_mov_b64 v[38:39], 0
v_mov_b64 v[40:41], 0
v_mov_b64 v[42:43], 0
v_lshrrev_b32 v6, 2, v1
ds_read_b128 v[44:47], v2 offset:0
ds_read_b128 v[48:51], v2 offset:1024
s_waitcnt vmcnt(0)
buffer_load_dwordx4 v[60:63], v1, s[4:7], s47 offen sc0 sc1
buffer_load_dwordx4 v[68:71], v1, s[4:7], s38 offen sc0 sc1
s_waitcnt vmcnt(0)
.p2align 6
L_top_w0s:
s_waitcnt vmcnt(1)
L_a0_w0s:
s_waitcnt lgkmcnt(0)
v_smfmac_f32_16x16x64_bf16 v[20:23], v[60:63], v[44:51], v0
ds_write_b128 v1, v[60:63] offset:1024
v_smfmac_f32_16x16x64_bf16 v[28:31], v[60:63], v[176:183], v0
ds_read_b128 v[44:47], v2 offset:2048
buffer_load_dwordx4 v[64:67], v1, s[4:7], s48 offen sc0 sc1
v_smfmac_f32_16x16x64_bf16 v[32:35], v[60:63], v[184:191], v0
ds_read_b128 v[48:51], v2 offset:3072
buffer_load_dword v76, v6, s[4:7], s49 offen sc0 sc1
v_smfmac_f32_16x16x64_bf16 v[36:39], v[60:63], a[48:55], v0
s_waitcnt vmcnt(2)
v_bitop3_b32 v77, v60, v68, s35 bitop3:0x7e
v_smfmac_f32_16x16x64_bf16 v[40:43], v[60:63], a[56:63], v0
v_and_b32 v77, 1, v77
v_smfmac_f32_16x16x64_bf16 v[20:23], v[68:71], v[80:87], v0
v_cmp_ne_u32 vcc, 0, v77
s_waitcnt lgkmcnt(0)
v_smfmac_f32_16x16x64_bf16 v[24:27], v[60:63], v[44:51], v0
ds_read_b128 v[44:47], v2 offset:4096
v_smfmac_f32_16x16x64_bf16 v[24:27], v[68:71], v[88:95], v0
s_cbranch_vccnz L_ra0_w0s
s_barrier
ds_read_b128 v[72:75], v1 offset:3072
v_smfmac_f32_16x16x64_bf16 v[28:31], v[68:71], v[192:199], v0
ds_read_b128 v[48:51], v2 offset:5120
v_smfmac_f32_16x16x64_bf16 v[32:35], v[68:71], v[200:207], v0
ds_read_b128 v[60:63], v1 offset:4096
v_smfmac_f32_16x16x64_bf16 v[36:39], v[68:71], a[64:71], v0
v_smfmac_f32_16x16x64_bf16 v[40:43], v[68:71], a[72:79], v0
s_waitcnt lgkmcnt(2)
s_waitcnt lgkmcnt(1)
v_smfmac_f32_16x16x64_bf16 v[20:23], v[72:75], v[44:51], v0
ds_read_b128 v[44:47], v2 offset:6144
v_smfmac_f32_16x16x64_bf16 v[28:31], v[72:75], v[208:215], v0
ds_read_b128 v[48:51], v2 offset:7168
v_smfmac_f32_16x16x64_bf16 v[32:35], v[72:75], v[216:223], v0
s_waitcnt vmcnt(0)
ds_write_b128 v1, v[64:67] offset:5120
v_smfmac_f32_16x16x64_bf16 v[36:39], v[72:75], a[80:87], v0
ds_write_addtid_b32 v76 offset:9216
v_bitop3_b32 v77, v64, s35, 1 bitop3:0x28
v_smfmac_f32_16x16x64_bf16 v[40:43], v[72:75], a[88:95], v0
v_bitop3_b32 v78, v76, s35, v11 bitop3:0x28
s_waitcnt lgkmcnt(2)
v_smfmac_f32_16x16x64_bf16 v[24:27], v[72:75], v[44:51], v0
ds_read_b128 v[44:47], v2 offset:8192
v_or_b32 v77, v77, v78
v_smfmac_f32_16x16x64_bf16 v[20:23], v[60:63], v[96:103], v0
ds_read_b128 v[48:51], v2 offset:9216
v_cmp_ne_u32 vcc, 0, v77
v_smfmac_f32_16x16x64_bf16 v[24:27], v[60:63], v[104:111], v0
v_smfmac_f32_16x16x64_bf16 v[36:39], v[60:63], a[96:103], v0
s_cbranch_vccnz L_ra1_w0s
L_a1_w0s:
s_waitcnt lgkmcnt(2)
s_barrier
ds_read_b128 v[68:71], v1 offset:6144
v_smfmac_f32_16x16x64_bf16 v[28:31], v[60:63], v[224:231], v0
ds_read_b128 v[72:75], v1 offset:7168
v_lshlrev_b32 v6, 2, v1
v_smfmac_f32_16x16x64_bf16 v[40:43], v[60:63], a[104:111], v0
ds_read_b128 v[76:79], v1 offset:9216
v_smfmac_f32_16x16x64_bf16 v[32:35], v[60:63], v[232:239], v0
ds_read_b128 v[60:63], v1 offset:8192
s_waitcnt lgkmcnt(4)
v_smfmac_f32_16x16x64_bf16 v[20:23], v[64:67], v[44:51], v0
ds_read_b128 v[44:47], v2 offset:10240
buffer_load_dword v6, s[4:7], s39 offen lds
s_waitcnt lgkmcnt(4)
v_smfmac_f32_16x16x64_bf16 v[20:23], v[68:71], v[112:119], v0
ds_read_b128 v[48:51], v2 offset:11264
v_smfmac_f32_16x16x64_bf16 v[24:27], v[68:71], v[120:127], v0
s_waitcnt lgkmcnt(4)
v_smfmac_f32_16x16x64_bf16 v[20:23], v[72:75], v[128:135], v0
s_waitcnt lgkmcnt(3)
v_smfmac_f32_16x16x64_bf16 v[20:23], v[76:79], v[160:167], v0
s_waitcnt lgkmcnt(2)
v_smfmac_f32_16x16x64_bf16 v[20:23], v[60:63], v[144:151], v0
s_waitcnt lgkmcnt(0)
v_smfmac_f32_16x16x64_bf16 v[24:27], v[64:67], v[44:51], v0
ds_read_b128 v[44:47], v2 offset:12288
v_smfmac_f32_16x16x64_bf16 v[24:27], v[72:75], v[136:143], v0
ds_read_b128 v[48:51], v2 offset:13312
v_add_f32 v20, v20, v22
v_smfmac_f32_16x16x64_bf16 v[24:27], v[76:79], v[168:175], v0
v_add_f32 v21, v21, v23
v_smfmac_f32_16x16x64_bf16 v[24:27], v[60:63], v[152:159], v0
v_cvt_pk_bf16_f32 v22, v20, v21
v_smfmac_f32_16x16x64_bf16 v[28:31], v[64:67], v[240:247], v0
v_smfmac_f32_16x16x64_bf16 v[28:31], v[72:75], a[0:7], v0
v_add_f32 v24, v24, v26
v_add_f32 v25, v25, v27
v_cvt_pk_bf16_f32 v23, v24, v25
s_waitcnt lgkmcnt(0)
v_smfmac_f32_16x16x64_bf16 v[28:31], v[68:71], v[44:51], v0
ds_write_b64 v3, v[22:23] offset:10240
v_smfmac_f32_16x16x64_bf16 v[28:31], v[76:79], a[32:39], v0
ds_read_b128 v[44:47], v2 offset:14336
v_smfmac_f32_16x16x64_bf16 v[28:31], v[60:63], a[16:23], v0
ds_read_b128 v[48:51], v2 offset:15360
v_smfmac_f32_16x16x64_bf16 v[32:35], v[64:67], v[248:255], v0
s_waitcnt lgkmcnt(2)
s_barrier
ds_read_b64_tr_b16 v[20:21], v4 offset:10240
ds_read_b64_tr_b16 v[22:23], v4 offset:10752
v_smfmac_f32_16x16x64_bf16 v[32:35], v[72:75], a[8:15], v0
ds_read_b64_tr_b16 v[24:25], v4 offset:11264
v_add_f32 v28, v28, v30
v_smfmac_f32_16x16x64_bf16 v[32:35], v[76:79], a[40:47], v0
ds_read_b64_tr_b16 v[26:27], v4 offset:11776
v_add_f32 v29, v29, v31
s_waitcnt lgkmcnt(4)
v_smfmac_f32_16x16x64_bf16 v[32:35], v[68:71], v[44:51], v0
ds_read_b128 v[44:47], v2 offset:18432
v_cvt_pk_bf16_f32 v30, v28, v29
v_smfmac_f32_16x16x64_bf16 v[32:35], v[60:63], a[24:31], v0
ds_read_b128 v[48:51], v2 offset:19456
s_waitcnt lgkmcnt(4)
v_mfma_f32_16x16x32_bf16 v[12:15], v[12:15], v[20:23], 0
s_waitcnt lgkmcnt(2)
v_mfma_f32_16x16x32_bf16 v[12:15], v[16:19], v[24:27], v[12:15]
v_add_f32 v32, v32, v34
v_add_f32 v33, v33, v35
v_cvt_pk_bf16_f32 v31, v32, v33
ds_write_b64 v3, v[30:31] offset:12288
v_smfmac_f32_16x16x64_bf16 v[36:39], v[64:67], a[112:119], v0
s_nop 2
v_add_f32_dpp v12, v14, v12 quad_perm:[2,3,0,1] row_mask:0xf bank_mask:0xf
v_add_f32_dpp v13, v15, v13 quad_perm:[2,3,0,1] row_mask:0xf bank_mask:0xf
ds_write_b64 v5, v[12:13] offset:14336
v_smfmac_f32_16x16x64_bf16 v[40:43], v[64:67], a[120:127], v0
s_waitcnt lgkmcnt(1)
s_barrier
ds_read_b64_tr_b16 v[64:65], v4 offset:12288
ds_read_b64_tr_b16 v[66:67], v4 offset:12800
v_smfmac_f32_16x16x64_bf16 v[36:39], v[68:71], a[128:135], v0
ds_read_b64_tr_b16 v[16:17], v4 offset:13312
ds_read_b64_tr_b16 v[18:19], v4 offset:13824
v_smfmac_f32_16x16x64_bf16 v[40:43], v[68:71], a[136:143], v0
s_waitcnt lgkmcnt(4)
s_barrier
ds_read_b128 v[68:71], v1 offset:14336
v_smfmac_f32_16x16x64_bf16 v[40:43], v[60:63], v[44:51], v0
ds_read_b128 v[44:47], v2 offset:16384
s_waitcnt lgkmcnt(4)
v_mfma_f32_16x16x32_bf16 v[64:67], v[64:67], v[20:23], 0
ds_read_b128 v[48:51], v2 offset:17408
s_waitcnt lgkmcnt(3)
v_mfma_f32_16x16x32_bf16 v[64:67], v[16:19], v[24:27], v[64:67]
v_smfmac_f32_16x16x64_bf16 v[40:43], v[72:75], a[152:159], v0
ds_read_b128 v[12:15], v2 offset:22528
s_waitcnt lgkmcnt(3)
v_max3_f32 v25, v68, v69, v70
v_smfmac_f32_16x16x64_bf16 v[40:43], v[76:79], a[168:175], v0
ds_read_b128 v[16:19], v2 offset:23552
v_add_f32_dpp v64, v66, v64 quad_perm:[2,3,0,1] row_mask:0xf bank_mask:0xf
v_add_f32_dpp v65, v67, v65 quad_perm:[2,3,0,1] row_mask:0xf bank_mask:0xf
v_max_f32 v25, v25, v71
v_max_f32 v24, v64, v65
v_mul_f32 v24, s50, v24
v_max_f32_dpp v25, v25, v25 quad_perm:[2,3,0,1] row_mask:0xf bank_mask:0xf
v_smfmac_f32_16x16x64_bf16 v[36:39], v[72:75], a[144:151], v0
s_nop 0
v_max_f32_dpp v26, v24, v25 quad_perm:[0,1,0,1] row_mask:0xf bank_mask:0xf
v_max_f32_dpp v27, v24, v25 quad_perm:[0,1,0,1] row_mask:0xf bank_mask:0xf
v_smfmac_f32_16x16x64_bf16 v[36:39], v[76:79], a[160:167], v0
s_nop 0
v_permlane16_swap_b32 v26, v27
v_max_f32 v28, v26, v27
v_max_f32 v29, v26, v27
s_waitcnt lgkmcnt(2)
v_smfmac_f32_16x16x64_bf16 v[36:39], v[60:63], v[44:51], v0
v_permlane32_swap_b32 v28, v29
v_max_f32 v28, v28, v29
v_sub_f32 v68, v68, v28
v_sub_f32 v69, v69, v28
v_sub_f32 v70, v70, v28
v_sub_f32 v71, v71, v28
v_exp_f32 v68, v68
v_exp_f32 v69, v69
v_exp_f32 v70, v70
v_exp_f32 v71, v71
v_cvt_pk_bf16_f32 v20, v68, v69
v_cvt_pk_bf16_f32 v21, v70, v71
v_pk_add_f32 v[36:37], v[36:37], v[38:39]
v_mov_b32_dpp v22, v20 quad_perm:[2,3,0,1] row_mask:0xf bank_mask:0xf
v_mov_b32_dpp v23, v21 quad_perm:[2,3,0,1] row_mask:0xf bank_mask:0xf
v_pk_fma_f32 v[64:65], v[64:65], s[50:51], v[28:29] op_sel_hi:[1,1,0] neg_lo:[0,0,1] neg_hi:[0,0,1]
v_cvt_pk_bf16_f32 v32, v36, v37
v_pk_add_f32 v[40:41], v[40:41], v[42:43]
v_mfma_f32_16x16x32_bf16 v[36:39], v[52:55], v[20:23], 0
v_mov_b64 v[72:73], s[52:53]
v_mov_b64 v[74:75], s[52:53]
v_cvt_pk_bf16_f32 v33, v40, v41
v_exp_f32 v64, v64
v_mfma_f32_16x16x32_bf16 v[68:71], v[72:75], v[20:23], 0
v_exp_f32 v65, v65
v_mov_b32 v25, 0
v_cvt_pk_bf16_f32 v24, v64, v65
v_mfma_f32_16x16x32_bf16 v[40:43], v[56:59], v[20:23], 0
v_cvt_pk_bf16_f32 v27, v64, v65
v_mov_b32 v26, 0
v_mfma_f32_16x16x16_bf16 v[68:71], v[72:73], v[24:25], v[68:71]
ds_read_b128 v[44:47], v2 offset:20480
v_mfma_f32_16x16x16_bf16 v[36:39], v[32:33], v[24:25], v[36:39]
ds_read_b128 v[48:51], v2 offset:21504
v_mfma_f32_16x16x16_bf16 v[40:43], v[32:33], v[26:27], v[40:43]
v_rcp_f32 v68, v68
v_mov_b64 v[76:77], 0
v_mov_b64 v[78:79], 0
s_nop 0
v_mul_f32 v36, v36, v68
v_mul_f32 v37, v37, v68
v_mul_f32 v38, v38, v68
v_mul_f32 v39, v39, v68
v_pk_mul_f32 v[40:41], v[40:41], v[68:69] op_sel_hi:[1,0]
v_pk_mul_f32 v[42:43], v[42:43], v[68:69] op_sel_hi:[1,0]
v_cvt_pk_bf16_f32 v36, v36, v37
v_cvt_pk_bf16_f32 v37, v38, v39
v_cvt_pk_bf16_f32 v38, v40, v41
v_cvt_pk_bf16_f32 v39, v42, v43
ds_write_b128 v1, v[36:39] offset:5120
ds_read_b128 v[60:63], v7 offset:5120
buffer_store_dwordx4 v[30:33], v1, s[4:7], s40 offen sc0 sc1
ds_read_b128 v[52:55], v2 offset:24576
ds_read_b128 v[56:59], v2 offset:25600
v_mov_b32 v28, s34
s_mov_b64 exec, 1
buffer_store_dword v28, v1, s[4:7], s101 offen sc0 sc1
s_mov_b64 exec, -1
s_cmp_eq_u32 s34, s100
v_mov_b64 v[20:21], 0
v_mov_b64 v[22:23], 0
s_cbranch_scc1 L_ev_w0s
L_evb_w0s:
s_waitcnt lgkmcnt(3)
s_barrier
ds_read_b128 v[64:67], v7 offset:6144
ds_read_b128 v[68:71], v7 offset:7168
ds_read_b128 v[72:75], v7 offset:8192
s_waitcnt lgkmcnt(5)
v_smfmac_f32_16x16x64_bf16 v[76:79], v[60:63], v[44:51], v0 abid:1
ds_read_b128 v[44:47], v2 offset:26624
v_mov_b64 v[24:25], 0
v_smfmac_f32_16x16x64_bf16 v[20:23], v[60:63], v[12:19], v0 abid:1
ds_read_b128 v[48:51], v2 offset:27648
v_mov_b64 v[26:27], 0
s_waitcnt lgkmcnt(4)
v_smfmac_f32_16x16x64_bf16 v[76:79], v[64:67], a[176:183], v0 abid:1
ds_read_b128 v[12:15], v2 offset:28672
v_mov_b64 v[40:41], 0
s_waitcnt lgkmcnt(4)
v_smfmac_f32_16x16x64_bf16 v[76:79], v[68:71], v[52:59], v0 abid:1
ds_read_b128 v[16:19], v2 offset:29696
v_mov_b64 v[42:43], 0
s_waitcnt lgkmcnt(4)
v_smfmac_f32_16x16x64_bf16 v[76:79], v[72:75], a[184:191], v0 abid:1
ds_read_b128 v[52:55], v2 offset:30720
v_mov_b64 v[36:37], 0
v_smfmac_f32_16x16x64_bf16 v[20:23], v[64:67], a[192:199], v0 abid:1
ds_read_b128 v[56:59], v2 offset:31744
v_mov_b64 v[38:39], 0
s_waitcnt lgkmcnt(4)
v_smfmac_f32_16x16x64_bf16 v[20:23], v[68:71], v[44:51], v0 abid:1
ds_read_b128 v[44:47], v2 offset:32768
v_cvt_pk_bf16_f32 v76, v76, v77
v_cvt_pk_bf16_f32 v77, v78, v79
v_bfi_b32 v76, 1, s35, v76
buffer_store_dwordx2 v[76:77], v8, s[4:7], s42 offen sc0 sc1
v_smfmac_f32_16x16x64_bf16 v[20:23], v[72:75], a[200:207], v0 abid:1
ds_read_b128 v[48:51], v2 offset:33792
s_waitcnt lgkmcnt(4)
v_smfmac_f32_16x16x64_bf16 v[24:27], v[60:63], v[12:19], v0 abid:1
ds_read_b128 v[12:15], v2 offset:34816
v_smfmac_f32_16x16x64_bf16 v[24:27], v[64:67], a[208:215], v0 abid:1
ds_read_b128 v[16:19], v2 offset:35840
v_cvt_pk_bf16_f32 v20, v20, v21
v_cvt_pk_bf16_f32 v21, v22, v23
v_bfi_b32 v20, 1, s35, v20
buffer_store_dwordx2 v[20:21], v8, s[4:7], s43 offen sc0 sc1
s_waitcnt lgkmcnt(4)
v_smfmac_f32_16x16x64_bf16 v[24:27], v[68:71], v[52:59], v0 abid:1
ds_read_b128 v[52:55], v2 offset:36864
v_smfmac_f32_16x16x64_bf16 v[24:27], v[72:75], a[216:223], v0 abid:1
ds_read_b128 v[56:59], v2 offset:37888
s_waitcnt lgkmcnt(4)
v_smfmac_f32_16x16x64_bf16 v[40:43], v[60:63], v[44:51], v0 abid:1
ds_read_b128 v[44:47], v2 offset:38912
v_smfmac_f32_16x16x64_bf16 v[40:43], v[64:67], a[224:231], v0 abid:1
ds_read_b128 v[48:51], v2 offset:39936
v_cvt_pk_bf16_f32 v24, v24, v25
s_waitcnt lgkmcnt(4)
v_smfmac_f32_16x16x64_bf16 v[40:43], v[68:71], v[12:19], v0 abid:1
v_cvt_pk_bf16_f32 v25, v26, v27
v_smfmac_f32_16x16x64_bf16 v[40:43], v[72:75], a[232:239], v0 abid:1
v_bfi_b32 v24, 1, s35, v24
buffer_store_dwordx2 v[24:25], v8, s[4:7], s44 offen sc0 sc1
s_waitcnt lgkmcnt(2)
v_smfmac_f32_16x16x64_bf16 v[36:39], v[60:63], v[52:59], v0 abid:1
v_smfmac_f32_16x16x64_bf16 v[36:39], v[64:67], a[240:247], v0 abid:1
v_cvt_pk_bf16_f32 v40, v40, v41
s_waitcnt lgkmcnt(0)
v_smfmac_f32_16x16x64_bf16 v[36:39], v[68:71], v[44:51], v0 abid:1
v_cvt_pk_bf16_f32 v41, v42, v43
v_smfmac_f32_16x16x64_bf16 v[36:39], v[72:75], a[248:255], v0 abid:1
v_bfi_b32 v40, 1, s35, v40
buffer_store_dwordx2 v[40:41], v8, s[4:7], s45 offen sc0 sc1
s_nop 5
v_cvt_pk_bf16_f32 v36, v36, v37
v_cvt_pk_bf16_f32 v37, v38, v39
v_bfi_b32 v36, 1, s35, v36
buffer_store_dwordx2 v[36:37], v8, s[4:7], s46 offen sc0 sc1
s_add_u32 s34, s34, 1
s_add_u32 s37, s37, 524288
s_add_u32 s39, s39, 524288
v_mov_b64 v[20:21], 0
v_mov_b64 v[22:23], 0
v_mov_b64 v[24:25], 0
v_mov_b64 v[26:27], 0
v_mov_b64 v[28:29], 0
v_mov_b64 v[34:35], 0
v_mov_b64 v[36:37], 0
v_mov_b64 v[38:39], 0
v_mov_b64 v[40:41], 0
v_mov_b64 v[42:43], 0
ds_read_b128 v[44:47], v2 offset:0
ds_read_b128 v[48:51], v2 offset:1024
s_waitcnt vmcnt(0)
buffer_load_dwordx4 v[12:15], v9, s[4:7], s37 offen offset:0
buffer_load_dwordx4 v[16:19], v9, s[4:7], s37 offen offset:1024
buffer_load_dwordx4 v[52:55], v1, s[4:7], s37 offen offset:2048
buffer_load_dwordx4 v[56:59], v1, s[4:7], s37 offen offset:3072
s_not_b32 s35, s35
s_not_b32 s36, s36
v_lshrrev_b32 v6, 2, v1
s_barrier
buffer_load_dwordx4 v[60:63], v1, s[4:7], s47 offen sc0 sc1
buffer_load_dwordx4 v[68:71], v1, s[4:7], s38 offen sc0 sc1
s_add_u32 s40, s40, 131072
v_mov_b64 v[30:31], 0
v_mov_b64 v[32:33], 0
s_branch L_top_w0s
L_done_w0s:
s_waitcnt vmcnt(0)
s_barrier
v_mov_b32 v28, 64
s_mov_b64 exec, 1
buffer_store_dword v28, v1, s[4:7], s101 offen sc0 sc1
s_mov_b64 exec, -1
s_waitcnt vmcnt(0) lgkmcnt(0)
s_endpgm
L_ra0_w0s:
buffer_load_dwordx4 v[60:63], v1, s[4:7], s47 offen sc0 sc1
buffer_load_dwordx4 v[68:71], v1, s[4:7], s38 offen sc0 sc1
s_sub_u32 s41, s41, 1
s_cbranch_scc1 L_exit
ds_read_b128 v[44:47], v2 offset:0
ds_read_b128 v[48:51], v2 offset:1024
s_waitcnt vmcnt(0) lgkmcnt(0)
v_mov_b64 v[20:21], 0
v_mov_b64 v[22:23], 0
v_mov_b64 v[24:25], 0
v_mov_b64 v[26:27], 0
v_mov_b64 v[28:29], 0
v_mov_b64 v[30:31], 0
v_mov_b64 v[32:33], 0
v_mov_b64 v[34:35], 0
v_mov_b64 v[36:37], 0
v_mov_b64 v[38:39], 0
v_mov_b64 v[40:41], 0
v_mov_b64 v[42:43], 0
s_nop 0
s_branch L_a0_w0s
L_ra1_w0s:
buffer_load_dwordx4 v[64:67], v1, s[4:7], s48 offen sc0 sc1
buffer_load_dword v76, v6, s[4:7], s49 offen sc0 sc1
s_sub_u32 s41, s41, 1
s_cbranch_scc1 L_exit
s_waitcnt vmcnt(0)
v_bitop3_b32 v77, v64, s35, 1 bitop3:0x28
v_bitop3_b32 v78, v76, s35, v11 bitop3:0x28
v_or_b32 v77, v77, v78
v_cmp_ne_u32 vcc, 0, v77
s_cbranch_vccnz L_ra1_w0s
ds_write_b128 v1, v[64:67] offset:5120
ds_write_addtid_b32 v76 offset:9216
s_waitcnt lgkmcnt(0)
s_branch L_a1_w0s
L_ev_w0s:
s_cmp_eq_u32 s34, 63
s_cbranch_scc1 L_done_w0s
s_mov_b32 s100, 63

s_lshl_b32 s55, s32, 2
v_mov_b32 v34, 0
L_kvw_w0s:
buffer_load_dword v29, v34, s[28:31], s55 offen offset:128 sc0 sc1
s_sub_u32 s41, s41, 1
s_cbranch_scc1 L_exit
s_waitcnt vmcnt(0)
v_readfirstlane_b32 s54, v29
s_nop 0
s_and_b32 s54, s54, 65280
s_cmp_lg_u32 s54, 1024
s_cbranch_scc1 L_kvw_w0s
s_branch L_evb_w0s
L_pro_w1:
v_and_b32 v20, 63, v0
v_and_b32 v21, 15, v0
v_bfe_u32 v22, v0, 4, 2
v_lshlrev_b32 v1, 4, v20
v_add_u32 v2, 57344, v1
v_bfe_u32 v23, v20, 4, 1
v_lshlrev_b32 v26, 4, v23
v_bfe_u32 v23, v20, 2, 2
v_lshl_add_u32 v26, v23, 1, v26
v_bfe_u32 v23, v20, 5, 1
v_add_u32 v26, v26, v23
v_lshlrev_b32 v26, 13, v26
v_and_b32 v23, 3, v20
v_lshl_add_u32 v26, v23, 4, v26
v_lshrrev_b32 v24, 2, v20
v_mul_u32_u24 v27, 1152, v24
v_lshl_add_u32 v27, v23, 4, v27
v_lshrrev_b32 v24, 2, v21
v_lshl_add_u32 v25, v22, 3, v24
v_lshlrev_b32 v28, 6, v25
v_lshl_add_u32 v28, v23, 3, v28
v_add_u32 v28, 57344, v28
v_and_b32 v25, 1, v22
v_lshlrev_b32 v29, 10, v25
v_lshrrev_b32 v25, 1, v22
v_lshl_add_u32 v29, v25, 8, v29
v_and_b32 v25, 1, v24
v_lshl_add_u32 v29, v25, 6, v29
v_lshrrev_b32 v25, 1, v24
v_lshl_add_u32 v29, v25, 5, v29
v_lshl_add_u32 v29, v23, 3, v29
v_add_u32 v29, 57344, v29
s_lshl_b32 s54, s32, 8
s_add_u32 s54, s54, 64
s_mul_i32 s55, s32, 147456
s_waitcnt lgkmcnt(0)
s_add_u32 s56, s54, 1048576
s_mov_b32 m0, 69632
s_nop 0
buffer_load_dwordx4 v26, s[8:11], s56 offen lds
s_add_u32 s56, s54, 1114112
s_mov_b32 m0, 70656
s_nop 0
buffer_load_dwordx4 v26, s[8:11], s56 offen lds
s_add_u32 s56, s54, 1310720
s_mov_b32 m0, 71680
s_nop 0
buffer_load_dwordx4 v26, s[8:11], s56 offen lds
s_add_u32 s56, s54, 1376256
s_mov_b32 m0, 72704
s_nop 0
buffer_load_dwordx4 v26, s[8:11], s56 offen lds
s_add_u32 s56, s54, 0
s_mov_b32 m0, 73728
s_nop 0
buffer_load_dwordx4 v26, s[8:11], s56 offen lds
s_add_u32 s56, s54, 65536
s_mov_b32 m0, 74752
s_nop 0
buffer_load_dwordx4 v26, s[8:11], s56 offen lds
s_add_u32 s56, s54, 262144
s_mov_b32 m0, 75776
s_nop 0
buffer_load_dwordx4 v26, s[8:11], s56 offen lds
s_add_u32 s56, s54, 327680
s_mov_b32 m0, 76800
s_nop 0
buffer_load_dwordx4 v26, s[8:11], s56 offen lds
s_add_u32 s56, s54, 3145728
s_mov_b32 m0, 77824
s_nop 0
buffer_load_dwordx4 v26, s[8:11], s56 offen lds
s_add_u32 s56, s54, 3211264
s_mov_b32 m0, 78848
s_nop 0
buffer_load_dwordx4 v26, s[8:11], s56 offen lds
s_add_u32 s56, s54, 3407872
s_mov_b32 m0, 79872
s_nop 0
buffer_load_dwordx4 v26, s[8:11], s56 offen lds
s_add_u32 s56, s54, 3473408
s_mov_b32 m0, 80896
s_nop 0
buffer_load_dwordx4 v26, s[8:11], s56 offen lds
s_add_u32 s56, s54, 3670016
s_mov_b32 m0, 81920
s_nop 0
buffer_load_dwordx4 v26, s[8:11], s56 offen lds
s_add_u32 s56, s54, 3735552
s_mov_b32 m0, 82944
s_nop 0
buffer_load_dwordx4 v26, s[8:11], s56 offen lds
s_add_u32 s56, s54, 3932160
s_mov_b32 m0, 83968
s_nop 0
buffer_load_dwordx4 v26, s[8:11], s56 offen lds
s_add_u32 s56, s54, 3997696
s_mov_b32 m0, 84992
s_nop 0
buffer_load_dwordx4 v26, s[8:11], s56 offen lds
s_add_u32 s56, s54, 2097152
s_mov_b32 m0, 86016
s_nop 0
buffer_load_dwordx4 v26, s[8:11], s56 offen lds
s_add_u32 s56, s54, 2162688
s_mov_b32 m0, 87040
s_nop 0
buffer_load_dwordx4 v26, s[8:11], s56 offen lds
s_add_u32 s56, s54, 2359296
s_mov_b32 m0, 88064
s_nop 0
buffer_load_dwordx4 v26, s[8:11], s56 offen lds
s_add_u32 s56, s54, 2424832
s_mov_b32 m0, 89088
s_nop 0
buffer_load_dwordx4 v26, s[8:11], s56 offen lds
s_add_u32 s56, s54, 4194304
s_mov_b32 m0, 90112
s_nop 0
buffer_load_dwordx4 v26, s[8:11], s56 offen lds
s_add_u32 s56, s54, 4259840
s_mov_b32 m0, 91136
s_nop 0
buffer_load_dwordx4 v26, s[8:11], s56 offen lds
s_add_u32 s56, s54, 4456448
s_mov_b32 m0, 92160
s_nop 0
buffer_load_dwordx4 v26, s[8:11], s56 offen lds
s_add_u32 s56, s54, 4521984
s_mov_b32 m0, 93184
s_nop 0
buffer_load_dwordx4 v26, s[8:11], s56 offen lds
s_add_u32 s56, s54, 524288
s_mov_b32 m0, 94208
s_nop 0
buffer_load_dwordx4 v26, s[12:15], s56 offen lds
s_add_u32 s56, s54, 589824
s_mov_b32 m0, 95232
s_nop 0
buffer_load_dwordx4 v26, s[12:15], s56 offen lds
s_add_u32 s56, s54, 786432
s_mov_b32 m0, 96256
s_nop 0
buffer_load_dwordx4 v26, s[12:15], s56 offen lds
s_add_u32 s56, s54, 851968
s_mov_b32 m0, 97280
s_nop 0
buffer_load_dwordx4 v26, s[12:15], s56 offen lds
s_add_u32 s56, s54, 1048576
s_mov_b32 m0, 57344
s_nop 0
buffer_load_dwordx4 v26, s[12:15], s56 offen lds
s_add_u32 s56, s54, 1114112
s_mov_b32 m0, 58368
s_nop 0
buffer_load_dwordx4 v26, s[12:15], s56 offen lds
s_add_u32 s56, s54, 1310720
s_mov_b32 m0, 59392
s_nop 0
buffer_load_dwordx4 v26, s[12:15], s56 offen lds
s_add_u32 s56, s54, 1376256
s_mov_b32 m0, 60416
s_nop 0
buffer_load_dwordx4 v26, s[12:15], s56 offen lds
s_add_u32 s56, s54, 1572864
s_mov_b32 m0, 61440
s_nop 0
buffer_load_dwordx4 v26, s[12:15], s56 offen lds
s_add_u32 s56, s54, 1638400
s_mov_b32 m0, 62464
s_nop 0
buffer_load_dwordx4 v26, s[12:15], s56 offen lds
s_add_u32 s56, s54, 1835008
s_mov_b32 m0, 63488
s_nop 0
buffer_load_dwordx4 v26, s[12:15], s56 offen lds
s_add_u32 s56, s54, 1900544
s_mov_b32 m0, 64512
s_nop 0
buffer_load_dwordx4 v26, s[12:15], s56 offen lds
v_bfe_u32 v23, v21, 1, 1
v_and_b32 v24, 1, v21
v_lshl_add_u32 v23, v24, 16, v23
v_mul_u32_u24 v23, 0xaaaa, v23
v_add_u32 v0, 0x44444444, v23
v_lshlrev_b32 v3, 3, v20
v_lshrrev_b32 v25, 5, v20
v_lshlrev_b32 v25, 6, v25
v_xor_b32 v3, v3, v25
v_lshrrev_b32 v25, 2, v20
v_and_b32 v4, 3, v21
v_lshl_add_u32 v4, v4, 4, v25
v_lshlrev_b32 v4, 3, v4
v_bfe_u32 v25, v21, 1, 1
v_lshlrev_b32 v23, 6, v25
v_xor_b32 v4, v4, v23
v_and_b32 v23, 2, v22
v_xor_b32 v5, v21, v23
v_lshlrev_b32 v5, 4, v5
v_lshl_add_u32 v5, v25, 10, v5
v_and_b32 v23, 1, v22
v_lshl_add_u32 v5, v23, 3, v5
v_lshlrev_b32 v9, 8, v22
v_lshl_add_u32 v9, v25, 6, v9
v_bfe_u32 v23, v21, 3, 1
v_lshl_add_u32 v9, v23, 7, v9
v_bfe_u32 v23, v21, 2, 1
v_lshl_add_u32 v9, v23, 5, v9
v_and_b32 v23, 1, v21
v_lshl_add_u32 v9, v23, 4, v9
v_lshrrev_b32 v23, 1, v22
v_and_b32 v24, 1, v22
v_and_b32 v25, 7, v21
v_lshrrev_b32 v7, 3, v21
v_lshl_add_u32 v8, v7, 1, v23
v_lshlrev_b32 v8, 12, v8
v_lshl_add_u32 v8, v24, 7, v8
v_lshl_add_u32 v8, v25, 3, v8
s_lshr_b32 s56, s32, 1
s_lshl_b32 s56, s56, 8
s_and_b32 s57, s32, 1
s_lshl_b32 s57, s57, 6
s_add_u32 s56, s56, s57
s_add_u32 s56, s56, 16384
v_add_u32 v8, s56, v8
v_and_b32 v7, 12, v21
v_bfe_u32 v25, v21, 1, 1
v_add_u32 v7, v7, v25
v_lshlrev_b32 v7, 4, v7
v_lshl_add_u32 v7, v22, 8, v7
s_mov_b32 s42, 0
s_mov_b32 s43, 65536
s_mov_b32 s44, 131072
s_mov_b32 s45, 196608
s_mov_b32 s46, 262144
s_mov_b32 s47, 295936
s_mov_b32 s48, 300032
s_mov_b32 s49, 303360
s_mov_b32 s38, 296960
s_mov_b32 s50, 0x3e0293ee
s_mov_b32 s51, 0x3e0293ee
s_mov_b32 s52, 0x3f803f80
s_mov_b32 s53, 0x3f803f80
v_and_b32 v11, 3, v21
v_cmp_eq_u32 vcc, 0, v11
s_nop 1
v_cndmask_b32 v11, 0, 1, vcc
s_mov_b32 s34, 0
s_mov_b32 s35, -1
s_mov_b32 s36, 0
s_mov_b32 s41, 400000
s_lshl_b32 s37, s32, 14
s_add_u32 s39, s37, 17305600
s_add_u32 s37, s37, 16781312
s_lshl_b32 s40, s32, 12
s_add_u32 s40, s40, 8389632
v_mov_b64 v[36:37], 0
v_mov_b64 v[38:39], 0
s_waitcnt vmcnt(0) lgkmcnt(0)
s_barrier
s_getreg_b32 s56, hwreg(HW_REG_XCC_ID)
s_and_b32 s56, s56, 15
s_mul_i32 s57, s56, s56
s_lshl_b32 s57, s57, 18
s_lshl_b32 s56, s56, 8
s_add_u32 s57, s57, s56
s_add_u32 s58, s57, 1
ds_read_b64_tr_b16 v[80:81], v28 offset:12288
ds_read_b64_tr_b16 v[82:83], v28 offset:12544
ds_read_b64_tr_b16 v[84:85], v28 offset:14336
ds_read_b64_tr_b16 v[86:87], v28 offset:14592
ds_read_b64_tr_b16 v[88:89], v28 offset:12320
ds_read_b64_tr_b16 v[90:91], v28 offset:12576
ds_read_b64_tr_b16 v[92:93], v28 offset:14368
ds_read_b64_tr_b16 v[94:95], v28 offset:14624
s_waitcnt lgkmcnt(0)
s_add_u32 s56, s54, 0
s_mov_b32 m0, 65536
s_nop 0
buffer_load_dwordx4 v26, s[12:15], s56 offen lds
s_add_u32 s56, s54, 65536
s_mov_b32 m0, 66560
s_nop 0
buffer_load_dwordx4 v26, s[12:15], s56 offen lds
s_add_u32 s56, s54, 262144
s_mov_b32 m0, 67584
s_nop 0
buffer_load_dwordx4 v26, s[12:15], s56 offen lds
s_add_u32 s56, s54, 327680
s_mov_b32 m0, 68608
s_nop 0
buffer_load_dwordx4 v26, s[12:15], s56 offen lds
ds_read_b64_tr_b16 v[96:97], v28 offset:16384
ds_read_b64_tr_b16 v[98:99], v28 offset:16640
ds_read_b64_tr_b16 v[100:101], v28 offset:18432
ds_read_b64_tr_b16 v[102:103], v28 offset:18688
ds_read_b64_tr_b16 v[104:105], v28 offset:16416
ds_read_b64_tr_b16 v[106:107], v28 offset:16672
ds_read_b64_tr_b16 v[108:109], v28 offset:18464
ds_read_b64_tr_b16 v[110:111], v28 offset:18720
s_waitcnt lgkmcnt(0)
s_add_u32 s56, s54, 2621440
s_mov_b32 m0, 69632
s_nop 0
buffer_load_dwordx4 v26, s[12:15], s56 offen lds
s_add_u32 s56, s54, 2686976
s_mov_b32 m0, 70656
s_nop 0
buffer_load_dwordx4 v26, s[12:15], s56 offen lds
s_add_u32 s56, s54, 2883584
s_mov_b32 m0, 71680
s_nop 0
buffer_load_dwordx4 v26, s[12:15], s56 offen lds
s_add_u32 s56, s54, 2949120
s_mov_b32 m0, 72704
s_nop 0
buffer_load_dwordx4 v26, s[12:15], s56 offen lds
ds_read_b64_tr_b16 v[112:113], v28 offset:20480
ds_read_b64_tr_b16 v[114:115], v28 offset:20736
ds_read_b64_tr_b16 v[116:117], v28 offset:22528
ds_read_b64_tr_b16 v[118:119], v28 offset:22784
ds_read_b64_tr_b16 v[120:121], v28 offset:20512
ds_read_b64_tr_b16 v[122:123], v28 offset:20768
ds_read_b64_tr_b16 v[124:125], v28 offset:22560
ds_read_b64_tr_b16 v[126:127], v28 offset:22816
s_waitcnt lgkmcnt(0)
s_add_u32 s56, s54, 3670016
s_mov_b32 m0, 73728
s_nop 0
buffer_load_dwordx4 v26, s[12:15], s56 offen lds
s_add_u32 s56, s54, 3735552
s_mov_b32 m0, 74752
s_nop 0
buffer_load_dwordx4 v26, s[12:15], s56 offen lds
s_add_u32 s56, s54, 3932160
s_mov_b32 m0, 75776
s_nop 0
buffer_load_dwordx4 v26, s[12:15], s56 offen lds
s_add_u32 s56, s54, 3997696
s_mov_b32 m0, 76800
s_nop 0
buffer_load_dwordx4 v26, s[12:15], s56 offen lds
ds_read_b64_tr_b16 v[128:129], v28 offset:24576
ds_read_b64_tr_b16 v[130:131], v28 offset:24832
ds_read_b64_tr_b16 v[132:133], v28 offset:26624
ds_read_b64_tr_b16 v[134:135], v28 offset:26880
ds_read_b64_tr_b16 v[136:137], v28 offset:24608
ds_read_b64_tr_b16 v[138:139], v28 offset:24864
ds_read_b64_tr_b16 v[140:141], v28 offset:26656
ds_read_b64_tr_b16 v[142:143], v28 offset:26912
s_waitcnt lgkmcnt(0)
s_add_u32 s56, s54, 2097152
s_mov_b32 m0, 77824
s_nop 0
buffer_load_dwordx4 v26, s[12:15], s56 offen lds
s_add_u32 s56, s54, 2162688
s_mov_b32 m0, 78848
s_nop 0
buffer_load_dwordx4 v26, s[12:15], s56 offen lds
s_add_u32 s56, s54, 2359296
s_mov_b32 m0, 79872
s_nop 0
buffer_load_dwordx4 v26, s[12:15], s56 offen lds
s_add_u32 s56, s54, 2424832
s_mov_b32 m0, 80896
s_nop 0
buffer_load_dwordx4 v26, s[12:15], s56 offen lds
ds_read_b64_tr_b16 v[144:145], v28 offset:28672
ds_read_b64_tr_b16 v[146:147], v28 offset:28928
ds_read_b64_tr_b16 v[148:149], v28 offset:30720
ds_read_b64_tr_b16 v[150:151], v28 offset:30976
ds_read_b64_tr_b16 v[152:153], v28 offset:28704
ds_read_b64_tr_b16 v[154:155], v28 offset:28960
ds_read_b64_tr_b16 v[156:157], v28 offset:30752
ds_read_b64_tr_b16 v[158:159], v28 offset:31008
s_waitcnt lgkmcnt(0)
s_add_u32 s56, s54, 4194304
s_mov_b32 m0, 81920
s_nop 0
buffer_load_dwordx4 v26, s[12:15], s56 offen lds
s_add_u32 s56, s54, 4259840
s_mov_b32 m0, 82944
s_nop 0
buffer_load_dwordx4 v26, s[12:15], s56 offen lds
s_add_u32 s56, s54, 4456448
s_mov_b32 m0, 83968
s_nop 0
buffer_load_dwordx4 v26, s[12:15], s56 offen lds
s_add_u32 s56, s54, 4521984
s_mov_b32 m0, 84992
s_nop 0
buffer_load_dwordx4 v26, s[12:15], s56 offen lds
ds_read_b64_tr_b16 v[160:161], v28 offset:32768
ds_read_b64_tr_b16 v[162:163], v28 offset:33024
ds_read_b64_tr_b16 v[164:165], v28 offset:34816
ds_read_b64_tr_b16 v[166:167], v28 offset:35072
ds_read_b64_tr_b16 v[168:169], v28 offset:32800
ds_read_b64_tr_b16 v[170:171], v28 offset:33056
ds_read_b64_tr_b16 v[172:173], v28 offset:34848
ds_read_b64_tr_b16 v[174:175], v28 offset:35104
s_waitcnt lgkmcnt(0)
s_add_u32 s56, s54, 524288
s_mov_b32 m0, 86016
s_nop 0
buffer_load_dwordx4 v26, s[16:19], s56 offen lds
s_add_u32 s56, s54, 589824
s_mov_b32 m0, 87040
s_nop 0
buffer_load_dwordx4 v26, s[16:19], s56 offen lds
s_add_u32 s56, s54, 786432
s_mov_b32 m0, 88064
s_nop 0
buffer_load_dwordx4 v26, s[16:19], s56 offen lds
s_add_u32 s56, s54, 851968
s_mov_b32 m0, 89088
s_nop 0
buffer_load_dwordx4 v26, s[16:19], s56 offen lds
ds_read_b64_tr_b16 v[176:177], v28 offset:36864
ds_read_b64_tr_b16 v[178:179], v28 offset:37120
ds_read_b64_tr_b16 v[180:181], v28 offset:38912
ds_read_b64_tr_b16 v[182:183], v28 offset:39168
ds_read_b64_tr_b16 v[184:185], v28 offset:36896
ds_read_b64_tr_b16 v[186:187], v28 offset:37152
ds_read_b64_tr_b16 v[188:189], v28 offset:38944
ds_read_b64_tr_b16 v[190:191], v28 offset:39200
s_waitcnt lgkmcnt(0)
s_add_u32 s56, s54, 1048576
s_mov_b32 m0, 90112
s_nop 0
buffer_load_dwordx4 v26, s[16:19], s56 offen lds
s_add_u32 s56, s54, 1114112
s_mov_b32 m0, 91136
s_nop 0
buffer_load_dwordx4 v26, s[16:19], s56 offen lds
s_add_u32 s56, s54, 1310720
s_mov_b32 m0, 92160
s_nop 0
buffer_load_dwordx4 v26, s[16:19], s56 offen lds
s_add_u32 s56, s54, 1376256
s_mov_b32 m0, 93184
s_nop 0
buffer_load_dwordx4 v26, s[16:19], s56 offen lds
ds_read_b64_tr_b16 v[192:193], v28 offset:0
ds_read_b64_tr_b16 v[194:195], v28 offset:256
ds_read_b64_tr_b16 v[196:197], v28 offset:2048
ds_read_b64_tr_b16 v[198:199], v28 offset:2304
ds_read_b64_tr_b16 v[200:201], v28 offset:32
ds_read_b64_tr_b16 v[202:203], v28 offset:288
ds_read_b64_tr_b16 v[204:205], v28 offset:2080
ds_read_b64_tr_b16 v[206:207], v28 offset:2336
s_waitcnt lgkmcnt(0)
s_add_u32 s56, s54, 1572864
s_mov_b32 m0, 94208
s_nop 0
buffer_load_dwordx4 v26, s[16:19], s56 offen lds
s_add_u32 s56, s54, 1638400
s_mov_b32 m0, 95232
s_nop 0
buffer_load_dwordx4 v26, s[16:19], s56 offen lds
s_add_u32 s56, s54, 1835008
s_mov_b32 m0, 96256
s_nop 0
buffer_load_dwordx4 v26, s[16:19], s56 offen lds
s_add_u32 s56, s54, 1900544
s_mov_b32 m0, 97280
s_nop 0
buffer_load_dwordx4 v26, s[16:19], s56 offen lds
ds_read_b64_tr_b16 v[208:209], v28 offset:4096
ds_read_b64_tr_b16 v[210:211], v28 offset:4352
ds_read_b64_tr_b16 v[212:213], v28 offset:6144
ds_read_b64_tr_b16 v[214:215], v28 offset:6400
ds_read_b64_tr_b16 v[216:217], v28 offset:4128
ds_read_b64_tr_b16 v[218:219], v28 offset:4384
ds_read_b64_tr_b16 v[220:221], v28 offset:6176
ds_read_b64_tr_b16 v[222:223], v28 offset:6432
s_waitcnt lgkmcnt(0)
s_add_u32 s56, s54, 0
s_mov_b32 m0, 57344
s_nop 0
buffer_load_dwordx4 v26, s[16:19], s56 offen lds
s_add_u32 s56, s54, 65536
s_mov_b32 m0, 58368
s_nop 0
buffer_load_dwordx4 v26, s[16:19], s56 offen lds
s_add_u32 s56, s54, 262144
s_mov_b32 m0, 59392
s_nop 0
buffer_load_dwordx4 v26, s[16:19], s56 offen lds
s_add_u32 s56, s54, 327680
s_mov_b32 m0, 60416
s_nop 0
buffer_load_dwordx4 v26, s[16:19], s56 offen lds
s_waitcnt vmcnt(32)
ds_read_b64_tr_b16 v[224:225], v28 offset:8192
ds_read_b64_tr_b16 v[226:227], v28 offset:8448
ds_read_b64_tr_b16 v[228:229], v28 offset:10240
ds_read_b64_tr_b16 v[230:231], v28 offset:10496
ds_read_b64_tr_b16 v[232:233], v28 offset:8224
ds_read_b64_tr_b16 v[234:235], v28 offset:8480
ds_read_b64_tr_b16 v[236:237], v28 offset:10272
ds_read_b64_tr_b16 v[238:239], v28 offset:10528
s_waitcnt lgkmcnt(0)
s_add_u32 s56, s54, 2621440
s_mov_b32 m0, 61440
s_nop 0
buffer_load_dwordx4 v26, s[16:19], s56 offen lds
s_add_u32 s56, s54, 2686976
s_mov_b32 m0, 62464
s_nop 0
buffer_load_dwordx4 v26, s[16:19], s56 offen lds
s_add_u32 s56, s54, 2883584
s_mov_b32 m0, 63488
s_nop 0
buffer_load_dwordx4 v26, s[16:19], s56 offen lds
s_add_u32 s56, s54, 2949120
s_mov_b32 m0, 64512
s_nop 0
buffer_load_dwordx4 v26, s[16:19], s56 offen lds
s_waitcnt vmcnt(32)
ds_read_b64_tr_b16 v[240:241], v28 offset:12288
ds_read_b64_tr_b16 v[242:243], v28 offset:12544
ds_read_b64_tr_b16 v[244:245], v28 offset:14336
ds_read_b64_tr_b16 v[246:247], v28 offset:14592
ds_read_b64_tr_b16 v[248:249], v28 offset:12320
ds_read_b64_tr_b16 v[250:251], v28 offset:12576
ds_read_b64_tr_b16 v[252:253], v28 offset:14368
ds_read_b64_tr_b16 v[254:255], v28 offset:14624
s_waitcnt lgkmcnt(0)
s_add_u32 s56, s54, 3145728
s_mov_b32 m0, 65536
s_nop 0
buffer_load_dwordx4 v26, s[16:19], s56 offen lds
s_add_u32 s56, s54, 3211264
s_mov_b32 m0, 66560
s_nop 0
buffer_load_dwordx4 v26, s[16:19], s56 offen lds
s_add_u32 s56, s54, 3407872
s_mov_b32 m0, 67584
s_nop 0
buffer_load_dwordx4 v26, s[16:19], s56 offen lds
s_add_u32 s56, s54, 3473408
s_mov_b32 m0, 68608
s_nop 0
buffer_load_dwordx4 v26, s[16:19], s56 offen lds
s_waitcnt vmcnt(32)
ds_read_b64_tr_b16 a[0:1], v28 offset:16384
ds_read_b64_tr_b16 a[2:3], v28 offset:16640
ds_read_b64_tr_b16 a[4:5], v28 offset:18432
ds_read_b64_tr_b16 a[6:7], v28 offset:18688
ds_read_b64_tr_b16 a[8:9], v28 offset:16416
ds_read_b64_tr_b16 a[10:11], v28 offset:16672
ds_read_b64_tr_b16 a[12:13], v28 offset:18464
ds_read_b64_tr_b16 a[14:15], v28 offset:18720
s_waitcnt lgkmcnt(0)
s_add_u32 s56, s54, 3670016
s_mov_b32 m0, 69632
s_nop 0
buffer_load_dwordx4 v26, s[16:19], s56 offen lds
s_add_u32 s56, s54, 3735552
s_mov_b32 m0, 70656
s_nop 0
buffer_load_dwordx4 v26, s[16:19], s56 offen lds
s_add_u32 s56, s54, 3932160
s_mov_b32 m0, 71680
s_nop 0
buffer_load_dwordx4 v26, s[16:19], s56 offen lds
s_add_u32 s56, s54, 3997696
s_mov_b32 m0, 72704
s_nop 0
buffer_load_dwordx4 v26, s[16:19], s56 offen lds
s_waitcnt vmcnt(32)
ds_read_b64_tr_b16 a[16:17], v28 offset:20480
ds_read_b64_tr_b16 a[18:19], v28 offset:20736
ds_read_b64_tr_b16 a[20:21], v28 offset:22528
ds_read_b64_tr_b16 a[22:23], v28 offset:22784
ds_read_b64_tr_b16 a[24:25], v28 offset:20512
ds_read_b64_tr_b16 a[26:27], v28 offset:20768
ds_read_b64_tr_b16 a[28:29], v28 offset:22560
ds_read_b64_tr_b16 a[30:31], v28 offset:22816
s_waitcnt lgkmcnt(0)
s_add_u32 s56, s54, 4194304
s_mov_b32 m0, 73728
s_nop 0
buffer_load_dwordx4 v26, s[16:19], s56 offen lds
s_add_u32 s56, s54, 4259840
s_mov_b32 m0, 74752
s_nop 0
buffer_load_dwordx4 v26, s[16:19], s56 offen lds
s_add_u32 s56, s54, 4456448
s_mov_b32 m0, 75776
s_nop 0
buffer_load_dwordx4 v26, s[16:19], s56 offen lds
s_add_u32 s56, s54, 4521984
s_mov_b32 m0, 76800
s_nop 0
buffer_load_dwordx4 v26, s[16:19], s56 offen lds
s_waitcnt vmcnt(32)
ds_read_b64_tr_b16 a[32:33], v28 offset:24576
ds_read_b64_tr_b16 a[34:35], v28 offset:24832
ds_read_b64_tr_b16 a[36:37], v28 offset:26624
ds_read_b64_tr_b16 a[38:39], v28 offset:26880
ds_read_b64_tr_b16 a[40:41], v28 offset:24608
ds_read_b64_tr_b16 a[42:43], v28 offset:24864
ds_read_b64_tr_b16 a[44:45], v28 offset:26656
ds_read_b64_tr_b16 a[46:47], v28 offset:26912
s_waitcnt lgkmcnt(0)
s_add_u32 s56, s55, 73792
s_mov_b32 m0, 77824
s_nop 0
buffer_load_dwordx4 v27, s[20:23], s56 offen lds
s_add_u32 s56, s55, 92224
s_mov_b32 m0, 78848
s_nop 0
buffer_load_dwordx4 v27, s[20:23], s56 offen lds
s_add_u32 s56, s55, 64
s_mov_b32 m0, 79872
s_nop 0
buffer_load_dwordx4 v27, s[20:23], s56 offen lds
s_add_u32 s56, s55, 18496
s_mov_b32 m0, 80896
s_nop 0
buffer_load_dwordx4 v27, s[20:23], s56 offen lds
s_waitcnt vmcnt(32)
ds_read_b64_tr_b16 a[48:49], v28 offset:28672
ds_read_b64_tr_b16 a[50:51], v28 offset:28928
ds_read_b64_tr_b16 a[52:53], v28 offset:30720
ds_read_b64_tr_b16 a[54:55], v28 offset:30976
ds_read_b64_tr_b16 a[56:57], v28 offset:28704
ds_read_b64_tr_b16 a[58:59], v28 offset:28960
ds_read_b64_tr_b16 a[60:61], v28 offset:30752
ds_read_b64_tr_b16 a[62:63], v28 offset:31008
s_waitcnt lgkmcnt(0)
s_add_u32 s56, s55, 74048
s_mov_b32 m0, 81920
s_nop 0
buffer_load_dwordx4 v27, s[20:23], s56 offen lds
s_add_u32 s56, s55, 92480
s_mov_b32 m0, 82944
s_nop 0
buffer_load_dwordx4 v27, s[20:23], s56 offen lds
s_add_u32 s56, s55, 320
s_mov_b32 m0, 83968
s_nop 0
buffer_load_dwordx4 v27, s[20:23], s56 offen lds
s_add_u32 s56, s55, 18752
s_mov_b32 m0, 84992
s_nop 0
buffer_load_dwordx4 v27, s[20:23], s56 offen lds
s_waitcnt vmcnt(32)
ds_read_b64_tr_b16 a[64:65], v28 offset:32768
ds_read_b64_tr_b16 a[66:67], v28 offset:33024
ds_read_b64_tr_b16 a[68:69], v28 offset:34816
ds_read_b64_tr_b16 a[70:71], v28 offset:35072
ds_read_b64_tr_b16 a[72:73], v28 offset:32800
ds_read_b64_tr_b16 a[74:75], v28 offset:33056
ds_read_b64_tr_b16 a[76:77], v28 offset:34848
ds_read_b64_tr_b16 a[78:79], v28 offset:35104
s_waitcnt lgkmcnt(0)
s_add_u32 s56, s55, 74304
s_mov_b32 m0, 86016
s_nop 0
buffer_load_dwordx4 v27, s[20:23], s56 offen lds
s_add_u32 s56, s55, 92736
s_mov_b32 m0, 87040
s_nop 0
buffer_load_dwordx4 v27, s[20:23], s56 offen lds
s_add_u32 s56, s55, 576
s_mov_b32 m0, 88064
s_nop 0
buffer_load_dwordx4 v27, s[20:23], s56 offen lds
s_add_u32 s56, s55, 19008
s_mov_b32 m0, 89088
s_nop 0
buffer_load_dwordx4 v27, s[20:23], s56 offen lds
s_waitcnt vmcnt(32)
ds_read_b64_tr_b16 a[80:81], v28 offset:36864
ds_read_b64_tr_b16 a[82:83], v28 offset:37120
ds_read_b64_tr_b16 a[84:85], v28 offset:38912
ds_read_b64_tr_b16 a[86:87], v28 offset:39168
ds_read_b64_tr_b16 a[88:89], v28 offset:36896
ds_read_b64_tr_b16 a[90:91], v28 offset:37152
ds_read_b64_tr_b16 a[92:93], v28 offset:38944
ds_read_b64_tr_b16 a[94:95], v28 offset:39200
s_waitcnt lgkmcnt(0)
s_add_u32 s56, s55, 74560
s_mov_b32 m0, 90112
s_nop 0
buffer_load_dwordx4 v27, s[20:23], s56 offen lds
s_add_u32 s56, s55, 92992
s_mov_b32 m0, 91136
s_nop 0
buffer_load_dwordx4 v27, s[20:23], s56 offen lds
s_add_u32 s56, s55, 832
s_mov_b32 m0, 92160
s_nop 0
buffer_load_dwordx4 v27, s[20:23], s56 offen lds
s_add_u32 s56, s55, 19264
s_mov_b32 m0, 93184
s_nop 0
buffer_load_dwordx4 v27, s[20:23], s56 offen lds
s_waitcnt vmcnt(32)
ds_read_b64_tr_b16 a[96:97], v28 offset:0
ds_read_b64_tr_b16 a[98:99], v28 offset:256
ds_read_b64_tr_b16 a[100:101], v28 offset:2048
ds_read_b64_tr_b16 a[102:103], v28 offset:2304
ds_read_b64_tr_b16 a[104:105], v28 offset:32
ds_read_b64_tr_b16 a[106:107], v28 offset:288
ds_read_b64_tr_b16 a[108:109], v28 offset:2080
ds_read_b64_tr_b16 a[110:111], v28 offset:2336
s_waitcnt lgkmcnt(0)
s_add_u32 s56, s55, 74816
s_mov_b32 m0, 94208
s_nop 0
buffer_load_dwordx4 v27, s[20:23], s56 offen lds
s_add_u32 s56, s55, 93248
s_mov_b32 m0, 95232
s_nop 0
buffer_load_dwordx4 v27, s[20:23], s56 offen lds
s_add_u32 s56, s55, 1088
s_mov_b32 m0, 96256
s_nop 0
buffer_load_dwordx4 v27, s[20:23], s56 offen lds
s_add_u32 s56, s55, 19520
s_mov_b32 m0, 97280
s_nop 0
buffer_load_dwordx4 v27, s[20:23], s56 offen lds
s_waitcnt vmcnt(32)
ds_read_b64_tr_b16 a[112:113], v28 offset:4096
ds_read_b64_tr_b16 a[114:115], v28 offset:4352
ds_read_b64_tr_b16 a[116:117], v28 offset:6144
ds_read_b64_tr_b16 a[118:119], v28 offset:6400
ds_read_b64_tr_b16 a[120:121], v28 offset:4128
ds_read_b64_tr_b16 a[122:123], v28 offset:4384
ds_read_b64_tr_b16 a[124:125], v28 offset:6176
ds_read_b64_tr_b16 a[126:127], v28 offset:6432
s_waitcnt lgkmcnt(0)
s_add_u32 s56, s54, 524288
s_mov_b32 m0, 57344
s_nop 0
buffer_load_dwordx4 v26, s[8:11], s56 offen lds
s_add_u32 s56, s54, 589824
s_mov_b32 m0, 58368
s_nop 0
buffer_load_dwordx4 v26, s[8:11], s56 offen lds
s_add_u32 s56, s54, 786432
s_mov_b32 m0, 59392
s_nop 0
buffer_load_dwordx4 v26, s[8:11], s56 offen lds
s_add_u32 s56, s54, 851968
s_mov_b32 m0, 60416
s_nop 0
buffer_load_dwordx4 v26, s[8:11], s56 offen lds
s_waitcnt vmcnt(32)
ds_read_b64_tr_b16 a[128:129], v28 offset:8192
ds_read_b64_tr_b16 a[130:131], v28 offset:8448
ds_read_b64_tr_b16 a[132:133], v28 offset:10240
ds_read_b64_tr_b16 a[134:135], v28 offset:10496
ds_read_b64_tr_b16 a[136:137], v28 offset:8224
ds_read_b64_tr_b16 a[138:139], v28 offset:8480
ds_read_b64_tr_b16 a[140:141], v28 offset:10272
ds_read_b64_tr_b16 a[142:143], v28 offset:10528
s_waitcnt lgkmcnt(0)
s_add_u32 s56, s54, 1572864
s_mov_b32 m0, 61440
s_nop 0
buffer_load_dwordx4 v26, s[8:11], s56 offen lds
s_add_u32 s56, s54, 1638400
s_mov_b32 m0, 62464
s_nop 0
buffer_load_dwordx4 v26, s[8:11], s56 offen lds
s_add_u32 s56, s54, 1835008
s_mov_b32 m0, 63488
s_nop 0
buffer_load_dwordx4 v26, s[8:11], s56 offen lds
s_add_u32 s56, s54, 1900544
s_mov_b32 m0, 64512
s_nop 0
buffer_load_dwordx4 v26, s[8:11], s56 offen lds
s_waitcnt vmcnt(32)
ds_read_b64_tr_b16 a[144:145], v28 offset:12288
ds_read_b64_tr_b16 a[146:147], v28 offset:12544
ds_read_b64_tr_b16 a[148:149], v28 offset:14336
ds_read_b64_tr_b16 a[150:151], v28 offset:14592
ds_read_b64_tr_b16 a[152:153], v28 offset:12320
ds_read_b64_tr_b16 a[154:155], v28 offset:12576
ds_read_b64_tr_b16 a[156:157], v28 offset:14368
ds_read_b64_tr_b16 a[158:159], v28 offset:14624
s_waitcnt lgkmcnt(0)
s_add_u32 s56, s54, 2621440
s_mov_b32 m0, 65536
s_nop 0
buffer_load_dwordx4 v26, s[8:11], s56 offen lds
s_add_u32 s56, s54, 2686976
s_mov_b32 m0, 66560
s_nop 0
buffer_load_dwordx4 v26, s[8:11], s56 offen lds
s_add_u32 s56, s54, 2883584
s_mov_b32 m0, 67584
s_nop 0
buffer_load_dwordx4 v26, s[8:11], s56 offen lds
s_add_u32 s56, s54, 2949120
s_mov_b32 m0, 68608
s_nop 0
buffer_load_dwordx4 v26, s[8:11], s56 offen lds
s_waitcnt vmcnt(32)
ds_read_b64_tr_b16 a[160:161], v28 offset:16384
ds_read_b64_tr_b16 a[162:163], v28 offset:16640
ds_read_b64_tr_b16 a[164:165], v28 offset:18432
ds_read_b64_tr_b16 a[166:167], v28 offset:18688
ds_read_b64_tr_b16 a[168:169], v28 offset:16416
ds_read_b64_tr_b16 a[170:171], v28 offset:16672
ds_read_b64_tr_b16 a[172:173], v28 offset:18464
ds_read_b64_tr_b16 a[174:175], v28 offset:18720
s_waitcnt lgkmcnt(0)
s_add_u32 s56, s54, 3145728
s_mov_b32 m0, 69632
s_nop 0
buffer_load_dwordx4 v26, s[12:15], s56 offen lds
s_add_u32 s56, s54, 3211264
s_mov_b32 m0, 70656
s_nop 0
buffer_load_dwordx4 v26, s[12:15], s56 offen lds
s_add_u32 s56, s54, 3407872
s_mov_b32 m0, 71680
s_nop 0
buffer_load_dwordx4 v26, s[12:15], s56 offen lds
s_add_u32 s56, s54, 3473408
s_mov_b32 m0, 72704
s_nop 0
buffer_load_dwordx4 v26, s[12:15], s56 offen lds
s_waitcnt vmcnt(32)
ds_read_b64_tr_b16 a[176:177], v29 offset:20480
ds_read_b64_tr_b16 a[178:179], v29 offset:20608
ds_read_b64_tr_b16 a[180:181], v29 offset:20992
ds_read_b64_tr_b16 a[182:183], v29 offset:21120
ds_read_b64_tr_b16 a[184:185], v29 offset:22528
ds_read_b64_tr_b16 a[186:187], v29 offset:22656
ds_read_b64_tr_b16 a[188:189], v29 offset:23040
ds_read_b64_tr_b16 a[190:191], v29 offset:23168
s_waitcnt lgkmcnt(0)
s_add_u32 s56, s54, 2097152
s_mov_b32 m0, 73728
s_nop 0
buffer_load_dwordx4 v26, s[16:19], s56 offen lds
s_add_u32 s56, s54, 2162688
s_mov_b32 m0, 74752
s_nop 0
buffer_load_dwordx4 v26, s[16:19], s56 offen lds
s_add_u32 s56, s54, 2359296
s_mov_b32 m0, 75776
s_nop 0
buffer_load_dwordx4 v26, s[16:19], s56 offen lds
s_add_u32 s56, s54, 2424832
s_mov_b32 m0, 76800
s_nop 0
buffer_load_dwordx4 v26, s[16:19], s56 offen lds
s_waitcnt vmcnt(32)
ds_read_b64_tr_b16 a[192:193], v29 offset:24576
ds_read_b64_tr_b16 a[194:195], v29 offset:24704
ds_read_b64_tr_b16 a[196:197], v29 offset:25088
ds_read_b64_tr_b16 a[198:199], v29 offset:25216
ds_read_b64_tr_b16 a[200:201], v29 offset:26624
ds_read_b64_tr_b16 a[202:203], v29 offset:26752
ds_read_b64_tr_b16 a[204:205], v29 offset:27136
ds_read_b64_tr_b16 a[206:207], v29 offset:27264
s_waitcnt lgkmcnt(0)
s_add_u32 s56, s55, 36928
s_mov_b32 m0, 77824
s_nop 0
buffer_load_dwordx4 v27, s[20:23], s56 offen lds
s_add_u32 s56, s55, 55360
s_mov_b32 m0, 78848
s_nop 0
buffer_load_dwordx4 v27, s[20:23], s56 offen lds
s_add_u32 s56, s55, 37184
s_mov_b32 m0, 79872
s_nop 0
buffer_load_dwordx4 v27, s[20:23], s56 offen lds
s_add_u32 s56, s55, 55616
s_mov_b32 m0, 80896
s_nop 0
buffer_load_dwordx4 v27, s[20:23], s56 offen lds
s_waitcnt vmcnt(32)
ds_read_b64_tr_b16 a[208:209], v29 offset:28672
ds_read_b64_tr_b16 a[210:211], v29 offset:28800
ds_read_b64_tr_b16 a[212:213], v29 offset:29184
ds_read_b64_tr_b16 a[214:215], v29 offset:29312
ds_read_b64_tr_b16 a[216:217], v29 offset:30720
ds_read_b64_tr_b16 a[218:219], v29 offset:30848
ds_read_b64_tr_b16 a[220:221], v29 offset:31232
ds_read_b64_tr_b16 a[222:223], v29 offset:31360
s_waitcnt lgkmcnt(0)
s_add_u32 s56, s55, 110656
s_mov_b32 m0, 81920
s_nop 0
buffer_load_dwordx4 v27, s[20:23], s56 offen lds
s_add_u32 s56, s55, 129088
s_mov_b32 m0, 82944
s_nop 0
buffer_load_dwordx4 v27, s[20:23], s56 offen lds
s_add_u32 s56, s55, 110912
s_mov_b32 m0, 83968
s_nop 0
buffer_load_dwordx4 v27, s[20:23], s56 offen lds
s_add_u32 s56, s55, 129344
s_mov_b32 m0, 84992
s_nop 0
buffer_load_dwordx4 v27, s[20:23], s56 offen lds
s_waitcnt vmcnt(32)
ds_read_b64_tr_b16 a[224:225], v29 offset:32768
ds_read_b64_tr_b16 a[226:227], v29 offset:32896
ds_read_b64_tr_b16 a[228:229], v29 offset:33280
ds_read_b64_tr_b16 a[230:231], v29 offset:33408
ds_read_b64_tr_b16 a[232:233], v29 offset:34816
ds_read_b64_tr_b16 a[234:235], v29 offset:34944
ds_read_b64_tr_b16 a[236:237], v29 offset:35328
ds_read_b64_tr_b16 a[238:239], v29 offset:35456
s_waitcnt lgkmcnt(0)
s_add_u32 s56, s55, 37440
s_mov_b32 m0, 86016
s_nop 0
buffer_load_dwordx4 v27, s[20:23], s56 offen lds
s_add_u32 s56, s55, 55872
s_mov_b32 m0, 87040
s_nop 0
buffer_load_dwordx4 v27, s[20:23], s56 offen lds
s_add_u32 s56, s55, 111168
s_mov_b32 m0, 88064
s_nop 0
buffer_load_dwordx4 v27, s[20:23], s56 offen lds
s_add_u32 s56, s55, 129600
s_mov_b32 m0, 89088
s_nop 0
buffer_load_dwordx4 v27, s[20:23], s56 offen lds
s_waitcnt vmcnt(32)
ds_read_b64_tr_b16 a[240:241], v29 offset:36864
ds_read_b64_tr_b16 a[242:243], v29 offset:36992
ds_read_b64_tr_b16 a[244:245], v29 offset:37376
ds_read_b64_tr_b16 a[246:247], v29 offset:37504
ds_read_b64_tr_b16 a[248:249], v29 offset:38912
ds_read_b64_tr_b16 a[250:251], v29 offset:39040
ds_read_b64_tr_b16 a[252:253], v29 offset:39424
ds_read_b64_tr_b16 a[254:255], v29 offset:39552
s_waitcnt lgkmcnt(0)
s_add_u32 s56, s55, 37696
s_mov_b32 m0, 90112
s_nop 0
buffer_load_dwordx4 v27, s[20:23], s56 offen lds
s_add_u32 s56, s55, 56128
s_mov_b32 m0, 91136
s_nop 0
buffer_load_dwordx4 v27, s[20:23], s56 offen lds
s_add_u32 s56, s55, 111424
s_mov_b32 m0, 92160
s_nop 0
buffer_load_dwordx4 v27, s[20:23], s56 offen lds
s_add_u32 s56, s55, 129856
s_mov_b32 m0, 93184
s_nop 0
buffer_load_dwordx4 v27, s[20:23], s56 offen lds
s_waitcnt vmcnt(32)
ds_read_b64_tr_b16 v[44:45], v28 offset:0
ds_read_b64_tr_b16 v[46:47], v28 offset:256
ds_read_b64_tr_b16 v[48:49], v28 offset:2048
ds_read_b64_tr_b16 v[50:51], v28 offset:2304
ds_read_b64_tr_b16 v[52:53], v28 offset:32
ds_read_b64_tr_b16 v[54:55], v28 offset:288
ds_read_b64_tr_b16 v[56:57], v28 offset:2080
ds_read_b64_tr_b16 v[58:59], v28 offset:2336
s_waitcnt lgkmcnt(0)
ds_write_b128 v2, v[44:47] offset:0
ds_write_b128 v2, v[48:51] offset:1024
ds_write_b128 v2, v[52:55] offset:2048
ds_write_b128 v2, v[56:59] offset:3072
s_waitcnt lgkmcnt(0)
s_add_u32 s56, s55, 37952
s_mov_b32 m0, 94208
s_nop 0
buffer_load_dwordx4 v27, s[20:23], s56 offen lds
s_add_u32 s56, s55, 56384
s_mov_b32 m0, 95232
s_nop 0
buffer_load_dwordx4 v27, s[20:23], s56 offen lds
s_add_u32 s56, s55, 111680
s_mov_b32 m0, 96256
s_nop 0
buffer_load_dwordx4 v27, s[20:23], s56 offen lds
s_add_u32 s56, s55, 130112
s_mov_b32 m0, 97280
s_nop 0
buffer_load_dwordx4 v27, s[20:23], s56 offen lds
s_waitcnt vmcnt(32)
ds_read_b64_tr_b16 v[44:45], v28 offset:4096
ds_read_b64_tr_b16 v[46:47], v28 offset:4352
ds_read_b64_tr_b16 v[48:49], v28 offset:6144
ds_read_b64_tr_b16 v[50:51], v28 offset:6400
ds_read_b64_tr_b16 v[52:53], v28 offset:4128
ds_read_b64_tr_b16 v[54:55], v28 offset:4384
ds_read_b64_tr_b16 v[56:57], v28 offset:6176
ds_read_b64_tr_b16 v[58:59], v28 offset:6432
s_waitcnt lgkmcnt(0)
ds_write_b128 v2, v[44:47] offset:4096
ds_write_b128 v2, v[48:51] offset:5120
ds_write_b128 v2, v[52:55] offset:6144
ds_write_b128 v2, v[56:59] offset:7168
s_waitcnt lgkmcnt(0)
s_waitcnt vmcnt(28)
ds_read_b64_tr_b16 v[44:45], v28 offset:8192
ds_read_b64_tr_b16 v[46:47], v28 offset:8448
ds_read_b64_tr_b16 v[48:49], v28 offset:10240
ds_read_b64_tr_b16 v[50:51], v28 offset:10496
ds_read_b64_tr_b16 v[52:53], v28 offset:8224
ds_read_b64_tr_b16 v[54:55], v28 offset:8480
ds_read_b64_tr_b16 v[56:57], v28 offset:10272
ds_read_b64_tr_b16 v[58:59], v28 offset:10528
s_waitcnt lgkmcnt(0)
ds_write_b128 v2, v[44:47] offset:8192
ds_write_b128 v2, v[48:51] offset:9216
ds_write_b128 v2, v[52:55] offset:10240
ds_write_b128 v2, v[56:59] offset:11264
s_waitcnt lgkmcnt(0)
s_waitcnt vmcnt(24)
ds_read_b64_tr_b16 v[44:45], v28 offset:12288
ds_read_b64_tr_b16 v[46:47], v28 offset:12544
ds_read_b64_tr_b16 v[48:49], v28 offset:14336
ds_read_b64_tr_b16 v[50:51], v28 offset:14592
ds_read_b64_tr_b16 v[52:53], v28 offset:12320
ds_read_b64_tr_b16 v[54:55], v28 offset:12576
ds_read_b64_tr_b16 v[56:57], v28 offset:14368
ds_read_b64_tr_b16 v[58:59], v28 offset:14624
s_waitcnt lgkmcnt(0)
ds_write_b128 v2, v[44:47] offset:12288
ds_write_b128 v2, v[48:51] offset:13312
ds_write_b128 v2, v[52:55] offset:14336
ds_write_b128 v2, v[56:59] offset:15360
s_waitcnt lgkmcnt(0)
s_waitcnt vmcnt(20)
ds_read_b64_tr_b16 v[44:45], v28 offset:16384
ds_read_b64_tr_b16 v[46:47], v28 offset:16640
ds_read_b64_tr_b16 v[48:49], v28 offset:18432
ds_read_b64_tr_b16 v[50:51], v28 offset:18688
ds_read_b64_tr_b16 v[52:53], v28 offset:16416
ds_read_b64_tr_b16 v[54:55], v28 offset:16672
ds_read_b64_tr_b16 v[56:57], v28 offset:18464
ds_read_b64_tr_b16 v[58:59], v28 offset:18720
s_waitcnt lgkmcnt(0)
ds_write_b128 v2, v[44:47] offset:16384
ds_write_b128 v2, v[48:51] offset:17408
ds_write_b128 v2, v[52:55] offset:18432
ds_write_b128 v2, v[56:59] offset:19456
s_waitcnt lgkmcnt(0)
s_waitcnt vmcnt(16)
ds_read_b64_tr_b16 v[44:45], v29 offset:20480
ds_read_b64_tr_b16 v[46:47], v29 offset:20608
ds_read_b64_tr_b16 v[48:49], v29 offset:20992
ds_read_b64_tr_b16 v[50:51], v29 offset:21120
ds_read_b64_tr_b16 v[52:53], v29 offset:22528
ds_read_b64_tr_b16 v[54:55], v29 offset:22656
ds_read_b64_tr_b16 v[56:57], v29 offset:23040
ds_read_b64_tr_b16 v[58:59], v29 offset:23168
s_waitcnt lgkmcnt(0)
ds_write_b128 v2, v[44:47] offset:20480
ds_write_b128 v2, v[48:51] offset:21504
ds_write_b128 v2, v[52:55] offset:22528
ds_write_b128 v2, v[56:59] offset:23552
s_waitcnt lgkmcnt(0)
s_waitcnt vmcnt(12)
ds_read_b64_tr_b16 v[44:45], v29 offset:24576
ds_read_b64_tr_b16 v[46:47], v29 offset:24704
ds_read_b64_tr_b16 v[48:49], v29 offset:25088
ds_read_b64_tr_b16 v[50:51], v29 offset:25216
ds_read_b64_tr_b16 v[52:53], v29 offset:26624
ds_read_b64_tr_b16 v[54:55], v29 offset:26752
ds_read_b64_tr_b16 v[56:57], v29 offset:27136
ds_read_b64_tr_b16 v[58:59], v29 offset:27264
s_waitcnt lgkmcnt(0)
ds_write_b128 v2, v[44:47] offset:24576
ds_write_b128 v2, v[48:51] offset:25600
ds_write_b128 v2, v[52:55] offset:26624
ds_write_b128 v2, v[56:59] offset:27648
s_waitcnt lgkmcnt(0)
s_waitcnt vmcnt(8)
ds_read_b64_tr_b16 v[44:45], v29 offset:28672
ds_read_b64_tr_b16 v[46:47], v29 offset:28800
ds_read_b64_tr_b16 v[48:49], v29 offset:29184
ds_read_b64_tr_b16 v[50:51], v29 offset:29312
ds_read_b64_tr_b16 v[52:53], v29 offset:30720
ds_read_b64_tr_b16 v[54:55], v29 offset:30848
ds_read_b64_tr_b16 v[56:57], v29 offset:31232
ds_read_b64_tr_b16 v[58:59], v29 offset:31360
s_waitcnt lgkmcnt(0)
ds_write_b128 v2, v[44:47] offset:28672
ds_write_b128 v2, v[48:51] offset:29696
ds_write_b128 v2, v[52:55] offset:30720
ds_write_b128 v2, v[56:59] offset:31744
s_waitcnt lgkmcnt(0)
s_waitcnt vmcnt(4)
ds_read_b64_tr_b16 v[44:45], v29 offset:32768
ds_read_b64_tr_b16 v[46:47], v29 offset:32896
ds_read_b64_tr_b16 v[48:49], v29 offset:33280
ds_read_b64_tr_b16 v[50:51], v29 offset:33408
ds_read_b64_tr_b16 v[52:53], v29 offset:34816
ds_read_b64_tr_b16 v[54:55], v29 offset:34944
ds_read_b64_tr_b16 v[56:57], v29 offset:35328
ds_read_b64_tr_b16 v[58:59], v29 offset:35456
s_waitcnt lgkmcnt(0)
ds_write_b128 v2, v[44:47] offset:32768
ds_write_b128 v2, v[48:51] offset:33792
ds_write_b128 v2, v[52:55] offset:34816
ds_write_b128 v2, v[56:59] offset:35840
s_waitcnt lgkmcnt(0)
s_waitcnt vmcnt(0)
ds_read_b64_tr_b16 v[44:45], v29 offset:36864
ds_read_b64_tr_b16 v[46:47], v29 offset:36992
ds_read_b64_tr_b16 v[48:49], v29 offset:37376
ds_read_b64_tr_b16 v[50:51], v29 offset:37504
ds_read_b64_tr_b16 v[52:53], v29 offset:38912
ds_read_b64_tr_b16 v[54:55], v29 offset:39040
ds_read_b64_tr_b16 v[56:57], v29 offset:39424
ds_read_b64_tr_b16 v[58:59], v29 offset:39552
s_waitcnt lgkmcnt(0)
ds_write_b128 v2, v[44:47] offset:36864
ds_write_b128 v2, v[48:51] offset:37888
ds_write_b128 v2, v[52:55] offset:38912
ds_write_b128 v2, v[56:59] offset:39936
s_waitcnt lgkmcnt(0)
v_mov_b32 v24, 0
L_rdv_w1:
buffer_load_dword v23, v24, s[28:31], 0 offen sc0 sc1
s_sub_u32 s41, s41, 1
s_cbranch_scc1 L_exit
s_waitcnt vmcnt(0)
v_readfirstlane_b32 s56, v23
s_nop 0
s_and_b32 s57, s56, 0xff
s_cmp_lg_u32 s57, 32
s_cbranch_scc1 L_rdv_w1
s_lshl_b32 s55, s32, 2
v_mov_b32 v24, 0
L_kvw_w1p:
buffer_load_dword v23, v24, s[28:31], s55 offen offset:128 sc0 sc1
s_sub_u32 s41, s41, 1
s_cbranch_scc1 L_exit
s_waitcnt vmcnt(0)
v_readfirstlane_b32 s54, v23
s_nop 0
s_and_b32 s54, s54, 255
s_cmp_lg_u32 s54, 4
s_cbranch_scc1 L_kvw_w1p
s_mov_b32 m0, 0
s_lshl_b32 s101, s32, 7
s_add_u32 s101, s101, 327680
s_mov_b32 s100, 22
s_lshl_b32 s58, s58, 5
s_cmp_eq_u32 s56, s58
s_cbranch_scc0 L_slow_w1
buffer_load_dwordx4 v[12:15], v9, s[4:7], s37 offen offset:0
buffer_load_dwordx4 v[16:19], v9, s[4:7], s37 offen offset:1024
buffer_load_dwordx4 v[52:55], v1, s[4:7], s37 offen offset:2048
buffer_load_dwordx4 v[56:59], v1, s[4:7], s37 offen offset:3072
v_mov_b64 v[20:21], 0
v_mov_b64 v[22:23], 0
v_mov_b64 v[24:25], 0
v_mov_b64 v[26:27], 0
v_mov_b64 v[28:29], 0
v_mov_b64 v[30:31], 0
v_mov_b64 v[32:33], 0
v_mov_b64 v[34:35], 0
v_mov_b64 v[36:37], 0
v_mov_b64 v[38:39], 0
v_mov_b64 v[40:41], 0
v_mov_b64 v[42:43], 0
v_lshrrev_b32 v6, 2, v1
ds_read_b128 v[44:47], v2 offset:0
ds_read_b128 v[48:51], v2 offset:1024
s_waitcnt vmcnt(0)
buffer_load_dwordx4 v[60:63], v1, s[4:7], s47 offen sc1
buffer_load_dwordx4 v[68:71], v1, s[4:7], s38 offen sc1
s_waitcnt vmcnt(0)
.p2align 6
L_top_w1f:
s_waitcnt vmcnt(1)
L_a0_w1f:
s_waitcnt lgkmcnt(0)
v_smfmac_f32_16x16x64_bf16 v[20:23], v[60:63], v[44:51], v0
ds_write_b128 v1, v[60:63] offset:2048
v_smfmac_f32_16x16x64_bf16 v[28:31], v[60:63], v[176:183], v0
ds_read_b128 v[44:47], v2 offset:2048
buffer_load_dwordx4 v[64:67], v1, s[4:7], s48 offen sc1
v_smfmac_f32_16x16x64_bf16 v[32:35], v[60:63], v[184:191], v0
ds_read_b128 v[48:51], v2 offset:3072
buffer_load_dword v76, v6, s[4:7], s49 offen sc1
v_smfmac_f32_16x16x64_bf16 v[36:39], v[60:63], a[48:55], v0
s_waitcnt vmcnt(2)
v_bitop3_b32 v77, v60, v68, s35 bitop3:0x7e
v_smfmac_f32_16x16x64_bf16 v[40:43], v[60:63], a[56:63], v0
v_and_b32 v77, 1, v77
v_smfmac_f32_16x16x64_bf16 v[20:23], v[68:71], v[80:87], v0
v_cmp_ne_u32 vcc, 0, v77
s_waitcnt lgkmcnt(0)
v_smfmac_f32_16x16x64_bf16 v[24:27], v[60:63], v[44:51], v0
ds_read_b128 v[44:47], v2 offset:4096
v_smfmac_f32_16x16x64_bf16 v[24:27], v[68:71], v[88:95], v0
s_cbranch_vccnz L_ra0_w1f
s_barrier
ds_read_b128 v[72:75], v1 offset:4096
v_smfmac_f32_16x16x64_bf16 v[28:31], v[68:71], v[192:199], v0
ds_read_b128 v[48:51], v2 offset:5120
v_smfmac_f32_16x16x64_bf16 v[32:35], v[68:71], v[200:207], v0
ds_read_b128 v[60:63], v1 offset:1024
v_smfmac_f32_16x16x64_bf16 v[36:39], v[68:71], a[64:71], v0
v_smfmac_f32_16x16x64_bf16 v[40:43], v[68:71], a[72:79], v0
s_waitcnt lgkmcnt(2)
s_waitcnt lgkmcnt(1)
v_smfmac_f32_16x16x64_bf16 v[20:23], v[72:75], v[44:51], v0
ds_read_b128 v[44:47], v2 offset:6144
v_smfmac_f32_16x16x64_bf16 v[28:31], v[72:75], v[208:215], v0
ds_read_b128 v[48:51], v2 offset:7168
v_smfmac_f32_16x16x64_bf16 v[32:35], v[72:75], v[216:223], v0
s_waitcnt vmcnt(0)
ds_write_b128 v1, v[64:67] offset:6144
v_smfmac_f32_16x16x64_bf16 v[36:39], v[72:75], a[80:87], v0
ds_write_addtid_b32 v76 offset:9472
v_bitop3_b32 v77, v64, s35, 1 bitop3:0x28
v_smfmac_f32_16x16x64_bf16 v[40:43], v[72:75], a[88:95], v0
v_bitop3_b32 v78, v76, s35, v11 bitop3:0x28
s_waitcnt lgkmcnt(2)
v_smfmac_f32_16x16x64_bf16 v[24:27], v[72:75], v[44:51], v0
ds_read_b128 v[44:47], v2 offset:8192
v_or_b32 v77, v77, v78
v_smfmac_f32_16x16x64_bf16 v[20:23], v[60:63], v[96:103], v0
ds_read_b128 v[48:51], v2 offset:9216
v_cmp_ne_u32 vcc, 0, v77
v_smfmac_f32_16x16x64_bf16 v[24:27], v[60:63], v[104:111], v0
v_smfmac_f32_16x16x64_bf16 v[36:39], v[60:63], a[96:103], v0
s_cbranch_vccnz L_ra1_w1f
L_a1_w1f:
s_waitcnt lgkmcnt(2)
s_barrier
ds_read_b128 v[68:71], v1 offset:7168
v_smfmac_f32_16x16x64_bf16 v[28:31], v[60:63], v[224:231], v0
ds_read_b128 v[72:75], v1 offset:8192
v_lshlrev_b32 v6, 2, v1
v_smfmac_f32_16x16x64_bf16 v[40:43], v[60:63], a[104:111], v0
ds_read_b128 v[76:79], v1 offset:9216
v_smfmac_f32_16x16x64_bf16 v[32:35], v[60:63], v[232:239], v0
ds_read_b128 v[60:63], v1 offset:5120
s_waitcnt lgkmcnt(4)
v_smfmac_f32_16x16x64_bf16 v[20:23], v[64:67], v[44:51], v0
ds_read_b128 v[44:47], v2 offset:10240
buffer_load_dword v6, s[4:7], s39 offen lds
s_waitcnt lgkmcnt(4)
v_smfmac_f32_16x16x64_bf16 v[20:23], v[68:71], v[112:119], v0
ds_read_b128 v[48:51], v2 offset:11264
v_smfmac_f32_16x16x64_bf16 v[24:27], v[68:71], v[120:127], v0
s_waitcnt lgkmcnt(4)
v_smfmac_f32_16x16x64_bf16 v[20:23], v[72:75], v[128:135], v0
s_waitcnt lgkmcnt(3)
v_smfmac_f32_16x16x64_bf16 v[20:23], v[76:79], v[160:167], v0
s_waitcnt lgkmcnt(2)
v_smfmac_f32_16x16x64_bf16 v[20:23], v[60:63], v[144:151], v0
s_waitcnt lgkmcnt(0)
v_smfmac_f32_16x16x64_bf16 v[24:27], v[64:67], v[44:51], v0
ds_read_b128 v[44:47], v2 offset:12288
v_smfmac_f32_16x16x64_bf16 v[24:27], v[72:75], v[136:143], v0
ds_read_b128 v[48:51], v2 offset:13312
v_add_f32 v20, v20, v22
v_smfmac_f32_16x16x64_bf16 v[24:27], v[76:79], v[168:175], v0
v_add_f32 v21, v21, v23
v_smfmac_f32_16x16x64_bf16 v[24:27], v[60:63], v[152:159], v0
v_cvt_pk_bf16_f32 v22, v20, v21
v_smfmac_f32_16x16x64_bf16 v[28:31], v[64:67], v[240:247], v0
v_smfmac_f32_16x16x64_bf16 v[28:31], v[72:75], a[0:7], v0
v_add_f32 v24, v24, v26
v_add_f32 v25, v25, v27
v_cvt_pk_bf16_f32 v23, v24, v25
s_waitcnt lgkmcnt(0)
v_smfmac_f32_16x16x64_bf16 v[28:31], v[68:71], v[44:51], v0
ds_write_b64 v3, v[22:23] offset:10752
v_smfmac_f32_16x16x64_bf16 v[28:31], v[76:79], a[32:39], v0
ds_read_b128 v[44:47], v2 offset:14336
v_smfmac_f32_16x16x64_bf16 v[28:31], v[60:63], a[16:23], v0
ds_read_b128 v[48:51], v2 offset:15360
v_smfmac_f32_16x16x64_bf16 v[32:35], v[64:67], v[248:255], v0
s_waitcnt lgkmcnt(2)
s_barrier
ds_read_b64_tr_b16 v[20:21], v4 offset:10240
ds_read_b64_tr_b16 v[22:23], v4 offset:10752
v_smfmac_f32_16x16x64_bf16 v[32:35], v[72:75], a[8:15], v0
ds_read_b64_tr_b16 v[24:25], v4 offset:11264
v_add_f32 v28, v28, v30
v_smfmac_f32_16x16x64_bf16 v[32:35], v[76:79], a[40:47], v0
ds_read_b64_tr_b16 v[26:27], v4 offset:11776
v_add_f32 v29, v29, v31
s_waitcnt lgkmcnt(4)
v_smfmac_f32_16x16x64_bf16 v[32:35], v[68:71], v[44:51], v0
ds_read_b128 v[44:47], v2 offset:18432
v_cvt_pk_bf16_f32 v30, v28, v29
v_smfmac_f32_16x16x64_bf16 v[32:35], v[60:63], a[24:31], v0
ds_read_b128 v[48:51], v2 offset:19456
s_waitcnt lgkmcnt(4)
v_mfma_f32_16x16x32_bf16 v[12:15], v[12:15], v[20:23], 0
s_waitcnt lgkmcnt(2)
v_mfma_f32_16x16x32_bf16 v[12:15], v[16:19], v[24:27], v[12:15]
v_add_f32 v32, v32, v34
v_add_f32 v33, v33, v35
v_cvt_pk_bf16_f32 v31, v32, v33
ds_write_b64 v3, v[30:31] offset:12800
v_smfmac_f32_16x16x64_bf16 v[36:39], v[64:67], a[112:119], v0
s_nop 2
v_add_f32_dpp v12, v14, v12 quad_perm:[2,3,0,1] row_mask:0xf bank_mask:0xf
v_add_f32_dpp v13, v15, v13 quad_perm:[2,3,0,1] row_mask:0xf bank_mask:0xf
ds_write_b64 v5, v[12:13] offset:14592
v_smfmac_f32_16x16x64_bf16 v[40:43], v[64:67], a[120:127], v0
s_waitcnt lgkmcnt(1)
s_barrier
ds_read_b64_tr_b16 v[64:65], v4 offset:12288
ds_read_b64_tr_b16 v[66:67], v4 offset:12800
v_smfmac_f32_16x16x64_bf16 v[36:39], v[68:71], a[128:135], v0
ds_read_b64_tr_b16 v[16:17], v4 offset:13312
ds_read_b64_tr_b16 v[18:19], v4 offset:13824
v_smfmac_f32_16x16x64_bf16 v[40:43], v[68:71], a[136:143], v0
s_waitcnt lgkmcnt(4)
s_barrier
ds_read_b128 v[68:71], v1 offset:14336
v_smfmac_f32_16x16x64_bf16 v[40:43], v[60:63], v[44:51], v0
ds_read_b128 v[44:47], v2 offset:16384
s_waitcnt lgkmcnt(4)
v_mfma_f32_16x16x32_bf16 v[64:67], v[64:67], v[20:23], 0
ds_read_b128 v[48:51], v2 offset:17408
s_waitcnt lgkmcnt(3)
v_mfma_f32_16x16x32_bf16 v[64:67], v[16:19], v[24:27], v[64:67]
v_smfmac_f32_16x16x64_bf16 v[40:43], v[72:75], a[152:159], v0
ds_read_b128 v[12:15], v2 offset:22528
s_waitcnt lgkmcnt(3)
v_max3_f32 v25, v68, v69, v70
v_smfmac_f32_16x16x64_bf16 v[40:43], v[76:79], a[168:175], v0
ds_read_b128 v[16:19], v2 offset:23552
v_add_f32_dpp v64, v66, v64 quad_perm:[2,3,0,1] row_mask:0xf bank_mask:0xf
v_add_f32_dpp v65, v67, v65 quad_perm:[2,3,0,1] row_mask:0xf bank_mask:0xf
v_max_f32 v25, v25, v71
v_max_f32 v24, v64, v65
v_mul_f32 v24, s50, v24
v_max_f32_dpp v25, v25, v25 quad_perm:[2,3,0,1] row_mask:0xf bank_mask:0xf
v_smfmac_f32_16x16x64_bf16 v[36:39], v[72:75], a[144:151], v0
s_nop 0
v_max_f32_dpp v26, v24, v25 quad_perm:[0,1,0,1] row_mask:0xf bank_mask:0xf
v_max_f32_dpp v27, v24, v25 quad_perm:[0,1,0,1] row_mask:0xf bank_mask:0xf
v_smfmac_f32_16x16x64_bf16 v[36:39], v[76:79], a[160:167], v0
s_nop 0
v_permlane16_swap_b32 v26, v27
v_max_f32 v28, v26, v27
v_max_f32 v29, v26, v27
s_waitcnt lgkmcnt(2)
v_smfmac_f32_16x16x64_bf16 v[36:39], v[60:63], v[44:51], v0
v_permlane32_swap_b32 v28, v29
v_max_f32 v28, v28, v29
v_sub_f32 v68, v68, v28
v_sub_f32 v69, v69, v28
v_sub_f32 v70, v70, v28
v_sub_f32 v71, v71, v28
v_exp_f32 v68, v68
v_exp_f32 v69, v69
v_exp_f32 v70, v70
v_exp_f32 v71, v71
v_cvt_pk_bf16_f32 v20, v68, v69
v_cvt_pk_bf16_f32 v21, v70, v71
v_pk_add_f32 v[36:37], v[36:37], v[38:39]
v_mov_b32_dpp v22, v20 quad_perm:[2,3,0,1] row_mask:0xf bank_mask:0xf
v_mov_b32_dpp v23, v21 quad_perm:[2,3,0,1] row_mask:0xf bank_mask:0xf
v_pk_fma_f32 v[64:65], v[64:65], s[50:51], v[28:29] op_sel_hi:[1,1,0] neg_lo:[0,0,1] neg_hi:[0,0,1]
v_cvt_pk_bf16_f32 v32, v36, v37
v_pk_add_f32 v[40:41], v[40:41], v[42:43]
v_mfma_f32_16x16x32_bf16 v[36:39], v[52:55], v[20:23], 0
v_mov_b64 v[72:73], s[52:53]
v_mov_b64 v[74:75], s[52:53]
v_cvt_pk_bf16_f32 v33, v40, v41
v_exp_f32 v64, v64
v_mfma_f32_16x16x32_bf16 v[68:71], v[72:75], v[20:23], 0
v_exp_f32 v65, v65
v_mov_b32 v25, 0
v_cvt_pk_bf16_f32 v24, v64, v65
v_mfma_f32_16x16x32_bf16 v[40:43], v[56:59], v[20:23], 0
v_cvt_pk_bf16_f32 v27, v64, v65
v_mov_b32 v26, 0
v_mfma_f32_16x16x16_bf16 v[68:71], v[72:73], v[24:25], v[68:71]
ds_read_b128 v[44:47], v2 offset:20480
v_mfma_f32_16x16x16_bf16 v[36:39], v[32:33], v[24:25], v[36:39]
ds_read_b128 v[48:51], v2 offset:21504
v_mfma_f32_16x16x16_bf16 v[40:43], v[32:33], v[26:27], v[40:43]
v_rcp_f32 v68, v68
v_mov_b64 v[76:77], 0
v_mov_b64 v[78:79], 0
s_nop 0
v_mul_f32 v36, v36, v68
v_mul_f32 v37, v37, v68
v_mul_f32 v38, v38, v68
v_mul_f32 v39, v39, v68
v_pk_mul_f32 v[40:41], v[40:41], v[68:69] op_sel_hi:[1,0]
v_pk_mul_f32 v[42:43], v[42:43], v[68:69] op_sel_hi:[1,0]
v_cvt_pk_bf16_f32 v36, v36, v37
v_cvt_pk_bf16_f32 v37, v38, v39
v_cvt_pk_bf16_f32 v38, v40, v41
v_cvt_pk_bf16_f32 v39, v42, v43
ds_write_b128 v1, v[36:39] offset:6144
ds_read_b128 v[60:63], v7 offset:6144
buffer_store_dwordx4 v[30:33], v1, s[4:7], s40 offen sc0 sc1
ds_read_b128 v[52:55], v2 offset:24576
ds_read_b128 v[56:59], v2 offset:25600
s_cmp_eq_u32 s34, s100
v_mov_b64 v[20:21], 0
v_mov_b64 v[22:23], 0
s_cbranch_scc1 L_ev_w1f
L_evb_w1f:
s_waitcnt lgkmcnt(3)
s_barrier
ds_read_b128 v[64:67], v7 offset:7168
ds_read_b128 v[68:71], v7 offset:8192
ds_read_b128 v[72:75], v7 offset:5120
s_waitcnt lgkmcnt(5)
v_smfmac_f32_16x16x64_bf16 v[76:79], v[60:63], v[44:51], v0 abid:1
ds_read_b128 v[44:47], v2 offset:26624
v_mov_b64 v[24:25], 0
v_smfmac_f32_16x16x64_bf16 v[20:23], v[60:63], v[12:19], v0 abid:1
ds_read_b128 v[48:51], v2 offset:27648
v_mov_b64 v[26:27], 0
s_waitcnt lgkmcnt(4)
v_smfmac_f32_16x16x64_bf16 v[76:79], v[64:67], a[176:183], v0 abid:1
ds_read_b128 v[12:15], v2 offset:28672
v_mov_b64 v[40:41], 0
s_waitcnt lgkmcnt(4)
v_smfmac_f32_16x16x64_bf16 v[76:79], v[68:71], v[52:59], v0 abid:1
ds_read_b128 v[16:19], v2 offset:29696
v_mov_b64 v[42:43], 0
s_waitcnt lgkmcnt(4)
v_smfmac_f32_16x16x64_bf16 v[76:79], v[72:75], a[184:191], v0 abid:1
ds_read_b128 v[52:55], v2 offset:30720
v_mov_b64 v[36:37], 0
v_smfmac_f32_16x16x64_bf16 v[20:23], v[64:67], a[192:199], v0 abid:1
ds_read_b128 v[56:59], v2 offset:31744
v_mov_b64 v[38:39], 0
s_waitcnt lgkmcnt(4)
v_smfmac_f32_16x16x64_bf16 v[20:23], v[68:71], v[44:51], v0 abid:1
ds_read_b128 v[44:47], v2 offset:32768
v_cvt_pk_bf16_f32 v76, v76, v77
v_cvt_pk_bf16_f32 v77, v78, v79
v_bfi_b32 v76, 1, s35, v76
buffer_store_dwordx2 v[76:77], v8, s[4:7], s42 offen
v_smfmac_f32_16x16x64_bf16 v[20:23], v[72:75], a[200:207], v0 abid:1
ds_read_b128 v[48:51], v2 offset:33792
s_waitcnt lgkmcnt(4)
v_smfmac_f32_16x16x64_bf16 v[24:27], v[60:63], v[12:19], v0 abid:1
ds_read_b128 v[12:15], v2 offset:34816
v_smfmac_f32_16x16x64_bf16 v[24:27], v[64:67], a[208:215], v0 abid:1
ds_read_b128 v[16:19], v2 offset:35840
v_cvt_pk_bf16_f32 v20, v20, v21
v_cvt_pk_bf16_f32 v21, v22, v23
v_bfi_b32 v20, 1, s35, v20
buffer_store_dwordx2 v[20:21], v8, s[4:7], s43 offen
s_waitcnt lgkmcnt(4)
v_smfmac_f32_16x16x64_bf16 v[24:27], v[68:71], v[52:59], v0 abid:1
ds_read_b128 v[52:55], v2 offset:36864
v_smfmac_f32_16x16x64_bf16 v[24:27], v[72:75], a[216:223], v0 abid:1
ds_read_b128 v[56:59], v2 offset:37888
s_waitcnt lgkmcnt(4)
v_smfmac_f32_16x16x64_bf16 v[40:43], v[60:63], v[44:51], v0 abid:1
ds_read_b128 v[44:47], v2 offset:38912
v_smfmac_f32_16x16x64_bf16 v[40:43], v[64:67], a[224:231], v0 abid:1
ds_read_b128 v[48:51], v2 offset:39936
v_cvt_pk_bf16_f32 v24, v24, v25
s_waitcnt lgkmcnt(4)
v_smfmac_f32_16x16x64_bf16 v[40:43], v[68:71], v[12:19], v0 abid:1
v_cvt_pk_bf16_f32 v25, v26, v27
v_smfmac_f32_16x16x64_bf16 v[40:43], v[72:75], a[232:239], v0 abid:1
v_bfi_b32 v24, 1, s35, v24
buffer_store_dwordx2 v[24:25], v8, s[4:7], s44 offen
s_waitcnt lgkmcnt(2)
v_smfmac_f32_16x16x64_bf16 v[36:39], v[60:63], v[52:59], v0 abid:1
v_smfmac_f32_16x16x64_bf16 v[36:39], v[64:67], a[240:247], v0 abid:1
v_cvt_pk_bf16_f32 v40, v40, v41
s_waitcnt lgkmcnt(0)
v_smfmac_f32_16x16x64_bf16 v[36:39], v[68:71], v[44:51], v0 abid:1
v_cvt_pk_bf16_f32 v41, v42, v43
v_smfmac_f32_16x16x64_bf16 v[36:39], v[72:75], a[248:255], v0 abid:1
v_bfi_b32 v40, 1, s35, v40
buffer_store_dwordx2 v[40:41], v8, s[4:7], s45 offen
s_nop 5
v_cvt_pk_bf16_f32 v36, v36, v37
v_cvt_pk_bf16_f32 v37, v38, v39
v_bfi_b32 v36, 1, s35, v36
buffer_store_dwordx2 v[36:37], v8, s[4:7], s46 offen
s_add_u32 s34, s34, 1
s_add_u32 s37, s37, 524288
s_add_u32 s39, s39, 524288
v_mov_b64 v[20:21], 0
v_mov_b64 v[22:23], 0
v_mov_b64 v[24:25], 0
v_mov_b64 v[26:27], 0
v_mov_b64 v[28:29], 0
v_mov_b64 v[34:35], 0
v_mov_b64 v[36:37], 0
v_mov_b64 v[38:39], 0
v_mov_b64 v[40:41], 0
v_mov_b64 v[42:43], 0
ds_read_b128 v[44:47], v2 offset:0
ds_read_b128 v[48:51], v2 offset:1024
s_waitcnt vmcnt(0)
buffer_load_dwordx4 v[12:15], v9, s[4:7], s37 offen offset:0
buffer_load_dwordx4 v[16:19], v9, s[4:7], s37 offen offset:1024
buffer_load_dwordx4 v[52:55], v1, s[4:7], s37 offen offset:2048
buffer_load_dwordx4 v[56:59], v1, s[4:7], s37 offen offset:3072
s_not_b32 s35, s35
s_not_b32 s36, s36
v_lshrrev_b32 v6, 2, v1
s_barrier
buffer_load_dwordx4 v[60:63], v1, s[4:7], s47 offen sc1
buffer_load_dwordx4 v[68:71], v1, s[4:7], s38 offen sc1
s_add_u32 s40, s40, 131072
v_mov_b64 v[30:31], 0
v_mov_b64 v[32:33], 0
s_branch L_top_w1f
L_done_w1f:
s_waitcnt vmcnt(0)
s_barrier
s_waitcnt vmcnt(0) lgkmcnt(0)
s_endpgm
L_ra0_w1f:
buffer_load_dwordx4 v[60:63], v1, s[4:7], s47 offen sc1
buffer_load_dwordx4 v[68:71], v1, s[4:7], s38 offen sc1
s_sub_u32 s41, s41, 1
s_cbranch_scc1 L_exit
ds_read_b128 v[44:47], v2 offset:0
ds_read_b128 v[48:51], v2 offset:1024
s_waitcnt vmcnt(0) lgkmcnt(0)
v_mov_b64 v[20:21], 0
v_mov_b64 v[22:23], 0
v_mov_b64 v[24:25], 0
v_mov_b64 v[26:27], 0
v_mov_b64 v[28:29], 0
v_mov_b64 v[30:31], 0
v_mov_b64 v[32:33], 0
v_mov_b64 v[34:35], 0
v_mov_b64 v[36:37], 0
v_mov_b64 v[38:39], 0
v_mov_b64 v[40:41], 0
v_mov_b64 v[42:43], 0
s_nop 0
s_branch L_a0_w1f
L_ra1_w1f:
buffer_load_dwordx4 v[64:67], v1, s[4:7], s48 offen sc1
buffer_load_dword v76, v6, s[4:7], s49 offen sc1
s_sub_u32 s41, s41, 1
s_cbranch_scc1 L_exit
s_waitcnt vmcnt(0)
v_bitop3_b32 v77, v64, s35, 1 bitop3:0x28
v_bitop3_b32 v78, v76, s35, v11 bitop3:0x28
v_or_b32 v77, v77, v78
v_cmp_ne_u32 vcc, 0, v77
s_cbranch_vccnz L_ra1_w1f
ds_write_b128 v1, v[64:67] offset:6144
ds_write_addtid_b32 v76 offset:9472
s_waitcnt lgkmcnt(0)
s_branch L_a1_w1f
L_ev_w1f:
s_cmp_eq_u32 s34, 63
s_cbranch_scc1 L_done_w1f
s_mov_b32 s100, 63

s_lshl_b32 s55, s32, 2
v_mov_b32 v34, 0
L_kvw_w1f:
buffer_load_dword v29, v34, s[28:31], s55 offen offset:128 sc0 sc1
s_sub_u32 s41, s41, 1
s_cbranch_scc1 L_exit
s_waitcnt vmcnt(0)
v_readfirstlane_b32 s54, v29
s_nop 0
s_and_b32 s54, s54, 65280
s_cmp_lg_u32 s54, 1024
s_cbranch_scc1 L_kvw_w1f
s_branch L_evb_w1f
L_slow_w1:
buffer_load_dwordx4 v[12:15], v9, s[4:7], s37 offen offset:0
buffer_load_dwordx4 v[16:19], v9, s[4:7], s37 offen offset:1024
buffer_load_dwordx4 v[52:55], v1, s[4:7], s37 offen offset:2048
buffer_load_dwordx4 v[56:59], v1, s[4:7], s37 offen offset:3072
v_mov_b64 v[20:21], 0
v_mov_b64 v[22:23], 0
v_mov_b64 v[24:25], 0
v_mov_b64 v[26:27], 0
v_mov_b64 v[28:29], 0
v_mov_b64 v[30:31], 0
v_mov_b64 v[32:33], 0
v_mov_b64 v[34:35], 0
v_mov_b64 v[36:37], 0
v_mov_b64 v[38:39], 0
v_mov_b64 v[40:41], 0
v_mov_b64 v[42:43], 0
v_lshrrev_b32 v6, 2, v1
ds_read_b128 v[44:47], v2 offset:0
ds_read_b128 v[48:51], v2 offset:1024
s_waitcnt vmcnt(0)
buffer_load_dwordx4 v[60:63], v1, s[4:7], s47 offen sc0 sc1
buffer_load_dwordx4 v[68:71], v1, s[4:7], s38 offen sc0 sc1
s_waitcnt vmcnt(0)
.p2align 6
L_top_w1s:
s_waitcnt vmcnt(1)
L_a0_w1s:
s_waitcnt lgkmcnt(0)
v_smfmac_f32_16x16x64_bf16 v[20:23], v[60:63], v[44:51], v0
ds_write_b128 v1, v[60:63] offset:2048
v_smfmac_f32_16x16x64_bf16 v[28:31], v[60:63], v[176:183], v0
ds_read_b128 v[44:47], v2 offset:2048
buffer_load_dwordx4 v[64:67], v1, s[4:7], s48 offen sc0 sc1
v_smfmac_f32_16x16x64_bf16 v[32:35], v[60:63], v[184:191], v0
ds_read_b128 v[48:51], v2 offset:3072
buffer_load_dword v76, v6, s[4:7], s49 offen sc0 sc1
v_smfmac_f32_16x16x64_bf16 v[36:39], v[60:63], a[48:55], v0
s_waitcnt vmcnt(2)
v_bitop3_b32 v77, v60, v68, s35 bitop3:0x7e
v_smfmac_f32_16x16x64_bf16 v[40:43], v[60:63], a[56:63], v0
v_and_b32 v77, 1, v77
v_smfmac_f32_16x16x64_bf16 v[20:23], v[68:71], v[80:87], v0
v_cmp_ne_u32 vcc, 0, v77
s_waitcnt lgkmcnt(0)
v_smfmac_f32_16x16x64_bf16 v[24:27], v[60:63], v[44:51], v0
ds_read_b128 v[44:47], v2 offset:4096
v_smfmac_f32_16x16x64_bf16 v[24:27], v[68:71], v[88:95], v0
s_cbranch_vccnz L_ra0_w1s
s_barrier
ds_read_b128 v[72:75], v1 offset:4096
v_smfmac_f32_16x16x64_bf16 v[28:31], v[68:71], v[192:199], v0
ds_read_b128 v[48:51], v2 offset:5120
v_smfmac_f32_16x16x64_bf16 v[32:35], v[68:71], v[200:207], v0
ds_read_b128 v[60:63], v1 offset:1024
v_smfmac_f32_16x16x64_bf16 v[36:39], v[68:71], a[64:71], v0
v_smfmac_f32_16x16x64_bf16 v[40:43], v[68:71], a[72:79], v0
s_waitcnt lgkmcnt(2)
s_waitcnt lgkmcnt(1)
v_smfmac_f32_16x16x64_bf16 v[20:23], v[72:75], v[44:51], v0
ds_read_b128 v[44:47], v2 offset:6144
v_smfmac_f32_16x16x64_bf16 v[28:31], v[72:75], v[208:215], v0
ds_read_b128 v[48:51], v2 offset:7168
v_smfmac_f32_16x16x64_bf16 v[32:35], v[72:75], v[216:223], v0
s_waitcnt vmcnt(0)
ds_write_b128 v1, v[64:67] offset:6144
v_smfmac_f32_16x16x64_bf16 v[36:39], v[72:75], a[80:87], v0
ds_write_addtid_b32 v76 offset:9472
v_bitop3_b32 v77, v64, s35, 1 bitop3:0x28
v_smfmac_f32_16x16x64_bf16 v[40:43], v[72:75], a[88:95], v0
v_bitop3_b32 v78, v76, s35, v11 bitop3:0x28
s_waitcnt lgkmcnt(2)
v_smfmac_f32_16x16x64_bf16 v[24:27], v[72:75], v[44:51], v0
ds_read_b128 v[44:47], v2 offset:8192
v_or_b32 v77, v77, v78
v_smfmac_f32_16x16x64_bf16 v[20:23], v[60:63], v[96:103], v0
ds_read_b128 v[48:51], v2 offset:9216
v_cmp_ne_u32 vcc, 0, v77
v_smfmac_f32_16x16x64_bf16 v[24:27], v[60:63], v[104:111], v0
v_smfmac_f32_16x16x64_bf16 v[36:39], v[60:63], a[96:103], v0
s_cbranch_vccnz L_ra1_w1s
L_a1_w1s:
s_waitcnt lgkmcnt(2)
s_barrier
ds_read_b128 v[68:71], v1 offset:7168
v_smfmac_f32_16x16x64_bf16 v[28:31], v[60:63], v[224:231], v0
ds_read_b128 v[72:75], v1 offset:8192
v_lshlrev_b32 v6, 2, v1
v_smfmac_f32_16x16x64_bf16 v[40:43], v[60:63], a[104:111], v0
ds_read_b128 v[76:79], v1 offset:9216
v_smfmac_f32_16x16x64_bf16 v[32:35], v[60:63], v[232:239], v0
ds_read_b128 v[60:63], v1 offset:5120
s_waitcnt lgkmcnt(4)
v_smfmac_f32_16x16x64_bf16 v[20:23], v[64:67], v[44:51], v0
ds_read_b128 v[44:47], v2 offset:10240
buffer_load_dword v6, s[4:7], s39 offen lds
s_waitcnt lgkmcnt(4)
v_smfmac_f32_16x16x64_bf16 v[20:23], v[68:71], v[112:119], v0
ds_read_b128 v[48:51], v2 offset:11264
v_smfmac_f32_16x16x64_bf16 v[24:27], v[68:71], v[120:127], v0
s_waitcnt lgkmcnt(4)
v_smfmac_f32_16x16x64_bf16 v[20:23], v[72:75], v[128:135], v0
s_waitcnt lgkmcnt(3)
v_smfmac_f32_16x16x64_bf16 v[20:23], v[76:79], v[160:167], v0
s_waitcnt lgkmcnt(2)
v_smfmac_f32_16x16x64_bf16 v[20:23], v[60:63], v[144:151], v0
s_waitcnt lgkmcnt(0)
v_smfmac_f32_16x16x64_bf16 v[24:27], v[64:67], v[44:51], v0
ds_read_b128 v[44:47], v2 offset:12288
v_smfmac_f32_16x16x64_bf16 v[24:27], v[72:75], v[136:143], v0
ds_read_b128 v[48:51], v2 offset:13312
v_add_f32 v20, v20, v22
v_smfmac_f32_16x16x64_bf16 v[24:27], v[76:79], v[168:175], v0
v_add_f32 v21, v21, v23
v_smfmac_f32_16x16x64_bf16 v[24:27], v[60:63], v[152:159], v0
v_cvt_pk_bf16_f32 v22, v20, v21
v_smfmac_f32_16x16x64_bf16 v[28:31], v[64:67], v[240:247], v0
v_smfmac_f32_16x16x64_bf16 v[28:31], v[72:75], a[0:7], v0
v_add_f32 v24, v24, v26
v_add_f32 v25, v25, v27
v_cvt_pk_bf16_f32 v23, v24, v25
s_waitcnt lgkmcnt(0)
v_smfmac_f32_16x16x64_bf16 v[28:31], v[68:71], v[44:51], v0
ds_write_b64 v3, v[22:23] offset:10752
v_smfmac_f32_16x16x64_bf16 v[28:31], v[76:79], a[32:39], v0
ds_read_b128 v[44:47], v2 offset:14336
v_smfmac_f32_16x16x64_bf16 v[28:31], v[60:63], a[16:23], v0
ds_read_b128 v[48:51], v2 offset:15360
v_smfmac_f32_16x16x64_bf16 v[32:35], v[64:67], v[248:255], v0
s_waitcnt lgkmcnt(2)
s_barrier
ds_read_b64_tr_b16 v[20:21], v4 offset:10240
ds_read_b64_tr_b16 v[22:23], v4 offset:10752
v_smfmac_f32_16x16x64_bf16 v[32:35], v[72:75], a[8:15], v0
ds_read_b64_tr_b16 v[24:25], v4 offset:11264
v_add_f32 v28, v28, v30
v_smfmac_f32_16x16x64_bf16 v[32:35], v[76:79], a[40:47], v0
ds_read_b64_tr_b16 v[26:27], v4 offset:11776
v_add_f32 v29, v29, v31
s_waitcnt lgkmcnt(4)
v_smfmac_f32_16x16x64_bf16 v[32:35], v[68:71], v[44:51], v0
ds_read_b128 v[44:47], v2 offset:18432
v_cvt_pk_bf16_f32 v30, v28, v29
v_smfmac_f32_16x16x64_bf16 v[32:35], v[60:63], a[24:31], v0
ds_read_b128 v[48:51], v2 offset:19456
s_waitcnt lgkmcnt(4)
v_mfma_f32_16x16x32_bf16 v[12:15], v[12:15], v[20:23], 0
s_waitcnt lgkmcnt(2)
v_mfma_f32_16x16x32_bf16 v[12:15], v[16:19], v[24:27], v[12:15]
v_add_f32 v32, v32, v34
v_add_f32 v33, v33, v35
v_cvt_pk_bf16_f32 v31, v32, v33
ds_write_b64 v3, v[30:31] offset:12800
v_smfmac_f32_16x16x64_bf16 v[36:39], v[64:67], a[112:119], v0
s_nop 2
v_add_f32_dpp v12, v14, v12 quad_perm:[2,3,0,1] row_mask:0xf bank_mask:0xf
v_add_f32_dpp v13, v15, v13 quad_perm:[2,3,0,1] row_mask:0xf bank_mask:0xf
ds_write_b64 v5, v[12:13] offset:14592
v_smfmac_f32_16x16x64_bf16 v[40:43], v[64:67], a[120:127], v0
s_waitcnt lgkmcnt(1)
s_barrier
ds_read_b64_tr_b16 v[64:65], v4 offset:12288
ds_read_b64_tr_b16 v[66:67], v4 offset:12800
v_smfmac_f32_16x16x64_bf16 v[36:39], v[68:71], a[128:135], v0
ds_read_b64_tr_b16 v[16:17], v4 offset:13312
ds_read_b64_tr_b16 v[18:19], v4 offset:13824
v_smfmac_f32_16x16x64_bf16 v[40:43], v[68:71], a[136:143], v0
s_waitcnt lgkmcnt(4)
s_barrier
ds_read_b128 v[68:71], v1 offset:14336
v_smfmac_f32_16x16x64_bf16 v[40:43], v[60:63], v[44:51], v0
ds_read_b128 v[44:47], v2 offset:16384
s_waitcnt lgkmcnt(4)
v_mfma_f32_16x16x32_bf16 v[64:67], v[64:67], v[20:23], 0
ds_read_b128 v[48:51], v2 offset:17408
s_waitcnt lgkmcnt(3)
v_mfma_f32_16x16x32_bf16 v[64:67], v[16:19], v[24:27], v[64:67]
v_smfmac_f32_16x16x64_bf16 v[40:43], v[72:75], a[152:159], v0
ds_read_b128 v[12:15], v2 offset:22528
s_waitcnt lgkmcnt(3)
v_max3_f32 v25, v68, v69, v70
v_smfmac_f32_16x16x64_bf16 v[40:43], v[76:79], a[168:175], v0
ds_read_b128 v[16:19], v2 offset:23552
v_add_f32_dpp v64, v66, v64 quad_perm:[2,3,0,1] row_mask:0xf bank_mask:0xf
v_add_f32_dpp v65, v67, v65 quad_perm:[2,3,0,1] row_mask:0xf bank_mask:0xf
v_max_f32 v25, v25, v71
v_max_f32 v24, v64, v65
v_mul_f32 v24, s50, v24
v_max_f32_dpp v25, v25, v25 quad_perm:[2,3,0,1] row_mask:0xf bank_mask:0xf
v_smfmac_f32_16x16x64_bf16 v[36:39], v[72:75], a[144:151], v0
s_nop 0
v_max_f32_dpp v26, v24, v25 quad_perm:[0,1,0,1] row_mask:0xf bank_mask:0xf
v_max_f32_dpp v27, v24, v25 quad_perm:[0,1,0,1] row_mask:0xf bank_mask:0xf
v_smfmac_f32_16x16x64_bf16 v[36:39], v[76:79], a[160:167], v0
s_nop 0
v_permlane16_swap_b32 v26, v27
v_max_f32 v28, v26, v27
v_max_f32 v29, v26, v27
s_waitcnt lgkmcnt(2)
v_smfmac_f32_16x16x64_bf16 v[36:39], v[60:63], v[44:51], v0
v_permlane32_swap_b32 v28, v29
v_max_f32 v28, v28, v29
v_sub_f32 v68, v68, v28
v_sub_f32 v69, v69, v28
v_sub_f32 v70, v70, v28
v_sub_f32 v71, v71, v28
v_exp_f32 v68, v68
v_exp_f32 v69, v69
v_exp_f32 v70, v70
v_exp_f32 v71, v71
v_cvt_pk_bf16_f32 v20, v68, v69
v_cvt_pk_bf16_f32 v21, v70, v71
v_pk_add_f32 v[36:37], v[36:37], v[38:39]
v_mov_b32_dpp v22, v20 quad_perm:[2,3,0,1] row_mask:0xf bank_mask:0xf
v_mov_b32_dpp v23, v21 quad_perm:[2,3,0,1] row_mask:0xf bank_mask:0xf
v_pk_fma_f32 v[64:65], v[64:65], s[50:51], v[28:29] op_sel_hi:[1,1,0] neg_lo:[0,0,1] neg_hi:[0,0,1]
v_cvt_pk_bf16_f32 v32, v36, v37
v_pk_add_f32 v[40:41], v[40:41], v[42:43]
v_mfma_f32_16x16x32_bf16 v[36:39], v[52:55], v[20:23], 0
v_mov_b64 v[72:73], s[52:53]
v_mov_b64 v[74:75], s[52:53]
v_cvt_pk_bf16_f32 v33, v40, v41
v_exp_f32 v64, v64
v_mfma_f32_16x16x32_bf16 v[68:71], v[72:75], v[20:23], 0
v_exp_f32 v65, v65
v_mov_b32 v25, 0
v_cvt_pk_bf16_f32 v24, v64, v65
v_mfma_f32_16x16x32_bf16 v[40:43], v[56:59], v[20:23], 0
v_cvt_pk_bf16_f32 v27, v64, v65
v_mov_b32 v26, 0
v_mfma_f32_16x16x16_bf16 v[68:71], v[72:73], v[24:25], v[68:71]
ds_read_b128 v[44:47], v2 offset:20480
v_mfma_f32_16x16x16_bf16 v[36:39], v[32:33], v[24:25], v[36:39]
ds_read_b128 v[48:51], v2 offset:21504
v_mfma_f32_16x16x16_bf16 v[40:43], v[32:33], v[26:27], v[40:43]
v_rcp_f32 v68, v68
v_mov_b64 v[76:77], 0
v_mov_b64 v[78:79], 0
s_nop 0
v_mul_f32 v36, v36, v68
v_mul_f32 v37, v37, v68
v_mul_f32 v38, v38, v68
v_mul_f32 v39, v39, v68
v_pk_mul_f32 v[40:41], v[40:41], v[68:69] op_sel_hi:[1,0]
v_pk_mul_f32 v[42:43], v[42:43], v[68:69] op_sel_hi:[1,0]
v_cvt_pk_bf16_f32 v36, v36, v37
v_cvt_pk_bf16_f32 v37, v38, v39
v_cvt_pk_bf16_f32 v38, v40, v41
v_cvt_pk_bf16_f32 v39, v42, v43
ds_write_b128 v1, v[36:39] offset:6144
ds_read_b128 v[60:63], v7 offset:6144
buffer_store_dwordx4 v[30:33], v1, s[4:7], s40 offen sc0 sc1
ds_read_b128 v[52:55], v2 offset:24576
ds_read_b128 v[56:59], v2 offset:25600
s_cmp_eq_u32 s34, s100
v_mov_b64 v[20:21], 0
v_mov_b64 v[22:23], 0
s_cbranch_scc1 L_ev_w1s
L_evb_w1s:
s_waitcnt lgkmcnt(3)
s_barrier
ds_read_b128 v[64:67], v7 offset:7168
ds_read_b128 v[68:71], v7 offset:8192
ds_read_b128 v[72:75], v7 offset:5120
s_waitcnt lgkmcnt(5)
v_smfmac_f32_16x16x64_bf16 v[76:79], v[60:63], v[44:51], v0 abid:1
ds_read_b128 v[44:47], v2 offset:26624
v_mov_b64 v[24:25], 0
v_smfmac_f32_16x16x64_bf16 v[20:23], v[60:63], v[12:19], v0 abid:1
ds_read_b128 v[48:51], v2 offset:27648
v_mov_b64 v[26:27], 0
s_waitcnt lgkmcnt(4)
v_smfmac_f32_16x16x64_bf16 v[76:79], v[64:67], a[176:183], v0 abid:1
ds_read_b128 v[12:15], v2 offset:28672
v_mov_b64 v[40:41], 0
s_waitcnt lgkmcnt(4)
v_smfmac_f32_16x16x64_bf16 v[76:79], v[68:71], v[52:59], v0 abid:1
ds_read_b128 v[16:19], v2 offset:29696
v_mov_b64 v[42:43], 0
s_waitcnt lgkmcnt(4)
v_smfmac_f32_16x16x64_bf16 v[76:79], v[72:75], a[184:191], v0 abid:1
ds_read_b128 v[52:55], v2 offset:30720
v_mov_b64 v[36:37], 0
v_smfmac_f32_16x16x64_bf16 v[20:23], v[64:67], a[192:199], v0 abid:1
ds_read_b128 v[56:59], v2 offset:31744
v_mov_b64 v[38:39], 0
s_waitcnt lgkmcnt(4)
v_smfmac_f32_16x16x64_bf16 v[20:23], v[68:71], v[44:51], v0 abid:1
ds_read_b128 v[44:47], v2 offset:32768
v_cvt_pk_bf16_f32 v76, v76, v77
v_cvt_pk_bf16_f32 v77, v78, v79
v_bfi_b32 v76, 1, s35, v76
buffer_store_dwordx2 v[76:77], v8, s[4:7], s42 offen sc0 sc1
v_smfmac_f32_16x16x64_bf16 v[20:23], v[72:75], a[200:207], v0 abid:1
ds_read_b128 v[48:51], v2 offset:33792
s_waitcnt lgkmcnt(4)
v_smfmac_f32_16x16x64_bf16 v[24:27], v[60:63], v[12:19], v0 abid:1
ds_read_b128 v[12:15], v2 offset:34816
v_smfmac_f32_16x16x64_bf16 v[24:27], v[64:67], a[208:215], v0 abid:1
ds_read_b128 v[16:19], v2 offset:35840
v_cvt_pk_bf16_f32 v20, v20, v21
v_cvt_pk_bf16_f32 v21, v22, v23
v_bfi_b32 v20, 1, s35, v20
buffer_store_dwordx2 v[20:21], v8, s[4:7], s43 offen sc0 sc1
s_waitcnt lgkmcnt(4)
v_smfmac_f32_16x16x64_bf16 v[24:27], v[68:71], v[52:59], v0 abid:1
ds_read_b128 v[52:55], v2 offset:36864
v_smfmac_f32_16x16x64_bf16 v[24:27], v[72:75], a[216:223], v0 abid:1
ds_read_b128 v[56:59], v2 offset:37888
s_waitcnt lgkmcnt(4)
v_smfmac_f32_16x16x64_bf16 v[40:43], v[60:63], v[44:51], v0 abid:1
ds_read_b128 v[44:47], v2 offset:38912
v_smfmac_f32_16x16x64_bf16 v[40:43], v[64:67], a[224:231], v0 abid:1
ds_read_b128 v[48:51], v2 offset:39936
v_cvt_pk_bf16_f32 v24, v24, v25
s_waitcnt lgkmcnt(4)
v_smfmac_f32_16x16x64_bf16 v[40:43], v[68:71], v[12:19], v0 abid:1
v_cvt_pk_bf16_f32 v25, v26, v27
v_smfmac_f32_16x16x64_bf16 v[40:43], v[72:75], a[232:239], v0 abid:1
v_bfi_b32 v24, 1, s35, v24
buffer_store_dwordx2 v[24:25], v8, s[4:7], s44 offen sc0 sc1
s_waitcnt lgkmcnt(2)
v_smfmac_f32_16x16x64_bf16 v[36:39], v[60:63], v[52:59], v0 abid:1
v_smfmac_f32_16x16x64_bf16 v[36:39], v[64:67], a[240:247], v0 abid:1
v_cvt_pk_bf16_f32 v40, v40, v41
s_waitcnt lgkmcnt(0)
v_smfmac_f32_16x16x64_bf16 v[36:39], v[68:71], v[44:51], v0 abid:1
v_cvt_pk_bf16_f32 v41, v42, v43
v_smfmac_f32_16x16x64_bf16 v[36:39], v[72:75], a[248:255], v0 abid:1
v_bfi_b32 v40, 1, s35, v40
buffer_store_dwordx2 v[40:41], v8, s[4:7], s45 offen sc0 sc1
s_nop 5
v_cvt_pk_bf16_f32 v36, v36, v37
v_cvt_pk_bf16_f32 v37, v38, v39
v_bfi_b32 v36, 1, s35, v36
buffer_store_dwordx2 v[36:37], v8, s[4:7], s46 offen sc0 sc1
s_add_u32 s34, s34, 1
s_add_u32 s37, s37, 524288
s_add_u32 s39, s39, 524288
v_mov_b64 v[20:21], 0
v_mov_b64 v[22:23], 0
v_mov_b64 v[24:25], 0
v_mov_b64 v[26:27], 0
v_mov_b64 v[28:29], 0
v_mov_b64 v[34:35], 0
v_mov_b64 v[36:37], 0
v_mov_b64 v[38:39], 0
v_mov_b64 v[40:41], 0
v_mov_b64 v[42:43], 0
ds_read_b128 v[44:47], v2 offset:0
ds_read_b128 v[48:51], v2 offset:1024
s_waitcnt vmcnt(0)
buffer_load_dwordx4 v[12:15], v9, s[4:7], s37 offen offset:0
buffer_load_dwordx4 v[16:19], v9, s[4:7], s37 offen offset:1024
buffer_load_dwordx4 v[52:55], v1, s[4:7], s37 offen offset:2048
buffer_load_dwordx4 v[56:59], v1, s[4:7], s37 offen offset:3072
s_not_b32 s35, s35
s_not_b32 s36, s36
v_lshrrev_b32 v6, 2, v1
s_barrier
buffer_load_dwordx4 v[60:63], v1, s[4:7], s47 offen sc0 sc1
buffer_load_dwordx4 v[68:71], v1, s[4:7], s38 offen sc0 sc1
s_add_u32 s40, s40, 131072
v_mov_b64 v[30:31], 0
v_mov_b64 v[32:33], 0
s_branch L_top_w1s
L_done_w1s:
s_waitcnt vmcnt(0)
s_barrier
s_waitcnt vmcnt(0) lgkmcnt(0)
s_endpgm
L_ra0_w1s:
buffer_load_dwordx4 v[60:63], v1, s[4:7], s47 offen sc0 sc1
buffer_load_dwordx4 v[68:71], v1, s[4:7], s38 offen sc0 sc1
s_sub_u32 s41, s41, 1
s_cbranch_scc1 L_exit
ds_read_b128 v[44:47], v2 offset:0
ds_read_b128 v[48:51], v2 offset:1024
s_waitcnt vmcnt(0) lgkmcnt(0)
v_mov_b64 v[20:21], 0
v_mov_b64 v[22:23], 0
v_mov_b64 v[24:25], 0
v_mov_b64 v[26:27], 0
v_mov_b64 v[28:29], 0
v_mov_b64 v[30:31], 0
v_mov_b64 v[32:33], 0
v_mov_b64 v[34:35], 0
v_mov_b64 v[36:37], 0
v_mov_b64 v[38:39], 0
v_mov_b64 v[40:41], 0
v_mov_b64 v[42:43], 0
s_nop 0
s_branch L_a0_w1s
L_ra1_w1s:
buffer_load_dwordx4 v[64:67], v1, s[4:7], s48 offen sc0 sc1
buffer_load_dword v76, v6, s[4:7], s49 offen sc0 sc1
s_sub_u32 s41, s41, 1
s_cbranch_scc1 L_exit
s_waitcnt vmcnt(0)
v_bitop3_b32 v77, v64, s35, 1 bitop3:0x28
v_bitop3_b32 v78, v76, s35, v11 bitop3:0x28
v_or_b32 v77, v77, v78
v_cmp_ne_u32 vcc, 0, v77
s_cbranch_vccnz L_ra1_w1s
ds_write_b128 v1, v[64:67] offset:6144
ds_write_addtid_b32 v76 offset:9472
s_waitcnt lgkmcnt(0)
s_branch L_a1_w1s
L_ev_w1s:
s_cmp_eq_u32 s34, 63
s_cbranch_scc1 L_done_w1s
s_mov_b32 s100, 63

s_lshl_b32 s55, s32, 2
v_mov_b32 v34, 0
L_kvw_w1s:
buffer_load_dword v29, v34, s[28:31], s55 offen offset:128 sc0 sc1
s_sub_u32 s41, s41, 1
s_cbranch_scc1 L_exit
s_waitcnt vmcnt(0)
v_readfirstlane_b32 s54, v29
s_nop 0
s_and_b32 s54, s54, 65280
s_cmp_lg_u32 s54, 1024
s_cbranch_scc1 L_kvw_w1s
s_branch L_evb_w1s
L_pro_w1r:
v_and_b32 v20, 63, v0
v_and_b32 v21, 15, v0
v_bfe_u32 v22, v0, 4, 2
v_lshlrev_b32 v1, 4, v20
v_add_u32 v2, 57344, v1
v_bfe_u32 v23, v20, 4, 1
v_lshlrev_b32 v26, 4, v23
v_bfe_u32 v23, v20, 2, 2
v_lshl_add_u32 v26, v23, 1, v26
v_bfe_u32 v23, v20, 5, 1
v_add_u32 v26, v26, v23
v_lshlrev_b32 v26, 13, v26
v_and_b32 v23, 3, v20
v_lshl_add_u32 v26, v23, 4, v26
v_lshrrev_b32 v24, 2, v20
v_mul_u32_u24 v27, 1152, v24
v_lshl_add_u32 v27, v23, 4, v27
v_lshrrev_b32 v24, 2, v21
v_lshl_add_u32 v25, v22, 3, v24
v_lshlrev_b32 v28, 6, v25
v_lshl_add_u32 v28, v23, 3, v28
v_add_u32 v28, 57344, v28
v_and_b32 v25, 1, v22
v_lshlrev_b32 v29, 10, v25
v_lshrrev_b32 v25, 1, v22
v_lshl_add_u32 v29, v25, 8, v29
v_and_b32 v25, 1, v24
v_lshl_add_u32 v29, v25, 6, v29
v_lshrrev_b32 v25, 1, v24
v_lshl_add_u32 v29, v25, 5, v29
v_lshl_add_u32 v29, v23, 3, v29
v_add_u32 v29, 57344, v29
s_lshl_b32 s54, s32, 8
s_add_u32 s54, s54, 64
s_mul_i32 s55, s32, 147456
s_waitcnt lgkmcnt(0)
s_add_u32 s56, s54, 1048576
s_mov_b32 m0, 69632
s_nop 0
buffer_load_dwordx4 v26, s[8:11], s56 offen lds
s_add_u32 s56, s54, 1114112
s_mov_b32 m0, 70656
s_nop 0
buffer_load_dwordx4 v26, s[8:11], s56 offen lds
s_add_u32 s56, s54, 1310720
s_mov_b32 m0, 71680
s_nop 0
buffer_load_dwordx4 v26, s[8:11], s56 offen lds
s_add_u32 s56, s54, 1376256
s_mov_b32 m0, 72704
s_nop 0
buffer_load_dwordx4 v26, s[8:11], s56 offen lds
s_add_u32 s56, s54, 0
s_mov_b32 m0, 73728
s_nop 0
buffer_load_dwordx4 v26, s[8:11], s56 offen lds
s_add_u32 s56, s54, 65536
s_mov_b32 m0, 74752
s_nop 0
buffer_load_dwordx4 v26, s[8:11], s56 offen lds
s_add_u32 s56, s54, 262144
s_mov_b32 m0, 75776
s_nop 0
buffer_load_dwordx4 v26, s[8:11], s56 offen lds
s_add_u32 s56, s54, 327680
s_mov_b32 m0, 76800
s_nop 0
buffer_load_dwordx4 v26, s[8:11], s56 offen lds
s_add_u32 s56, s54, 3145728
s_mov_b32 m0, 77824
s_nop 0
buffer_load_dwordx4 v26, s[8:11], s56 offen lds
s_add_u32 s56, s54, 3211264
s_mov_b32 m0, 78848
s_nop 0
buffer_load_dwordx4 v26, s[8:11], s56 offen lds
s_add_u32 s56, s54, 3407872
s_mov_b32 m0, 79872
s_nop 0
buffer_load_dwordx4 v26, s[8:11], s56 offen lds
s_add_u32 s56, s54, 3473408
s_mov_b32 m0, 80896
s_nop 0
buffer_load_dwordx4 v26, s[8:11], s56 offen lds
s_add_u32 s56, s54, 3670016
s_mov_b32 m0, 81920
s_nop 0
buffer_load_dwordx4 v26, s[8:11], s56 offen lds
s_add_u32 s56, s54, 3735552
s_mov_b32 m0, 82944
s_nop 0
buffer_load_dwordx4 v26, s[8:11], s56 offen lds
s_add_u32 s56, s54, 3932160
s_mov_b32 m0, 83968
s_nop 0
buffer_load_dwordx4 v26, s[8:11], s56 offen lds
s_add_u32 s56, s54, 3997696
s_mov_b32 m0, 84992
s_nop 0
buffer_load_dwordx4 v26, s[8:11], s56 offen lds
s_add_u32 s56, s54, 2097152
s_mov_b32 m0, 86016
s_nop 0
buffer_load_dwordx4 v26, s[8:11], s56 offen lds
s_add_u32 s56, s54, 2162688
s_mov_b32 m0, 87040
s_nop 0
buffer_load_dwordx4 v26, s[8:11], s56 offen lds
s_add_u32 s56, s54, 2359296
s_mov_b32 m0, 88064
s_nop 0
buffer_load_dwordx4 v26, s[8:11], s56 offen lds
s_add_u32 s56, s54, 2424832
s_mov_b32 m0, 89088
s_nop 0
buffer_load_dwordx4 v26, s[8:11], s56 offen lds
s_add_u32 s56, s54, 4194304
s_mov_b32 m0, 90112
s_nop 0
buffer_load_dwordx4 v26, s[8:11], s56 offen lds
s_add_u32 s56, s54, 4259840
s_mov_b32 m0, 91136
s_nop 0
buffer_load_dwordx4 v26, s[8:11], s56 offen lds
s_add_u32 s56, s54, 4456448
s_mov_b32 m0, 92160
s_nop 0
buffer_load_dwordx4 v26, s[8:11], s56 offen lds
s_add_u32 s56, s54, 4521984
s_mov_b32 m0, 93184
s_nop 0
buffer_load_dwordx4 v26, s[8:11], s56 offen lds
s_add_u32 s56, s54, 524288
s_mov_b32 m0, 94208
s_nop 0
buffer_load_dwordx4 v26, s[12:15], s56 offen lds
s_add_u32 s56, s54, 589824
s_mov_b32 m0, 95232
s_nop 0
buffer_load_dwordx4 v26, s[12:15], s56 offen lds
s_add_u32 s56, s54, 786432
s_mov_b32 m0, 96256
s_nop 0
buffer_load_dwordx4 v26, s[12:15], s56 offen lds
s_add_u32 s56, s54, 851968
s_mov_b32 m0, 97280
s_nop 0
buffer_load_dwordx4 v26, s[12:15], s56 offen lds
s_add_u32 s56, s54, 1048576
s_mov_b32 m0, 57344
s_nop 0
buffer_load_dwordx4 v26, s[12:15], s56 offen lds
s_add_u32 s56, s54, 1114112
s_mov_b32 m0, 58368
s_nop 0
buffer_load_dwordx4 v26, s[12:15], s56 offen lds
s_add_u32 s56, s54, 1310720
s_mov_b32 m0, 59392
s_nop 0
buffer_load_dwordx4 v26, s[12:15], s56 offen lds
s_add_u32 s56, s54, 1376256
s_mov_b32 m0, 60416
s_nop 0
buffer_load_dwordx4 v26, s[12:15], s56 offen lds
s_add_u32 s56, s54, 1572864
s_mov_b32 m0, 61440
s_nop 0
buffer_load_dwordx4 v26, s[12:15], s56 offen lds
s_add_u32 s56, s54, 1638400
s_mov_b32 m0, 62464
s_nop 0
buffer_load_dwordx4 v26, s[12:15], s56 offen lds
s_add_u32 s56, s54, 1835008
s_mov_b32 m0, 63488
s_nop 0
buffer_load_dwordx4 v26, s[12:15], s56 offen lds
s_add_u32 s56, s54, 1900544
s_mov_b32 m0, 64512
s_nop 0
buffer_load_dwordx4 v26, s[12:15], s56 offen lds
v_bfe_u32 v23, v21, 1, 1
v_and_b32 v24, 1, v21
v_lshl_add_u32 v23, v24, 16, v23
v_mul_u32_u24 v23, 0xaaaa, v23
v_add_u32 v0, 0x44444444, v23
v_lshlrev_b32 v3, 3, v20
v_lshrrev_b32 v25, 5, v20
v_lshlrev_b32 v25, 6, v25
v_xor_b32 v3, v3, v25
v_lshrrev_b32 v25, 2, v20
v_and_b32 v4, 3, v21
v_lshl_add_u32 v4, v4, 4, v25
v_lshlrev_b32 v4, 3, v4
v_bfe_u32 v25, v21, 1, 1
v_lshlrev_b32 v23, 6, v25
v_xor_b32 v4, v4, v23
v_and_b32 v23, 2, v22
v_xor_b32 v5, v21, v23
v_lshlrev_b32 v5, 4, v5
v_lshl_add_u32 v5, v25, 10, v5
v_and_b32 v23, 1, v22
v_lshl_add_u32 v5, v23, 3, v5
v_lshlrev_b32 v9, 8, v22
v_lshl_add_u32 v9, v25, 6, v9
v_bfe_u32 v23, v21, 3, 1
v_lshl_add_u32 v9, v23, 7, v9
v_bfe_u32 v23, v21, 2, 1
v_lshl_add_u32 v9, v23, 5, v9
v_and_b32 v23, 1, v21
v_lshl_add_u32 v9, v23, 4, v9
v_lshrrev_b32 v23, 1, v22
v_and_b32 v24, 1, v22
v_and_b32 v25, 7, v21
v_lshrrev_b32 v7, 3, v21
v_lshl_add_u32 v8, v7, 1, v23
v_lshlrev_b32 v8, 12, v8
v_lshl_add_u32 v8, v24, 7, v8
v_lshl_add_u32 v8, v25, 3, v8
s_lshr_b32 s56, s32, 1
s_lshl_b32 s56, s56, 8
s_and_b32 s57, s32, 1
s_lshl_b32 s57, s57, 6
s_add_u32 s56, s56, s57
s_add_u32 s56, s56, 16384
v_add_u32 v8, s56, v8
v_and_b32 v7, 12, v21
v_bfe_u32 v25, v21, 1, 1
v_add_u32 v7, v7, v25
v_lshlrev_b32 v7, 4, v7
v_lshl_add_u32 v7, v22, 8, v7
s_mov_b32 s42, 0
s_mov_b32 s43, 65536
s_mov_b32 s44, 131072
s_mov_b32 s45, 196608
s_mov_b32 s46, 262144
s_mov_b32 s47, 295936
s_mov_b32 s48, 300032
s_mov_b32 s49, 303360
s_mov_b32 s38, 296960
s_mov_b32 s50, 0x3e0293ee
s_mov_b32 s51, 0x3e0293ee
s_mov_b32 s52, 0x3f803f80
s_mov_b32 s53, 0x3f803f80
v_and_b32 v11, 3, v21
v_cmp_eq_u32 vcc, 0, v11
s_nop 1
v_cndmask_b32 v11, 0, 1, vcc
s_mov_b32 s34, 0
s_mov_b32 s35, -1
s_mov_b32 s36, 0
s_mov_b32 s41, 400000
s_lshl_b32 s37, s32, 14
s_add_u32 s39, s37, 17305600
s_add_u32 s37, s37, 16781312
s_lshl_b32 s40, s32, 12
s_add_u32 s40, s40, 8389632
v_mov_b64 v[36:37], 0
v_mov_b64 v[38:39], 0
s_add_u32 s56, s32, 64
s_lshl_b32 s3, s56, 12
v_bfe_u32 v23, v21, 1, 1
v_bfe_u32 v24, v21, 2, 1
v_and_b32 v25, 1, v21
s_lshl_b32 s57, s56, 7
s_add_u32 s57, s57, 294912
v_and_b32 v10, 7, v21
v_lshlrev_b32 v10, 2, v10
v_lshl_add_u32 v10, v22, 5, v10
v_add_u32 v10, s57, v10
v_lshl_add_u32 v23, v23, 1, v24
v_lshlrev_b32 v25, 4, v25
v_mov_b32 v24, 0x3f80
v_lshlrev_b32 v24, v25, v24
v_cmp_eq_u32 vcc, 0, v23
s_nop 1
v_cndmask_b32 v76, 0, v24, vcc
v_cmp_eq_u32 vcc, 1, v23
s_nop 1
v_cndmask_b32 v77, 0, v24, vcc
v_cmp_eq_u32 vcc, 2, v23
s_nop 1
v_cndmask_b32 v78, 0, v24, vcc
v_cmp_eq_u32 vcc, 3, v23
s_nop 1
v_cndmask_b32 v79, 0, v24, vcc
buffer_store_dwordx4 v[36:39], v9, s[4:7], s3 offen offset:0 sc0 sc1
buffer_store_dwordx4 v[36:39], v9, s[4:7], s3 offen offset:1024 sc0 sc1
buffer_store_dwordx4 v[36:39], v9, s[4:7], s3 offen offset:2048 sc0 sc1
buffer_store_dwordx4 v[36:39], v9, s[4:7], s3 offen offset:3072 sc0 sc1
s_waitcnt vmcnt(0) lgkmcnt(0)
s_barrier
s_getreg_b32 s56, hwreg(HW_REG_XCC_ID)
s_and_b32 s56, s56, 15
s_mul_i32 s57, s56, s56
s_lshl_b32 s57, s57, 18
s_lshl_b32 s56, s56, 8
s_add_u32 s57, s57, s56
s_add_u32 s58, s57, 1
ds_read_b64_tr_b16 v[80:81], v28 offset:12288
ds_read_b64_tr_b16 v[82:83], v28 offset:12544
ds_read_b64_tr_b16 v[84:85], v28 offset:14336
ds_read_b64_tr_b16 v[86:87], v28 offset:14592
ds_read_b64_tr_b16 v[88:89], v28 offset:12320
ds_read_b64_tr_b16 v[90:91], v28 offset:12576
ds_read_b64_tr_b16 v[92:93], v28 offset:14368
ds_read_b64_tr_b16 v[94:95], v28 offset:14624
s_waitcnt lgkmcnt(0)
s_add_u32 s56, s54, 0
s_mov_b32 m0, 65536
s_nop 0
buffer_load_dwordx4 v26, s[12:15], s56 offen lds
s_add_u32 s56, s54, 65536
s_mov_b32 m0, 66560
s_nop 0
buffer_load_dwordx4 v26, s[12:15], s56 offen lds
s_add_u32 s56, s54, 262144
s_mov_b32 m0, 67584
s_nop 0
buffer_load_dwordx4 v26, s[12:15], s56 offen lds
s_add_u32 s56, s54, 327680
s_mov_b32 m0, 68608
s_nop 0
buffer_load_dwordx4 v26, s[12:15], s56 offen lds
ds_read_b64_tr_b16 v[96:97], v28 offset:16384
ds_read_b64_tr_b16 v[98:99], v28 offset:16640
ds_read_b64_tr_b16 v[100:101], v28 offset:18432
ds_read_b64_tr_b16 v[102:103], v28 offset:18688
ds_read_b64_tr_b16 v[104:105], v28 offset:16416
ds_read_b64_tr_b16 v[106:107], v28 offset:16672
ds_read_b64_tr_b16 v[108:109], v28 offset:18464
ds_read_b64_tr_b16 v[110:111], v28 offset:18720
s_waitcnt lgkmcnt(0)
s_add_u32 s56, s54, 2621440
s_mov_b32 m0, 69632
s_nop 0
buffer_load_dwordx4 v26, s[12:15], s56 offen lds
s_add_u32 s56, s54, 2686976
s_mov_b32 m0, 70656
s_nop 0
buffer_load_dwordx4 v26, s[12:15], s56 offen lds
s_add_u32 s56, s54, 2883584
s_mov_b32 m0, 71680
s_nop 0
buffer_load_dwordx4 v26, s[12:15], s56 offen lds
s_add_u32 s56, s54, 2949120
s_mov_b32 m0, 72704
s_nop 0
buffer_load_dwordx4 v26, s[12:15], s56 offen lds
ds_read_b64_tr_b16 v[112:113], v28 offset:20480
ds_read_b64_tr_b16 v[114:115], v28 offset:20736
ds_read_b64_tr_b16 v[116:117], v28 offset:22528
ds_read_b64_tr_b16 v[118:119], v28 offset:22784
ds_read_b64_tr_b16 v[120:121], v28 offset:20512
ds_read_b64_tr_b16 v[122:123], v28 offset:20768
ds_read_b64_tr_b16 v[124:125], v28 offset:22560
ds_read_b64_tr_b16 v[126:127], v28 offset:22816
s_waitcnt lgkmcnt(0)
s_add_u32 s56, s54, 3670016
s_mov_b32 m0, 73728
s_nop 0
buffer_load_dwordx4 v26, s[12:15], s56 offen lds
s_add_u32 s56, s54, 3735552
s_mov_b32 m0, 74752
s_nop 0
buffer_load_dwordx4 v26, s[12:15], s56 offen lds
s_add_u32 s56, s54, 3932160
s_mov_b32 m0, 75776
s_nop 0
buffer_load_dwordx4 v26, s[12:15], s56 offen lds
s_add_u32 s56, s54, 3997696
s_mov_b32 m0, 76800
s_nop 0
buffer_load_dwordx4 v26, s[12:15], s56 offen lds
ds_read_b64_tr_b16 v[128:129], v28 offset:24576
ds_read_b64_tr_b16 v[130:131], v28 offset:24832
ds_read_b64_tr_b16 v[132:133], v28 offset:26624
ds_read_b64_tr_b16 v[134:135], v28 offset:26880
ds_read_b64_tr_b16 v[136:137], v28 offset:24608
ds_read_b64_tr_b16 v[138:139], v28 offset:24864
ds_read_b64_tr_b16 v[140:141], v28 offset:26656
ds_read_b64_tr_b16 v[142:143], v28 offset:26912
s_waitcnt lgkmcnt(0)
s_add_u32 s56, s54, 2097152
s_mov_b32 m0, 77824
s_nop 0
buffer_load_dwordx4 v26, s[12:15], s56 offen lds
s_add_u32 s56, s54, 2162688
s_mov_b32 m0, 78848
s_nop 0
buffer_load_dwordx4 v26, s[12:15], s56 offen lds
s_add_u32 s56, s54, 2359296
s_mov_b32 m0, 79872
s_nop 0
buffer_load_dwordx4 v26, s[12:15], s56 offen lds
s_add_u32 s56, s54, 2424832
s_mov_b32 m0, 80896
s_nop 0
buffer_load_dwordx4 v26, s[12:15], s56 offen lds
ds_read_b64_tr_b16 v[144:145], v28 offset:28672
ds_read_b64_tr_b16 v[146:147], v28 offset:28928
ds_read_b64_tr_b16 v[148:149], v28 offset:30720
ds_read_b64_tr_b16 v[150:151], v28 offset:30976
ds_read_b64_tr_b16 v[152:153], v28 offset:28704
ds_read_b64_tr_b16 v[154:155], v28 offset:28960
ds_read_b64_tr_b16 v[156:157], v28 offset:30752
ds_read_b64_tr_b16 v[158:159], v28 offset:31008
s_waitcnt lgkmcnt(0)
s_add_u32 s56, s54, 4194304
s_mov_b32 m0, 81920
s_nop 0
buffer_load_dwordx4 v26, s[12:15], s56 offen lds
s_add_u32 s56, s54, 4259840
s_mov_b32 m0, 82944
s_nop 0
buffer_load_dwordx4 v26, s[12:15], s56 offen lds
s_add_u32 s56, s54, 4456448
s_mov_b32 m0, 83968
s_nop 0
buffer_load_dwordx4 v26, s[12:15], s56 offen lds
s_add_u32 s56, s54, 4521984
s_mov_b32 m0, 84992
s_nop 0
buffer_load_dwordx4 v26, s[12:15], s56 offen lds
ds_read_b64_tr_b16 v[160:161], v28 offset:32768
ds_read_b64_tr_b16 v[162:163], v28 offset:33024
ds_read_b64_tr_b16 v[164:165], v28 offset:34816
ds_read_b64_tr_b16 v[166:167], v28 offset:35072
ds_read_b64_tr_b16 v[168:169], v28 offset:32800
ds_read_b64_tr_b16 v[170:171], v28 offset:33056
ds_read_b64_tr_b16 v[172:173], v28 offset:34848
ds_read_b64_tr_b16 v[174:175], v28 offset:35104
s_waitcnt lgkmcnt(0)
s_add_u32 s56, s54, 524288
s_mov_b32 m0, 86016
s_nop 0
buffer_load_dwordx4 v26, s[16:19], s56 offen lds
s_add_u32 s56, s54, 589824
s_mov_b32 m0, 87040
s_nop 0
buffer_load_dwordx4 v26, s[16:19], s56 offen lds
s_add_u32 s56, s54, 786432
s_mov_b32 m0, 88064
s_nop 0
buffer_load_dwordx4 v26, s[16:19], s56 offen lds
s_add_u32 s56, s54, 851968
s_mov_b32 m0, 89088
s_nop 0
buffer_load_dwordx4 v26, s[16:19], s56 offen lds
ds_read_b64_tr_b16 v[176:177], v28 offset:36864
ds_read_b64_tr_b16 v[178:179], v28 offset:37120
ds_read_b64_tr_b16 v[180:181], v28 offset:38912
ds_read_b64_tr_b16 v[182:183], v28 offset:39168
ds_read_b64_tr_b16 v[184:185], v28 offset:36896
ds_read_b64_tr_b16 v[186:187], v28 offset:37152
ds_read_b64_tr_b16 v[188:189], v28 offset:38944
ds_read_b64_tr_b16 v[190:191], v28 offset:39200
s_waitcnt lgkmcnt(0)
s_add_u32 s56, s54, 1048576
s_mov_b32 m0, 90112
s_nop 0
buffer_load_dwordx4 v26, s[16:19], s56 offen lds
s_add_u32 s56, s54, 1114112
s_mov_b32 m0, 91136
s_nop 0
buffer_load_dwordx4 v26, s[16:19], s56 offen lds
s_add_u32 s56, s54, 1310720
s_mov_b32 m0, 92160
s_nop 0
buffer_load_dwordx4 v26, s[16:19], s56 offen lds
s_add_u32 s56, s54, 1376256
s_mov_b32 m0, 93184
s_nop 0
buffer_load_dwordx4 v26, s[16:19], s56 offen lds
ds_read_b64_tr_b16 v[192:193], v28 offset:0
ds_read_b64_tr_b16 v[194:195], v28 offset:256
ds_read_b64_tr_b16 v[196:197], v28 offset:2048
ds_read_b64_tr_b16 v[198:199], v28 offset:2304
ds_read_b64_tr_b16 v[200:201], v28 offset:32
ds_read_b64_tr_b16 v[202:203], v28 offset:288
ds_read_b64_tr_b16 v[204:205], v28 offset:2080
ds_read_b64_tr_b16 v[206:207], v28 offset:2336
s_waitcnt lgkmcnt(0)
s_add_u32 s56, s54, 1572864
s_mov_b32 m0, 94208
s_nop 0
buffer_load_dwordx4 v26, s[16:19], s56 offen lds
s_add_u32 s56, s54, 1638400
s_mov_b32 m0, 95232
s_nop 0
buffer_load_dwordx4 v26, s[16:19], s56 offen lds
s_add_u32 s56, s54, 1835008
s_mov_b32 m0, 96256
s_nop 0
buffer_load_dwordx4 v26, s[16:19], s56 offen lds
s_add_u32 s56, s54, 1900544
s_mov_b32 m0, 97280
s_nop 0
buffer_load_dwordx4 v26, s[16:19], s56 offen lds
ds_read_b64_tr_b16 v[208:209], v28 offset:4096
ds_read_b64_tr_b16 v[210:211], v28 offset:4352
ds_read_b64_tr_b16 v[212:213], v28 offset:6144
ds_read_b64_tr_b16 v[214:215], v28 offset:6400
ds_read_b64_tr_b16 v[216:217], v28 offset:4128
ds_read_b64_tr_b16 v[218:219], v28 offset:4384
ds_read_b64_tr_b16 v[220:221], v28 offset:6176
ds_read_b64_tr_b16 v[222:223], v28 offset:6432
s_waitcnt lgkmcnt(0)
s_add_u32 s56, s54, 0
s_mov_b32 m0, 57344
s_nop 0
buffer_load_dwordx4 v26, s[16:19], s56 offen lds
s_add_u32 s56, s54, 65536
s_mov_b32 m0, 58368
s_nop 0
buffer_load_dwordx4 v26, s[16:19], s56 offen lds
s_add_u32 s56, s54, 262144
s_mov_b32 m0, 59392
s_nop 0
buffer_load_dwordx4 v26, s[16:19], s56 offen lds
s_add_u32 s56, s54, 327680
s_mov_b32 m0, 60416
s_nop 0
buffer_load_dwordx4 v26, s[16:19], s56 offen lds
s_waitcnt vmcnt(32)
ds_read_b64_tr_b16 v[224:225], v28 offset:8192
ds_read_b64_tr_b16 v[226:227], v28 offset:8448
ds_read_b64_tr_b16 v[228:229], v28 offset:10240
ds_read_b64_tr_b16 v[230:231], v28 offset:10496
ds_read_b64_tr_b16 v[232:233], v28 offset:8224
ds_read_b64_tr_b16 v[234:235], v28 offset:8480
ds_read_b64_tr_b16 v[236:237], v28 offset:10272
ds_read_b64_tr_b16 v[238:239], v28 offset:10528
s_waitcnt lgkmcnt(0)
s_add_u32 s56, s54, 2621440
s_mov_b32 m0, 61440
s_nop 0
buffer_load_dwordx4 v26, s[16:19], s56 offen lds
s_add_u32 s56, s54, 2686976
s_mov_b32 m0, 62464
s_nop 0
buffer_load_dwordx4 v26, s[16:19], s56 offen lds
s_add_u32 s56, s54, 2883584
s_mov_b32 m0, 63488
s_nop 0
buffer_load_dwordx4 v26, s[16:19], s56 offen lds
s_add_u32 s56, s54, 2949120
s_mov_b32 m0, 64512
s_nop 0
buffer_load_dwordx4 v26, s[16:19], s56 offen lds
s_waitcnt vmcnt(32)
ds_read_b64_tr_b16 v[240:241], v28 offset:12288
ds_read_b64_tr_b16 v[242:243], v28 offset:12544
ds_read_b64_tr_b16 v[244:245], v28 offset:14336
ds_read_b64_tr_b16 v[246:247], v28 offset:14592
ds_read_b64_tr_b16 v[248:249], v28 offset:12320
ds_read_b64_tr_b16 v[250:251], v28 offset:12576
ds_read_b64_tr_b16 v[252:253], v28 offset:14368
ds_read_b64_tr_b16 v[254:255], v28 offset:14624
s_waitcnt lgkmcnt(0)
s_add_u32 s56, s54, 3145728
s_mov_b32 m0, 65536
s_nop 0
buffer_load_dwordx4 v26, s[16:19], s56 offen lds
s_add_u32 s56, s54, 3211264
s_mov_b32 m0, 66560
s_nop 0
buffer_load_dwordx4 v26, s[16:19], s56 offen lds
s_add_u32 s56, s54, 3407872
s_mov_b32 m0, 67584
s_nop 0
buffer_load_dwordx4 v26, s[16:19], s56 offen lds
s_add_u32 s56, s54, 3473408
s_mov_b32 m0, 68608
s_nop 0
buffer_load_dwordx4 v26, s[16:19], s56 offen lds
s_waitcnt vmcnt(32)
ds_read_b64_tr_b16 a[0:1], v28 offset:16384
ds_read_b64_tr_b16 a[2:3], v28 offset:16640
ds_read_b64_tr_b16 a[4:5], v28 offset:18432
ds_read_b64_tr_b16 a[6:7], v28 offset:18688
ds_read_b64_tr_b16 a[8:9], v28 offset:16416
ds_read_b64_tr_b16 a[10:11], v28 offset:16672
ds_read_b64_tr_b16 a[12:13], v28 offset:18464
ds_read_b64_tr_b16 a[14:15], v28 offset:18720
s_waitcnt lgkmcnt(0)
s_add_u32 s56, s54, 3670016
s_mov_b32 m0, 69632
s_nop 0
buffer_load_dwordx4 v26, s[16:19], s56 offen lds
s_add_u32 s56, s54, 3735552
s_mov_b32 m0, 70656
s_nop 0
buffer_load_dwordx4 v26, s[16:19], s56 offen lds
s_add_u32 s56, s54, 3932160
s_mov_b32 m0, 71680
s_nop 0
buffer_load_dwordx4 v26, s[16:19], s56 offen lds
s_add_u32 s56, s54, 3997696
s_mov_b32 m0, 72704
s_nop 0
buffer_load_dwordx4 v26, s[16:19], s56 offen lds
s_waitcnt vmcnt(32)
ds_read_b64_tr_b16 a[16:17], v28 offset:20480
ds_read_b64_tr_b16 a[18:19], v28 offset:20736
ds_read_b64_tr_b16 a[20:21], v28 offset:22528
ds_read_b64_tr_b16 a[22:23], v28 offset:22784
ds_read_b64_tr_b16 a[24:25], v28 offset:20512
ds_read_b64_tr_b16 a[26:27], v28 offset:20768
ds_read_b64_tr_b16 a[28:29], v28 offset:22560
ds_read_b64_tr_b16 a[30:31], v28 offset:22816
s_waitcnt lgkmcnt(0)
s_add_u32 s56, s54, 4194304
s_mov_b32 m0, 73728
s_nop 0
buffer_load_dwordx4 v26, s[16:19], s56 offen lds
s_add_u32 s56, s54, 4259840
s_mov_b32 m0, 74752
s_nop 0
buffer_load_dwordx4 v26, s[16:19], s56 offen lds
s_add_u32 s56, s54, 4456448
s_mov_b32 m0, 75776
s_nop 0
buffer_load_dwordx4 v26, s[16:19], s56 offen lds
s_add_u32 s56, s54, 4521984
s_mov_b32 m0, 76800
s_nop 0
buffer_load_dwordx4 v26, s[16:19], s56 offen lds
s_waitcnt vmcnt(32)
ds_read_b64_tr_b16 a[32:33], v28 offset:24576
ds_read_b64_tr_b16 a[34:35], v28 offset:24832
ds_read_b64_tr_b16 a[36:37], v28 offset:26624
ds_read_b64_tr_b16 a[38:39], v28 offset:26880
ds_read_b64_tr_b16 a[40:41], v28 offset:24608
ds_read_b64_tr_b16 a[42:43], v28 offset:24864
ds_read_b64_tr_b16 a[44:45], v28 offset:26656
ds_read_b64_tr_b16 a[46:47], v28 offset:26912
s_waitcnt lgkmcnt(0)
s_add_u32 s56, s55, 73792
s_mov_b32 m0, 77824
s_nop 0
buffer_load_dwordx4 v27, s[20:23], s56 offen lds
s_add_u32 s56, s55, 92224
s_mov_b32 m0, 78848
s_nop 0
buffer_load_dwordx4 v27, s[20:23], s56 offen lds
s_add_u32 s56, s55, 64
s_mov_b32 m0, 79872
s_nop 0
buffer_load_dwordx4 v27, s[20:23], s56 offen lds
s_add_u32 s56, s55, 18496
s_mov_b32 m0, 80896
s_nop 0
buffer_load_dwordx4 v27, s[20:23], s56 offen lds
s_waitcnt vmcnt(32)
ds_read_b64_tr_b16 a[48:49], v28 offset:28672
ds_read_b64_tr_b16 a[50:51], v28 offset:28928
ds_read_b64_tr_b16 a[52:53], v28 offset:30720
ds_read_b64_tr_b16 a[54:55], v28 offset:30976
ds_read_b64_tr_b16 a[56:57], v28 offset:28704
ds_read_b64_tr_b16 a[58:59], v28 offset:28960
ds_read_b64_tr_b16 a[60:61], v28 offset:30752
ds_read_b64_tr_b16 a[62:63], v28 offset:31008
s_waitcnt lgkmcnt(0)
s_add_u32 s56, s55, 74048
s_mov_b32 m0, 81920
s_nop 0
buffer_load_dwordx4 v27, s[20:23], s56 offen lds
s_add_u32 s56, s55, 92480
s_mov_b32 m0, 82944
s_nop 0
buffer_load_dwordx4 v27, s[20:23], s56 offen lds
s_add_u32 s56, s55, 320
s_mov_b32 m0, 83968
s_nop 0
buffer_load_dwordx4 v27, s[20:23], s56 offen lds
s_add_u32 s56, s55, 18752
s_mov_b32 m0, 84992
s_nop 0
buffer_load_dwordx4 v27, s[20:23], s56 offen lds
s_waitcnt vmcnt(32)
ds_read_b64_tr_b16 a[64:65], v28 offset:32768
ds_read_b64_tr_b16 a[66:67], v28 offset:33024
ds_read_b64_tr_b16 a[68:69], v28 offset:34816
ds_read_b64_tr_b16 a[70:71], v28 offset:35072
ds_read_b64_tr_b16 a[72:73], v28 offset:32800
ds_read_b64_tr_b16 a[74:75], v28 offset:33056
ds_read_b64_tr_b16 a[76:77], v28 offset:34848
ds_read_b64_tr_b16 a[78:79], v28 offset:35104
s_waitcnt lgkmcnt(0)
s_add_u32 s56, s55, 74304
s_mov_b32 m0, 86016
s_nop 0
buffer_load_dwordx4 v27, s[20:23], s56 offen lds
s_add_u32 s56, s55, 92736
s_mov_b32 m0, 87040
s_nop 0
buffer_load_dwordx4 v27, s[20:23], s56 offen lds
s_add_u32 s56, s55, 576
s_mov_b32 m0, 88064
s_nop 0
buffer_load_dwordx4 v27, s[20:23], s56 offen lds
s_add_u32 s56, s55, 19008
s_mov_b32 m0, 89088
s_nop 0
buffer_load_dwordx4 v27, s[20:23], s56 offen lds
s_waitcnt vmcnt(32)
ds_read_b64_tr_b16 a[80:81], v28 offset:36864
ds_read_b64_tr_b16 a[82:83], v28 offset:37120
ds_read_b64_tr_b16 a[84:85], v28 offset:38912
ds_read_b64_tr_b16 a[86:87], v28 offset:39168
ds_read_b64_tr_b16 a[88:89], v28 offset:36896
ds_read_b64_tr_b16 a[90:91], v28 offset:37152
ds_read_b64_tr_b16 a[92:93], v28 offset:38944
ds_read_b64_tr_b16 a[94:95], v28 offset:39200
s_waitcnt lgkmcnt(0)
s_add_u32 s56, s55, 74560
s_mov_b32 m0, 90112
s_nop 0
buffer_load_dwordx4 v27, s[20:23], s56 offen lds
s_add_u32 s56, s55, 92992
s_mov_b32 m0, 91136
s_nop 0
buffer_load_dwordx4 v27, s[20:23], s56 offen lds
s_add_u32 s56, s55, 832
s_mov_b32 m0, 92160
s_nop 0
buffer_load_dwordx4 v27, s[20:23], s56 offen lds
s_add_u32 s56, s55, 19264
s_mov_b32 m0, 93184
s_nop 0
buffer_load_dwordx4 v27, s[20:23], s56 offen lds
s_waitcnt vmcnt(32)
ds_read_b64_tr_b16 a[96:97], v28 offset:0
ds_read_b64_tr_b16 a[98:99], v28 offset:256
ds_read_b64_tr_b16 a[100:101], v28 offset:2048
ds_read_b64_tr_b16 a[102:103], v28 offset:2304
ds_read_b64_tr_b16 a[104:105], v28 offset:32
ds_read_b64_tr_b16 a[106:107], v28 offset:288
ds_read_b64_tr_b16 a[108:109], v28 offset:2080
ds_read_b64_tr_b16 a[110:111], v28 offset:2336
s_waitcnt lgkmcnt(0)
s_add_u32 s56, s55, 74816
s_mov_b32 m0, 94208
s_nop 0
buffer_load_dwordx4 v27, s[20:23], s56 offen lds
s_add_u32 s56, s55, 93248
s_mov_b32 m0, 95232
s_nop 0
buffer_load_dwordx4 v27, s[20:23], s56 offen lds
s_add_u32 s56, s55, 1088
s_mov_b32 m0, 96256
s_nop 0
buffer_load_dwordx4 v27, s[20:23], s56 offen lds
s_add_u32 s56, s55, 19520
s_mov_b32 m0, 97280
s_nop 0
buffer_load_dwordx4 v27, s[20:23], s56 offen lds
s_waitcnt vmcnt(32)
ds_read_b64_tr_b16 a[112:113], v28 offset:4096
ds_read_b64_tr_b16 a[114:115], v28 offset:4352
ds_read_b64_tr_b16 a[116:117], v28 offset:6144
ds_read_b64_tr_b16 a[118:119], v28 offset:6400
ds_read_b64_tr_b16 a[120:121], v28 offset:4128
ds_read_b64_tr_b16 a[122:123], v28 offset:4384
ds_read_b64_tr_b16 a[124:125], v28 offset:6176
ds_read_b64_tr_b16 a[126:127], v28 offset:6432
s_waitcnt lgkmcnt(0)
s_add_u32 s56, s54, 524288
s_mov_b32 m0, 57344
s_nop 0
buffer_load_dwordx4 v26, s[8:11], s56 offen lds
s_add_u32 s56, s54, 589824
s_mov_b32 m0, 58368
s_nop 0
buffer_load_dwordx4 v26, s[8:11], s56 offen lds
s_add_u32 s56, s54, 786432
s_mov_b32 m0, 59392
s_nop 0
buffer_load_dwordx4 v26, s[8:11], s56 offen lds
s_add_u32 s56, s54, 851968
s_mov_b32 m0, 60416
s_nop 0
buffer_load_dwordx4 v26, s[8:11], s56 offen lds
s_waitcnt vmcnt(32)
ds_read_b64_tr_b16 a[128:129], v28 offset:8192
ds_read_b64_tr_b16 a[130:131], v28 offset:8448
ds_read_b64_tr_b16 a[132:133], v28 offset:10240
ds_read_b64_tr_b16 a[134:135], v28 offset:10496
ds_read_b64_tr_b16 a[136:137], v28 offset:8224
ds_read_b64_tr_b16 a[138:139], v28 offset:8480
ds_read_b64_tr_b16 a[140:141], v28 offset:10272
ds_read_b64_tr_b16 a[142:143], v28 offset:10528
s_waitcnt lgkmcnt(0)
s_add_u32 s56, s54, 1572864
s_mov_b32 m0, 61440
s_nop 0
buffer_load_dwordx4 v26, s[8:11], s56 offen lds
s_add_u32 s56, s54, 1638400
s_mov_b32 m0, 62464
s_nop 0
buffer_load_dwordx4 v26, s[8:11], s56 offen lds
s_add_u32 s56, s54, 1835008
s_mov_b32 m0, 63488
s_nop 0
buffer_load_dwordx4 v26, s[8:11], s56 offen lds
s_add_u32 s56, s54, 1900544
s_mov_b32 m0, 64512
s_nop 0
buffer_load_dwordx4 v26, s[8:11], s56 offen lds
s_waitcnt vmcnt(32)
ds_read_b64_tr_b16 a[144:145], v28 offset:12288
ds_read_b64_tr_b16 a[146:147], v28 offset:12544
ds_read_b64_tr_b16 a[148:149], v28 offset:14336
ds_read_b64_tr_b16 a[150:151], v28 offset:14592
ds_read_b64_tr_b16 a[152:153], v28 offset:12320
ds_read_b64_tr_b16 a[154:155], v28 offset:12576
ds_read_b64_tr_b16 a[156:157], v28 offset:14368
ds_read_b64_tr_b16 a[158:159], v28 offset:14624
s_waitcnt lgkmcnt(0)
s_add_u32 s56, s54, 2621440
s_mov_b32 m0, 65536
s_nop 0
buffer_load_dwordx4 v26, s[8:11], s56 offen lds
s_add_u32 s56, s54, 2686976
s_mov_b32 m0, 66560
s_nop 0
buffer_load_dwordx4 v26, s[8:11], s56 offen lds
s_add_u32 s56, s54, 2883584
s_mov_b32 m0, 67584
s_nop 0
buffer_load_dwordx4 v26, s[8:11], s56 offen lds
s_add_u32 s56, s54, 2949120
s_mov_b32 m0, 68608
s_nop 0
buffer_load_dwordx4 v26, s[8:11], s56 offen lds
s_waitcnt vmcnt(32)
ds_read_b64_tr_b16 a[160:161], v28 offset:16384
ds_read_b64_tr_b16 a[162:163], v28 offset:16640
ds_read_b64_tr_b16 a[164:165], v28 offset:18432
ds_read_b64_tr_b16 a[166:167], v28 offset:18688
ds_read_b64_tr_b16 a[168:169], v28 offset:16416
ds_read_b64_tr_b16 a[170:171], v28 offset:16672
ds_read_b64_tr_b16 a[172:173], v28 offset:18464
ds_read_b64_tr_b16 a[174:175], v28 offset:18720
s_waitcnt lgkmcnt(0)
s_add_u32 s56, s54, 3145728
s_mov_b32 m0, 69632
s_nop 0
buffer_load_dwordx4 v26, s[12:15], s56 offen lds
s_add_u32 s56, s54, 3211264
s_mov_b32 m0, 70656
s_nop 0
buffer_load_dwordx4 v26, s[12:15], s56 offen lds
s_add_u32 s56, s54, 3407872
s_mov_b32 m0, 71680
s_nop 0
buffer_load_dwordx4 v26, s[12:15], s56 offen lds
s_add_u32 s56, s54, 3473408
s_mov_b32 m0, 72704
s_nop 0
buffer_load_dwordx4 v26, s[12:15], s56 offen lds
s_waitcnt vmcnt(32)
ds_read_b64_tr_b16 a[176:177], v29 offset:20480
ds_read_b64_tr_b16 a[178:179], v29 offset:20608
ds_read_b64_tr_b16 a[180:181], v29 offset:20992
ds_read_b64_tr_b16 a[182:183], v29 offset:21120
ds_read_b64_tr_b16 a[184:185], v29 offset:22528
ds_read_b64_tr_b16 a[186:187], v29 offset:22656
ds_read_b64_tr_b16 a[188:189], v29 offset:23040
ds_read_b64_tr_b16 a[190:191], v29 offset:23168
s_waitcnt lgkmcnt(0)
s_add_u32 s56, s54, 2097152
s_mov_b32 m0, 73728
s_nop 0
buffer_load_dwordx4 v26, s[16:19], s56 offen lds
s_add_u32 s56, s54, 2162688
s_mov_b32 m0, 74752
s_nop 0
buffer_load_dwordx4 v26, s[16:19], s56 offen lds
s_add_u32 s56, s54, 2359296
s_mov_b32 m0, 75776
s_nop 0
buffer_load_dwordx4 v26, s[16:19], s56 offen lds
s_add_u32 s56, s54, 2424832
s_mov_b32 m0, 76800
s_nop 0
buffer_load_dwordx4 v26, s[16:19], s56 offen lds
s_waitcnt vmcnt(32)
ds_read_b64_tr_b16 a[192:193], v29 offset:24576
ds_read_b64_tr_b16 a[194:195], v29 offset:24704
ds_read_b64_tr_b16 a[196:197], v29 offset:25088
ds_read_b64_tr_b16 a[198:199], v29 offset:25216
ds_read_b64_tr_b16 a[200:201], v29 offset:26624
ds_read_b64_tr_b16 a[202:203], v29 offset:26752
ds_read_b64_tr_b16 a[204:205], v29 offset:27136
ds_read_b64_tr_b16 a[206:207], v29 offset:27264
s_waitcnt lgkmcnt(0)
s_add_u32 s56, s55, 36928
s_mov_b32 m0, 77824
s_nop 0
buffer_load_dwordx4 v27, s[20:23], s56 offen lds
s_add_u32 s56, s55, 55360
s_mov_b32 m0, 78848
s_nop 0
buffer_load_dwordx4 v27, s[20:23], s56 offen lds
s_add_u32 s56, s55, 37184
s_mov_b32 m0, 79872
s_nop 0
buffer_load_dwordx4 v27, s[20:23], s56 offen lds
s_add_u32 s56, s55, 55616
s_mov_b32 m0, 80896
s_nop 0
buffer_load_dwordx4 v27, s[20:23], s56 offen lds
s_waitcnt vmcnt(32)
ds_read_b64_tr_b16 a[208:209], v29 offset:28672
ds_read_b64_tr_b16 a[210:211], v29 offset:28800
ds_read_b64_tr_b16 a[212:213], v29 offset:29184
ds_read_b64_tr_b16 a[214:215], v29 offset:29312
ds_read_b64_tr_b16 a[216:217], v29 offset:30720
ds_read_b64_tr_b16 a[218:219], v29 offset:30848
ds_read_b64_tr_b16 a[220:221], v29 offset:31232
ds_read_b64_tr_b16 a[222:223], v29 offset:31360
s_waitcnt lgkmcnt(0)
s_add_u32 s56, s55, 110656
s_mov_b32 m0, 81920
s_nop 0
buffer_load_dwordx4 v27, s[20:23], s56 offen lds
s_add_u32 s56, s55, 129088
s_mov_b32 m0, 82944
s_nop 0
buffer_load_dwordx4 v27, s[20:23], s56 offen lds
s_add_u32 s56, s55, 110912
s_mov_b32 m0, 83968
s_nop 0
buffer_load_dwordx4 v27, s[20:23], s56 offen lds
s_add_u32 s56, s55, 129344
s_mov_b32 m0, 84992
s_nop 0
buffer_load_dwordx4 v27, s[20:23], s56 offen lds
s_waitcnt vmcnt(32)
ds_read_b64_tr_b16 a[224:225], v29 offset:32768
ds_read_b64_tr_b16 a[226:227], v29 offset:32896
ds_read_b64_tr_b16 a[228:229], v29 offset:33280
ds_read_b64_tr_b16 a[230:231], v29 offset:33408
ds_read_b64_tr_b16 a[232:233], v29 offset:34816
ds_read_b64_tr_b16 a[234:235], v29 offset:34944
ds_read_b64_tr_b16 a[236:237], v29 offset:35328
ds_read_b64_tr_b16 a[238:239], v29 offset:35456
s_waitcnt lgkmcnt(0)
s_add_u32 s56, s55, 37440
s_mov_b32 m0, 86016
s_nop 0
buffer_load_dwordx4 v27, s[20:23], s56 offen lds
s_add_u32 s56, s55, 55872
s_mov_b32 m0, 87040
s_nop 0
buffer_load_dwordx4 v27, s[20:23], s56 offen lds
s_add_u32 s56, s55, 111168
s_mov_b32 m0, 88064
s_nop 0
buffer_load_dwordx4 v27, s[20:23], s56 offen lds
s_add_u32 s56, s55, 129600
s_mov_b32 m0, 89088
s_nop 0
buffer_load_dwordx4 v27, s[20:23], s56 offen lds
s_waitcnt vmcnt(32)
ds_read_b64_tr_b16 a[240:241], v29 offset:36864
ds_read_b64_tr_b16 a[242:243], v29 offset:36992
ds_read_b64_tr_b16 a[244:245], v29 offset:37376
ds_read_b64_tr_b16 a[246:247], v29 offset:37504
ds_read_b64_tr_b16 a[248:249], v29 offset:38912
ds_read_b64_tr_b16 a[250:251], v29 offset:39040
ds_read_b64_tr_b16 a[252:253], v29 offset:39424
ds_read_b64_tr_b16 a[254:255], v29 offset:39552
s_waitcnt lgkmcnt(0)
s_add_u32 s56, s55, 37696
s_mov_b32 m0, 90112
s_nop 0
buffer_load_dwordx4 v27, s[20:23], s56 offen lds
s_add_u32 s56, s55, 56128
s_mov_b32 m0, 91136
s_nop 0
buffer_load_dwordx4 v27, s[20:23], s56 offen lds
s_add_u32 s56, s55, 111424
s_mov_b32 m0, 92160
s_nop 0
buffer_load_dwordx4 v27, s[20:23], s56 offen lds
s_add_u32 s56, s55, 129856
s_mov_b32 m0, 93184
s_nop 0
buffer_load_dwordx4 v27, s[20:23], s56 offen lds
s_waitcnt vmcnt(32)
ds_read_b64_tr_b16 v[44:45], v28 offset:0
ds_read_b64_tr_b16 v[46:47], v28 offset:256
ds_read_b64_tr_b16 v[48:49], v28 offset:2048
ds_read_b64_tr_b16 v[50:51], v28 offset:2304
ds_read_b64_tr_b16 v[52:53], v28 offset:32
ds_read_b64_tr_b16 v[54:55], v28 offset:288
ds_read_b64_tr_b16 v[56:57], v28 offset:2080
ds_read_b64_tr_b16 v[58:59], v28 offset:2336
s_waitcnt lgkmcnt(0)
ds_write_b128 v2, v[44:47] offset:0
ds_write_b128 v2, v[48:51] offset:1024
ds_write_b128 v2, v[52:55] offset:2048
ds_write_b128 v2, v[56:59] offset:3072
s_waitcnt lgkmcnt(0)
s_add_u32 s56, s55, 37952
s_mov_b32 m0, 94208
s_nop 0
buffer_load_dwordx4 v27, s[20:23], s56 offen lds
s_add_u32 s56, s55, 56384
s_mov_b32 m0, 95232
s_nop 0
buffer_load_dwordx4 v27, s[20:23], s56 offen lds
s_add_u32 s56, s55, 111680
s_mov_b32 m0, 96256
s_nop 0
buffer_load_dwordx4 v27, s[20:23], s56 offen lds
s_add_u32 s56, s55, 130112
s_mov_b32 m0, 97280
s_nop 0
buffer_load_dwordx4 v27, s[20:23], s56 offen lds
s_waitcnt vmcnt(32)
ds_read_b64_tr_b16 v[44:45], v28 offset:4096
ds_read_b64_tr_b16 v[46:47], v28 offset:4352
ds_read_b64_tr_b16 v[48:49], v28 offset:6144
ds_read_b64_tr_b16 v[50:51], v28 offset:6400
ds_read_b64_tr_b16 v[52:53], v28 offset:4128
ds_read_b64_tr_b16 v[54:55], v28 offset:4384
ds_read_b64_tr_b16 v[56:57], v28 offset:6176
ds_read_b64_tr_b16 v[58:59], v28 offset:6432
s_waitcnt lgkmcnt(0)
ds_write_b128 v2, v[44:47] offset:4096
ds_write_b128 v2, v[48:51] offset:5120
ds_write_b128 v2, v[52:55] offset:6144
ds_write_b128 v2, v[56:59] offset:7168
s_waitcnt lgkmcnt(0)
s_waitcnt vmcnt(28)
ds_read_b64_tr_b16 v[44:45], v28 offset:8192
ds_read_b64_tr_b16 v[46:47], v28 offset:8448
ds_read_b64_tr_b16 v[48:49], v28 offset:10240
ds_read_b64_tr_b16 v[50:51], v28 offset:10496
ds_read_b64_tr_b16 v[52:53], v28 offset:8224
ds_read_b64_tr_b16 v[54:55], v28 offset:8480
ds_read_b64_tr_b16 v[56:57], v28 offset:10272
ds_read_b64_tr_b16 v[58:59], v28 offset:10528
s_waitcnt lgkmcnt(0)
ds_write_b128 v2, v[44:47] offset:8192
ds_write_b128 v2, v[48:51] offset:9216
ds_write_b128 v2, v[52:55] offset:10240
ds_write_b128 v2, v[56:59] offset:11264
s_waitcnt lgkmcnt(0)
s_waitcnt vmcnt(24)
ds_read_b64_tr_b16 v[44:45], v28 offset:12288
ds_read_b64_tr_b16 v[46:47], v28 offset:12544
ds_read_b64_tr_b16 v[48:49], v28 offset:14336
ds_read_b64_tr_b16 v[50:51], v28 offset:14592
ds_read_b64_tr_b16 v[52:53], v28 offset:12320
ds_read_b64_tr_b16 v[54:55], v28 offset:12576
ds_read_b64_tr_b16 v[56:57], v28 offset:14368
ds_read_b64_tr_b16 v[58:59], v28 offset:14624
s_waitcnt lgkmcnt(0)
ds_write_b128 v2, v[44:47] offset:12288
ds_write_b128 v2, v[48:51] offset:13312
ds_write_b128 v2, v[52:55] offset:14336
ds_write_b128 v2, v[56:59] offset:15360
s_waitcnt lgkmcnt(0)
s_waitcnt vmcnt(20)
ds_read_b64_tr_b16 v[44:45], v28 offset:16384
ds_read_b64_tr_b16 v[46:47], v28 offset:16640
ds_read_b64_tr_b16 v[48:49], v28 offset:18432
ds_read_b64_tr_b16 v[50:51], v28 offset:18688
ds_read_b64_tr_b16 v[52:53], v28 offset:16416
ds_read_b64_tr_b16 v[54:55], v28 offset:16672
ds_read_b64_tr_b16 v[56:57], v28 offset:18464
ds_read_b64_tr_b16 v[58:59], v28 offset:18720
s_waitcnt lgkmcnt(0)
ds_write_b128 v2, v[44:47] offset:16384
ds_write_b128 v2, v[48:51] offset:17408
ds_write_b128 v2, v[52:55] offset:18432
ds_write_b128 v2, v[56:59] offset:19456
s_waitcnt lgkmcnt(0)
s_waitcnt vmcnt(16)
ds_read_b64_tr_b16 v[44:45], v29 offset:20480
ds_read_b64_tr_b16 v[46:47], v29 offset:20608
ds_read_b64_tr_b16 v[48:49], v29 offset:20992
ds_read_b64_tr_b16 v[50:51], v29 offset:21120
ds_read_b64_tr_b16 v[52:53], v29 offset:22528
ds_read_b64_tr_b16 v[54:55], v29 offset:22656
ds_read_b64_tr_b16 v[56:57], v29 offset:23040
ds_read_b64_tr_b16 v[58:59], v29 offset:23168
s_waitcnt lgkmcnt(0)
ds_write_b128 v2, v[44:47] offset:20480
ds_write_b128 v2, v[48:51] offset:21504
ds_write_b128 v2, v[52:55] offset:22528
ds_write_b128 v2, v[56:59] offset:23552
s_waitcnt lgkmcnt(0)
s_waitcnt vmcnt(12)
ds_read_b64_tr_b16 v[44:45], v29 offset:24576
ds_read_b64_tr_b16 v[46:47], v29 offset:24704
ds_read_b64_tr_b16 v[48:49], v29 offset:25088
ds_read_b64_tr_b16 v[50:51], v29 offset:25216
ds_read_b64_tr_b16 v[52:53], v29 offset:26624
ds_read_b64_tr_b16 v[54:55], v29 offset:26752
ds_read_b64_tr_b16 v[56:57], v29 offset:27136
ds_read_b64_tr_b16 v[58:59], v29 offset:27264
s_waitcnt lgkmcnt(0)
ds_write_b128 v2, v[44:47] offset:24576
ds_write_b128 v2, v[48:51] offset:25600
ds_write_b128 v2, v[52:55] offset:26624
ds_write_b128 v2, v[56:59] offset:27648
s_waitcnt lgkmcnt(0)
s_waitcnt vmcnt(8)
ds_read_b64_tr_b16 v[44:45], v29 offset:28672
ds_read_b64_tr_b16 v[46:47], v29 offset:28800
ds_read_b64_tr_b16 v[48:49], v29 offset:29184
ds_read_b64_tr_b16 v[50:51], v29 offset:29312
ds_read_b64_tr_b16 v[52:53], v29 offset:30720
ds_read_b64_tr_b16 v[54:55], v29 offset:30848
ds_read_b64_tr_b16 v[56:57], v29 offset:31232
ds_read_b64_tr_b16 v[58:59], v29 offset:31360
s_waitcnt lgkmcnt(0)
ds_write_b128 v2, v[44:47] offset:28672
ds_write_b128 v2, v[48:51] offset:29696
ds_write_b128 v2, v[52:55] offset:30720
ds_write_b128 v2, v[56:59] offset:31744
s_waitcnt lgkmcnt(0)
s_waitcnt vmcnt(4)
ds_read_b64_tr_b16 v[44:45], v29 offset:32768
ds_read_b64_tr_b16 v[46:47], v29 offset:32896
ds_read_b64_tr_b16 v[48:49], v29 offset:33280
ds_read_b64_tr_b16 v[50:51], v29 offset:33408
ds_read_b64_tr_b16 v[52:53], v29 offset:34816
ds_read_b64_tr_b16 v[54:55], v29 offset:34944
ds_read_b64_tr_b16 v[56:57], v29 offset:35328
ds_read_b64_tr_b16 v[58:59], v29 offset:35456
s_waitcnt lgkmcnt(0)
ds_write_b128 v2, v[44:47] offset:32768
ds_write_b128 v2, v[48:51] offset:33792
ds_write_b128 v2, v[52:55] offset:34816
ds_write_b128 v2, v[56:59] offset:35840
s_waitcnt lgkmcnt(0)
s_waitcnt vmcnt(0)
ds_read_b64_tr_b16 v[44:45], v29 offset:36864
ds_read_b64_tr_b16 v[46:47], v29 offset:36992
ds_read_b64_tr_b16 v[48:49], v29 offset:37376
ds_read_b64_tr_b16 v[50:51], v29 offset:37504
ds_read_b64_tr_b16 v[52:53], v29 offset:38912
ds_read_b64_tr_b16 v[54:55], v29 offset:39040
ds_read_b64_tr_b16 v[56:57], v29 offset:39424
ds_read_b64_tr_b16 v[58:59], v29 offset:39552
s_waitcnt lgkmcnt(0)
ds_write_b128 v2, v[44:47] offset:36864
ds_write_b128 v2, v[48:51] offset:37888
ds_write_b128 v2, v[52:55] offset:38912
ds_write_b128 v2, v[56:59] offset:39936
s_waitcnt lgkmcnt(0)
v_mov_b32 v24, 0
L_rdv_w1r:
buffer_load_dword v23, v24, s[28:31], 0 offen sc0 sc1
s_sub_u32 s41, s41, 1
s_cbranch_scc1 L_exit
s_waitcnt vmcnt(0)
v_readfirstlane_b32 s56, v23
s_nop 0
s_and_b32 s57, s56, 0xff
s_cmp_lg_u32 s57, 32
s_cbranch_scc1 L_rdv_w1r
s_lshl_b32 s55, s32, 2
v_mov_b32 v24, 0
L_kvw_w1rp:
buffer_load_dword v23, v24, s[28:31], s55 offen offset:128 sc0 sc1
s_sub_u32 s41, s41, 1
s_cbranch_scc1 L_exit
s_waitcnt vmcnt(0)
v_readfirstlane_b32 s54, v23
s_nop 0
s_and_b32 s54, s54, 255
s_cmp_lg_u32 s54, 4
s_cbranch_scc1 L_kvw_w1rp
s_mov_b32 m0, 0
s_lshl_b32 s101, s32, 7
s_add_u32 s101, s101, 327680
s_mov_b32 s100, 22
s_lshl_b32 s58, s58, 5
s_cmp_eq_u32 s56, s58
s_cbranch_scc0 L_slow_w1r
buffer_load_dwordx4 v[12:15], v9, s[4:7], s37 offen offset:0
buffer_load_dwordx4 v[16:19], v9, s[4:7], s37 offen offset:1024
buffer_load_dwordx4 v[52:55], v1, s[4:7], s37 offen offset:2048
buffer_load_dwordx4 v[56:59], v1, s[4:7], s37 offen offset:3072
v_mov_b64 v[20:21], 0
v_mov_b64 v[22:23], 0
v_mov_b64 v[24:25], 0
v_mov_b64 v[26:27], 0
v_mov_b64 v[28:29], 0
v_mov_b64 v[30:31], 0
v_mov_b64 v[32:33], 0
v_mov_b64 v[34:35], 0
v_mov_b64 v[36:37], 0
v_mov_b64 v[38:39], 0
v_mov_b64 v[40:41], 0
v_mov_b64 v[42:43], 0
v_lshrrev_b32 v6, 2, v1
ds_read_b128 v[44:47], v2 offset:0
ds_read_b128 v[48:51], v2 offset:1024
s_waitcnt vmcnt(0)
buffer_load_dwordx4 v[60:63], v1, s[4:7], s47 offen sc1
buffer_load_dwordx4 v[68:71], v1, s[4:7], s38 offen sc1
s_waitcnt vmcnt(0)
.p2align 6
L_top_w1rf:
s_waitcnt vmcnt(5)
L_a0_w1rf:
s_waitcnt lgkmcnt(0)
v_smfmac_f32_16x16x64_bf16 v[20:23], v[60:63], v[44:51], v0
ds_write_b128 v1, v[60:63] offset:2048
v_smfmac_f32_16x16x64_bf16 v[28:31], v[60:63], v[176:183], v0
ds_read_b128 v[44:47], v2 offset:2048
buffer_load_dwordx4 v[64:67], v1, s[4:7], s48 offen sc1
v_smfmac_f32_16x16x64_bf16 v[32:35], v[60:63], v[184:191], v0
ds_read_b128 v[48:51], v2 offset:3072
buffer_load_dword v76, v6, s[4:7], s49 offen sc1
v_smfmac_f32_16x16x64_bf16 v[36:39], v[60:63], a[48:55], v0
s_waitcnt vmcnt(6)
v_bitop3_b32 v77, v60, v68, s35 bitop3:0x7e
v_smfmac_f32_16x16x64_bf16 v[40:43], v[60:63], a[56:63], v0
v_and_b32 v77, 1, v77
v_smfmac_f32_16x16x64_bf16 v[20:23], v[68:71], v[80:87], v0
v_cmp_ne_u32 vcc, 0, v77
s_waitcnt lgkmcnt(0)
v_smfmac_f32_16x16x64_bf16 v[24:27], v[60:63], v[44:51], v0
ds_read_b128 v[44:47], v2 offset:4096
v_smfmac_f32_16x16x64_bf16 v[24:27], v[68:71], v[88:95], v0
s_cbranch_vccnz L_ra0_w1rf
s_barrier
ds_read_b128 v[72:75], v1 offset:4096
v_smfmac_f32_16x16x64_bf16 v[28:31], v[68:71], v[192:199], v0
ds_read_b128 v[48:51], v2 offset:5120
v_smfmac_f32_16x16x64_bf16 v[32:35], v[68:71], v[200:207], v0
ds_read_b128 v[60:63], v1 offset:1024
v_smfmac_f32_16x16x64_bf16 v[36:39], v[68:71], a[64:71], v0
v_smfmac_f32_16x16x64_bf16 v[40:43], v[68:71], a[72:79], v0
s_waitcnt lgkmcnt(2)
s_waitcnt lgkmcnt(1)
v_smfmac_f32_16x16x64_bf16 v[20:23], v[72:75], v[44:51], v0
ds_read_b128 v[44:47], v2 offset:6144
v_smfmac_f32_16x16x64_bf16 v[28:31], v[72:75], v[208:215], v0
ds_read_b128 v[48:51], v2 offset:7168
v_smfmac_f32_16x16x64_bf16 v[32:35], v[72:75], v[216:223], v0
s_waitcnt vmcnt(0)
ds_write_b128 v1, v[64:67] offset:6144
v_smfmac_f32_16x16x64_bf16 v[36:39], v[72:75], a[80:87], v0
ds_write_addtid_b32 v76 offset:9472
v_bitop3_b32 v77, v64, s35, 1 bitop3:0x28
v_smfmac_f32_16x16x64_bf16 v[40:43], v[72:75], a[88:95], v0
v_bitop3_b32 v78, v76, s35, v11 bitop3:0x28
s_waitcnt lgkmcnt(2)
v_smfmac_f32_16x16x64_bf16 v[24:27], v[72:75], v[44:51], v0
ds_read_b128 v[44:47], v2 offset:8192
v_or_b32 v77, v77, v78
v_smfmac_f32_16x16x64_bf16 v[20:23], v[60:63], v[96:103], v0
ds_read_b128 v[48:51], v2 offset:9216
v_cmp_ne_u32 vcc, 0, v77
v_smfmac_f32_16x16x64_bf16 v[24:27], v[60:63], v[104:111], v0
v_smfmac_f32_16x16x64_bf16 v[36:39], v[60:63], a[96:103], v0
s_cbranch_vccnz L_ra1_w1rf
L_a1_w1rf:
s_waitcnt lgkmcnt(2)
s_barrier
ds_read_b128 v[68:71], v1 offset:7168
v_smfmac_f32_16x16x64_bf16 v[28:31], v[60:63], v[224:231], v0
ds_read_b128 v[72:75], v1 offset:8192
v_lshlrev_b32 v6, 2, v1
v_smfmac_f32_16x16x64_bf16 v[40:43], v[60:63], a[104:111], v0
ds_read_b128 v[76:79], v1 offset:9216
v_smfmac_f32_16x16x64_bf16 v[32:35], v[60:63], v[232:239], v0
ds_read_b128 v[60:63], v1 offset:5120
s_waitcnt lgkmcnt(4)
v_smfmac_f32_16x16x64_bf16 v[20:23], v[64:67], v[44:51], v0
ds_read_b128 v[44:47], v2 offset:10240
buffer_load_dword v6, s[4:7], s39 offen lds
s_waitcnt lgkmcnt(4)
v_smfmac_f32_16x16x64_bf16 v[20:23], v[68:71], v[112:119], v0
ds_read_b128 v[48:51], v2 offset:11264
v_smfmac_f32_16x16x64_bf16 v[24:27], v[68:71], v[120:127], v0
s_waitcnt lgkmcnt(4)
v_smfmac_f32_16x16x64_bf16 v[20:23], v[72:75], v[128:135], v0
s_waitcnt lgkmcnt(3)
v_smfmac_f32_16x16x64_bf16 v[20:23], v[76:79], v[160:167], v0
s_waitcnt lgkmcnt(2)
v_smfmac_f32_16x16x64_bf16 v[20:23], v[60:63], v[144:151], v0
s_waitcnt lgkmcnt(0)
v_smfmac_f32_16x16x64_bf16 v[24:27], v[64:67], v[44:51], v0
ds_read_b128 v[44:47], v2 offset:12288
v_smfmac_f32_16x16x64_bf16 v[24:27], v[72:75], v[136:143], v0
ds_read_b128 v[48:51], v2 offset:13312
v_add_f32 v20, v20, v22
v_smfmac_f32_16x16x64_bf16 v[24:27], v[76:79], v[168:175], v0
v_add_f32 v21, v21, v23
v_smfmac_f32_16x16x64_bf16 v[24:27], v[60:63], v[152:159], v0
v_cvt_pk_bf16_f32 v22, v20, v21
v_smfmac_f32_16x16x64_bf16 v[28:31], v[64:67], v[240:247], v0
v_smfmac_f32_16x16x64_bf16 v[28:31], v[72:75], a[0:7], v0
v_add_f32 v24, v24, v26
v_add_f32 v25, v25, v27
v_cvt_pk_bf16_f32 v23, v24, v25
s_waitcnt lgkmcnt(0)
v_smfmac_f32_16x16x64_bf16 v[28:31], v[68:71], v[44:51], v0
ds_write_b64 v3, v[22:23] offset:10752
v_smfmac_f32_16x16x64_bf16 v[28:31], v[76:79], a[32:39], v0
ds_read_b128 v[44:47], v2 offset:14336
v_smfmac_f32_16x16x64_bf16 v[28:31], v[60:63], a[16:23], v0
ds_read_b128 v[48:51], v2 offset:15360
v_smfmac_f32_16x16x64_bf16 v[32:35], v[64:67], v[248:255], v0
s_waitcnt lgkmcnt(2)
s_barrier
ds_read_b64_tr_b16 v[20:21], v4 offset:10240
ds_read_b64_tr_b16 v[22:23], v4 offset:10752
v_smfmac_f32_16x16x64_bf16 v[32:35], v[72:75], a[8:15], v0
ds_read_b64_tr_b16 v[24:25], v4 offset:11264
v_add_f32 v28, v28, v30
v_smfmac_f32_16x16x64_bf16 v[32:35], v[76:79], a[40:47], v0
ds_read_b64_tr_b16 v[26:27], v4 offset:11776
v_add_f32 v29, v29, v31
s_waitcnt lgkmcnt(4)
v_smfmac_f32_16x16x64_bf16 v[32:35], v[68:71], v[44:51], v0
ds_read_b128 v[44:47], v2 offset:18432
v_cvt_pk_bf16_f32 v30, v28, v29
v_smfmac_f32_16x16x64_bf16 v[32:35], v[60:63], a[24:31], v0
ds_read_b128 v[48:51], v2 offset:19456
s_waitcnt lgkmcnt(4)
v_mfma_f32_16x16x32_bf16 v[12:15], v[12:15], v[20:23], 0
s_waitcnt lgkmcnt(2)
v_mfma_f32_16x16x32_bf16 v[12:15], v[16:19], v[24:27], v[12:15]
v_add_f32 v32, v32, v34
v_add_f32 v33, v33, v35
v_cvt_pk_bf16_f32 v31, v32, v33
ds_write_b64 v3, v[30:31] offset:12800
v_smfmac_f32_16x16x64_bf16 v[36:39], v[64:67], a[112:119], v0
s_nop 2
v_add_f32_dpp v12, v14, v12 quad_perm:[2,3,0,1] row_mask:0xf bank_mask:0xf
v_add_f32_dpp v13, v15, v13 quad_perm:[2,3,0,1] row_mask:0xf bank_mask:0xf
ds_write_b64 v5, v[12:13] offset:14592
v_smfmac_f32_16x16x64_bf16 v[40:43], v[64:67], a[120:127], v0
s_waitcnt lgkmcnt(1)
s_barrier
ds_read_b64_tr_b16 v[64:65], v4 offset:12288
ds_read_b64_tr_b16 v[66:67], v4 offset:12800
v_smfmac_f32_16x16x64_bf16 v[36:39], v[68:71], a[128:135], v0
ds_read_b64_tr_b16 v[16:17], v4 offset:13312
ds_read_b64_tr_b16 v[18:19], v4 offset:13824
v_smfmac_f32_16x16x64_bf16 v[40:43], v[68:71], a[136:143], v0
s_waitcnt lgkmcnt(4)
s_barrier
ds_read_b128 v[68:71], v1 offset:14336
v_smfmac_f32_16x16x64_bf16 v[40:43], v[60:63], v[44:51], v0
ds_read_b128 v[44:47], v2 offset:16384
s_waitcnt lgkmcnt(4)
v_mfma_f32_16x16x32_bf16 v[64:67], v[64:67], v[20:23], 0
ds_read_b128 v[48:51], v2 offset:17408
s_waitcnt lgkmcnt(3)
v_mfma_f32_16x16x32_bf16 v[64:67], v[16:19], v[24:27], v[64:67]
v_smfmac_f32_16x16x64_bf16 v[40:43], v[72:75], a[152:159], v0
ds_read_b128 v[12:15], v2 offset:22528
s_waitcnt lgkmcnt(3)
v_max3_f32 v25, v68, v69, v70
v_smfmac_f32_16x16x64_bf16 v[40:43], v[76:79], a[168:175], v0
ds_read_b128 v[16:19], v2 offset:23552
v_add_f32_dpp v64, v66, v64 quad_perm:[2,3,0,1] row_mask:0xf bank_mask:0xf
v_add_f32_dpp v65, v67, v65 quad_perm:[2,3,0,1] row_mask:0xf bank_mask:0xf
v_max_f32 v25, v25, v71
v_max_f32 v24, v64, v65
v_mul_f32 v24, s50, v24
v_max_f32_dpp v25, v25, v25 quad_perm:[2,3,0,1] row_mask:0xf bank_mask:0xf
v_smfmac_f32_16x16x64_bf16 v[36:39], v[72:75], a[144:151], v0
s_nop 0
v_max_f32_dpp v26, v24, v25 quad_perm:[0,1,0,1] row_mask:0xf bank_mask:0xf
v_max_f32_dpp v27, v24, v25 quad_perm:[0,1,0,1] row_mask:0xf bank_mask:0xf
v_smfmac_f32_16x16x64_bf16 v[36:39], v[76:79], a[160:167], v0
s_nop 0
v_permlane16_swap_b32 v26, v27
v_max_f32 v28, v26, v27
v_max_f32 v29, v26, v27
s_waitcnt lgkmcnt(2)
v_smfmac_f32_16x16x64_bf16 v[36:39], v[60:63], v[44:51], v0
v_permlane32_swap_b32 v28, v29
v_max_f32 v28, v28, v29
v_sub_f32 v68, v68, v28
v_sub_f32 v69, v69, v28
v_sub_f32 v70, v70, v28
v_sub_f32 v71, v71, v28
v_exp_f32 v68, v68
v_exp_f32 v69, v69
v_exp_f32 v70, v70
v_exp_f32 v71, v71
v_cvt_pk_bf16_f32 v20, v68, v69
v_cvt_pk_bf16_f32 v21, v70, v71
v_pk_add_f32 v[36:37], v[36:37], v[38:39]
v_mov_b32_dpp v22, v20 quad_perm:[2,3,0,1] row_mask:0xf bank_mask:0xf
v_mov_b32_dpp v23, v21 quad_perm:[2,3,0,1] row_mask:0xf bank_mask:0xf
v_pk_fma_f32 v[64:65], v[64:65], s[50:51], v[28:29] op_sel_hi:[1,1,0] neg_lo:[0,0,1] neg_hi:[0,0,1]
v_cvt_pk_bf16_f32 v32, v36, v37
v_pk_add_f32 v[40:41], v[40:41], v[42:43]
v_mfma_f32_16x16x32_bf16 v[36:39], v[52:55], v[20:23], 0
v_mov_b64 v[72:73], s[52:53]
v_mov_b64 v[74:75], s[52:53]
v_cvt_pk_bf16_f32 v33, v40, v41
v_exp_f32 v64, v64
v_mfma_f32_16x16x32_bf16 v[68:71], v[72:75], v[20:23], 0
v_exp_f32 v65, v65
v_mov_b32 v25, 0
v_cvt_pk_bf16_f32 v24, v64, v65
v_mfma_f32_16x16x32_bf16 v[40:43], v[56:59], v[20:23], 0
v_cvt_pk_bf16_f32 v27, v64, v65
v_mov_b32 v26, 0
v_mfma_f32_16x16x16_bf16 v[68:71], v[72:73], v[24:25], v[68:71]
ds_read_b128 v[44:47], v2 offset:20480
v_mfma_f32_16x16x16_bf16 v[36:39], v[32:33], v[24:25], v[36:39]
ds_read_b128 v[48:51], v2 offset:21504
v_mfma_f32_16x16x16_bf16 v[40:43], v[32:33], v[26:27], v[40:43]
v_rcp_f32 v68, v68
v_mov_b64 v[76:77], 0
v_mov_b64 v[78:79], 0
s_nop 0
v_mul_f32 v36, v36, v68
v_mul_f32 v37, v37, v68
v_mul_f32 v38, v38, v68
v_mul_f32 v39, v39, v68
v_pk_mul_f32 v[40:41], v[40:41], v[68:69] op_sel_hi:[1,0]
v_pk_mul_f32 v[42:43], v[42:43], v[68:69] op_sel_hi:[1,0]
v_cvt_pk_bf16_f32 v36, v36, v37
v_cvt_pk_bf16_f32 v37, v38, v39
v_cvt_pk_bf16_f32 v38, v40, v41
v_cvt_pk_bf16_f32 v39, v42, v43
ds_write_b128 v1, v[36:39] offset:6144
ds_read_b128 v[60:63], v7 offset:6144
buffer_store_dwordx4 v[30:33], v1, s[4:7], s40 offen sc0 sc1
ds_read_b128 v[52:55], v2 offset:24576
ds_read_b128 v[56:59], v2 offset:25600
s_cmp_eq_u32 s34, s100
v_mov_b64 v[20:21], 0
v_mov_b64 v[22:23], 0
s_cbranch_scc1 L_ev_w1rf
L_evb_w1rf:
s_waitcnt lgkmcnt(3)
s_barrier
ds_read_b128 v[64:67], v7 offset:7168
ds_read_b128 v[68:71], v7 offset:8192
ds_read_b128 v[72:75], v7 offset:5120
s_waitcnt lgkmcnt(5)
v_smfmac_f32_16x16x64_bf16 v[76:79], v[60:63], v[44:51], v0 abid:1
ds_read_b128 v[44:47], v2 offset:26624
v_mov_b64 v[24:25], 0
v_smfmac_f32_16x16x64_bf16 v[20:23], v[60:63], v[12:19], v0 abid:1
ds_read_b128 v[48:51], v2 offset:27648
v_mov_b64 v[26:27], 0
s_waitcnt lgkmcnt(4)
v_smfmac_f32_16x16x64_bf16 v[76:79], v[64:67], a[176:183], v0 abid:1
ds_read_b128 v[12:15], v2 offset:28672
v_mov_b64 v[40:41], 0
s_waitcnt lgkmcnt(4)
v_smfmac_f32_16x16x64_bf16 v[76:79], v[68:71], v[52:59], v0 abid:1
ds_read_b128 v[16:19], v2 offset:29696
v_mov_b64 v[42:43], 0
s_waitcnt lgkmcnt(4)
v_smfmac_f32_16x16x64_bf16 v[76:79], v[72:75], a[184:191], v0 abid:1
ds_read_b128 v[52:55], v2 offset:30720
v_mov_b64 v[36:37], 0
v_smfmac_f32_16x16x64_bf16 v[20:23], v[64:67], a[192:199], v0 abid:1
ds_read_b128 v[56:59], v2 offset:31744
v_mov_b64 v[38:39], 0
s_waitcnt lgkmcnt(4)
v_smfmac_f32_16x16x64_bf16 v[20:23], v[68:71], v[44:51], v0 abid:1
ds_read_b128 v[44:47], v2 offset:32768
v_cvt_pk_bf16_f32 v76, v76, v77
v_cvt_pk_bf16_f32 v77, v78, v79
v_bfi_b32 v76, 1, s35, v76
buffer_store_dwordx2 v[76:77], v8, s[4:7], s42 offen
v_smfmac_f32_16x16x64_bf16 v[20:23], v[72:75], a[200:207], v0 abid:1
ds_read_b128 v[48:51], v2 offset:33792
s_waitcnt lgkmcnt(4)
v_smfmac_f32_16x16x64_bf16 v[24:27], v[60:63], v[12:19], v0 abid:1
ds_read_b128 v[12:15], v2 offset:34816
v_smfmac_f32_16x16x64_bf16 v[24:27], v[64:67], a[208:215], v0 abid:1
ds_read_b128 v[16:19], v2 offset:35840
v_cvt_pk_bf16_f32 v20, v20, v21
v_cvt_pk_bf16_f32 v21, v22, v23
v_bfi_b32 v20, 1, s35, v20
buffer_store_dwordx2 v[20:21], v8, s[4:7], s43 offen
s_waitcnt lgkmcnt(4)
v_smfmac_f32_16x16x64_bf16 v[24:27], v[68:71], v[52:59], v0 abid:1
ds_read_b128 v[52:55], v2 offset:36864
v_smfmac_f32_16x16x64_bf16 v[24:27], v[72:75], a[216:223], v0 abid:1
ds_read_b128 v[56:59], v2 offset:37888
s_waitcnt lgkmcnt(4)
v_smfmac_f32_16x16x64_bf16 v[40:43], v[60:63], v[44:51], v0 abid:1
ds_read_b128 v[44:47], v2 offset:38912
v_smfmac_f32_16x16x64_bf16 v[40:43], v[64:67], a[224:231], v0 abid:1
ds_read_b128 v[48:51], v2 offset:39936
v_cvt_pk_bf16_f32 v24, v24, v25
s_waitcnt lgkmcnt(4)
v_smfmac_f32_16x16x64_bf16 v[40:43], v[68:71], v[12:19], v0 abid:1
v_cvt_pk_bf16_f32 v25, v26, v27
v_smfmac_f32_16x16x64_bf16 v[40:43], v[72:75], a[232:239], v0 abid:1
v_bfi_b32 v24, 1, s35, v24
buffer_store_dwordx2 v[24:25], v8, s[4:7], s44 offen
s_waitcnt lgkmcnt(2)
v_smfmac_f32_16x16x64_bf16 v[36:39], v[60:63], v[52:59], v0 abid:1
v_smfmac_f32_16x16x64_bf16 v[36:39], v[64:67], a[240:247], v0 abid:1
v_cvt_pk_bf16_f32 v40, v40, v41
s_waitcnt lgkmcnt(0)
v_smfmac_f32_16x16x64_bf16 v[36:39], v[68:71], v[44:51], v0 abid:1
v_cvt_pk_bf16_f32 v41, v42, v43
v_smfmac_f32_16x16x64_bf16 v[36:39], v[72:75], a[248:255], v0 abid:1
v_bfi_b32 v40, 1, s35, v40
buffer_store_dwordx2 v[40:41], v8, s[4:7], s45 offen
s_nop 5
v_cvt_pk_bf16_f32 v36, v36, v37
v_cvt_pk_bf16_f32 v37, v38, v39
v_bfi_b32 v36, 1, s35, v36
buffer_store_dwordx2 v[36:37], v8, s[4:7], s46 offen
s_add_u32 s34, s34, 1
s_add_u32 s37, s37, 524288
s_add_u32 s39, s39, 524288
v_and_b32 v6, 0x70, v1
ds_read_b128 v[76:79], v6 offset:256
v_mov_b64 v[20:21], 0
v_mov_b64 v[22:23], 0
v_mov_b64 v[24:25], 0
v_mov_b64 v[26:27], 0
v_mov_b64 v[28:29], 0
v_mov_b64 v[34:35], 0
v_mov_b64 v[36:37], 0
v_mov_b64 v[38:39], 0
v_mov_b64 v[40:41], 0
v_mov_b64 v[42:43], 0
s_waitcnt vmcnt(0)
buffer_load_dwordx4 v[44:47], v9, s[4:7], s3 offen offset:0 sc1
buffer_load_dwordx4 v[48:51], v9, s[4:7], s3 offen offset:1024 sc1
buffer_load_dwordx4 v[52:55], v9, s[4:7], s3 offen offset:2048 sc1
buffer_load_dwordx4 v[56:59], v9, s[4:7], s3 offen offset:3072 sc1
s_waitcnt lgkmcnt(0)
s_waitcnt vmcnt(3)
L_r_w1rf:
v_mfma_f32_16x16x32_bf16 v[72:75], v[44:47], v[76:79], 0
s_waitcnt vmcnt(2)
v_mfma_f32_16x16x32_bf16 v[72:75], v[48:51], v[76:79], v[72:75]
v_bitop3_b32 v68, v44, v48, s35 bitop3:0x7e
s_waitcnt vmcnt(1)
v_mfma_f32_16x16x32_bf16 v[72:75], v[52:55], v[76:79], v[72:75]
s_waitcnt vmcnt(0)
v_mfma_f32_16x16x32_bf16 v[72:75], v[56:59], v[76:79], v[72:75]
v_bitop3_b32 v69, v52, v56, s35 bitop3:0x7e
v_bitop3_b32 v68, v68, v69, 1 bitop3:0xa8
v_cmp_ne_u32 vcc, 0, v68
s_cbranch_vccnz L_rr_w1rf
ds_read_b128 v[44:47], v2 offset:0
ds_read_b128 v[48:51], v2 offset:1024
s_nop 1
v_pk_add_f32 v[72:73], v[72:73], v[74:75]
v_cvt_pk_bf16_f32 v68, v72, v73
v_bfi_b32 v68, v11, s36, v68
buffer_store_dword v68, v10, s[4:7], 0 offen
s_not_b32 s35, s35
s_not_b32 s36, s36
v_lshrrev_b32 v6, 2, v1
s_barrier
buffer_load_dwordx4 v[60:63], v1, s[4:7], s47 offen sc1
buffer_load_dwordx4 v[68:71], v1, s[4:7], s38 offen sc1
s_add_u32 s40, s40, 131072
v_mov_b64 v[30:31], 0
v_mov_b64 v[32:33], 0
buffer_load_dwordx4 v[12:15], v9, s[4:7], s37 offen offset:0
buffer_load_dwordx4 v[16:19], v9, s[4:7], s37 offen offset:1024
buffer_load_dwordx4 v[52:55], v1, s[4:7], s37 offen offset:2048
buffer_load_dwordx4 v[56:59], v1, s[4:7], s37 offen offset:3072
s_branch L_top_w1rf
L_done_w1rf:
s_waitcnt vmcnt(0)
s_barrier
s_waitcnt vmcnt(0) lgkmcnt(0)
s_endpgm
L_ra0_w1rf:
buffer_load_dwordx4 v[60:63], v1, s[4:7], s47 offen sc1
buffer_load_dwordx4 v[68:71], v1, s[4:7], s38 offen sc1
s_sub_u32 s41, s41, 1
s_cbranch_scc1 L_exit
ds_read_b128 v[44:47], v2 offset:0
ds_read_b128 v[48:51], v2 offset:1024
s_waitcnt vmcnt(0) lgkmcnt(0)
v_mov_b64 v[20:21], 0
v_mov_b64 v[22:23], 0
v_mov_b64 v[24:25], 0
v_mov_b64 v[26:27], 0
v_mov_b64 v[28:29], 0
v_mov_b64 v[30:31], 0
v_mov_b64 v[32:33], 0
v_mov_b64 v[34:35], 0
v_mov_b64 v[36:37], 0
v_mov_b64 v[38:39], 0
v_mov_b64 v[40:41], 0
v_mov_b64 v[42:43], 0
s_nop 0
s_branch L_a0_w1rf
L_ra1_w1rf:
buffer_load_dwordx4 v[64:67], v1, s[4:7], s48 offen sc1
buffer_load_dword v76, v6, s[4:7], s49 offen sc1
s_sub_u32 s41, s41, 1
s_cbranch_scc1 L_exit
s_waitcnt vmcnt(0)
v_bitop3_b32 v77, v64, s35, 1 bitop3:0x28
v_bitop3_b32 v78, v76, s35, v11 bitop3:0x28
v_or_b32 v77, v77, v78
v_cmp_ne_u32 vcc, 0, v77
s_cbranch_vccnz L_ra1_w1rf
ds_write_b128 v1, v[64:67] offset:6144
ds_write_addtid_b32 v76 offset:9472
s_waitcnt lgkmcnt(0)
s_branch L_a1_w1rf
L_ev_w1rf:
s_cmp_eq_u32 s34, 63
s_cbranch_scc1 L_done_w1rf
s_mov_b32 s100, 63

s_lshl_b32 s55, s32, 2
v_mov_b32 v34, 0
L_kvw_w1rf:
buffer_load_dword v29, v34, s[28:31], s55 offen offset:128 sc0 sc1
s_sub_u32 s41, s41, 1
s_cbranch_scc1 L_exit
s_waitcnt vmcnt(0)
v_readfirstlane_b32 s54, v29
s_nop 0
s_and_b32 s54, s54, 65280
s_cmp_lg_u32 s54, 1024
s_cbranch_scc1 L_kvw_w1rf
s_branch L_evb_w1rf
L_rr_w1rf:
buffer_load_dwordx4 v[44:47], v9, s[4:7], s3 offen offset:0 sc1
buffer_load_dwordx4 v[48:51], v9, s[4:7], s3 offen offset:1024 sc1
buffer_load_dwordx4 v[52:55], v9, s[4:7], s3 offen offset:2048 sc1
buffer_load_dwordx4 v[56:59], v9, s[4:7], s3 offen offset:3072 sc1
s_sub_u32 s41, s41, 1
s_cbranch_scc1 L_exit
s_waitcnt vmcnt(0)
s_branch L_r_w1rf
L_slow_w1r:
buffer_load_dwordx4 v[12:15], v9, s[4:7], s37 offen offset:0
buffer_load_dwordx4 v[16:19], v9, s[4:7], s37 offen offset:1024
buffer_load_dwordx4 v[52:55], v1, s[4:7], s37 offen offset:2048
buffer_load_dwordx4 v[56:59], v1, s[4:7], s37 offen offset:3072
v_mov_b64 v[20:21], 0
v_mov_b64 v[22:23], 0
v_mov_b64 v[24:25], 0
v_mov_b64 v[26:27], 0
v_mov_b64 v[28:29], 0
v_mov_b64 v[30:31], 0
v_mov_b64 v[32:33], 0
v_mov_b64 v[34:35], 0
v_mov_b64 v[36:37], 0
v_mov_b64 v[38:39], 0
v_mov_b64 v[40:41], 0
v_mov_b64 v[42:43], 0
v_lshrrev_b32 v6, 2, v1
ds_read_b128 v[44:47], v2 offset:0
ds_read_b128 v[48:51], v2 offset:1024
s_waitcnt vmcnt(0)
buffer_load_dwordx4 v[60:63], v1, s[4:7], s47 offen sc0 sc1
buffer_load_dwordx4 v[68:71], v1, s[4:7], s38 offen sc0 sc1
s_waitcnt vmcnt(0)
.p2align 6
L_top_w1rs:
s_waitcnt vmcnt(5)
L_a0_w1rs:
s_waitcnt lgkmcnt(0)
v_smfmac_f32_16x16x64_bf16 v[20:23], v[60:63], v[44:51], v0
ds_write_b128 v1, v[60:63] offset:2048
v_smfmac_f32_16x16x64_bf16 v[28:31], v[60:63], v[176:183], v0
ds_read_b128 v[44:47], v2 offset:2048
buffer_load_dwordx4 v[64:67], v1, s[4:7], s48 offen sc0 sc1
v_smfmac_f32_16x16x64_bf16 v[32:35], v[60:63], v[184:191], v0
ds_read_b128 v[48:51], v2 offset:3072
buffer_load_dword v76, v6, s[4:7], s49 offen sc0 sc1
v_smfmac_f32_16x16x64_bf16 v[36:39], v[60:63], a[48:55], v0
s_waitcnt vmcnt(6)
v_bitop3_b32 v77, v60, v68, s35 bitop3:0x7e
v_smfmac_f32_16x16x64_bf16 v[40:43], v[60:63], a[56:63], v0
v_and_b32 v77, 1, v77
v_smfmac_f32_16x16x64_bf16 v[20:23], v[68:71], v[80:87], v0
v_cmp_ne_u32 vcc, 0, v77
s_waitcnt lgkmcnt(0)
v_smfmac_f32_16x16x64_bf16 v[24:27], v[60:63], v[44:51], v0
ds_read_b128 v[44:47], v2 offset:4096
v_smfmac_f32_16x16x64_bf16 v[24:27], v[68:71], v[88:95], v0
s_cbranch_vccnz L_ra0_w1rs
s_barrier
ds_read_b128 v[72:75], v1 offset:4096
v_smfmac_f32_16x16x64_bf16 v[28:31], v[68:71], v[192:199], v0
ds_read_b128 v[48:51], v2 offset:5120
v_smfmac_f32_16x16x64_bf16 v[32:35], v[68:71], v[200:207], v0
ds_read_b128 v[60:63], v1 offset:1024
v_smfmac_f32_16x16x64_bf16 v[36:39], v[68:71], a[64:71], v0
v_smfmac_f32_16x16x64_bf16 v[40:43], v[68:71], a[72:79], v0
s_waitcnt lgkmcnt(2)
s_waitcnt lgkmcnt(1)
v_smfmac_f32_16x16x64_bf16 v[20:23], v[72:75], v[44:51], v0
ds_read_b128 v[44:47], v2 offset:6144
v_smfmac_f32_16x16x64_bf16 v[28:31], v[72:75], v[208:215], v0
ds_read_b128 v[48:51], v2 offset:7168
v_smfmac_f32_16x16x64_bf16 v[32:35], v[72:75], v[216:223], v0
s_waitcnt vmcnt(0)
ds_write_b128 v1, v[64:67] offset:6144
v_smfmac_f32_16x16x64_bf16 v[36:39], v[72:75], a[80:87], v0
ds_write_addtid_b32 v76 offset:9472
v_bitop3_b32 v77, v64, s35, 1 bitop3:0x28
v_smfmac_f32_16x16x64_bf16 v[40:43], v[72:75], a[88:95], v0
v_bitop3_b32 v78, v76, s35, v11 bitop3:0x28
s_waitcnt lgkmcnt(2)
v_smfmac_f32_16x16x64_bf16 v[24:27], v[72:75], v[44:51], v0
ds_read_b128 v[44:47], v2 offset:8192
v_or_b32 v77, v77, v78
v_smfmac_f32_16x16x64_bf16 v[20:23], v[60:63], v[96:103], v0
ds_read_b128 v[48:51], v2 offset:9216
v_cmp_ne_u32 vcc, 0, v77
v_smfmac_f32_16x16x64_bf16 v[24:27], v[60:63], v[104:111], v0
v_smfmac_f32_16x16x64_bf16 v[36:39], v[60:63], a[96:103], v0
s_cbranch_vccnz L_ra1_w1rs
L_a1_w1rs:
s_waitcnt lgkmcnt(2)
s_barrier
ds_read_b128 v[68:71], v1 offset:7168
v_smfmac_f32_16x16x64_bf16 v[28:31], v[60:63], v[224:231], v0
ds_read_b128 v[72:75], v1 offset:8192
v_lshlrev_b32 v6, 2, v1
v_smfmac_f32_16x16x64_bf16 v[40:43], v[60:63], a[104:111], v0
ds_read_b128 v[76:79], v1 offset:9216
v_smfmac_f32_16x16x64_bf16 v[32:35], v[60:63], v[232:239], v0
ds_read_b128 v[60:63], v1 offset:5120
s_waitcnt lgkmcnt(4)
v_smfmac_f32_16x16x64_bf16 v[20:23], v[64:67], v[44:51], v0
ds_read_b128 v[44:47], v2 offset:10240
buffer_load_dword v6, s[4:7], s39 offen lds
s_waitcnt lgkmcnt(4)
v_smfmac_f32_16x16x64_bf16 v[20:23], v[68:71], v[112:119], v0
ds_read_b128 v[48:51], v2 offset:11264
v_smfmac_f32_16x16x64_bf16 v[24:27], v[68:71], v[120:127], v0
s_waitcnt lgkmcnt(4)
v_smfmac_f32_16x16x64_bf16 v[20:23], v[72:75], v[128:135], v0
s_waitcnt lgkmcnt(3)
v_smfmac_f32_16x16x64_bf16 v[20:23], v[76:79], v[160:167], v0
s_waitcnt lgkmcnt(2)
v_smfmac_f32_16x16x64_bf16 v[20:23], v[60:63], v[144:151], v0
s_waitcnt lgkmcnt(0)
v_smfmac_f32_16x16x64_bf16 v[24:27], v[64:67], v[44:51], v0
ds_read_b128 v[44:47], v2 offset:12288
v_smfmac_f32_16x16x64_bf16 v[24:27], v[72:75], v[136:143], v0
ds_read_b128 v[48:51], v2 offset:13312
v_add_f32 v20, v20, v22
v_smfmac_f32_16x16x64_bf16 v[24:27], v[76:79], v[168:175], v0
v_add_f32 v21, v21, v23
v_smfmac_f32_16x16x64_bf16 v[24:27], v[60:63], v[152:159], v0
v_cvt_pk_bf16_f32 v22, v20, v21
v_smfmac_f32_16x16x64_bf16 v[28:31], v[64:67], v[240:247], v0
v_smfmac_f32_16x16x64_bf16 v[28:31], v[72:75], a[0:7], v0
v_add_f32 v24, v24, v26
v_add_f32 v25, v25, v27
v_cvt_pk_bf16_f32 v23, v24, v25
s_waitcnt lgkmcnt(0)
v_smfmac_f32_16x16x64_bf16 v[28:31], v[68:71], v[44:51], v0
ds_write_b64 v3, v[22:23] offset:10752
v_smfmac_f32_16x16x64_bf16 v[28:31], v[76:79], a[32:39], v0
ds_read_b128 v[44:47], v2 offset:14336
v_smfmac_f32_16x16x64_bf16 v[28:31], v[60:63], a[16:23], v0
ds_read_b128 v[48:51], v2 offset:15360
v_smfmac_f32_16x16x64_bf16 v[32:35], v[64:67], v[248:255], v0
s_waitcnt lgkmcnt(2)
s_barrier
ds_read_b64_tr_b16 v[20:21], v4 offset:10240
ds_read_b64_tr_b16 v[22:23], v4 offset:10752
v_smfmac_f32_16x16x64_bf16 v[32:35], v[72:75], a[8:15], v0
ds_read_b64_tr_b16 v[24:25], v4 offset:11264
v_add_f32 v28, v28, v30
v_smfmac_f32_16x16x64_bf16 v[32:35], v[76:79], a[40:47], v0
ds_read_b64_tr_b16 v[26:27], v4 offset:11776
v_add_f32 v29, v29, v31
s_waitcnt lgkmcnt(4)
v_smfmac_f32_16x16x64_bf16 v[32:35], v[68:71], v[44:51], v0
ds_read_b128 v[44:47], v2 offset:18432
v_cvt_pk_bf16_f32 v30, v28, v29
v_smfmac_f32_16x16x64_bf16 v[32:35], v[60:63], a[24:31], v0
ds_read_b128 v[48:51], v2 offset:19456
s_waitcnt lgkmcnt(4)
v_mfma_f32_16x16x32_bf16 v[12:15], v[12:15], v[20:23], 0
s_waitcnt lgkmcnt(2)
v_mfma_f32_16x16x32_bf16 v[12:15], v[16:19], v[24:27], v[12:15]
v_add_f32 v32, v32, v34
v_add_f32 v33, v33, v35
v_cvt_pk_bf16_f32 v31, v32, v33
ds_write_b64 v3, v[30:31] offset:12800
v_smfmac_f32_16x16x64_bf16 v[36:39], v[64:67], a[112:119], v0
s_nop 2
v_add_f32_dpp v12, v14, v12 quad_perm:[2,3,0,1] row_mask:0xf bank_mask:0xf
v_add_f32_dpp v13, v15, v13 quad_perm:[2,3,0,1] row_mask:0xf bank_mask:0xf
ds_write_b64 v5, v[12:13] offset:14592
v_smfmac_f32_16x16x64_bf16 v[40:43], v[64:67], a[120:127], v0
s_waitcnt lgkmcnt(1)
s_barrier
ds_read_b64_tr_b16 v[64:65], v4 offset:12288
ds_read_b64_tr_b16 v[66:67], v4 offset:12800
v_smfmac_f32_16x16x64_bf16 v[36:39], v[68:71], a[128:135], v0
ds_read_b64_tr_b16 v[16:17], v4 offset:13312
ds_read_b64_tr_b16 v[18:19], v4 offset:13824
v_smfmac_f32_16x16x64_bf16 v[40:43], v[68:71], a[136:143], v0
s_waitcnt lgkmcnt(4)
s_barrier
ds_read_b128 v[68:71], v1 offset:14336
v_smfmac_f32_16x16x64_bf16 v[40:43], v[60:63], v[44:51], v0
ds_read_b128 v[44:47], v2 offset:16384
s_waitcnt lgkmcnt(4)
v_mfma_f32_16x16x32_bf16 v[64:67], v[64:67], v[20:23], 0
ds_read_b128 v[48:51], v2 offset:17408
s_waitcnt lgkmcnt(3)
v_mfma_f32_16x16x32_bf16 v[64:67], v[16:19], v[24:27], v[64:67]
v_smfmac_f32_16x16x64_bf16 v[40:43], v[72:75], a[152:159], v0
ds_read_b128 v[12:15], v2 offset:22528
s_waitcnt lgkmcnt(3)
v_max3_f32 v25, v68, v69, v70
v_smfmac_f32_16x16x64_bf16 v[40:43], v[76:79], a[168:175], v0
ds_read_b128 v[16:19], v2 offset:23552
v_add_f32_dpp v64, v66, v64 quad_perm:[2,3,0,1] row_mask:0xf bank_mask:0xf
v_add_f32_dpp v65, v67, v65 quad_perm:[2,3,0,1] row_mask:0xf bank_mask:0xf
v_max_f32 v25, v25, v71
v_max_f32 v24, v64, v65
v_mul_f32 v24, s50, v24
v_max_f32_dpp v25, v25, v25 quad_perm:[2,3,0,1] row_mask:0xf bank_mask:0xf
v_smfmac_f32_16x16x64_bf16 v[36:39], v[72:75], a[144:151], v0
s_nop 0
v_max_f32_dpp v26, v24, v25 quad_perm:[0,1,0,1] row_mask:0xf bank_mask:0xf
v_max_f32_dpp v27, v24, v25 quad_perm:[0,1,0,1] row_mask:0xf bank_mask:0xf
v_smfmac_f32_16x16x64_bf16 v[36:39], v[76:79], a[160:167], v0
s_nop 0
v_permlane16_swap_b32 v26, v27
v_max_f32 v28, v26, v27
v_max_f32 v29, v26, v27
s_waitcnt lgkmcnt(2)
v_smfmac_f32_16x16x64_bf16 v[36:39], v[60:63], v[44:51], v0
v_permlane32_swap_b32 v28, v29
v_max_f32 v28, v28, v29
v_sub_f32 v68, v68, v28
v_sub_f32 v69, v69, v28
v_sub_f32 v70, v70, v28
v_sub_f32 v71, v71, v28
v_exp_f32 v68, v68
v_exp_f32 v69, v69
v_exp_f32 v70, v70
v_exp_f32 v71, v71
v_cvt_pk_bf16_f32 v20, v68, v69
v_cvt_pk_bf16_f32 v21, v70, v71
v_pk_add_f32 v[36:37], v[36:37], v[38:39]
v_mov_b32_dpp v22, v20 quad_perm:[2,3,0,1] row_mask:0xf bank_mask:0xf
v_mov_b32_dpp v23, v21 quad_perm:[2,3,0,1] row_mask:0xf bank_mask:0xf
v_pk_fma_f32 v[64:65], v[64:65], s[50:51], v[28:29] op_sel_hi:[1,1,0] neg_lo:[0,0,1] neg_hi:[0,0,1]
v_cvt_pk_bf16_f32 v32, v36, v37
v_pk_add_f32 v[40:41], v[40:41], v[42:43]
v_mfma_f32_16x16x32_bf16 v[36:39], v[52:55], v[20:23], 0
v_mov_b64 v[72:73], s[52:53]
v_mov_b64 v[74:75], s[52:53]
v_cvt_pk_bf16_f32 v33, v40, v41
v_exp_f32 v64, v64
v_mfma_f32_16x16x32_bf16 v[68:71], v[72:75], v[20:23], 0
v_exp_f32 v65, v65
v_mov_b32 v25, 0
v_cvt_pk_bf16_f32 v24, v64, v65
v_mfma_f32_16x16x32_bf16 v[40:43], v[56:59], v[20:23], 0
v_cvt_pk_bf16_f32 v27, v64, v65
v_mov_b32 v26, 0
v_mfma_f32_16x16x16_bf16 v[68:71], v[72:73], v[24:25], v[68:71]
ds_read_b128 v[44:47], v2 offset:20480
v_mfma_f32_16x16x16_bf16 v[36:39], v[32:33], v[24:25], v[36:39]
ds_read_b128 v[48:51], v2 offset:21504
v_mfma_f32_16x16x16_bf16 v[40:43], v[32:33], v[26:27], v[40:43]
v_rcp_f32 v68, v68
v_mov_b64 v[76:77], 0
v_mov_b64 v[78:79], 0
s_nop 0
v_mul_f32 v36, v36, v68
v_mul_f32 v37, v37, v68
v_mul_f32 v38, v38, v68
v_mul_f32 v39, v39, v68
v_pk_mul_f32 v[40:41], v[40:41], v[68:69] op_sel_hi:[1,0]
v_pk_mul_f32 v[42:43], v[42:43], v[68:69] op_sel_hi:[1,0]
v_cvt_pk_bf16_f32 v36, v36, v37
v_cvt_pk_bf16_f32 v37, v38, v39
v_cvt_pk_bf16_f32 v38, v40, v41
v_cvt_pk_bf16_f32 v39, v42, v43
ds_write_b128 v1, v[36:39] offset:6144
ds_read_b128 v[60:63], v7 offset:6144
buffer_store_dwordx4 v[30:33], v1, s[4:7], s40 offen sc0 sc1
ds_read_b128 v[52:55], v2 offset:24576
ds_read_b128 v[56:59], v2 offset:25600
s_cmp_eq_u32 s34, s100
v_mov_b64 v[20:21], 0
v_mov_b64 v[22:23], 0
s_cbranch_scc1 L_ev_w1rs
L_evb_w1rs:
s_waitcnt lgkmcnt(3)
s_barrier
ds_read_b128 v[64:67], v7 offset:7168
ds_read_b128 v[68:71], v7 offset:8192
ds_read_b128 v[72:75], v7 offset:5120
s_waitcnt lgkmcnt(5)
v_smfmac_f32_16x16x64_bf16 v[76:79], v[60:63], v[44:51], v0 abid:1
ds_read_b128 v[44:47], v2 offset:26624
v_mov_b64 v[24:25], 0
v_smfmac_f32_16x16x64_bf16 v[20:23], v[60:63], v[12:19], v0 abid:1
ds_read_b128 v[48:51], v2 offset:27648
v_mov_b64 v[26:27], 0
s_waitcnt lgkmcnt(4)
v_smfmac_f32_16x16x64_bf16 v[76:79], v[64:67], a[176:183], v0 abid:1
ds_read_b128 v[12:15], v2 offset:28672
v_mov_b64 v[40:41], 0
s_waitcnt lgkmcnt(4)
v_smfmac_f32_16x16x64_bf16 v[76:79], v[68:71], v[52:59], v0 abid:1
ds_read_b128 v[16:19], v2 offset:29696
v_mov_b64 v[42:43], 0
s_waitcnt lgkmcnt(4)
v_smfmac_f32_16x16x64_bf16 v[76:79], v[72:75], a[184:191], v0 abid:1
ds_read_b128 v[52:55], v2 offset:30720
v_mov_b64 v[36:37], 0
v_smfmac_f32_16x16x64_bf16 v[20:23], v[64:67], a[192:199], v0 abid:1
ds_read_b128 v[56:59], v2 offset:31744
v_mov_b64 v[38:39], 0
s_waitcnt lgkmcnt(4)
v_smfmac_f32_16x16x64_bf16 v[20:23], v[68:71], v[44:51], v0 abid:1
ds_read_b128 v[44:47], v2 offset:32768
v_cvt_pk_bf16_f32 v76, v76, v77
v_cvt_pk_bf16_f32 v77, v78, v79
v_bfi_b32 v76, 1, s35, v76
buffer_store_dwordx2 v[76:77], v8, s[4:7], s42 offen sc0 sc1
v_smfmac_f32_16x16x64_bf16 v[20:23], v[72:75], a[200:207], v0 abid:1
ds_read_b128 v[48:51], v2 offset:33792
s_waitcnt lgkmcnt(4)
v_smfmac_f32_16x16x64_bf16 v[24:27], v[60:63], v[12:19], v0 abid:1
ds_read_b128 v[12:15], v2 offset:34816
v_smfmac_f32_16x16x64_bf16 v[24:27], v[64:67], a[208:215], v0 abid:1
ds_read_b128 v[16:19], v2 offset:35840
v_cvt_pk_bf16_f32 v20, v20, v21
v_cvt_pk_bf16_f32 v21, v22, v23
v_bfi_b32 v20, 1, s35, v20
buffer_store_dwordx2 v[20:21], v8, s[4:7], s43 offen sc0 sc1
s_waitcnt lgkmcnt(4)
v_smfmac_f32_16x16x64_bf16 v[24:27], v[68:71], v[52:59], v0 abid:1
ds_read_b128 v[52:55], v2 offset:36864
v_smfmac_f32_16x16x64_bf16 v[24:27], v[72:75], a[216:223], v0 abid:1
ds_read_b128 v[56:59], v2 offset:37888
s_waitcnt lgkmcnt(4)
v_smfmac_f32_16x16x64_bf16 v[40:43], v[60:63], v[44:51], v0 abid:1
ds_read_b128 v[44:47], v2 offset:38912
v_smfmac_f32_16x16x64_bf16 v[40:43], v[64:67], a[224:231], v0 abid:1
ds_read_b128 v[48:51], v2 offset:39936
v_cvt_pk_bf16_f32 v24, v24, v25
s_waitcnt lgkmcnt(4)
v_smfmac_f32_16x16x64_bf16 v[40:43], v[68:71], v[12:19], v0 abid:1
v_cvt_pk_bf16_f32 v25, v26, v27
v_smfmac_f32_16x16x64_bf16 v[40:43], v[72:75], a[232:239], v0 abid:1
v_bfi_b32 v24, 1, s35, v24
buffer_store_dwordx2 v[24:25], v8, s[4:7], s44 offen sc0 sc1
s_waitcnt lgkmcnt(2)
v_smfmac_f32_16x16x64_bf16 v[36:39], v[60:63], v[52:59], v0 abid:1
v_smfmac_f32_16x16x64_bf16 v[36:39], v[64:67], a[240:247], v0 abid:1
v_cvt_pk_bf16_f32 v40, v40, v41
s_waitcnt lgkmcnt(0)
v_smfmac_f32_16x16x64_bf16 v[36:39], v[68:71], v[44:51], v0 abid:1
v_cvt_pk_bf16_f32 v41, v42, v43
v_smfmac_f32_16x16x64_bf16 v[36:39], v[72:75], a[248:255], v0 abid:1
v_bfi_b32 v40, 1, s35, v40
buffer_store_dwordx2 v[40:41], v8, s[4:7], s45 offen sc0 sc1
s_nop 5
v_cvt_pk_bf16_f32 v36, v36, v37
v_cvt_pk_bf16_f32 v37, v38, v39
v_bfi_b32 v36, 1, s35, v36
buffer_store_dwordx2 v[36:37], v8, s[4:7], s46 offen sc0 sc1
s_add_u32 s34, s34, 1
s_add_u32 s37, s37, 524288
s_add_u32 s39, s39, 524288
v_and_b32 v6, 0x70, v1
ds_read_b128 v[76:79], v6 offset:256
v_mov_b64 v[20:21], 0
v_mov_b64 v[22:23], 0
v_mov_b64 v[24:25], 0
v_mov_b64 v[26:27], 0
v_mov_b64 v[28:29], 0
v_mov_b64 v[34:35], 0
v_mov_b64 v[36:37], 0
v_mov_b64 v[38:39], 0
v_mov_b64 v[40:41], 0
v_mov_b64 v[42:43], 0
s_waitcnt vmcnt(0)
buffer_load_dwordx4 v[44:47], v9, s[4:7], s3 offen offset:0 sc0 sc1
buffer_load_dwordx4 v[48:51], v9, s[4:7], s3 offen offset:1024 sc0 sc1
buffer_load_dwordx4 v[52:55], v9, s[4:7], s3 offen offset:2048 sc0 sc1
buffer_load_dwordx4 v[56:59], v9, s[4:7], s3 offen offset:3072 sc0 sc1
s_waitcnt lgkmcnt(0)
s_waitcnt vmcnt(3)
L_r_w1rs:
v_mfma_f32_16x16x32_bf16 v[72:75], v[44:47], v[76:79], 0
s_waitcnt vmcnt(2)
v_mfma_f32_16x16x32_bf16 v[72:75], v[48:51], v[76:79], v[72:75]
v_bitop3_b32 v68, v44, v48, s35 bitop3:0x7e
s_waitcnt vmcnt(1)
v_mfma_f32_16x16x32_bf16 v[72:75], v[52:55], v[76:79], v[72:75]
s_waitcnt vmcnt(0)
v_mfma_f32_16x16x32_bf16 v[72:75], v[56:59], v[76:79], v[72:75]
v_bitop3_b32 v69, v52, v56, s35 bitop3:0x7e
v_bitop3_b32 v68, v68, v69, 1 bitop3:0xa8
v_cmp_ne_u32 vcc, 0, v68
s_cbranch_vccnz L_rr_w1rs
ds_read_b128 v[44:47], v2 offset:0
ds_read_b128 v[48:51], v2 offset:1024
s_nop 1
v_pk_add_f32 v[72:73], v[72:73], v[74:75]
v_cvt_pk_bf16_f32 v68, v72, v73
v_bfi_b32 v68, v11, s36, v68
buffer_store_dword v68, v10, s[4:7], 0 offen sc0 sc1
s_not_b32 s35, s35
s_not_b32 s36, s36
v_lshrrev_b32 v6, 2, v1
s_barrier
buffer_load_dwordx4 v[60:63], v1, s[4:7], s47 offen sc0 sc1
buffer_load_dwordx4 v[68:71], v1, s[4:7], s38 offen sc0 sc1
s_add_u32 s40, s40, 131072
v_mov_b64 v[30:31], 0
v_mov_b64 v[32:33], 0
buffer_load_dwordx4 v[12:15], v9, s[4:7], s37 offen offset:0
buffer_load_dwordx4 v[16:19], v9, s[4:7], s37 offen offset:1024
buffer_load_dwordx4 v[52:55], v1, s[4:7], s37 offen offset:2048
buffer_load_dwordx4 v[56:59], v1, s[4:7], s37 offen offset:3072
s_branch L_top_w1rs
L_done_w1rs:
s_waitcnt vmcnt(0)
s_barrier
s_waitcnt vmcnt(0) lgkmcnt(0)
s_endpgm
L_ra0_w1rs:
buffer_load_dwordx4 v[60:63], v1, s[4:7], s47 offen sc0 sc1
buffer_load_dwordx4 v[68:71], v1, s[4:7], s38 offen sc0 sc1
s_sub_u32 s41, s41, 1
s_cbranch_scc1 L_exit
ds_read_b128 v[44:47], v2 offset:0
ds_read_b128 v[48:51], v2 offset:1024
s_waitcnt vmcnt(0) lgkmcnt(0)
v_mov_b64 v[20:21], 0
v_mov_b64 v[22:23], 0
v_mov_b64 v[24:25], 0
v_mov_b64 v[26:27], 0
v_mov_b64 v[28:29], 0
v_mov_b64 v[30:31], 0
v_mov_b64 v[32:33], 0
v_mov_b64 v[34:35], 0
v_mov_b64 v[36:37], 0
v_mov_b64 v[38:39], 0
v_mov_b64 v[40:41], 0
v_mov_b64 v[42:43], 0
s_nop 0
s_branch L_a0_w1rs
L_ra1_w1rs:
buffer_load_dwordx4 v[64:67], v1, s[4:7], s48 offen sc0 sc1
buffer_load_dword v76, v6, s[4:7], s49 offen sc0 sc1
s_sub_u32 s41, s41, 1
s_cbranch_scc1 L_exit
s_waitcnt vmcnt(0)
v_bitop3_b32 v77, v64, s35, 1 bitop3:0x28
v_bitop3_b32 v78, v76, s35, v11 bitop3:0x28
v_or_b32 v77, v77, v78
v_cmp_ne_u32 vcc, 0, v77
s_cbranch_vccnz L_ra1_w1rs
ds_write_b128 v1, v[64:67] offset:6144
ds_write_addtid_b32 v76 offset:9472
s_waitcnt lgkmcnt(0)
s_branch L_a1_w1rs
L_ev_w1rs:
s_cmp_eq_u32 s34, 63
s_cbranch_scc1 L_done_w1rs
s_mov_b32 s100, 63

s_lshl_b32 s55, s32, 2
v_mov_b32 v34, 0
L_kvw_w1rs:
buffer_load_dword v29, v34, s[28:31], s55 offen offset:128 sc0 sc1
s_sub_u32 s41, s41, 1
s_cbranch_scc1 L_exit
s_waitcnt vmcnt(0)
v_readfirstlane_b32 s54, v29
s_nop 0
s_and_b32 s54, s54, 65280
s_cmp_lg_u32 s54, 1024
s_cbranch_scc1 L_kvw_w1rs
s_branch L_evb_w1rs
L_rr_w1rs:
buffer_load_dwordx4 v[44:47], v9, s[4:7], s3 offen offset:0 sc0 sc1
buffer_load_dwordx4 v[48:51], v9, s[4:7], s3 offen offset:1024 sc0 sc1
buffer_load_dwordx4 v[52:55], v9, s[4:7], s3 offen offset:2048 sc0 sc1
buffer_load_dwordx4 v[56:59], v9, s[4:7], s3 offen offset:3072 sc0 sc1
s_sub_u32 s41, s41, 1
s_cbranch_scc1 L_exit
s_waitcnt vmcnt(0)
s_branch L_r_w1rs
L_pro_w2r:
v_and_b32 v20, 63, v0
v_and_b32 v21, 15, v0
v_bfe_u32 v22, v0, 4, 2
v_lshlrev_b32 v1, 4, v20
v_add_u32 v2, 98304, v1
v_bfe_u32 v23, v20, 4, 1
v_lshlrev_b32 v26, 4, v23
v_bfe_u32 v23, v20, 2, 2
v_lshl_add_u32 v26, v23, 1, v26
v_bfe_u32 v23, v20, 5, 1
v_add_u32 v26, v26, v23
v_lshlrev_b32 v26, 13, v26
v_and_b32 v23, 3, v20
v_lshl_add_u32 v26, v23, 4, v26
v_lshrrev_b32 v24, 2, v20
v_mul_u32_u24 v27, 1152, v24
v_lshl_add_u32 v27, v23, 4, v27
v_lshrrev_b32 v24, 2, v21
v_lshl_add_u32 v25, v22, 3, v24
v_lshlrev_b32 v28, 6, v25
v_lshl_add_u32 v28, v23, 3, v28
v_add_u32 v28, 98304, v28
v_and_b32 v25, 1, v22
v_lshlrev_b32 v29, 10, v25
v_lshrrev_b32 v25, 1, v22
v_lshl_add_u32 v29, v25, 8, v29
v_and_b32 v25, 1, v24
v_lshl_add_u32 v29, v25, 6, v29
v_lshrrev_b32 v25, 1, v24
v_lshl_add_u32 v29, v25, 5, v29
v_lshl_add_u32 v29, v23, 3, v29
v_add_u32 v29, 98304, v29
s_lshl_b32 s54, s32, 8
s_add_u32 s54, s54, 128
s_mul_i32 s55, s32, 147456
s_waitcnt lgkmcnt(0)
s_add_u32 s56, s54, 1572864
s_mov_b32 m0, 118784
s_nop 0
buffer_load_dwordx4 v26, s[8:11], s56 offen lds
s_add_u32 s56, s54, 1638400
s_mov_b32 m0, 119808
s_nop 0
buffer_load_dwordx4 v26, s[8:11], s56 offen lds
s_add_u32 s56, s54, 1835008
s_mov_b32 m0, 120832
s_nop 0
buffer_load_dwordx4 v26, s[8:11], s56 offen lds
s_add_u32 s56, s54, 1900544
s_mov_b32 m0, 121856
s_nop 0
buffer_load_dwordx4 v26, s[8:11], s56 offen lds
s_add_u32 s56, s54, 524288
s_mov_b32 m0, 122880
s_nop 0
buffer_load_dwordx4 v26, s[8:11], s56 offen lds
s_add_u32 s56, s54, 589824
s_mov_b32 m0, 123904
s_nop 0
buffer_load_dwordx4 v26, s[8:11], s56 offen lds
s_add_u32 s56, s54, 786432
s_mov_b32 m0, 124928
s_nop 0
buffer_load_dwordx4 v26, s[8:11], s56 offen lds
s_add_u32 s56, s54, 851968
s_mov_b32 m0, 125952
s_nop 0
buffer_load_dwordx4 v26, s[8:11], s56 offen lds
s_add_u32 s56, s54, 3670016
s_mov_b32 m0, 126976
s_nop 0
buffer_load_dwordx4 v26, s[8:11], s56 offen lds
s_add_u32 s56, s54, 3735552
s_mov_b32 m0, 128000
s_nop 0
buffer_load_dwordx4 v26, s[8:11], s56 offen lds
s_add_u32 s56, s54, 3932160
s_mov_b32 m0, 129024
s_nop 0
buffer_load_dwordx4 v26, s[8:11], s56 offen lds
s_add_u32 s56, s54, 3997696
s_mov_b32 m0, 130048
s_nop 0
buffer_load_dwordx4 v26, s[8:11], s56 offen lds
s_add_u32 s56, s54, 2097152
s_mov_b32 m0, 98304
s_nop 0
buffer_load_dwordx4 v26, s[8:11], s56 offen lds
s_add_u32 s56, s54, 2162688
s_mov_b32 m0, 99328
s_nop 0
buffer_load_dwordx4 v26, s[8:11], s56 offen lds
s_add_u32 s56, s54, 2359296
s_mov_b32 m0, 100352
s_nop 0
buffer_load_dwordx4 v26, s[8:11], s56 offen lds
s_add_u32 s56, s54, 2424832
s_mov_b32 m0, 101376
s_nop 0
buffer_load_dwordx4 v26, s[8:11], s56 offen lds
s_add_u32 s56, s54, 2621440
s_mov_b32 m0, 102400
s_nop 0
buffer_load_dwordx4 v26, s[8:11], s56 offen lds
s_add_u32 s56, s54, 2686976
s_mov_b32 m0, 103424
s_nop 0
buffer_load_dwordx4 v26, s[8:11], s56 offen lds
s_add_u32 s56, s54, 2883584
s_mov_b32 m0, 104448
s_nop 0
buffer_load_dwordx4 v26, s[8:11], s56 offen lds
s_add_u32 s56, s54, 2949120
s_mov_b32 m0, 105472
s_nop 0
buffer_load_dwordx4 v26, s[8:11], s56 offen lds
s_add_u32 s56, s54, 4194304
s_mov_b32 m0, 106496
s_nop 0
buffer_load_dwordx4 v26, s[8:11], s56 offen lds
s_add_u32 s56, s54, 4259840
s_mov_b32 m0, 107520
s_nop 0
buffer_load_dwordx4 v26, s[8:11], s56 offen lds
s_add_u32 s56, s54, 4456448
s_mov_b32 m0, 108544
s_nop 0
buffer_load_dwordx4 v26, s[8:11], s56 offen lds
s_add_u32 s56, s54, 4521984
s_mov_b32 m0, 109568
s_nop 0
buffer_load_dwordx4 v26, s[8:11], s56 offen lds
s_add_u32 s56, s54, 1048576
s_mov_b32 m0, 110592
s_nop 0
buffer_load_dwordx4 v26, s[12:15], s56 offen lds
s_add_u32 s56, s54, 1114112
s_mov_b32 m0, 111616
s_nop 0
buffer_load_dwordx4 v26, s[12:15], s56 offen lds
s_add_u32 s56, s54, 1310720
s_mov_b32 m0, 112640
s_nop 0
buffer_load_dwordx4 v26, s[12:15], s56 offen lds
s_add_u32 s56, s54, 1376256
s_mov_b32 m0, 113664
s_nop 0
buffer_load_dwordx4 v26, s[12:15], s56 offen lds
v_bfe_u32 v23, v21, 1, 1
v_and_b32 v24, 1, v21
v_lshl_add_u32 v23, v24, 16, v23
v_mul_u32_u24 v23, 0xaaaa, v23
v_add_u32 v0, 0x44444444, v23
v_lshlrev_b32 v3, 3, v20
v_lshrrev_b32 v25, 5, v20
v_lshlrev_b32 v25, 6, v25
v_xor_b32 v3, v3, v25
v_lshrrev_b32 v25, 2, v20
v_and_b32 v4, 3, v21
v_lshl_add_u32 v4, v4, 4, v25
v_lshlrev_b32 v4, 3, v4
v_bfe_u32 v25, v21, 1, 1
v_lshlrev_b32 v23, 6, v25
v_xor_b32 v4, v4, v23
v_and_b32 v23, 2, v22
v_xor_b32 v5, v21, v23
v_lshlrev_b32 v5, 4, v5
v_lshl_add_u32 v5, v25, 10, v5
v_and_b32 v23, 1, v22
v_lshl_add_u32 v5, v23, 3, v5
v_lshlrev_b32 v9, 8, v22
v_lshl_add_u32 v9, v25, 6, v9
v_bfe_u32 v23, v21, 3, 1
v_lshl_add_u32 v9, v23, 7, v9
v_bfe_u32 v23, v21, 2, 1
v_lshl_add_u32 v9, v23, 5, v9
v_and_b32 v23, 1, v21
v_lshl_add_u32 v9, v23, 4, v9
v_lshrrev_b32 v23, 1, v22
v_and_b32 v24, 1, v22
v_and_b32 v25, 7, v21
v_lshrrev_b32 v7, 3, v21
v_lshl_add_u32 v8, v7, 1, v23
v_lshlrev_b32 v8, 12, v8
v_lshl_add_u32 v8, v24, 7, v8
v_lshl_add_u32 v8, v25, 3, v8
s_lshr_b32 s56, s32, 1
s_lshl_b32 s56, s56, 8
s_and_b32 s57, s32, 1
s_lshl_b32 s57, s57, 6
s_add_u32 s56, s56, s57
s_add_u32 s56, s56, 32768
v_add_u32 v8, s56, v8
v_and_b32 v7, 12, v21
v_bfe_u32 v25, v21, 1, 1
v_add_u32 v7, v7, v25
v_lshlrev_b32 v7, 4, v7
v_lshl_add_u32 v7, v22, 8, v7
s_mov_b32 s42, 0
s_mov_b32 s43, 65536
s_mov_b32 s44, 131072
s_mov_b32 s45, 196608
s_mov_b32 s46, 262144
s_mov_b32 s47, 296960
s_mov_b32 s48, 301056
s_mov_b32 s49, 303616
s_mov_b32 s38, 297984
s_mov_b32 s50, 0x3e0293ee
s_mov_b32 s51, 0x3e0293ee
s_mov_b32 s52, 0x3f803f80
s_mov_b32 s53, 0x3f803f80
v_and_b32 v11, 3, v21
v_cmp_eq_u32 vcc, 0, v11
s_nop 1
v_cndmask_b32 v11, 0, 1, vcc
s_mov_b32 s34, 0
s_mov_b32 s35, -1
s_mov_b32 s36, 0
s_mov_b32 s41, 400000
s_lshl_b32 s37, s32, 14
s_add_u32 s39, s37, 17309696
s_add_u32 s37, s37, 16785408
s_lshl_b32 s40, s32, 12
s_add_u32 s40, s40, 8390656
v_mov_b64 v[36:37], 0
v_mov_b64 v[38:39], 0
s_add_u32 s56, s32, 0
s_lshl_b32 s3, s56, 12
v_bfe_u32 v23, v21, 1, 1
v_bfe_u32 v24, v21, 2, 1
v_and_b32 v25, 1, v21
s_lshl_b32 s57, s56, 7
s_add_u32 s57, s57, 294912
v_and_b32 v10, 7, v21
v_lshlrev_b32 v10, 2, v10
v_lshl_add_u32 v10, v22, 5, v10
v_add_u32 v10, s57, v10
v_lshl_add_u32 v23, v23, 1, v24
v_lshlrev_b32 v25, 4, v25
v_mov_b32 v24, 0x3f80
v_lshlrev_b32 v24, v25, v24
v_cmp_eq_u32 vcc, 0, v23
s_nop 1
v_cndmask_b32 v76, 0, v24, vcc
v_cmp_eq_u32 vcc, 1, v23
s_nop 1
v_cndmask_b32 v77, 0, v24, vcc
v_cmp_eq_u32 vcc, 2, v23
s_nop 1
v_cndmask_b32 v78, 0, v24, vcc
v_cmp_eq_u32 vcc, 3, v23
s_nop 1
v_cndmask_b32 v79, 0, v24, vcc
v_and_b32 v23, 0x70, v1
ds_write_b128 v23, v[76:79] offset:256
buffer_store_dwordx4 v[36:39], v9, s[4:7], s3 offen offset:0 sc0 sc1
buffer_store_dwordx4 v[36:39], v9, s[4:7], s3 offen offset:1024 sc0 sc1
buffer_store_dwordx4 v[36:39], v9, s[4:7], s3 offen offset:2048 sc0 sc1
buffer_store_dwordx4 v[36:39], v9, s[4:7], s3 offen offset:3072 sc0 sc1
s_waitcnt vmcnt(0) lgkmcnt(0)
s_barrier
s_getreg_b32 s56, hwreg(HW_REG_XCC_ID)
s_and_b32 s56, s56, 15
s_mul_i32 s57, s56, s56
s_lshl_b32 s57, s57, 18
s_lshl_b32 s56, s56, 8
s_add_u32 s57, s57, s56
s_add_u32 s58, s57, 1
ds_read_b64_tr_b16 v[80:81], v28 offset:20480
ds_read_b64_tr_b16 v[82:83], v28 offset:20736
ds_read_b64_tr_b16 v[84:85], v28 offset:22528
ds_read_b64_tr_b16 v[86:87], v28 offset:22784
ds_read_b64_tr_b16 v[88:89], v28 offset:20512
ds_read_b64_tr_b16 v[90:91], v28 offset:20768
ds_read_b64_tr_b16 v[92:93], v28 offset:22560
ds_read_b64_tr_b16 v[94:95], v28 offset:22816
s_waitcnt lgkmcnt(0)
s_add_u32 s56, s54, 1572864
s_mov_b32 m0, 114688
s_nop 0
buffer_load_dwordx4 v26, s[12:15], s56 offen lds
s_add_u32 s56, s54, 1638400
s_mov_b32 m0, 115712
s_nop 0
buffer_load_dwordx4 v26, s[12:15], s56 offen lds
s_add_u32 s56, s54, 1835008
s_mov_b32 m0, 116736
s_nop 0
buffer_load_dwordx4 v26, s[12:15], s56 offen lds
s_add_u32 s56, s54, 1900544
s_mov_b32 m0, 117760
s_nop 0
buffer_load_dwordx4 v26, s[12:15], s56 offen lds
ds_read_b64_tr_b16 v[96:97], v28 offset:24576
ds_read_b64_tr_b16 v[98:99], v28 offset:24832
ds_read_b64_tr_b16 v[100:101], v28 offset:26624
ds_read_b64_tr_b16 v[102:103], v28 offset:26880
ds_read_b64_tr_b16 v[104:105], v28 offset:24608
ds_read_b64_tr_b16 v[106:107], v28 offset:24864
ds_read_b64_tr_b16 v[108:109], v28 offset:26656
ds_read_b64_tr_b16 v[110:111], v28 offset:26912
s_waitcnt lgkmcnt(0)
s_add_u32 s56, s54, 0
s_mov_b32 m0, 118784
s_nop 0
buffer_load_dwordx4 v26, s[12:15], s56 offen lds
s_add_u32 s56, s54, 65536
s_mov_b32 m0, 119808
s_nop 0
buffer_load_dwordx4 v26, s[12:15], s56 offen lds
s_add_u32 s56, s54, 262144
s_mov_b32 m0, 120832
s_nop 0
buffer_load_dwordx4 v26, s[12:15], s56 offen lds
s_add_u32 s56, s54, 327680
s_mov_b32 m0, 121856
s_nop 0
buffer_load_dwordx4 v26, s[12:15], s56 offen lds
ds_read_b64_tr_b16 v[112:113], v28 offset:28672
ds_read_b64_tr_b16 v[114:115], v28 offset:28928
ds_read_b64_tr_b16 v[116:117], v28 offset:30720
ds_read_b64_tr_b16 v[118:119], v28 offset:30976
ds_read_b64_tr_b16 v[120:121], v28 offset:28704
ds_read_b64_tr_b16 v[122:123], v28 offset:28960
ds_read_b64_tr_b16 v[124:125], v28 offset:30752
ds_read_b64_tr_b16 v[126:127], v28 offset:31008
s_waitcnt lgkmcnt(0)
s_add_u32 s56, s54, 524288
s_mov_b32 m0, 122880
s_nop 0
buffer_load_dwordx4 v26, s[12:15], s56 offen lds
s_add_u32 s56, s54, 589824
s_mov_b32 m0, 123904
s_nop 0
buffer_load_dwordx4 v26, s[12:15], s56 offen lds
s_add_u32 s56, s54, 786432
s_mov_b32 m0, 124928
s_nop 0
buffer_load_dwordx4 v26, s[12:15], s56 offen lds
s_add_u32 s56, s54, 851968
s_mov_b32 m0, 125952
s_nop 0
buffer_load_dwordx4 v26, s[12:15], s56 offen lds
ds_read_b64_tr_b16 v[128:129], v28 offset:0
ds_read_b64_tr_b16 v[130:131], v28 offset:256
ds_read_b64_tr_b16 v[132:133], v28 offset:2048
ds_read_b64_tr_b16 v[134:135], v28 offset:2304
ds_read_b64_tr_b16 v[136:137], v28 offset:32
ds_read_b64_tr_b16 v[138:139], v28 offset:288
ds_read_b64_tr_b16 v[140:141], v28 offset:2080
ds_read_b64_tr_b16 v[142:143], v28 offset:2336
s_waitcnt lgkmcnt(0)
s_add_u32 s56, s54, 3145728
s_mov_b32 m0, 126976
s_nop 0
buffer_load_dwordx4 v26, s[12:15], s56 offen lds
s_add_u32 s56, s54, 3211264
s_mov_b32 m0, 128000
s_nop 0
buffer_load_dwordx4 v26, s[12:15], s56 offen lds
s_add_u32 s56, s54, 3407872
s_mov_b32 m0, 129024
s_nop 0
buffer_load_dwordx4 v26, s[12:15], s56 offen lds
s_add_u32 s56, s54, 3473408
s_mov_b32 m0, 130048
s_nop 0
buffer_load_dwordx4 v26, s[12:15], s56 offen lds
ds_read_b64_tr_b16 v[144:145], v28 offset:4096
ds_read_b64_tr_b16 v[146:147], v28 offset:4352
ds_read_b64_tr_b16 v[148:149], v28 offset:6144
ds_read_b64_tr_b16 v[150:151], v28 offset:6400
ds_read_b64_tr_b16 v[152:153], v28 offset:4128
ds_read_b64_tr_b16 v[154:155], v28 offset:4384
ds_read_b64_tr_b16 v[156:157], v28 offset:6176
ds_read_b64_tr_b16 v[158:159], v28 offset:6432
s_waitcnt lgkmcnt(0)
s_add_u32 s56, s54, 2097152
s_mov_b32 m0, 98304
s_nop 0
buffer_load_dwordx4 v26, s[12:15], s56 offen lds
s_add_u32 s56, s54, 2162688
s_mov_b32 m0, 99328
s_nop 0
buffer_load_dwordx4 v26, s[12:15], s56 offen lds
s_add_u32 s56, s54, 2359296
s_mov_b32 m0, 100352
s_nop 0
buffer_load_dwordx4 v26, s[12:15], s56 offen lds
s_add_u32 s56, s54, 2424832
s_mov_b32 m0, 101376
s_nop 0
buffer_load_dwordx4 v26, s[12:15], s56 offen lds
ds_read_b64_tr_b16 v[160:161], v28 offset:8192
ds_read_b64_tr_b16 v[162:163], v28 offset:8448
ds_read_b64_tr_b16 v[164:165], v28 offset:10240
ds_read_b64_tr_b16 v[166:167], v28 offset:10496
ds_read_b64_tr_b16 v[168:169], v28 offset:8224
ds_read_b64_tr_b16 v[170:171], v28 offset:8480
ds_read_b64_tr_b16 v[172:173], v28 offset:10272
ds_read_b64_tr_b16 v[174:175], v28 offset:10528
s_waitcnt lgkmcnt(0)
s_add_u32 s56, s54, 2621440
s_mov_b32 m0, 102400
s_nop 0
buffer_load_dwordx4 v26, s[12:15], s56 offen lds
s_add_u32 s56, s54, 2686976
s_mov_b32 m0, 103424
s_nop 0
buffer_load_dwordx4 v26, s[12:15], s56 offen lds
s_add_u32 s56, s54, 2883584
s_mov_b32 m0, 104448
s_nop 0
buffer_load_dwordx4 v26, s[12:15], s56 offen lds
s_add_u32 s56, s54, 2949120
s_mov_b32 m0, 105472
s_nop 0
buffer_load_dwordx4 v26, s[12:15], s56 offen lds
ds_read_b64_tr_b16 v[176:177], v28 offset:12288
ds_read_b64_tr_b16 v[178:179], v28 offset:12544
ds_read_b64_tr_b16 v[180:181], v28 offset:14336
ds_read_b64_tr_b16 v[182:183], v28 offset:14592
ds_read_b64_tr_b16 v[184:185], v28 offset:12320
ds_read_b64_tr_b16 v[186:187], v28 offset:12576
ds_read_b64_tr_b16 v[188:189], v28 offset:14368
ds_read_b64_tr_b16 v[190:191], v28 offset:14624
s_waitcnt lgkmcnt(0)
s_add_u32 s56, s54, 4194304
s_mov_b32 m0, 106496
s_nop 0
buffer_load_dwordx4 v26, s[12:15], s56 offen lds
s_add_u32 s56, s54, 4259840
s_mov_b32 m0, 107520
s_nop 0
buffer_load_dwordx4 v26, s[12:15], s56 offen lds
s_add_u32 s56, s54, 4456448
s_mov_b32 m0, 108544
s_nop 0
buffer_load_dwordx4 v26, s[12:15], s56 offen lds
s_add_u32 s56, s54, 4521984
s_mov_b32 m0, 109568
s_nop 0
buffer_load_dwordx4 v26, s[12:15], s56 offen lds
s_waitcnt vmcnt(24)
ds_read_b64_tr_b16 v[192:193], v28 offset:16384
ds_read_b64_tr_b16 v[194:195], v28 offset:16640
ds_read_b64_tr_b16 v[196:197], v28 offset:18432
ds_read_b64_tr_b16 v[198:199], v28 offset:18688
ds_read_b64_tr_b16 v[200:201], v28 offset:16416
ds_read_b64_tr_b16 v[202:203], v28 offset:16672
ds_read_b64_tr_b16 v[204:205], v28 offset:18464
ds_read_b64_tr_b16 v[206:207], v28 offset:18720
s_waitcnt lgkmcnt(0)
s_add_u32 s56, s54, 1048576
s_mov_b32 m0, 110592
s_nop 0
buffer_load_dwordx4 v26, s[16:19], s56 offen lds
s_add_u32 s56, s54, 1114112
s_mov_b32 m0, 111616
s_nop 0
buffer_load_dwordx4 v26, s[16:19], s56 offen lds
s_add_u32 s56, s54, 1310720
s_mov_b32 m0, 112640
s_nop 0
buffer_load_dwordx4 v26, s[16:19], s56 offen lds
s_add_u32 s56, s54, 1376256
s_mov_b32 m0, 113664
s_nop 0
buffer_load_dwordx4 v26, s[16:19], s56 offen lds
s_waitcnt vmcnt(24)
ds_read_b64_tr_b16 v[208:209], v28 offset:20480
ds_read_b64_tr_b16 v[210:211], v28 offset:20736
ds_read_b64_tr_b16 v[212:213], v28 offset:22528
ds_read_b64_tr_b16 v[214:215], v28 offset:22784
ds_read_b64_tr_b16 v[216:217], v28 offset:20512
ds_read_b64_tr_b16 v[218:219], v28 offset:20768
ds_read_b64_tr_b16 v[220:221], v28 offset:22560
ds_read_b64_tr_b16 v[222:223], v28 offset:22816
s_waitcnt lgkmcnt(0)
s_add_u32 s56, s54, 1572864
s_mov_b32 m0, 114688
s_nop 0
buffer_load_dwordx4 v26, s[16:19], s56 offen lds
s_add_u32 s56, s54, 1638400
s_mov_b32 m0, 115712
s_nop 0
buffer_load_dwordx4 v26, s[16:19], s56 offen lds
s_add_u32 s56, s54, 1835008
s_mov_b32 m0, 116736
s_nop 0
buffer_load_dwordx4 v26, s[16:19], s56 offen lds
s_add_u32 s56, s54, 1900544
s_mov_b32 m0, 117760
s_nop 0
buffer_load_dwordx4 v26, s[16:19], s56 offen lds
s_waitcnt vmcnt(24)
ds_read_b64_tr_b16 v[224:225], v28 offset:24576
ds_read_b64_tr_b16 v[226:227], v28 offset:24832
ds_read_b64_tr_b16 v[228:229], v28 offset:26624
ds_read_b64_tr_b16 v[230:231], v28 offset:26880
ds_read_b64_tr_b16 v[232:233], v28 offset:24608
ds_read_b64_tr_b16 v[234:235], v28 offset:24864
ds_read_b64_tr_b16 v[236:237], v28 offset:26656
ds_read_b64_tr_b16 v[238:239], v28 offset:26912
s_waitcnt lgkmcnt(0)
s_add_u32 s56, s54, 0
s_mov_b32 m0, 118784
s_nop 0
buffer_load_dwordx4 v26, s[16:19], s56 offen lds
s_add_u32 s56, s54, 65536
s_mov_b32 m0, 119808
s_nop 0
buffer_load_dwordx4 v26, s[16:19], s56 offen lds
s_add_u32 s56, s54, 262144
s_mov_b32 m0, 120832
s_nop 0
buffer_load_dwordx4 v26, s[16:19], s56 offen lds
s_add_u32 s56, s54, 327680
s_mov_b32 m0, 121856
s_nop 0
buffer_load_dwordx4 v26, s[16:19], s56 offen lds
s_waitcnt vmcnt(24)
ds_read_b64_tr_b16 v[240:241], v28 offset:28672
ds_read_b64_tr_b16 v[242:243], v28 offset:28928
ds_read_b64_tr_b16 v[244:245], v28 offset:30720
ds_read_b64_tr_b16 v[246:247], v28 offset:30976
ds_read_b64_tr_b16 v[248:249], v28 offset:28704
ds_read_b64_tr_b16 v[250:251], v28 offset:28960
ds_read_b64_tr_b16 v[252:253], v28 offset:30752
ds_read_b64_tr_b16 v[254:255], v28 offset:31008
s_waitcnt lgkmcnt(0)
s_add_u32 s56, s54, 524288
s_mov_b32 m0, 122880
s_nop 0
buffer_load_dwordx4 v26, s[16:19], s56 offen lds
s_add_u32 s56, s54, 589824
s_mov_b32 m0, 123904
s_nop 0
buffer_load_dwordx4 v26, s[16:19], s56 offen lds
s_add_u32 s56, s54, 786432
s_mov_b32 m0, 124928
s_nop 0
buffer_load_dwordx4 v26, s[16:19], s56 offen lds
s_add_u32 s56, s54, 851968
s_mov_b32 m0, 125952
s_nop 0
buffer_load_dwordx4 v26, s[16:19], s56 offen lds
s_waitcnt vmcnt(24)
ds_read_b64_tr_b16 a[0:1], v28 offset:0
ds_read_b64_tr_b16 a[2:3], v28 offset:256
ds_read_b64_tr_b16 a[4:5], v28 offset:2048
ds_read_b64_tr_b16 a[6:7], v28 offset:2304
ds_read_b64_tr_b16 a[8:9], v28 offset:32
ds_read_b64_tr_b16 a[10:11], v28 offset:288
ds_read_b64_tr_b16 a[12:13], v28 offset:2080
ds_read_b64_tr_b16 a[14:15], v28 offset:2336
s_waitcnt lgkmcnt(0)
s_add_u32 s56, s54, 3145728
s_mov_b32 m0, 126976
s_nop 0
buffer_load_dwordx4 v26, s[16:19], s56 offen lds
s_add_u32 s56, s54, 3211264
s_mov_b32 m0, 128000
s_nop 0
buffer_load_dwordx4 v26, s[16:19], s56 offen lds
s_add_u32 s56, s54, 3407872
s_mov_b32 m0, 129024
s_nop 0
buffer_load_dwordx4 v26, s[16:19], s56 offen lds
s_add_u32 s56, s54, 3473408
s_mov_b32 m0, 130048
s_nop 0
buffer_load_dwordx4 v26, s[16:19], s56 offen lds
s_waitcnt vmcnt(24)
ds_read_b64_tr_b16 a[16:17], v28 offset:4096
ds_read_b64_tr_b16 a[18:19], v28 offset:4352
ds_read_b64_tr_b16 a[20:21], v28 offset:6144
ds_read_b64_tr_b16 a[22:23], v28 offset:6400
ds_read_b64_tr_b16 a[24:25], v28 offset:4128
ds_read_b64_tr_b16 a[26:27], v28 offset:4384
ds_read_b64_tr_b16 a[28:29], v28 offset:6176
ds_read_b64_tr_b16 a[30:31], v28 offset:6432
s_waitcnt lgkmcnt(0)
s_add_u32 s56, s54, 3670016
s_mov_b32 m0, 98304
s_nop 0
buffer_load_dwordx4 v26, s[16:19], s56 offen lds
s_add_u32 s56, s54, 3735552
s_mov_b32 m0, 99328
s_nop 0
buffer_load_dwordx4 v26, s[16:19], s56 offen lds
s_add_u32 s56, s54, 3932160
s_mov_b32 m0, 100352
s_nop 0
buffer_load_dwordx4 v26, s[16:19], s56 offen lds
s_add_u32 s56, s54, 3997696
s_mov_b32 m0, 101376
s_nop 0
buffer_load_dwordx4 v26, s[16:19], s56 offen lds
s_waitcnt vmcnt(24)
ds_read_b64_tr_b16 a[32:33], v28 offset:8192
ds_read_b64_tr_b16 a[34:35], v28 offset:8448
ds_read_b64_tr_b16 a[36:37], v28 offset:10240
ds_read_b64_tr_b16 a[38:39], v28 offset:10496
ds_read_b64_tr_b16 a[40:41], v28 offset:8224
ds_read_b64_tr_b16 a[42:43], v28 offset:8480
ds_read_b64_tr_b16 a[44:45], v28 offset:10272
ds_read_b64_tr_b16 a[46:47], v28 offset:10528
s_waitcnt lgkmcnt(0)
s_add_u32 s56, s54, 2097152
s_mov_b32 m0, 102400
s_nop 0
buffer_load_dwordx4 v26, s[16:19], s56 offen lds
s_add_u32 s56, s54, 2162688
s_mov_b32 m0, 103424
s_nop 0
buffer_load_dwordx4 v26, s[16:19], s56 offen lds
s_add_u32 s56, s54, 2359296
s_mov_b32 m0, 104448
s_nop 0
buffer_load_dwordx4 v26, s[16:19], s56 offen lds
s_add_u32 s56, s54, 2424832
s_mov_b32 m0, 105472
s_nop 0
buffer_load_dwordx4 v26, s[16:19], s56 offen lds
s_waitcnt vmcnt(24)
ds_read_b64_tr_b16 a[48:49], v28 offset:12288
ds_read_b64_tr_b16 a[50:51], v28 offset:12544
ds_read_b64_tr_b16 a[52:53], v28 offset:14336
ds_read_b64_tr_b16 a[54:55], v28 offset:14592
ds_read_b64_tr_b16 a[56:57], v28 offset:12320
ds_read_b64_tr_b16 a[58:59], v28 offset:12576
ds_read_b64_tr_b16 a[60:61], v28 offset:14368
ds_read_b64_tr_b16 a[62:63], v28 offset:14624
s_waitcnt lgkmcnt(0)
s_add_u32 s56, s54, 4194304
s_mov_b32 m0, 106496
s_nop 0
buffer_load_dwordx4 v26, s[16:19], s56 offen lds
s_add_u32 s56, s54, 4259840
s_mov_b32 m0, 107520
s_nop 0
buffer_load_dwordx4 v26, s[16:19], s56 offen lds
s_add_u32 s56, s54, 4456448
s_mov_b32 m0, 108544
s_nop 0
buffer_load_dwordx4 v26, s[16:19], s56 offen lds
s_add_u32 s56, s54, 4521984
s_mov_b32 m0, 109568
s_nop 0
buffer_load_dwordx4 v26, s[16:19], s56 offen lds
s_waitcnt vmcnt(24)
ds_read_b64_tr_b16 a[64:65], v28 offset:16384
ds_read_b64_tr_b16 a[66:67], v28 offset:16640
ds_read_b64_tr_b16 a[68:69], v28 offset:18432
ds_read_b64_tr_b16 a[70:71], v28 offset:18688
ds_read_b64_tr_b16 a[72:73], v28 offset:16416
ds_read_b64_tr_b16 a[74:75], v28 offset:16672
ds_read_b64_tr_b16 a[76:77], v28 offset:18464
ds_read_b64_tr_b16 a[78:79], v28 offset:18720
s_waitcnt lgkmcnt(0)
s_add_u32 s56, s55, 110720
s_mov_b32 m0, 110592
s_nop 0
buffer_load_dwordx4 v27, s[20:23], s56 offen lds
s_add_u32 s56, s55, 129152
s_mov_b32 m0, 111616
s_nop 0
buffer_load_dwordx4 v27, s[20:23], s56 offen lds
s_add_u32 s56, s55, 36992
s_mov_b32 m0, 112640
s_nop 0
buffer_load_dwordx4 v27, s[20:23], s56 offen lds
s_add_u32 s56, s55, 55424
s_mov_b32 m0, 113664
s_nop 0
buffer_load_dwordx4 v27, s[20:23], s56 offen lds
s_waitcnt vmcnt(24)
ds_read_b64_tr_b16 a[80:81], v28 offset:20480
ds_read_b64_tr_b16 a[82:83], v28 offset:20736
ds_read_b64_tr_b16 a[84:85], v28 offset:22528
ds_read_b64_tr_b16 a[86:87], v28 offset:22784
ds_read_b64_tr_b16 a[88:89], v28 offset:20512
ds_read_b64_tr_b16 a[90:91], v28 offset:20768
ds_read_b64_tr_b16 a[92:93], v28 offset:22560
ds_read_b64_tr_b16 a[94:95], v28 offset:22816
s_waitcnt lgkmcnt(0)
s_add_u32 s56, s55, 110976
s_mov_b32 m0, 114688
s_nop 0
buffer_load_dwordx4 v27, s[20:23], s56 offen lds
s_add_u32 s56, s55, 129408
s_mov_b32 m0, 115712
s_nop 0
buffer_load_dwordx4 v27, s[20:23], s56 offen lds
s_add_u32 s56, s55, 384
s_mov_b32 m0, 116736
s_nop 0
buffer_load_dwordx4 v27, s[20:23], s56 offen lds
s_add_u32 s56, s55, 18816
s_mov_b32 m0, 117760
s_nop 0
buffer_load_dwordx4 v27, s[20:23], s56 offen lds
s_waitcnt vmcnt(24)
ds_read_b64_tr_b16 a[96:97], v28 offset:24576
ds_read_b64_tr_b16 a[98:99], v28 offset:24832
ds_read_b64_tr_b16 a[100:101], v28 offset:26624
ds_read_b64_tr_b16 a[102:103], v28 offset:26880
ds_read_b64_tr_b16 a[104:105], v28 offset:24608
ds_read_b64_tr_b16 a[106:107], v28 offset:24864
ds_read_b64_tr_b16 a[108:109], v28 offset:26656
ds_read_b64_tr_b16 a[110:111], v28 offset:26912
s_waitcnt lgkmcnt(0)
s_add_u32 s56, s55, 37248
s_mov_b32 m0, 118784
s_nop 0
buffer_load_dwordx4 v27, s[20:23], s56 offen lds
s_add_u32 s56, s55, 55680
s_mov_b32 m0, 119808
s_nop 0
buffer_load_dwordx4 v27, s[20:23], s56 offen lds
s_add_u32 s56, s55, 111232
s_mov_b32 m0, 120832
s_nop 0
buffer_load_dwordx4 v27, s[20:23], s56 offen lds
s_add_u32 s56, s55, 129664
s_mov_b32 m0, 121856
s_nop 0
buffer_load_dwordx4 v27, s[20:23], s56 offen lds
s_waitcnt vmcnt(24)
ds_read_b64_tr_b16 a[112:113], v28 offset:28672
ds_read_b64_tr_b16 a[114:115], v28 offset:28928
ds_read_b64_tr_b16 a[116:117], v28 offset:30720
ds_read_b64_tr_b16 a[118:119], v28 offset:30976
ds_read_b64_tr_b16 a[120:121], v28 offset:28704
ds_read_b64_tr_b16 a[122:123], v28 offset:28960
ds_read_b64_tr_b16 a[124:125], v28 offset:30752
ds_read_b64_tr_b16 a[126:127], v28 offset:31008
s_waitcnt lgkmcnt(0)
s_add_u32 s56, s55, 640
s_mov_b32 m0, 122880
s_nop 0
buffer_load_dwordx4 v27, s[20:23], s56 offen lds
s_add_u32 s56, s55, 19072
s_mov_b32 m0, 123904
s_nop 0
buffer_load_dwordx4 v27, s[20:23], s56 offen lds
s_add_u32 s56, s55, 74624
s_mov_b32 m0, 124928
s_nop 0
buffer_load_dwordx4 v27, s[20:23], s56 offen lds
s_add_u32 s56, s55, 93056
s_mov_b32 m0, 125952
s_nop 0
buffer_load_dwordx4 v27, s[20:23], s56 offen lds
s_waitcnt vmcnt(24)
ds_read_b64_tr_b16 a[128:129], v28 offset:0
ds_read_b64_tr_b16 a[130:131], v28 offset:256
ds_read_b64_tr_b16 a[132:133], v28 offset:2048
ds_read_b64_tr_b16 a[134:135], v28 offset:2304
ds_read_b64_tr_b16 a[136:137], v28 offset:32
ds_read_b64_tr_b16 a[138:139], v28 offset:288
ds_read_b64_tr_b16 a[140:141], v28 offset:2080
ds_read_b64_tr_b16 a[142:143], v28 offset:2336
s_waitcnt lgkmcnt(0)
s_add_u32 s56, s55, 111488
s_mov_b32 m0, 126976
s_nop 0
buffer_load_dwordx4 v27, s[20:23], s56 offen lds
s_add_u32 s56, s55, 129920
s_mov_b32 m0, 128000
s_nop 0
buffer_load_dwordx4 v27, s[20:23], s56 offen lds
s_add_u32 s56, s55, 37760
s_mov_b32 m0, 129024
s_nop 0
buffer_load_dwordx4 v27, s[20:23], s56 offen lds
s_add_u32 s56, s55, 56192
s_mov_b32 m0, 130048
s_nop 0
buffer_load_dwordx4 v27, s[20:23], s56 offen lds
s_waitcnt vmcnt(24)
ds_read_b64_tr_b16 a[144:145], v28 offset:4096
ds_read_b64_tr_b16 a[146:147], v28 offset:4352
ds_read_b64_tr_b16 a[148:149], v28 offset:6144
ds_read_b64_tr_b16 a[150:151], v28 offset:6400
ds_read_b64_tr_b16 a[152:153], v28 offset:4128
ds_read_b64_tr_b16 a[154:155], v28 offset:4384
ds_read_b64_tr_b16 a[156:157], v28 offset:6176
ds_read_b64_tr_b16 a[158:159], v28 offset:6432
s_waitcnt lgkmcnt(0)
s_add_u32 s56, s54, 1048576
s_mov_b32 m0, 98304
s_nop 0
buffer_load_dwordx4 v26, s[8:11], s56 offen lds
s_add_u32 s56, s54, 1114112
s_mov_b32 m0, 99328
s_nop 0
buffer_load_dwordx4 v26, s[8:11], s56 offen lds
s_add_u32 s56, s54, 1310720
s_mov_b32 m0, 100352
s_nop 0
buffer_load_dwordx4 v26, s[8:11], s56 offen lds
s_add_u32 s56, s54, 1376256
s_mov_b32 m0, 101376
s_nop 0
buffer_load_dwordx4 v26, s[8:11], s56 offen lds
s_waitcnt vmcnt(24)
ds_read_b64_tr_b16 a[160:161], v28 offset:8192
ds_read_b64_tr_b16 a[162:163], v28 offset:8448
ds_read_b64_tr_b16 a[164:165], v28 offset:10240
ds_read_b64_tr_b16 a[166:167], v28 offset:10496
ds_read_b64_tr_b16 a[168:169], v28 offset:8224
ds_read_b64_tr_b16 a[170:171], v28 offset:8480
ds_read_b64_tr_b16 a[172:173], v28 offset:10272
ds_read_b64_tr_b16 a[174:175], v28 offset:10528
s_waitcnt lgkmcnt(0)
s_add_u32 s56, s54, 0
s_mov_b32 m0, 102400
s_nop 0
buffer_load_dwordx4 v26, s[8:11], s56 offen lds
s_add_u32 s56, s54, 65536
s_mov_b32 m0, 103424
s_nop 0
buffer_load_dwordx4 v26, s[8:11], s56 offen lds
s_add_u32 s56, s54, 262144
s_mov_b32 m0, 104448
s_nop 0
buffer_load_dwordx4 v26, s[8:11], s56 offen lds
s_add_u32 s56, s54, 327680
s_mov_b32 m0, 105472
s_nop 0
buffer_load_dwordx4 v26, s[8:11], s56 offen lds
s_waitcnt vmcnt(24)
ds_read_b64_tr_b16 a[176:177], v29 offset:12288
ds_read_b64_tr_b16 a[178:179], v29 offset:12416
ds_read_b64_tr_b16 a[180:181], v29 offset:12800
ds_read_b64_tr_b16 a[182:183], v29 offset:12928
ds_read_b64_tr_b16 a[184:185], v29 offset:14336
ds_read_b64_tr_b16 a[186:187], v29 offset:14464
ds_read_b64_tr_b16 a[188:189], v29 offset:14848
ds_read_b64_tr_b16 a[190:191], v29 offset:14976
s_waitcnt lgkmcnt(0)
s_add_u32 s56, s54, 3145728
s_mov_b32 m0, 106496
s_nop 0
buffer_load_dwordx4 v26, s[8:11], s56 offen lds
s_add_u32 s56, s54, 3211264
s_mov_b32 m0, 107520
s_nop 0
buffer_load_dwordx4 v26, s[8:11], s56 offen lds
s_add_u32 s56, s54, 3407872
s_mov_b32 m0, 108544
s_nop 0
buffer_load_dwordx4 v26, s[8:11], s56 offen lds
s_add_u32 s56, s54, 3473408
s_mov_b32 m0, 109568
s_nop 0
buffer_load_dwordx4 v26, s[8:11], s56 offen lds
s_waitcnt vmcnt(24)
ds_read_b64_tr_b16 a[192:193], v29 offset:16384
ds_read_b64_tr_b16 a[194:195], v29 offset:16512
ds_read_b64_tr_b16 a[196:197], v29 offset:16896
ds_read_b64_tr_b16 a[198:199], v29 offset:17024
ds_read_b64_tr_b16 a[200:201], v29 offset:18432
ds_read_b64_tr_b16 a[202:203], v29 offset:18560
ds_read_b64_tr_b16 a[204:205], v29 offset:18944
ds_read_b64_tr_b16 a[206:207], v29 offset:19072
s_waitcnt lgkmcnt(0)
s_add_u32 s56, s54, 3670016
s_mov_b32 m0, 110592
s_nop 0
buffer_load_dwordx4 v26, s[12:15], s56 offen lds
s_add_u32 s56, s54, 3735552
s_mov_b32 m0, 111616
s_nop 0
buffer_load_dwordx4 v26, s[12:15], s56 offen lds
s_add_u32 s56, s54, 3932160
s_mov_b32 m0, 112640
s_nop 0
buffer_load_dwordx4 v26, s[12:15], s56 offen lds
s_add_u32 s56, s54, 3997696
s_mov_b32 m0, 113664
s_nop 0
buffer_load_dwordx4 v26, s[12:15], s56 offen lds
s_waitcnt vmcnt(24)
ds_read_b64_tr_b16 a[208:209], v29 offset:20480
ds_read_b64_tr_b16 a[210:211], v29 offset:20608
ds_read_b64_tr_b16 a[212:213], v29 offset:20992
ds_read_b64_tr_b16 a[214:215], v29 offset:21120
ds_read_b64_tr_b16 a[216:217], v29 offset:22528
ds_read_b64_tr_b16 a[218:219], v29 offset:22656
ds_read_b64_tr_b16 a[220:221], v29 offset:23040
ds_read_b64_tr_b16 a[222:223], v29 offset:23168
s_waitcnt lgkmcnt(0)
s_add_u32 s56, s54, 2621440
s_mov_b32 m0, 114688
s_nop 0
buffer_load_dwordx4 v26, s[16:19], s56 offen lds
s_add_u32 s56, s54, 2686976
s_mov_b32 m0, 115712
s_nop 0
buffer_load_dwordx4 v26, s[16:19], s56 offen lds
s_add_u32 s56, s54, 2883584
s_mov_b32 m0, 116736
s_nop 0
buffer_load_dwordx4 v26, s[16:19], s56 offen lds
s_add_u32 s56, s54, 2949120
s_mov_b32 m0, 117760
s_nop 0
buffer_load_dwordx4 v26, s[16:19], s56 offen lds
s_waitcnt vmcnt(24)
ds_read_b64_tr_b16 a[224:225], v29 offset:24576
ds_read_b64_tr_b16 a[226:227], v29 offset:24704
ds_read_b64_tr_b16 a[228:229], v29 offset:25088
ds_read_b64_tr_b16 a[230:231], v29 offset:25216
ds_read_b64_tr_b16 a[232:233], v29 offset:26624
ds_read_b64_tr_b16 a[234:235], v29 offset:26752
ds_read_b64_tr_b16 a[236:237], v29 offset:27136
ds_read_b64_tr_b16 a[238:239], v29 offset:27264
s_waitcnt lgkmcnt(0)
s_add_u32 s56, s55, 73856
s_mov_b32 m0, 118784
s_nop 0
buffer_load_dwordx4 v27, s[20:23], s56 offen lds
s_add_u32 s56, s55, 92288
s_mov_b32 m0, 119808
s_nop 0
buffer_load_dwordx4 v27, s[20:23], s56 offen lds
s_add_u32 s56, s55, 74112
s_mov_b32 m0, 120832
s_nop 0
buffer_load_dwordx4 v27, s[20:23], s56 offen lds
s_add_u32 s56, s55, 92544
s_mov_b32 m0, 121856
s_nop 0
buffer_load_dwordx4 v27, s[20:23], s56 offen lds
s_waitcnt vmcnt(24)
ds_read_b64_tr_b16 a[240:241], v29 offset:28672
ds_read_b64_tr_b16 a[242:243], v29 offset:28800
ds_read_b64_tr_b16 a[244:245], v29 offset:29184
ds_read_b64_tr_b16 a[246:247], v29 offset:29312
ds_read_b64_tr_b16 a[248:249], v29 offset:30720
ds_read_b64_tr_b16 a[250:251], v29 offset:30848
ds_read_b64_tr_b16 a[252:253], v29 offset:31232
ds_read_b64_tr_b16 a[254:255], v29 offset:31360
s_waitcnt lgkmcnt(0)
s_add_u32 s56, s55, 128
s_mov_b32 m0, 122880
s_nop 0
buffer_load_dwordx4 v27, s[20:23], s56 offen lds
s_add_u32 s56, s55, 18560
s_mov_b32 m0, 123904
s_nop 0
buffer_load_dwordx4 v27, s[20:23], s56 offen lds
s_add_u32 s56, s55, 74368
s_mov_b32 m0, 124928
s_nop 0
buffer_load_dwordx4 v27, s[20:23], s56 offen lds
s_add_u32 s56, s55, 92800
s_mov_b32 m0, 125952
s_nop 0
buffer_load_dwordx4 v27, s[20:23], s56 offen lds
s_waitcnt vmcnt(24)
ds_read_b64_tr_b16 v[44:45], v28 offset:0
ds_read_b64_tr_b16 v[46:47], v28 offset:256
ds_read_b64_tr_b16 v[48:49], v28 offset:2048
ds_read_b64_tr_b16 v[50:51], v28 offset:2304
ds_read_b64_tr_b16 v[52:53], v28 offset:32
ds_read_b64_tr_b16 v[54:55], v28 offset:288
ds_read_b64_tr_b16 v[56:57], v28 offset:2080
ds_read_b64_tr_b16 v[58:59], v28 offset:2336
s_waitcnt lgkmcnt(0)
ds_write_b128 v2, v[44:47] offset:0
ds_write_b128 v2, v[48:51] offset:1024
ds_write_b128 v2, v[52:55] offset:2048
ds_write_b128 v2, v[56:59] offset:3072
s_waitcnt lgkmcnt(0)
s_add_u32 s56, s55, 37504
s_mov_b32 m0, 126976
s_nop 0
buffer_load_dwordx4 v27, s[20:23], s56 offen lds
s_add_u32 s56, s55, 55936
s_mov_b32 m0, 128000
s_nop 0
buffer_load_dwordx4 v27, s[20:23], s56 offen lds
s_add_u32 s56, s55, 896
s_mov_b32 m0, 129024
s_nop 0
buffer_load_dwordx4 v27, s[20:23], s56 offen lds
s_add_u32 s56, s55, 19328
s_mov_b32 m0, 130048
s_nop 0
buffer_load_dwordx4 v27, s[20:23], s56 offen lds
s_waitcnt vmcnt(24)
ds_read_b64_tr_b16 v[44:45], v28 offset:4096
ds_read_b64_tr_b16 v[46:47], v28 offset:4352
ds_read_b64_tr_b16 v[48:49], v28 offset:6144
ds_read_b64_tr_b16 v[50:51], v28 offset:6400
ds_read_b64_tr_b16 v[52:53], v28 offset:4128
ds_read_b64_tr_b16 v[54:55], v28 offset:4384
ds_read_b64_tr_b16 v[56:57], v28 offset:6176
ds_read_b64_tr_b16 v[58:59], v28 offset:6432
s_waitcnt lgkmcnt(0)
ds_write_b128 v2, v[44:47] offset:4096
ds_write_b128 v2, v[48:51] offset:5120
ds_write_b128 v2, v[52:55] offset:6144
ds_write_b128 v2, v[56:59] offset:7168
s_waitcnt lgkmcnt(0)
s_waitcnt vmcnt(20)
ds_read_b64_tr_b16 v[44:45], v28 offset:8192
ds_read_b64_tr_b16 v[46:47], v28 offset:8448
ds_read_b64_tr_b16 v[48:49], v28 offset:10240
ds_read_b64_tr_b16 v[50:51], v28 offset:10496
ds_read_b64_tr_b16 v[52:53], v28 offset:8224
ds_read_b64_tr_b16 v[54:55], v28 offset:8480
ds_read_b64_tr_b16 v[56:57], v28 offset:10272
ds_read_b64_tr_b16 v[58:59], v28 offset:10528
s_waitcnt lgkmcnt(0)
ds_write_b128 v2, v[44:47] offset:8192
ds_write_b128 v2, v[48:51] offset:9216
ds_write_b128 v2, v[52:55] offset:10240
ds_write_b128 v2, v[56:59] offset:11264
s_waitcnt lgkmcnt(0)
s_waitcnt vmcnt(16)
ds_read_b64_tr_b16 v[44:45], v28 offset:12288
ds_read_b64_tr_b16 v[46:47], v28 offset:12544
ds_read_b64_tr_b16 v[48:49], v28 offset:14336
ds_read_b64_tr_b16 v[50:51], v28 offset:14592
ds_read_b64_tr_b16 v[52:53], v28 offset:12320
ds_read_b64_tr_b16 v[54:55], v28 offset:12576
ds_read_b64_tr_b16 v[56:57], v28 offset:14368
ds_read_b64_tr_b16 v[58:59], v28 offset:14624
s_waitcnt lgkmcnt(0)
ds_write_b128 v2, v[44:47] offset:12288
ds_write_b128 v2, v[48:51] offset:13312
ds_write_b128 v2, v[52:55] offset:14336
ds_write_b128 v2, v[56:59] offset:15360
s_waitcnt lgkmcnt(0)
s_waitcnt vmcnt(12)
ds_read_b64_tr_b16 v[44:45], v28 offset:16384
ds_read_b64_tr_b16 v[46:47], v28 offset:16640
ds_read_b64_tr_b16 v[48:49], v28 offset:18432
ds_read_b64_tr_b16 v[50:51], v28 offset:18688
ds_read_b64_tr_b16 v[52:53], v28 offset:16416
ds_read_b64_tr_b16 v[54:55], v28 offset:16672
ds_read_b64_tr_b16 v[56:57], v28 offset:18464
ds_read_b64_tr_b16 v[58:59], v28 offset:18720
s_waitcnt lgkmcnt(0)
ds_write_b128 v2, v[44:47] offset:16384
ds_write_b128 v2, v[48:51] offset:17408
ds_write_b128 v2, v[52:55] offset:18432
ds_write_b128 v2, v[56:59] offset:19456
s_waitcnt lgkmcnt(0)
s_waitcnt vmcnt(8)
ds_read_b64_tr_b16 v[44:45], v29 offset:20480
ds_read_b64_tr_b16 v[46:47], v29 offset:20608
ds_read_b64_tr_b16 v[48:49], v29 offset:20992
ds_read_b64_tr_b16 v[50:51], v29 offset:21120
ds_read_b64_tr_b16 v[52:53], v29 offset:22528
ds_read_b64_tr_b16 v[54:55], v29 offset:22656
ds_read_b64_tr_b16 v[56:57], v29 offset:23040
ds_read_b64_tr_b16 v[58:59], v29 offset:23168
s_waitcnt lgkmcnt(0)
ds_write_b128 v2, v[44:47] offset:20480
ds_write_b128 v2, v[48:51] offset:21504
ds_write_b128 v2, v[52:55] offset:22528
ds_write_b128 v2, v[56:59] offset:23552
s_waitcnt lgkmcnt(0)
s_waitcnt vmcnt(4)
ds_read_b64_tr_b16 v[44:45], v29 offset:24576
ds_read_b64_tr_b16 v[46:47], v29 offset:24704
ds_read_b64_tr_b16 v[48:49], v29 offset:25088
ds_read_b64_tr_b16 v[50:51], v29 offset:25216
ds_read_b64_tr_b16 v[52:53], v29 offset:26624
ds_read_b64_tr_b16 v[54:55], v29 offset:26752
ds_read_b64_tr_b16 v[56:57], v29 offset:27136
ds_read_b64_tr_b16 v[58:59], v29 offset:27264
s_waitcnt lgkmcnt(0)
ds_write_b128 v2, v[44:47] offset:24576
ds_write_b128 v2, v[48:51] offset:25600
ds_write_b128 v2, v[52:55] offset:26624
ds_write_b128 v2, v[56:59] offset:27648
s_waitcnt lgkmcnt(0)
s_waitcnt vmcnt(0)
ds_read_b64_tr_b16 v[44:45], v29 offset:28672
ds_read_b64_tr_b16 v[46:47], v29 offset:28800
ds_read_b64_tr_b16 v[48:49], v29 offset:29184
ds_read_b64_tr_b16 v[50:51], v29 offset:29312
ds_read_b64_tr_b16 v[52:53], v29 offset:30720
ds_read_b64_tr_b16 v[54:55], v29 offset:30848
ds_read_b64_tr_b16 v[56:57], v29 offset:31232
ds_read_b64_tr_b16 v[58:59], v29 offset:31360
s_waitcnt lgkmcnt(0)
ds_write_b128 v2, v[44:47] offset:28672
ds_write_b128 v2, v[48:51] offset:29696
ds_write_b128 v2, v[52:55] offset:30720
ds_write_b128 v2, v[56:59] offset:31744
s_waitcnt lgkmcnt(0)
v_mov_b32 v24, 0
L_rdv_w2r:
buffer_load_dword v23, v24, s[28:31], 0 offen sc0 sc1
s_sub_u32 s41, s41, 1
s_cbranch_scc1 L_exit
s_waitcnt vmcnt(0)
v_readfirstlane_b32 s56, v23
s_nop 0
s_and_b32 s57, s56, 0xff
s_cmp_lg_u32 s57, 32
s_cbranch_scc1 L_rdv_w2r
s_lshl_b32 s55, s32, 2
v_mov_b32 v24, 0
L_kvw_w2rp:
buffer_load_dword v23, v24, s[28:31], s55 offen offset:128 sc0 sc1
s_sub_u32 s41, s41, 1
s_cbranch_scc1 L_exit
s_waitcnt vmcnt(0)
v_readfirstlane_b32 s54, v23
s_nop 0
s_and_b32 s54, s54, 255
s_cmp_lg_u32 s54, 4
s_cbranch_scc1 L_kvw_w2rp
s_mov_b32 m0, 0
s_lshl_b32 s101, s32, 7
s_add_u32 s101, s101, 327680
s_mov_b32 s100, 22
s_lshl_b32 s58, s58, 5
s_cmp_eq_u32 s56, s58
s_cbranch_scc0 L_slow_w2r
buffer_load_dwordx4 v[12:15], v9, s[4:7], s37 offen offset:0
buffer_load_dwordx4 v[16:19], v9, s[4:7], s37 offen offset:1024
buffer_load_dwordx4 v[52:55], v1, s[4:7], s37 offen offset:2048
buffer_load_dwordx4 v[56:59], v1, s[4:7], s37 offen offset:3072
v_mov_b64 v[20:21], 0
v_mov_b64 v[22:23], 0
v_mov_b64 v[24:25], 0
v_mov_b64 v[26:27], 0
v_mov_b64 v[28:29], 0
v_mov_b64 v[30:31], 0
v_mov_b64 v[32:33], 0
v_mov_b64 v[34:35], 0
v_mov_b64 v[36:37], 0
v_mov_b64 v[38:39], 0
v_mov_b64 v[40:41], 0
v_mov_b64 v[42:43], 0
v_lshrrev_b32 v6, 2, v1
ds_read_b128 v[44:47], v2 offset:0
ds_read_b128 v[48:51], v2 offset:1024
s_waitcnt vmcnt(0)
buffer_load_dwordx4 v[60:63], v1, s[4:7], s47 offen sc1
buffer_load_dwordx4 v[68:71], v1, s[4:7], s38 offen sc1
s_waitcnt vmcnt(0)
.p2align 6
L_top_w2rf:
s_waitcnt vmcnt(1)
L_a0_w2rf:
s_waitcnt lgkmcnt(0)
v_smfmac_f32_16x16x64_bf16 v[20:23], v[60:63], v[44:51], v0
ds_write_b128 v1, v[60:63] offset:3072
v_smfmac_f32_16x16x64_bf16 v[28:31], v[60:63], v[176:183], v0
ds_read_b128 v[44:47], v2 offset:2048
buffer_load_dwordx4 v[64:67], v1, s[4:7], s48 offen sc1
v_smfmac_f32_16x16x64_bf16 v[32:35], v[60:63], v[184:191], v0
ds_read_b128 v[48:51], v2 offset:3072
buffer_load_dword v76, v6, s[4:7], s49 offen sc1
v_smfmac_f32_16x16x64_bf16 v[36:39], v[60:63], a[48:55], v0
s_waitcnt vmcnt(2)
v_bitop3_b32 v77, v60, v68, s35 bitop3:0x7e
v_smfmac_f32_16x16x64_bf16 v[40:43], v[60:63], a[56:63], v0
v_and_b32 v77, 1, v77
v_smfmac_f32_16x16x64_bf16 v[20:23], v[68:71], v[80:87], v0
v_cmp_ne_u32 vcc, 0, v77
s_waitcnt lgkmcnt(0)
v_smfmac_f32_16x16x64_bf16 v[24:27], v[60:63], v[44:51], v0
ds_read_b128 v[44:47], v2 offset:4096
v_smfmac_f32_16x16x64_bf16 v[24:27], v[68:71], v[88:95], v0
s_cbranch_vccnz L_ra0_w2rf
s_barrier
ds_read_b128 v[72:75], v1 offset:1024
v_smfmac_f32_16x16x64_bf16 v[28:31], v[68:71], v[192:199], v0
ds_read_b128 v[48:51], v2 offset:5120
v_smfmac_f32_16x16x64_bf16 v[32:35], v[68:71], v[200:207], v0
ds_read_b128 v[60:63], v1 offset:2048
v_smfmac_f32_16x16x64_bf16 v[36:39], v[68:71], a[64:71], v0
v_smfmac_f32_16x16x64_bf16 v[40:43], v[68:71], a[72:79], v0
s_waitcnt lgkmcnt(2)
s_waitcnt lgkmcnt(1)
v_smfmac_f32_16x16x64_bf16 v[20:23], v[72:75], v[44:51], v0
ds_read_b128 v[44:47], v2 offset:6144
v_smfmac_f32_16x16x64_bf16 v[28:31], v[72:75], v[208:215], v0
ds_read_b128 v[48:51], v2 offset:7168
v_smfmac_f32_16x16x64_bf16 v[32:35], v[72:75], v[216:223], v0
s_waitcnt vmcnt(0)
ds_write_b128 v1, v[64:67] offset:7168
v_smfmac_f32_16x16x64_bf16 v[36:39], v[72:75], a[80:87], v0
ds_write_addtid_b32 v76 offset:9728
v_bitop3_b32 v77, v64, s35, 1 bitop3:0x28
v_smfmac_f32_16x16x64_bf16 v[40:43], v[72:75], a[88:95], v0
v_bitop3_b32 v78, v76, s35, v11 bitop3:0x28
s_waitcnt lgkmcnt(2)
v_smfmac_f32_16x16x64_bf16 v[24:27], v[72:75], v[44:51], v0
ds_read_b128 v[44:47], v2 offset:8192
v_or_b32 v77, v77, v78
v_smfmac_f32_16x16x64_bf16 v[20:23], v[60:63], v[96:103], v0
ds_read_b128 v[48:51], v2 offset:9216
v_cmp_ne_u32 vcc, 0, v77
v_smfmac_f32_16x16x64_bf16 v[24:27], v[60:63], v[104:111], v0
v_smfmac_f32_16x16x64_bf16 v[36:39], v[60:63], a[96:103], v0
s_cbranch_vccnz L_ra1_w2rf
L_a1_w2rf:
s_waitcnt lgkmcnt(2)
s_barrier
ds_read_b128 v[68:71], v1 offset:8192
v_smfmac_f32_16x16x64_bf16 v[28:31], v[60:63], v[224:231], v0
ds_read_b128 v[72:75], v1 offset:5120
v_lshlrev_b32 v6, 2, v1
v_smfmac_f32_16x16x64_bf16 v[40:43], v[60:63], a[104:111], v0
ds_read_b128 v[76:79], v1 offset:9216
v_smfmac_f32_16x16x64_bf16 v[32:35], v[60:63], v[232:239], v0
ds_read_b128 v[60:63], v1 offset:6144
s_waitcnt lgkmcnt(4)
v_smfmac_f32_16x16x64_bf16 v[20:23], v[64:67], v[44:51], v0
ds_read_b128 v[44:47], v2 offset:10240
buffer_load_dword v6, s[4:7], s39 offen lds
s_waitcnt lgkmcnt(4)
v_smfmac_f32_16x16x64_bf16 v[20:23], v[68:71], v[112:119], v0
ds_read_b128 v[48:51], v2 offset:11264
v_smfmac_f32_16x16x64_bf16 v[24:27], v[68:71], v[120:127], v0
s_waitcnt lgkmcnt(4)
v_smfmac_f32_16x16x64_bf16 v[20:23], v[72:75], v[128:135], v0
s_waitcnt lgkmcnt(3)
v_smfmac_f32_16x16x64_bf16 v[20:23], v[76:79], v[160:167], v0
s_waitcnt lgkmcnt(2)
v_smfmac_f32_16x16x64_bf16 v[20:23], v[60:63], v[144:151], v0
s_waitcnt lgkmcnt(0)
v_smfmac_f32_16x16x64_bf16 v[24:27], v[64:67], v[44:51], v0
ds_read_b128 v[44:47], v2 offset:12288
v_smfmac_f32_16x16x64_bf16 v[24:27], v[72:75], v[136:143], v0
ds_read_b128 v[48:51], v2 offset:13312
v_add_f32 v20, v20, v22
v_smfmac_f32_16x16x64_bf16 v[24:27], v[76:79], v[168:175], v0
v_add_f32 v21, v21, v23
v_smfmac_f32_16x16x64_bf16 v[24:27], v[60:63], v[152:159], v0
v_cvt_pk_bf16_f32 v22, v20, v21
v_smfmac_f32_16x16x64_bf16 v[28:31], v[64:67], v[240:247], v0
v_smfmac_f32_16x16x64_bf16 v[28:31], v[72:75], a[0:7], v0
v_add_f32 v24, v24, v26
v_add_f32 v25, v25, v27
v_cvt_pk_bf16_f32 v23, v24, v25
s_waitcnt lgkmcnt(0)
v_smfmac_f32_16x16x64_bf16 v[28:31], v[68:71], v[44:51], v0
ds_write_b64 v3, v[22:23] offset:11264
v_smfmac_f32_16x16x64_bf16 v[28:31], v[76:79], a[32:39], v0
ds_read_b128 v[44:47], v2 offset:14336
v_smfmac_f32_16x16x64_bf16 v[28:31], v[60:63], a[16:23], v0
ds_read_b128 v[48:51], v2 offset:15360
v_smfmac_f32_16x16x64_bf16 v[32:35], v[64:67], v[248:255], v0
s_waitcnt lgkmcnt(2)
s_barrier
ds_read_b64_tr_b16 v[20:21], v4 offset:10240
ds_read_b64_tr_b16 v[22:23], v4 offset:10752
v_smfmac_f32_16x16x64_bf16 v[32:35], v[72:75], a[8:15], v0
ds_read_b64_tr_b16 v[24:25], v4 offset:11264
v_add_f32 v28, v28, v30
v_smfmac_f32_16x16x64_bf16 v[32:35], v[76:79], a[40:47], v0
ds_read_b64_tr_b16 v[26:27], v4 offset:11776
v_add_f32 v29, v29, v31
s_waitcnt lgkmcnt(4)
v_smfmac_f32_16x16x64_bf16 v[32:35], v[68:71], v[44:51], v0
ds_read_b128 v[44:47], v2 offset:18432
v_cvt_pk_bf16_f32 v30, v28, v29
v_smfmac_f32_16x16x64_bf16 v[32:35], v[60:63], a[24:31], v0
ds_read_b128 v[48:51], v2 offset:19456
s_waitcnt lgkmcnt(4)
v_mfma_f32_16x16x32_bf16 v[12:15], v[12:15], v[20:23], 0
s_waitcnt lgkmcnt(2)
v_mfma_f32_16x16x32_bf16 v[12:15], v[16:19], v[24:27], v[12:15]
v_add_f32 v32, v32, v34
v_add_f32 v33, v33, v35
v_cvt_pk_bf16_f32 v31, v32, v33
ds_write_b64 v3, v[30:31] offset:13312
v_smfmac_f32_16x16x64_bf16 v[36:39], v[64:67], a[112:119], v0
s_nop 2
v_add_f32_dpp v12, v14, v12 quad_perm:[2,3,0,1] row_mask:0xf bank_mask:0xf
v_add_f32_dpp v13, v15, v13 quad_perm:[2,3,0,1] row_mask:0xf bank_mask:0xf
ds_write_b64 v5, v[12:13] offset:14848
v_smfmac_f32_16x16x64_bf16 v[40:43], v[64:67], a[120:127], v0
s_waitcnt lgkmcnt(1)
s_barrier
ds_read_b64_tr_b16 v[64:65], v4 offset:12288
ds_read_b64_tr_b16 v[66:67], v4 offset:12800
v_smfmac_f32_16x16x64_bf16 v[36:39], v[68:71], a[128:135], v0
ds_read_b64_tr_b16 v[16:17], v4 offset:13312
ds_read_b64_tr_b16 v[18:19], v4 offset:13824
v_smfmac_f32_16x16x64_bf16 v[40:43], v[68:71], a[136:143], v0
s_waitcnt lgkmcnt(4)
s_barrier
ds_read_b128 v[68:71], v1 offset:14336
v_smfmac_f32_16x16x64_bf16 v[40:43], v[60:63], v[44:51], v0
ds_read_b128 v[44:47], v2 offset:16384
s_waitcnt lgkmcnt(4)
v_mfma_f32_16x16x32_bf16 v[64:67], v[64:67], v[20:23], 0
ds_read_b128 v[48:51], v2 offset:17408
s_waitcnt lgkmcnt(3)
v_mfma_f32_16x16x32_bf16 v[64:67], v[16:19], v[24:27], v[64:67]
v_smfmac_f32_16x16x64_bf16 v[40:43], v[72:75], a[152:159], v0
ds_read_b128 v[12:15], v2 offset:22528
s_waitcnt lgkmcnt(3)
v_max3_f32 v25, v68, v69, v70
v_smfmac_f32_16x16x64_bf16 v[40:43], v[76:79], a[168:175], v0
ds_read_b128 v[16:19], v2 offset:23552
v_add_f32_dpp v64, v66, v64 quad_perm:[2,3,0,1] row_mask:0xf bank_mask:0xf
v_add_f32_dpp v65, v67, v65 quad_perm:[2,3,0,1] row_mask:0xf bank_mask:0xf
v_max_f32 v25, v25, v71
v_max_f32 v24, v64, v65
v_mul_f32 v24, s50, v24
v_max_f32_dpp v25, v25, v25 quad_perm:[2,3,0,1] row_mask:0xf bank_mask:0xf
v_smfmac_f32_16x16x64_bf16 v[36:39], v[72:75], a[144:151], v0
s_nop 0
v_max_f32_dpp v26, v24, v25 quad_perm:[0,1,0,1] row_mask:0xf bank_mask:0xf
v_max_f32_dpp v27, v24, v25 quad_perm:[0,1,0,1] row_mask:0xf bank_mask:0xf
v_smfmac_f32_16x16x64_bf16 v[36:39], v[76:79], a[160:167], v0
s_nop 0
v_permlane16_swap_b32 v26, v27
v_max_f32 v28, v26, v27
v_max_f32 v29, v26, v27
s_waitcnt lgkmcnt(2)
v_smfmac_f32_16x16x64_bf16 v[36:39], v[60:63], v[44:51], v0
v_permlane32_swap_b32 v28, v29
v_max_f32 v28, v28, v29
v_sub_f32 v68, v68, v28
v_sub_f32 v69, v69, v28
v_sub_f32 v70, v70, v28
v_sub_f32 v71, v71, v28
v_exp_f32 v68, v68
v_exp_f32 v69, v69
v_exp_f32 v70, v70
v_exp_f32 v71, v71
v_cvt_pk_bf16_f32 v20, v68, v69
v_cvt_pk_bf16_f32 v21, v70, v71
v_pk_add_f32 v[36:37], v[36:37], v[38:39]
v_mov_b32_dpp v22, v20 quad_perm:[2,3,0,1] row_mask:0xf bank_mask:0xf
v_mov_b32_dpp v23, v21 quad_perm:[2,3,0,1] row_mask:0xf bank_mask:0xf
v_pk_fma_f32 v[64:65], v[64:65], s[50:51], v[28:29] op_sel_hi:[1,1,0] neg_lo:[0,0,1] neg_hi:[0,0,1]
v_cvt_pk_bf16_f32 v32, v36, v37
v_pk_add_f32 v[40:41], v[40:41], v[42:43]
v_mfma_f32_16x16x32_bf16 v[36:39], v[52:55], v[20:23], 0
v_mov_b64 v[72:73], s[52:53]
v_mov_b64 v[74:75], s[52:53]
v_cvt_pk_bf16_f32 v33, v40, v41
v_exp_f32 v64, v64
v_mfma_f32_16x16x32_bf16 v[68:71], v[72:75], v[20:23], 0
v_exp_f32 v65, v65
v_mov_b32 v25, 0
v_cvt_pk_bf16_f32 v24, v64, v65
v_mfma_f32_16x16x32_bf16 v[40:43], v[56:59], v[20:23], 0
v_cvt_pk_bf16_f32 v27, v64, v65
v_mov_b32 v26, 0
v_mfma_f32_16x16x16_bf16 v[68:71], v[72:73], v[24:25], v[68:71]
ds_read_b128 v[44:47], v2 offset:20480
v_mfma_f32_16x16x16_bf16 v[36:39], v[32:33], v[24:25], v[36:39]
ds_read_b128 v[48:51], v2 offset:21504
v_mfma_f32_16x16x16_bf16 v[40:43], v[32:33], v[26:27], v[40:43]
v_rcp_f32 v68, v68
v_mov_b64 v[76:77], 0
v_mov_b64 v[78:79], 0
s_nop 0
v_mul_f32 v36, v36, v68
v_mul_f32 v37, v37, v68
v_mul_f32 v38, v38, v68
v_mul_f32 v39, v39, v68
v_pk_mul_f32 v[40:41], v[40:41], v[68:69] op_sel_hi:[1,0]
v_pk_mul_f32 v[42:43], v[42:43], v[68:69] op_sel_hi:[1,0]
v_cvt_pk_bf16_f32 v36, v36, v37
v_cvt_pk_bf16_f32 v37, v38, v39
v_cvt_pk_bf16_f32 v38, v40, v41
v_cvt_pk_bf16_f32 v39, v42, v43
ds_write_b128 v1, v[36:39] offset:7168
ds_read_b128 v[60:63], v7 offset:7168
buffer_store_dwordx4 v[30:33], v1, s[4:7], s40 offen sc0 sc1
ds_read_b128 v[52:55], v2 offset:24576
ds_read_b128 v[56:59], v2 offset:25600
s_cmp_eq_u32 s34, s100
v_mov_b64 v[20:21], 0
v_mov_b64 v[22:23], 0
s_cbranch_scc1 L_ev_w2rf
L_evb_w2rf:
s_waitcnt lgkmcnt(3)
s_barrier
ds_read_b128 v[64:67], v7 offset:8192
ds_read_b128 v[68:71], v7 offset:5120
ds_read_b128 v[72:75], v7 offset:6144
s_waitcnt lgkmcnt(5)
v_smfmac_f32_16x16x64_bf16 v[76:79], v[60:63], v[44:51], v0 abid:1
ds_read_b128 v[44:47], v2 offset:26624
v_mov_b64 v[24:25], 0
v_smfmac_f32_16x16x64_bf16 v[20:23], v[60:63], v[12:19], v0 abid:1
ds_read_b128 v[48:51], v2 offset:27648
v_mov_b64 v[26:27], 0
s_waitcnt lgkmcnt(4)
v_smfmac_f32_16x16x64_bf16 v[76:79], v[64:67], a[176:183], v0 abid:1
ds_read_b128 v[12:15], v2 offset:28672
v_mov_b64 v[40:41], 0
s_waitcnt lgkmcnt(4)
v_smfmac_f32_16x16x64_bf16 v[76:79], v[68:71], v[52:59], v0 abid:1
ds_read_b128 v[16:19], v2 offset:29696
v_mov_b64 v[42:43], 0
s_waitcnt lgkmcnt(4)
v_smfmac_f32_16x16x64_bf16 v[76:79], v[72:75], a[184:191], v0 abid:1
ds_read_b128 v[52:55], v2 offset:30720
v_smfmac_f32_16x16x64_bf16 v[20:23], v[64:67], a[192:199], v0 abid:1
ds_read_b128 v[56:59], v2 offset:31744
v_smfmac_f32_16x16x64_bf16 v[20:23], v[68:71], a[200:207], v0 abid:1
v_cvt_pk_bf16_f32 v76, v76, v77
v_cvt_pk_bf16_f32 v77, v78, v79
v_bfi_b32 v76, 1, s35, v76
buffer_store_dwordx2 v[76:77], v8, s[4:7], s42 offen
v_smfmac_f32_16x16x64_bf16 v[20:23], v[72:75], a[208:215], v0 abid:1
s_waitcnt lgkmcnt(4)
v_smfmac_f32_16x16x64_bf16 v[24:27], v[60:63], v[44:51], v0 abid:1
v_smfmac_f32_16x16x64_bf16 v[24:27], v[64:67], a[216:223], v0 abid:1
v_cvt_pk_bf16_f32 v20, v20, v21
v_cvt_pk_bf16_f32 v21, v22, v23
v_bfi_b32 v20, 1, s35, v20
buffer_store_dwordx2 v[20:21], v8, s[4:7], s43 offen
v_smfmac_f32_16x16x64_bf16 v[24:27], v[68:71], a[224:231], v0 abid:1
s_waitcnt lgkmcnt(2)
v_smfmac_f32_16x16x64_bf16 v[24:27], v[72:75], v[12:19], v0 abid:1
v_smfmac_f32_16x16x64_bf16 v[40:43], v[60:63], a[232:239], v0 abid:1
v_smfmac_f32_16x16x64_bf16 v[40:43], v[64:67], a[240:247], v0 abid:1
v_cvt_pk_bf16_f32 v24, v24, v25
s_waitcnt lgkmcnt(0)
v_smfmac_f32_16x16x64_bf16 v[40:43], v[68:71], v[52:59], v0 abid:1
v_cvt_pk_bf16_f32 v25, v26, v27
v_smfmac_f32_16x16x64_bf16 v[40:43], v[72:75], a[248:255], v0 abid:1
v_bfi_b32 v24, 1, s35, v24
buffer_store_dwordx2 v[24:25], v8, s[4:7], s44 offen
s_nop 5
v_cvt_pk_bf16_f32 v40, v40, v41
v_cvt_pk_bf16_f32 v41, v42, v43
v_bfi_b32 v40, 1, s35, v40
buffer_store_dwordx2 v[40:41], v8, s[4:7], s45 offen
s_add_u32 s34, s34, 1
s_add_u32 s37, s37, 524288
s_add_u32 s39, s39, 524288
v_and_b32 v6, 0x70, v1
ds_read_b128 v[76:79], v6 offset:256
v_mov_b64 v[20:21], 0
v_mov_b64 v[22:23], 0
v_mov_b64 v[24:25], 0
v_mov_b64 v[26:27], 0
v_mov_b64 v[28:29], 0
v_mov_b64 v[34:35], 0
v_mov_b64 v[36:37], 0
v_mov_b64 v[38:39], 0
v_mov_b64 v[40:41], 0
v_mov_b64 v[42:43], 0
s_waitcnt vmcnt(2)
buffer_load_dwordx4 v[44:47], v9, s[4:7], s3 offen offset:0 sc1
buffer_load_dwordx4 v[48:51], v9, s[4:7], s3 offen offset:1024 sc1
buffer_load_dwordx4 v[52:55], v9, s[4:7], s3 offen offset:2048 sc1
buffer_load_dwordx4 v[56:59], v9, s[4:7], s3 offen offset:3072 sc1
s_waitcnt lgkmcnt(0)
s_waitcnt vmcnt(3)
L_r_w2rf:
v_mfma_f32_16x16x32_bf16 v[72:75], v[44:47], v[76:79], 0
s_waitcnt vmcnt(2)
v_mfma_f32_16x16x32_bf16 v[72:75], v[48:51], v[76:79], v[72:75]
v_bitop3_b32 v68, v44, v48, s35 bitop3:0x7e
s_waitcnt vmcnt(1)
v_mfma_f32_16x16x32_bf16 v[72:75], v[52:55], v[76:79], v[72:75]
s_waitcnt vmcnt(0)
v_mfma_f32_16x16x32_bf16 v[72:75], v[56:59], v[76:79], v[72:75]
v_bitop3_b32 v69, v52, v56, s35 bitop3:0x7e
v_bitop3_b32 v68, v68, v69, 1 bitop3:0xa8
v_cmp_ne_u32 vcc, 0, v68
s_cbranch_vccnz L_rr_w2rf
ds_read_b128 v[44:47], v2 offset:0
ds_read_b128 v[48:51], v2 offset:1024
s_nop 1
v_pk_add_f32 v[72:73], v[72:73], v[74:75]
v_cvt_pk_bf16_f32 v68, v72, v73
v_bfi_b32 v68, v11, s36, v68
buffer_store_dword v68, v10, s[4:7], 0 offen
buffer_load_dwordx4 v[12:15], v9, s[4:7], s37 offen offset:0
buffer_load_dwordx4 v[16:19], v9, s[4:7], s37 offen offset:1024
buffer_load_dwordx4 v[52:55], v1, s[4:7], s37 offen offset:2048
buffer_load_dwordx4 v[56:59], v1, s[4:7], s37 offen offset:3072
s_not_b32 s35, s35
s_not_b32 s36, s36
v_lshrrev_b32 v6, 2, v1
s_waitcnt vmcnt(4)
s_barrier
buffer_load_dwordx4 v[60:63], v1, s[4:7], s47 offen sc1
buffer_load_dwordx4 v[68:71], v1, s[4:7], s38 offen sc1
s_add_u32 s40, s40, 131072
v_mov_b64 v[30:31], 0
v_mov_b64 v[32:33], 0
s_branch L_top_w2rf
L_done_w2rf:
s_waitcnt vmcnt(0)
s_barrier
s_waitcnt vmcnt(0) lgkmcnt(0)
s_endpgm
L_ra0_w2rf:
buffer_load_dwordx4 v[60:63], v1, s[4:7], s47 offen sc1
buffer_load_dwordx4 v[68:71], v1, s[4:7], s38 offen sc1
s_sub_u32 s41, s41, 1
s_cbranch_scc1 L_exit
ds_read_b128 v[44:47], v2 offset:0
ds_read_b128 v[48:51], v2 offset:1024
s_waitcnt vmcnt(0) lgkmcnt(0)
v_mov_b64 v[20:21], 0
v_mov_b64 v[22:23], 0
v_mov_b64 v[24:25], 0
v_mov_b64 v[26:27], 0
v_mov_b64 v[28:29], 0
v_mov_b64 v[30:31], 0
v_mov_b64 v[32:33], 0
v_mov_b64 v[34:35], 0
v_mov_b64 v[36:37], 0
v_mov_b64 v[38:39], 0
v_mov_b64 v[40:41], 0
v_mov_b64 v[42:43], 0
s_nop 0
s_branch L_a0_w2rf
L_ra1_w2rf:
buffer_load_dwordx4 v[64:67], v1, s[4:7], s48 offen sc1
buffer_load_dword v76, v6, s[4:7], s49 offen sc1
s_sub_u32 s41, s41, 1
s_cbranch_scc1 L_exit
s_waitcnt vmcnt(0)
v_bitop3_b32 v77, v64, s35, 1 bitop3:0x28
v_bitop3_b32 v78, v76, s35, v11 bitop3:0x28
v_or_b32 v77, v77, v78
v_cmp_ne_u32 vcc, 0, v77
s_cbranch_vccnz L_ra1_w2rf
ds_write_b128 v1, v[64:67] offset:7168
ds_write_addtid_b32 v76 offset:9728
s_waitcnt lgkmcnt(0)
s_branch L_a1_w2rf
L_ev_w2rf:
s_cmp_eq_u32 s34, 63
s_cbranch_scc1 L_done_w2rf
s_mov_b32 s100, 63

s_lshl_b32 s55, s32, 2
v_mov_b32 v34, 0
L_kvw_w2rf:
buffer_load_dword v29, v34, s[28:31], s55 offen offset:128 sc0 sc1
s_sub_u32 s41, s41, 1
s_cbranch_scc1 L_exit
s_waitcnt vmcnt(0)
v_readfirstlane_b32 s54, v29
s_nop 0
s_and_b32 s54, s54, 65280
s_cmp_lg_u32 s54, 1024
s_cbranch_scc1 L_kvw_w2rf
s_branch L_evb_w2rf
L_rr_w2rf:
buffer_load_dwordx4 v[44:47], v9, s[4:7], s3 offen offset:0 sc1
buffer_load_dwordx4 v[48:51], v9, s[4:7], s3 offen offset:1024 sc1
buffer_load_dwordx4 v[52:55], v9, s[4:7], s3 offen offset:2048 sc1
buffer_load_dwordx4 v[56:59], v9, s[4:7], s3 offen offset:3072 sc1
s_sub_u32 s41, s41, 1
s_cbranch_scc1 L_exit
s_waitcnt vmcnt(0)
s_branch L_r_w2rf
L_slow_w2r:
buffer_load_dwordx4 v[12:15], v9, s[4:7], s37 offen offset:0
buffer_load_dwordx4 v[16:19], v9, s[4:7], s37 offen offset:1024
buffer_load_dwordx4 v[52:55], v1, s[4:7], s37 offen offset:2048
buffer_load_dwordx4 v[56:59], v1, s[4:7], s37 offen offset:3072
v_mov_b64 v[20:21], 0
v_mov_b64 v[22:23], 0
v_mov_b64 v[24:25], 0
v_mov_b64 v[26:27], 0
v_mov_b64 v[28:29], 0
v_mov_b64 v[30:31], 0
v_mov_b64 v[32:33], 0
v_mov_b64 v[34:35], 0
v_mov_b64 v[36:37], 0
v_mov_b64 v[38:39], 0
v_mov_b64 v[40:41], 0
v_mov_b64 v[42:43], 0
v_lshrrev_b32 v6, 2, v1
ds_read_b128 v[44:47], v2 offset:0
ds_read_b128 v[48:51], v2 offset:1024
s_waitcnt vmcnt(0)
buffer_load_dwordx4 v[60:63], v1, s[4:7], s47 offen sc0 sc1
buffer_load_dwordx4 v[68:71], v1, s[4:7], s38 offen sc0 sc1
s_waitcnt vmcnt(0)
.p2align 6
L_top_w2rs:
s_waitcnt vmcnt(1)
L_a0_w2rs:
s_waitcnt lgkmcnt(0)
v_smfmac_f32_16x16x64_bf16 v[20:23], v[60:63], v[44:51], v0
ds_write_b128 v1, v[60:63] offset:3072
v_smfmac_f32_16x16x64_bf16 v[28:31], v[60:63], v[176:183], v0
ds_read_b128 v[44:47], v2 offset:2048
buffer_load_dwordx4 v[64:67], v1, s[4:7], s48 offen sc0 sc1
v_smfmac_f32_16x16x64_bf16 v[32:35], v[60:63], v[184:191], v0
ds_read_b128 v[48:51], v2 offset:3072
buffer_load_dword v76, v6, s[4:7], s49 offen sc0 sc1
v_smfmac_f32_16x16x64_bf16 v[36:39], v[60:63], a[48:55], v0
s_waitcnt vmcnt(2)
v_bitop3_b32 v77, v60, v68, s35 bitop3:0x7e
v_smfmac_f32_16x16x64_bf16 v[40:43], v[60:63], a[56:63], v0
v_and_b32 v77, 1, v77
v_smfmac_f32_16x16x64_bf16 v[20:23], v[68:71], v[80:87], v0
v_cmp_ne_u32 vcc, 0, v77
s_waitcnt lgkmcnt(0)
v_smfmac_f32_16x16x64_bf16 v[24:27], v[60:63], v[44:51], v0
ds_read_b128 v[44:47], v2 offset:4096
v_smfmac_f32_16x16x64_bf16 v[24:27], v[68:71], v[88:95], v0
s_cbranch_vccnz L_ra0_w2rs
s_barrier
ds_read_b128 v[72:75], v1 offset:1024
v_smfmac_f32_16x16x64_bf16 v[28:31], v[68:71], v[192:199], v0
ds_read_b128 v[48:51], v2 offset:5120
v_smfmac_f32_16x16x64_bf16 v[32:35], v[68:71], v[200:207], v0
ds_read_b128 v[60:63], v1 offset:2048
v_smfmac_f32_16x16x64_bf16 v[36:39], v[68:71], a[64:71], v0
v_smfmac_f32_16x16x64_bf16 v[40:43], v[68:71], a[72:79], v0
s_waitcnt lgkmcnt(2)
s_waitcnt lgkmcnt(1)
v_smfmac_f32_16x16x64_bf16 v[20:23], v[72:75], v[44:51], v0
ds_read_b128 v[44:47], v2 offset:6144
v_smfmac_f32_16x16x64_bf16 v[28:31], v[72:75], v[208:215], v0
ds_read_b128 v[48:51], v2 offset:7168
v_smfmac_f32_16x16x64_bf16 v[32:35], v[72:75], v[216:223], v0
s_waitcnt vmcnt(0)
ds_write_b128 v1, v[64:67] offset:7168
v_smfmac_f32_16x16x64_bf16 v[36:39], v[72:75], a[80:87], v0
ds_write_addtid_b32 v76 offset:9728
v_bitop3_b32 v77, v64, s35, 1 bitop3:0x28
v_smfmac_f32_16x16x64_bf16 v[40:43], v[72:75], a[88:95], v0
v_bitop3_b32 v78, v76, s35, v11 bitop3:0x28
s_waitcnt lgkmcnt(2)
v_smfmac_f32_16x16x64_bf16 v[24:27], v[72:75], v[44:51], v0
ds_read_b128 v[44:47], v2 offset:8192
v_or_b32 v77, v77, v78
v_smfmac_f32_16x16x64_bf16 v[20:23], v[60:63], v[96:103], v0
ds_read_b128 v[48:51], v2 offset:9216
v_cmp_ne_u32 vcc, 0, v77
v_smfmac_f32_16x16x64_bf16 v[24:27], v[60:63], v[104:111], v0
v_smfmac_f32_16x16x64_bf16 v[36:39], v[60:63], a[96:103], v0
s_cbranch_vccnz L_ra1_w2rs
L_a1_w2rs:
s_waitcnt lgkmcnt(2)
s_barrier
ds_read_b128 v[68:71], v1 offset:8192
v_smfmac_f32_16x16x64_bf16 v[28:31], v[60:63], v[224:231], v0
ds_read_b128 v[72:75], v1 offset:5120
v_lshlrev_b32 v6, 2, v1
v_smfmac_f32_16x16x64_bf16 v[40:43], v[60:63], a[104:111], v0
ds_read_b128 v[76:79], v1 offset:9216
v_smfmac_f32_16x16x64_bf16 v[32:35], v[60:63], v[232:239], v0
ds_read_b128 v[60:63], v1 offset:6144
s_waitcnt lgkmcnt(4)
v_smfmac_f32_16x16x64_bf16 v[20:23], v[64:67], v[44:51], v0
ds_read_b128 v[44:47], v2 offset:10240
buffer_load_dword v6, s[4:7], s39 offen lds
s_waitcnt lgkmcnt(4)
v_smfmac_f32_16x16x64_bf16 v[20:23], v[68:71], v[112:119], v0
ds_read_b128 v[48:51], v2 offset:11264
v_smfmac_f32_16x16x64_bf16 v[24:27], v[68:71], v[120:127], v0
s_waitcnt lgkmcnt(4)
v_smfmac_f32_16x16x64_bf16 v[20:23], v[72:75], v[128:135], v0
s_waitcnt lgkmcnt(3)
v_smfmac_f32_16x16x64_bf16 v[20:23], v[76:79], v[160:167], v0
s_waitcnt lgkmcnt(2)
v_smfmac_f32_16x16x64_bf16 v[20:23], v[60:63], v[144:151], v0
s_waitcnt lgkmcnt(0)
v_smfmac_f32_16x16x64_bf16 v[24:27], v[64:67], v[44:51], v0
ds_read_b128 v[44:47], v2 offset:12288
v_smfmac_f32_16x16x64_bf16 v[24:27], v[72:75], v[136:143], v0
ds_read_b128 v[48:51], v2 offset:13312
v_add_f32 v20, v20, v22
v_smfmac_f32_16x16x64_bf16 v[24:27], v[76:79], v[168:175], v0
v_add_f32 v21, v21, v23
v_smfmac_f32_16x16x64_bf16 v[24:27], v[60:63], v[152:159], v0
v_cvt_pk_bf16_f32 v22, v20, v21
v_smfmac_f32_16x16x64_bf16 v[28:31], v[64:67], v[240:247], v0
v_smfmac_f32_16x16x64_bf16 v[28:31], v[72:75], a[0:7], v0
v_add_f32 v24, v24, v26
v_add_f32 v25, v25, v27
v_cvt_pk_bf16_f32 v23, v24, v25
s_waitcnt lgkmcnt(0)
v_smfmac_f32_16x16x64_bf16 v[28:31], v[68:71], v[44:51], v0
ds_write_b64 v3, v[22:23] offset:11264
v_smfmac_f32_16x16x64_bf16 v[28:31], v[76:79], a[32:39], v0
ds_read_b128 v[44:47], v2 offset:14336
v_smfmac_f32_16x16x64_bf16 v[28:31], v[60:63], a[16:23], v0
ds_read_b128 v[48:51], v2 offset:15360
v_smfmac_f32_16x16x64_bf16 v[32:35], v[64:67], v[248:255], v0
s_waitcnt lgkmcnt(2)
s_barrier
ds_read_b64_tr_b16 v[20:21], v4 offset:10240
ds_read_b64_tr_b16 v[22:23], v4 offset:10752
v_smfmac_f32_16x16x64_bf16 v[32:35], v[72:75], a[8:15], v0
ds_read_b64_tr_b16 v[24:25], v4 offset:11264
v_add_f32 v28, v28, v30
v_smfmac_f32_16x16x64_bf16 v[32:35], v[76:79], a[40:47], v0
ds_read_b64_tr_b16 v[26:27], v4 offset:11776
v_add_f32 v29, v29, v31
s_waitcnt lgkmcnt(4)
v_smfmac_f32_16x16x64_bf16 v[32:35], v[68:71], v[44:51], v0
ds_read_b128 v[44:47], v2 offset:18432
v_cvt_pk_bf16_f32 v30, v28, v29
v_smfmac_f32_16x16x64_bf16 v[32:35], v[60:63], a[24:31], v0
ds_read_b128 v[48:51], v2 offset:19456
s_waitcnt lgkmcnt(4)
v_mfma_f32_16x16x32_bf16 v[12:15], v[12:15], v[20:23], 0
s_waitcnt lgkmcnt(2)
v_mfma_f32_16x16x32_bf16 v[12:15], v[16:19], v[24:27], v[12:15]
v_add_f32 v32, v32, v34
v_add_f32 v33, v33, v35
v_cvt_pk_bf16_f32 v31, v32, v33
ds_write_b64 v3, v[30:31] offset:13312
v_smfmac_f32_16x16x64_bf16 v[36:39], v[64:67], a[112:119], v0
s_nop 2
v_add_f32_dpp v12, v14, v12 quad_perm:[2,3,0,1] row_mask:0xf bank_mask:0xf
v_add_f32_dpp v13, v15, v13 quad_perm:[2,3,0,1] row_mask:0xf bank_mask:0xf
ds_write_b64 v5, v[12:13] offset:14848
v_smfmac_f32_16x16x64_bf16 v[40:43], v[64:67], a[120:127], v0
s_waitcnt lgkmcnt(1)
s_barrier
ds_read_b64_tr_b16 v[64:65], v4 offset:12288
ds_read_b64_tr_b16 v[66:67], v4 offset:12800
v_smfmac_f32_16x16x64_bf16 v[36:39], v[68:71], a[128:135], v0
ds_read_b64_tr_b16 v[16:17], v4 offset:13312
ds_read_b64_tr_b16 v[18:19], v4 offset:13824
v_smfmac_f32_16x16x64_bf16 v[40:43], v[68:71], a[136:143], v0
s_waitcnt lgkmcnt(4)
s_barrier
ds_read_b128 v[68:71], v1 offset:14336
v_smfmac_f32_16x16x64_bf16 v[40:43], v[60:63], v[44:51], v0
ds_read_b128 v[44:47], v2 offset:16384
s_waitcnt lgkmcnt(4)
v_mfma_f32_16x16x32_bf16 v[64:67], v[64:67], v[20:23], 0
ds_read_b128 v[48:51], v2 offset:17408
s_waitcnt lgkmcnt(3)
v_mfma_f32_16x16x32_bf16 v[64:67], v[16:19], v[24:27], v[64:67]
v_smfmac_f32_16x16x64_bf16 v[40:43], v[72:75], a[152:159], v0
ds_read_b128 v[12:15], v2 offset:22528
s_waitcnt lgkmcnt(3)
v_max3_f32 v25, v68, v69, v70
v_smfmac_f32_16x16x64_bf16 v[40:43], v[76:79], a[168:175], v0
ds_read_b128 v[16:19], v2 offset:23552
v_add_f32_dpp v64, v66, v64 quad_perm:[2,3,0,1] row_mask:0xf bank_mask:0xf
v_add_f32_dpp v65, v67, v65 quad_perm:[2,3,0,1] row_mask:0xf bank_mask:0xf
v_max_f32 v25, v25, v71
v_max_f32 v24, v64, v65
v_mul_f32 v24, s50, v24
v_max_f32_dpp v25, v25, v25 quad_perm:[2,3,0,1] row_mask:0xf bank_mask:0xf
v_smfmac_f32_16x16x64_bf16 v[36:39], v[72:75], a[144:151], v0
s_nop 0
v_max_f32_dpp v26, v24, v25 quad_perm:[0,1,0,1] row_mask:0xf bank_mask:0xf
v_max_f32_dpp v27, v24, v25 quad_perm:[0,1,0,1] row_mask:0xf bank_mask:0xf
v_smfmac_f32_16x16x64_bf16 v[36:39], v[76:79], a[160:167], v0
s_nop 0
v_permlane16_swap_b32 v26, v27
v_max_f32 v28, v26, v27
v_max_f32 v29, v26, v27
s_waitcnt lgkmcnt(2)
v_smfmac_f32_16x16x64_bf16 v[36:39], v[60:63], v[44:51], v0
v_permlane32_swap_b32 v28, v29
v_max_f32 v28, v28, v29
v_sub_f32 v68, v68, v28
v_sub_f32 v69, v69, v28
v_sub_f32 v70, v70, v28
v_sub_f32 v71, v71, v28
v_exp_f32 v68, v68
v_exp_f32 v69, v69
v_exp_f32 v70, v70
v_exp_f32 v71, v71
v_cvt_pk_bf16_f32 v20, v68, v69
v_cvt_pk_bf16_f32 v21, v70, v71
v_pk_add_f32 v[36:37], v[36:37], v[38:39]
v_mov_b32_dpp v22, v20 quad_perm:[2,3,0,1] row_mask:0xf bank_mask:0xf
v_mov_b32_dpp v23, v21 quad_perm:[2,3,0,1] row_mask:0xf bank_mask:0xf
v_pk_fma_f32 v[64:65], v[64:65], s[50:51], v[28:29] op_sel_hi:[1,1,0] neg_lo:[0,0,1] neg_hi:[0,0,1]
v_cvt_pk_bf16_f32 v32, v36, v37
v_pk_add_f32 v[40:41], v[40:41], v[42:43]
v_mfma_f32_16x16x32_bf16 v[36:39], v[52:55], v[20:23], 0
v_mov_b64 v[72:73], s[52:53]
v_mov_b64 v[74:75], s[52:53]
v_cvt_pk_bf16_f32 v33, v40, v41
v_exp_f32 v64, v64
v_mfma_f32_16x16x32_bf16 v[68:71], v[72:75], v[20:23], 0
v_exp_f32 v65, v65
v_mov_b32 v25, 0
v_cvt_pk_bf16_f32 v24, v64, v65
v_mfma_f32_16x16x32_bf16 v[40:43], v[56:59], v[20:23], 0
v_cvt_pk_bf16_f32 v27, v64, v65
v_mov_b32 v26, 0
v_mfma_f32_16x16x16_bf16 v[68:71], v[72:73], v[24:25], v[68:71]
ds_read_b128 v[44:47], v2 offset:20480
v_mfma_f32_16x16x16_bf16 v[36:39], v[32:33], v[24:25], v[36:39]
ds_read_b128 v[48:51], v2 offset:21504
v_mfma_f32_16x16x16_bf16 v[40:43], v[32:33], v[26:27], v[40:43]
v_rcp_f32 v68, v68
v_mov_b64 v[76:77], 0
v_mov_b64 v[78:79], 0
s_nop 0
v_mul_f32 v36, v36, v68
v_mul_f32 v37, v37, v68
v_mul_f32 v38, v38, v68
v_mul_f32 v39, v39, v68
v_pk_mul_f32 v[40:41], v[40:41], v[68:69] op_sel_hi:[1,0]
v_pk_mul_f32 v[42:43], v[42:43], v[68:69] op_sel_hi:[1,0]
v_cvt_pk_bf16_f32 v36, v36, v37
v_cvt_pk_bf16_f32 v37, v38, v39
v_cvt_pk_bf16_f32 v38, v40, v41
v_cvt_pk_bf16_f32 v39, v42, v43
ds_write_b128 v1, v[36:39] offset:7168
ds_read_b128 v[60:63], v7 offset:7168
buffer_store_dwordx4 v[30:33], v1, s[4:7], s40 offen sc0 sc1
ds_read_b128 v[52:55], v2 offset:24576
ds_read_b128 v[56:59], v2 offset:25600
s_cmp_eq_u32 s34, s100
v_mov_b64 v[20:21], 0
v_mov_b64 v[22:23], 0
s_cbranch_scc1 L_ev_w2rs
L_evb_w2rs:
s_waitcnt lgkmcnt(3)
s_barrier
ds_read_b128 v[64:67], v7 offset:8192
ds_read_b128 v[68:71], v7 offset:5120
ds_read_b128 v[72:75], v7 offset:6144
s_waitcnt lgkmcnt(5)
v_smfmac_f32_16x16x64_bf16 v[76:79], v[60:63], v[44:51], v0 abid:1
ds_read_b128 v[44:47], v2 offset:26624
v_mov_b64 v[24:25], 0
v_smfmac_f32_16x16x64_bf16 v[20:23], v[60:63], v[12:19], v0 abid:1
ds_read_b128 v[48:51], v2 offset:27648
v_mov_b64 v[26:27], 0
s_waitcnt lgkmcnt(4)
v_smfmac_f32_16x16x64_bf16 v[76:79], v[64:67], a[176:183], v0 abid:1
ds_read_b128 v[12:15], v2 offset:28672
v_mov_b64 v[40:41], 0
s_waitcnt lgkmcnt(4)
v_smfmac_f32_16x16x64_bf16 v[76:79], v[68:71], v[52:59], v0 abid:1
ds_read_b128 v[16:19], v2 offset:29696
v_mov_b64 v[42:43], 0
s_waitcnt lgkmcnt(4)
v_smfmac_f32_16x16x64_bf16 v[76:79], v[72:75], a[184:191], v0 abid:1
ds_read_b128 v[52:55], v2 offset:30720
v_smfmac_f32_16x16x64_bf16 v[20:23], v[64:67], a[192:199], v0 abid:1
ds_read_b128 v[56:59], v2 offset:31744
v_smfmac_f32_16x16x64_bf16 v[20:23], v[68:71], a[200:207], v0 abid:1
v_cvt_pk_bf16_f32 v76, v76, v77
v_cvt_pk_bf16_f32 v77, v78, v79
v_bfi_b32 v76, 1, s35, v76
buffer_store_dwordx2 v[76:77], v8, s[4:7], s42 offen sc0 sc1
v_smfmac_f32_16x16x64_bf16 v[20:23], v[72:75], a[208:215], v0 abid:1
s_waitcnt lgkmcnt(4)
v_smfmac_f32_16x16x64_bf16 v[24:27], v[60:63], v[44:51], v0 abid:1
v_smfmac_f32_16x16x64_bf16 v[24:27], v[64:67], a[216:223], v0 abid:1
v_cvt_pk_bf16_f32 v20, v20, v21
v_cvt_pk_bf16_f32 v21, v22, v23
v_bfi_b32 v20, 1, s35, v20
buffer_store_dwordx2 v[20:21], v8, s[4:7], s43 offen sc0 sc1
v_smfmac_f32_16x16x64_bf16 v[24:27], v[68:71], a[224:231], v0 abid:1
s_waitcnt lgkmcnt(2)
v_smfmac_f32_16x16x64_bf16 v[24:27], v[72:75], v[12:19], v0 abid:1
v_smfmac_f32_16x16x64_bf16 v[40:43], v[60:63], a[232:239], v0 abid:1
v_smfmac_f32_16x16x64_bf16 v[40:43], v[64:67], a[240:247], v0 abid:1
v_cvt_pk_bf16_f32 v24, v24, v25
s_waitcnt lgkmcnt(0)
v_smfmac_f32_16x16x64_bf16 v[40:43], v[68:71], v[52:59], v0 abid:1
v_cvt_pk_bf16_f32 v25, v26, v27
v_smfmac_f32_16x16x64_bf16 v[40:43], v[72:75], a[248:255], v0 abid:1
v_bfi_b32 v24, 1, s35, v24
buffer_store_dwordx2 v[24:25], v8, s[4:7], s44 offen sc0 sc1
s_nop 5
v_cvt_pk_bf16_f32 v40, v40, v41
v_cvt_pk_bf16_f32 v41, v42, v43
v_bfi_b32 v40, 1, s35, v40
buffer_store_dwordx2 v[40:41], v8, s[4:7], s45 offen sc0 sc1
s_add_u32 s34, s34, 1
s_add_u32 s37, s37, 524288
s_add_u32 s39, s39, 524288
v_and_b32 v6, 0x70, v1
ds_read_b128 v[76:79], v6 offset:256
v_mov_b64 v[20:21], 0
v_mov_b64 v[22:23], 0
v_mov_b64 v[24:25], 0
v_mov_b64 v[26:27], 0
v_mov_b64 v[28:29], 0
v_mov_b64 v[34:35], 0
v_mov_b64 v[36:37], 0
v_mov_b64 v[38:39], 0
v_mov_b64 v[40:41], 0
v_mov_b64 v[42:43], 0
s_waitcnt vmcnt(2)
buffer_load_dwordx4 v[44:47], v9, s[4:7], s3 offen offset:0 sc0 sc1
buffer_load_dwordx4 v[48:51], v9, s[4:7], s3 offen offset:1024 sc0 sc1
buffer_load_dwordx4 v[52:55], v9, s[4:7], s3 offen offset:2048 sc0 sc1
buffer_load_dwordx4 v[56:59], v9, s[4:7], s3 offen offset:3072 sc0 sc1
s_waitcnt lgkmcnt(0)
s_waitcnt vmcnt(3)
L_r_w2rs:
v_mfma_f32_16x16x32_bf16 v[72:75], v[44:47], v[76:79], 0
s_waitcnt vmcnt(2)
v_mfma_f32_16x16x32_bf16 v[72:75], v[48:51], v[76:79], v[72:75]
v_bitop3_b32 v68, v44, v48, s35 bitop3:0x7e
s_waitcnt vmcnt(1)
v_mfma_f32_16x16x32_bf16 v[72:75], v[52:55], v[76:79], v[72:75]
s_waitcnt vmcnt(0)
v_mfma_f32_16x16x32_bf16 v[72:75], v[56:59], v[76:79], v[72:75]
v_bitop3_b32 v69, v52, v56, s35 bitop3:0x7e
v_bitop3_b32 v68, v68, v69, 1 bitop3:0xa8
v_cmp_ne_u32 vcc, 0, v68
s_cbranch_vccnz L_rr_w2rs
ds_read_b128 v[44:47], v2 offset:0
ds_read_b128 v[48:51], v2 offset:1024
s_nop 1
v_pk_add_f32 v[72:73], v[72:73], v[74:75]
v_cvt_pk_bf16_f32 v68, v72, v73
v_bfi_b32 v68, v11, s36, v68
buffer_store_dword v68, v10, s[4:7], 0 offen sc0 sc1
buffer_load_dwordx4 v[12:15], v9, s[4:7], s37 offen offset:0
buffer_load_dwordx4 v[16:19], v9, s[4:7], s37 offen offset:1024
buffer_load_dwordx4 v[52:55], v1, s[4:7], s37 offen offset:2048
buffer_load_dwordx4 v[56:59], v1, s[4:7], s37 offen offset:3072
s_not_b32 s35, s35
s_not_b32 s36, s36
v_lshrrev_b32 v6, 2, v1
s_waitcnt vmcnt(4)
s_barrier
buffer_load_dwordx4 v[60:63], v1, s[4:7], s47 offen sc0 sc1
buffer_load_dwordx4 v[68:71], v1, s[4:7], s38 offen sc0 sc1
s_add_u32 s40, s40, 131072
v_mov_b64 v[30:31], 0
v_mov_b64 v[32:33], 0
s_branch L_top_w2rs
L_done_w2rs:
s_waitcnt vmcnt(0)
s_barrier
s_waitcnt vmcnt(0) lgkmcnt(0)
s_endpgm
L_ra0_w2rs:
buffer_load_dwordx4 v[60:63], v1, s[4:7], s47 offen sc0 sc1
buffer_load_dwordx4 v[68:71], v1, s[4:7], s38 offen sc0 sc1
s_sub_u32 s41, s41, 1
s_cbranch_scc1 L_exit
ds_read_b128 v[44:47], v2 offset:0
ds_read_b128 v[48:51], v2 offset:1024
s_waitcnt vmcnt(0) lgkmcnt(0)
v_mov_b64 v[20:21], 0
v_mov_b64 v[22:23], 0
v_mov_b64 v[24:25], 0
v_mov_b64 v[26:27], 0
v_mov_b64 v[28:29], 0
v_mov_b64 v[30:31], 0
v_mov_b64 v[32:33], 0
v_mov_b64 v[34:35], 0
v_mov_b64 v[36:37], 0
v_mov_b64 v[38:39], 0
v_mov_b64 v[40:41], 0
v_mov_b64 v[42:43], 0
s_nop 0
s_branch L_a0_w2rs
L_ra1_w2rs:
buffer_load_dwordx4 v[64:67], v1, s[4:7], s48 offen sc0 sc1
buffer_load_dword v76, v6, s[4:7], s49 offen sc0 sc1
s_sub_u32 s41, s41, 1
s_cbranch_scc1 L_exit
s_waitcnt vmcnt(0)
v_bitop3_b32 v77, v64, s35, 1 bitop3:0x28
v_bitop3_b32 v78, v76, s35, v11 bitop3:0x28
v_or_b32 v77, v77, v78
v_cmp_ne_u32 vcc, 0, v77
s_cbranch_vccnz L_ra1_w2rs
ds_write_b128 v1, v[64:67] offset:7168
ds_write_addtid_b32 v76 offset:9728
s_waitcnt lgkmcnt(0)
s_branch L_a1_w2rs
L_ev_w2rs:
s_cmp_eq_u32 s34, 63
s_cbranch_scc1 L_done_w2rs
s_mov_b32 s100, 63

s_lshl_b32 s55, s32, 2
v_mov_b32 v34, 0
L_kvw_w2rs:
buffer_load_dword v29, v34, s[28:31], s55 offen offset:128 sc0 sc1
s_sub_u32 s41, s41, 1
s_cbranch_scc1 L_exit
s_waitcnt vmcnt(0)
v_readfirstlane_b32 s54, v29
s_nop 0
s_and_b32 s54, s54, 65280
s_cmp_lg_u32 s54, 1024
s_cbranch_scc1 L_kvw_w2rs
s_branch L_evb_w2rs
L_rr_w2rs:
buffer_load_dwordx4 v[44:47], v9, s[4:7], s3 offen offset:0 sc0 sc1
buffer_load_dwordx4 v[48:51], v9, s[4:7], s3 offen offset:1024 sc0 sc1
buffer_load_dwordx4 v[52:55], v9, s[4:7], s3 offen offset:2048 sc0 sc1
buffer_load_dwordx4 v[56:59], v9, s[4:7], s3 offen offset:3072 sc0 sc1
s_sub_u32 s41, s41, 1
s_cbranch_scc1 L_exit
s_waitcnt vmcnt(0)
s_branch L_r_w2rs
L_pro_w3r:
v_and_b32 v20, 63, v0
v_and_b32 v21, 15, v0
v_bfe_u32 v22, v0, 4, 2
v_lshlrev_b32 v1, 4, v20
v_add_u32 v2, 131072, v1
v_bfe_u32 v23, v20, 4, 1
v_lshlrev_b32 v26, 4, v23
v_bfe_u32 v23, v20, 2, 2
v_lshl_add_u32 v26, v23, 1, v26
v_bfe_u32 v23, v20, 5, 1
v_add_u32 v26, v26, v23
v_lshlrev_b32 v26, 13, v26
v_and_b32 v23, 3, v20
v_lshl_add_u32 v26, v23, 4, v26
v_lshrrev_b32 v24, 2, v20
v_mul_u32_u24 v27, 1152, v24
v_lshl_add_u32 v27, v23, 4, v27
v_lshrrev_b32 v24, 2, v21
v_lshl_add_u32 v25, v22, 3, v24
v_lshlrev_b32 v28, 6, v25
v_lshl_add_u32 v28, v23, 3, v28
v_add_u32 v28, 131072, v28
v_and_b32 v25, 1, v22
v_lshlrev_b32 v29, 10, v25
v_lshrrev_b32 v25, 1, v22
v_lshl_add_u32 v29, v25, 8, v29
v_and_b32 v25, 1, v24
v_lshl_add_u32 v29, v25, 6, v29
v_lshrrev_b32 v25, 1, v24
v_lshl_add_u32 v29, v25, 5, v29
v_lshl_add_u32 v29, v23, 3, v29
v_add_u32 v29, 131072, v29
s_lshl_b32 s54, s32, 8
s_add_u32 s54, s54, 192
s_mul_i32 s55, s32, 147456
s_waitcnt lgkmcnt(0)
s_add_u32 s56, s54, 0
s_mov_b32 m0, 151552
s_nop 0
buffer_load_dwordx4 v26, s[8:11], s56 offen lds
s_add_u32 s56, s54, 65536
s_mov_b32 m0, 152576
s_nop 0
buffer_load_dwordx4 v26, s[8:11], s56 offen lds
s_add_u32 s56, s54, 262144
s_mov_b32 m0, 153600
s_nop 0
buffer_load_dwordx4 v26, s[8:11], s56 offen lds
s_add_u32 s56, s54, 327680
s_mov_b32 m0, 154624
s_nop 0
buffer_load_dwordx4 v26, s[8:11], s56 offen lds
s_add_u32 s56, s54, 1048576
s_mov_b32 m0, 155648
s_nop 0
buffer_load_dwordx4 v26, s[8:11], s56 offen lds
s_add_u32 s56, s54, 1114112
s_mov_b32 m0, 156672
s_nop 0
buffer_load_dwordx4 v26, s[8:11], s56 offen lds
s_add_u32 s56, s54, 1310720
s_mov_b32 m0, 157696
s_nop 0
buffer_load_dwordx4 v26, s[8:11], s56 offen lds
s_add_u32 s56, s54, 1376256
s_mov_b32 m0, 158720
s_nop 0
buffer_load_dwordx4 v26, s[8:11], s56 offen lds
s_add_u32 s56, s54, 2097152
s_mov_b32 m0, 159744
s_nop 0
buffer_load_dwordx4 v26, s[8:11], s56 offen lds
s_add_u32 s56, s54, 2162688
s_mov_b32 m0, 160768
s_nop 0
buffer_load_dwordx4 v26, s[8:11], s56 offen lds
s_add_u32 s56, s54, 2359296
s_mov_b32 m0, 161792
s_nop 0
buffer_load_dwordx4 v26, s[8:11], s56 offen lds
s_add_u32 s56, s54, 2424832
s_mov_b32 m0, 162816
s_nop 0
buffer_load_dwordx4 v26, s[8:11], s56 offen lds
s_add_u32 s56, s54, 2621440
s_mov_b32 m0, 131072
s_nop 0
buffer_load_dwordx4 v26, s[8:11], s56 offen lds
s_add_u32 s56, s54, 2686976
s_mov_b32 m0, 132096
s_nop 0
buffer_load_dwordx4 v26, s[8:11], s56 offen lds
s_add_u32 s56, s54, 2883584
s_mov_b32 m0, 133120
s_nop 0
buffer_load_dwordx4 v26, s[8:11], s56 offen lds
s_add_u32 s56, s54, 2949120
s_mov_b32 m0, 134144
s_nop 0
buffer_load_dwordx4 v26, s[8:11], s56 offen lds
s_add_u32 s56, s54, 3145728
s_mov_b32 m0, 135168
s_nop 0
buffer_load_dwordx4 v26, s[8:11], s56 offen lds
s_add_u32 s56, s54, 3211264
s_mov_b32 m0, 136192
s_nop 0
buffer_load_dwordx4 v26, s[8:11], s56 offen lds
s_add_u32 s56, s54, 3407872
s_mov_b32 m0, 137216
s_nop 0
buffer_load_dwordx4 v26, s[8:11], s56 offen lds
s_add_u32 s56, s54, 3473408
s_mov_b32 m0, 138240
s_nop 0
buffer_load_dwordx4 v26, s[8:11], s56 offen lds
s_add_u32 s56, s54, 4194304
s_mov_b32 m0, 139264
s_nop 0
buffer_load_dwordx4 v26, s[8:11], s56 offen lds
s_add_u32 s56, s54, 4259840
s_mov_b32 m0, 140288
s_nop 0
buffer_load_dwordx4 v26, s[8:11], s56 offen lds
s_add_u32 s56, s54, 4456448
s_mov_b32 m0, 141312
s_nop 0
buffer_load_dwordx4 v26, s[8:11], s56 offen lds
s_add_u32 s56, s54, 4521984
s_mov_b32 m0, 142336
s_nop 0
buffer_load_dwordx4 v26, s[8:11], s56 offen lds
s_add_u32 s56, s54, 1572864
s_mov_b32 m0, 143360
s_nop 0
buffer_load_dwordx4 v26, s[12:15], s56 offen lds
s_add_u32 s56, s54, 1638400
s_mov_b32 m0, 144384
s_nop 0
buffer_load_dwordx4 v26, s[12:15], s56 offen lds
s_add_u32 s56, s54, 1835008
s_mov_b32 m0, 145408
s_nop 0
buffer_load_dwordx4 v26, s[12:15], s56 offen lds
s_add_u32 s56, s54, 1900544
s_mov_b32 m0, 146432
s_nop 0
buffer_load_dwordx4 v26, s[12:15], s56 offen lds
v_bfe_u32 v23, v21, 1, 1
v_and_b32 v24, 1, v21
v_lshl_add_u32 v23, v24, 16, v23
v_mul_u32_u24 v23, 0xaaaa, v23
v_add_u32 v0, 0x44444444, v23
v_lshlrev_b32 v3, 3, v20
v_lshrrev_b32 v25, 5, v20
v_lshlrev_b32 v25, 6, v25
v_xor_b32 v3, v3, v25
v_lshrrev_b32 v25, 2, v20
v_and_b32 v4, 3, v21
v_lshl_add_u32 v4, v4, 4, v25
v_lshlrev_b32 v4, 3, v4
v_bfe_u32 v25, v21, 1, 1
v_lshlrev_b32 v23, 6, v25
v_xor_b32 v4, v4, v23
v_and_b32 v23, 2, v22
v_xor_b32 v5, v21, v23
v_lshlrev_b32 v5, 4, v5
v_lshl_add_u32 v5, v25, 10, v5
v_and_b32 v23, 1, v22
v_lshl_add_u32 v5, v23, 3, v5
v_lshlrev_b32 v9, 8, v22
v_lshl_add_u32 v9, v25, 6, v9
v_bfe_u32 v23, v21, 3, 1
v_lshl_add_u32 v9, v23, 7, v9
v_bfe_u32 v23, v21, 2, 1
v_lshl_add_u32 v9, v23, 5, v9
v_and_b32 v23, 1, v21
v_lshl_add_u32 v9, v23, 4, v9
v_lshrrev_b32 v23, 1, v22
v_and_b32 v24, 1, v22
v_and_b32 v25, 7, v21
v_lshrrev_b32 v7, 3, v21
v_lshl_add_u32 v8, v7, 1, v23
v_lshlrev_b32 v8, 12, v8
v_lshl_add_u32 v8, v24, 7, v8
v_lshl_add_u32 v8, v25, 3, v8
s_lshr_b32 s56, s32, 1
s_lshl_b32 s56, s56, 8
s_and_b32 s57, s32, 1
s_lshl_b32 s57, s57, 6
s_add_u32 s56, s56, s57
s_add_u32 s56, s56, 49152
v_add_u32 v8, s56, v8
v_and_b32 v7, 12, v21
v_bfe_u32 v25, v21, 1, 1
v_add_u32 v7, v7, v25
v_lshlrev_b32 v7, 4, v7
v_lshl_add_u32 v7, v22, 8, v7
s_mov_b32 s42, 0
s_mov_b32 s43, 65536
s_mov_b32 s44, 131072
s_mov_b32 s45, 196608
s_mov_b32 s46, 262144
s_mov_b32 s47, 297984
s_mov_b32 s48, 302080
s_mov_b32 s49, 303872
s_mov_b32 s38, 294912
s_mov_b32 s50, 0x3e0293ee
s_mov_b32 s51, 0x3e0293ee
s_mov_b32 s52, 0x3f803f80
s_mov_b32 s53, 0x3f803f80
v_and_b32 v11, 3, v21
v_cmp_eq_u32 vcc, 0, v11
s_nop 1
v_cndmask_b32 v11, 0, 1, vcc
s_mov_b32 s34, 0
s_mov_b32 s35, -1
s_mov_b32 s36, 0
s_mov_b32 s41, 400000
s_lshl_b32 s37, s32, 14
s_add_u32 s39, s37, 17313792
s_add_u32 s37, s37, 16789504
s_lshl_b32 s40, s32, 12
s_add_u32 s40, s40, 8391680
v_mov_b64 v[36:37], 0
v_mov_b64 v[38:39], 0
s_add_u32 s56, s32, 32
s_lshl_b32 s3, s56, 12
v_bfe_u32 v23, v21, 1, 1
v_bfe_u32 v24, v21, 2, 1
v_and_b32 v25, 1, v21
s_lshl_b32 s57, s56, 7
s_add_u32 s57, s57, 294912
v_and_b32 v10, 7, v21
v_lshlrev_b32 v10, 2, v10
v_lshl_add_u32 v10, v22, 5, v10
v_add_u32 v10, s57, v10
v_lshl_add_u32 v23, v23, 1, v24
v_lshlrev_b32 v25, 4, v25
v_mov_b32 v24, 0x3f80
v_lshlrev_b32 v24, v25, v24
v_cmp_eq_u32 vcc, 0, v23
s_nop 1
v_cndmask_b32 v76, 0, v24, vcc
v_cmp_eq_u32 vcc, 1, v23
s_nop 1
v_cndmask_b32 v77, 0, v24, vcc
v_cmp_eq_u32 vcc, 2, v23
s_nop 1
v_cndmask_b32 v78, 0, v24, vcc
v_cmp_eq_u32 vcc, 3, v23
s_nop 1
v_cndmask_b32 v79, 0, v24, vcc
buffer_store_dwordx4 v[36:39], v9, s[4:7], s3 offen offset:0 sc0 sc1
buffer_store_dwordx4 v[36:39], v9, s[4:7], s3 offen offset:1024 sc0 sc1
buffer_store_dwordx4 v[36:39], v9, s[4:7], s3 offen offset:2048 sc0 sc1
buffer_store_dwordx4 v[36:39], v9, s[4:7], s3 offen offset:3072 sc0 sc1
s_waitcnt vmcnt(0) lgkmcnt(0)
s_barrier
s_getreg_b32 s56, hwreg(HW_REG_XCC_ID)
s_and_b32 s56, s56, 15
s_mul_i32 s57, s56, s56
s_lshl_b32 s57, s57, 18
s_lshl_b32 s56, s56, 8
s_add_u32 s57, s57, s56
s_add_u32 s58, s57, 1
ds_read_b64_tr_b16 v[80:81], v28 offset:20480
ds_read_b64_tr_b16 v[82:83], v28 offset:20736
ds_read_b64_tr_b16 v[84:85], v28 offset:22528
ds_read_b64_tr_b16 v[86:87], v28 offset:22784
ds_read_b64_tr_b16 v[88:89], v28 offset:20512
ds_read_b64_tr_b16 v[90:91], v28 offset:20768
ds_read_b64_tr_b16 v[92:93], v28 offset:22560
ds_read_b64_tr_b16 v[94:95], v28 offset:22816
s_waitcnt lgkmcnt(0)
s_add_u32 s56, s54, 0
s_mov_b32 m0, 147456
s_nop 0
buffer_load_dwordx4 v26, s[12:15], s56 offen lds
s_add_u32 s56, s54, 65536
s_mov_b32 m0, 148480
s_nop 0
buffer_load_dwordx4 v26, s[12:15], s56 offen lds
s_add_u32 s56, s54, 262144
s_mov_b32 m0, 149504
s_nop 0
buffer_load_dwordx4 v26, s[12:15], s56 offen lds
s_add_u32 s56, s54, 327680
s_mov_b32 m0, 150528
s_nop 0
buffer_load_dwordx4 v26, s[12:15], s56 offen lds
ds_read_b64_tr_b16 v[96:97], v28 offset:24576
ds_read_b64_tr_b16 v[98:99], v28 offset:24832
ds_read_b64_tr_b16 v[100:101], v28 offset:26624
ds_read_b64_tr_b16 v[102:103], v28 offset:26880
ds_read_b64_tr_b16 v[104:105], v28 offset:24608
ds_read_b64_tr_b16 v[106:107], v28 offset:24864
ds_read_b64_tr_b16 v[108:109], v28 offset:26656
ds_read_b64_tr_b16 v[110:111], v28 offset:26912
s_waitcnt lgkmcnt(0)
s_add_u32 s56, s54, 524288
s_mov_b32 m0, 151552
s_nop 0
buffer_load_dwordx4 v26, s[12:15], s56 offen lds
s_add_u32 s56, s54, 589824
s_mov_b32 m0, 152576
s_nop 0
buffer_load_dwordx4 v26, s[12:15], s56 offen lds
s_add_u32 s56, s54, 786432
s_mov_b32 m0, 153600
s_nop 0
buffer_load_dwordx4 v26, s[12:15], s56 offen lds
s_add_u32 s56, s54, 851968
s_mov_b32 m0, 154624
s_nop 0
buffer_load_dwordx4 v26, s[12:15], s56 offen lds
ds_read_b64_tr_b16 v[112:113], v28 offset:28672
ds_read_b64_tr_b16 v[114:115], v28 offset:28928
ds_read_b64_tr_b16 v[116:117], v28 offset:30720
ds_read_b64_tr_b16 v[118:119], v28 offset:30976
ds_read_b64_tr_b16 v[120:121], v28 offset:28704
ds_read_b64_tr_b16 v[122:123], v28 offset:28960
ds_read_b64_tr_b16 v[124:125], v28 offset:30752
ds_read_b64_tr_b16 v[126:127], v28 offset:31008
s_waitcnt lgkmcnt(0)
s_add_u32 s56, s54, 1048576
s_mov_b32 m0, 155648
s_nop 0
buffer_load_dwordx4 v26, s[12:15], s56 offen lds
s_add_u32 s56, s54, 1114112
s_mov_b32 m0, 156672
s_nop 0
buffer_load_dwordx4 v26, s[12:15], s56 offen lds
s_add_u32 s56, s54, 1310720
s_mov_b32 m0, 157696
s_nop 0
buffer_load_dwordx4 v26, s[12:15], s56 offen lds
s_add_u32 s56, s54, 1376256
s_mov_b32 m0, 158720
s_nop 0
buffer_load_dwordx4 v26, s[12:15], s56 offen lds
ds_read_b64_tr_b16 v[128:129], v28 offset:0
ds_read_b64_tr_b16 v[130:131], v28 offset:256
ds_read_b64_tr_b16 v[132:133], v28 offset:2048
ds_read_b64_tr_b16 v[134:135], v28 offset:2304
ds_read_b64_tr_b16 v[136:137], v28 offset:32
ds_read_b64_tr_b16 v[138:139], v28 offset:288
ds_read_b64_tr_b16 v[140:141], v28 offset:2080
ds_read_b64_tr_b16 v[142:143], v28 offset:2336
s_waitcnt lgkmcnt(0)
s_add_u32 s56, s54, 3670016
s_mov_b32 m0, 159744
s_nop 0
buffer_load_dwordx4 v26, s[12:15], s56 offen lds
s_add_u32 s56, s54, 3735552
s_mov_b32 m0, 160768
s_nop 0
buffer_load_dwordx4 v26, s[12:15], s56 offen lds
s_add_u32 s56, s54, 3932160
s_mov_b32 m0, 161792
s_nop 0
buffer_load_dwordx4 v26, s[12:15], s56 offen lds
s_add_u32 s56, s54, 3997696
s_mov_b32 m0, 162816
s_nop 0
buffer_load_dwordx4 v26, s[12:15], s56 offen lds
ds_read_b64_tr_b16 v[144:145], v28 offset:4096
ds_read_b64_tr_b16 v[146:147], v28 offset:4352
ds_read_b64_tr_b16 v[148:149], v28 offset:6144
ds_read_b64_tr_b16 v[150:151], v28 offset:6400
ds_read_b64_tr_b16 v[152:153], v28 offset:4128
ds_read_b64_tr_b16 v[154:155], v28 offset:4384
ds_read_b64_tr_b16 v[156:157], v28 offset:6176
ds_read_b64_tr_b16 v[158:159], v28 offset:6432
s_waitcnt lgkmcnt(0)
s_add_u32 s56, s54, 2621440
s_mov_b32 m0, 131072
s_nop 0
buffer_load_dwordx4 v26, s[12:15], s56 offen lds
s_add_u32 s56, s54, 2686976
s_mov_b32 m0, 132096
s_nop 0
buffer_load_dwordx4 v26, s[12:15], s56 offen lds
s_add_u32 s56, s54, 2883584
s_mov_b32 m0, 133120
s_nop 0
buffer_load_dwordx4 v26, s[12:15], s56 offen lds
s_add_u32 s56, s54, 2949120
s_mov_b32 m0, 134144
s_nop 0
buffer_load_dwordx4 v26, s[12:15], s56 offen lds
ds_read_b64_tr_b16 v[160:161], v28 offset:8192
ds_read_b64_tr_b16 v[162:163], v28 offset:8448
ds_read_b64_tr_b16 v[164:165], v28 offset:10240
ds_read_b64_tr_b16 v[166:167], v28 offset:10496
ds_read_b64_tr_b16 v[168:169], v28 offset:8224
ds_read_b64_tr_b16 v[170:171], v28 offset:8480
ds_read_b64_tr_b16 v[172:173], v28 offset:10272
ds_read_b64_tr_b16 v[174:175], v28 offset:10528
s_waitcnt lgkmcnt(0)
s_add_u32 s56, s54, 3145728
s_mov_b32 m0, 135168
s_nop 0
buffer_load_dwordx4 v26, s[12:15], s56 offen lds
s_add_u32 s56, s54, 3211264
s_mov_b32 m0, 136192
s_nop 0
buffer_load_dwordx4 v26, s[12:15], s56 offen lds
s_add_u32 s56, s54, 3407872
s_mov_b32 m0, 137216
s_nop 0
buffer_load_dwordx4 v26, s[12:15], s56 offen lds
s_add_u32 s56, s54, 3473408
s_mov_b32 m0, 138240
s_nop 0
buffer_load_dwordx4 v26, s[12:15], s56 offen lds
ds_read_b64_tr_b16 v[176:177], v28 offset:12288
ds_read_b64_tr_b16 v[178:179], v28 offset:12544
ds_read_b64_tr_b16 v[180:181], v28 offset:14336
ds_read_b64_tr_b16 v[182:183], v28 offset:14592
ds_read_b64_tr_b16 v[184:185], v28 offset:12320
ds_read_b64_tr_b16 v[186:187], v28 offset:12576
ds_read_b64_tr_b16 v[188:189], v28 offset:14368
ds_read_b64_tr_b16 v[190:191], v28 offset:14624
s_waitcnt lgkmcnt(0)
s_add_u32 s56, s54, 4194304
s_mov_b32 m0, 139264
s_nop 0
buffer_load_dwordx4 v26, s[12:15], s56 offen lds
s_add_u32 s56, s54, 4259840
s_mov_b32 m0, 140288
s_nop 0
buffer_load_dwordx4 v26, s[12:15], s56 offen lds
s_add_u32 s56, s54, 4456448
s_mov_b32 m0, 141312
s_nop 0
buffer_load_dwordx4 v26, s[12:15], s56 offen lds
s_add_u32 s56, s54, 4521984
s_mov_b32 m0, 142336
s_nop 0
buffer_load_dwordx4 v26, s[12:15], s56 offen lds
s_waitcnt vmcnt(24)
ds_read_b64_tr_b16 v[192:193], v28 offset:16384
ds_read_b64_tr_b16 v[194:195], v28 offset:16640
ds_read_b64_tr_b16 v[196:197], v28 offset:18432
ds_read_b64_tr_b16 v[198:199], v28 offset:18688
ds_read_b64_tr_b16 v[200:201], v28 offset:16416
ds_read_b64_tr_b16 v[202:203], v28 offset:16672
ds_read_b64_tr_b16 v[204:205], v28 offset:18464
ds_read_b64_tr_b16 v[206:207], v28 offset:18720
s_waitcnt lgkmcnt(0)
s_add_u32 s56, s54, 1572864
s_mov_b32 m0, 143360
s_nop 0
buffer_load_dwordx4 v26, s[16:19], s56 offen lds
s_add_u32 s56, s54, 1638400
s_mov_b32 m0, 144384
s_nop 0
buffer_load_dwordx4 v26, s[16:19], s56 offen lds
s_add_u32 s56, s54, 1835008
s_mov_b32 m0, 145408
s_nop 0
buffer_load_dwordx4 v26, s[16:19], s56 offen lds
s_add_u32 s56, s54, 1900544
s_mov_b32 m0, 146432
s_nop 0
buffer_load_dwordx4 v26, s[16:19], s56 offen lds
s_waitcnt vmcnt(24)
ds_read_b64_tr_b16 v[208:209], v28 offset:20480
ds_read_b64_tr_b16 v[210:211], v28 offset:20736
ds_read_b64_tr_b16 v[212:213], v28 offset:22528
ds_read_b64_tr_b16 v[214:215], v28 offset:22784
ds_read_b64_tr_b16 v[216:217], v28 offset:20512
ds_read_b64_tr_b16 v[218:219], v28 offset:20768
ds_read_b64_tr_b16 v[220:221], v28 offset:22560
ds_read_b64_tr_b16 v[222:223], v28 offset:22816
s_waitcnt lgkmcnt(0)
s_add_u32 s56, s54, 0
s_mov_b32 m0, 147456
s_nop 0
buffer_load_dwordx4 v26, s[16:19], s56 offen lds
s_add_u32 s56, s54, 65536
s_mov_b32 m0, 148480
s_nop 0
buffer_load_dwordx4 v26, s[16:19], s56 offen lds
s_add_u32 s56, s54, 262144
s_mov_b32 m0, 149504
s_nop 0
buffer_load_dwordx4 v26, s[16:19], s56 offen lds
s_add_u32 s56, s54, 327680
s_mov_b32 m0, 150528
s_nop 0
buffer_load_dwordx4 v26, s[16:19], s56 offen lds
s_waitcnt vmcnt(24)
ds_read_b64_tr_b16 v[224:225], v28 offset:24576
ds_read_b64_tr_b16 v[226:227], v28 offset:24832
ds_read_b64_tr_b16 v[228:229], v28 offset:26624
ds_read_b64_tr_b16 v[230:231], v28 offset:26880
ds_read_b64_tr_b16 v[232:233], v28 offset:24608
ds_read_b64_tr_b16 v[234:235], v28 offset:24864
ds_read_b64_tr_b16 v[236:237], v28 offset:26656
ds_read_b64_tr_b16 v[238:239], v28 offset:26912
s_waitcnt lgkmcnt(0)
s_add_u32 s56, s54, 524288
s_mov_b32 m0, 151552
s_nop 0
buffer_load_dwordx4 v26, s[16:19], s56 offen lds
s_add_u32 s56, s54, 589824
s_mov_b32 m0, 152576
s_nop 0
buffer_load_dwordx4 v26, s[16:19], s56 offen lds
s_add_u32 s56, s54, 786432
s_mov_b32 m0, 153600
s_nop 0
buffer_load_dwordx4 v26, s[16:19], s56 offen lds
s_add_u32 s56, s54, 851968
s_mov_b32 m0, 154624
s_nop 0
buffer_load_dwordx4 v26, s[16:19], s56 offen lds
s_waitcnt vmcnt(24)
ds_read_b64_tr_b16 v[240:241], v28 offset:28672
ds_read_b64_tr_b16 v[242:243], v28 offset:28928
ds_read_b64_tr_b16 v[244:245], v28 offset:30720
ds_read_b64_tr_b16 v[246:247], v28 offset:30976
ds_read_b64_tr_b16 v[248:249], v28 offset:28704
ds_read_b64_tr_b16 v[250:251], v28 offset:28960
ds_read_b64_tr_b16 v[252:253], v28 offset:30752
ds_read_b64_tr_b16 v[254:255], v28 offset:31008
s_waitcnt lgkmcnt(0)
s_add_u32 s56, s54, 1048576
s_mov_b32 m0, 155648
s_nop 0
buffer_load_dwordx4 v26, s[16:19], s56 offen lds
s_add_u32 s56, s54, 1114112
s_mov_b32 m0, 156672
s_nop 0
buffer_load_dwordx4 v26, s[16:19], s56 offen lds
s_add_u32 s56, s54, 1310720
s_mov_b32 m0, 157696
s_nop 0
buffer_load_dwordx4 v26, s[16:19], s56 offen lds
s_add_u32 s56, s54, 1376256
s_mov_b32 m0, 158720
s_nop 0
buffer_load_dwordx4 v26, s[16:19], s56 offen lds
s_waitcnt vmcnt(24)
ds_read_b64_tr_b16 a[0:1], v28 offset:0
ds_read_b64_tr_b16 a[2:3], v28 offset:256
ds_read_b64_tr_b16 a[4:5], v28 offset:2048
ds_read_b64_tr_b16 a[6:7], v28 offset:2304
ds_read_b64_tr_b16 a[8:9], v28 offset:32
ds_read_b64_tr_b16 a[10:11], v28 offset:288
ds_read_b64_tr_b16 a[12:13], v28 offset:2080
ds_read_b64_tr_b16 a[14:15], v28 offset:2336
s_waitcnt lgkmcnt(0)
s_add_u32 s56, s54, 3670016
s_mov_b32 m0, 159744
s_nop 0
buffer_load_dwordx4 v26, s[16:19], s56 offen lds
s_add_u32 s56, s54, 3735552
s_mov_b32 m0, 160768
s_nop 0
buffer_load_dwordx4 v26, s[16:19], s56 offen lds
s_add_u32 s56, s54, 3932160
s_mov_b32 m0, 161792
s_nop 0
buffer_load_dwordx4 v26, s[16:19], s56 offen lds
s_add_u32 s56, s54, 3997696
s_mov_b32 m0, 162816
s_nop 0
buffer_load_dwordx4 v26, s[16:19], s56 offen lds
s_waitcnt vmcnt(24)
ds_read_b64_tr_b16 a[16:17], v28 offset:4096
ds_read_b64_tr_b16 a[18:19], v28 offset:4352
ds_read_b64_tr_b16 a[20:21], v28 offset:6144
ds_read_b64_tr_b16 a[22:23], v28 offset:6400
ds_read_b64_tr_b16 a[24:25], v28 offset:4128
ds_read_b64_tr_b16 a[26:27], v28 offset:4384
ds_read_b64_tr_b16 a[28:29], v28 offset:6176
ds_read_b64_tr_b16 a[30:31], v28 offset:6432
s_waitcnt lgkmcnt(0)
s_add_u32 s56, s54, 2097152
s_mov_b32 m0, 131072
s_nop 0
buffer_load_dwordx4 v26, s[16:19], s56 offen lds
s_add_u32 s56, s54, 2162688
s_mov_b32 m0, 132096
s_nop 0
buffer_load_dwordx4 v26, s[16:19], s56 offen lds
s_add_u32 s56, s54, 2359296
s_mov_b32 m0, 133120
s_nop 0
buffer_load_dwordx4 v26, s[16:19], s56 offen lds
s_add_u32 s56, s54, 2424832
s_mov_b32 m0, 134144
s_nop 0
buffer_load_dwordx4 v26, s[16:19], s56 offen lds
s_waitcnt vmcnt(24)
ds_read_b64_tr_b16 a[32:33], v28 offset:8192
ds_read_b64_tr_b16 a[34:35], v28 offset:8448
ds_read_b64_tr_b16 a[36:37], v28 offset:10240
ds_read_b64_tr_b16 a[38:39], v28 offset:10496
ds_read_b64_tr_b16 a[40:41], v28 offset:8224
ds_read_b64_tr_b16 a[42:43], v28 offset:8480
ds_read_b64_tr_b16 a[44:45], v28 offset:10272
ds_read_b64_tr_b16 a[46:47], v28 offset:10528
s_waitcnt lgkmcnt(0)
s_add_u32 s56, s54, 2621440
s_mov_b32 m0, 135168
s_nop 0
buffer_load_dwordx4 v26, s[16:19], s56 offen lds
s_add_u32 s56, s54, 2686976
s_mov_b32 m0, 136192
s_nop 0
buffer_load_dwordx4 v26, s[16:19], s56 offen lds
s_add_u32 s56, s54, 2883584
s_mov_b32 m0, 137216
s_nop 0
buffer_load_dwordx4 v26, s[16:19], s56 offen lds
s_add_u32 s56, s54, 2949120
s_mov_b32 m0, 138240
s_nop 0
buffer_load_dwordx4 v26, s[16:19], s56 offen lds
s_waitcnt vmcnt(24)
ds_read_b64_tr_b16 a[48:49], v28 offset:12288
ds_read_b64_tr_b16 a[50:51], v28 offset:12544
ds_read_b64_tr_b16 a[52:53], v28 offset:14336
ds_read_b64_tr_b16 a[54:55], v28 offset:14592
ds_read_b64_tr_b16 a[56:57], v28 offset:12320
ds_read_b64_tr_b16 a[58:59], v28 offset:12576
ds_read_b64_tr_b16 a[60:61], v28 offset:14368
ds_read_b64_tr_b16 a[62:63], v28 offset:14624
s_waitcnt lgkmcnt(0)
s_add_u32 s56, s54, 4194304
s_mov_b32 m0, 139264
s_nop 0
buffer_load_dwordx4 v26, s[16:19], s56 offen lds
s_add_u32 s56, s54, 4259840
s_mov_b32 m0, 140288
s_nop 0
buffer_load_dwordx4 v26, s[16:19], s56 offen lds
s_add_u32 s56, s54, 4456448
s_mov_b32 m0, 141312
s_nop 0
buffer_load_dwordx4 v26, s[16:19], s56 offen lds
s_add_u32 s56, s54, 4521984
s_mov_b32 m0, 142336
s_nop 0
buffer_load_dwordx4 v26, s[16:19], s56 offen lds
s_waitcnt vmcnt(24)
ds_read_b64_tr_b16 a[64:65], v28 offset:16384
ds_read_b64_tr_b16 a[66:67], v28 offset:16640
ds_read_b64_tr_b16 a[68:69], v28 offset:18432
ds_read_b64_tr_b16 a[70:71], v28 offset:18688
ds_read_b64_tr_b16 a[72:73], v28 offset:16416
ds_read_b64_tr_b16 a[74:75], v28 offset:16672
ds_read_b64_tr_b16 a[76:77], v28 offset:18464
ds_read_b64_tr_b16 a[78:79], v28 offset:18720
s_waitcnt lgkmcnt(0)
s_add_u32 s56, s55, 192
s_mov_b32 m0, 143360
s_nop 0
buffer_load_dwordx4 v27, s[20:23], s56 offen lds
s_add_u32 s56, s55, 18624
s_mov_b32 m0, 144384
s_nop 0
buffer_load_dwordx4 v27, s[20:23], s56 offen lds
s_add_u32 s56, s55, 73920
s_mov_b32 m0, 145408
s_nop 0
buffer_load_dwordx4 v27, s[20:23], s56 offen lds
s_add_u32 s56, s55, 92352
s_mov_b32 m0, 146432
s_nop 0
buffer_load_dwordx4 v27, s[20:23], s56 offen lds
s_waitcnt vmcnt(24)
ds_read_b64_tr_b16 a[80:81], v28 offset:20480
ds_read_b64_tr_b16 a[82:83], v28 offset:20736
ds_read_b64_tr_b16 a[84:85], v28 offset:22528
ds_read_b64_tr_b16 a[86:87], v28 offset:22784
ds_read_b64_tr_b16 a[88:89], v28 offset:20512
ds_read_b64_tr_b16 a[90:91], v28 offset:20768
ds_read_b64_tr_b16 a[92:93], v28 offset:22560
ds_read_b64_tr_b16 a[94:95], v28 offset:22816
s_waitcnt lgkmcnt(0)
s_add_u32 s56, s55, 448
s_mov_b32 m0, 147456
s_nop 0
buffer_load_dwordx4 v27, s[20:23], s56 offen lds
s_add_u32 s56, s55, 18880
s_mov_b32 m0, 148480
s_nop 0
buffer_load_dwordx4 v27, s[20:23], s56 offen lds
s_add_u32 s56, s55, 37312
s_mov_b32 m0, 149504
s_nop 0
buffer_load_dwordx4 v27, s[20:23], s56 offen lds
s_add_u32 s56, s55, 55744
s_mov_b32 m0, 150528
s_nop 0
buffer_load_dwordx4 v27, s[20:23], s56 offen lds
s_waitcnt vmcnt(24)
ds_read_b64_tr_b16 a[96:97], v28 offset:24576
ds_read_b64_tr_b16 a[98:99], v28 offset:24832
ds_read_b64_tr_b16 a[100:101], v28 offset:26624
ds_read_b64_tr_b16 a[102:103], v28 offset:26880
ds_read_b64_tr_b16 a[104:105], v28 offset:24608
ds_read_b64_tr_b16 a[106:107], v28 offset:24864
ds_read_b64_tr_b16 a[108:109], v28 offset:26656
ds_read_b64_tr_b16 a[110:111], v28 offset:26912
s_waitcnt lgkmcnt(0)
s_add_u32 s56, s55, 74176
s_mov_b32 m0, 151552
s_nop 0
buffer_load_dwordx4 v27, s[20:23], s56 offen lds
s_add_u32 s56, s55, 92608
s_mov_b32 m0, 152576
s_nop 0
buffer_load_dwordx4 v27, s[20:23], s56 offen lds
s_add_u32 s56, s55, 704
s_mov_b32 m0, 153600
s_nop 0
buffer_load_dwordx4 v27, s[20:23], s56 offen lds
s_add_u32 s56, s55, 19136
s_mov_b32 m0, 154624
s_nop 0
buffer_load_dwordx4 v27, s[20:23], s56 offen lds
s_waitcnt vmcnt(24)
ds_read_b64_tr_b16 a[112:113], v28 offset:28672
ds_read_b64_tr_b16 a[114:115], v28 offset:28928
ds_read_b64_tr_b16 a[116:117], v28 offset:30720
ds_read_b64_tr_b16 a[118:119], v28 offset:30976
ds_read_b64_tr_b16 a[120:121], v28 offset:28704
ds_read_b64_tr_b16 a[122:123], v28 offset:28960
ds_read_b64_tr_b16 a[124:125], v28 offset:30752
ds_read_b64_tr_b16 a[126:127], v28 offset:31008
s_waitcnt lgkmcnt(0)
s_add_u32 s56, s55, 37568
s_mov_b32 m0, 155648
s_nop 0
buffer_load_dwordx4 v27, s[20:23], s56 offen lds
s_add_u32 s56, s55, 56000
s_mov_b32 m0, 156672
s_nop 0
buffer_load_dwordx4 v27, s[20:23], s56 offen lds
s_add_u32 s56, s55, 111552
s_mov_b32 m0, 157696
s_nop 0
buffer_load_dwordx4 v27, s[20:23], s56 offen lds
s_add_u32 s56, s55, 129984
s_mov_b32 m0, 158720
s_nop 0
buffer_load_dwordx4 v27, s[20:23], s56 offen lds
s_waitcnt vmcnt(24)
ds_read_b64_tr_b16 a[128:129], v28 offset:0
ds_read_b64_tr_b16 a[130:131], v28 offset:256
ds_read_b64_tr_b16 a[132:133], v28 offset:2048
ds_read_b64_tr_b16 a[134:135], v28 offset:2304
ds_read_b64_tr_b16 a[136:137], v28 offset:32
ds_read_b64_tr_b16 a[138:139], v28 offset:288
ds_read_b64_tr_b16 a[140:141], v28 offset:2080
ds_read_b64_tr_b16 a[142:143], v28 offset:2336
s_waitcnt lgkmcnt(0)
s_add_u32 s56, s55, 960
s_mov_b32 m0, 159744
s_nop 0
buffer_load_dwordx4 v27, s[20:23], s56 offen lds
s_add_u32 s56, s55, 19392
s_mov_b32 m0, 160768
s_nop 0
buffer_load_dwordx4 v27, s[20:23], s56 offen lds
s_add_u32 s56, s55, 74688
s_mov_b32 m0, 161792
s_nop 0
buffer_load_dwordx4 v27, s[20:23], s56 offen lds
s_add_u32 s56, s55, 93120
s_mov_b32 m0, 162816
s_nop 0
buffer_load_dwordx4 v27, s[20:23], s56 offen lds
s_waitcnt vmcnt(24)
ds_read_b64_tr_b16 a[144:145], v28 offset:4096
ds_read_b64_tr_b16 a[146:147], v28 offset:4352
ds_read_b64_tr_b16 a[148:149], v28 offset:6144
ds_read_b64_tr_b16 a[150:151], v28 offset:6400
ds_read_b64_tr_b16 a[152:153], v28 offset:4128
ds_read_b64_tr_b16 a[154:155], v28 offset:4384
ds_read_b64_tr_b16 a[156:157], v28 offset:6176
ds_read_b64_tr_b16 a[158:159], v28 offset:6432
s_waitcnt lgkmcnt(0)
s_add_u32 s56, s54, 1572864
s_mov_b32 m0, 131072
s_nop 0
buffer_load_dwordx4 v26, s[8:11], s56 offen lds
s_add_u32 s56, s54, 1638400
s_mov_b32 m0, 132096
s_nop 0
buffer_load_dwordx4 v26, s[8:11], s56 offen lds
s_add_u32 s56, s54, 1835008
s_mov_b32 m0, 133120
s_nop 0
buffer_load_dwordx4 v26, s[8:11], s56 offen lds
s_add_u32 s56, s54, 1900544
s_mov_b32 m0, 134144
s_nop 0
buffer_load_dwordx4 v26, s[8:11], s56 offen lds
s_waitcnt vmcnt(24)
ds_read_b64_tr_b16 a[160:161], v28 offset:8192
ds_read_b64_tr_b16 a[162:163], v28 offset:8448
ds_read_b64_tr_b16 a[164:165], v28 offset:10240
ds_read_b64_tr_b16 a[166:167], v28 offset:10496
ds_read_b64_tr_b16 a[168:169], v28 offset:8224
ds_read_b64_tr_b16 a[170:171], v28 offset:8480
ds_read_b64_tr_b16 a[172:173], v28 offset:10272
ds_read_b64_tr_b16 a[174:175], v28 offset:10528
s_waitcnt lgkmcnt(0)
s_add_u32 s56, s54, 524288
s_mov_b32 m0, 135168
s_nop 0
buffer_load_dwordx4 v26, s[8:11], s56 offen lds
s_add_u32 s56, s54, 589824
s_mov_b32 m0, 136192
s_nop 0
buffer_load_dwordx4 v26, s[8:11], s56 offen lds
s_add_u32 s56, s54, 786432
s_mov_b32 m0, 137216
s_nop 0
buffer_load_dwordx4 v26, s[8:11], s56 offen lds
s_add_u32 s56, s54, 851968
s_mov_b32 m0, 138240
s_nop 0
buffer_load_dwordx4 v26, s[8:11], s56 offen lds
s_waitcnt vmcnt(24)
ds_read_b64_tr_b16 a[176:177], v29 offset:12288
ds_read_b64_tr_b16 a[178:179], v29 offset:12416
ds_read_b64_tr_b16 a[180:181], v29 offset:12800
ds_read_b64_tr_b16 a[182:183], v29 offset:12928
ds_read_b64_tr_b16 a[184:185], v29 offset:14336
ds_read_b64_tr_b16 a[186:187], v29 offset:14464
ds_read_b64_tr_b16 a[188:189], v29 offset:14848
ds_read_b64_tr_b16 a[190:191], v29 offset:14976
s_waitcnt lgkmcnt(0)
s_add_u32 s56, s54, 3670016
s_mov_b32 m0, 139264
s_nop 0
buffer_load_dwordx4 v26, s[8:11], s56 offen lds
s_add_u32 s56, s54, 3735552
s_mov_b32 m0, 140288
s_nop 0
buffer_load_dwordx4 v26, s[8:11], s56 offen lds
s_add_u32 s56, s54, 3932160
s_mov_b32 m0, 141312
s_nop 0
buffer_load_dwordx4 v26, s[8:11], s56 offen lds
s_add_u32 s56, s54, 3997696
s_mov_b32 m0, 142336
s_nop 0
buffer_load_dwordx4 v26, s[8:11], s56 offen lds
s_waitcnt vmcnt(24)
ds_read_b64_tr_b16 a[192:193], v29 offset:16384
ds_read_b64_tr_b16 a[194:195], v29 offset:16512
ds_read_b64_tr_b16 a[196:197], v29 offset:16896
ds_read_b64_tr_b16 a[198:199], v29 offset:17024
ds_read_b64_tr_b16 a[200:201], v29 offset:18432
ds_read_b64_tr_b16 a[202:203], v29 offset:18560
ds_read_b64_tr_b16 a[204:205], v29 offset:18944
ds_read_b64_tr_b16 a[206:207], v29 offset:19072
s_waitcnt lgkmcnt(0)
s_add_u32 s56, s54, 2097152
s_mov_b32 m0, 143360
s_nop 0
buffer_load_dwordx4 v26, s[12:15], s56 offen lds
s_add_u32 s56, s54, 2162688
s_mov_b32 m0, 144384
s_nop 0
buffer_load_dwordx4 v26, s[12:15], s56 offen lds
s_add_u32 s56, s54, 2359296
s_mov_b32 m0, 145408
s_nop 0
buffer_load_dwordx4 v26, s[12:15], s56 offen lds
s_add_u32 s56, s54, 2424832
s_mov_b32 m0, 146432
s_nop 0
buffer_load_dwordx4 v26, s[12:15], s56 offen lds
s_waitcnt vmcnt(24)
ds_read_b64_tr_b16 a[208:209], v29 offset:20480
ds_read_b64_tr_b16 a[210:211], v29 offset:20608
ds_read_b64_tr_b16 a[212:213], v29 offset:20992
ds_read_b64_tr_b16 a[214:215], v29 offset:21120
ds_read_b64_tr_b16 a[216:217], v29 offset:22528
ds_read_b64_tr_b16 a[218:219], v29 offset:22656
ds_read_b64_tr_b16 a[220:221], v29 offset:23040
ds_read_b64_tr_b16 a[222:223], v29 offset:23168
s_waitcnt lgkmcnt(0)
s_add_u32 s56, s54, 3145728
s_mov_b32 m0, 147456
s_nop 0
buffer_load_dwordx4 v26, s[16:19], s56 offen lds
s_add_u32 s56, s54, 3211264
s_mov_b32 m0, 148480
s_nop 0
buffer_load_dwordx4 v26, s[16:19], s56 offen lds
s_add_u32 s56, s54, 3407872
s_mov_b32 m0, 149504
s_nop 0
buffer_load_dwordx4 v26, s[16:19], s56 offen lds
s_add_u32 s56, s54, 3473408
s_mov_b32 m0, 150528
s_nop 0
buffer_load_dwordx4 v26, s[16:19], s56 offen lds
s_waitcnt vmcnt(24)
ds_read_b64_tr_b16 a[224:225], v29 offset:24576
ds_read_b64_tr_b16 a[226:227], v29 offset:24704
ds_read_b64_tr_b16 a[228:229], v29 offset:25088
ds_read_b64_tr_b16 a[230:231], v29 offset:25216
ds_read_b64_tr_b16 a[232:233], v29 offset:26624
ds_read_b64_tr_b16 a[234:235], v29 offset:26752
ds_read_b64_tr_b16 a[236:237], v29 offset:27136
ds_read_b64_tr_b16 a[238:239], v29 offset:27264
s_waitcnt lgkmcnt(0)
s_add_u32 s56, s55, 110784
s_mov_b32 m0, 151552
s_nop 0
buffer_load_dwordx4 v27, s[20:23], s56 offen lds
s_add_u32 s56, s55, 129216
s_mov_b32 m0, 152576
s_nop 0
buffer_load_dwordx4 v27, s[20:23], s56 offen lds
s_add_u32 s56, s55, 111040
s_mov_b32 m0, 153600
s_nop 0
buffer_load_dwordx4 v27, s[20:23], s56 offen lds
s_add_u32 s56, s55, 129472
s_mov_b32 m0, 154624
s_nop 0
buffer_load_dwordx4 v27, s[20:23], s56 offen lds
s_waitcnt vmcnt(24)
ds_read_b64_tr_b16 a[240:241], v29 offset:28672
ds_read_b64_tr_b16 a[242:243], v29 offset:28800
ds_read_b64_tr_b16 a[244:245], v29 offset:29184
ds_read_b64_tr_b16 a[246:247], v29 offset:29312
ds_read_b64_tr_b16 a[248:249], v29 offset:30720
ds_read_b64_tr_b16 a[250:251], v29 offset:30848
ds_read_b64_tr_b16 a[252:253], v29 offset:31232
ds_read_b64_tr_b16 a[254:255], v29 offset:31360
s_waitcnt lgkmcnt(0)
s_add_u32 s56, s55, 37056
s_mov_b32 m0, 155648
s_nop 0
buffer_load_dwordx4 v27, s[20:23], s56 offen lds
s_add_u32 s56, s55, 55488
s_mov_b32 m0, 156672
s_nop 0
buffer_load_dwordx4 v27, s[20:23], s56 offen lds
s_add_u32 s56, s55, 111296
s_mov_b32 m0, 157696
s_nop 0
buffer_load_dwordx4 v27, s[20:23], s56 offen lds
s_add_u32 s56, s55, 129728
s_mov_b32 m0, 158720
s_nop 0
buffer_load_dwordx4 v27, s[20:23], s56 offen lds
s_waitcnt vmcnt(24)
ds_read_b64_tr_b16 v[44:45], v28 offset:0
ds_read_b64_tr_b16 v[46:47], v28 offset:256
ds_read_b64_tr_b16 v[48:49], v28 offset:2048
ds_read_b64_tr_b16 v[50:51], v28 offset:2304
ds_read_b64_tr_b16 v[52:53], v28 offset:32
ds_read_b64_tr_b16 v[54:55], v28 offset:288
ds_read_b64_tr_b16 v[56:57], v28 offset:2080
ds_read_b64_tr_b16 v[58:59], v28 offset:2336
s_waitcnt lgkmcnt(0)
ds_write_b128 v2, v[44:47] offset:0
ds_write_b128 v2, v[48:51] offset:1024
ds_write_b128 v2, v[52:55] offset:2048
ds_write_b128 v2, v[56:59] offset:3072
s_waitcnt lgkmcnt(0)
s_add_u32 s56, s55, 74432
s_mov_b32 m0, 159744
s_nop 0
buffer_load_dwordx4 v27, s[20:23], s56 offen lds
s_add_u32 s56, s55, 92864
s_mov_b32 m0, 160768
s_nop 0
buffer_load_dwordx4 v27, s[20:23], s56 offen lds
s_add_u32 s56, s55, 37824
s_mov_b32 m0, 161792
s_nop 0
buffer_load_dwordx4 v27, s[20:23], s56 offen lds
s_add_u32 s56, s55, 56256
s_mov_b32 m0, 162816
s_nop 0
buffer_load_dwordx4 v27, s[20:23], s56 offen lds
s_waitcnt vmcnt(24)
ds_read_b64_tr_b16 v[44:45], v28 offset:4096
ds_read_b64_tr_b16 v[46:47], v28 offset:4352
ds_read_b64_tr_b16 v[48:49], v28 offset:6144
ds_read_b64_tr_b16 v[50:51], v28 offset:6400
ds_read_b64_tr_b16 v[52:53], v28 offset:4128
ds_read_b64_tr_b16 v[54:55], v28 offset:4384
ds_read_b64_tr_b16 v[56:57], v28 offset:6176
ds_read_b64_tr_b16 v[58:59], v28 offset:6432
s_waitcnt lgkmcnt(0)
ds_write_b128 v2, v[44:47] offset:4096
ds_write_b128 v2, v[48:51] offset:5120
ds_write_b128 v2, v[52:55] offset:6144
ds_write_b128 v2, v[56:59] offset:7168
s_waitcnt lgkmcnt(0)
s_waitcnt vmcnt(20)
ds_read_b64_tr_b16 v[44:45], v28 offset:8192
ds_read_b64_tr_b16 v[46:47], v28 offset:8448
ds_read_b64_tr_b16 v[48:49], v28 offset:10240
ds_read_b64_tr_b16 v[50:51], v28 offset:10496
ds_read_b64_tr_b16 v[52:53], v28 offset:8224
ds_read_b64_tr_b16 v[54:55], v28 offset:8480
ds_read_b64_tr_b16 v[56:57], v28 offset:10272
ds_read_b64_tr_b16 v[58:59], v28 offset:10528
s_waitcnt lgkmcnt(0)
ds_write_b128 v2, v[44:47] offset:8192
ds_write_b128 v2, v[48:51] offset:9216
ds_write_b128 v2, v[52:55] offset:10240
ds_write_b128 v2, v[56:59] offset:11264
s_waitcnt lgkmcnt(0)
s_waitcnt vmcnt(16)
ds_read_b64_tr_b16 v[44:45], v28 offset:12288
ds_read_b64_tr_b16 v[46:47], v28 offset:12544
ds_read_b64_tr_b16 v[48:49], v28 offset:14336
ds_read_b64_tr_b16 v[50:51], v28 offset:14592
ds_read_b64_tr_b16 v[52:53], v28 offset:12320
ds_read_b64_tr_b16 v[54:55], v28 offset:12576
ds_read_b64_tr_b16 v[56:57], v28 offset:14368
ds_read_b64_tr_b16 v[58:59], v28 offset:14624
s_waitcnt lgkmcnt(0)
ds_write_b128 v2, v[44:47] offset:12288
ds_write_b128 v2, v[48:51] offset:13312
ds_write_b128 v2, v[52:55] offset:14336
ds_write_b128 v2, v[56:59] offset:15360
s_waitcnt lgkmcnt(0)
s_waitcnt vmcnt(12)
ds_read_b64_tr_b16 v[44:45], v28 offset:16384
ds_read_b64_tr_b16 v[46:47], v28 offset:16640
ds_read_b64_tr_b16 v[48:49], v28 offset:18432
ds_read_b64_tr_b16 v[50:51], v28 offset:18688
ds_read_b64_tr_b16 v[52:53], v28 offset:16416
ds_read_b64_tr_b16 v[54:55], v28 offset:16672
ds_read_b64_tr_b16 v[56:57], v28 offset:18464
ds_read_b64_tr_b16 v[58:59], v28 offset:18720
s_waitcnt lgkmcnt(0)
ds_write_b128 v2, v[44:47] offset:16384
ds_write_b128 v2, v[48:51] offset:17408
ds_write_b128 v2, v[52:55] offset:18432
ds_write_b128 v2, v[56:59] offset:19456
s_waitcnt lgkmcnt(0)
s_waitcnt vmcnt(8)
ds_read_b64_tr_b16 v[44:45], v29 offset:20480
ds_read_b64_tr_b16 v[46:47], v29 offset:20608
ds_read_b64_tr_b16 v[48:49], v29 offset:20992
ds_read_b64_tr_b16 v[50:51], v29 offset:21120
ds_read_b64_tr_b16 v[52:53], v29 offset:22528
ds_read_b64_tr_b16 v[54:55], v29 offset:22656
ds_read_b64_tr_b16 v[56:57], v29 offset:23040
ds_read_b64_tr_b16 v[58:59], v29 offset:23168
s_waitcnt lgkmcnt(0)
ds_write_b128 v2, v[44:47] offset:20480
ds_write_b128 v2, v[48:51] offset:21504
ds_write_b128 v2, v[52:55] offset:22528
ds_write_b128 v2, v[56:59] offset:23552
s_waitcnt lgkmcnt(0)
s_waitcnt vmcnt(4)
ds_read_b64_tr_b16 v[44:45], v29 offset:24576
ds_read_b64_tr_b16 v[46:47], v29 offset:24704
ds_read_b64_tr_b16 v[48:49], v29 offset:25088
ds_read_b64_tr_b16 v[50:51], v29 offset:25216
ds_read_b64_tr_b16 v[52:53], v29 offset:26624
ds_read_b64_tr_b16 v[54:55], v29 offset:26752
ds_read_b64_tr_b16 v[56:57], v29 offset:27136
ds_read_b64_tr_b16 v[58:59], v29 offset:27264
s_waitcnt lgkmcnt(0)
ds_write_b128 v2, v[44:47] offset:24576
ds_write_b128 v2, v[48:51] offset:25600
ds_write_b128 v2, v[52:55] offset:26624
ds_write_b128 v2, v[56:59] offset:27648
s_waitcnt lgkmcnt(0)
s_waitcnt vmcnt(0)
ds_read_b64_tr_b16 v[44:45], v29 offset:28672
ds_read_b64_tr_b16 v[46:47], v29 offset:28800
ds_read_b64_tr_b16 v[48:49], v29 offset:29184
ds_read_b64_tr_b16 v[50:51], v29 offset:29312
ds_read_b64_tr_b16 v[52:53], v29 offset:30720
ds_read_b64_tr_b16 v[54:55], v29 offset:30848
ds_read_b64_tr_b16 v[56:57], v29 offset:31232
ds_read_b64_tr_b16 v[58:59], v29 offset:31360
s_waitcnt lgkmcnt(0)
ds_write_b128 v2, v[44:47] offset:28672
ds_write_b128 v2, v[48:51] offset:29696
ds_write_b128 v2, v[52:55] offset:30720
ds_write_b128 v2, v[56:59] offset:31744
s_waitcnt lgkmcnt(0)
v_mov_b32 v24, 0
L_rdv_w3r:
buffer_load_dword v23, v24, s[28:31], 0 offen sc0 sc1
s_sub_u32 s41, s41, 1
s_cbranch_scc1 L_exit
s_waitcnt vmcnt(0)
v_readfirstlane_b32 s56, v23
s_nop 0
s_and_b32 s57, s56, 0xff
s_cmp_lg_u32 s57, 32
s_cbranch_scc1 L_rdv_w3r
s_lshl_b32 s55, s32, 2
v_mov_b32 v24, 0
L_kvw_w3rp:
buffer_load_dword v23, v24, s[28:31], s55 offen offset:128 sc0 sc1
s_sub_u32 s41, s41, 1
s_cbranch_scc1 L_exit
s_waitcnt vmcnt(0)
v_readfirstlane_b32 s54, v23
s_nop 0
s_and_b32 s54, s54, 255
s_cmp_lg_u32 s54, 4
s_cbranch_scc1 L_kvw_w3rp
s_mov_b32 m0, 0
s_lshl_b32 s101, s32, 7
s_add_u32 s101, s101, 327680
s_mov_b32 s100, 22
s_lshl_b32 s58, s58, 5
s_cmp_eq_u32 s56, s58
s_cbranch_scc0 L_slow_w3r
buffer_load_dwordx4 v[12:15], v9, s[4:7], s37 offen offset:0
buffer_load_dwordx4 v[16:19], v9, s[4:7], s37 offen offset:1024
buffer_load_dwordx4 v[52:55], v1, s[4:7], s37 offen offset:2048
buffer_load_dwordx4 v[56:59], v1, s[4:7], s37 offen offset:3072
v_mov_b64 v[20:21], 0
v_mov_b64 v[22:23], 0
v_mov_b64 v[24:25], 0
v_mov_b64 v[26:27], 0
v_mov_b64 v[28:29], 0
v_mov_b64 v[30:31], 0
v_mov_b64 v[32:33], 0
v_mov_b64 v[34:35], 0
v_mov_b64 v[36:37], 0
v_mov_b64 v[38:39], 0
v_mov_b64 v[40:41], 0
v_mov_b64 v[42:43], 0
v_lshrrev_b32 v6, 2, v1
ds_read_b128 v[44:47], v2 offset:0
ds_read_b128 v[48:51], v2 offset:1024
s_waitcnt vmcnt(0)
buffer_load_dwordx4 v[60:63], v1, s[4:7], s47 offen sc1
buffer_load_dwordx4 v[68:71], v1, s[4:7], s38 offen sc1
s_waitcnt vmcnt(0)
.p2align 6
L_top_w3rf:
s_waitcnt vmcnt(5)
L_a0_w3rf:
s_waitcnt lgkmcnt(0)
v_smfmac_f32_16x16x64_bf16 v[20:23], v[60:63], v[44:51], v0
ds_write_b128 v1, v[60:63] offset:4096
v_smfmac_f32_16x16x64_bf16 v[28:31], v[60:63], v[176:183], v0
ds_read_b128 v[44:47], v2 offset:2048
buffer_load_dwordx4 v[64:67], v1, s[4:7], s48 offen sc1
v_smfmac_f32_16x16x64_bf16 v[32:35], v[60:63], v[184:191], v0
ds_read_b128 v[48:51], v2 offset:3072
buffer_load_dword v76, v6, s[4:7], s49 offen sc1
v_smfmac_f32_16x16x64_bf16 v[36:39], v[60:63], a[48:55], v0
s_waitcnt vmcnt(6)
v_bitop3_b32 v77, v60, v68, s35 bitop3:0x7e
v_smfmac_f32_16x16x64_bf16 v[40:43], v[60:63], a[56:63], v0
v_and_b32 v77, 1, v77
v_smfmac_f32_16x16x64_bf16 v[20:23], v[68:71], v[80:87], v0
v_cmp_ne_u32 vcc, 0, v77
s_waitcnt lgkmcnt(0)
v_smfmac_f32_16x16x64_bf16 v[24:27], v[60:63], v[44:51], v0
ds_read_b128 v[44:47], v2 offset:4096
v_smfmac_f32_16x16x64_bf16 v[24:27], v[68:71], v[88:95], v0
s_cbranch_vccnz L_ra0_w3rf
s_barrier
ds_read_b128 v[72:75], v1 offset:2048
v_smfmac_f32_16x16x64_bf16 v[28:31], v[68:71], v[192:199], v0
ds_read_b128 v[48:51], v2 offset:5120
v_smfmac_f32_16x16x64_bf16 v[32:35], v[68:71], v[200:207], v0
ds_read_b128 v[60:63], v1 offset:3072
v_smfmac_f32_16x16x64_bf16 v[36:39], v[68:71], a[64:71], v0
v_smfmac_f32_16x16x64_bf16 v[40:43], v[68:71], a[72:79], v0
s_waitcnt lgkmcnt(2)
s_waitcnt lgkmcnt(1)
v_smfmac_f32_16x16x64_bf16 v[20:23], v[72:75], v[44:51], v0
ds_read_b128 v[44:47], v2 offset:6144
v_smfmac_f32_16x16x64_bf16 v[28:31], v[72:75], v[208:215], v0
ds_read_b128 v[48:51], v2 offset:7168
v_smfmac_f32_16x16x64_bf16 v[32:35], v[72:75], v[216:223], v0
s_waitcnt vmcnt(0)
ds_write_b128 v1, v[64:67] offset:8192
v_smfmac_f32_16x16x64_bf16 v[36:39], v[72:75], a[80:87], v0
ds_write_addtid_b32 v76 offset:9984
v_bitop3_b32 v77, v64, s35, 1 bitop3:0x28
v_smfmac_f32_16x16x64_bf16 v[40:43], v[72:75], a[88:95], v0
v_bitop3_b32 v78, v76, s35, v11 bitop3:0x28
s_waitcnt lgkmcnt(2)
v_smfmac_f32_16x16x64_bf16 v[24:27], v[72:75], v[44:51], v0
ds_read_b128 v[44:47], v2 offset:8192
v_or_b32 v77, v77, v78
v_smfmac_f32_16x16x64_bf16 v[20:23], v[60:63], v[96:103], v0
ds_read_b128 v[48:51], v2 offset:9216
v_cmp_ne_u32 vcc, 0, v77
v_smfmac_f32_16x16x64_bf16 v[24:27], v[60:63], v[104:111], v0
v_smfmac_f32_16x16x64_bf16 v[36:39], v[60:63], a[96:103], v0
s_cbranch_vccnz L_ra1_w3rf
L_a1_w3rf:
s_waitcnt lgkmcnt(2)
s_barrier
ds_read_b128 v[68:71], v1 offset:5120
v_smfmac_f32_16x16x64_bf16 v[28:31], v[60:63], v[224:231], v0
ds_read_b128 v[72:75], v1 offset:6144
v_lshlrev_b32 v6, 2, v1
v_smfmac_f32_16x16x64_bf16 v[40:43], v[60:63], a[104:111], v0
ds_read_b128 v[76:79], v1 offset:9216
v_smfmac_f32_16x16x64_bf16 v[32:35], v[60:63], v[232:239], v0
ds_read_b128 v[60:63], v1 offset:7168
s_waitcnt lgkmcnt(4)
v_smfmac_f32_16x16x64_bf16 v[20:23], v[64:67], v[44:51], v0
ds_read_b128 v[44:47], v2 offset:10240
buffer_load_dword v6, s[4:7], s39 offen lds
s_waitcnt lgkmcnt(4)
v_smfmac_f32_16x16x64_bf16 v[20:23], v[68:71], v[112:119], v0
ds_read_b128 v[48:51], v2 offset:11264
v_smfmac_f32_16x16x64_bf16 v[24:27], v[68:71], v[120:127], v0
s_waitcnt lgkmcnt(4)
v_smfmac_f32_16x16x64_bf16 v[20:23], v[72:75], v[128:135], v0
s_waitcnt lgkmcnt(3)
v_smfmac_f32_16x16x64_bf16 v[20:23], v[76:79], v[160:167], v0
s_waitcnt lgkmcnt(2)
v_smfmac_f32_16x16x64_bf16 v[20:23], v[60:63], v[144:151], v0
s_waitcnt lgkmcnt(0)
v_smfmac_f32_16x16x64_bf16 v[24:27], v[64:67], v[44:51], v0
ds_read_b128 v[44:47], v2 offset:12288
v_smfmac_f32_16x16x64_bf16 v[24:27], v[72:75], v[136:143], v0
ds_read_b128 v[48:51], v2 offset:13312
v_add_f32 v20, v20, v22
v_smfmac_f32_16x16x64_bf16 v[24:27], v[76:79], v[168:175], v0
v_add_f32 v21, v21, v23
v_smfmac_f32_16x16x64_bf16 v[24:27], v[60:63], v[152:159], v0
v_cvt_pk_bf16_f32 v22, v20, v21
v_smfmac_f32_16x16x64_bf16 v[28:31], v[64:67], v[240:247], v0
v_smfmac_f32_16x16x64_bf16 v[28:31], v[72:75], a[0:7], v0
v_add_f32 v24, v24, v26
v_add_f32 v25, v25, v27
v_cvt_pk_bf16_f32 v23, v24, v25
s_waitcnt lgkmcnt(0)
v_smfmac_f32_16x16x64_bf16 v[28:31], v[68:71], v[44:51], v0
ds_write_b64 v3, v[22:23] offset:11776
v_smfmac_f32_16x16x64_bf16 v[28:31], v[76:79], a[32:39], v0
ds_read_b128 v[44:47], v2 offset:14336
v_smfmac_f32_16x16x64_bf16 v[28:31], v[60:63], a[16:23], v0
ds_read_b128 v[48:51], v2 offset:15360
v_smfmac_f32_16x16x64_bf16 v[32:35], v[64:67], v[248:255], v0
s_waitcnt lgkmcnt(2)
s_barrier
ds_read_b64_tr_b16 v[20:21], v4 offset:10240
ds_read_b64_tr_b16 v[22:23], v4 offset:10752
v_smfmac_f32_16x16x64_bf16 v[32:35], v[72:75], a[8:15], v0
ds_read_b64_tr_b16 v[24:25], v4 offset:11264
v_add_f32 v28, v28, v30
v_smfmac_f32_16x16x64_bf16 v[32:35], v[76:79], a[40:47], v0
ds_read_b64_tr_b16 v[26:27], v4 offset:11776
v_add_f32 v29, v29, v31
s_waitcnt lgkmcnt(4)
v_smfmac_f32_16x16x64_bf16 v[32:35], v[68:71], v[44:51], v0
ds_read_b128 v[44:47], v2 offset:18432
v_cvt_pk_bf16_f32 v30, v28, v29
v_smfmac_f32_16x16x64_bf16 v[32:35], v[60:63], a[24:31], v0
ds_read_b128 v[48:51], v2 offset:19456
s_waitcnt lgkmcnt(4)
v_mfma_f32_16x16x32_bf16 v[12:15], v[12:15], v[20:23], 0
s_waitcnt lgkmcnt(2)
v_mfma_f32_16x16x32_bf16 v[12:15], v[16:19], v[24:27], v[12:15]
v_add_f32 v32, v32, v34
v_add_f32 v33, v33, v35
v_cvt_pk_bf16_f32 v31, v32, v33
ds_write_b64 v3, v[30:31] offset:13824
v_smfmac_f32_16x16x64_bf16 v[36:39], v[64:67], a[112:119], v0
s_nop 2
v_add_f32_dpp v12, v14, v12 quad_perm:[2,3,0,1] row_mask:0xf bank_mask:0xf
v_add_f32_dpp v13, v15, v13 quad_perm:[2,3,0,1] row_mask:0xf bank_mask:0xf
ds_write_b64 v5, v[12:13] offset:15104
v_smfmac_f32_16x16x64_bf16 v[40:43], v[64:67], a[120:127], v0
s_waitcnt lgkmcnt(1)
s_barrier
ds_read_b64_tr_b16 v[64:65], v4 offset:12288
ds_read_b64_tr_b16 v[66:67], v4 offset:12800
v_smfmac_f32_16x16x64_bf16 v[36:39], v[68:71], a[128:135], v0
ds_read_b64_tr_b16 v[16:17], v4 offset:13312
ds_read_b64_tr_b16 v[18:19], v4 offset:13824
v_smfmac_f32_16x16x64_bf16 v[40:43], v[68:71], a[136:143], v0
s_waitcnt lgkmcnt(4)
s_barrier
ds_read_b128 v[68:71], v1 offset:14336
v_smfmac_f32_16x16x64_bf16 v[40:43], v[60:63], v[44:51], v0
ds_read_b128 v[44:47], v2 offset:16384
s_waitcnt lgkmcnt(4)
v_mfma_f32_16x16x32_bf16 v[64:67], v[64:67], v[20:23], 0
ds_read_b128 v[48:51], v2 offset:17408
s_waitcnt lgkmcnt(3)
v_mfma_f32_16x16x32_bf16 v[64:67], v[16:19], v[24:27], v[64:67]
v_smfmac_f32_16x16x64_bf16 v[40:43], v[72:75], a[152:159], v0
ds_read_b128 v[12:15], v2 offset:22528
s_waitcnt lgkmcnt(3)
v_max3_f32 v25, v68, v69, v70
v_smfmac_f32_16x16x64_bf16 v[40:43], v[76:79], a[168:175], v0
ds_read_b128 v[16:19], v2 offset:23552
v_add_f32_dpp v64, v66, v64 quad_perm:[2,3,0,1] row_mask:0xf bank_mask:0xf
v_add_f32_dpp v65, v67, v65 quad_perm:[2,3,0,1] row_mask:0xf bank_mask:0xf
v_max_f32 v25, v25, v71
v_max_f32 v24, v64, v65
v_mul_f32 v24, s50, v24
v_max_f32_dpp v25, v25, v25 quad_perm:[2,3,0,1] row_mask:0xf bank_mask:0xf
v_smfmac_f32_16x16x64_bf16 v[36:39], v[72:75], a[144:151], v0
s_nop 0
v_max_f32_dpp v26, v24, v25 quad_perm:[0,1,0,1] row_mask:0xf bank_mask:0xf
v_max_f32_dpp v27, v24, v25 quad_perm:[0,1,0,1] row_mask:0xf bank_mask:0xf
v_smfmac_f32_16x16x64_bf16 v[36:39], v[76:79], a[160:167], v0
s_nop 0
v_permlane16_swap_b32 v26, v27
v_max_f32 v28, v26, v27
v_max_f32 v29, v26, v27
s_waitcnt lgkmcnt(2)
v_smfmac_f32_16x16x64_bf16 v[36:39], v[60:63], v[44:51], v0
v_permlane32_swap_b32 v28, v29
v_max_f32 v28, v28, v29
v_sub_f32 v68, v68, v28
v_sub_f32 v69, v69, v28
v_sub_f32 v70, v70, v28
v_sub_f32 v71, v71, v28
v_exp_f32 v68, v68
v_exp_f32 v69, v69
v_exp_f32 v70, v70
v_exp_f32 v71, v71
v_cvt_pk_bf16_f32 v20, v68, v69
v_cvt_pk_bf16_f32 v21, v70, v71
v_pk_add_f32 v[36:37], v[36:37], v[38:39]
v_mov_b32_dpp v22, v20 quad_perm:[2,3,0,1] row_mask:0xf bank_mask:0xf
v_mov_b32_dpp v23, v21 quad_perm:[2,3,0,1] row_mask:0xf bank_mask:0xf
v_pk_fma_f32 v[64:65], v[64:65], s[50:51], v[28:29] op_sel_hi:[1,1,0] neg_lo:[0,0,1] neg_hi:[0,0,1]
v_cvt_pk_bf16_f32 v32, v36, v37
v_pk_add_f32 v[40:41], v[40:41], v[42:43]
v_mfma_f32_16x16x32_bf16 v[36:39], v[52:55], v[20:23], 0
v_mov_b64 v[72:73], s[52:53]
v_mov_b64 v[74:75], s[52:53]
v_cvt_pk_bf16_f32 v33, v40, v41
v_exp_f32 v64, v64
v_mfma_f32_16x16x32_bf16 v[68:71], v[72:75], v[20:23], 0
v_exp_f32 v65, v65
v_mov_b32 v25, 0
v_cvt_pk_bf16_f32 v24, v64, v65
v_mfma_f32_16x16x32_bf16 v[40:43], v[56:59], v[20:23], 0
v_cvt_pk_bf16_f32 v27, v64, v65
v_mov_b32 v26, 0
v_mfma_f32_16x16x16_bf16 v[68:71], v[72:73], v[24:25], v[68:71]
ds_read_b128 v[44:47], v2 offset:20480
v_mfma_f32_16x16x16_bf16 v[36:39], v[32:33], v[24:25], v[36:39]
ds_read_b128 v[48:51], v2 offset:21504
v_mfma_f32_16x16x16_bf16 v[40:43], v[32:33], v[26:27], v[40:43]
v_rcp_f32 v68, v68
v_mov_b64 v[76:77], 0
v_mov_b64 v[78:79], 0
s_nop 0
v_mul_f32 v36, v36, v68
v_mul_f32 v37, v37, v68
v_mul_f32 v38, v38, v68
v_mul_f32 v39, v39, v68
v_pk_mul_f32 v[40:41], v[40:41], v[68:69] op_sel_hi:[1,0]
v_pk_mul_f32 v[42:43], v[42:43], v[68:69] op_sel_hi:[1,0]
v_cvt_pk_bf16_f32 v36, v36, v37
v_cvt_pk_bf16_f32 v37, v38, v39
v_cvt_pk_bf16_f32 v38, v40, v41
v_cvt_pk_bf16_f32 v39, v42, v43
ds_write_b128 v1, v[36:39] offset:8192
ds_read_b128 v[60:63], v7 offset:8192
buffer_store_dwordx4 v[30:33], v1, s[4:7], s40 offen sc0 sc1
ds_read_b128 v[52:55], v2 offset:24576
ds_read_b128 v[56:59], v2 offset:25600
s_cmp_eq_u32 s34, s100
v_mov_b64 v[20:21], 0
v_mov_b64 v[22:23], 0
s_cbranch_scc1 L_ev_w3rf
L_evb_w3rf:
s_waitcnt lgkmcnt(3)
s_barrier
ds_read_b128 v[64:67], v7 offset:5120
ds_read_b128 v[68:71], v7 offset:6144
ds_read_b128 v[72:75], v7 offset:7168
s_waitcnt lgkmcnt(5)
v_smfmac_f32_16x16x64_bf16 v[76:79], v[60:63], v[44:51], v0 abid:1
ds_read_b128 v[44:47], v2 offset:26624
v_mov_b64 v[24:25], 0
v_smfmac_f32_16x16x64_bf16 v[20:23], v[60:63], v[12:19], v0 abid:1
ds_read_b128 v[48:51], v2 offset:27648
v_mov_b64 v[26:27], 0
s_waitcnt lgkmcnt(4)
v_smfmac_f32_16x16x64_bf16 v[76:79], v[64:67], a[176:183], v0 abid:1
ds_read_b128 v[12:15], v2 offset:28672
v_mov_b64 v[40:41], 0
s_waitcnt lgkmcnt(4)
v_smfmac_f32_16x16x64_bf16 v[76:79], v[68:71], v[52:59], v0 abid:1
ds_read_b128 v[16:19], v2 offset:29696
v_mov_b64 v[42:43], 0
s_waitcnt lgkmcnt(4)
v_smfmac_f32_16x16x64_bf16 v[76:79], v[72:75], a[184:191], v0 abid:1
ds_read_b128 v[52:55], v2 offset:30720
v_smfmac_f32_16x16x64_bf16 v[20:23], v[64:67], a[192:199], v0 abid:1
ds_read_b128 v[56:59], v2 offset:31744
v_smfmac_f32_16x16x64_bf16 v[20:23], v[68:71], a[200:207], v0 abid:1
v_cvt_pk_bf16_f32 v76, v76, v77
v_cvt_pk_bf16_f32 v77, v78, v79
v_bfi_b32 v76, 1, s35, v76
buffer_store_dwordx2 v[76:77], v8, s[4:7], s42 offen
v_smfmac_f32_16x16x64_bf16 v[20:23], v[72:75], a[208:215], v0 abid:1
s_waitcnt lgkmcnt(4)
v_smfmac_f32_16x16x64_bf16 v[24:27], v[60:63], v[44:51], v0 abid:1
v_smfmac_f32_16x16x64_bf16 v[24:27], v[64:67], a[216:223], v0 abid:1
v_cvt_pk_bf16_f32 v20, v20, v21
v_cvt_pk_bf16_f32 v21, v22, v23
v_bfi_b32 v20, 1, s35, v20
buffer_store_dwordx2 v[20:21], v8, s[4:7], s43 offen
v_smfmac_f32_16x16x64_bf16 v[24:27], v[68:71], a[224:231], v0 abid:1
s_waitcnt lgkmcnt(2)
v_smfmac_f32_16x16x64_bf16 v[24:27], v[72:75], v[12:19], v0 abid:1
v_smfmac_f32_16x16x64_bf16 v[40:43], v[60:63], a[232:239], v0 abid:1
v_smfmac_f32_16x16x64_bf16 v[40:43], v[64:67], a[240:247], v0 abid:1
v_cvt_pk_bf16_f32 v24, v24, v25
s_waitcnt lgkmcnt(0)
v_smfmac_f32_16x16x64_bf16 v[40:43], v[68:71], v[52:59], v0 abid:1
v_cvt_pk_bf16_f32 v25, v26, v27
v_smfmac_f32_16x16x64_bf16 v[40:43], v[72:75], a[248:255], v0 abid:1
v_bfi_b32 v24, 1, s35, v24
buffer_store_dwordx2 v[24:25], v8, s[4:7], s44 offen
s_nop 5
v_cvt_pk_bf16_f32 v40, v40, v41
v_cvt_pk_bf16_f32 v41, v42, v43
v_bfi_b32 v40, 1, s35, v40
buffer_store_dwordx2 v[40:41], v8, s[4:7], s45 offen
s_add_u32 s34, s34, 1
s_add_u32 s37, s37, 524288
s_add_u32 s39, s39, 524288
v_and_b32 v6, 0x70, v1
ds_read_b128 v[76:79], v6 offset:256
v_mov_b64 v[20:21], 0
v_mov_b64 v[22:23], 0
v_mov_b64 v[24:25], 0
v_mov_b64 v[26:27], 0
v_mov_b64 v[28:29], 0
v_mov_b64 v[34:35], 0
v_mov_b64 v[36:37], 0
v_mov_b64 v[38:39], 0
v_mov_b64 v[40:41], 0
v_mov_b64 v[42:43], 0
s_waitcnt vmcnt(0)
buffer_load_dwordx4 v[44:47], v9, s[4:7], s3 offen offset:0 sc1
buffer_load_dwordx4 v[48:51], v9, s[4:7], s3 offen offset:1024 sc1
buffer_load_dwordx4 v[52:55], v9, s[4:7], s3 offen offset:2048 sc1
buffer_load_dwordx4 v[56:59], v9, s[4:7], s3 offen offset:3072 sc1
s_waitcnt lgkmcnt(0)
s_waitcnt vmcnt(3)
L_r_w3rf:
v_mfma_f32_16x16x32_bf16 v[72:75], v[44:47], v[76:79], 0
s_waitcnt vmcnt(2)
v_mfma_f32_16x16x32_bf16 v[72:75], v[48:51], v[76:79], v[72:75]
v_bitop3_b32 v68, v44, v48, s35 bitop3:0x7e
s_waitcnt vmcnt(1)
v_mfma_f32_16x16x32_bf16 v[72:75], v[52:55], v[76:79], v[72:75]
s_waitcnt vmcnt(0)
v_mfma_f32_16x16x32_bf16 v[72:75], v[56:59], v[76:79], v[72:75]
v_bitop3_b32 v69, v52, v56, s35 bitop3:0x7e
v_bitop3_b32 v68, v68, v69, 1 bitop3:0xa8
v_cmp_ne_u32 vcc, 0, v68
s_cbranch_vccnz L_rr_w3rf
ds_read_b128 v[44:47], v2 offset:0
ds_read_b128 v[48:51], v2 offset:1024
s_nop 1
v_pk_add_f32 v[72:73], v[72:73], v[74:75]
v_cvt_pk_bf16_f32 v68, v72, v73
v_bfi_b32 v68, v11, s36, v68
buffer_store_dword v68, v10, s[4:7], 0 offen
s_not_b32 s35, s35
s_not_b32 s36, s36
v_lshrrev_b32 v6, 2, v1
s_barrier
buffer_load_dwordx4 v[60:63], v1, s[4:7], s47 offen sc1
buffer_load_dwordx4 v[68:71], v1, s[4:7], s38 offen sc1
s_add_u32 s40, s40, 131072
v_mov_b64 v[30:31], 0
v_mov_b64 v[32:33], 0
buffer_load_dwordx4 v[12:15], v9, s[4:7], s37 offen offset:0
buffer_load_dwordx4 v[16:19], v9, s[4:7], s37 offen offset:1024
buffer_load_dwordx4 v[52:55], v1, s[4:7], s37 offen offset:2048
buffer_load_dwordx4 v[56:59], v1, s[4:7], s37 offen offset:3072
s_branch L_top_w3rf
L_done_w3rf:
s_waitcnt vmcnt(0)
s_barrier
s_waitcnt vmcnt(0) lgkmcnt(0)
s_endpgm
L_ra0_w3rf:
buffer_load_dwordx4 v[60:63], v1, s[4:7], s47 offen sc1
buffer_load_dwordx4 v[68:71], v1, s[4:7], s38 offen sc1
s_sub_u32 s41, s41, 1
s_cbranch_scc1 L_exit
ds_read_b128 v[44:47], v2 offset:0
ds_read_b128 v[48:51], v2 offset:1024
s_waitcnt vmcnt(0) lgkmcnt(0)
v_mov_b64 v[20:21], 0
v_mov_b64 v[22:23], 0
v_mov_b64 v[24:25], 0
v_mov_b64 v[26:27], 0
v_mov_b64 v[28:29], 0
v_mov_b64 v[30:31], 0
v_mov_b64 v[32:33], 0
v_mov_b64 v[34:35], 0
v_mov_b64 v[36:37], 0
v_mov_b64 v[38:39], 0
v_mov_b64 v[40:41], 0
v_mov_b64 v[42:43], 0
s_nop 0
s_branch L_a0_w3rf
L_ra1_w3rf:
buffer_load_dwordx4 v[64:67], v1, s[4:7], s48 offen sc1
buffer_load_dword v76, v6, s[4:7], s49 offen sc1
s_sub_u32 s41, s41, 1
s_cbranch_scc1 L_exit
s_waitcnt vmcnt(0)
v_bitop3_b32 v77, v64, s35, 1 bitop3:0x28
v_bitop3_b32 v78, v76, s35, v11 bitop3:0x28
v_or_b32 v77, v77, v78
v_cmp_ne_u32 vcc, 0, v77
s_cbranch_vccnz L_ra1_w3rf
ds_write_b128 v1, v[64:67] offset:8192
ds_write_addtid_b32 v76 offset:9984
s_waitcnt lgkmcnt(0)
s_branch L_a1_w3rf
L_ev_w3rf:
s_cmp_eq_u32 s34, 63
s_cbranch_scc1 L_done_w3rf
s_mov_b32 s100, 63

s_lshl_b32 s55, s32, 2
v_mov_b32 v34, 0
L_kvw_w3rf:
buffer_load_dword v29, v34, s[28:31], s55 offen offset:128 sc0 sc1
s_sub_u32 s41, s41, 1
s_cbranch_scc1 L_exit
s_waitcnt vmcnt(0)
v_readfirstlane_b32 s54, v29
s_nop 0
s_and_b32 s54, s54, 65280
s_cmp_lg_u32 s54, 1024
s_cbranch_scc1 L_kvw_w3rf
s_branch L_evb_w3rf
L_rr_w3rf:
buffer_load_dwordx4 v[44:47], v9, s[4:7], s3 offen offset:0 sc1
buffer_load_dwordx4 v[48:51], v9, s[4:7], s3 offen offset:1024 sc1
buffer_load_dwordx4 v[52:55], v9, s[4:7], s3 offen offset:2048 sc1
buffer_load_dwordx4 v[56:59], v9, s[4:7], s3 offen offset:3072 sc1
s_sub_u32 s41, s41, 1
s_cbranch_scc1 L_exit
s_waitcnt vmcnt(0)
s_branch L_r_w3rf
L_slow_w3r:
buffer_load_dwordx4 v[12:15], v9, s[4:7], s37 offen offset:0
buffer_load_dwordx4 v[16:19], v9, s[4:7], s37 offen offset:1024
buffer_load_dwordx4 v[52:55], v1, s[4:7], s37 offen offset:2048
buffer_load_dwordx4 v[56:59], v1, s[4:7], s37 offen offset:3072
v_mov_b64 v[20:21], 0
v_mov_b64 v[22:23], 0
v_mov_b64 v[24:25], 0
v_mov_b64 v[26:27], 0
v_mov_b64 v[28:29], 0
v_mov_b64 v[30:31], 0
v_mov_b64 v[32:33], 0
v_mov_b64 v[34:35], 0
v_mov_b64 v[36:37], 0
v_mov_b64 v[38:39], 0
v_mov_b64 v[40:41], 0
v_mov_b64 v[42:43], 0
v_lshrrev_b32 v6, 2, v1
ds_read_b128 v[44:47], v2 offset:0
ds_read_b128 v[48:51], v2 offset:1024
s_waitcnt vmcnt(0)
buffer_load_dwordx4 v[60:63], v1, s[4:7], s47 offen sc0 sc1
buffer_load_dwordx4 v[68:71], v1, s[4:7], s38 offen sc0 sc1
s_waitcnt vmcnt(0)
.p2align 6
L_top_w3rs:
s_waitcnt vmcnt(5)
L_a0_w3rs:
s_waitcnt lgkmcnt(0)
v_smfmac_f32_16x16x64_bf16 v[20:23], v[60:63], v[44:51], v0
ds_write_b128 v1, v[60:63] offset:4096
v_smfmac_f32_16x16x64_bf16 v[28:31], v[60:63], v[176:183], v0
ds_read_b128 v[44:47], v2 offset:2048
buffer_load_dwordx4 v[64:67], v1, s[4:7], s48 offen sc0 sc1
v_smfmac_f32_16x16x64_bf16 v[32:35], v[60:63], v[184:191], v0
ds_read_b128 v[48:51], v2 offset:3072
buffer_load_dword v76, v6, s[4:7], s49 offen sc0 sc1
v_smfmac_f32_16x16x64_bf16 v[36:39], v[60:63], a[48:55], v0
s_waitcnt vmcnt(6)
v_bitop3_b32 v77, v60, v68, s35 bitop3:0x7e
v_smfmac_f32_16x16x64_bf16 v[40:43], v[60:63], a[56:63], v0
v_and_b32 v77, 1, v77
v_smfmac_f32_16x16x64_bf16 v[20:23], v[68:71], v[80:87], v0
v_cmp_ne_u32 vcc, 0, v77
s_waitcnt lgkmcnt(0)
v_smfmac_f32_16x16x64_bf16 v[24:27], v[60:63], v[44:51], v0
ds_read_b128 v[44:47], v2 offset:4096
v_smfmac_f32_16x16x64_bf16 v[24:27], v[68:71], v[88:95], v0
s_cbranch_vccnz L_ra0_w3rs
s_barrier
ds_read_b128 v[72:75], v1 offset:2048
v_smfmac_f32_16x16x64_bf16 v[28:31], v[68:71], v[192:199], v0
ds_read_b128 v[48:51], v2 offset:5120
v_smfmac_f32_16x16x64_bf16 v[32:35], v[68:71], v[200:207], v0
ds_read_b128 v[60:63], v1 offset:3072
v_smfmac_f32_16x16x64_bf16 v[36:39], v[68:71], a[64:71], v0
v_smfmac_f32_16x16x64_bf16 v[40:43], v[68:71], a[72:79], v0
s_waitcnt lgkmcnt(2)
s_waitcnt lgkmcnt(1)
v_smfmac_f32_16x16x64_bf16 v[20:23], v[72:75], v[44:51], v0
ds_read_b128 v[44:47], v2 offset:6144
v_smfmac_f32_16x16x64_bf16 v[28:31], v[72:75], v[208:215], v0
ds_read_b128 v[48:51], v2 offset:7168
v_smfmac_f32_16x16x64_bf16 v[32:35], v[72:75], v[216:223], v0
s_waitcnt vmcnt(0)
ds_write_b128 v1, v[64:67] offset:8192
v_smfmac_f32_16x16x64_bf16 v[36:39], v[72:75], a[80:87], v0
ds_write_addtid_b32 v76 offset:9984
v_bitop3_b32 v77, v64, s35, 1 bitop3:0x28
v_smfmac_f32_16x16x64_bf16 v[40:43], v[72:75], a[88:95], v0
v_bitop3_b32 v78, v76, s35, v11 bitop3:0x28
s_waitcnt lgkmcnt(2)
v_smfmac_f32_16x16x64_bf16 v[24:27], v[72:75], v[44:51], v0
ds_read_b128 v[44:47], v2 offset:8192
v_or_b32 v77, v77, v78
v_smfmac_f32_16x16x64_bf16 v[20:23], v[60:63], v[96:103], v0
ds_read_b128 v[48:51], v2 offset:9216
v_cmp_ne_u32 vcc, 0, v77
v_smfmac_f32_16x16x64_bf16 v[24:27], v[60:63], v[104:111], v0
v_smfmac_f32_16x16x64_bf16 v[36:39], v[60:63], a[96:103], v0
s_cbranch_vccnz L_ra1_w3rs
L_a1_w3rs:
s_waitcnt lgkmcnt(2)
s_barrier
ds_read_b128 v[68:71], v1 offset:5120
v_smfmac_f32_16x16x64_bf16 v[28:31], v[60:63], v[224:231], v0
ds_read_b128 v[72:75], v1 offset:6144
v_lshlrev_b32 v6, 2, v1
v_smfmac_f32_16x16x64_bf16 v[40:43], v[60:63], a[104:111], v0
ds_read_b128 v[76:79], v1 offset:9216
v_smfmac_f32_16x16x64_bf16 v[32:35], v[60:63], v[232:239], v0
ds_read_b128 v[60:63], v1 offset:7168
s_waitcnt lgkmcnt(4)
v_smfmac_f32_16x16x64_bf16 v[20:23], v[64:67], v[44:51], v0
ds_read_b128 v[44:47], v2 offset:10240
buffer_load_dword v6, s[4:7], s39 offen lds
s_waitcnt lgkmcnt(4)
v_smfmac_f32_16x16x64_bf16 v[20:23], v[68:71], v[112:119], v0
ds_read_b128 v[48:51], v2 offset:11264
v_smfmac_f32_16x16x64_bf16 v[24:27], v[68:71], v[120:127], v0
s_waitcnt lgkmcnt(4)
v_smfmac_f32_16x16x64_bf16 v[20:23], v[72:75], v[128:135], v0
s_waitcnt lgkmcnt(3)
v_smfmac_f32_16x16x64_bf16 v[20:23], v[76:79], v[160:167], v0
s_waitcnt lgkmcnt(2)
v_smfmac_f32_16x16x64_bf16 v[20:23], v[60:63], v[144:151], v0
s_waitcnt lgkmcnt(0)
v_smfmac_f32_16x16x64_bf16 v[24:27], v[64:67], v[44:51], v0
ds_read_b128 v[44:47], v2 offset:12288
v_smfmac_f32_16x16x64_bf16 v[24:27], v[72:75], v[136:143], v0
ds_read_b128 v[48:51], v2 offset:13312
v_add_f32 v20, v20, v22
v_smfmac_f32_16x16x64_bf16 v[24:27], v[76:79], v[168:175], v0
v_add_f32 v21, v21, v23
v_smfmac_f32_16x16x64_bf16 v[24:27], v[60:63], v[152:159], v0
v_cvt_pk_bf16_f32 v22, v20, v21
v_smfmac_f32_16x16x64_bf16 v[28:31], v[64:67], v[240:247], v0
v_smfmac_f32_16x16x64_bf16 v[28:31], v[72:75], a[0:7], v0
v_add_f32 v24, v24, v26
v_add_f32 v25, v25, v27
v_cvt_pk_bf16_f32 v23, v24, v25
s_waitcnt lgkmcnt(0)
v_smfmac_f32_16x16x64_bf16 v[28:31], v[68:71], v[44:51], v0
ds_write_b64 v3, v[22:23] offset:11776
v_smfmac_f32_16x16x64_bf16 v[28:31], v[76:79], a[32:39], v0
ds_read_b128 v[44:47], v2 offset:14336
v_smfmac_f32_16x16x64_bf16 v[28:31], v[60:63], a[16:23], v0
ds_read_b128 v[48:51], v2 offset:15360
v_smfmac_f32_16x16x64_bf16 v[32:35], v[64:67], v[248:255], v0
s_waitcnt lgkmcnt(2)
s_barrier
ds_read_b64_tr_b16 v[20:21], v4 offset:10240
ds_read_b64_tr_b16 v[22:23], v4 offset:10752
v_smfmac_f32_16x16x64_bf16 v[32:35], v[72:75], a[8:15], v0
ds_read_b64_tr_b16 v[24:25], v4 offset:11264
v_add_f32 v28, v28, v30
v_smfmac_f32_16x16x64_bf16 v[32:35], v[76:79], a[40:47], v0
ds_read_b64_tr_b16 v[26:27], v4 offset:11776
v_add_f32 v29, v29, v31
s_waitcnt lgkmcnt(4)
v_smfmac_f32_16x16x64_bf16 v[32:35], v[68:71], v[44:51], v0
ds_read_b128 v[44:47], v2 offset:18432
v_cvt_pk_bf16_f32 v30, v28, v29
v_smfmac_f32_16x16x64_bf16 v[32:35], v[60:63], a[24:31], v0
ds_read_b128 v[48:51], v2 offset:19456
s_waitcnt lgkmcnt(4)
v_mfma_f32_16x16x32_bf16 v[12:15], v[12:15], v[20:23], 0
s_waitcnt lgkmcnt(2)
v_mfma_f32_16x16x32_bf16 v[12:15], v[16:19], v[24:27], v[12:15]
v_add_f32 v32, v32, v34
v_add_f32 v33, v33, v35
v_cvt_pk_bf16_f32 v31, v32, v33
ds_write_b64 v3, v[30:31] offset:13824
v_smfmac_f32_16x16x64_bf16 v[36:39], v[64:67], a[112:119], v0
s_nop 2
v_add_f32_dpp v12, v14, v12 quad_perm:[2,3,0,1] row_mask:0xf bank_mask:0xf
v_add_f32_dpp v13, v15, v13 quad_perm:[2,3,0,1] row_mask:0xf bank_mask:0xf
ds_write_b64 v5, v[12:13] offset:15104
v_smfmac_f32_16x16x64_bf16 v[40:43], v[64:67], a[120:127], v0
s_waitcnt lgkmcnt(1)
s_barrier
ds_read_b64_tr_b16 v[64:65], v4 offset:12288
ds_read_b64_tr_b16 v[66:67], v4 offset:12800
v_smfmac_f32_16x16x64_bf16 v[36:39], v[68:71], a[128:135], v0
ds_read_b64_tr_b16 v[16:17], v4 offset:13312
ds_read_b64_tr_b16 v[18:19], v4 offset:13824
v_smfmac_f32_16x16x64_bf16 v[40:43], v[68:71], a[136:143], v0
s_waitcnt lgkmcnt(4)
s_barrier
ds_read_b128 v[68:71], v1 offset:14336
v_smfmac_f32_16x16x64_bf16 v[40:43], v[60:63], v[44:51], v0
ds_read_b128 v[44:47], v2 offset:16384
s_waitcnt lgkmcnt(4)
v_mfma_f32_16x16x32_bf16 v[64:67], v[64:67], v[20:23], 0
ds_read_b128 v[48:51], v2 offset:17408
s_waitcnt lgkmcnt(3)
v_mfma_f32_16x16x32_bf16 v[64:67], v[16:19], v[24:27], v[64:67]
v_smfmac_f32_16x16x64_bf16 v[40:43], v[72:75], a[152:159], v0
ds_read_b128 v[12:15], v2 offset:22528
s_waitcnt lgkmcnt(3)
v_max3_f32 v25, v68, v69, v70
v_smfmac_f32_16x16x64_bf16 v[40:43], v[76:79], a[168:175], v0
ds_read_b128 v[16:19], v2 offset:23552
v_add_f32_dpp v64, v66, v64 quad_perm:[2,3,0,1] row_mask:0xf bank_mask:0xf
v_add_f32_dpp v65, v67, v65 quad_perm:[2,3,0,1] row_mask:0xf bank_mask:0xf
v_max_f32 v25, v25, v71
v_max_f32 v24, v64, v65
v_mul_f32 v24, s50, v24
v_max_f32_dpp v25, v25, v25 quad_perm:[2,3,0,1] row_mask:0xf bank_mask:0xf
v_smfmac_f32_16x16x64_bf16 v[36:39], v[72:75], a[144:151], v0
s_nop 0
v_max_f32_dpp v26, v24, v25 quad_perm:[0,1,0,1] row_mask:0xf bank_mask:0xf
v_max_f32_dpp v27, v24, v25 quad_perm:[0,1,0,1] row_mask:0xf bank_mask:0xf
v_smfmac_f32_16x16x64_bf16 v[36:39], v[76:79], a[160:167], v0
s_nop 0
v_permlane16_swap_b32 v26, v27
v_max_f32 v28, v26, v27
v_max_f32 v29, v26, v27
s_waitcnt lgkmcnt(2)
v_smfmac_f32_16x16x64_bf16 v[36:39], v[60:63], v[44:51], v0
v_permlane32_swap_b32 v28, v29
v_max_f32 v28, v28, v29
v_sub_f32 v68, v68, v28
v_sub_f32 v69, v69, v28
v_sub_f32 v70, v70, v28
v_sub_f32 v71, v71, v28
v_exp_f32 v68, v68
v_exp_f32 v69, v69
v_exp_f32 v70, v70
v_exp_f32 v71, v71
v_cvt_pk_bf16_f32 v20, v68, v69
v_cvt_pk_bf16_f32 v21, v70, v71
v_pk_add_f32 v[36:37], v[36:37], v[38:39]
v_mov_b32_dpp v22, v20 quad_perm:[2,3,0,1] row_mask:0xf bank_mask:0xf
v_mov_b32_dpp v23, v21 quad_perm:[2,3,0,1] row_mask:0xf bank_mask:0xf
v_pk_fma_f32 v[64:65], v[64:65], s[50:51], v[28:29] op_sel_hi:[1,1,0] neg_lo:[0,0,1] neg_hi:[0,0,1]
v_cvt_pk_bf16_f32 v32, v36, v37
v_pk_add_f32 v[40:41], v[40:41], v[42:43]
v_mfma_f32_16x16x32_bf16 v[36:39], v[52:55], v[20:23], 0
v_mov_b64 v[72:73], s[52:53]
v_mov_b64 v[74:75], s[52:53]
v_cvt_pk_bf16_f32 v33, v40, v41
v_exp_f32 v64, v64
v_mfma_f32_16x16x32_bf16 v[68:71], v[72:75], v[20:23], 0
v_exp_f32 v65, v65
v_mov_b32 v25, 0
v_cvt_pk_bf16_f32 v24, v64, v65
v_mfma_f32_16x16x32_bf16 v[40:43], v[56:59], v[20:23], 0
v_cvt_pk_bf16_f32 v27, v64, v65
v_mov_b32 v26, 0
v_mfma_f32_16x16x16_bf16 v[68:71], v[72:73], v[24:25], v[68:71]
ds_read_b128 v[44:47], v2 offset:20480
v_mfma_f32_16x16x16_bf16 v[36:39], v[32:33], v[24:25], v[36:39]
ds_read_b128 v[48:51], v2 offset:21504
v_mfma_f32_16x16x16_bf16 v[40:43], v[32:33], v[26:27], v[40:43]
v_rcp_f32 v68, v68
v_mov_b64 v[76:77], 0
v_mov_b64 v[78:79], 0
s_nop 0
v_mul_f32 v36, v36, v68
v_mul_f32 v37, v37, v68
v_mul_f32 v38, v38, v68
v_mul_f32 v39, v39, v68
v_pk_mul_f32 v[40:41], v[40:41], v[68:69] op_sel_hi:[1,0]
v_pk_mul_f32 v[42:43], v[42:43], v[68:69] op_sel_hi:[1,0]
v_cvt_pk_bf16_f32 v36, v36, v37
v_cvt_pk_bf16_f32 v37, v38, v39
v_cvt_pk_bf16_f32 v38, v40, v41
v_cvt_pk_bf16_f32 v39, v42, v43
ds_write_b128 v1, v[36:39] offset:8192
ds_read_b128 v[60:63], v7 offset:8192
buffer_store_dwordx4 v[30:33], v1, s[4:7], s40 offen sc0 sc1
ds_read_b128 v[52:55], v2 offset:24576
ds_read_b128 v[56:59], v2 offset:25600
s_cmp_eq_u32 s34, s100
v_mov_b64 v[20:21], 0
v_mov_b64 v[22:23], 0
s_cbranch_scc1 L_ev_w3rs
L_evb_w3rs:
s_waitcnt lgkmcnt(3)
s_barrier
ds_read_b128 v[64:67], v7 offset:5120
ds_read_b128 v[68:71], v7 offset:6144
ds_read_b128 v[72:75], v7 offset:7168
s_waitcnt lgkmcnt(5)
v_smfmac_f32_16x16x64_bf16 v[76:79], v[60:63], v[44:51], v0 abid:1
ds_read_b128 v[44:47], v2 offset:26624
v_mov_b64 v[24:25], 0
v_smfmac_f32_16x16x64_bf16 v[20:23], v[60:63], v[12:19], v0 abid:1
ds_read_b128 v[48:51], v2 offset:27648
v_mov_b64 v[26:27], 0
s_waitcnt lgkmcnt(4)
v_smfmac_f32_16x16x64_bf16 v[76:79], v[64:67], a[176:183], v0 abid:1
ds_read_b128 v[12:15], v2 offset:28672
v_mov_b64 v[40:41], 0
s_waitcnt lgkmcnt(4)
v_smfmac_f32_16x16x64_bf16 v[76:79], v[68:71], v[52:59], v0 abid:1
ds_read_b128 v[16:19], v2 offset:29696
v_mov_b64 v[42:43], 0
s_waitcnt lgkmcnt(4)
v_smfmac_f32_16x16x64_bf16 v[76:79], v[72:75], a[184:191], v0 abid:1
ds_read_b128 v[52:55], v2 offset:30720
v_smfmac_f32_16x16x64_bf16 v[20:23], v[64:67], a[192:199], v0 abid:1
ds_read_b128 v[56:59], v2 offset:31744
v_smfmac_f32_16x16x64_bf16 v[20:23], v[68:71], a[200:207], v0 abid:1
v_cvt_pk_bf16_f32 v76, v76, v77
v_cvt_pk_bf16_f32 v77, v78, v79
v_bfi_b32 v76, 1, s35, v76
buffer_store_dwordx2 v[76:77], v8, s[4:7], s42 offen sc0 sc1
v_smfmac_f32_16x16x64_bf16 v[20:23], v[72:75], a[208:215], v0 abid:1
s_waitcnt lgkmcnt(4)
v_smfmac_f32_16x16x64_bf16 v[24:27], v[60:63], v[44:51], v0 abid:1
v_smfmac_f32_16x16x64_bf16 v[24:27], v[64:67], a[216:223], v0 abid:1
v_cvt_pk_bf16_f32 v20, v20, v21
v_cvt_pk_bf16_f32 v21, v22, v23
v_bfi_b32 v20, 1, s35, v20
buffer_store_dwordx2 v[20:21], v8, s[4:7], s43 offen sc0 sc1
v_smfmac_f32_16x16x64_bf16 v[24:27], v[68:71], a[224:231], v0 abid:1
s_waitcnt lgkmcnt(2)
v_smfmac_f32_16x16x64_bf16 v[24:27], v[72:75], v[12:19], v0 abid:1
v_smfmac_f32_16x16x64_bf16 v[40:43], v[60:63], a[232:239], v0 abid:1
v_smfmac_f32_16x16x64_bf16 v[40:43], v[64:67], a[240:247], v0 abid:1
v_cvt_pk_bf16_f32 v24, v24, v25
s_waitcnt lgkmcnt(0)
v_smfmac_f32_16x16x64_bf16 v[40:43], v[68:71], v[52:59], v0 abid:1
v_cvt_pk_bf16_f32 v25, v26, v27
v_smfmac_f32_16x16x64_bf16 v[40:43], v[72:75], a[248:255], v0 abid:1
v_bfi_b32 v24, 1, s35, v24
buffer_store_dwordx2 v[24:25], v8, s[4:7], s44 offen sc0 sc1
s_nop 5
v_cvt_pk_bf16_f32 v40, v40, v41
v_cvt_pk_bf16_f32 v41, v42, v43
v_bfi_b32 v40, 1, s35, v40
buffer_store_dwordx2 v[40:41], v8, s[4:7], s45 offen sc0 sc1
s_add_u32 s34, s34, 1
s_add_u32 s37, s37, 524288
s_add_u32 s39, s39, 524288
v_and_b32 v6, 0x70, v1
ds_read_b128 v[76:79], v6 offset:256
v_mov_b64 v[20:21], 0
v_mov_b64 v[22:23], 0
v_mov_b64 v[24:25], 0
v_mov_b64 v[26:27], 0
v_mov_b64 v[28:29], 0
v_mov_b64 v[34:35], 0
v_mov_b64 v[36:37], 0
v_mov_b64 v[38:39], 0
v_mov_b64 v[40:41], 0
v_mov_b64 v[42:43], 0
s_waitcnt vmcnt(0)
buffer_load_dwordx4 v[44:47], v9, s[4:7], s3 offen offset:0 sc0 sc1
buffer_load_dwordx4 v[48:51], v9, s[4:7], s3 offen offset:1024 sc0 sc1
buffer_load_dwordx4 v[52:55], v9, s[4:7], s3 offen offset:2048 sc0 sc1
buffer_load_dwordx4 v[56:59], v9, s[4:7], s3 offen offset:3072 sc0 sc1
s_waitcnt lgkmcnt(0)
s_waitcnt vmcnt(3)
L_r_w3rs:
v_mfma_f32_16x16x32_bf16 v[72:75], v[44:47], v[76:79], 0
s_waitcnt vmcnt(2)
v_mfma_f32_16x16x32_bf16 v[72:75], v[48:51], v[76:79], v[72:75]
v_bitop3_b32 v68, v44, v48, s35 bitop3:0x7e
s_waitcnt vmcnt(1)
v_mfma_f32_16x16x32_bf16 v[72:75], v[52:55], v[76:79], v[72:75]
s_waitcnt vmcnt(0)
v_mfma_f32_16x16x32_bf16 v[72:75], v[56:59], v[76:79], v[72:75]
v_bitop3_b32 v69, v52, v56, s35 bitop3:0x7e
v_bitop3_b32 v68, v68, v69, 1 bitop3:0xa8
v_cmp_ne_u32 vcc, 0, v68
s_cbranch_vccnz L_rr_w3rs
ds_read_b128 v[44:47], v2 offset:0
ds_read_b128 v[48:51], v2 offset:1024
s_nop 1
v_pk_add_f32 v[72:73], v[72:73], v[74:75]
v_cvt_pk_bf16_f32 v68, v72, v73
v_bfi_b32 v68, v11, s36, v68
buffer_store_dword v68, v10, s[4:7], 0 offen sc0 sc1
s_not_b32 s35, s35
s_not_b32 s36, s36
v_lshrrev_b32 v6, 2, v1
s_barrier
buffer_load_dwordx4 v[60:63], v1, s[4:7], s47 offen sc0 sc1
buffer_load_dwordx4 v[68:71], v1, s[4:7], s38 offen sc0 sc1
s_add_u32 s40, s40, 131072
v_mov_b64 v[30:31], 0
v_mov_b64 v[32:33], 0
buffer_load_dwordx4 v[12:15], v9, s[4:7], s37 offen offset:0
buffer_load_dwordx4 v[16:19], v9, s[4:7], s37 offen offset:1024
buffer_load_dwordx4 v[52:55], v1, s[4:7], s37 offen offset:2048
buffer_load_dwordx4 v[56:59], v1, s[4:7], s37 offen offset:3072
s_branch L_top_w3rs
L_done_w3rs:
s_waitcnt vmcnt(0)
s_barrier
s_waitcnt vmcnt(0) lgkmcnt(0)
s_endpgm
L_ra0_w3rs:
buffer_load_dwordx4 v[60:63], v1, s[4:7], s47 offen sc0 sc1
buffer_load_dwordx4 v[68:71], v1, s[4:7], s38 offen sc0 sc1
s_sub_u32 s41, s41, 1
s_cbranch_scc1 L_exit
ds_read_b128 v[44:47], v2 offset:0
ds_read_b128 v[48:51], v2 offset:1024
s_waitcnt vmcnt(0) lgkmcnt(0)
v_mov_b64 v[20:21], 0
v_mov_b64 v[22:23], 0
v_mov_b64 v[24:25], 0
v_mov_b64 v[26:27], 0
v_mov_b64 v[28:29], 0
v_mov_b64 v[30:31], 0
v_mov_b64 v[32:33], 0
v_mov_b64 v[34:35], 0
v_mov_b64 v[36:37], 0
v_mov_b64 v[38:39], 0
v_mov_b64 v[40:41], 0
v_mov_b64 v[42:43], 0
s_nop 0
s_branch L_a0_w3rs
L_ra1_w3rs:
buffer_load_dwordx4 v[64:67], v1, s[4:7], s48 offen sc0 sc1
buffer_load_dword v76, v6, s[4:7], s49 offen sc0 sc1
s_sub_u32 s41, s41, 1
s_cbranch_scc1 L_exit
s_waitcnt vmcnt(0)
v_bitop3_b32 v77, v64, s35, 1 bitop3:0x28
v_bitop3_b32 v78, v76, s35, v11 bitop3:0x28
v_or_b32 v77, v77, v78
v_cmp_ne_u32 vcc, 0, v77
s_cbranch_vccnz L_ra1_w3rs
ds_write_b128 v1, v[64:67] offset:8192
ds_write_addtid_b32 v76 offset:9984
s_waitcnt lgkmcnt(0)
s_branch L_a1_w3rs
L_ev_w3rs:
s_cmp_eq_u32 s34, 63
s_cbranch_scc1 L_done_w3rs
s_mov_b32 s100, 63

s_lshl_b32 s55, s32, 2
v_mov_b32 v34, 0
L_kvw_w3rs:
buffer_load_dword v29, v34, s[28:31], s55 offen offset:128 sc0 sc1
s_sub_u32 s41, s41, 1
s_cbranch_scc1 L_exit
s_waitcnt vmcnt(0)
v_readfirstlane_b32 s54, v29
s_nop 0
s_and_b32 s54, s54, 65280
s_cmp_lg_u32 s54, 1024
s_cbranch_scc1 L_kvw_w3rs
s_branch L_evb_w3rs
L_rr_w3rs:
buffer_load_dwordx4 v[44:47], v9, s[4:7], s3 offen offset:0 sc0 sc1
buffer_load_dwordx4 v[48:51], v9, s[4:7], s3 offen offset:1024 sc0 sc1
buffer_load_dwordx4 v[52:55], v9, s[4:7], s3 offen offset:2048 sc0 sc1
buffer_load_dwordx4 v[56:59], v9, s[4:7], s3 offen offset:3072 sc0 sc1
s_sub_u32 s41, s41, 1
s_cbranch_scc1 L_exit
s_waitcnt vmcnt(0)
s_branch L_r_w3rs
s_endpgm

.section .rodata,"a"
.p2align 6
.amdhsa_kernel gated_mix__sliding_local_dilated__memory_aug_recurrent_mem_tr__prompt_kernel
  .amdhsa_next_free_vgpr 512
  .amdhsa_next_free_sgpr 102
  .amdhsa_accum_offset 256
  .amdhsa_group_segment_fixed_size 0
  .amdhsa_kernarg_size 112
  .amdhsa_user_sgpr_count 2
  .amdhsa_user_sgpr_kernarg_segment_ptr 1
  .amdhsa_system_sgpr_workgroup_id_x 1
  .amdhsa_float_denorm_mode_32 3
.end_amdhsa_kernel
```

```asm
; @launch grid=(256,1,1) block=(256,1,1) lds=163840
.amdgcn_target "amdgcn-amd-amdhsa--gfx950"
.text
.globl gated_mix__sliding_local_dilated__memory_aug_recurrent_mem_tr__prompt_kernel
.p2align 8
.type gated_mix__sliding_local_dilated__memory_aug_recurrent_mem_tr__prompt_kernel,@function
gated_mix__sliding_local_dilated__memory_aug_recurrent_mem_tr__prompt_kernel:

s_cmp_ge_u32 s2, 256
s_cbranch_scc1 L_exit_w
s_and_b32 s3, s2, 7
s_lshr_b32 s32, s2, 3
s_cmp_eq_u32 s3, 0
s_cbranch_scc1 L_role_chain
s_cmp_ge_u32 s3, 5
s_cbranch_scc1 L_pre_aw
s_lshr_b32 s33, s32, 3
s_and_b32 s32, s32, 7
s_sub_u32 s3, s3, 1
s_lshl_b32 s3, s3, 3
s_add_u32 s32, s32, s3
s_branch L_role_q
L_pre_aw:
s_sub_u32 s3, s3, 5
s_lshl_b32 s49, s3, 5
s_add_u32 s49, s49, s32
s_lshr_b32 s33, s49, 3
s_and_b32 s32, s32, 7
s_mul_i32 s48, s49, 43
s_lshr_b32 s48, s48, 9
s_mul_i32 s3, s48, 12
s_sub_u32 s49, s49, s3
s_branch L_role_aw
L_exit_w:
s_endpgm
L_role_q:
s_load_dwordx2 s[4:5], s[0:1], 104
s_mov_b32 s6, 268435456
s_mov_b32 s7, 0x20000
s_load_dwordx2 s[8:9], s[0:1], 0
s_mov_b32 s10, 2359296
s_mov_b32 s11, 0x20000
s_load_dwordx2 s[12:13], s[0:1], 40
s_mov_b32 s14, 4718592
s_mov_b32 s15, 0x20000
s_load_dwordx2 s[16:17], s[0:1], 48
s_mov_b32 s18, 4718592
s_mov_b32 s19, 0x20000
s_load_dwordx2 s[20:21], s[0:1], 56
s_mov_b32 s22, 4718592
s_mov_b32 s23, 0x20000
s_load_dwordx2 s[24:25], s[0:1], 96
s_mov_b32 s26, 256
s_mov_b32 s27, 0x20000
v_and_b32 v9, 63, v0
v_and_b32 v10, 15, v0
v_bfe_u32 v11, v0, 4, 2
v_lshrrev_b32 v1, 6, v0
s_nop 0
v_readfirstlane_b32 s34, v1
v_lshrrev_b32 v12, 2, v9
v_mul_u32_u24 v2, 1152, v12
v_lshrrev_b32 v12, 5, v9
v_lshlrev_b32 v12, 1, v12
v_and_b32 v13, 3, v9
v_xor_b32 v12, v12, v13
v_lshl_add_u32 v2, v12, 4, v2
v_lshrrev_b32 v12, 3, v10
v_lshlrev_b32 v12, 1, v12
v_xor_b32 v12, v12, v11
v_lshlrev_b32 v12, 4, v12
v_lshl_add_u32 v3, v10, 6, v12
v_lshrrev_b32 v12, 2, v10
v_lshl_add_u32 v12, v11, 3, v12
v_mul_u32_u24 v7, 64, v12
v_and_b32 v12, 3, v10
v_lshl_add_u32 v7, v12, 3, v7
v_lshlrev_b32 v1, 4, v9
s_mul_i32 s38, s34, 20480
s_add_u32 s38, s38, 73728
v_add_u32 v7, s38, v7
v_lshrrev_b32 v12, 2, v9
v_lshlrev_b32 v12, 13, v12
v_and_b32 v13, 3, v9
v_lshl_add_u32 v6, v13, 4, v12
v_and_b32 v13, 1, v9
v_lshl_add_u32 v5, v13, 4, v12
v_bfe_u32 v13, v9, 1, 1
v_lshl_add_u32 v5, v13, 6, v5
s_lshl_b32 s39, s32, 8
s_lshl_b32 s40, s34, 6
s_add_u32 s40, s40, s39
s_lshr_b32 s41, s34, 1
s_lshl_b32 s41, s41, 7
s_add_u32 s39, s39, s41
s_and_b32 s41, s34, 1
s_lshl_b32 s41, s41, 5
s_add_u32 s39, s39, s41
s_lshl_b32 s43, s33, 1
s_and_b32 s41, s34, 1
s_add_u32 s43, s43, s41
s_mul_i32 s43, s43, 18432
s_lshr_b32 s41, s34, 1
s_lshl_b32 s41, s41, 6
s_add_u32 s43, s43, s41
s_lshl_b32 s44, s34, 10
s_mov_b32 s36, 400000
s_mov_b32 s46, 0x3e0293ee
s_mov_b32 s47, 0x3e0293ee
v_mov_b32 v8, 0
v_lshrrev_b32 v12, 2, v10
v_lshlrev_b32 v4, 12, v12
v_lshl_add_u32 v4, v11, 8, v4
v_and_b32 v12, 3, v10
v_lshl_add_u32 v4, v12, 4, v4
s_waitcnt lgkmcnt(0)
s_add_u32 s37, s39, 0
s_add_u32 m0, s38, 0
s_nop 0
buffer_load_dwordx4 v5, s[12:15], s37 offen lds
s_add_u32 s37, s39, 131072
s_add_u32 m0, s38, 1024
s_nop 0
buffer_load_dwordx4 v5, s[12:15], s37 offen lds
s_add_u32 s37, s39, 262144
s_add_u32 m0, s38, 2048
s_nop 0
buffer_load_dwordx4 v5, s[12:15], s37 offen lds
s_add_u32 s37, s39, 393216
s_add_u32 m0, s38, 3072
s_nop 0
buffer_load_dwordx4 v5, s[12:15], s37 offen lds
s_add_u32 s37, s39, 524288
s_add_u32 m0, s38, 4096
s_nop 0
buffer_load_dwordx4 v5, s[12:15], s37 offen lds
s_add_u32 s37, s39, 655360
s_add_u32 m0, s38, 5120
s_nop 0
buffer_load_dwordx4 v5, s[12:15], s37 offen lds
s_add_u32 s37, s39, 786432
s_add_u32 m0, s38, 6144
s_nop 0
buffer_load_dwordx4 v5, s[12:15], s37 offen lds
s_add_u32 s37, s39, 917504
s_add_u32 m0, s38, 7168
s_nop 0
buffer_load_dwordx4 v5, s[12:15], s37 offen lds
s_add_u32 s37, s39, 1048576
s_add_u32 m0, s38, 8192
s_nop 0
buffer_load_dwordx4 v5, s[12:15], s37 offen lds
s_add_u32 s37, s39, 1179648
s_add_u32 m0, s38, 9216
s_nop 0
buffer_load_dwordx4 v5, s[12:15], s37 offen lds
s_add_u32 s37, s39, 1310720
s_add_u32 m0, s38, 10240
s_nop 0
buffer_load_dwordx4 v5, s[12:15], s37 offen lds
s_add_u32 s37, s39, 1441792
s_add_u32 m0, s38, 11264
s_nop 0
buffer_load_dwordx4 v5, s[12:15], s37 offen lds
s_add_u32 s37, s39, 1572864
s_add_u32 m0, s38, 12288
s_nop 0
buffer_load_dwordx4 v5, s[12:15], s37 offen lds
s_add_u32 s37, s39, 1703936
s_add_u32 m0, s38, 13312
s_nop 0
buffer_load_dwordx4 v5, s[12:15], s37 offen lds
s_add_u32 s37, s39, 1835008
s_add_u32 m0, s38, 14336
s_nop 0
buffer_load_dwordx4 v5, s[12:15], s37 offen lds
s_add_u32 s37, s39, 1966080
s_add_u32 m0, s38, 15360
s_nop 0
buffer_load_dwordx4 v5, s[12:15], s37 offen lds
s_add_u32 s37, s43, 0
s_add_u32 m0, s44, 0
s_nop 0
buffer_load_dwordx4 v2, s[8:11], s37 offen lds
s_add_u32 s37, s43, 128
s_add_u32 m0, s44, 4096
s_nop 0
buffer_load_dwordx4 v2, s[8:11], s37 offen lds
s_add_u32 s37, s43, 256
s_add_u32 m0, s44, 8192
s_nop 0
buffer_load_dwordx4 v2, s[8:11], s37 offen lds
s_add_u32 s37, s43, 384
s_add_u32 m0, s44, 12288
s_nop 0
buffer_load_dwordx4 v2, s[8:11], s37 offen lds
s_add_u32 s37, s43, 512
s_add_u32 m0, s44, 16384
s_nop 0
buffer_load_dwordx4 v2, s[8:11], s37 offen lds
s_add_u32 s37, s43, 640
s_add_u32 m0, s44, 20480
s_nop 0
buffer_load_dwordx4 v2, s[8:11], s37 offen lds
s_add_u32 s37, s43, 768
s_add_u32 m0, s44, 24576
s_nop 0
buffer_load_dwordx4 v2, s[8:11], s37 offen lds
s_add_u32 s37, s43, 896
s_add_u32 m0, s44, 28672
s_nop 0
buffer_load_dwordx4 v2, s[8:11], s37 offen lds
s_add_u32 s37, s43, 1024
s_add_u32 m0, s44, 32768
s_nop 0
buffer_load_dwordx4 v2, s[8:11], s37 offen lds
s_waitcnt vmcnt(21)
ds_read_b64_tr_b16 v[80:81], v7 offset:0
ds_read_b64_tr_b16 v[82:83], v7 offset:256
ds_read_b64_tr_b16 v[84:85], v7 offset:2048
ds_read_b64_tr_b16 v[86:87], v7 offset:2304
ds_read_b64_tr_b16 v[152:153], v7 offset:32
ds_read_b64_tr_b16 v[154:155], v7 offset:288
ds_read_b64_tr_b16 v[156:157], v7 offset:2080
ds_read_b64_tr_b16 v[158:159], v7 offset:2336
s_waitcnt lgkmcnt(0)
s_add_u32 s37, s39, 2097152
s_add_u32 m0, s38, 16384
s_nop 0
buffer_load_dwordx4 v5, s[12:15], s37 offen lds
s_add_u32 s37, s39, 2228224
s_add_u32 m0, s38, 17408
s_nop 0
buffer_load_dwordx4 v5, s[12:15], s37 offen lds
s_add_u32 s37, s39, 2359296
s_add_u32 m0, s38, 18432
s_nop 0
buffer_load_dwordx4 v5, s[12:15], s37 offen lds
s_add_u32 s37, s39, 2490368
s_add_u32 m0, s38, 19456
s_nop 0
buffer_load_dwordx4 v5, s[12:15], s37 offen lds
s_waitcnt vmcnt(21)
ds_read_b64_tr_b16 v[88:89], v7 offset:4096
ds_read_b64_tr_b16 v[90:91], v7 offset:4352
ds_read_b64_tr_b16 v[92:93], v7 offset:6144
ds_read_b64_tr_b16 v[94:95], v7 offset:6400
ds_read_b64_tr_b16 v[160:161], v7 offset:4128
ds_read_b64_tr_b16 v[162:163], v7 offset:4384
ds_read_b64_tr_b16 v[164:165], v7 offset:6176
ds_read_b64_tr_b16 v[166:167], v7 offset:6432
s_waitcnt lgkmcnt(0)
s_add_u32 s37, s39, 2621440
s_add_u32 m0, s38, 0
s_nop 0
buffer_load_dwordx4 v5, s[12:15], s37 offen lds
s_add_u32 s37, s39, 2752512
s_add_u32 m0, s38, 1024
s_nop 0
buffer_load_dwordx4 v5, s[12:15], s37 offen lds
s_add_u32 s37, s39, 2883584
s_add_u32 m0, s38, 2048
s_nop 0
buffer_load_dwordx4 v5, s[12:15], s37 offen lds
s_add_u32 s37, s39, 3014656
s_add_u32 m0, s38, 3072
s_nop 0
buffer_load_dwordx4 v5, s[12:15], s37 offen lds
s_waitcnt vmcnt(21)
ds_read_b64_tr_b16 v[96:97], v7 offset:8192
ds_read_b64_tr_b16 v[98:99], v7 offset:8448
ds_read_b64_tr_b16 v[100:101], v7 offset:10240
ds_read_b64_tr_b16 v[102:103], v7 offset:10496
ds_read_b64_tr_b16 v[168:169], v7 offset:8224
ds_read_b64_tr_b16 v[170:171], v7 offset:8480
ds_read_b64_tr_b16 v[172:173], v7 offset:10272
ds_read_b64_tr_b16 v[174:175], v7 offset:10528
s_waitcnt lgkmcnt(0)
s_add_u32 s37, s39, 3145728
s_add_u32 m0, s38, 4096
s_nop 0
buffer_load_dwordx4 v5, s[12:15], s37 offen lds
s_add_u32 s37, s39, 3276800
s_add_u32 m0, s38, 5120
s_nop 0
buffer_load_dwordx4 v5, s[12:15], s37 offen lds
s_add_u32 s37, s39, 3407872
s_add_u32 m0, s38, 6144
s_nop 0
buffer_load_dwordx4 v5, s[12:15], s37 offen lds
s_add_u32 s37, s39, 3538944
s_add_u32 m0, s38, 7168
s_nop 0
buffer_load_dwordx4 v5, s[12:15], s37 offen lds
s_waitcnt vmcnt(21)
ds_read_b64_tr_b16 v[104:105], v7 offset:12288
ds_read_b64_tr_b16 v[106:107], v7 offset:12544
ds_read_b64_tr_b16 v[108:109], v7 offset:14336
ds_read_b64_tr_b16 v[110:111], v7 offset:14592
ds_read_b64_tr_b16 v[176:177], v7 offset:12320
ds_read_b64_tr_b16 v[178:179], v7 offset:12576
ds_read_b64_tr_b16 v[180:181], v7 offset:14368
ds_read_b64_tr_b16 v[182:183], v7 offset:14624
s_waitcnt lgkmcnt(0)
s_add_u32 s37, s39, 3670016
s_add_u32 m0, s38, 8192
s_nop 0
buffer_load_dwordx4 v5, s[12:15], s37 offen lds
s_add_u32 s37, s39, 3801088
s_add_u32 m0, s38, 9216
s_nop 0
buffer_load_dwordx4 v5, s[12:15], s37 offen lds
s_add_u32 s37, s39, 3932160
s_add_u32 m0, s38, 10240
s_nop 0
buffer_load_dwordx4 v5, s[12:15], s37 offen lds
s_add_u32 s37, s39, 4063232
s_add_u32 m0, s38, 11264
s_nop 0
buffer_load_dwordx4 v5, s[12:15], s37 offen lds
s_waitcnt vmcnt(12)
ds_read_b64_tr_b16 v[112:113], v7 offset:16384
ds_read_b64_tr_b16 v[114:115], v7 offset:16640
ds_read_b64_tr_b16 v[116:117], v7 offset:18432
ds_read_b64_tr_b16 v[118:119], v7 offset:18688
ds_read_b64_tr_b16 v[184:185], v7 offset:16416
ds_read_b64_tr_b16 v[186:187], v7 offset:16672
ds_read_b64_tr_b16 v[188:189], v7 offset:18464
ds_read_b64_tr_b16 v[190:191], v7 offset:18720
s_waitcnt lgkmcnt(0)
s_add_u32 s37, s39, 4194304
s_add_u32 m0, s38, 12288
s_nop 0
buffer_load_dwordx4 v5, s[12:15], s37 offen lds
s_add_u32 s37, s39, 4325376
s_add_u32 m0, s38, 13312
s_nop 0
buffer_load_dwordx4 v5, s[12:15], s37 offen lds
s_add_u32 s37, s39, 4456448
s_add_u32 m0, s38, 14336
s_nop 0
buffer_load_dwordx4 v5, s[12:15], s37 offen lds
s_add_u32 s37, s39, 4587520
s_add_u32 m0, s38, 15360
s_nop 0
buffer_load_dwordx4 v5, s[12:15], s37 offen lds
s_waitcnt vmcnt(12)
ds_read_b64_tr_b16 v[120:121], v7 offset:0
ds_read_b64_tr_b16 v[122:123], v7 offset:256
ds_read_b64_tr_b16 v[124:125], v7 offset:2048
ds_read_b64_tr_b16 v[126:127], v7 offset:2304
ds_read_b64_tr_b16 v[192:193], v7 offset:32
ds_read_b64_tr_b16 v[194:195], v7 offset:288
ds_read_b64_tr_b16 v[196:197], v7 offset:2080
ds_read_b64_tr_b16 v[198:199], v7 offset:2336
s_waitcnt lgkmcnt(0)
s_add_u32 s37, s39, 0
s_add_u32 m0, s38, 16384
s_nop 0
buffer_load_dwordx4 v5, s[16:19], s37 offen lds
s_add_u32 s37, s39, 131072
s_add_u32 m0, s38, 17408
s_nop 0
buffer_load_dwordx4 v5, s[16:19], s37 offen lds
s_add_u32 s37, s39, 262144
s_add_u32 m0, s38, 18432
s_nop 0
buffer_load_dwordx4 v5, s[16:19], s37 offen lds
s_add_u32 s37, s39, 393216
s_add_u32 m0, s38, 19456
s_nop 0
buffer_load_dwordx4 v5, s[16:19], s37 offen lds
s_waitcnt vmcnt(12)
ds_read_b64_tr_b16 v[128:129], v7 offset:4096
ds_read_b64_tr_b16 v[130:131], v7 offset:4352
ds_read_b64_tr_b16 v[132:133], v7 offset:6144
ds_read_b64_tr_b16 v[134:135], v7 offset:6400
ds_read_b64_tr_b16 v[200:201], v7 offset:4128
ds_read_b64_tr_b16 v[202:203], v7 offset:4384
ds_read_b64_tr_b16 v[204:205], v7 offset:6176
ds_read_b64_tr_b16 v[206:207], v7 offset:6432
s_waitcnt lgkmcnt(0)
s_add_u32 s37, s39, 524288
s_add_u32 m0, s38, 0
s_nop 0
buffer_load_dwordx4 v5, s[16:19], s37 offen lds
s_add_u32 s37, s39, 655360
s_add_u32 m0, s38, 1024
s_nop 0
buffer_load_dwordx4 v5, s[16:19], s37 offen lds
s_add_u32 s37, s39, 786432
s_add_u32 m0, s38, 2048
s_nop 0
buffer_load_dwordx4 v5, s[16:19], s37 offen lds
s_add_u32 s37, s39, 917504
s_add_u32 m0, s38, 3072
s_nop 0
buffer_load_dwordx4 v5, s[16:19], s37 offen lds
s_waitcnt vmcnt(12)
ds_read_b64_tr_b16 v[136:137], v7 offset:8192
ds_read_b64_tr_b16 v[138:139], v7 offset:8448
ds_read_b64_tr_b16 v[140:141], v7 offset:10240
ds_read_b64_tr_b16 v[142:143], v7 offset:10496
ds_read_b64_tr_b16 v[208:209], v7 offset:8224
ds_read_b64_tr_b16 v[210:211], v7 offset:8480
ds_read_b64_tr_b16 v[212:213], v7 offset:10272
ds_read_b64_tr_b16 v[214:215], v7 offset:10528
s_waitcnt lgkmcnt(0)
s_add_u32 s37, s39, 1048576
s_add_u32 m0, s38, 4096
s_nop 0
buffer_load_dwordx4 v5, s[16:19], s37 offen lds
s_add_u32 s37, s39, 1179648
s_add_u32 m0, s38, 5120
s_nop 0
buffer_load_dwordx4 v5, s[16:19], s37 offen lds
s_add_u32 s37, s39, 1310720
s_add_u32 m0, s38, 6144
s_nop 0
buffer_load_dwordx4 v5, s[16:19], s37 offen lds
s_add_u32 s37, s39, 1441792
s_add_u32 m0, s38, 7168
s_nop 0
buffer_load_dwordx4 v5, s[16:19], s37 offen lds
s_waitcnt vmcnt(12)
ds_read_b64_tr_b16 v[144:145], v7 offset:12288
ds_read_b64_tr_b16 v[146:147], v7 offset:12544
ds_read_b64_tr_b16 v[148:149], v7 offset:14336
ds_read_b64_tr_b16 v[150:151], v7 offset:14592
ds_read_b64_tr_b16 v[216:217], v7 offset:12320
ds_read_b64_tr_b16 v[218:219], v7 offset:12576
ds_read_b64_tr_b16 v[220:221], v7 offset:14368
ds_read_b64_tr_b16 v[222:223], v7 offset:14624
s_waitcnt lgkmcnt(0)
s_add_u32 s37, s39, 1572864
s_add_u32 m0, s38, 8192
s_nop 0
buffer_load_dwordx4 v5, s[16:19], s37 offen lds
s_add_u32 s37, s39, 1703936
s_add_u32 m0, s38, 9216
s_nop 0
buffer_load_dwordx4 v5, s[16:19], s37 offen lds
s_add_u32 s37, s39, 1835008
s_add_u32 m0, s38, 10240
s_nop 0
buffer_load_dwordx4 v5, s[16:19], s37 offen lds
s_add_u32 s37, s39, 1966080
s_add_u32 m0, s38, 11264
s_nop 0
buffer_load_dwordx4 v5, s[16:19], s37 offen lds
s_waitcnt vmcnt(12)
ds_read_b64_tr_b16 v[224:225], v7 offset:16384
ds_read_b64_tr_b16 v[226:227], v7 offset:16640
ds_read_b64_tr_b16 v[228:229], v7 offset:18432
ds_read_b64_tr_b16 v[230:231], v7 offset:18688
ds_read_b64_tr_b16 a[40:41], v7 offset:16416
ds_read_b64_tr_b16 a[42:43], v7 offset:16672
ds_read_b64_tr_b16 a[44:45], v7 offset:18464
ds_read_b64_tr_b16 a[46:47], v7 offset:18720
s_waitcnt lgkmcnt(0)
s_add_u32 s37, s39, 2097152
s_add_u32 m0, s38, 12288
s_nop 0
buffer_load_dwordx4 v5, s[16:19], s37 offen lds
s_add_u32 s37, s39, 2228224
s_add_u32 m0, s38, 13312
s_nop 0
buffer_load_dwordx4 v5, s[16:19], s37 offen lds
s_add_u32 s37, s39, 2359296
s_add_u32 m0, s38, 14336
s_nop 0
buffer_load_dwordx4 v5, s[16:19], s37 offen lds
s_add_u32 s37, s39, 2490368
s_add_u32 m0, s38, 15360
s_nop 0
buffer_load_dwordx4 v5, s[16:19], s37 offen lds
s_waitcnt vmcnt(12)
ds_read_b64_tr_b16 v[232:233], v7 offset:0
ds_read_b64_tr_b16 v[234:235], v7 offset:256
ds_read_b64_tr_b16 v[236:237], v7 offset:2048
ds_read_b64_tr_b16 v[238:239], v7 offset:2304
ds_read_b64_tr_b16 a[48:49], v7 offset:32
ds_read_b64_tr_b16 a[50:51], v7 offset:288
ds_read_b64_tr_b16 a[52:53], v7 offset:2080
ds_read_b64_tr_b16 a[54:55], v7 offset:2336
s_waitcnt lgkmcnt(0)
s_add_u32 s37, s39, 2621440
s_add_u32 m0, s38, 16384
s_nop 0
buffer_load_dwordx4 v5, s[16:19], s37 offen lds
s_add_u32 s37, s39, 2752512
s_add_u32 m0, s38, 17408
s_nop 0
buffer_load_dwordx4 v5, s[16:19], s37 offen lds
s_add_u32 s37, s39, 2883584
s_add_u32 m0, s38, 18432
s_nop 0
buffer_load_dwordx4 v5, s[16:19], s37 offen lds
s_add_u32 s37, s39, 3014656
s_add_u32 m0, s38, 19456
s_nop 0
buffer_load_dwordx4 v5, s[16:19], s37 offen lds
s_waitcnt vmcnt(12)
ds_read_b64_tr_b16 v[240:241], v7 offset:4096
ds_read_b64_tr_b16 v[242:243], v7 offset:4352
ds_read_b64_tr_b16 v[244:245], v7 offset:6144
ds_read_b64_tr_b16 v[246:247], v7 offset:6400
ds_read_b64_tr_b16 a[56:57], v7 offset:4128
ds_read_b64_tr_b16 a[58:59], v7 offset:4384
ds_read_b64_tr_b16 a[60:61], v7 offset:6176
ds_read_b64_tr_b16 a[62:63], v7 offset:6432
s_waitcnt lgkmcnt(0)
s_add_u32 s37, s39, 3145728
s_add_u32 m0, s38, 0
s_nop 0
buffer_load_dwordx4 v5, s[16:19], s37 offen lds
s_add_u32 s37, s39, 3276800
s_add_u32 m0, s38, 1024
s_nop 0
buffer_load_dwordx4 v5, s[16:19], s37 offen lds
s_add_u32 s37, s39, 3407872
s_add_u32 m0, s38, 2048
s_nop 0
buffer_load_dwordx4 v5, s[16:19], s37 offen lds
s_add_u32 s37, s39, 3538944
s_add_u32 m0, s38, 3072
s_nop 0
buffer_load_dwordx4 v5, s[16:19], s37 offen lds
s_waitcnt vmcnt(12)
ds_read_b64_tr_b16 v[248:249], v7 offset:8192
ds_read_b64_tr_b16 v[250:251], v7 offset:8448
ds_read_b64_tr_b16 v[252:253], v7 offset:10240
ds_read_b64_tr_b16 v[254:255], v7 offset:10496
ds_read_b64_tr_b16 a[64:65], v7 offset:8224
ds_read_b64_tr_b16 a[66:67], v7 offset:8480
ds_read_b64_tr_b16 a[68:69], v7 offset:10272
ds_read_b64_tr_b16 a[70:71], v7 offset:10528
s_waitcnt lgkmcnt(0)
s_add_u32 s37, s39, 3670016
s_add_u32 m0, s38, 4096
s_nop 0
buffer_load_dwordx4 v5, s[16:19], s37 offen lds
s_add_u32 s37, s39, 3801088
s_add_u32 m0, s38, 5120
s_nop 0
buffer_load_dwordx4 v5, s[16:19], s37 offen lds
s_add_u32 s37, s39, 3932160
s_add_u32 m0, s38, 6144
s_nop 0
buffer_load_dwordx4 v5, s[16:19], s37 offen lds
s_add_u32 s37, s39, 4063232
s_add_u32 m0, s38, 7168
s_nop 0
buffer_load_dwordx4 v5, s[16:19], s37 offen lds
s_waitcnt vmcnt(12)
ds_read_b64_tr_b16 a[0:1], v7 offset:12288
ds_read_b64_tr_b16 a[2:3], v7 offset:12544
ds_read_b64_tr_b16 a[4:5], v7 offset:14336
ds_read_b64_tr_b16 a[6:7], v7 offset:14592
ds_read_b64_tr_b16 a[72:73], v7 offset:12320
ds_read_b64_tr_b16 a[74:75], v7 offset:12576
ds_read_b64_tr_b16 a[76:77], v7 offset:14368
ds_read_b64_tr_b16 a[78:79], v7 offset:14624
s_waitcnt lgkmcnt(0)
s_add_u32 s37, s39, 4194304
s_add_u32 m0, s38, 8192
s_nop 0
buffer_load_dwordx4 v5, s[16:19], s37 offen lds
s_add_u32 s37, s39, 4325376
s_add_u32 m0, s38, 9216
s_nop 0
buffer_load_dwordx4 v5, s[16:19], s37 offen lds
s_add_u32 s37, s39, 4456448
s_add_u32 m0, s38, 10240
s_nop 0
buffer_load_dwordx4 v5, s[16:19], s37 offen lds
s_add_u32 s37, s39, 4587520
s_add_u32 m0, s38, 11264
s_nop 0
buffer_load_dwordx4 v5, s[16:19], s37 offen lds
s_waitcnt vmcnt(12)
ds_read_b64_tr_b16 a[8:9], v7 offset:16384
ds_read_b64_tr_b16 a[10:11], v7 offset:16640
ds_read_b64_tr_b16 a[12:13], v7 offset:18432
ds_read_b64_tr_b16 a[14:15], v7 offset:18688
ds_read_b64_tr_b16 a[80:81], v7 offset:16416
ds_read_b64_tr_b16 a[82:83], v7 offset:16672
ds_read_b64_tr_b16 a[84:85], v7 offset:18464
ds_read_b64_tr_b16 a[86:87], v7 offset:18720
s_waitcnt lgkmcnt(0)
s_add_u32 s37, s40, 0
s_add_u32 m0, s38, 12288
s_nop 0
buffer_load_dwordx4 v6, s[20:23], s37 offen lds
s_add_u32 s37, s40, 131072
s_add_u32 m0, s38, 13312
s_nop 0
buffer_load_dwordx4 v6, s[20:23], s37 offen lds
s_add_u32 s37, s40, 262144
s_add_u32 m0, s38, 14336
s_nop 0
buffer_load_dwordx4 v6, s[20:23], s37 offen lds
s_add_u32 s37, s40, 393216
s_add_u32 m0, s38, 15360
s_nop 0
buffer_load_dwordx4 v6, s[20:23], s37 offen lds
s_waitcnt vmcnt(12)
ds_read_b64_tr_b16 a[16:17], v7 offset:0
ds_read_b64_tr_b16 a[18:19], v7 offset:256
ds_read_b64_tr_b16 a[20:21], v7 offset:2048
ds_read_b64_tr_b16 a[22:23], v7 offset:2304
ds_read_b64_tr_b16 a[88:89], v7 offset:32
ds_read_b64_tr_b16 a[90:91], v7 offset:288
ds_read_b64_tr_b16 a[92:93], v7 offset:2080
ds_read_b64_tr_b16 a[94:95], v7 offset:2336
s_waitcnt lgkmcnt(0)
s_add_u32 s37, s40, 524288
s_add_u32 m0, s38, 16384
s_nop 0
buffer_load_dwordx4 v6, s[20:23], s37 offen lds
s_add_u32 s37, s40, 655360
s_add_u32 m0, s38, 17408
s_nop 0
buffer_load_dwordx4 v6, s[20:23], s37 offen lds
s_add_u32 s37, s40, 786432
s_add_u32 m0, s38, 18432
s_nop 0
buffer_load_dwordx4 v6, s[20:23], s37 offen lds
s_add_u32 s37, s40, 917504
s_add_u32 m0, s38, 19456
s_nop 0
buffer_load_dwordx4 v6, s[20:23], s37 offen lds
s_waitcnt vmcnt(12)
ds_read_b64_tr_b16 a[24:25], v7 offset:4096
ds_read_b64_tr_b16 a[26:27], v7 offset:4352
ds_read_b64_tr_b16 a[28:29], v7 offset:6144
ds_read_b64_tr_b16 a[30:31], v7 offset:6400
ds_read_b64_tr_b16 a[96:97], v7 offset:4128
ds_read_b64_tr_b16 a[98:99], v7 offset:4384
ds_read_b64_tr_b16 a[100:101], v7 offset:6176
ds_read_b64_tr_b16 a[102:103], v7 offset:6432
s_waitcnt lgkmcnt(0)
s_add_u32 s37, s40, 1048576
s_add_u32 m0, s38, 0
s_nop 0
buffer_load_dwordx4 v6, s[20:23], s37 offen lds
s_add_u32 s37, s40, 1179648
s_add_u32 m0, s38, 1024
s_nop 0
buffer_load_dwordx4 v6, s[20:23], s37 offen lds
s_add_u32 s37, s40, 1310720
s_add_u32 m0, s38, 2048
s_nop 0
buffer_load_dwordx4 v6, s[20:23], s37 offen lds
s_add_u32 s37, s40, 1441792
s_add_u32 m0, s38, 3072
s_nop 0
buffer_load_dwordx4 v6, s[20:23], s37 offen lds
s_waitcnt vmcnt(12)
ds_read_b64_tr_b16 a[32:33], v7 offset:8192
ds_read_b64_tr_b16 a[34:35], v7 offset:8448
ds_read_b64_tr_b16 a[36:37], v7 offset:10240
ds_read_b64_tr_b16 a[38:39], v7 offset:10496
ds_read_b64_tr_b16 a[104:105], v7 offset:8224
ds_read_b64_tr_b16 a[106:107], v7 offset:8480
ds_read_b64_tr_b16 a[108:109], v7 offset:10272
ds_read_b64_tr_b16 a[110:111], v7 offset:10528
s_waitcnt lgkmcnt(0)
s_add_u32 s37, s40, 1572864
s_add_u32 m0, s38, 4096
s_nop 0
buffer_load_dwordx4 v6, s[20:23], s37 offen lds
s_add_u32 s37, s40, 1703936
s_add_u32 m0, s38, 5120
s_nop 0
buffer_load_dwordx4 v6, s[20:23], s37 offen lds
s_add_u32 s37, s40, 1835008
s_add_u32 m0, s38, 6144
s_nop 0
buffer_load_dwordx4 v6, s[20:23], s37 offen lds
s_add_u32 s37, s40, 1966080
s_add_u32 m0, s38, 7168
s_nop 0
buffer_load_dwordx4 v6, s[20:23], s37 offen lds
s_waitcnt vmcnt(12)
ds_read_b64_tr_b16 a[112:113], v7 offset:12288
ds_read_b64_tr_b16 a[114:115], v7 offset:12544
ds_read_b64_tr_b16 a[116:117], v7 offset:14336
ds_read_b64_tr_b16 a[118:119], v7 offset:14592
ds_read_b64_tr_b16 a[184:185], v7 offset:12320
ds_read_b64_tr_b16 a[186:187], v7 offset:12576
ds_read_b64_tr_b16 a[188:189], v7 offset:14368
ds_read_b64_tr_b16 a[190:191], v7 offset:14624
s_waitcnt lgkmcnt(0)
s_add_u32 s37, s40, 2097152
s_add_u32 m0, s38, 8192
s_nop 0
buffer_load_dwordx4 v6, s[20:23], s37 offen lds
s_add_u32 s37, s40, 2228224
s_add_u32 m0, s38, 9216
s_nop 0
buffer_load_dwordx4 v6, s[20:23], s37 offen lds
s_add_u32 s37, s40, 2359296
s_add_u32 m0, s38, 10240
s_nop 0
buffer_load_dwordx4 v6, s[20:23], s37 offen lds
s_add_u32 s37, s40, 2490368
s_add_u32 m0, s38, 11264
s_nop 0
buffer_load_dwordx4 v6, s[20:23], s37 offen lds
s_waitcnt vmcnt(12)
ds_read_b64_tr_b16 a[120:121], v7 offset:16384
ds_read_b64_tr_b16 a[122:123], v7 offset:16640
ds_read_b64_tr_b16 a[124:125], v7 offset:18432
ds_read_b64_tr_b16 a[126:127], v7 offset:18688
ds_read_b64_tr_b16 a[192:193], v7 offset:16416
ds_read_b64_tr_b16 a[194:195], v7 offset:16672
ds_read_b64_tr_b16 a[196:197], v7 offset:18464
ds_read_b64_tr_b16 a[198:199], v7 offset:18720
s_waitcnt lgkmcnt(0)
s_add_u32 s37, s40, 2621440
s_add_u32 m0, s38, 12288
s_nop 0
buffer_load_dwordx4 v6, s[20:23], s37 offen lds
s_add_u32 s37, s40, 2752512
s_add_u32 m0, s38, 13312
s_nop 0
buffer_load_dwordx4 v6, s[20:23], s37 offen lds
s_add_u32 s37, s40, 2883584
s_add_u32 m0, s38, 14336
s_nop 0
buffer_load_dwordx4 v6, s[20:23], s37 offen lds
s_add_u32 s37, s40, 3014656
s_add_u32 m0, s38, 15360
s_nop 0
buffer_load_dwordx4 v6, s[20:23], s37 offen lds
s_waitcnt vmcnt(12)
ds_read_b64_tr_b16 a[128:129], v7 offset:0
ds_read_b64_tr_b16 a[130:131], v7 offset:256
ds_read_b64_tr_b16 a[132:133], v7 offset:2048
ds_read_b64_tr_b16 a[134:135], v7 offset:2304
ds_read_b64_tr_b16 a[200:201], v7 offset:32
ds_read_b64_tr_b16 a[202:203], v7 offset:288
ds_read_b64_tr_b16 a[204:205], v7 offset:2080
ds_read_b64_tr_b16 a[206:207], v7 offset:2336
s_waitcnt lgkmcnt(0)
s_add_u32 s37, s40, 3145728
s_add_u32 m0, s38, 16384
s_nop 0
buffer_load_dwordx4 v6, s[20:23], s37 offen lds
s_add_u32 s37, s40, 3276800
s_add_u32 m0, s38, 17408
s_nop 0
buffer_load_dwordx4 v6, s[20:23], s37 offen lds
s_add_u32 s37, s40, 3407872
s_add_u32 m0, s38, 18432
s_nop 0
buffer_load_dwordx4 v6, s[20:23], s37 offen lds
s_add_u32 s37, s40, 3538944
s_add_u32 m0, s38, 19456
s_nop 0
buffer_load_dwordx4 v6, s[20:23], s37 offen lds
s_waitcnt vmcnt(12)
ds_read_b64_tr_b16 a[136:137], v7 offset:4096
ds_read_b64_tr_b16 a[138:139], v7 offset:4352
ds_read_b64_tr_b16 a[140:141], v7 offset:6144
ds_read_b64_tr_b16 a[142:143], v7 offset:6400
ds_read_b64_tr_b16 a[208:209], v7 offset:4128
ds_read_b64_tr_b16 a[210:211], v7 offset:4384
ds_read_b64_tr_b16 a[212:213], v7 offset:6176
ds_read_b64_tr_b16 a[214:215], v7 offset:6432
s_waitcnt lgkmcnt(0)
s_add_u32 s37, s40, 3670016
s_add_u32 m0, s38, 0
s_nop 0
buffer_load_dwordx4 v6, s[20:23], s37 offen lds
s_add_u32 s37, s40, 3801088
s_add_u32 m0, s38, 1024
s_nop 0
buffer_load_dwordx4 v6, s[20:23], s37 offen lds
s_add_u32 s37, s40, 3932160
s_add_u32 m0, s38, 2048
s_nop 0
buffer_load_dwordx4 v6, s[20:23], s37 offen lds
s_add_u32 s37, s40, 4063232
s_add_u32 m0, s38, 3072
s_nop 0
buffer_load_dwordx4 v6, s[20:23], s37 offen lds
s_waitcnt vmcnt(12)
ds_read_b64_tr_b16 a[144:145], v7 offset:8192
ds_read_b64_tr_b16 a[146:147], v7 offset:8448
ds_read_b64_tr_b16 a[148:149], v7 offset:10240
ds_read_b64_tr_b16 a[150:151], v7 offset:10496
ds_read_b64_tr_b16 a[216:217], v7 offset:8224
ds_read_b64_tr_b16 a[218:219], v7 offset:8480
ds_read_b64_tr_b16 a[220:221], v7 offset:10272
ds_read_b64_tr_b16 a[222:223], v7 offset:10528
s_waitcnt lgkmcnt(0)
s_add_u32 s37, s40, 4194304
s_add_u32 m0, s38, 4096
s_nop 0
buffer_load_dwordx4 v6, s[20:23], s37 offen lds
s_add_u32 s37, s40, 4325376
s_add_u32 m0, s38, 5120
s_nop 0
buffer_load_dwordx4 v6, s[20:23], s37 offen lds
s_add_u32 s37, s40, 4456448
s_add_u32 m0, s38, 6144
s_nop 0
buffer_load_dwordx4 v6, s[20:23], s37 offen lds
s_add_u32 s37, s40, 4587520
s_add_u32 m0, s38, 7168
s_nop 0
buffer_load_dwordx4 v6, s[20:23], s37 offen lds
s_waitcnt vmcnt(12)
ds_read_b64_tr_b16 a[152:153], v7 offset:12288
ds_read_b64_tr_b16 a[154:155], v7 offset:12544
ds_read_b64_tr_b16 a[156:157], v7 offset:14336
ds_read_b64_tr_b16 a[158:159], v7 offset:14592
ds_read_b64_tr_b16 a[224:225], v7 offset:12320
ds_read_b64_tr_b16 a[226:227], v7 offset:12576
ds_read_b64_tr_b16 a[228:229], v7 offset:14368
ds_read_b64_tr_b16 a[230:231], v7 offset:14624
s_waitcnt lgkmcnt(0)
s_waitcnt vmcnt(8)
ds_read_b64_tr_b16 a[160:161], v7 offset:16384
ds_read_b64_tr_b16 a[162:163], v7 offset:16640
ds_read_b64_tr_b16 a[164:165], v7 offset:18432
ds_read_b64_tr_b16 a[166:167], v7 offset:18688
ds_read_b64_tr_b16 a[232:233], v7 offset:16416
ds_read_b64_tr_b16 a[234:235], v7 offset:16672
ds_read_b64_tr_b16 a[236:237], v7 offset:18464
ds_read_b64_tr_b16 a[238:239], v7 offset:18720
s_waitcnt lgkmcnt(0)
s_waitcnt vmcnt(4)
ds_read_b64_tr_b16 a[168:169], v7 offset:0
ds_read_b64_tr_b16 a[170:171], v7 offset:256
ds_read_b64_tr_b16 a[172:173], v7 offset:2048
ds_read_b64_tr_b16 a[174:175], v7 offset:2304
ds_read_b64_tr_b16 a[240:241], v7 offset:32
ds_read_b64_tr_b16 a[242:243], v7 offset:288
ds_read_b64_tr_b16 a[244:245], v7 offset:2080
ds_read_b64_tr_b16 a[246:247], v7 offset:2336
s_waitcnt lgkmcnt(0)
s_waitcnt vmcnt(0)
ds_read_b64_tr_b16 a[176:177], v7 offset:4096
ds_read_b64_tr_b16 a[178:179], v7 offset:4352
ds_read_b64_tr_b16 a[180:181], v7 offset:6144
ds_read_b64_tr_b16 a[182:183], v7 offset:6400
ds_read_b64_tr_b16 a[248:249], v7 offset:4128
ds_read_b64_tr_b16 a[250:251], v7 offset:4384
ds_read_b64_tr_b16 a[252:253], v7 offset:6176
ds_read_b64_tr_b16 a[254:255], v7 offset:6432
s_waitcnt lgkmcnt(0)
s_lshl_b32 s42, s33, 5
s_add_u32 s42, s42, s32
s_lshl_b32 s39, s42, 13
s_lshl_b32 s37, s34, 11
s_add_u32 s39, s39, s37
s_add_u32 s39, s39, 50331648
s_lshl_b32 s40, s42, 14
s_add_u32 s40, s40, 16777216
s_lshl_b32 s37, s34, 12
s_add_u32 s41, s40, s37
s_lshr_b32 s37, s34, 1
s_lshl_b32 s37, s37, 10
s_add_u32 s40, s40, s37
s_and_b32 s37, s34, 1
s_lshl_b32 s37, s37, 6
s_add_u32 s40, s40, s37
s_mov_b32 s35, 0
s_mov_b32 s48, 36864
s_lshl_b32 s49, s32, 5
s_lshl_b32 s37, s33, 2
s_add_u32 s49, s49, s37
s_add_u32 s49, s49, s34
s_lshl_b32 s49, s49, 2
s_add_u32 s49, s49, 327680
s_branch L_q_init_in
L_q_init:
s_sleep 4
L_q_init_in:
buffer_load_dword v12, v8, s[24:27], 0 offen offset:0 sc0 sc1
s_sub_u32 s36, s36, 1
s_cbranch_scc1 L_exit_w
s_waitcnt vmcnt(0)
v_readfirstlane_b32 s37, v12
s_nop 0
s_and_b32 s37, s37, 0xff
s_cmp_eq_u32 s37, 32
s_cbranch_scc0 L_q_init
.p2align 6
L_q_loop:
s_waitcnt vmcnt(7)
s_barrier
s_add_u32 s43, s43, 147456
s_add_u32 s44, s44, s48
ds_read_b128 v[64:67], v3 offset:0
ds_read_b128 v[68:71], v3 offset:1024
ds_read_b128 v[72:75], v3 offset:2048
ds_read_b128 v[76:79], v3 offset:3072
s_waitcnt lgkmcnt(2)
v_mfma_f32_16x16x32_bf16 v[16:19], v[80:83], v[64:67], 0
v_mfma_f32_16x16x32_bf16 v[20:23], v[80:83], v[68:71], 0
v_mfma_f32_16x16x32_bf16 v[24:27], v[152:155], v[64:67], 0
v_mfma_f32_16x16x32_bf16 v[28:31], v[152:155], v[68:71], 0
s_add_u32 s37, s43, 0
s_add_u32 m0, s44, 0
s_nop 0
buffer_load_dwordx4 v2, s[8:11], s37 offen lds
v_mfma_f32_16x16x32_bf16 v[32:35], v[224:227], v[64:67], 0
v_mfma_f32_16x16x32_bf16 v[36:39], v[224:227], v[68:71], 0
v_mfma_f32_16x16x32_bf16 v[40:43], a[40:43], v[64:67], 0
v_mfma_f32_16x16x32_bf16 v[44:47], a[40:43], v[68:71], 0
v_mfma_f32_16x16x32_bf16 v[48:51], v[64:67], a[112:115], 0
v_mfma_f32_16x16x32_bf16 v[52:55], v[68:71], a[112:115], 0
v_mfma_f32_16x16x32_bf16 v[56:59], v[64:67], a[184:187], 0
v_mfma_f32_16x16x32_bf16 v[60:63], v[68:71], a[184:187], 0
ds_read_b128 v[64:67], v3 offset:4096
ds_read_b128 v[68:71], v3 offset:5120
s_waitcnt lgkmcnt(2)
v_mfma_f32_16x16x32_bf16 v[16:19], v[84:87], v[72:75], v[16:19]
v_mfma_f32_16x16x32_bf16 v[20:23], v[84:87], v[76:79], v[20:23]
v_mfma_f32_16x16x32_bf16 v[24:27], v[156:159], v[72:75], v[24:27]
v_mfma_f32_16x16x32_bf16 v[28:31], v[156:159], v[76:79], v[28:31]
s_add_u32 s37, s43, 128
s_add_u32 m0, s44, 4096
s_nop 0
buffer_load_dwordx4 v2, s[8:11], s37 offen lds
v_mfma_f32_16x16x32_bf16 v[32:35], v[228:231], v[72:75], v[32:35]
v_mfma_f32_16x16x32_bf16 v[36:39], v[228:231], v[76:79], v[36:39]
v_mfma_f32_16x16x32_bf16 v[40:43], a[44:47], v[72:75], v[40:43]
v_mfma_f32_16x16x32_bf16 v[44:47], a[44:47], v[76:79], v[44:47]
v_mfma_f32_16x16x32_bf16 v[48:51], v[72:75], a[116:119], v[48:51]
v_mfma_f32_16x16x32_bf16 v[52:55], v[76:79], a[116:119], v[52:55]
v_mfma_f32_16x16x32_bf16 v[56:59], v[72:75], a[188:191], v[56:59]
v_mfma_f32_16x16x32_bf16 v[60:63], v[76:79], a[188:191], v[60:63]
ds_read_b128 v[72:75], v3 offset:6144
ds_read_b128 v[76:79], v3 offset:7168
s_waitcnt lgkmcnt(2)
v_mfma_f32_16x16x32_bf16 v[16:19], v[88:91], v[64:67], v[16:19]
v_mfma_f32_16x16x32_bf16 v[20:23], v[88:91], v[68:71], v[20:23]
v_mfma_f32_16x16x32_bf16 v[24:27], v[160:163], v[64:67], v[24:27]
v_mfma_f32_16x16x32_bf16 v[28:31], v[160:163], v[68:71], v[28:31]
s_add_u32 s37, s43, 256
s_add_u32 m0, s44, 8192
s_nop 0
buffer_load_dwordx4 v2, s[8:11], s37 offen lds
v_mfma_f32_16x16x32_bf16 v[32:35], v[232:235], v[64:67], v[32:35]
v_mfma_f32_16x16x32_bf16 v[36:39], v[232:235], v[68:71], v[36:39]
v_mfma_f32_16x16x32_bf16 v[40:43], a[48:51], v[64:67], v[40:43]
v_mfma_f32_16x16x32_bf16 v[44:47], a[48:51], v[68:71], v[44:47]
v_mfma_f32_16x16x32_bf16 v[48:51], v[64:67], a[120:123], v[48:51]
v_mfma_f32_16x16x32_bf16 v[52:55], v[68:71], a[120:123], v[52:55]
v_mfma_f32_16x16x32_bf16 v[56:59], v[64:67], a[192:195], v[56:59]
v_mfma_f32_16x16x32_bf16 v[60:63], v[68:71], a[192:195], v[60:63]
ds_read_b128 v[64:67], v3 offset:8192
ds_read_b128 v[68:71], v3 offset:9216
s_waitcnt lgkmcnt(2)
v_mfma_f32_16x16x32_bf16 v[16:19], v[92:95], v[72:75], v[16:19]
v_mfma_f32_16x16x32_bf16 v[20:23], v[92:95], v[76:79], v[20:23]
v_mfma_f32_16x16x32_bf16 v[24:27], v[164:167], v[72:75], v[24:27]
v_mfma_f32_16x16x32_bf16 v[28:31], v[164:167], v[76:79], v[28:31]
s_add_u32 s37, s43, 384
s_add_u32 m0, s44, 12288
s_nop 0
buffer_load_dwordx4 v2, s[8:11], s37 offen lds
v_mfma_f32_16x16x32_bf16 v[32:35], v[236:239], v[72:75], v[32:35]
v_mfma_f32_16x16x32_bf16 v[36:39], v[236:239], v[76:79], v[36:39]
v_mfma_f32_16x16x32_bf16 v[40:43], a[52:55], v[72:75], v[40:43]
v_mfma_f32_16x16x32_bf16 v[44:47], a[52:55], v[76:79], v[44:47]
v_mfma_f32_16x16x32_bf16 v[48:51], v[72:75], a[124:127], v[48:51]
v_mfma_f32_16x16x32_bf16 v[52:55], v[76:79], a[124:127], v[52:55]
v_mfma_f32_16x16x32_bf16 v[56:59], v[72:75], a[196:199], v[56:59]
v_mfma_f32_16x16x32_bf16 v[60:63], v[76:79], a[196:199], v[60:63]
ds_read_b128 v[72:75], v3 offset:10240
ds_read_b128 v[76:79], v3 offset:11264
s_waitcnt lgkmcnt(2)
v_mfma_f32_16x16x32_bf16 v[16:19], v[96:99], v[64:67], v[16:19]
v_mfma_f32_16x16x32_bf16 v[20:23], v[96:99], v[68:71], v[20:23]
v_mfma_f32_16x16x32_bf16 v[24:27], v[168:171], v[64:67], v[24:27]
v_mfma_f32_16x16x32_bf16 v[28:31], v[168:171], v[68:71], v[28:31]
s_add_u32 s37, s43, 512
s_add_u32 m0, s44, 16384
s_nop 0
buffer_load_dwordx4 v2, s[8:11], s37 offen lds
v_mfma_f32_16x16x32_bf16 v[32:35], v[240:243], v[64:67], v[32:35]
v_mfma_f32_16x16x32_bf16 v[36:39], v[240:243], v[68:71], v[36:39]
v_mfma_f32_16x16x32_bf16 v[40:43], a[56:59], v[64:67], v[40:43]
v_mfma_f32_16x16x32_bf16 v[44:47], a[56:59], v[68:71], v[44:47]
v_mfma_f32_16x16x32_bf16 v[48:51], v[64:67], a[128:131], v[48:51]
v_mfma_f32_16x16x32_bf16 v[52:55], v[68:71], a[128:131], v[52:55]
v_mfma_f32_16x16x32_bf16 v[56:59], v[64:67], a[200:203], v[56:59]
v_mfma_f32_16x16x32_bf16 v[60:63], v[68:71], a[200:203], v[60:63]
ds_read_b128 v[64:67], v3 offset:12288
ds_read_b128 v[68:71], v3 offset:13312
s_waitcnt lgkmcnt(2)
v_mfma_f32_16x16x32_bf16 v[16:19], v[100:103], v[72:75], v[16:19]
v_mfma_f32_16x16x32_bf16 v[20:23], v[100:103], v[76:79], v[20:23]
v_mfma_f32_16x16x32_bf16 v[24:27], v[172:175], v[72:75], v[24:27]
v_mfma_f32_16x16x32_bf16 v[28:31], v[172:175], v[76:79], v[28:31]
s_add_u32 s37, s43, 640
s_add_u32 m0, s44, 20480
s_nop 0
buffer_load_dwordx4 v2, s[8:11], s37 offen lds
v_mfma_f32_16x16x32_bf16 v[32:35], v[244:247], v[72:75], v[32:35]
v_mfma_f32_16x16x32_bf16 v[36:39], v[244:247], v[76:79], v[36:39]
v_mfma_f32_16x16x32_bf16 v[40:43], a[60:63], v[72:75], v[40:43]
v_mfma_f32_16x16x32_bf16 v[44:47], a[60:63], v[76:79], v[44:47]
v_mfma_f32_16x16x32_bf16 v[48:51], v[72:75], a[132:135], v[48:51]
v_mfma_f32_16x16x32_bf16 v[52:55], v[76:79], a[132:135], v[52:55]
v_mfma_f32_16x16x32_bf16 v[56:59], v[72:75], a[204:207], v[56:59]
v_mfma_f32_16x16x32_bf16 v[60:63], v[76:79], a[204:207], v[60:63]
ds_read_b128 v[72:75], v3 offset:14336
ds_read_b128 v[76:79], v3 offset:15360
s_waitcnt lgkmcnt(2)
v_mfma_f32_16x16x32_bf16 v[16:19], v[104:107], v[64:67], v[16:19]
v_mfma_f32_16x16x32_bf16 v[20:23], v[104:107], v[68:71], v[20:23]
v_mfma_f32_16x16x32_bf16 v[24:27], v[176:179], v[64:67], v[24:27]
v_mfma_f32_16x16x32_bf16 v[28:31], v[176:179], v[68:71], v[28:31]
s_add_u32 s37, s43, 768
s_add_u32 m0, s44, 24576
s_nop 0
buffer_load_dwordx4 v2, s[8:11], s37 offen lds
v_mfma_f32_16x16x32_bf16 v[32:35], v[248:251], v[64:67], v[32:35]
v_mfma_f32_16x16x32_bf16 v[36:39], v[248:251], v[68:71], v[36:39]
v_mfma_f32_16x16x32_bf16 v[40:43], a[64:67], v[64:67], v[40:43]
v_mfma_f32_16x16x32_bf16 v[44:47], a[64:67], v[68:71], v[44:47]
v_mfma_f32_16x16x32_bf16 v[48:51], v[64:67], a[136:139], v[48:51]
v_mfma_f32_16x16x32_bf16 v[52:55], v[68:71], a[136:139], v[52:55]
v_mfma_f32_16x16x32_bf16 v[56:59], v[64:67], a[208:211], v[56:59]
v_mfma_f32_16x16x32_bf16 v[60:63], v[68:71], a[208:211], v[60:63]
ds_read_b128 v[64:67], v3 offset:16384
ds_read_b128 v[68:71], v3 offset:17408
s_waitcnt lgkmcnt(2)
v_mfma_f32_16x16x32_bf16 v[16:19], v[108:111], v[72:75], v[16:19]
v_mfma_f32_16x16x32_bf16 v[20:23], v[108:111], v[76:79], v[20:23]
v_mfma_f32_16x16x32_bf16 v[24:27], v[180:183], v[72:75], v[24:27]
v_mfma_f32_16x16x32_bf16 v[28:31], v[180:183], v[76:79], v[28:31]
s_add_u32 s37, s43, 896
s_add_u32 m0, s44, 28672
s_nop 0
buffer_load_dwordx4 v2, s[8:11], s37 offen lds
v_mfma_f32_16x16x32_bf16 v[32:35], v[252:255], v[72:75], v[32:35]
v_mfma_f32_16x16x32_bf16 v[36:39], v[252:255], v[76:79], v[36:39]
v_mfma_f32_16x16x32_bf16 v[40:43], a[68:71], v[72:75], v[40:43]
v_mfma_f32_16x16x32_bf16 v[44:47], a[68:71], v[76:79], v[44:47]
v_mfma_f32_16x16x32_bf16 v[48:51], v[72:75], a[140:143], v[48:51]
v_mfma_f32_16x16x32_bf16 v[52:55], v[76:79], a[140:143], v[52:55]
v_mfma_f32_16x16x32_bf16 v[56:59], v[72:75], a[212:215], v[56:59]
v_mfma_f32_16x16x32_bf16 v[60:63], v[76:79], a[212:215], v[60:63]
ds_read_b128 v[72:75], v3 offset:18432
ds_read_b128 v[76:79], v3 offset:19456
s_waitcnt lgkmcnt(2)
v_mfma_f32_16x16x32_bf16 v[16:19], v[112:115], v[64:67], v[16:19]
v_mfma_f32_16x16x32_bf16 v[20:23], v[112:115], v[68:71], v[20:23]
v_mfma_f32_16x16x32_bf16 v[24:27], v[184:187], v[64:67], v[24:27]
v_mfma_f32_16x16x32_bf16 v[28:31], v[184:187], v[68:71], v[28:31]
s_add_u32 s37, s43, 1024
s_add_u32 m0, s44, 32768
s_nop 0
buffer_load_dwordx4 v2, s[8:11], s37 offen lds
v_mfma_f32_16x16x32_bf16 v[32:35], a[0:3], v[64:67], v[32:35]
v_mfma_f32_16x16x32_bf16 v[36:39], a[0:3], v[68:71], v[36:39]
v_mfma_f32_16x16x32_bf16 v[40:43], a[72:75], v[64:67], v[40:43]
v_mfma_f32_16x16x32_bf16 v[44:47], a[72:75], v[68:71], v[44:47]
v_mfma_f32_16x16x32_bf16 v[48:51], v[64:67], a[144:147], v[48:51]
v_mfma_f32_16x16x32_bf16 v[52:55], v[68:71], a[144:147], v[52:55]
v_mfma_f32_16x16x32_bf16 v[56:59], v[64:67], a[216:219], v[56:59]
v_mfma_f32_16x16x32_bf16 v[60:63], v[68:71], a[216:219], v[60:63]
ds_read_b128 v[64:67], v3 offset:20480
ds_read_b128 v[68:71], v3 offset:21504
s_waitcnt lgkmcnt(2)
v_mfma_f32_16x16x32_bf16 v[16:19], v[116:119], v[72:75], v[16:19]
v_mfma_f32_16x16x32_bf16 v[20:23], v[116:119], v[76:79], v[20:23]
v_mfma_f32_16x16x32_bf16 v[24:27], v[188:191], v[72:75], v[24:27]
v_mfma_f32_16x16x32_bf16 v[28:31], v[188:191], v[76:79], v[28:31]
v_mfma_f32_16x16x32_bf16 v[32:35], a[4:7], v[72:75], v[32:35]
v_mfma_f32_16x16x32_bf16 v[36:39], a[4:7], v[76:79], v[36:39]
v_mfma_f32_16x16x32_bf16 v[40:43], a[76:79], v[72:75], v[40:43]
v_mfma_f32_16x16x32_bf16 v[44:47], a[76:79], v[76:79], v[44:47]
v_mfma_f32_16x16x32_bf16 v[48:51], v[72:75], a[148:151], v[48:51]
v_mfma_f32_16x16x32_bf16 v[52:55], v[76:79], a[148:151], v[52:55]
v_mfma_f32_16x16x32_bf16 v[56:59], v[72:75], a[220:223], v[56:59]
v_mfma_f32_16x16x32_bf16 v[60:63], v[76:79], a[220:223], v[60:63]
ds_read_b128 v[72:75], v3 offset:22528
ds_read_b128 v[76:79], v3 offset:23552
s_waitcnt lgkmcnt(2)
v_mfma_f32_16x16x32_bf16 v[16:19], v[120:123], v[64:67], v[16:19]
v_mfma_f32_16x16x32_bf16 v[20:23], v[120:123], v[68:71], v[20:23]
v_mfma_f32_16x16x32_bf16 v[24:27], v[192:195], v[64:67], v[24:27]
v_mfma_f32_16x16x32_bf16 v[28:31], v[192:195], v[68:71], v[28:31]
s_waitcnt vmcnt(9)
v_mov_b32 v12, s35
s_mov_b64 exec, 1
buffer_store_dword v12, v8, s[4:7], s49 offen sc0 sc1
s_mov_b64 exec, -1
v_mfma_f32_16x16x32_bf16 v[32:35], a[8:11], v[64:67], v[32:35]
v_mfma_f32_16x16x32_bf16 v[36:39], a[8:11], v[68:71], v[36:39]
v_mfma_f32_16x16x32_bf16 v[40:43], a[80:83], v[64:67], v[40:43]
v_mfma_f32_16x16x32_bf16 v[44:47], a[80:83], v[68:71], v[44:47]
v_mfma_f32_16x16x32_bf16 v[48:51], v[64:67], a[152:155], v[48:51]
v_mfma_f32_16x16x32_bf16 v[52:55], v[68:71], a[152:155], v[52:55]
v_mfma_f32_16x16x32_bf16 v[56:59], v[64:67], a[224:227], v[56:59]
v_mfma_f32_16x16x32_bf16 v[60:63], v[68:71], a[224:227], v[60:63]
ds_read_b128 v[64:67], v3 offset:24576
ds_read_b128 v[68:71], v3 offset:25600
s_waitcnt lgkmcnt(2)
v_mfma_f32_16x16x32_bf16 v[16:19], v[124:127], v[72:75], v[16:19]
v_mfma_f32_16x16x32_bf16 v[20:23], v[124:127], v[76:79], v[20:23]
v_mfma_f32_16x16x32_bf16 v[24:27], v[196:199], v[72:75], v[24:27]
v_mfma_f32_16x16x32_bf16 v[28:31], v[196:199], v[76:79], v[28:31]
v_mfma_f32_16x16x32_bf16 v[32:35], a[12:15], v[72:75], v[32:35]
v_mfma_f32_16x16x32_bf16 v[36:39], a[12:15], v[76:79], v[36:39]
v_mfma_f32_16x16x32_bf16 v[40:43], a[84:87], v[72:75], v[40:43]
v_mfma_f32_16x16x32_bf16 v[44:47], a[84:87], v[76:79], v[44:47]
v_mfma_f32_16x16x32_bf16 v[48:51], v[72:75], a[156:159], v[48:51]
v_mfma_f32_16x16x32_bf16 v[52:55], v[76:79], a[156:159], v[52:55]
v_mfma_f32_16x16x32_bf16 v[56:59], v[72:75], a[228:231], v[56:59]
v_mfma_f32_16x16x32_bf16 v[60:63], v[76:79], a[228:231], v[60:63]
ds_read_b128 v[72:75], v3 offset:26624
ds_read_b128 v[76:79], v3 offset:27648
s_waitcnt lgkmcnt(2)
v_mfma_f32_16x16x32_bf16 v[16:19], v[128:131], v[64:67], v[16:19]
v_mfma_f32_16x16x32_bf16 v[20:23], v[128:131], v[68:71], v[20:23]
v_mfma_f32_16x16x32_bf16 v[24:27], v[200:203], v[64:67], v[24:27]
v_mfma_f32_16x16x32_bf16 v[28:31], v[200:203], v[68:71], v[28:31]
v_mfma_f32_16x16x32_bf16 v[32:35], a[16:19], v[64:67], v[32:35]
v_mfma_f32_16x16x32_bf16 v[36:39], a[16:19], v[68:71], v[36:39]
v_mfma_f32_16x16x32_bf16 v[40:43], a[88:91], v[64:67], v[40:43]
v_mfma_f32_16x16x32_bf16 v[44:47], a[88:91], v[68:71], v[44:47]
v_mfma_f32_16x16x32_bf16 v[48:51], v[64:67], a[160:163], v[48:51]
v_mfma_f32_16x16x32_bf16 v[52:55], v[68:71], a[160:163], v[52:55]
v_mfma_f32_16x16x32_bf16 v[56:59], v[64:67], a[232:235], v[56:59]
v_mfma_f32_16x16x32_bf16 v[60:63], v[68:71], a[232:235], v[60:63]
ds_read_b128 v[64:67], v3 offset:28672
ds_read_b128 v[68:71], v3 offset:29696
s_waitcnt lgkmcnt(2)
v_mfma_f32_16x16x32_bf16 v[16:19], v[132:135], v[72:75], v[16:19]
v_mfma_f32_16x16x32_bf16 v[20:23], v[132:135], v[76:79], v[20:23]
v_mfma_f32_16x16x32_bf16 v[24:27], v[204:207], v[72:75], v[24:27]
v_mfma_f32_16x16x32_bf16 v[28:31], v[204:207], v[76:79], v[28:31]
v_mfma_f32_16x16x32_bf16 v[32:35], a[20:23], v[72:75], v[32:35]
v_mfma_f32_16x16x32_bf16 v[36:39], a[20:23], v[76:79], v[36:39]
v_mfma_f32_16x16x32_bf16 v[40:43], a[92:95], v[72:75], v[40:43]
v_mfma_f32_16x16x32_bf16 v[44:47], a[92:95], v[76:79], v[44:47]
v_mfma_f32_16x16x32_bf16 v[48:51], v[72:75], a[164:167], v[48:51]
v_mfma_f32_16x16x32_bf16 v[52:55], v[76:79], a[164:167], v[52:55]
v_mfma_f32_16x16x32_bf16 v[56:59], v[72:75], a[236:239], v[56:59]
v_mfma_f32_16x16x32_bf16 v[60:63], v[76:79], a[236:239], v[60:63]
ds_read_b128 v[72:75], v3 offset:30720
ds_read_b128 v[76:79], v3 offset:31744
s_waitcnt lgkmcnt(2)
v_mfma_f32_16x16x32_bf16 v[16:19], v[136:139], v[64:67], v[16:19]
v_mfma_f32_16x16x32_bf16 v[20:23], v[136:139], v[68:71], v[20:23]
v_mfma_f32_16x16x32_bf16 v[24:27], v[208:211], v[64:67], v[24:27]
v_mfma_f32_16x16x32_bf16 v[28:31], v[208:211], v[68:71], v[28:31]
v_mfma_f32_16x16x32_bf16 v[32:35], a[24:27], v[64:67], v[32:35]
v_mfma_f32_16x16x32_bf16 v[36:39], a[24:27], v[68:71], v[36:39]
v_mfma_f32_16x16x32_bf16 v[40:43], a[96:99], v[64:67], v[40:43]
v_mfma_f32_16x16x32_bf16 v[44:47], a[96:99], v[68:71], v[44:47]
v_mfma_f32_16x16x32_bf16 v[48:51], v[64:67], a[168:171], v[48:51]
v_mfma_f32_16x16x32_bf16 v[52:55], v[68:71], a[168:171], v[52:55]
v_mfma_f32_16x16x32_bf16 v[56:59], v[64:67], a[240:243], v[56:59]
v_mfma_f32_16x16x32_bf16 v[60:63], v[68:71], a[240:243], v[60:63]
ds_read_b128 v[64:67], v3 offset:32768
ds_read_b128 v[68:71], v3 offset:33792
s_waitcnt lgkmcnt(2)
v_mfma_f32_16x16x32_bf16 v[16:19], v[140:143], v[72:75], v[16:19]
v_mfma_f32_16x16x32_bf16 v[20:23], v[140:143], v[76:79], v[20:23]
v_mfma_f32_16x16x32_bf16 v[24:27], v[212:215], v[72:75], v[24:27]
v_mfma_f32_16x16x32_bf16 v[28:31], v[212:215], v[76:79], v[28:31]
v_mfma_f32_16x16x32_bf16 v[32:35], a[28:31], v[72:75], v[32:35]
v_mfma_f32_16x16x32_bf16 v[36:39], a[28:31], v[76:79], v[36:39]
v_mfma_f32_16x16x32_bf16 v[40:43], a[100:103], v[72:75], v[40:43]
v_mfma_f32_16x16x32_bf16 v[44:47], a[100:103], v[76:79], v[44:47]
v_mfma_f32_16x16x32_bf16 v[48:51], v[72:75], a[172:175], v[48:51]
v_mfma_f32_16x16x32_bf16 v[52:55], v[76:79], a[172:175], v[52:55]
v_mfma_f32_16x16x32_bf16 v[56:59], v[72:75], a[244:247], v[56:59]
v_mfma_f32_16x16x32_bf16 v[60:63], v[76:79], a[244:247], v[60:63]
ds_read_b128 v[72:75], v3 offset:34816
ds_read_b128 v[76:79], v3 offset:35840
s_waitcnt lgkmcnt(2)
v_mfma_f32_16x16x32_bf16 v[16:19], v[144:147], v[64:67], v[16:19]
v_mfma_f32_16x16x32_bf16 v[20:23], v[144:147], v[68:71], v[20:23]
v_mfma_f32_16x16x32_bf16 v[24:27], v[216:219], v[64:67], v[24:27]
v_mfma_f32_16x16x32_bf16 v[28:31], v[216:219], v[68:71], v[28:31]
v_mfma_f32_16x16x32_bf16 v[32:35], a[32:35], v[64:67], v[32:35]
v_mfma_f32_16x16x32_bf16 v[36:39], a[32:35], v[68:71], v[36:39]
v_mfma_f32_16x16x32_bf16 v[40:43], a[104:107], v[64:67], v[40:43]
v_mfma_f32_16x16x32_bf16 v[44:47], a[104:107], v[68:71], v[44:47]
v_mfma_f32_16x16x32_bf16 v[48:51], v[64:67], a[176:179], v[48:51]
v_mfma_f32_16x16x32_bf16 v[52:55], v[68:71], a[176:179], v[52:55]
v_mfma_f32_16x16x32_bf16 v[56:59], v[64:67], a[248:251], v[56:59]
v_mfma_f32_16x16x32_bf16 v[60:63], v[68:71], a[248:251], v[60:63]
s_waitcnt lgkmcnt(0)
v_mfma_f32_16x16x32_bf16 v[16:19], v[148:151], v[72:75], v[16:19]
v_mfma_f32_16x16x32_bf16 v[20:23], v[148:151], v[76:79], v[20:23]
v_mfma_f32_16x16x32_bf16 v[24:27], v[220:223], v[72:75], v[24:27]
v_mfma_f32_16x16x32_bf16 v[28:31], v[220:223], v[76:79], v[28:31]
v_mfma_f32_16x16x32_bf16 v[32:35], a[36:39], v[72:75], v[32:35]
v_mfma_f32_16x16x32_bf16 v[36:39], a[36:39], v[76:79], v[36:39]
v_mfma_f32_16x16x32_bf16 v[40:43], a[108:111], v[72:75], v[40:43]
v_mfma_f32_16x16x32_bf16 v[44:47], a[108:111], v[76:79], v[44:47]
v_mfma_f32_16x16x32_bf16 v[48:51], v[72:75], a[180:183], v[48:51]
v_mfma_f32_16x16x32_bf16 v[52:55], v[76:79], a[180:183], v[52:55]
v_mfma_f32_16x16x32_bf16 v[56:59], v[72:75], a[252:255], v[56:59]
v_mfma_f32_16x16x32_bf16 v[60:63], v[76:79], a[252:255], v[60:63]
v_add_u32 v3, s48, v3
s_sub_u32 s48, 0, s48
v_cvt_pk_bf16_f32 v64, v16, v17
v_cvt_pk_bf16_f32 v65, v18, v19
v_cvt_pk_bf16_f32 v66, v24, v25
v_cvt_pk_bf16_f32 v67, v26, v27
buffer_store_dwordx4 v[64:67], v1, s[4:7], s39 offen offset:0
v_cvt_pk_bf16_f32 v68, v20, v21
v_cvt_pk_bf16_f32 v69, v22, v23
v_cvt_pk_bf16_f32 v70, v28, v29
v_cvt_pk_bf16_f32 v71, v30, v31
buffer_store_dwordx4 v[68:71], v1, s[4:7], s39 offen offset:1024
v_pk_mul_f32 v[32:33], v[32:33], s[46:47]
v_pk_mul_f32 v[34:35], v[34:35], s[46:47]
v_pk_mul_f32 v[36:37], v[36:37], s[46:47]
v_pk_mul_f32 v[38:39], v[38:39], s[46:47]
v_pk_mul_f32 v[40:41], v[40:41], s[46:47]
v_pk_mul_f32 v[42:43], v[42:43], s[46:47]
v_pk_mul_f32 v[44:45], v[44:45], s[46:47]
v_pk_mul_f32 v[46:47], v[46:47], s[46:47]
v_cvt_pk_bf16_f32 v72, v32, v33
v_cvt_pk_bf16_f32 v73, v34, v35
v_cvt_pk_bf16_f32 v74, v40, v41
v_cvt_pk_bf16_f32 v75, v42, v43
buffer_store_dwordx4 v[72:75], v4, s[4:7], s40 offen offset:0 sc0 sc1
v_cvt_pk_bf16_f32 v76, v36, v37
v_cvt_pk_bf16_f32 v77, v38, v39
v_cvt_pk_bf16_f32 v78, v44, v45
v_cvt_pk_bf16_f32 v79, v46, v47
buffer_store_dwordx4 v[76:79], v4, s[4:7], s40 offen offset:128 sc0 sc1
v_cvt_pk_bf16_f32 v16, v48, v49
v_cvt_pk_bf16_f32 v17, v50, v51
v_cvt_pk_bf16_f32 v18, v52, v53
v_cvt_pk_bf16_f32 v19, v54, v55
buffer_store_dwordx4 v[16:19], v1, s[4:7], s41 offen offset:2048 sc0 sc1
v_cvt_pk_bf16_f32 v20, v56, v57
v_cvt_pk_bf16_f32 v21, v58, v59
v_cvt_pk_bf16_f32 v22, v60, v61
v_cvt_pk_bf16_f32 v23, v62, v63
buffer_store_dwordx4 v[20:23], v1, s[4:7], s41 offen offset:3072 sc0 sc1
s_add_u32 s39, s39, 1048576
s_add_u32 s40, s40, 2097152
s_add_u32 s41, s41, 2097152
s_add_u32 s35, s35, 1
s_cmp_lg_u32 s35, 1
s_cbranch_scc1 L_q_n1
s_waitcnt vmcnt(0)
v_mov_b32 v12, s35
s_mov_b64 exec, 1
buffer_store_dword v12, v8, s[4:7], s49 offen sc0 sc1
s_mov_b64 exec, -1
s_waitcnt vmcnt(0)
L_q_n1:
s_cmp_lt_u32 s35, 16
s_cbranch_scc1 L_q_loop
s_waitcnt vmcnt(0)
v_mov_b32 v12, s35
s_mov_b64 exec, 1
buffer_store_dword v12, v8, s[4:7], s49 offen sc0 sc1
s_mov_b64 exec, -1
s_barrier
s_lshr_b32 s37, s34, 1
s_and_b32 s38, s34, 1
s_lshl_b32 s50, s42, 13
s_lshl_b32 s39, s37, 10
s_add_u32 s50, s50, s39
s_add_u32 s50, s50, 50331648
s_lshl_b32 s52, s42, 14
s_add_u32 s52, s52, 16777216
s_lshl_b32 s39, s38, 13
s_add_u32 s53, s52, s39
s_mul_i32 s55, s33, 10240
s_add_u32 s55, s55, 8388608
s_and_b32 s59, s33, 1
s_sub_u32 s59, s59, 1
s_lshl_b32 s39, s33, 1
s_add_u32 s39, s39, s37
s_lshl_b32 s56, s39, 6
s_lshl_b32 s40, s32, 1
s_add_u32 s40, s40, s38
s_add_u32 s56, s56, s40
s_lshl_b32 s58, s56, 2
s_add_u32 s58, s58, 331776
s_lshl_b32 s56, s56, 11
s_add_u32 s56, s56, 67108864
s_mov_b32 s35, 0
s_lshl_b32 s37, s37, 4
v_add_u32 v12, s37, v10
v_lshlrev_b32 v13, 2, v11
v_sub_u32 v12, v12, v13
v_mov_b32 v13, 0xf149f2ca
v_cmp_le_i32 vcc, 0, v12
s_nop 1
v_cndmask_b32 v80, v13, v8, vcc
v_cmp_le_i32 vcc, 1, v12
s_nop 1
v_cndmask_b32 v81, v13, v8, vcc
v_cmp_le_i32 vcc, 2, v12
s_nop 1
v_cndmask_b32 v82, v13, v8, vcc
v_cmp_le_i32 vcc, 3, v12
s_nop 1
v_cndmask_b32 v83, v13, v8, vcc
v_cmp_le_i32 vcc, 16, v12
s_nop 1
v_cndmask_b32 v84, v13, v8, vcc
v_cmp_le_i32 vcc, 17, v12
s_nop 1
v_cndmask_b32 v85, v13, v8, vcc
v_cmp_le_i32 vcc, 18, v12
s_nop 1
v_cndmask_b32 v86, v13, v8, vcc
v_cmp_le_i32 vcc, 19, v12
s_nop 1
v_cndmask_b32 v87, v13, v8, vcc
v_cmp_gt_u32 vcc, 2, v11
s_nop 1
v_cndmask_b32 v88, v13, v8, vcc
v_cndmask_b32 v89, v13, v8, vcc
v_cndmask_b32 v90, v13, v8, vcc
v_cndmask_b32 v91, v13, v8, vcc
v_mov_b32 v92, 0x3f803f80
v_mov_b32 v93, 0x3f803f80
v_mov_b32 v94, 0x3f803f80
v_mov_b32 v95, 0x3f803f80
v_lshrrev_b32 v12, 1, v11
v_lshlrev_b32 v14, 8, v12
v_and_b32 v12, 1, v11
v_lshl_add_u32 v14, v12, 5, v14
v_bfe_u32 v12, v10, 1, 2
v_lshl_add_u32 v14, v12, 6, v14
v_and_b32 v12, 1, v10
v_lshl_add_u32 v14, v12, 4, v14
s_lshl_b32 s37, s34, 8
v_lshl_add_u32 v15, v9, 2, s37
s_lshl_b32 s37, s34, 10
v_add_u32 v6, s37, v1
s_lshl_b32 s38, s38, 11
v_add_u32 v3, s38, v1
v_and_b32 v12, 3, v10
v_cmp_eq_u32 vcc, 0, v12
s_nop 1
v_cndmask_b32 v5, 0, 1, vcc
L_at_loop:
s_add_u32 s51, s50, 4096
s_add_u32 s54, s53, 4096
s_add_u32 s60, s55, 4096
s_add_u32 s57, s55, 8192
buffer_load_dwordx4 v[16:19], v1, s[4:7], s50 offen offset:0
buffer_load_dwordx4 v[32:35], v4, s[4:7], s52 offen offset:0 sc1
buffer_load_dwordx4 v[48:51], v4, s[4:7], s52 offen offset:128 sc1
buffer_load_dwordx4 v[20:23], v1, s[4:7], s50 offen offset:2048
buffer_load_dwordx4 v[36:39], v4, s[4:7], s52 offen offset:64 sc1
buffer_load_dwordx4 v[52:55], v4, s[4:7], s52 offen offset:192 sc1
buffer_load_dwordx4 v[24:27], v1, s[4:7], s51 offen offset:0
buffer_load_dwordx4 v[40:43], v4, s[4:7], s52 offen offset:1024 sc1
buffer_load_dwordx4 v[56:59], v4, s[4:7], s52 offen offset:1152 sc1
buffer_load_dwordx4 v[28:31], v1, s[4:7], s51 offen offset:2048
buffer_load_dwordx4 v[44:47], v4, s[4:7], s52 offen offset:1088 sc1
buffer_load_dwordx4 v[60:63], v4, s[4:7], s52 offen offset:1216 sc1
buffer_load_dwordx4 v[64:67], v1, s[4:7], s53 offen offset:2048 sc1
buffer_load_dwordx4 v[68:71], v1, s[4:7], s53 offen offset:3072 sc1
buffer_load_dwordx4 v[72:75], v1, s[4:7], s54 offen offset:2048 sc1
buffer_load_dwordx4 v[76:79], v1, s[4:7], s54 offen offset:3072 sc1
s_waitcnt vmcnt(13)
v_mfma_f32_16x16x32_bf16 v[96:99], v[32:35], v[16:19], v[80:83]
v_mfma_f32_16x16x32_bf16 v[100:103], v[48:51], v[16:19], v[84:87]
s_waitcnt vmcnt(10)
v_mfma_f32_16x16x32_bf16 v[96:99], v[36:39], v[20:23], v[96:99]
v_mfma_f32_16x16x32_bf16 v[100:103], v[52:55], v[20:23], v[100:103]
s_waitcnt vmcnt(7)
v_mfma_f32_16x16x32_bf16 v[96:99], v[40:43], v[24:27], v[96:99]
v_mfma_f32_16x16x32_bf16 v[100:103], v[56:59], v[24:27], v[100:103]
s_waitcnt vmcnt(4)
v_mfma_f32_16x16x32_bf16 v[96:99], v[44:47], v[28:31], v[96:99]
v_mfma_f32_16x16x32_bf16 v[100:103], v[60:63], v[28:31], v[100:103]
s_nop 3
v_max3_f32 v160, v96, v97, v98
s_nop 2
v_max3_f32 v160, v160, v99, v100
v_max3_f32 v160, v160, v101, v102
v_max_f32 v160, v160, v103
s_branch L_at_in
L_at_poll:
s_sleep 2
L_at_in:
buffer_load_dwordx4 v[164:167], v6, s[4:7], s55 offen sc0 sc1
buffer_load_dwordx4 v[168:171], v6, s[4:7], s60 offen sc0 sc1
buffer_load_dword v172, v15, s[4:7], s57 offen sc0 sc1
s_sub_u32 s36, s36, 1
s_cbranch_scc1 L_exit_w
s_waitcnt vmcnt(0)
v_bitop3_b32 v12, v164, v168, s59 bitop3:0x7e
v_bitop3_b32 v13, v172, s59, v5 bitop3:0x28
v_and_or_b32 v12, v12, 1, v13
v_cmp_ne_u32 vcc, 0, v12
s_cbranch_vccnz L_at_poll
ds_write_b128 v6, v[164:167]
ds_write_b128 v6, v[168:171] offset:4096
ds_write_b32 v15, v172 offset:8192
s_waitcnt lgkmcnt(0)
s_barrier
ds_read_b128 v[176:179], v14 offset:0
ds_read_b128 v[180:183], v14 offset:512
ds_read_b128 v[184:187], v14 offset:1024
ds_read_b128 v[188:191], v14 offset:1536
s_waitcnt lgkmcnt(3)
v_mfma_f32_16x16x32_bf16 v[192:195], v[224:227], v[176:179], 0
v_mfma_f32_16x16x32_bf16 v[196:199], a[40:43], v[176:179], 0
v_mfma_f32_16x16x32_bf16 v[200:203], v[176:179], a[112:115], 0
v_mfma_f32_16x16x32_bf16 v[204:207], v[176:179], a[184:187], 0
ds_read_b128 v[176:179], v14 offset:2048
s_waitcnt lgkmcnt(3)
v_mfma_f32_16x16x32_bf16 v[192:195], v[228:231], v[180:183], v[192:195]
v_mfma_f32_16x16x32_bf16 v[196:199], a[44:47], v[180:183], v[196:199]
v_mfma_f32_16x16x32_bf16 v[200:203], v[180:183], a[116:119], v[200:203]
v_mfma_f32_16x16x32_bf16 v[204:207], v[180:183], a[188:191], v[204:207]
ds_read_b128 v[180:183], v14 offset:2560
s_waitcnt lgkmcnt(3)
v_mfma_f32_16x16x32_bf16 v[192:195], v[232:235], v[184:187], v[192:195]
v_mfma_f32_16x16x32_bf16 v[196:199], a[48:51], v[184:187], v[196:199]
v_mfma_f32_16x16x32_bf16 v[200:203], v[184:187], a[120:123], v[200:203]
v_mfma_f32_16x16x32_bf16 v[204:207], v[184:187], a[192:195], v[204:207]
ds_read_b128 v[184:187], v14 offset:3072
s_waitcnt lgkmcnt(3)
v_mfma_f32_16x16x32_bf16 v[192:195], v[236:239], v[188:191], v[192:195]
v_mfma_f32_16x16x32_bf16 v[196:199], a[52:55], v[188:191], v[196:199]
v_mfma_f32_16x16x32_bf16 v[200:203], v[188:191], a[124:127], v[200:203]
v_mfma_f32_16x16x32_bf16 v[204:207], v[188:191], a[196:199], v[204:207]
ds_read_b128 v[188:191], v14 offset:3584
s_waitcnt lgkmcnt(3)
v_mfma_f32_16x16x32_bf16 v[192:195], v[240:243], v[176:179], v[192:195]
v_mfma_f32_16x16x32_bf16 v[196:199], a[56:59], v[176:179], v[196:199]
v_mfma_f32_16x16x32_bf16 v[200:203], v[176:179], a[128:131], v[200:203]
v_mfma_f32_16x16x32_bf16 v[204:207], v[176:179], a[200:203], v[204:207]
ds_read_b128 v[176:179], v14 offset:4096
s_waitcnt lgkmcnt(3)
v_mfma_f32_16x16x32_bf16 v[192:195], v[244:247], v[180:183], v[192:195]
v_mfma_f32_16x16x32_bf16 v[196:199], a[60:63], v[180:183], v[196:199]
v_mfma_f32_16x16x32_bf16 v[200:203], v[180:183], a[132:135], v[200:203]
v_mfma_f32_16x16x32_bf16 v[204:207], v[180:183], a[204:207], v[204:207]
ds_read_b128 v[180:183], v14 offset:4608
s_waitcnt lgkmcnt(3)
v_mfma_f32_16x16x32_bf16 v[192:195], v[248:251], v[184:187], v[192:195]
v_mfma_f32_16x16x32_bf16 v[196:199], a[64:67], v[184:187], v[196:199]
v_mfma_f32_16x16x32_bf16 v[200:203], v[184:187], a[136:139], v[200:203]
v_mfma_f32_16x16x32_bf16 v[204:207], v[184:187], a[208:211], v[204:207]
ds_read_b128 v[184:187], v14 offset:5120
s_waitcnt lgkmcnt(3)
v_mfma_f32_16x16x32_bf16 v[192:195], v[252:255], v[188:191], v[192:195]
v_mfma_f32_16x16x32_bf16 v[196:199], a[68:71], v[188:191], v[196:199]
v_mfma_f32_16x16x32_bf16 v[200:203], v[188:191], a[140:143], v[200:203]
v_mfma_f32_16x16x32_bf16 v[204:207], v[188:191], a[212:215], v[204:207]
ds_read_b128 v[188:191], v14 offset:5632
s_waitcnt lgkmcnt(3)
v_mfma_f32_16x16x32_bf16 v[192:195], a[0:3], v[176:179], v[192:195]
v_mfma_f32_16x16x32_bf16 v[196:199], a[72:75], v[176:179], v[196:199]
v_mfma_f32_16x16x32_bf16 v[200:203], v[176:179], a[144:147], v[200:203]
v_mfma_f32_16x16x32_bf16 v[204:207], v[176:179], a[216:219], v[204:207]
ds_read_b128 v[176:179], v14 offset:6144
s_waitcnt lgkmcnt(3)
v_mfma_f32_16x16x32_bf16 v[192:195], a[4:7], v[180:183], v[192:195]
v_mfma_f32_16x16x32_bf16 v[196:199], a[76:79], v[180:183], v[196:199]
v_mfma_f32_16x16x32_bf16 v[200:203], v[180:183], a[148:151], v[200:203]
v_mfma_f32_16x16x32_bf16 v[204:207], v[180:183], a[220:223], v[204:207]
ds_read_b128 v[180:183], v14 offset:6656
s_waitcnt lgkmcnt(3)
v_mfma_f32_16x16x32_bf16 v[192:195], a[8:11], v[184:187], v[192:195]
v_mfma_f32_16x16x32_bf16 v[196:199], a[80:83], v[184:187], v[196:199]
v_mfma_f32_16x16x32_bf16 v[200:203], v[184:187], a[152:155], v[200:203]
v_mfma_f32_16x16x32_bf16 v[204:207], v[184:187], a[224:227], v[204:207]
ds_read_b128 v[184:187], v14 offset:7168
s_waitcnt lgkmcnt(3)
v_mfma_f32_16x16x32_bf16 v[192:195], a[12:15], v[188:191], v[192:195]
v_mfma_f32_16x16x32_bf16 v[196:199], a[84:87], v[188:191], v[196:199]
v_mfma_f32_16x16x32_bf16 v[200:203], v[188:191], a[156:159], v[200:203]
v_mfma_f32_16x16x32_bf16 v[204:207], v[188:191], a[228:231], v[204:207]
ds_read_b128 v[188:191], v14 offset:7680
s_waitcnt lgkmcnt(3)
v_mfma_f32_16x16x32_bf16 v[192:195], a[16:19], v[176:179], v[192:195]
v_mfma_f32_16x16x32_bf16 v[196:199], a[88:91], v[176:179], v[196:199]
v_mfma_f32_16x16x32_bf16 v[200:203], v[176:179], a[160:163], v[200:203]
v_mfma_f32_16x16x32_bf16 v[204:207], v[176:179], a[232:235], v[204:207]
ds_read_b128 v[176:179], v14 offset:8192
s_waitcnt lgkmcnt(3)
v_mfma_f32_16x16x32_bf16 v[192:195], a[20:23], v[180:183], v[192:195]
v_mfma_f32_16x16x32_bf16 v[196:199], a[92:95], v[180:183], v[196:199]
v_mfma_f32_16x16x32_bf16 v[200:203], v[180:183], a[164:167], v[200:203]
v_mfma_f32_16x16x32_bf16 v[204:207], v[180:183], a[236:239], v[204:207]
ds_read_b128 v[180:183], v14 offset:8704
s_waitcnt lgkmcnt(3)
v_mfma_f32_16x16x32_bf16 v[192:195], a[24:27], v[184:187], v[192:195]
v_mfma_f32_16x16x32_bf16 v[196:199], a[96:99], v[184:187], v[196:199]
v_mfma_f32_16x16x32_bf16 v[200:203], v[184:187], a[168:171], v[200:203]
v_mfma_f32_16x16x32_bf16 v[204:207], v[184:187], a[240:243], v[204:207]
s_waitcnt lgkmcnt(2)
v_mfma_f32_16x16x32_bf16 v[192:195], a[28:31], v[188:191], v[192:195]
v_mfma_f32_16x16x32_bf16 v[196:199], a[100:103], v[188:191], v[196:199]
v_mfma_f32_16x16x32_bf16 v[200:203], v[188:191], a[172:175], v[200:203]
v_mfma_f32_16x16x32_bf16 v[204:207], v[188:191], a[244:247], v[204:207]
s_waitcnt lgkmcnt(1)
v_mfma_f32_16x16x32_bf16 v[192:195], a[32:35], v[176:179], v[192:195]
v_mfma_f32_16x16x32_bf16 v[196:199], a[104:107], v[176:179], v[196:199]
v_mfma_f32_16x16x32_bf16 v[200:203], v[176:179], a[176:179], v[200:203]
v_mfma_f32_16x16x32_bf16 v[204:207], v[176:179], a[248:251], v[204:207]
s_waitcnt lgkmcnt(0)
v_mfma_f32_16x16x32_bf16 v[192:195], a[36:39], v[180:183], v[192:195]
v_mfma_f32_16x16x32_bf16 v[196:199], a[108:111], v[180:183], v[196:199]
v_mfma_f32_16x16x32_bf16 v[200:203], v[180:183], a[180:183], v[200:203]
v_mfma_f32_16x16x32_bf16 v[204:207], v[180:183], a[252:255], v[204:207]
v_mul_f32 v192, s46, v192
v_mul_f32 v193, s46, v193
v_mul_f32 v194, s46, v194
v_mul_f32 v195, s46, v195
v_mul_f32 v196, s46, v196
v_mul_f32 v197, s46, v197
v_mul_f32 v198, s46, v198
v_mul_f32 v199, s46, v199
v_cvt_pk_bf16_f32 v208, v192, v193
v_cvt_pk_bf16_f32 v209, v194, v195
v_cvt_pk_bf16_f32 v210, v196, v197
v_cvt_pk_bf16_f32 v211, v198, v199
ds_write_b128 v6, v[208:211] offset:9216
v_cvt_pk_bf16_f32 v212, v200, v201
v_cvt_pk_bf16_f32 v213, v202, v203
v_cvt_pk_bf16_f32 v214, v204, v205
v_cvt_pk_bf16_f32 v215, v206, v207
ds_write_b128 v6, v[212:215] offset:13312
s_waitcnt lgkmcnt(0)
s_barrier
ds_read_b128 v[108:111], v1 offset:9216
ds_read_b128 v[112:115], v1 offset:10240
ds_read_b128 v[116:119], v1 offset:11264
ds_read_b128 v[120:123], v1 offset:12288
ds_read_b128 v[124:127], v3 offset:13312
ds_read_b128 v[128:131], v3 offset:14336
s_waitcnt lgkmcnt(5)
v_mfma_f32_16x16x32_bf16 v[104:107], v[108:111], v[16:19], v[88:91]
s_waitcnt lgkmcnt(4)
v_mfma_f32_16x16x32_bf16 v[104:107], v[112:115], v[20:23], v[104:107]
s_waitcnt lgkmcnt(3)
v_mfma_f32_16x16x32_bf16 v[104:107], v[116:119], v[24:27], v[104:107]
s_waitcnt lgkmcnt(2)
v_mfma_f32_16x16x32_bf16 v[104:107], v[120:123], v[28:31], v[104:107]
s_nop 7
v_max3_f32 v160, v160, v104, v105
v_max3_f32 v161, v160, v106, v107
v_max3_f32 v160, v160, v106, v107
s_nop 1
v_permlane16_swap_b32 v160, v161
v_max_f32 v162, v160, v161
v_max_f32 v163, v160, v161
s_nop 1
v_permlane32_swap_b32 v162, v163
v_max_f32 v160, v162, v163
v_pk_add_f32 v[96:97], v[96:97], v[160:161] op_sel_hi:[1,0] neg_lo:[0,1] neg_hi:[0,1]
v_pk_add_f32 v[98:99], v[98:99], v[160:161] op_sel_hi:[1,0] neg_lo:[0,1] neg_hi:[0,1]
v_pk_add_f32 v[100:101], v[100:101], v[160:161] op_sel_hi:[1,0] neg_lo:[0,1] neg_hi:[0,1]
v_pk_add_f32 v[102:103], v[102:103], v[160:161] op_sel_hi:[1,0] neg_lo:[0,1] neg_hi:[0,1]
v_pk_add_f32 v[104:105], v[104:105], v[160:161] op_sel_hi:[1,0] neg_lo:[0,1] neg_hi:[0,1]
v_pk_add_f32 v[106:107], v[106:107], v[160:161] op_sel_hi:[1,0] neg_lo:[0,1] neg_hi:[0,1]
v_exp_f32 v96, v96
v_exp_f32 v97, v97
v_exp_f32 v98, v98
v_exp_f32 v99, v99
v_exp_f32 v100, v100
v_exp_f32 v101, v101
v_exp_f32 v102, v102
v_exp_f32 v103, v103
v_exp_f32 v104, v104
v_exp_f32 v105, v105
v_exp_f32 v106, v106
v_exp_f32 v107, v107
v_cvt_pk_bf16_f32 v132, v96, v97
v_cvt_pk_bf16_f32 v133, v98, v99
v_cvt_pk_bf16_f32 v134, v100, v101
v_cvt_pk_bf16_f32 v135, v102, v103
v_cvt_pk_bf16_f32 v136, v104, v105
v_cvt_pk_bf16_f32 v137, v106, v107
v_mfma_f32_16x16x32_bf16 v[156:159], v[92:95], v[132:135], 0
v_mfma_f32_16x16x32_bf16 v[140:143], v[64:67], v[132:135], 0
v_mfma_f32_16x16x32_bf16 v[144:147], v[68:71], v[132:135], 0
v_mfma_f32_16x16x32_bf16 v[148:151], v[72:75], v[132:135], 0
v_mfma_f32_16x16x32_bf16 v[152:155], v[76:79], v[132:135], 0
s_waitcnt lgkmcnt(0)
v_mfma_f32_16x16x16_bf16 v[156:159], v[92:93], v[136:137], v[156:159]
v_mfma_f32_16x16x16_bf16 v[140:143], v[124:125], v[136:137], v[140:143]
v_mfma_f32_16x16x16_bf16 v[144:147], v[126:127], v[136:137], v[144:147]
v_mfma_f32_16x16x16_bf16 v[148:151], v[128:129], v[136:137], v[148:151]
v_mfma_f32_16x16x16_bf16 v[152:155], v[130:131], v[136:137], v[152:155]
v_rcp_f32 v156, v156
s_nop 0
v_mul_f32 v140, v140, v156
v_mul_f32 v141, v141, v156
v_mul_f32 v142, v142, v156
v_mul_f32 v143, v143, v156
v_mul_f32 v144, v144, v156
v_mul_f32 v145, v145, v156
v_mul_f32 v146, v146, v156
v_mul_f32 v147, v147, v156
v_cvt_pk_bf16_f32 v140, v140, v141
v_cvt_pk_bf16_f32 v141, v142, v143
v_cvt_pk_bf16_f32 v142, v144, v145
v_cvt_pk_bf16_f32 v143, v146, v147
buffer_store_dwordx4 v[140:143], v1, s[4:7], s56 offen offset:0 sc0 sc1
v_mul_f32 v148, v148, v156
v_mul_f32 v149, v149, v156
v_mul_f32 v150, v150, v156
v_mul_f32 v151, v151, v156
v_mul_f32 v152, v152, v156
v_mul_f32 v153, v153, v156
v_mul_f32 v154, v154, v156
v_mul_f32 v155, v155, v156
v_cvt_pk_bf16_f32 v148, v148, v149
v_cvt_pk_bf16_f32 v149, v150, v151
v_cvt_pk_bf16_f32 v150, v152, v153
v_cvt_pk_bf16_f32 v151, v154, v155
buffer_store_dwordx4 v[148:151], v1, s[4:7], s56 offen offset:1024 sc0 sc1
s_add_u32 s35, s35, 1
v_mov_b32 v13, s35
s_add_u32 s50, s50, 1048576
s_add_u32 s52, s52, 2097152
s_add_u32 s53, s53, 2097152
s_add_u32 s55, s55, 40960
s_add_u32 s56, s56, 1048576
s_waitcnt vmcnt(0)
s_mov_b64 exec, 1
buffer_store_dword v13, v8, s[4:7], s58 offen sc0 sc1
s_mov_b64 exec, -1
s_cmp_lt_u32 s35, 16
s_cbranch_scc1 L_at_loop
s_waitcnt vmcnt(0)
s_endpgm
L_role_aw:
s_load_dwordx2 s[4:5], s[0:1], 104
s_mov_b32 s6, 268435456
s_mov_b32 s7, 0x20000
s_load_dwordx2 s[8:9], s[0:1], 0
s_mov_b32 s10, 2359296
s_mov_b32 s11, 0x20000
s_load_dwordx2 s[12:13], s[0:1], 8
s_mov_b32 s14, 1990656
s_mov_b32 s15, 0x20000
s_load_dwordx2 s[16:17], s[0:1], 16
s_mov_b32 s18, 663552
s_mov_b32 s19, 0x20000
s_load_dwordx2 s[20:21], s[0:1], 64
s_mov_b32 s22, 4718592
s_mov_b32 s23, 0x20000
s_load_dwordx2 s[24:25], s[0:1], 96
s_mov_b32 s26, 256
s_mov_b32 s27, 0x20000
s_load_dwordx2 s[28:29], s[0:1], 88
s_mov_b32 s30, 2359296
s_mov_b32 s31, 0x20000
s_load_dwordx2 s[64:65], s[0:1], 80
s_mov_b32 s66, 1152
s_mov_b32 s67, 0x20000
v_and_b32 v9, 63, v0
v_and_b32 v10, 15, v0
v_bfe_u32 v11, v0, 4, 2
v_lshrrev_b32 v1, 6, v0
s_nop 0
v_readfirstlane_b32 s34, v1
v_lshrrev_b32 v12, 2, v9
v_mul_u32_u24 v2, 1152, v12
v_lshrrev_b32 v12, 5, v9
v_lshlrev_b32 v12, 1, v12
v_and_b32 v13, 3, v9
v_xor_b32 v12, v12, v13
v_lshl_add_u32 v2, v12, 4, v2
v_lshrrev_b32 v12, 3, v10
v_lshlrev_b32 v12, 1, v12
v_xor_b32 v12, v12, v11
v_lshlrev_b32 v12, 4, v12
v_lshl_add_u32 v3, v10, 6, v12
v_lshrrev_b32 v12, 2, v10
v_lshl_add_u32 v12, v11, 3, v12
v_mul_u32_u24 v7, 64, v12
v_and_b32 v12, 3, v10
v_lshl_add_u32 v7, v12, 3, v7
v_lshlrev_b32 v1, 4, v9
s_mul_i32 s38, s34, 20480
s_add_u32 s38, s38, 73728
v_add_u32 v7, s38, v7
v_mov_b32 v8, 0
s_lshl_b32 s37, s34, 3
s_add_u32 s37, s37, 0
v_and_b32 v12, 3, v9
v_add_u32 v12, s37, v12
v_min_u32 v12, 26, v12
v_mul_u32_u24 v13, 57, v12
v_lshrrev_b32 v13, 9, v13
v_mul_u32_u24 v13, 1008, v13
v_lshl_add_u32 v13, v12, 4, v13
v_lshrrev_b32 v12, 2, v9
v_mul_u32_u24 v12, 3456, v12
v_add_u32 v5, v12, v13
s_lshl_b32 s37, s34, 3
s_add_u32 s37, s37, 4
v_and_b32 v12, 3, v9
v_add_u32 v12, s37, v12
v_min_u32 v12, 26, v12
v_mul_u32_u24 v13, 57, v12
v_lshrrev_b32 v13, 9, v13
v_mul_u32_u24 v13, 1008, v13
v_lshl_add_u32 v13, v12, 4, v13
v_lshrrev_b32 v12, 2, v9
v_mul_u32_u24 v12, 3456, v12
v_add_u32 v6, v12, v13
s_mul_i32 s39, s32, 144
s_mul_i32 s40, s33, 11
s_and_b32 s41, s34, 1
s_add_u32 s40, s40, s41
s_sub_u32 s40, s40, 1
s_max_i32 s41, s40, 0
s_lshr_b32 s42, s34, 1
s_lshl_b32 s42, s42, 6
s_mul_i32 s43, s41, 18432
s_add_u32 s43, s43, s42
s_mul_i32 s40, s40, 18432
s_add_u32 s40, s40, s42
s_lshl_b32 s44, s34, 10
s_mov_b32 s36, 400000
v_mul_u32_u24 v4, 456, v10
v_lshl_add_u32 v4, v11, 3, v4
s_lshl_b32 s37, s34, 7
s_add_u32 s37, s37, 73728
v_add_u32 v4, s37, v4
v_lshlrev_b32 v14, 2, v10
v_add_u32 v14, 161280, v14
s_waitcnt lgkmcnt(0)
s_add_u32 s37, s39, 0
s_add_u32 m0, s38, 0
s_nop 0
buffer_load_dwordx4 v5, s[12:15], s37 offen lds
s_add_u32 s37, s39, 55296
s_add_u32 m0, s38, 1024
s_nop 0
buffer_load_dwordx4 v5, s[12:15], s37 offen lds
s_add_u32 s37, s39, 110592
s_add_u32 m0, s38, 2048
s_nop 0
buffer_load_dwordx4 v5, s[12:15], s37 offen lds
s_add_u32 s37, s39, 165888
s_add_u32 m0, s38, 3072
s_nop 0
buffer_load_dwordx4 v5, s[12:15], s37 offen lds
s_add_u32 s37, s39, 221184
s_add_u32 m0, s38, 4096
s_nop 0
buffer_load_dwordx4 v5, s[12:15], s37 offen lds
s_add_u32 s37, s39, 276480
s_add_u32 m0, s38, 5120
s_nop 0
buffer_load_dwordx4 v5, s[12:15], s37 offen lds
s_add_u32 s37, s39, 331776
s_add_u32 m0, s38, 6144
s_nop 0
buffer_load_dwordx4 v5, s[12:15], s37 offen lds
s_add_u32 s37, s39, 387072
s_add_u32 m0, s38, 7168
s_nop 0
buffer_load_dwordx4 v5, s[12:15], s37 offen lds
s_add_u32 s37, s39, 442368
s_add_u32 m0, s38, 8192
s_nop 0
buffer_load_dwordx4 v5, s[12:15], s37 offen lds
s_add_u32 s37, s39, 497664
s_add_u32 m0, s38, 9216
s_nop 0
buffer_load_dwordx4 v5, s[12:15], s37 offen lds
s_add_u32 s37, s39, 552960
s_add_u32 m0, s38, 10240
s_nop 0
buffer_load_dwordx4 v5, s[12:15], s37 offen lds
s_add_u32 s37, s39, 608256
s_add_u32 m0, s38, 11264
s_nop 0
buffer_load_dwordx4 v5, s[12:15], s37 offen lds
s_add_u32 s37, s39, 663552
s_add_u32 m0, s38, 12288
s_nop 0
buffer_load_dwordx4 v5, s[12:15], s37 offen lds
s_add_u32 s37, s39, 718848
s_add_u32 m0, s38, 13312
s_nop 0
buffer_load_dwordx4 v5, s[12:15], s37 offen lds
s_add_u32 s37, s39, 774144
s_add_u32 m0, s38, 14336
s_nop 0
buffer_load_dwordx4 v5, s[12:15], s37 offen lds
s_add_u32 s37, s39, 829440
s_add_u32 m0, s38, 15360
s_nop 0
buffer_load_dwordx4 v5, s[12:15], s37 offen lds
s_add_u32 s37, s43, 0
s_add_u32 m0, s44, 0
s_nop 0
buffer_load_dwordx4 v2, s[8:11], s37 offen lds
s_add_u32 s37, s43, 128
s_add_u32 m0, s44, 4096
s_nop 0
buffer_load_dwordx4 v2, s[8:11], s37 offen lds
s_add_u32 s37, s43, 256
s_add_u32 m0, s44, 8192
s_nop 0
buffer_load_dwordx4 v2, s[8:11], s37 offen lds
s_add_u32 s37, s43, 384
s_add_u32 m0, s44, 12288
s_nop 0
buffer_load_dwordx4 v2, s[8:11], s37 offen lds
s_add_u32 s37, s43, 512
s_add_u32 m0, s44, 16384
s_nop 0
buffer_load_dwordx4 v2, s[8:11], s37 offen lds
s_add_u32 s37, s43, 640
s_add_u32 m0, s44, 20480
s_nop 0
buffer_load_dwordx4 v2, s[8:11], s37 offen lds
s_add_u32 s37, s43, 768
s_add_u32 m0, s44, 24576
s_nop 0
buffer_load_dwordx4 v2, s[8:11], s37 offen lds
s_add_u32 s37, s43, 896
s_add_u32 m0, s44, 28672
s_nop 0
buffer_load_dwordx4 v2, s[8:11], s37 offen lds
s_add_u32 s37, s43, 1024
s_add_u32 m0, s44, 32768
s_nop 0
buffer_load_dwordx4 v2, s[8:11], s37 offen lds
s_waitcnt vmcnt(21)
ds_read_b64_tr_b16 v[80:81], v7 offset:0
ds_read_b64_tr_b16 v[82:83], v7 offset:256
ds_read_b64_tr_b16 v[84:85], v7 offset:2048
ds_read_b64_tr_b16 v[86:87], v7 offset:2304
ds_read_b64_tr_b16 v[152:153], v7 offset:32
ds_read_b64_tr_b16 v[154:155], v7 offset:288
ds_read_b64_tr_b16 v[156:157], v7 offset:2080
ds_read_b64_tr_b16 v[158:159], v7 offset:2336
s_waitcnt lgkmcnt(0)
s_add_u32 s37, s39, 884736
s_add_u32 m0, s38, 16384
s_nop 0
buffer_load_dwordx4 v5, s[12:15], s37 offen lds
s_add_u32 s37, s39, 940032
s_add_u32 m0, s38, 17408
s_nop 0
buffer_load_dwordx4 v5, s[12:15], s37 offen lds
s_add_u32 s37, s39, 995328
s_add_u32 m0, s38, 18432
s_nop 0
buffer_load_dwordx4 v5, s[12:15], s37 offen lds
s_add_u32 s37, s39, 1050624
s_add_u32 m0, s38, 19456
s_nop 0
buffer_load_dwordx4 v5, s[12:15], s37 offen lds
s_waitcnt vmcnt(21)
ds_read_b64_tr_b16 v[88:89], v7 offset:4096
ds_read_b64_tr_b16 v[90:91], v7 offset:4352
ds_read_b64_tr_b16 v[92:93], v7 offset:6144
ds_read_b64_tr_b16 v[94:95], v7 offset:6400
ds_read_b64_tr_b16 v[160:161], v7 offset:4128
ds_read_b64_tr_b16 v[162:163], v7 offset:4384
ds_read_b64_tr_b16 v[164:165], v7 offset:6176
ds_read_b64_tr_b16 v[166:167], v7 offset:6432
s_waitcnt lgkmcnt(0)
s_add_u32 s37, s39, 1105920
s_add_u32 m0, s38, 0
s_nop 0
buffer_load_dwordx4 v5, s[12:15], s37 offen lds
s_add_u32 s37, s39, 1161216
s_add_u32 m0, s38, 1024
s_nop 0
buffer_load_dwordx4 v5, s[12:15], s37 offen lds
s_add_u32 s37, s39, 1216512
s_add_u32 m0, s38, 2048
s_nop 0
buffer_load_dwordx4 v5, s[12:15], s37 offen lds
s_add_u32 s37, s39, 1271808
s_add_u32 m0, s38, 3072
s_nop 0
buffer_load_dwordx4 v5, s[12:15], s37 offen lds
s_waitcnt vmcnt(21)
ds_read_b64_tr_b16 v[96:97], v7 offset:8192
ds_read_b64_tr_b16 v[98:99], v7 offset:8448
ds_read_b64_tr_b16 v[100:101], v7 offset:10240
ds_read_b64_tr_b16 v[102:103], v7 offset:10496
ds_read_b64_tr_b16 v[168:169], v7 offset:8224
ds_read_b64_tr_b16 v[170:171], v7 offset:8480
ds_read_b64_tr_b16 v[172:173], v7 offset:10272
ds_read_b64_tr_b16 v[174:175], v7 offset:10528
s_waitcnt lgkmcnt(0)
s_add_u32 s37, s39, 1327104
s_add_u32 m0, s38, 4096
s_nop 0
buffer_load_dwordx4 v5, s[12:15], s37 offen lds
s_add_u32 s37, s39, 1382400
s_add_u32 m0, s38, 5120
s_nop 0
buffer_load_dwordx4 v5, s[12:15], s37 offen lds
s_add_u32 s37, s39, 1437696
s_add_u32 m0, s38, 6144
s_nop 0
buffer_load_dwordx4 v5, s[12:15], s37 offen lds
s_add_u32 s37, s39, 1492992
s_add_u32 m0, s38, 7168
s_nop 0
buffer_load_dwordx4 v5, s[12:15], s37 offen lds
s_waitcnt vmcnt(21)
ds_read_b64_tr_b16 v[104:105], v7 offset:12288
ds_read_b64_tr_b16 v[106:107], v7 offset:12544
ds_read_b64_tr_b16 v[108:109], v7 offset:14336
ds_read_b64_tr_b16 v[110:111], v7 offset:14592
ds_read_b64_tr_b16 v[176:177], v7 offset:12320
ds_read_b64_tr_b16 v[178:179], v7 offset:12576
ds_read_b64_tr_b16 v[180:181], v7 offset:14368
ds_read_b64_tr_b16 v[182:183], v7 offset:14624
s_waitcnt lgkmcnt(0)
s_add_u32 s37, s39, 1548288
s_add_u32 m0, s38, 8192
s_nop 0
buffer_load_dwordx4 v5, s[12:15], s37 offen lds
s_add_u32 s37, s39, 1603584
s_add_u32 m0, s38, 9216
s_nop 0
buffer_load_dwordx4 v5, s[12:15], s37 offen lds
s_add_u32 s37, s39, 1658880
s_add_u32 m0, s38, 10240
s_nop 0
buffer_load_dwordx4 v5, s[12:15], s37 offen lds
s_add_u32 s37, s39, 1714176
s_add_u32 m0, s38, 11264
s_nop 0
buffer_load_dwordx4 v5, s[12:15], s37 offen lds
s_waitcnt vmcnt(12)
ds_read_b64_tr_b16 v[112:113], v7 offset:16384
ds_read_b64_tr_b16 v[114:115], v7 offset:16640
ds_read_b64_tr_b16 v[116:117], v7 offset:18432
ds_read_b64_tr_b16 v[118:119], v7 offset:18688
ds_read_b64_tr_b16 v[184:185], v7 offset:16416
ds_read_b64_tr_b16 v[186:187], v7 offset:16672
ds_read_b64_tr_b16 v[188:189], v7 offset:18464
ds_read_b64_tr_b16 v[190:191], v7 offset:18720
s_waitcnt lgkmcnt(0)
s_add_u32 s37, s39, 1769472
s_add_u32 m0, s38, 12288
s_nop 0
buffer_load_dwordx4 v5, s[12:15], s37 offen lds
s_add_u32 s37, s39, 1824768
s_add_u32 m0, s38, 13312
s_nop 0
buffer_load_dwordx4 v5, s[12:15], s37 offen lds
s_add_u32 s37, s39, 1880064
s_add_u32 m0, s38, 14336
s_nop 0
buffer_load_dwordx4 v5, s[12:15], s37 offen lds
s_add_u32 s37, s39, 1935360
s_add_u32 m0, s38, 15360
s_nop 0
buffer_load_dwordx4 v5, s[12:15], s37 offen lds
s_waitcnt vmcnt(12)
ds_read_b64_tr_b16 v[120:121], v7 offset:0
ds_read_b64_tr_b16 v[122:123], v7 offset:256
ds_read_b64_tr_b16 v[124:125], v7 offset:2048
ds_read_b64_tr_b16 v[126:127], v7 offset:2304
ds_read_b64_tr_b16 v[192:193], v7 offset:32
ds_read_b64_tr_b16 v[194:195], v7 offset:288
ds_read_b64_tr_b16 v[196:197], v7 offset:2080
ds_read_b64_tr_b16 v[198:199], v7 offset:2336
s_waitcnt lgkmcnt(0)
s_add_u32 s37, s39, 0
s_add_u32 m0, s38, 16384
s_nop 0
buffer_load_dwordx4 v6, s[12:15], s37 offen lds
s_add_u32 s37, s39, 55296
s_add_u32 m0, s38, 17408
s_nop 0
buffer_load_dwordx4 v6, s[12:15], s37 offen lds
s_add_u32 s37, s39, 110592
s_add_u32 m0, s38, 18432
s_nop 0
buffer_load_dwordx4 v6, s[12:15], s37 offen lds
s_add_u32 s37, s39, 165888
s_add_u32 m0, s38, 19456
s_nop 0
buffer_load_dwordx4 v6, s[12:15], s37 offen lds
s_waitcnt vmcnt(12)
ds_read_b64_tr_b16 v[128:129], v7 offset:4096
ds_read_b64_tr_b16 v[130:131], v7 offset:4352
ds_read_b64_tr_b16 v[132:133], v7 offset:6144
ds_read_b64_tr_b16 v[134:135], v7 offset:6400
ds_read_b64_tr_b16 v[200:201], v7 offset:4128
ds_read_b64_tr_b16 v[202:203], v7 offset:4384
ds_read_b64_tr_b16 v[204:205], v7 offset:6176
ds_read_b64_tr_b16 v[206:207], v7 offset:6432
s_waitcnt lgkmcnt(0)
s_add_u32 s37, s39, 221184
s_add_u32 m0, s38, 0
s_nop 0
buffer_load_dwordx4 v6, s[12:15], s37 offen lds
s_add_u32 s37, s39, 276480
s_add_u32 m0, s38, 1024
s_nop 0
buffer_load_dwordx4 v6, s[12:15], s37 offen lds
s_add_u32 s37, s39, 331776
s_add_u32 m0, s38, 2048
s_nop 0
buffer_load_dwordx4 v6, s[12:15], s37 offen lds
s_add_u32 s37, s39, 387072
s_add_u32 m0, s38, 3072
s_nop 0
buffer_load_dwordx4 v6, s[12:15], s37 offen lds
s_waitcnt vmcnt(12)
ds_read_b64_tr_b16 v[136:137], v7 offset:8192
ds_read_b64_tr_b16 v[138:139], v7 offset:8448
ds_read_b64_tr_b16 v[140:141], v7 offset:10240
ds_read_b64_tr_b16 v[142:143], v7 offset:10496
ds_read_b64_tr_b16 v[208:209], v7 offset:8224
ds_read_b64_tr_b16 v[210:211], v7 offset:8480
ds_read_b64_tr_b16 v[212:213], v7 offset:10272
ds_read_b64_tr_b16 v[214:215], v7 offset:10528
s_waitcnt lgkmcnt(0)
s_add_u32 s37, s39, 442368
s_add_u32 m0, s38, 4096
s_nop 0
buffer_load_dwordx4 v6, s[12:15], s37 offen lds
s_add_u32 s37, s39, 497664
s_add_u32 m0, s38, 5120
s_nop 0
buffer_load_dwordx4 v6, s[12:15], s37 offen lds
s_add_u32 s37, s39, 552960
s_add_u32 m0, s38, 6144
s_nop 0
buffer_load_dwordx4 v6, s[12:15], s37 offen lds
s_add_u32 s37, s39, 608256
s_add_u32 m0, s38, 7168
s_nop 0
buffer_load_dwordx4 v6, s[12:15], s37 offen lds
s_waitcnt vmcnt(12)
ds_read_b64_tr_b16 v[144:145], v7 offset:12288
ds_read_b64_tr_b16 v[146:147], v7 offset:12544
ds_read_b64_tr_b16 v[148:149], v7 offset:14336
ds_read_b64_tr_b16 v[150:151], v7 offset:14592
ds_read_b64_tr_b16 v[216:217], v7 offset:12320
ds_read_b64_tr_b16 v[218:219], v7 offset:12576
ds_read_b64_tr_b16 v[220:221], v7 offset:14368
ds_read_b64_tr_b16 v[222:223], v7 offset:14624
s_waitcnt lgkmcnt(0)
s_add_u32 s37, s39, 663552
s_add_u32 m0, s38, 8192
s_nop 0
buffer_load_dwordx4 v6, s[12:15], s37 offen lds
s_add_u32 s37, s39, 718848
s_add_u32 m0, s38, 9216
s_nop 0
buffer_load_dwordx4 v6, s[12:15], s37 offen lds
s_add_u32 s37, s39, 774144
s_add_u32 m0, s38, 10240
s_nop 0
buffer_load_dwordx4 v6, s[12:15], s37 offen lds
s_add_u32 s37, s39, 829440
s_add_u32 m0, s38, 11264
s_nop 0
buffer_load_dwordx4 v6, s[12:15], s37 offen lds
s_waitcnt vmcnt(12)
ds_read_b64_tr_b16 v[224:225], v7 offset:16384
ds_read_b64_tr_b16 v[226:227], v7 offset:16640
ds_read_b64_tr_b16 v[228:229], v7 offset:18432
ds_read_b64_tr_b16 v[230:231], v7 offset:18688
ds_read_b64_tr_b16 a[40:41], v7 offset:16416
ds_read_b64_tr_b16 a[42:43], v7 offset:16672
ds_read_b64_tr_b16 a[44:45], v7 offset:18464
ds_read_b64_tr_b16 a[46:47], v7 offset:18720
s_waitcnt lgkmcnt(0)
s_add_u32 s37, s39, 884736
s_add_u32 m0, s38, 12288
s_nop 0
buffer_load_dwordx4 v6, s[12:15], s37 offen lds
s_add_u32 s37, s39, 940032
s_add_u32 m0, s38, 13312
s_nop 0
buffer_load_dwordx4 v6, s[12:15], s37 offen lds
s_add_u32 s37, s39, 995328
s_add_u32 m0, s38, 14336
s_nop 0
buffer_load_dwordx4 v6, s[12:15], s37 offen lds
s_add_u32 s37, s39, 1050624
s_add_u32 m0, s38, 15360
s_nop 0
buffer_load_dwordx4 v6, s[12:15], s37 offen lds
s_waitcnt vmcnt(12)
ds_read_b64_tr_b16 v[232:233], v7 offset:0
ds_read_b64_tr_b16 v[234:235], v7 offset:256
ds_read_b64_tr_b16 v[236:237], v7 offset:2048
ds_read_b64_tr_b16 v[238:239], v7 offset:2304
ds_read_b64_tr_b16 a[48:49], v7 offset:32
ds_read_b64_tr_b16 a[50:51], v7 offset:288
ds_read_b64_tr_b16 a[52:53], v7 offset:2080
ds_read_b64_tr_b16 a[54:55], v7 offset:2336
s_waitcnt lgkmcnt(0)
s_add_u32 s37, s39, 1105920
s_add_u32 m0, s38, 16384
s_nop 0
buffer_load_dwordx4 v6, s[12:15], s37 offen lds
s_add_u32 s37, s39, 1161216
s_add_u32 m0, s38, 17408
s_nop 0
buffer_load_dwordx4 v6, s[12:15], s37 offen lds
s_add_u32 s37, s39, 1216512
s_add_u32 m0, s38, 18432
s_nop 0
buffer_load_dwordx4 v6, s[12:15], s37 offen lds
s_add_u32 s37, s39, 1271808
s_add_u32 m0, s38, 19456
s_nop 0
buffer_load_dwordx4 v6, s[12:15], s37 offen lds
s_waitcnt vmcnt(12)
ds_read_b64_tr_b16 v[240:241], v7 offset:4096
ds_read_b64_tr_b16 v[242:243], v7 offset:4352
ds_read_b64_tr_b16 v[244:245], v7 offset:6144
ds_read_b64_tr_b16 v[246:247], v7 offset:6400
ds_read_b64_tr_b16 a[56:57], v7 offset:4128
ds_read_b64_tr_b16 a[58:59], v7 offset:4384
ds_read_b64_tr_b16 a[60:61], v7 offset:6176
ds_read_b64_tr_b16 a[62:63], v7 offset:6432
s_waitcnt lgkmcnt(0)
s_add_u32 s37, s39, 1327104
s_add_u32 m0, s38, 0
s_nop 0
buffer_load_dwordx4 v6, s[12:15], s37 offen lds
s_add_u32 s37, s39, 1382400
s_add_u32 m0, s38, 1024
s_nop 0
buffer_load_dwordx4 v6, s[12:15], s37 offen lds
s_add_u32 s37, s39, 1437696
s_add_u32 m0, s38, 2048
s_nop 0
buffer_load_dwordx4 v6, s[12:15], s37 offen lds
s_add_u32 s37, s39, 1492992
s_add_u32 m0, s38, 3072
s_nop 0
buffer_load_dwordx4 v6, s[12:15], s37 offen lds
s_waitcnt vmcnt(12)
ds_read_b64_tr_b16 v[248:249], v7 offset:8192
ds_read_b64_tr_b16 v[250:251], v7 offset:8448
ds_read_b64_tr_b16 v[252:253], v7 offset:10240
ds_read_b64_tr_b16 v[254:255], v7 offset:10496
ds_read_b64_tr_b16 a[64:65], v7 offset:8224
ds_read_b64_tr_b16 a[66:67], v7 offset:8480
ds_read_b64_tr_b16 a[68:69], v7 offset:10272
ds_read_b64_tr_b16 a[70:71], v7 offset:10528
s_waitcnt lgkmcnt(0)
s_add_u32 s37, s39, 1548288
s_add_u32 m0, s38, 4096
s_nop 0
buffer_load_dwordx4 v6, s[12:15], s37 offen lds
s_add_u32 s37, s39, 1603584
s_add_u32 m0, s38, 5120
s_nop 0
buffer_load_dwordx4 v6, s[12:15], s37 offen lds
s_add_u32 s37, s39, 1658880
s_add_u32 m0, s38, 6144
s_nop 0
buffer_load_dwordx4 v6, s[12:15], s37 offen lds
s_add_u32 s37, s39, 1714176
s_add_u32 m0, s38, 7168
s_nop 0
buffer_load_dwordx4 v6, s[12:15], s37 offen lds
s_waitcnt vmcnt(12)
ds_read_b64_tr_b16 a[0:1], v7 offset:12288
ds_read_b64_tr_b16 a[2:3], v7 offset:12544
ds_read_b64_tr_b16 a[4:5], v7 offset:14336
ds_read_b64_tr_b16 a[6:7], v7 offset:14592
ds_read_b64_tr_b16 a[72:73], v7 offset:12320
ds_read_b64_tr_b16 a[74:75], v7 offset:12576
ds_read_b64_tr_b16 a[76:77], v7 offset:14368
ds_read_b64_tr_b16 a[78:79], v7 offset:14624
s_waitcnt lgkmcnt(0)
s_add_u32 s37, s39, 1769472
s_add_u32 m0, s38, 8192
s_nop 0
buffer_load_dwordx4 v6, s[12:15], s37 offen lds
s_add_u32 s37, s39, 1824768
s_add_u32 m0, s38, 9216
s_nop 0
buffer_load_dwordx4 v6, s[12:15], s37 offen lds
s_add_u32 s37, s39, 1880064
s_add_u32 m0, s38, 10240
s_nop 0
buffer_load_dwordx4 v6, s[12:15], s37 offen lds
s_add_u32 s37, s39, 1935360
s_add_u32 m0, s38, 11264
s_nop 0
buffer_load_dwordx4 v6, s[12:15], s37 offen lds
s_waitcnt vmcnt(12)
ds_read_b64_tr_b16 a[8:9], v7 offset:16384
ds_read_b64_tr_b16 a[10:11], v7 offset:16640
ds_read_b64_tr_b16 a[12:13], v7 offset:18432
ds_read_b64_tr_b16 a[14:15], v7 offset:18688
ds_read_b64_tr_b16 a[80:81], v7 offset:16416
ds_read_b64_tr_b16 a[82:83], v7 offset:16672
ds_read_b64_tr_b16 a[84:85], v7 offset:18464
ds_read_b64_tr_b16 a[86:87], v7 offset:18720
s_waitcnt lgkmcnt(0)
s_waitcnt vmcnt(8)
ds_read_b64_tr_b16 a[16:17], v7 offset:0
ds_read_b64_tr_b16 a[18:19], v7 offset:256
ds_read_b64_tr_b16 a[20:21], v7 offset:2048
ds_read_b64_tr_b16 a[22:23], v7 offset:2304
ds_read_b64_tr_b16 a[88:89], v7 offset:32
ds_read_b64_tr_b16 a[90:91], v7 offset:288
ds_read_b64_tr_b16 a[92:93], v7 offset:2080
ds_read_b64_tr_b16 a[94:95], v7 offset:2336
s_waitcnt lgkmcnt(0)
s_waitcnt vmcnt(4)
ds_read_b64_tr_b16 a[24:25], v7 offset:4096
ds_read_b64_tr_b16 a[26:27], v7 offset:4352
ds_read_b64_tr_b16 a[28:29], v7 offset:6144
ds_read_b64_tr_b16 a[30:31], v7 offset:6400
ds_read_b64_tr_b16 a[96:97], v7 offset:4128
ds_read_b64_tr_b16 a[98:99], v7 offset:4384
ds_read_b64_tr_b16 a[100:101], v7 offset:6176
ds_read_b64_tr_b16 a[102:103], v7 offset:6432
s_waitcnt lgkmcnt(0)
s_waitcnt vmcnt(0)
ds_read_b64_tr_b16 a[32:33], v7 offset:8192
ds_read_b64_tr_b16 a[34:35], v7 offset:8448
ds_read_b64_tr_b16 a[36:37], v7 offset:10240
ds_read_b64_tr_b16 a[38:39], v7 offset:10496
ds_read_b64_tr_b16 a[104:105], v7 offset:8224
ds_read_b64_tr_b16 a[106:107], v7 offset:8480
ds_read_b64_tr_b16 a[108:109], v7 offset:10272
ds_read_b64_tr_b16 a[110:111], v7 offset:10528
s_waitcnt lgkmcnt(0)
s_cmp_lg_u32 s34, 3
s_cbranch_scc1 L_a_nogate
v_lshlrev_b32 v12, 4, v11
buffer_load_dwordx4 v[224:227], v12, s[64:67], 0 offen offset:0
buffer_load_dwordx4 v[228:231], v12, s[64:67], 0 offen offset:64
buffer_load_dwordx4 v[232:235], v12, s[64:67], 0 offen offset:128
buffer_load_dwordx4 v[236:239], v12, s[64:67], 0 offen offset:192
buffer_load_dwordx4 v[240:243], v12, s[64:67], 0 offen offset:256
buffer_load_dwordx4 v[244:247], v12, s[64:67], 0 offen offset:320
buffer_load_dwordx4 v[248:251], v12, s[64:67], 0 offen offset:384
buffer_load_dwordx4 v[252:255], v12, s[64:67], 0 offen offset:448
buffer_load_dwordx4 a[0:3], v12, s[64:67], 0 offen offset:512
buffer_load_dwordx4 a[4:7], v12, s[64:67], 0 offen offset:576
buffer_load_dwordx4 a[8:11], v12, s[64:67], 0 offen offset:640
buffer_load_dwordx4 a[12:15], v12, s[64:67], 0 offen offset:704
buffer_load_dwordx4 a[16:19], v12, s[64:67], 0 offen offset:768
buffer_load_dwordx4 a[20:23], v12, s[64:67], 0 offen offset:832
buffer_load_dwordx4 a[24:27], v12, s[64:67], 0 offen offset:896
buffer_load_dwordx4 a[28:31], v12, s[64:67], 0 offen offset:960
buffer_load_dwordx4 a[32:35], v12, s[64:67], 0 offen offset:1024
buffer_load_dwordx4 a[36:39], v12, s[64:67], 0 offen offset:1088
L_a_nogate:
s_mov_b32 s43, s40
s_mov_b32 s35, 0
s_mov_b32 s50, 36864
.p2align 6
L_a_loop:
s_waitcnt vmcnt(0)
s_barrier
s_add_u32 s43, s43, 36864
s_add_u32 s44, s44, s50
ds_read_b128 v[64:67], v3 offset:0
ds_read_b128 v[68:71], v3 offset:1024
ds_read_b128 v[72:75], v3 offset:2048
ds_read_b128 v[76:79], v3 offset:3072
s_waitcnt lgkmcnt(2)
v_mfma_f32_16x16x32_bf16 v[16:19], v[80:83], v[64:67], 0
v_mfma_f32_16x16x32_bf16 v[20:23], v[80:83], v[68:71], 0
v_mfma_f32_16x16x32_bf16 v[24:27], v[152:155], v[64:67], 0
v_mfma_f32_16x16x32_bf16 v[28:31], v[152:155], v[68:71], 0
s_add_u32 s37, s43, 0
s_add_u32 m0, s44, 0
s_nop 0
buffer_load_dwordx4 v2, s[8:11], s37 offen lds
v_mfma_f32_16x16x32_bf16 v[32:35], v[224:227], v[64:67], 0
v_mfma_f32_16x16x32_bf16 v[36:39], v[224:227], v[68:71], 0
v_mfma_f32_16x16x32_bf16 v[40:43], a[40:43], v[64:67], 0
v_mfma_f32_16x16x32_bf16 v[44:47], a[40:43], v[68:71], 0
ds_read_b128 v[64:67], v3 offset:4096
ds_read_b128 v[68:71], v3 offset:5120
s_waitcnt lgkmcnt(2)
v_mfma_f32_16x16x32_bf16 v[16:19], v[84:87], v[72:75], v[16:19]
v_mfma_f32_16x16x32_bf16 v[20:23], v[84:87], v[76:79], v[20:23]
v_mfma_f32_16x16x32_bf16 v[24:27], v[156:159], v[72:75], v[24:27]
v_mfma_f32_16x16x32_bf16 v[28:31], v[156:159], v[76:79], v[28:31]
s_add_u32 s37, s43, 128
s_add_u32 m0, s44, 4096
s_nop 0
buffer_load_dwordx4 v2, s[8:11], s37 offen lds
v_mfma_f32_16x16x32_bf16 v[32:35], v[228:231], v[72:75], v[32:35]
v_mfma_f32_16x16x32_bf16 v[36:39], v[228:231], v[76:79], v[36:39]
v_mfma_f32_16x16x32_bf16 v[40:43], a[44:47], v[72:75], v[40:43]
v_mfma_f32_16x16x32_bf16 v[44:47], a[44:47], v[76:79], v[44:47]
ds_read_b128 v[72:75], v3 offset:6144
ds_read_b128 v[76:79], v3 offset:7168
s_waitcnt lgkmcnt(2)
v_mfma_f32_16x16x32_bf16 v[16:19], v[88:91], v[64:67], v[16:19]
v_mfma_f32_16x16x32_bf16 v[20:23], v[88:91], v[68:71], v[20:23]
v_mfma_f32_16x16x32_bf16 v[24:27], v[160:163], v[64:67], v[24:27]
v_mfma_f32_16x16x32_bf16 v[28:31], v[160:163], v[68:71], v[28:31]
s_add_u32 s37, s43, 256
s_add_u32 m0, s44, 8192
s_nop 0
buffer_load_dwordx4 v2, s[8:11], s37 offen lds
v_mfma_f32_16x16x32_bf16 v[32:35], v[232:235], v[64:67], v[32:35]
v_mfma_f32_16x16x32_bf16 v[36:39], v[232:235], v[68:71], v[36:39]
v_mfma_f32_16x16x32_bf16 v[40:43], a[48:51], v[64:67], v[40:43]
v_mfma_f32_16x16x32_bf16 v[44:47], a[48:51], v[68:71], v[44:47]
ds_read_b128 v[64:67], v3 offset:8192
ds_read_b128 v[68:71], v3 offset:9216
s_waitcnt lgkmcnt(2)
v_mfma_f32_16x16x32_bf16 v[16:19], v[92:95], v[72:75], v[16:19]
v_mfma_f32_16x16x32_bf16 v[20:23], v[92:95], v[76:79], v[20:23]
v_mfma_f32_16x16x32_bf16 v[24:27], v[164:167], v[72:75], v[24:27]
v_mfma_f32_16x16x32_bf16 v[28:31], v[164:167], v[76:79], v[28:31]
s_add_u32 s37, s43, 384
s_add_u32 m0, s44, 12288
s_nop 0
buffer_load_dwordx4 v2, s[8:11], s37 offen lds
v_mfma_f32_16x16x32_bf16 v[32:35], v[236:239], v[72:75], v[32:35]
v_mfma_f32_16x16x32_bf16 v[36:39], v[236:239], v[76:79], v[36:39]
v_mfma_f32_16x16x32_bf16 v[40:43], a[52:55], v[72:75], v[40:43]
v_mfma_f32_16x16x32_bf16 v[44:47], a[52:55], v[76:79], v[44:47]
ds_read_b128 v[72:75], v3 offset:10240
ds_read_b128 v[76:79], v3 offset:11264
s_waitcnt lgkmcnt(2)
v_mfma_f32_16x16x32_bf16 v[16:19], v[96:99], v[64:67], v[16:19]
v_mfma_f32_16x16x32_bf16 v[20:23], v[96:99], v[68:71], v[20:23]
v_mfma_f32_16x16x32_bf16 v[24:27], v[168:171], v[64:67], v[24:27]
v_mfma_f32_16x16x32_bf16 v[28:31], v[168:171], v[68:71], v[28:31]
s_add_u32 s37, s43, 512
s_add_u32 m0, s44, 16384
s_nop 0
buffer_load_dwordx4 v2, s[8:11], s37 offen lds
v_mfma_f32_16x16x32_bf16 v[32:35], v[240:243], v[64:67], v[32:35]
v_mfma_f32_16x16x32_bf16 v[36:39], v[240:243], v[68:71], v[36:39]
v_mfma_f32_16x16x32_bf16 v[40:43], a[56:59], v[64:67], v[40:43]
v_mfma_f32_16x16x32_bf16 v[44:47], a[56:59], v[68:71], v[44:47]
ds_read_b128 v[64:67], v3 offset:12288
ds_read_b128 v[68:71], v3 offset:13312
s_waitcnt lgkmcnt(2)
v_mfma_f32_16x16x32_bf16 v[16:19], v[100:103], v[72:75], v[16:19]
v_mfma_f32_16x16x32_bf16 v[20:23], v[100:103], v[76:79], v[20:23]
v_mfma_f32_16x16x32_bf16 v[24:27], v[172:175], v[72:75], v[24:27]
v_mfma_f32_16x16x32_bf16 v[28:31], v[172:175], v[76:79], v[28:31]
s_add_u32 s37, s43, 640
s_add_u32 m0, s44, 20480
s_nop 0
buffer_load_dwordx4 v2, s[8:11], s37 offen lds
v_mfma_f32_16x16x32_bf16 v[32:35], v[244:247], v[72:75], v[32:35]
v_mfma_f32_16x16x32_bf16 v[36:39], v[244:247], v[76:79], v[36:39]
v_mfma_f32_16x16x32_bf16 v[40:43], a[60:63], v[72:75], v[40:43]
v_mfma_f32_16x16x32_bf16 v[44:47], a[60:63], v[76:79], v[44:47]
ds_read_b128 v[72:75], v3 offset:14336
ds_read_b128 v[76:79], v3 offset:15360
s_waitcnt lgkmcnt(2)
v_mfma_f32_16x16x32_bf16 v[16:19], v[104:107], v[64:67], v[16:19]
v_mfma_f32_16x16x32_bf16 v[20:23], v[104:107], v[68:71], v[20:23]
v_mfma_f32_16x16x32_bf16 v[24:27], v[176:179], v[64:67], v[24:27]
v_mfma_f32_16x16x32_bf16 v[28:31], v[176:179], v[68:71], v[28:31]
s_add_u32 s37, s43, 768
s_add_u32 m0, s44, 24576
s_nop 0
buffer_load_dwordx4 v2, s[8:11], s37 offen lds
v_mfma_f32_16x16x32_bf16 v[32:35], v[248:251], v[64:67], v[32:35]
v_mfma_f32_16x16x32_bf16 v[36:39], v[248:251], v[68:71], v[36:39]
v_mfma_f32_16x16x32_bf16 v[40:43], a[64:67], v[64:67], v[40:43]
v_mfma_f32_16x16x32_bf16 v[44:47], a[64:67], v[68:71], v[44:47]
ds_read_b128 v[64:67], v3 offset:16384
ds_read_b128 v[68:71], v3 offset:17408
s_waitcnt lgkmcnt(2)
v_mfma_f32_16x16x32_bf16 v[16:19], v[108:111], v[72:75], v[16:19]
v_mfma_f32_16x16x32_bf16 v[20:23], v[108:111], v[76:79], v[20:23]
v_mfma_f32_16x16x32_bf16 v[24:27], v[180:183], v[72:75], v[24:27]
v_mfma_f32_16x16x32_bf16 v[28:31], v[180:183], v[76:79], v[28:31]
s_add_u32 s37, s43, 896
s_add_u32 m0, s44, 28672
s_nop 0
buffer_load_dwordx4 v2, s[8:11], s37 offen lds
v_mfma_f32_16x16x32_bf16 v[32:35], v[252:255], v[72:75], v[32:35]
v_mfma_f32_16x16x32_bf16 v[36:39], v[252:255], v[76:79], v[36:39]
v_mfma_f32_16x16x32_bf16 v[40:43], a[68:71], v[72:75], v[40:43]
v_mfma_f32_16x16x32_bf16 v[44:47], a[68:71], v[76:79], v[44:47]
ds_read_b128 v[72:75], v3 offset:18432
ds_read_b128 v[76:79], v3 offset:19456
s_waitcnt lgkmcnt(2)
v_mfma_f32_16x16x32_bf16 v[16:19], v[112:115], v[64:67], v[16:19]
v_mfma_f32_16x16x32_bf16 v[20:23], v[112:115], v[68:71], v[20:23]
v_mfma_f32_16x16x32_bf16 v[24:27], v[184:187], v[64:67], v[24:27]
v_mfma_f32_16x16x32_bf16 v[28:31], v[184:187], v[68:71], v[28:31]
s_add_u32 s37, s43, 1024
s_add_u32 m0, s44, 32768
s_nop 0
buffer_load_dwordx4 v2, s[8:11], s37 offen lds
v_mfma_f32_16x16x32_bf16 v[32:35], a[0:3], v[64:67], v[32:35]
v_mfma_f32_16x16x32_bf16 v[36:39], a[0:3], v[68:71], v[36:39]
v_mfma_f32_16x16x32_bf16 v[40:43], a[72:75], v[64:67], v[40:43]
v_mfma_f32_16x16x32_bf16 v[44:47], a[72:75], v[68:71], v[44:47]
ds_read_b128 v[64:67], v3 offset:20480
ds_read_b128 v[68:71], v3 offset:21504
s_waitcnt lgkmcnt(2)
v_mfma_f32_16x16x32_bf16 v[16:19], v[116:119], v[72:75], v[16:19]
v_mfma_f32_16x16x32_bf16 v[20:23], v[116:119], v[76:79], v[20:23]
v_mfma_f32_16x16x32_bf16 v[24:27], v[188:191], v[72:75], v[24:27]
v_mfma_f32_16x16x32_bf16 v[28:31], v[188:191], v[76:79], v[28:31]
v_mfma_f32_16x16x32_bf16 v[32:35], a[4:7], v[72:75], v[32:35]
v_mfma_f32_16x16x32_bf16 v[36:39], a[4:7], v[76:79], v[36:39]
v_mfma_f32_16x16x32_bf16 v[40:43], a[76:79], v[72:75], v[40:43]
v_mfma_f32_16x16x32_bf16 v[44:47], a[76:79], v[76:79], v[44:47]
ds_read_b128 v[72:75], v3 offset:22528
ds_read_b128 v[76:79], v3 offset:23552
s_waitcnt lgkmcnt(2)
v_mfma_f32_16x16x32_bf16 v[16:19], v[120:123], v[64:67], v[16:19]
v_mfma_f32_16x16x32_bf16 v[20:23], v[120:123], v[68:71], v[20:23]
v_mfma_f32_16x16x32_bf16 v[24:27], v[192:195], v[64:67], v[24:27]
v_mfma_f32_16x16x32_bf16 v[28:31], v[192:195], v[68:71], v[28:31]
v_mfma_f32_16x16x32_bf16 v[32:35], a[8:11], v[64:67], v[32:35]
v_mfma_f32_16x16x32_bf16 v[36:39], a[8:11], v[68:71], v[36:39]
v_mfma_f32_16x16x32_bf16 v[40:43], a[80:83], v[64:67], v[40:43]
v_mfma_f32_16x16x32_bf16 v[44:47], a[80:83], v[68:71], v[44:47]
ds_read_b128 v[64:67], v3 offset:24576
ds_read_b128 v[68:71], v3 offset:25600
s_waitcnt lgkmcnt(2)
v_mfma_f32_16x16x32_bf16 v[16:19], v[124:127], v[72:75], v[16:19]
v_mfma_f32_16x16x32_bf16 v[20:23], v[124:127], v[76:79], v[20:23]
v_mfma_f32_16x16x32_bf16 v[24:27], v[196:199], v[72:75], v[24:27]
v_mfma_f32_16x16x32_bf16 v[28:31], v[196:199], v[76:79], v[28:31]
v_mfma_f32_16x16x32_bf16 v[32:35], a[12:15], v[72:75], v[32:35]
v_mfma_f32_16x16x32_bf16 v[36:39], a[12:15], v[76:79], v[36:39]
v_mfma_f32_16x16x32_bf16 v[40:43], a[84:87], v[72:75], v[40:43]
v_mfma_f32_16x16x32_bf16 v[44:47], a[84:87], v[76:79], v[44:47]
ds_read_b128 v[72:75], v3 offset:26624
ds_read_b128 v[76:79], v3 offset:27648
s_waitcnt lgkmcnt(2)
v_mfma_f32_16x16x32_bf16 v[16:19], v[128:131], v[64:67], v[16:19]
v_mfma_f32_16x16x32_bf16 v[20:23], v[128:131], v[68:71], v[20:23]
v_mfma_f32_16x16x32_bf16 v[24:27], v[200:203], v[64:67], v[24:27]
v_mfma_f32_16x16x32_bf16 v[28:31], v[200:203], v[68:71], v[28:31]
v_mfma_f32_16x16x32_bf16 v[32:35], a[16:19], v[64:67], v[32:35]
v_mfma_f32_16x16x32_bf16 v[36:39], a[16:19], v[68:71], v[36:39]
v_mfma_f32_16x16x32_bf16 v[40:43], a[88:91], v[64:67], v[40:43]
v_mfma_f32_16x16x32_bf16 v[44:47], a[88:91], v[68:71], v[44:47]
ds_read_b128 v[64:67], v3 offset:28672
ds_read_b128 v[68:71], v3 offset:29696
s_waitcnt lgkmcnt(2)
v_mfma_f32_16x16x32_bf16 v[16:19], v[132:135], v[72:75], v[16:19]
v_mfma_f32_16x16x32_bf16 v[20:23], v[132:135], v[76:79], v[20:23]
v_mfma_f32_16x16x32_bf16 v[24:27], v[204:207], v[72:75], v[24:27]
v_mfma_f32_16x16x32_bf16 v[28:31], v[204:207], v[76:79], v[28:31]
v_mfma_f32_16x16x32_bf16 v[32:35], a[20:23], v[72:75], v[32:35]
v_mfma_f32_16x16x32_bf16 v[36:39], a[20:23], v[76:79], v[36:39]
v_mfma_f32_16x16x32_bf16 v[40:43], a[92:95], v[72:75], v[40:43]
v_mfma_f32_16x16x32_bf16 v[44:47], a[92:95], v[76:79], v[44:47]
ds_read_b128 v[72:75], v3 offset:30720
ds_read_b128 v[76:79], v3 offset:31744
s_waitcnt lgkmcnt(2)
v_mfma_f32_16x16x32_bf16 v[16:19], v[136:139], v[64:67], v[16:19]
v_mfma_f32_16x16x32_bf16 v[20:23], v[136:139], v[68:71], v[20:23]
v_mfma_f32_16x16x32_bf16 v[24:27], v[208:211], v[64:67], v[24:27]
v_mfma_f32_16x16x32_bf16 v[28:31], v[208:211], v[68:71], v[28:31]
v_mfma_f32_16x16x32_bf16 v[32:35], a[24:27], v[64:67], v[32:35]
v_mfma_f32_16x16x32_bf16 v[36:39], a[24:27], v[68:71], v[36:39]
v_mfma_f32_16x16x32_bf16 v[40:43], a[96:99], v[64:67], v[40:43]
v_mfma_f32_16x16x32_bf16 v[44:47], a[96:99], v[68:71], v[44:47]
ds_read_b128 v[64:67], v3 offset:32768
ds_read_b128 v[68:71], v3 offset:33792
s_waitcnt lgkmcnt(2)
v_mfma_f32_16x16x32_bf16 v[16:19], v[140:143], v[72:75], v[16:19]
v_mfma_f32_16x16x32_bf16 v[20:23], v[140:143], v[76:79], v[20:23]
v_mfma_f32_16x16x32_bf16 v[24:27], v[212:215], v[72:75], v[24:27]
v_mfma_f32_16x16x32_bf16 v[28:31], v[212:215], v[76:79], v[28:31]
v_mfma_f32_16x16x32_bf16 v[32:35], a[28:31], v[72:75], v[32:35]
v_mfma_f32_16x16x32_bf16 v[36:39], a[28:31], v[76:79], v[36:39]
v_mfma_f32_16x16x32_bf16 v[40:43], a[100:103], v[72:75], v[40:43]
v_mfma_f32_16x16x32_bf16 v[44:47], a[100:103], v[76:79], v[44:47]
ds_read_b128 v[72:75], v3 offset:34816
ds_read_b128 v[76:79], v3 offset:35840
s_waitcnt lgkmcnt(2)
v_mfma_f32_16x16x32_bf16 v[16:19], v[144:147], v[64:67], v[16:19]
v_mfma_f32_16x16x32_bf16 v[20:23], v[144:147], v[68:71], v[20:23]
v_mfma_f32_16x16x32_bf16 v[24:27], v[216:219], v[64:67], v[24:27]
v_mfma_f32_16x16x32_bf16 v[28:31], v[216:219], v[68:71], v[28:31]
v_mfma_f32_16x16x32_bf16 v[32:35], a[32:35], v[64:67], v[32:35]
v_mfma_f32_16x16x32_bf16 v[36:39], a[32:35], v[68:71], v[36:39]
v_mfma_f32_16x16x32_bf16 v[40:43], a[104:107], v[64:67], v[40:43]
v_mfma_f32_16x16x32_bf16 v[44:47], a[104:107], v[68:71], v[44:47]
s_waitcnt lgkmcnt(0)
v_mfma_f32_16x16x32_bf16 v[16:19], v[148:151], v[72:75], v[16:19]
v_mfma_f32_16x16x32_bf16 v[20:23], v[148:151], v[76:79], v[20:23]
v_mfma_f32_16x16x32_bf16 v[24:27], v[220:223], v[72:75], v[24:27]
v_mfma_f32_16x16x32_bf16 v[28:31], v[220:223], v[76:79], v[28:31]
v_mfma_f32_16x16x32_bf16 v[32:35], a[36:39], v[72:75], v[32:35]
v_mfma_f32_16x16x32_bf16 v[36:39], a[36:39], v[76:79], v[36:39]
v_mfma_f32_16x16x32_bf16 v[40:43], a[108:111], v[72:75], v[40:43]
v_mfma_f32_16x16x32_bf16 v[44:47], a[108:111], v[76:79], v[44:47]
v_add_u32 v3, s50, v3
s_sub_u32 s50, 0, s50
v_cvt_pk_bf16_f32 v16, v16, v17
v_cvt_pk_bf16_f32 v17, v18, v19
ds_write_b64 v4, v[16:17] offset:0
v_cvt_pk_bf16_f32 v20, v20, v21
v_cvt_pk_bf16_f32 v21, v22, v23
ds_write_b64 v4, v[20:21] offset:7296
v_cvt_pk_bf16_f32 v24, v24, v25
v_cvt_pk_bf16_f32 v25, v26, v27
ds_write_b64 v4, v[24:25] offset:32
v_cvt_pk_bf16_f32 v28, v28, v29
v_cvt_pk_bf16_f32 v29, v30, v31
ds_write_b64 v4, v[28:29] offset:7328
s_cmp_eq_u32 s34, 3
s_cbranch_scc1 L_a_gate
v_cvt_pk_bf16_f32 v32, v32, v33
v_cvt_pk_bf16_f32 v33, v34, v35
ds_write_b64 v4, v[32:33] offset:64
v_cvt_pk_bf16_f32 v36, v36, v37
v_cvt_pk_bf16_f32 v37, v38, v39
ds_write_b64 v4, v[36:37] offset:7360
v_cvt_pk_bf16_f32 v40, v40, v41
v_cvt_pk_bf16_f32 v41, v42, v43
ds_write_b64 v4, v[40:41] offset:96
v_cvt_pk_bf16_f32 v44, v44, v45
v_cvt_pk_bf16_f32 v45, v46, v47
ds_write_b64 v4, v[44:45] offset:7392
s_branch L_a_nog2
L_a_gate:
ds_write_b32 v14, v32
ds_write_b32 v14, v36 offset:64
L_a_nog2:
v_add_u32 v4, 14592, v4
v_add_u32 v14, 128, v14
s_add_u32 s35, s35, 1
s_cmp_lt_u32 s35, 6
s_cbranch_scc1 L_a_loop
s_waitcnt vmcnt(0) lgkmcnt(0)
s_barrier
s_mov_b32 s35, 0
s_mul_i32 s39, s34, 36
s_add_u32 s39, s39, 73728
s_mul_i32 s40, s33, 176
s_mov_b32 s41, 0x3eae1a93
s_mov_b32 s42, 0xbfb8aa3b
L_la_loop:
v_add_u32 v12, s35, v9
v_min_u32 v12, 175, v12
v_add_u32 v2, s40, v12
v_add_u32 v12, 16, v12
v_mul_u32_u24 v14, 456, v12
v_add_u32 v14, s39, v14
v_lshlrev_b32 v12, 2, v12
v_add_u32 v12, 161280, v12
ds_read_b32 v3, v12
ds_read2_b32 v[16:17], v14 offset0:0 offset1:1
ds_read2_b32 v[18:19], v14 offset0:2 offset1:3
ds_read2_b32 v[20:21], v14 offset0:4 offset1:5
ds_read2_b32 v[22:23], v14 offset0:6 offset1:7
ds_read_b32 v24, v14 offset:32
v_subrev_u32 v15, 0, v14
ds_read2_b32 v[26:27], v15 offset0:36 offset1:37
ds_read2_b32 v[28:29], v15 offset0:38 offset1:39
ds_read2_b32 v[30:31], v15 offset0:40 offset1:41
ds_read2_b32 v[32:33], v15 offset0:42 offset1:43
ds_read_b32 v34, v15 offset:176
v_subrev_u32 v15, 912, v14
ds_read2_b32 v[36:37], v15 offset0:36 offset1:37
ds_read2_b32 v[38:39], v15 offset0:38 offset1:39
ds_read2_b32 v[40:41], v15 offset0:40 offset1:41
ds_read2_b32 v[42:43], v15 offset0:42 offset1:43
ds_read_b32 v44, v15 offset:176
s_waitcnt lgkmcnt(5)
v_dot2_f32_bf16 v176, v16, v26, 0
v_dot2_f32_bf16 v176, v17, v27, v176
v_dot2_f32_bf16 v176, v18, v28, v176
v_dot2_f32_bf16 v176, v19, v29, v176
v_dot2_f32_bf16 v176, v20, v30, v176
v_dot2_f32_bf16 v176, v21, v31, v176
v_dot2_f32_bf16 v176, v22, v32, v176
v_dot2_f32_bf16 v176, v23, v33, v176
v_dot2_f32_bf16 v176, v24, v34, v176
v_subrev_u32 v15, 1824, v14
ds_read2_b32 v[46:47], v15 offset0:36 offset1:37
ds_read2_b32 v[48:49], v15 offset0:38 offset1:39
ds_read2_b32 v[50:51], v15 offset0:40 offset1:41
ds_read2_b32 v[52:53], v15 offset0:42 offset1:43
ds_read_b32 v54, v15 offset:176
s_waitcnt lgkmcnt(5)
v_dot2_f32_bf16 v177, v16, v36, 0
v_dot2_f32_bf16 v177, v17, v37, v177
v_dot2_f32_bf16 v177, v18, v38, v177
v_dot2_f32_bf16 v177, v19, v39, v177
v_dot2_f32_bf16 v177, v20, v40, v177
v_dot2_f32_bf16 v177, v21, v41, v177
v_dot2_f32_bf16 v177, v22, v42, v177
v_dot2_f32_bf16 v177, v23, v43, v177
v_dot2_f32_bf16 v177, v24, v44, v177
v_subrev_u32 v15, 2736, v14
ds_read2_b32 v[56:57], v15 offset0:36 offset1:37
ds_read2_b32 v[58:59], v15 offset0:38 offset1:39
ds_read2_b32 v[60:61], v15 offset0:40 offset1:41
ds_read2_b32 v[62:63], v15 offset0:42 offset1:43
ds_read_b32 v64, v15 offset:176
s_waitcnt lgkmcnt(5)
v_dot2_f32_bf16 v178, v16, v46, 0
v_dot2_f32_bf16 v178, v17, v47, v178
v_dot2_f32_bf16 v178, v18, v48, v178
v_dot2_f32_bf16 v178, v19, v49, v178
v_dot2_f32_bf16 v178, v20, v50, v178
v_dot2_f32_bf16 v178, v21, v51, v178
v_dot2_f32_bf16 v178, v22, v52, v178
v_dot2_f32_bf16 v178, v23, v53, v178
v_dot2_f32_bf16 v178, v24, v54, v178
v_subrev_u32 v15, 3648, v14
ds_read2_b32 v[26:27], v15 offset0:36 offset1:37
ds_read2_b32 v[28:29], v15 offset0:38 offset1:39
ds_read2_b32 v[30:31], v15 offset0:40 offset1:41
ds_read2_b32 v[32:33], v15 offset0:42 offset1:43
ds_read_b32 v34, v15 offset:176
s_waitcnt lgkmcnt(5)
v_dot2_f32_bf16 v179, v16, v56, 0
v_dot2_f32_bf16 v179, v17, v57, v179
v_dot2_f32_bf16 v179, v18, v58, v179
v_dot2_f32_bf16 v179, v19, v59, v179
v_dot2_f32_bf16 v179, v20, v60, v179
v_dot2_f32_bf16 v179, v21, v61, v179
v_dot2_f32_bf16 v179, v22, v62, v179
v_dot2_f32_bf16 v179, v23, v63, v179
v_dot2_f32_bf16 v179, v24, v64, v179
v_subrev_u32 v15, 4560, v14
ds_read2_b32 v[36:37], v15 offset0:36 offset1:37
ds_read2_b32 v[38:39], v15 offset0:38 offset1:39
ds_read2_b32 v[40:41], v15 offset0:40 offset1:41
ds_read2_b32 v[42:43], v15 offset0:42 offset1:43
ds_read_b32 v44, v15 offset:176
s_waitcnt lgkmcnt(5)
v_dot2_f32_bf16 v180, v16, v26, 0
v_dot2_f32_bf16 v180, v17, v27, v180
v_dot2_f32_bf16 v180, v18, v28, v180
v_dot2_f32_bf16 v180, v19, v29, v180
v_dot2_f32_bf16 v180, v20, v30, v180
v_dot2_f32_bf16 v180, v21, v31, v180
v_dot2_f32_bf16 v180, v22, v32, v180
v_dot2_f32_bf16 v180, v23, v33, v180
v_dot2_f32_bf16 v180, v24, v34, v180
v_subrev_u32 v15, 5472, v14
ds_read2_b32 v[46:47], v15 offset0:36 offset1:37
ds_read2_b32 v[48:49], v15 offset0:38 offset1:39
ds_read2_b32 v[50:51], v15 offset0:40 offset1:41
ds_read2_b32 v[52:53], v15 offset0:42 offset1:43
ds_read_b32 v54, v15 offset:176
s_waitcnt lgkmcnt(5)
v_dot2_f32_bf16 v181, v16, v36, 0
v_dot2_f32_bf16 v181, v17, v37, v181
v_dot2_f32_bf16 v181, v18, v38, v181
v_dot2_f32_bf16 v181, v19, v39, v181
v_dot2_f32_bf16 v181, v20, v40, v181
v_dot2_f32_bf16 v181, v21, v41, v181
v_dot2_f32_bf16 v181, v22, v42, v181
v_dot2_f32_bf16 v181, v23, v43, v181
v_dot2_f32_bf16 v181, v24, v44, v181
v_subrev_u32 v15, 6384, v14
ds_read2_b32 v[56:57], v15 offset0:36 offset1:37
ds_read2_b32 v[58:59], v15 offset0:38 offset1:39
ds_read2_b32 v[60:61], v15 offset0:40 offset1:41
ds_read2_b32 v[62:63], v15 offset0:42 offset1:43
ds_read_b32 v64, v15 offset:176
s_waitcnt lgkmcnt(5)
v_dot2_f32_bf16 v182, v16, v46, 0
v_dot2_f32_bf16 v182, v17, v47, v182
v_dot2_f32_bf16 v182, v18, v48, v182
v_dot2_f32_bf16 v182, v19, v49, v182
v_dot2_f32_bf16 v182, v20, v50, v182
v_dot2_f32_bf16 v182, v21, v51, v182
v_dot2_f32_bf16 v182, v22, v52, v182
v_dot2_f32_bf16 v182, v23, v53, v182
v_dot2_f32_bf16 v182, v24, v54, v182
s_waitcnt lgkmcnt(0)
v_dot2_f32_bf16 v183, v16, v56, 0
v_dot2_f32_bf16 v183, v17, v57, v183
v_dot2_f32_bf16 v183, v18, v58, v183
v_dot2_f32_bf16 v183, v19, v59, v183
v_dot2_f32_bf16 v183, v20, v60, v183
v_dot2_f32_bf16 v183, v21, v61, v183
v_dot2_f32_bf16 v183, v22, v62, v183
v_dot2_f32_bf16 v183, v23, v63, v183
v_dot2_f32_bf16 v183, v24, v64, v183
v_subrev_u32 v15, 0, v14
ds_read2_b32 v[100:101], v15 offset0:72 offset1:73
ds_read2_b32 v[102:103], v15 offset0:74 offset1:75
ds_read2_b32 v[104:105], v15 offset0:76 offset1:77
ds_read2_b32 v[106:107], v15 offset0:78 offset1:79
ds_read_b32 v108, v15 offset:320
v_subrev_u32 v15, 912, v14
ds_read2_b32 v[110:111], v15 offset0:72 offset1:73
ds_read2_b32 v[112:113], v15 offset0:74 offset1:75
ds_read2_b32 v[114:115], v15 offset0:76 offset1:77
ds_read2_b32 v[116:117], v15 offset0:78 offset1:79
ds_read_b32 v118, v15 offset:320
v_mov_b32 v13, 0xf149f2ca
v_mul_f32 v176, s41, v176
v_mul_f32 v177, s41, v177
v_mul_f32 v178, s41, v178
v_mul_f32 v179, s41, v179
v_mul_f32 v180, s41, v180
v_mul_f32 v181, s41, v181
v_mul_f32 v182, s41, v182
v_mul_f32 v183, s41, v183
v_cmp_le_u32 vcc, 2, v2
s_nop 1
v_cndmask_b32 v177, v13, v177, vcc
v_cmp_le_u32 vcc, 4, v2
s_nop 1
v_cndmask_b32 v178, v13, v178, vcc
v_cmp_le_u32 vcc, 6, v2
s_nop 1
v_cndmask_b32 v179, v13, v179, vcc
v_cmp_le_u32 vcc, 8, v2
s_nop 1
v_cndmask_b32 v180, v13, v180, vcc
v_cmp_le_u32 vcc, 10, v2
s_nop 1
v_cndmask_b32 v181, v13, v181, vcc
v_cmp_le_u32 vcc, 12, v2
s_nop 1
v_cndmask_b32 v182, v13, v182, vcc
v_cmp_le_u32 vcc, 14, v2
s_nop 1
v_cndmask_b32 v183, v13, v183, vcc
v_max3_f32 v12, v176, v177, v178
v_max3_f32 v12, v12, v179, v180
v_max3_f32 v12, v12, v181, v182
v_max_f32 v12, v12, v183
v_sub_f32 v176, v176, v12
v_sub_f32 v177, v177, v12
v_sub_f32 v178, v178, v12
v_sub_f32 v179, v179, v12
v_sub_f32 v180, v180, v12
v_sub_f32 v181, v181, v12
v_sub_f32 v182, v182, v12
v_sub_f32 v183, v183, v12
v_exp_f32 v176, v176
v_exp_f32 v177, v177
v_exp_f32 v178, v178
v_exp_f32 v179, v179
v_exp_f32 v180, v180
v_exp_f32 v181, v181
v_exp_f32 v182, v182
v_exp_f32 v183, v183
v_cvt_pk_bf16_f32 v204, v176, v8
v_cvt_pk_bf16_f32 v205, v177, v8
v_cvt_pk_bf16_f32 v206, v178, v8
v_cvt_pk_bf16_f32 v207, v179, v8
v_cvt_pk_bf16_f32 v208, v180, v8
v_cvt_pk_bf16_f32 v209, v181, v8
v_cvt_pk_bf16_f32 v210, v182, v8
v_cvt_pk_bf16_f32 v211, v183, v8
v_lshlrev_b32 v212, 16, v204
v_lshlrev_b32 v213, 16, v205
v_lshlrev_b32 v214, 16, v206
v_lshlrev_b32 v215, 16, v207
v_lshlrev_b32 v216, 16, v208
v_lshlrev_b32 v217, 16, v209
v_lshlrev_b32 v218, 16, v210
v_lshlrev_b32 v219, 16, v211
v_add_f32 v12, v212, v213
v_add_f32 v13, v214, v215
v_add_f32 v12, v12, v216
v_add_f32 v13, v13, v217
v_add_f32 v12, v12, v218
v_add_f32 v13, v13, v219
v_add_f32 v12, v12, v13
v_mul_f32 v13, s42, v3
v_exp_f32 v3, v13
v_exp_f32 v13, -v13
v_add_f32 v3, 1.0, v3
v_add_f32 v13, 1.0, v13
v_mul_f32 v12, v12, v3
v_rcp_f32 v12, v12
v_rcp_f32 v13, v13
v_subrev_u32 v15, 1824, v14
ds_read2_b32 v[120:121], v15 offset0:72 offset1:73
ds_read2_b32 v[122:123], v15 offset0:74 offset1:75
ds_read2_b32 v[124:125], v15 offset0:76 offset1:77
ds_read2_b32 v[126:127], v15 offset0:78 offset1:79
ds_read_b32 v128, v15 offset:320
s_waitcnt lgkmcnt(10)
v_dot2_f32_bf16 v184, v100, v204, 0
v_dot2_f32_bf16 v185, v100, v212, 0
v_dot2_f32_bf16 v186, v101, v204, 0
v_dot2_f32_bf16 v187, v101, v212, 0
v_dot2_f32_bf16 v188, v102, v204, 0
v_dot2_f32_bf16 v189, v102, v212, 0
v_dot2_f32_bf16 v190, v103, v204, 0
v_dot2_f32_bf16 v191, v103, v212, 0
v_dot2_f32_bf16 v192, v104, v204, 0
v_dot2_f32_bf16 v193, v104, v212, 0
v_dot2_f32_bf16 v194, v105, v204, 0
v_dot2_f32_bf16 v195, v105, v212, 0
v_dot2_f32_bf16 v196, v106, v204, 0
v_dot2_f32_bf16 v197, v106, v212, 0
v_dot2_f32_bf16 v198, v107, v204, 0
v_dot2_f32_bf16 v199, v107, v212, 0
v_dot2_f32_bf16 v200, v108, v204, 0
v_dot2_f32_bf16 v201, v108, v212, 0
v_subrev_u32 v15, 2736, v14
ds_read2_b32 v[130:131], v15 offset0:72 offset1:73
ds_read2_b32 v[132:133], v15 offset0:74 offset1:75
ds_read2_b32 v[134:135], v15 offset0:76 offset1:77
ds_read2_b32 v[136:137], v15 offset0:78 offset1:79
ds_read_b32 v138, v15 offset:320
s_waitcnt lgkmcnt(10)
v_dot2_f32_bf16 v184, v110, v205, v184
v_dot2_f32_bf16 v185, v110, v213, v185
v_dot2_f32_bf16 v186, v111, v205, v186
v_dot2_f32_bf16 v187, v111, v213, v187
v_dot2_f32_bf16 v188, v112, v205, v188
v_dot2_f32_bf16 v189, v112, v213, v189
v_dot2_f32_bf16 v190, v113, v205, v190
v_dot2_f32_bf16 v191, v113, v213, v191
v_dot2_f32_bf16 v192, v114, v205, v192
v_dot2_f32_bf16 v193, v114, v213, v193
v_dot2_f32_bf16 v194, v115, v205, v194
v_dot2_f32_bf16 v195, v115, v213, v195
v_dot2_f32_bf16 v196, v116, v205, v196
v_dot2_f32_bf16 v197, v116, v213, v197
v_dot2_f32_bf16 v198, v117, v205, v198
v_dot2_f32_bf16 v199, v117, v213, v199
v_dot2_f32_bf16 v200, v118, v205, v200
v_dot2_f32_bf16 v201, v118, v213, v201
v_subrev_u32 v15, 3648, v14
ds_read2_b32 v[100:101], v15 offset0:72 offset1:73
ds_read2_b32 v[102:103], v15 offset0:74 offset1:75
ds_read2_b32 v[104:105], v15 offset0:76 offset1:77
ds_read2_b32 v[106:107], v15 offset0:78 offset1:79
ds_read_b32 v108, v15 offset:320
s_waitcnt lgkmcnt(10)
v_dot2_f32_bf16 v184, v120, v206, v184
v_dot2_f32_bf16 v185, v120, v214, v185
v_dot2_f32_bf16 v186, v121, v206, v186
v_dot2_f32_bf16 v187, v121, v214, v187
v_dot2_f32_bf16 v188, v122, v206, v188
v_dot2_f32_bf16 v189, v122, v214, v189
v_dot2_f32_bf16 v190, v123, v206, v190
v_dot2_f32_bf16 v191, v123, v214, v191
v_dot2_f32_bf16 v192, v124, v206, v192
v_dot2_f32_bf16 v193, v124, v214, v193
v_dot2_f32_bf16 v194, v125, v206, v194
v_dot2_f32_bf16 v195, v125, v214, v195
v_dot2_f32_bf16 v196, v126, v206, v196
v_dot2_f32_bf16 v197, v126, v214, v197
v_dot2_f32_bf16 v198, v127, v206, v198
v_dot2_f32_bf16 v199, v127, v214, v199
v_dot2_f32_bf16 v200, v128, v206, v200
v_dot2_f32_bf16 v201, v128, v214, v201
v_subrev_u32 v15, 4560, v14
ds_read2_b32 v[110:111], v15 offset0:72 offset1:73
ds_read2_b32 v[112:113], v15 offset0:74 offset1:75
ds_read2_b32 v[114:115], v15 offset0:76 offset1:77
ds_read2_b32 v[116:117], v15 offset0:78 offset1:79
ds_read_b32 v118, v15 offset:320
s_waitcnt lgkmcnt(10)
v_dot2_f32_bf16 v184, v130, v207, v184
v_dot2_f32_bf16 v185, v130, v215, v185
v_dot2_f32_bf16 v186, v131, v207, v186
v_dot2_f32_bf16 v187, v131, v215, v187
v_dot2_f32_bf16 v188, v132, v207, v188
v_dot2_f32_bf16 v189, v132, v215, v189
v_dot2_f32_bf16 v190, v133, v207, v190
v_dot2_f32_bf16 v191, v133, v215, v191
v_dot2_f32_bf16 v192, v134, v207, v192
v_dot2_f32_bf16 v193, v134, v215, v193
v_dot2_f32_bf16 v194, v135, v207, v194
v_dot2_f32_bf16 v195, v135, v215, v195
v_dot2_f32_bf16 v196, v136, v207, v196
v_dot2_f32_bf16 v197, v136, v215, v197
v_dot2_f32_bf16 v198, v137, v207, v198
v_dot2_f32_bf16 v199, v137, v215, v199
v_dot2_f32_bf16 v200, v138, v207, v200
v_dot2_f32_bf16 v201, v138, v215, v201
v_subrev_u32 v15, 5472, v14
ds_read2_b32 v[120:121], v15 offset0:72 offset1:73
ds_read2_b32 v[122:123], v15 offset0:74 offset1:75
ds_read2_b32 v[124:125], v15 offset0:76 offset1:77
ds_read2_b32 v[126:127], v15 offset0:78 offset1:79
ds_read_b32 v128, v15 offset:320
s_waitcnt lgkmcnt(10)
v_dot2_f32_bf16 v184, v100, v208, v184
v_dot2_f32_bf16 v185, v100, v216, v185
v_dot2_f32_bf16 v186, v101, v208, v186
v_dot2_f32_bf16 v187, v101, v216, v187
v_dot2_f32_bf16 v188, v102, v208, v188
v_dot2_f32_bf16 v189, v102, v216, v189
v_dot2_f32_bf16 v190, v103, v208, v190
v_dot2_f32_bf16 v191, v103, v216, v191
v_dot2_f32_bf16 v192, v104, v208, v192
v_dot2_f32_bf16 v193, v104, v216, v193
v_dot2_f32_bf16 v194, v105, v208, v194
v_dot2_f32_bf16 v195, v105, v216, v195
v_dot2_f32_bf16 v196, v106, v208, v196
v_dot2_f32_bf16 v197, v106, v216, v197
v_dot2_f32_bf16 v198, v107, v208, v198
v_dot2_f32_bf16 v199, v107, v216, v199
v_dot2_f32_bf16 v200, v108, v208, v200
v_dot2_f32_bf16 v201, v108, v216, v201
v_subrev_u32 v15, 6384, v14
ds_read2_b32 v[130:131], v15 offset0:72 offset1:73
ds_read2_b32 v[132:133], v15 offset0:74 offset1:75
ds_read2_b32 v[134:135], v15 offset0:76 offset1:77
ds_read2_b32 v[136:137], v15 offset0:78 offset1:79
ds_read_b32 v138, v15 offset:320
s_waitcnt lgkmcnt(10)
v_dot2_f32_bf16 v184, v110, v209, v184
v_dot2_f32_bf16 v185, v110, v217, v185
v_dot2_f32_bf16 v186, v111, v209, v186
v_dot2_f32_bf16 v187, v111, v217, v187
v_dot2_f32_bf16 v188, v112, v209, v188
v_dot2_f32_bf16 v189, v112, v217, v189
v_dot2_f32_bf16 v190, v113, v209, v190
v_dot2_f32_bf16 v191, v113, v217, v191
v_dot2_f32_bf16 v192, v114, v209, v192
v_dot2_f32_bf16 v193, v114, v217, v193
v_dot2_f32_bf16 v194, v115, v209, v194
v_dot2_f32_bf16 v195, v115, v217, v195
v_dot2_f32_bf16 v196, v116, v209, v196
v_dot2_f32_bf16 v197, v116, v217, v197
v_dot2_f32_bf16 v198, v117, v209, v198
v_dot2_f32_bf16 v199, v117, v217, v199
v_dot2_f32_bf16 v200, v118, v209, v200
v_dot2_f32_bf16 v201, v118, v217, v201
s_waitcnt lgkmcnt(5)
v_dot2_f32_bf16 v184, v120, v210, v184
v_dot2_f32_bf16 v185, v120, v218, v185
v_dot2_f32_bf16 v186, v121, v210, v186
v_dot2_f32_bf16 v187, v121, v218, v187
v_dot2_f32_bf16 v188, v122, v210, v188
v_dot2_f32_bf16 v189, v122, v218, v189
v_dot2_f32_bf16 v190, v123, v210, v190
v_dot2_f32_bf16 v191, v123, v218, v191
v_dot2_f32_bf16 v192, v124, v210, v192
v_dot2_f32_bf16 v193, v124, v218, v193
v_dot2_f32_bf16 v194, v125, v210, v194
v_dot2_f32_bf16 v195, v125, v218, v195
v_dot2_f32_bf16 v196, v126, v210, v196
v_dot2_f32_bf16 v197, v126, v218, v197
v_dot2_f32_bf16 v198, v127, v210, v198
v_dot2_f32_bf16 v199, v127, v218, v199
v_dot2_f32_bf16 v200, v128, v210, v200
v_dot2_f32_bf16 v201, v128, v218, v201
s_waitcnt lgkmcnt(0)
v_dot2_f32_bf16 v184, v130, v211, v184
v_dot2_f32_bf16 v185, v130, v219, v185
v_dot2_f32_bf16 v186, v131, v211, v186
v_dot2_f32_bf16 v187, v131, v219, v187
v_dot2_f32_bf16 v188, v132, v211, v188
v_dot2_f32_bf16 v189, v132, v219, v189
v_dot2_f32_bf16 v190, v133, v211, v190
v_dot2_f32_bf16 v191, v133, v219, v191
v_dot2_f32_bf16 v192, v134, v211, v192
v_dot2_f32_bf16 v193, v134, v219, v193
v_dot2_f32_bf16 v194, v135, v211, v194
v_dot2_f32_bf16 v195, v135, v219, v195
v_dot2_f32_bf16 v196, v136, v211, v196
v_dot2_f32_bf16 v197, v136, v219, v197
v_dot2_f32_bf16 v198, v137, v211, v198
v_dot2_f32_bf16 v199, v137, v219, v199
v_dot2_f32_bf16 v200, v138, v211, v200
v_dot2_f32_bf16 v201, v138, v219, v201
s_or_b32 s37, s32, s34
s_cmp_lg_u32 s37, 0
s_cbranch_scc1 L_la_noomg
v_lshlrev_b32 v15, 2, v2
v_min_u32 v15, 8192, v15
s_mov_b32 s37, 87031808
buffer_store_dword v13, v15, s[4:7], s37 offen sc0 sc1
L_la_noomg:
v_mul_f32 v184, v184, v12
v_mul_f32 v185, v185, v12
v_mul_f32 v186, v186, v12
v_mul_f32 v187, v187, v12
v_mul_f32 v188, v188, v12
v_mul_f32 v189, v189, v12
v_mul_f32 v190, v190, v12
v_mul_f32 v191, v191, v12
v_mul_f32 v192, v192, v12
v_mul_f32 v193, v193, v12
v_mul_f32 v194, v194, v12
v_mul_f32 v195, v195, v12
v_mul_f32 v196, v196, v12
v_mul_f32 v197, v197, v12
v_mul_f32 v198, v198, v12
v_mul_f32 v199, v199, v12
v_mul_f32 v200, v200, v12
v_mul_f32 v201, v201, v12
v_cvt_pk_bf16_f32 v184, v184, v185
v_cvt_pk_bf16_f32 v185, v186, v187
v_cvt_pk_bf16_f32 v186, v188, v189
v_cvt_pk_bf16_f32 v187, v190, v191
v_cvt_pk_bf16_f32 v188, v192, v193
v_cvt_pk_bf16_f32 v189, v194, v195
v_cvt_pk_bf16_f32 v190, v196, v197
v_cvt_pk_bf16_f32 v191, v198, v199
v_cvt_pk_bf16_f32 v192, v200, v201
ds_write2_b32 v14, v184, v185 offset0:0 offset1:1
ds_write2_b32 v14, v186, v187 offset0:2 offset1:3
ds_write2_b32 v14, v188, v189 offset0:4 offset1:5
ds_write2_b32 v14, v190, v191 offset0:6 offset1:7
ds_write_b32 v14, v192 offset:32
s_add_u32 s35, s35, 64
s_cmp_lt_u32 s35, 192
s_cbranch_scc1 L_la_loop
s_waitcnt lgkmcnt(0)
s_barrier
v_mul_u32_u24 v14, 456, v10
v_lshl_add_u32 v14, v11, 4, v14
s_add_u32 s37, s34, 1
s_mul_i32 s37, s37, 7296
s_add_u32 s37, s37, 73728
v_add_u32 v14, s37, v14
s_mul_i32 s40, s33, 11
s_add_u32 s40, s40, s34
s_mov_b32 s35, s34
s_mul_i32 s41, s32, 2304
s_add_u32 s41, s41, 83886080
L_oa_loop:
s_cmp_ge_u32 s40, 128
s_cbranch_scc1 L_oa_done
ds_read2_b64 v[16:19], v14 offset0:0 offset1:1
ds_read2_b64 v[20:23], v14 offset0:8 offset1:9
ds_read2_b64 v[24:27], v14 offset0:16 offset1:17
s_mul_i32 s37, s40, 18432
s_add_u32 s37, s37, s41
s_waitcnt lgkmcnt(2)
buffer_store_dwordx4 v[16:19], v1, s[4:7], s37 offen offset:0 sc0 sc1
s_waitcnt lgkmcnt(1)
buffer_store_dwordx4 v[20:23], v1, s[4:7], s37 offen offset:1024 sc0 sc1
s_waitcnt lgkmcnt(0)
s_mov_b64 exec, 0xffff
buffer_store_dwordx4 v[24:27], v1, s[4:7], s37 offen offset:2048 sc0 sc1
s_mov_b64 exec, -1
v_add_u32 v14, 29184, v14
s_add_u32 s40, s40, 4
s_add_u32 s35, s35, 4
s_cmp_lt_u32 s35, 11
s_cbranch_scc1 L_oa_loop
L_oa_done:
s_waitcnt vmcnt(0)
s_barrier
s_cmp_lg_u32 s34, 0
s_cbranch_scc1 L_a_sig
v_mov_b32 v12, 1
s_mov_b64 exec, 1
buffer_atomic_add v12, v8, s[24:27], 0 offen offset:4 sc1
s_mov_b64 exec, -1
L_a_sig:
v_add_u32 v12, 0, v9
v_mul_u32_u24 v13, 171, v12
v_lshrrev_b32 v13, 10, v13
v_mul_u32_u24 v13, 1056, v13
v_lshl_add_u32 v2, v12, 4, v13
v_add_u32 v12, 64, v9
v_mul_u32_u24 v13, 171, v12
v_lshrrev_b32 v13, 10, v13
v_mul_u32_u24 v13, 1056, v13
v_lshl_add_u32 v3, v12, 4, v13
v_add_u32 v12, 128, v9
v_mul_u32_u24 v13, 171, v12
v_lshrrev_b32 v13, 10, v13
v_mul_u32_u24 v13, 1056, v13
v_lshl_add_u32 v4, v12, 4, v13
v_lshrrev_b32 v12, 2, v10
v_lshl_add_u32 v12, v11, 2, v12
v_mul_u32_u24 v5, 96, v12
v_and_b32 v12, 3, v10
v_lshl_add_u32 v5, v12, 3, v5
v_lshrrev_b32 v12, 2, v10
v_lshl_add_u32 v12, v11, 3, v12
v_mul_u32_u24 v6, 96, v12
v_and_b32 v12, 3, v10
v_lshl_add_u32 v6, v12, 3, v6
s_lshl_b32 s50, s34, 15
v_add_u32 v5, s50, v5
v_add_u32 v6, s50, v6
v_add_u32 v7, s50, v1
s_mul_i32 s37, s49, 96
s_mul_i32 s51, s34, 1179648
s_add_u32 s51, s51, s37
s_mul_i32 s52, s34, 184320
s_add_u32 s52, s52, s37
v_mul_u32_u24 v15, 1152, v10
v_lshl_add_u32 v15, v11, 3, v15
s_lshl_b32 s38, s34, 5
s_add_u32 s37, s37, s38
s_mul_i32 s55, s48, 18432
s_add_u32 s54, s55, 83886080
s_add_u32 s55, s55, s37
s_lshl_b32 s53, s48, 17
s_add_u32 s53, s53, s50
s_add_u32 s53, s53, 67108864
s_lshl_b32 s56, s48, 6
s_add_u32 s56, s56, 87031808
s_lshl_b32 s57, s48, 8
s_add_u32 s57, s57, 331776
v_lshlrev_b32 v9, 2, v9
v_lshlrev_b32 v10, 2, v10
v_add_u32 v14, 131072, v1
s_add_u32 s37, s52, 0
s_add_u32 m0, s50, 0
s_nop 0
buffer_load_dwordx4 v2, s[16:19], s37 offen lds
s_add_u32 m0, s50, 1024
s_nop 0
buffer_load_dwordx4 v3, s[16:19], s37 offen lds
s_add_u32 m0, s50, 2048
s_nop 0
buffer_load_dwordx4 v4, s[16:19], s37 offen lds
s_add_u32 s37, s52, 36864
s_add_u32 m0, s50, 3072
s_nop 0
buffer_load_dwordx4 v2, s[16:19], s37 offen lds
s_add_u32 m0, s50, 4096
s_nop 0
buffer_load_dwordx4 v3, s[16:19], s37 offen lds
s_add_u32 m0, s50, 5120
s_nop 0
buffer_load_dwordx4 v4, s[16:19], s37 offen lds
s_add_u32 s37, s52, 73728
s_add_u32 m0, s50, 6144
s_nop 0
buffer_load_dwordx4 v2, s[16:19], s37 offen lds
s_add_u32 m0, s50, 7168
s_nop 0
buffer_load_dwordx4 v3, s[16:19], s37 offen lds
s_add_u32 m0, s50, 8192
s_nop 0
buffer_load_dwordx4 v4, s[16:19], s37 offen lds
s_add_u32 s37, s52, 110592
s_add_u32 m0, s50, 9216
s_nop 0
buffer_load_dwordx4 v2, s[16:19], s37 offen lds
s_add_u32 m0, s50, 10240
s_nop 0
buffer_load_dwordx4 v3, s[16:19], s37 offen lds
s_add_u32 m0, s50, 11264
s_nop 0
buffer_load_dwordx4 v4, s[16:19], s37 offen lds
s_add_u32 s37, s52, 147456
s_add_u32 m0, s50, 12288
s_nop 0
buffer_load_dwordx4 v2, s[16:19], s37 offen lds
s_add_u32 m0, s50, 13312
s_nop 0
buffer_load_dwordx4 v3, s[16:19], s37 offen lds
s_add_u32 m0, s50, 14336
s_nop 0
buffer_load_dwordx4 v4, s[16:19], s37 offen lds
s_add_u32 s37, s51, 0
s_add_u32 m0, s50, 15360
s_nop 0
buffer_load_dwordx4 v2, s[20:23], s37 offen lds
s_add_u32 m0, s50, 16384
s_nop 0
buffer_load_dwordx4 v3, s[20:23], s37 offen lds
s_add_u32 m0, s50, 17408
s_nop 0
buffer_load_dwordx4 v4, s[20:23], s37 offen lds
s_add_u32 s37, s51, 36864
s_add_u32 m0, s50, 18432
s_nop 0
buffer_load_dwordx4 v2, s[20:23], s37 offen lds
s_add_u32 m0, s50, 19456
s_nop 0
buffer_load_dwordx4 v3, s[20:23], s37 offen lds
s_add_u32 m0, s50, 20480
s_nop 0
buffer_load_dwordx4 v4, s[20:23], s37 offen lds
s_add_u32 s37, s51, 73728
s_add_u32 m0, s50, 21504
s_nop 0
buffer_load_dwordx4 v2, s[20:23], s37 offen lds
s_add_u32 m0, s50, 22528
s_nop 0
buffer_load_dwordx4 v3, s[20:23], s37 offen lds
s_add_u32 m0, s50, 23552
s_nop 0
buffer_load_dwordx4 v4, s[20:23], s37 offen lds
s_add_u32 s37, s51, 110592
s_add_u32 m0, s50, 24576
s_nop 0
buffer_load_dwordx4 v2, s[20:23], s37 offen lds
s_add_u32 m0, s50, 25600
s_nop 0
buffer_load_dwordx4 v3, s[20:23], s37 offen lds
s_add_u32 m0, s50, 26624
s_nop 0
buffer_load_dwordx4 v4, s[20:23], s37 offen lds
s_waitcnt vmcnt(24)
ds_read_b64_tr_b16 v[68:69], v6 offset:0
ds_read_b64_tr_b16 v[70:71], v6 offset:384
ds_read_b64_tr_b16 v[72:73], v6 offset:32
ds_read_b64_tr_b16 v[74:75], v6 offset:416
ds_read_b64_tr_b16 v[76:77], v6 offset:64
ds_read_b64_tr_b16 v[78:79], v6 offset:448
s_waitcnt lgkmcnt(0)
s_add_u32 s37, s51, 147456
s_add_u32 m0, s50, 27648
s_nop 0
buffer_load_dwordx4 v2, s[20:23], s37 offen lds
s_add_u32 m0, s50, 28672
s_nop 0
buffer_load_dwordx4 v3, s[20:23], s37 offen lds
s_add_u32 m0, s50, 29696
s_nop 0
buffer_load_dwordx4 v4, s[20:23], s37 offen lds
s_waitcnt vmcnt(24)
ds_read_b64_tr_b16 v[80:81], v6 offset:3072
ds_read_b64_tr_b16 v[82:83], v6 offset:3456
ds_read_b64_tr_b16 v[84:85], v6 offset:3104
ds_read_b64_tr_b16 v[86:87], v6 offset:3488
ds_read_b64_tr_b16 v[88:89], v6 offset:3136
ds_read_b64_tr_b16 v[90:91], v6 offset:3520
s_waitcnt lgkmcnt(0)
s_add_u32 s37, s51, 184320
s_add_u32 m0, s50, 0
s_nop 0
buffer_load_dwordx4 v2, s[20:23], s37 offen lds
s_add_u32 m0, s50, 1024
s_nop 0
buffer_load_dwordx4 v3, s[20:23], s37 offen lds
s_add_u32 m0, s50, 2048
s_nop 0
buffer_load_dwordx4 v4, s[20:23], s37 offen lds
s_waitcnt vmcnt(24)
ds_read_b64_tr_b16 v[92:93], v6 offset:6144
ds_read_b64_tr_b16 v[94:95], v6 offset:6528
ds_read_b64_tr_b16 v[96:97], v6 offset:6176
ds_read_b64_tr_b16 v[98:99], v6 offset:6560
ds_read_b64_tr_b16 v[100:101], v6 offset:6208
ds_read_b64_tr_b16 v[102:103], v6 offset:6592
s_waitcnt lgkmcnt(0)
s_add_u32 s37, s51, 221184
s_add_u32 m0, s50, 3072
s_nop 0
buffer_load_dwordx4 v2, s[20:23], s37 offen lds
s_add_u32 m0, s50, 4096
s_nop 0
buffer_load_dwordx4 v3, s[20:23], s37 offen lds
s_add_u32 m0, s50, 5120
s_nop 0
buffer_load_dwordx4 v4, s[20:23], s37 offen lds
s_waitcnt vmcnt(24)
ds_read_b64_tr_b16 v[104:105], v6 offset:9216
ds_read_b64_tr_b16 v[106:107], v6 offset:9600
ds_read_b64_tr_b16 v[108:109], v6 offset:9248
ds_read_b64_tr_b16 v[110:111], v6 offset:9632
ds_read_b64_tr_b16 v[112:113], v6 offset:9280
ds_read_b64_tr_b16 v[114:115], v6 offset:9664
s_waitcnt lgkmcnt(0)
s_add_u32 s37, s51, 258048
s_add_u32 m0, s50, 6144
s_nop 0
buffer_load_dwordx4 v2, s[20:23], s37 offen lds
s_add_u32 m0, s50, 7168
s_nop 0
buffer_load_dwordx4 v3, s[20:23], s37 offen lds
s_add_u32 m0, s50, 8192
s_nop 0
buffer_load_dwordx4 v4, s[20:23], s37 offen lds
s_waitcnt vmcnt(24)
ds_read_b64_tr_b16 v[116:117], v6 offset:12288
ds_read_b64_tr_b16 v[118:119], v6 offset:12672
ds_read_b64_tr_b16 v[120:121], v6 offset:12320
ds_read_b64_tr_b16 v[122:123], v6 offset:12704
ds_read_b64_tr_b16 v[124:125], v6 offset:12352
ds_read_b64_tr_b16 v[126:127], v6 offset:12736
s_waitcnt lgkmcnt(0)
s_add_u32 s37, s51, 294912
s_add_u32 m0, s50, 9216
s_nop 0
buffer_load_dwordx4 v2, s[20:23], s37 offen lds
s_add_u32 m0, s50, 10240
s_nop 0
buffer_load_dwordx4 v3, s[20:23], s37 offen lds
s_add_u32 m0, s50, 11264
s_nop 0
buffer_load_dwordx4 v4, s[20:23], s37 offen lds
s_waitcnt vmcnt(24)
ds_read_b64_tr_b16 v[128:129], v5 offset:15360
ds_read_b64_tr_b16 v[130:131], v5 offset:16896
ds_read_b64_tr_b16 v[132:133], v5 offset:15392
ds_read_b64_tr_b16 v[134:135], v5 offset:16928
ds_read_b64_tr_b16 v[136:137], v5 offset:15424
ds_read_b64_tr_b16 v[138:139], v5 offset:16960
s_waitcnt lgkmcnt(0)
s_add_u32 s37, s51, 331776
s_add_u32 m0, s50, 12288
s_nop 0
buffer_load_dwordx4 v2, s[20:23], s37 offen lds
s_add_u32 m0, s50, 13312
s_nop 0
buffer_load_dwordx4 v3, s[20:23], s37 offen lds
s_add_u32 m0, s50, 14336
s_nop 0
buffer_load_dwordx4 v4, s[20:23], s37 offen lds
s_waitcnt vmcnt(24)
ds_read_b64_tr_b16 v[140:141], v5 offset:18432
ds_read_b64_tr_b16 v[142:143], v5 offset:19968
ds_read_b64_tr_b16 v[144:145], v5 offset:18464
ds_read_b64_tr_b16 v[146:147], v5 offset:20000
ds_read_b64_tr_b16 v[148:149], v5 offset:18496
ds_read_b64_tr_b16 v[150:151], v5 offset:20032
s_waitcnt lgkmcnt(0)
s_add_u32 s37, s51, 368640
s_add_u32 m0, s50, 15360
s_nop 0
buffer_load_dwordx4 v2, s[20:23], s37 offen lds
s_add_u32 m0, s50, 16384
s_nop 0
buffer_load_dwordx4 v3, s[20:23], s37 offen lds
s_add_u32 m0, s50, 17408
s_nop 0
buffer_load_dwordx4 v4, s[20:23], s37 offen lds
s_waitcnt vmcnt(24)
ds_read_b64_tr_b16 v[152:153], v5 offset:21504
ds_read_b64_tr_b16 v[154:155], v5 offset:23040
ds_read_b64_tr_b16 v[156:157], v5 offset:21536
ds_read_b64_tr_b16 v[158:159], v5 offset:23072
ds_read_b64_tr_b16 v[160:161], v5 offset:21568
ds_read_b64_tr_b16 v[162:163], v5 offset:23104
s_waitcnt lgkmcnt(0)
s_add_u32 s37, s51, 405504
s_add_u32 m0, s50, 18432
s_nop 0
buffer_load_dwordx4 v2, s[20:23], s37 offen lds
s_add_u32 m0, s50, 19456
s_nop 0
buffer_load_dwordx4 v3, s[20:23], s37 offen lds
s_add_u32 m0, s50, 20480
s_nop 0
buffer_load_dwordx4 v4, s[20:23], s37 offen lds
s_waitcnt vmcnt(24)
ds_read_b64_tr_b16 v[164:165], v5 offset:24576
ds_read_b64_tr_b16 v[166:167], v5 offset:26112
ds_read_b64_tr_b16 v[168:169], v5 offset:24608
ds_read_b64_tr_b16 v[170:171], v5 offset:26144
ds_read_b64_tr_b16 v[172:173], v5 offset:24640
ds_read_b64_tr_b16 v[174:175], v5 offset:26176
s_waitcnt lgkmcnt(0)
s_add_u32 s37, s51, 442368
s_add_u32 m0, s50, 21504
s_nop 0
buffer_load_dwordx4 v2, s[20:23], s37 offen lds
s_add_u32 m0, s50, 22528
s_nop 0
buffer_load_dwordx4 v3, s[20:23], s37 offen lds
s_add_u32 m0, s50, 23552
s_nop 0
buffer_load_dwordx4 v4, s[20:23], s37 offen lds
s_waitcnt vmcnt(24)
ds_read_b64_tr_b16 v[176:177], v5 offset:27648
ds_read_b64_tr_b16 v[178:179], v5 offset:29184
ds_read_b64_tr_b16 v[180:181], v5 offset:27680
ds_read_b64_tr_b16 v[182:183], v5 offset:29216
ds_read_b64_tr_b16 v[184:185], v5 offset:27712
ds_read_b64_tr_b16 v[186:187], v5 offset:29248
s_waitcnt lgkmcnt(0)
s_add_u32 s37, s51, 479232
s_add_u32 m0, s50, 24576
s_nop 0
buffer_load_dwordx4 v2, s[20:23], s37 offen lds
s_add_u32 m0, s50, 25600
s_nop 0
buffer_load_dwordx4 v3, s[20:23], s37 offen lds
s_add_u32 m0, s50, 26624
s_nop 0
buffer_load_dwordx4 v4, s[20:23], s37 offen lds
s_waitcnt vmcnt(24)
ds_read_b64_tr_b16 v[188:189], v5 offset:0
ds_read_b64_tr_b16 v[190:191], v5 offset:1536
ds_read_b64_tr_b16 v[192:193], v5 offset:32
ds_read_b64_tr_b16 v[194:195], v5 offset:1568
ds_read_b64_tr_b16 v[196:197], v5 offset:64
ds_read_b64_tr_b16 v[198:199], v5 offset:1600
s_waitcnt lgkmcnt(0)
s_add_u32 s37, s51, 516096
s_add_u32 m0, s50, 27648
s_nop 0
buffer_load_dwordx4 v2, s[20:23], s37 offen lds
s_add_u32 m0, s50, 28672
s_nop 0
buffer_load_dwordx4 v3, s[20:23], s37 offen lds
s_add_u32 m0, s50, 29696
s_nop 0
buffer_load_dwordx4 v4, s[20:23], s37 offen lds
s_waitcnt vmcnt(24)
ds_read_b64_tr_b16 v[200:201], v5 offset:3072
ds_read_b64_tr_b16 v[202:203], v5 offset:4608
ds_read_b64_tr_b16 v[204:205], v5 offset:3104
ds_read_b64_tr_b16 v[206:207], v5 offset:4640
ds_read_b64_tr_b16 v[208:209], v5 offset:3136
ds_read_b64_tr_b16 v[210:211], v5 offset:4672
s_waitcnt lgkmcnt(0)
s_add_u32 s37, s51, 552960
s_add_u32 m0, s50, 0
s_nop 0
buffer_load_dwordx4 v2, s[20:23], s37 offen lds
s_add_u32 m0, s50, 1024
s_nop 0
buffer_load_dwordx4 v3, s[20:23], s37 offen lds
s_add_u32 m0, s50, 2048
s_nop 0
buffer_load_dwordx4 v4, s[20:23], s37 offen lds
s_waitcnt vmcnt(24)
ds_read_b64_tr_b16 v[212:213], v5 offset:6144
ds_read_b64_tr_b16 v[214:215], v5 offset:7680
ds_read_b64_tr_b16 v[216:217], v5 offset:6176
ds_read_b64_tr_b16 v[218:219], v5 offset:7712
ds_read_b64_tr_b16 v[220:221], v5 offset:6208
ds_read_b64_tr_b16 v[222:223], v5 offset:7744
s_waitcnt lgkmcnt(0)
s_add_u32 s37, s51, 589824
s_add_u32 m0, s50, 3072
s_nop 0
buffer_load_dwordx4 v2, s[20:23], s37 offen lds
s_add_u32 m0, s50, 4096
s_nop 0
buffer_load_dwordx4 v3, s[20:23], s37 offen lds
s_add_u32 m0, s50, 5120
s_nop 0
buffer_load_dwordx4 v4, s[20:23], s37 offen lds
s_waitcnt vmcnt(24)
ds_read_b64_tr_b16 v[224:225], v5 offset:9216
ds_read_b64_tr_b16 v[226:227], v5 offset:10752
ds_read_b64_tr_b16 v[228:229], v5 offset:9248
ds_read_b64_tr_b16 v[230:231], v5 offset:10784
ds_read_b64_tr_b16 v[232:233], v5 offset:9280
ds_read_b64_tr_b16 v[234:235], v5 offset:10816
s_waitcnt lgkmcnt(0)
s_add_u32 s37, s51, 626688
s_add_u32 m0, s50, 6144
s_nop 0
buffer_load_dwordx4 v2, s[20:23], s37 offen lds
s_add_u32 m0, s50, 7168
s_nop 0
buffer_load_dwordx4 v3, s[20:23], s37 offen lds
s_add_u32 m0, s50, 8192
s_nop 0
buffer_load_dwordx4 v4, s[20:23], s37 offen lds
s_waitcnt vmcnt(24)
ds_read_b64_tr_b16 v[236:237], v5 offset:12288
ds_read_b64_tr_b16 v[238:239], v5 offset:13824
ds_read_b64_tr_b16 v[240:241], v5 offset:12320
ds_read_b64_tr_b16 v[242:243], v5 offset:13856
ds_read_b64_tr_b16 v[244:245], v5 offset:12352
ds_read_b64_tr_b16 v[246:247], v5 offset:13888
s_waitcnt lgkmcnt(0)
s_add_u32 s37, s51, 663552
s_add_u32 m0, s50, 9216
s_nop 0
buffer_load_dwordx4 v2, s[20:23], s37 offen lds
s_add_u32 m0, s50, 10240
s_nop 0
buffer_load_dwordx4 v3, s[20:23], s37 offen lds
s_add_u32 m0, s50, 11264
s_nop 0
buffer_load_dwordx4 v4, s[20:23], s37 offen lds
s_waitcnt vmcnt(24)
ds_read_b64_tr_b16 v[248:249], v5 offset:15360
ds_read_b64_tr_b16 v[250:251], v5 offset:16896
ds_read_b64_tr_b16 v[252:253], v5 offset:15392
ds_read_b64_tr_b16 v[254:255], v5 offset:16928
ds_read_b64_tr_b16 a[0:1], v5 offset:15424
ds_read_b64_tr_b16 a[2:3], v5 offset:16960
s_waitcnt lgkmcnt(0)
s_add_u32 s37, s51, 700416
s_add_u32 m0, s50, 12288
s_nop 0
buffer_load_dwordx4 v2, s[20:23], s37 offen lds
s_add_u32 m0, s50, 13312
s_nop 0
buffer_load_dwordx4 v3, s[20:23], s37 offen lds
s_add_u32 m0, s50, 14336
s_nop 0
buffer_load_dwordx4 v4, s[20:23], s37 offen lds
s_waitcnt vmcnt(24)
ds_read_b64_tr_b16 a[4:5], v5 offset:18432
ds_read_b64_tr_b16 a[6:7], v5 offset:19968
ds_read_b64_tr_b16 a[8:9], v5 offset:18464
ds_read_b64_tr_b16 a[10:11], v5 offset:20000
ds_read_b64_tr_b16 a[12:13], v5 offset:18496
ds_read_b64_tr_b16 a[14:15], v5 offset:20032
s_waitcnt lgkmcnt(0)
s_add_u32 s37, s51, 737280
s_add_u32 m0, s50, 15360
s_nop 0
buffer_load_dwordx4 v2, s[20:23], s37 offen lds
s_add_u32 m0, s50, 16384
s_nop 0
buffer_load_dwordx4 v3, s[20:23], s37 offen lds
s_add_u32 m0, s50, 17408
s_nop 0
buffer_load_dwordx4 v4, s[20:23], s37 offen lds
s_waitcnt vmcnt(24)
ds_read_b64_tr_b16 a[16:17], v5 offset:21504
ds_read_b64_tr_b16 a[18:19], v5 offset:23040
ds_read_b64_tr_b16 a[20:21], v5 offset:21536
ds_read_b64_tr_b16 a[22:23], v5 offset:23072
ds_read_b64_tr_b16 a[24:25], v5 offset:21568
ds_read_b64_tr_b16 a[26:27], v5 offset:23104
s_waitcnt lgkmcnt(0)
s_add_u32 s37, s51, 774144
s_add_u32 m0, s50, 18432
s_nop 0
buffer_load_dwordx4 v2, s[20:23], s37 offen lds
s_add_u32 m0, s50, 19456
s_nop 0
buffer_load_dwordx4 v3, s[20:23], s37 offen lds
s_add_u32 m0, s50, 20480
s_nop 0
buffer_load_dwordx4 v4, s[20:23], s37 offen lds
s_waitcnt vmcnt(24)
ds_read_b64_tr_b16 a[28:29], v5 offset:24576
ds_read_b64_tr_b16 a[30:31], v5 offset:26112
ds_read_b64_tr_b16 a[32:33], v5 offset:24608
ds_read_b64_tr_b16 a[34:35], v5 offset:26144
ds_read_b64_tr_b16 a[36:37], v5 offset:24640
ds_read_b64_tr_b16 a[38:39], v5 offset:26176
s_waitcnt lgkmcnt(0)
s_add_u32 s37, s51, 811008
s_add_u32 m0, s50, 21504
s_nop 0
buffer_load_dwordx4 v2, s[20:23], s37 offen lds
s_add_u32 m0, s50, 22528
s_nop 0
buffer_load_dwordx4 v3, s[20:23], s37 offen lds
s_add_u32 m0, s50, 23552
s_nop 0
buffer_load_dwordx4 v4, s[20:23], s37 offen lds
s_waitcnt vmcnt(24)
ds_read_b64_tr_b16 a[40:41], v5 offset:27648
ds_read_b64_tr_b16 a[42:43], v5 offset:29184
ds_read_b64_tr_b16 a[44:45], v5 offset:27680
ds_read_b64_tr_b16 a[46:47], v5 offset:29216
ds_read_b64_tr_b16 a[48:49], v5 offset:27712
ds_read_b64_tr_b16 a[50:51], v5 offset:29248
s_waitcnt lgkmcnt(0)
s_add_u32 s37, s51, 847872
s_add_u32 m0, s50, 24576
s_nop 0
buffer_load_dwordx4 v2, s[20:23], s37 offen lds
s_add_u32 m0, s50, 25600
s_nop 0
buffer_load_dwordx4 v3, s[20:23], s37 offen lds
s_add_u32 m0, s50, 26624
s_nop 0
buffer_load_dwordx4 v4, s[20:23], s37 offen lds
s_waitcnt vmcnt(24)
ds_read_b64_tr_b16 a[52:53], v5 offset:0
ds_read_b64_tr_b16 a[54:55], v5 offset:1536
ds_read_b64_tr_b16 a[56:57], v5 offset:32
ds_read_b64_tr_b16 a[58:59], v5 offset:1568
ds_read_b64_tr_b16 a[60:61], v5 offset:64
ds_read_b64_tr_b16 a[62:63], v5 offset:1600
s_waitcnt lgkmcnt(0)
s_add_u32 s37, s51, 884736
s_add_u32 m0, s50, 27648
s_nop 0
buffer_load_dwordx4 v2, s[20:23], s37 offen lds
s_add_u32 m0, s50, 28672
s_nop 0
buffer_load_dwordx4 v3, s[20:23], s37 offen lds
s_add_u32 m0, s50, 29696
s_nop 0
buffer_load_dwordx4 v4, s[20:23], s37 offen lds
s_waitcnt vmcnt(24)
ds_read_b64_tr_b16 a[64:65], v5 offset:3072
ds_read_b64_tr_b16 a[66:67], v5 offset:4608
ds_read_b64_tr_b16 a[68:69], v5 offset:3104
ds_read_b64_tr_b16 a[70:71], v5 offset:4640
ds_read_b64_tr_b16 a[72:73], v5 offset:3136
ds_read_b64_tr_b16 a[74:75], v5 offset:4672
s_waitcnt lgkmcnt(0)
s_add_u32 s37, s51, 921600
s_add_u32 m0, s50, 0
s_nop 0
buffer_load_dwordx4 v2, s[20:23], s37 offen lds
s_add_u32 m0, s50, 1024
s_nop 0
buffer_load_dwordx4 v3, s[20:23], s37 offen lds
s_add_u32 m0, s50, 2048
s_nop 0
buffer_load_dwordx4 v4, s[20:23], s37 offen lds
s_waitcnt vmcnt(24)
ds_read_b64_tr_b16 a[76:77], v5 offset:6144
ds_read_b64_tr_b16 a[78:79], v5 offset:7680
ds_read_b64_tr_b16 a[80:81], v5 offset:6176
ds_read_b64_tr_b16 a[82:83], v5 offset:7712
ds_read_b64_tr_b16 a[84:85], v5 offset:6208
ds_read_b64_tr_b16 a[86:87], v5 offset:7744
s_waitcnt lgkmcnt(0)
s_add_u32 s37, s51, 958464
s_add_u32 m0, s50, 3072
s_nop 0
buffer_load_dwordx4 v2, s[20:23], s37 offen lds
s_add_u32 m0, s50, 4096
s_nop 0
buffer_load_dwordx4 v3, s[20:23], s37 offen lds
s_add_u32 m0, s50, 5120
s_nop 0
buffer_load_dwordx4 v4, s[20:23], s37 offen lds
s_waitcnt vmcnt(24)
ds_read_b64_tr_b16 a[88:89], v5 offset:9216
ds_read_b64_tr_b16 a[90:91], v5 offset:10752
ds_read_b64_tr_b16 a[92:93], v5 offset:9248
ds_read_b64_tr_b16 a[94:95], v5 offset:10784
ds_read_b64_tr_b16 a[96:97], v5 offset:9280
ds_read_b64_tr_b16 a[98:99], v5 offset:10816
s_waitcnt lgkmcnt(0)
s_add_u32 s37, s51, 995328
s_add_u32 m0, s50, 6144
s_nop 0
buffer_load_dwordx4 v2, s[20:23], s37 offen lds
s_add_u32 m0, s50, 7168
s_nop 0
buffer_load_dwordx4 v3, s[20:23], s37 offen lds
s_add_u32 m0, s50, 8192
s_nop 0
buffer_load_dwordx4 v4, s[20:23], s37 offen lds
s_waitcnt vmcnt(24)
ds_read_b64_tr_b16 a[100:101], v5 offset:12288
ds_read_b64_tr_b16 a[102:103], v5 offset:13824
ds_read_b64_tr_b16 a[104:105], v5 offset:12320
ds_read_b64_tr_b16 a[106:107], v5 offset:13856
ds_read_b64_tr_b16 a[108:109], v5 offset:12352
ds_read_b64_tr_b16 a[110:111], v5 offset:13888
s_waitcnt lgkmcnt(0)
s_add_u32 s37, s51, 1032192
s_add_u32 m0, s50, 9216
s_nop 0
buffer_load_dwordx4 v2, s[20:23], s37 offen lds
s_add_u32 m0, s50, 10240
s_nop 0
buffer_load_dwordx4 v3, s[20:23], s37 offen lds
s_add_u32 m0, s50, 11264
s_nop 0
buffer_load_dwordx4 v4, s[20:23], s37 offen lds
s_waitcnt vmcnt(24)
ds_read_b64_tr_b16 a[112:113], v5 offset:15360
ds_read_b64_tr_b16 a[114:115], v5 offset:16896
ds_read_b64_tr_b16 a[116:117], v5 offset:15392
ds_read_b64_tr_b16 a[118:119], v5 offset:16928
ds_read_b64_tr_b16 a[120:121], v5 offset:15424
ds_read_b64_tr_b16 a[122:123], v5 offset:16960
s_waitcnt lgkmcnt(0)
s_add_u32 s37, s51, 1069056
s_add_u32 m0, s50, 12288
s_nop 0
buffer_load_dwordx4 v2, s[20:23], s37 offen lds
s_add_u32 m0, s50, 13312
s_nop 0
buffer_load_dwordx4 v3, s[20:23], s37 offen lds
s_add_u32 m0, s50, 14336
s_nop 0
buffer_load_dwordx4 v4, s[20:23], s37 offen lds
s_waitcnt vmcnt(24)
ds_read_b64_tr_b16 a[124:125], v5 offset:18432
ds_read_b64_tr_b16 a[126:127], v5 offset:19968
ds_read_b64_tr_b16 a[128:129], v5 offset:18464
ds_read_b64_tr_b16 a[130:131], v5 offset:20000
ds_read_b64_tr_b16 a[132:133], v5 offset:18496
ds_read_b64_tr_b16 a[134:135], v5 offset:20032
s_waitcnt lgkmcnt(0)
s_add_u32 s37, s51, 1105920
s_add_u32 m0, s50, 15360
s_nop 0
buffer_load_dwordx4 v2, s[20:23], s37 offen lds
s_add_u32 m0, s50, 16384
s_nop 0
buffer_load_dwordx4 v3, s[20:23], s37 offen lds
s_add_u32 m0, s50, 17408
s_nop 0
buffer_load_dwordx4 v4, s[20:23], s37 offen lds
s_waitcnt vmcnt(24)
ds_read_b64_tr_b16 a[136:137], v5 offset:21504
ds_read_b64_tr_b16 a[138:139], v5 offset:23040
ds_read_b64_tr_b16 a[140:141], v5 offset:21536
ds_read_b64_tr_b16 a[142:143], v5 offset:23072
ds_read_b64_tr_b16 a[144:145], v5 offset:21568
ds_read_b64_tr_b16 a[146:147], v5 offset:23104
s_waitcnt lgkmcnt(0)
s_add_u32 s37, s51, 1142784
s_add_u32 m0, s50, 18432
s_nop 0
buffer_load_dwordx4 v2, s[20:23], s37 offen lds
s_add_u32 m0, s50, 19456
s_nop 0
buffer_load_dwordx4 v3, s[20:23], s37 offen lds
s_add_u32 m0, s50, 20480
s_nop 0
buffer_load_dwordx4 v4, s[20:23], s37 offen lds
s_waitcnt vmcnt(24)
ds_read_b64_tr_b16 a[148:149], v5 offset:24576
ds_read_b64_tr_b16 a[150:151], v5 offset:26112
ds_read_b64_tr_b16 a[152:153], v5 offset:24608
ds_read_b64_tr_b16 a[154:155], v5 offset:26144
ds_read_b64_tr_b16 a[156:157], v5 offset:24640
ds_read_b64_tr_b16 a[158:159], v5 offset:26176
s_waitcnt lgkmcnt(0)
s_waitcnt vmcnt(21)
ds_read_b64_tr_b16 a[160:161], v5 offset:27648
ds_read_b64_tr_b16 a[162:163], v5 offset:29184
ds_read_b64_tr_b16 a[164:165], v5 offset:27680
ds_read_b64_tr_b16 a[166:167], v5 offset:29216
ds_read_b64_tr_b16 a[168:169], v5 offset:27712
ds_read_b64_tr_b16 a[170:171], v5 offset:29248
s_waitcnt lgkmcnt(0)
s_waitcnt vmcnt(18)
ds_read_b64_tr_b16 a[172:173], v5 offset:0
ds_read_b64_tr_b16 a[174:175], v5 offset:1536
ds_read_b64_tr_b16 a[176:177], v5 offset:32
ds_read_b64_tr_b16 a[178:179], v5 offset:1568
ds_read_b64_tr_b16 a[180:181], v5 offset:64
ds_read_b64_tr_b16 a[182:183], v5 offset:1600
s_waitcnt lgkmcnt(0)
s_waitcnt vmcnt(15)
ds_read_b64_tr_b16 a[184:185], v5 offset:3072
ds_read_b64_tr_b16 a[186:187], v5 offset:4608
ds_read_b64_tr_b16 a[188:189], v5 offset:3104
ds_read_b64_tr_b16 a[190:191], v5 offset:4640
ds_read_b64_tr_b16 a[192:193], v5 offset:3136
ds_read_b64_tr_b16 a[194:195], v5 offset:4672
s_waitcnt lgkmcnt(0)
s_waitcnt vmcnt(12)
ds_read_b64_tr_b16 a[196:197], v5 offset:6144
ds_read_b64_tr_b16 a[198:199], v5 offset:7680
ds_read_b64_tr_b16 a[200:201], v5 offset:6176
ds_read_b64_tr_b16 a[202:203], v5 offset:7712
ds_read_b64_tr_b16 a[204:205], v5 offset:6208
ds_read_b64_tr_b16 a[206:207], v5 offset:7744
s_waitcnt lgkmcnt(0)
s_waitcnt vmcnt(9)
ds_read_b64_tr_b16 a[208:209], v5 offset:9216
ds_read_b64_tr_b16 a[210:211], v5 offset:10752
ds_read_b64_tr_b16 a[212:213], v5 offset:9248
ds_read_b64_tr_b16 a[214:215], v5 offset:10784
ds_read_b64_tr_b16 a[216:217], v5 offset:9280
ds_read_b64_tr_b16 a[218:219], v5 offset:10816
s_waitcnt lgkmcnt(0)
s_waitcnt vmcnt(6)
ds_read_b64_tr_b16 a[220:221], v5 offset:12288
ds_read_b64_tr_b16 a[222:223], v5 offset:13824
ds_read_b64_tr_b16 a[224:225], v5 offset:12320
ds_read_b64_tr_b16 a[226:227], v5 offset:13856
ds_read_b64_tr_b16 a[228:229], v5 offset:12352
ds_read_b64_tr_b16 a[230:231], v5 offset:13888
s_waitcnt lgkmcnt(0)
s_waitcnt vmcnt(3)
ds_read_b64_tr_b16 a[232:233], v5 offset:15360
ds_read_b64_tr_b16 a[234:235], v5 offset:16896
ds_read_b64_tr_b16 a[236:237], v5 offset:15392
ds_read_b64_tr_b16 a[238:239], v5 offset:16928
ds_read_b64_tr_b16 a[240:241], v5 offset:15424
ds_read_b64_tr_b16 a[242:243], v5 offset:16960
s_waitcnt lgkmcnt(0)
s_waitcnt vmcnt(0)
ds_read_b64_tr_b16 a[244:245], v5 offset:18432
ds_read_b64_tr_b16 a[246:247], v5 offset:19968
ds_read_b64_tr_b16 a[248:249], v5 offset:18464
ds_read_b64_tr_b16 a[250:251], v5 offset:20000
ds_read_b64_tr_b16 a[252:253], v5 offset:18496
ds_read_b64_tr_b16 a[254:255], v5 offset:20032
s_waitcnt lgkmcnt(0)
s_branch L_w_init_in
L_w_init:
s_sleep 4
L_w_init_in:
buffer_load_dword v12, v8, s[24:27], 0 offen offset:0 sc0 sc1
s_sub_u32 s36, s36, 1
s_cbranch_scc1 L_exit_w
s_waitcnt vmcnt(0)
v_readfirstlane_b32 s37, v12
s_nop 0
s_and_b32 s37, s37, 0xff
s_cmp_eq_u32 s37, 32
s_cbranch_scc0 L_w_init
s_branch L_w_adone_in
L_w_adone:
s_sleep 4
L_w_adone_in:
buffer_load_dword v12, v8, s[24:27], 0 offen offset:4 sc0 sc1
s_sub_u32 s36, s36, 1
s_cbranch_scc1 L_exit_w
s_waitcnt vmcnt(0)
v_readfirstlane_b32 s37, v12
s_nop 0
s_cmp_eq_u32 s37, 96
s_cbranch_scc0 L_w_adone
s_mov_b32 s35, 0
s_mul_i32 s52, s34, 5
s_mul_i32 s58, s34, 3072
v_add_u32 v2, s58, v14
s_lshl_b32 s37, s34, 10
v_add_u32 v14, s37, v14
L_w_loop:
s_add_u32 s37, s52, 0
s_min_u32 s37, s37, 17
s_lshl_b32 s37, s37, 10
s_add_u32 s37, s37, s54
buffer_load_dwordx4 v[40:43], v1, s[4:7], s37 offen sc1
s_add_u32 s37, s52, 1
s_min_u32 s37, s37, 17
s_lshl_b32 s37, s37, 10
s_add_u32 s37, s37, s54
buffer_load_dwordx4 v[44:47], v1, s[4:7], s37 offen sc1
s_add_u32 s37, s52, 2
s_min_u32 s37, s37, 17
s_lshl_b32 s37, s37, 10
s_add_u32 s37, s37, s54
buffer_load_dwordx4 v[48:51], v1, s[4:7], s37 offen sc1
s_add_u32 s37, s52, 3
s_min_u32 s37, s37, 17
s_lshl_b32 s37, s37, 10
s_add_u32 s37, s37, s54
buffer_load_dwordx4 v[52:55], v1, s[4:7], s37 offen sc1
s_add_u32 s37, s52, 4
s_min_u32 s37, s37, 17
s_lshl_b32 s37, s37, 10
s_add_u32 s37, s37, s54
buffer_load_dwordx4 v[56:59], v1, s[4:7], s37 offen sc1
buffer_load_dword v13, v10, s[4:7], s56 offen sc1
s_waitcnt vmcnt(5)
v_mfma_f32_16x16x32_bf16 v[28:31], v[68:71], v[40:43], 0
v_mfma_f32_16x16x32_bf16 v[32:35], v[72:75], v[40:43], 0
v_mfma_f32_16x16x32_bf16 v[36:39], v[76:79], v[40:43], 0
s_waitcnt vmcnt(4)
v_mfma_f32_16x16x32_bf16 v[28:31], v[80:83], v[44:47], v[28:31]
v_mfma_f32_16x16x32_bf16 v[32:35], v[84:87], v[44:47], v[32:35]
v_mfma_f32_16x16x32_bf16 v[36:39], v[88:91], v[44:47], v[36:39]
s_waitcnt vmcnt(3)
v_mfma_f32_16x16x32_bf16 v[28:31], v[92:95], v[48:51], v[28:31]
v_mfma_f32_16x16x32_bf16 v[32:35], v[96:99], v[48:51], v[32:35]
v_mfma_f32_16x16x32_bf16 v[36:39], v[100:103], v[48:51], v[36:39]
s_waitcnt vmcnt(2)
v_mfma_f32_16x16x32_bf16 v[28:31], v[104:107], v[52:55], v[28:31]
v_mfma_f32_16x16x32_bf16 v[32:35], v[108:111], v[52:55], v[32:35]
v_mfma_f32_16x16x32_bf16 v[36:39], v[112:115], v[52:55], v[36:39]
s_waitcnt vmcnt(1)
v_mfma_f32_16x16x32_bf16 v[28:31], v[116:119], v[56:59], v[28:31]
v_mfma_f32_16x16x32_bf16 v[32:35], v[120:123], v[56:59], v[32:35]
v_mfma_f32_16x16x32_bf16 v[36:39], v[124:127], v[56:59], v[36:39]
s_branch L_w_poll_in
L_w_poll:
s_sleep 2
L_w_poll_in:
buffer_load_dword v12, v9, s[4:7], s57 offen offset:0 sc0 sc1
s_sub_u32 s36, s36, 1
s_cbranch_scc1 L_exit_w
s_waitcnt vmcnt(0)
v_cmp_ge_u32 vcc, s35, v12
s_nop 1
s_cmp_eq_u64 vcc, 0
s_cbranch_scc0 L_w_poll
s_add_u32 s37, s53, 0
s_add_u32 m0, s50, 0
s_nop 0
buffer_load_dwordx4 v1, s[4:7], s37 offen offset:0 sc1 lds
buffer_load_dwordx4 v1, s[4:7], s37 offen offset:1024 sc1 lds
buffer_load_dwordx4 v1, s[4:7], s37 offen offset:2048 sc1 lds
buffer_load_dwordx4 v1, s[4:7], s37 offen offset:3072 sc1 lds
s_add_u32 s37, s53, 4096
s_add_u32 m0, s50, 4096
s_nop 0
buffer_load_dwordx4 v1, s[4:7], s37 offen offset:0 sc1 lds
buffer_load_dwordx4 v1, s[4:7], s37 offen offset:1024 sc1 lds
buffer_load_dwordx4 v1, s[4:7], s37 offen offset:2048 sc1 lds
buffer_load_dwordx4 v1, s[4:7], s37 offen offset:3072 sc1 lds
s_add_u32 s37, s53, 8192
s_add_u32 m0, s50, 8192
s_nop 0
buffer_load_dwordx4 v1, s[4:7], s37 offen offset:0 sc1 lds
buffer_load_dwordx4 v1, s[4:7], s37 offen offset:1024 sc1 lds
buffer_load_dwordx4 v1, s[4:7], s37 offen offset:2048 sc1 lds
buffer_load_dwordx4 v1, s[4:7], s37 offen offset:3072 sc1 lds
s_add_u32 s37, s53, 12288
s_add_u32 m0, s50, 12288
s_nop 0
buffer_load_dwordx4 v1, s[4:7], s37 offen offset:0 sc1 lds
buffer_load_dwordx4 v1, s[4:7], s37 offen offset:1024 sc1 lds
buffer_load_dwordx4 v1, s[4:7], s37 offen offset:2048 sc1 lds
buffer_load_dwordx4 v1, s[4:7], s37 offen offset:3072 sc1 lds
s_add_u32 s37, s53, 16384
s_add_u32 m0, s50, 16384
s_nop 0
buffer_load_dwordx4 v1, s[4:7], s37 offen offset:0 sc1 lds
buffer_load_dwordx4 v1, s[4:7], s37 offen offset:1024 sc1 lds
buffer_load_dwordx4 v1, s[4:7], s37 offen offset:2048 sc1 lds
buffer_load_dwordx4 v1, s[4:7], s37 offen offset:3072 sc1 lds
s_add_u32 s37, s53, 20480
s_add_u32 m0, s50, 20480
s_nop 0
buffer_load_dwordx4 v1, s[4:7], s37 offen offset:0 sc1 lds
buffer_load_dwordx4 v1, s[4:7], s37 offen offset:1024 sc1 lds
buffer_load_dwordx4 v1, s[4:7], s37 offen offset:2048 sc1 lds
buffer_load_dwordx4 v1, s[4:7], s37 offen offset:3072 sc1 lds
s_add_u32 s37, s53, 24576
s_add_u32 m0, s50, 24576
s_nop 0
buffer_load_dwordx4 v1, s[4:7], s37 offen offset:0 sc1 lds
buffer_load_dwordx4 v1, s[4:7], s37 offen offset:1024 sc1 lds
buffer_load_dwordx4 v1, s[4:7], s37 offen offset:2048 sc1 lds
buffer_load_dwordx4 v1, s[4:7], s37 offen offset:3072 sc1 lds
s_add_u32 s37, s53, 28672
s_add_u32 m0, s50, 28672
s_nop 0
buffer_load_dwordx4 v1, s[4:7], s37 offen offset:0 sc1 lds
buffer_load_dwordx4 v1, s[4:7], s37 offen offset:1024 sc1 lds
buffer_load_dwordx4 v1, s[4:7], s37 offen offset:2048 sc1 lds
buffer_load_dwordx4 v1, s[4:7], s37 offen offset:3072 sc1 lds
s_waitcnt vmcnt(31)
ds_read_b128 v[40:43], v7 offset:0
s_waitcnt vmcnt(30)
ds_read_b128 v[44:47], v7 offset:1024
s_waitcnt vmcnt(29)
ds_read_b128 v[48:51], v7 offset:2048
s_waitcnt lgkmcnt(2)
v_mfma_f32_16x16x32_bf16 v[16:19], v[128:131], v[40:43], 0
v_mfma_f32_16x16x32_bf16 v[20:23], v[132:135], v[40:43], 0
v_mfma_f32_16x16x32_bf16 v[24:27], v[136:139], v[40:43], 0
s_waitcnt vmcnt(28)
ds_read_b128 v[52:55], v7 offset:3072
s_waitcnt lgkmcnt(2)
v_mfma_f32_16x16x32_bf16 v[16:19], v[140:143], v[44:47], v[16:19]
v_mfma_f32_16x16x32_bf16 v[20:23], v[144:147], v[44:47], v[20:23]
v_mfma_f32_16x16x32_bf16 v[24:27], v[148:151], v[44:47], v[24:27]
s_waitcnt vmcnt(27)
ds_read_b128 v[40:43], v7 offset:4096
s_waitcnt lgkmcnt(2)
v_mfma_f32_16x16x32_bf16 v[16:19], v[152:155], v[48:51], v[16:19]
v_mfma_f32_16x16x32_bf16 v[20:23], v[156:159], v[48:51], v[20:23]
v_mfma_f32_16x16x32_bf16 v[24:27], v[160:163], v[48:51], v[24:27]
s_waitcnt vmcnt(26)
ds_read_b128 v[44:47], v7 offset:5120
s_waitcnt lgkmcnt(2)
v_mfma_f32_16x16x32_bf16 v[16:19], v[164:167], v[52:55], v[16:19]
v_mfma_f32_16x16x32_bf16 v[20:23], v[168:171], v[52:55], v[20:23]
v_mfma_f32_16x16x32_bf16 v[24:27], v[172:175], v[52:55], v[24:27]
s_waitcnt vmcnt(25)
ds_read_b128 v[48:51], v7 offset:6144
s_waitcnt lgkmcnt(2)
v_mfma_f32_16x16x32_bf16 v[16:19], v[176:179], v[40:43], v[16:19]
v_mfma_f32_16x16x32_bf16 v[20:23], v[180:183], v[40:43], v[20:23]
v_mfma_f32_16x16x32_bf16 v[24:27], v[184:187], v[40:43], v[24:27]
s_waitcnt vmcnt(24)
ds_read_b128 v[52:55], v7 offset:7168
s_waitcnt lgkmcnt(2)
v_mfma_f32_16x16x32_bf16 v[16:19], v[188:191], v[44:47], v[16:19]
v_mfma_f32_16x16x32_bf16 v[20:23], v[192:195], v[44:47], v[20:23]
v_mfma_f32_16x16x32_bf16 v[24:27], v[196:199], v[44:47], v[24:27]
s_waitcnt vmcnt(23)
ds_read_b128 v[40:43], v7 offset:8192
s_waitcnt lgkmcnt(2)
v_mfma_f32_16x16x32_bf16 v[16:19], v[200:203], v[48:51], v[16:19]
v_mfma_f32_16x16x32_bf16 v[20:23], v[204:207], v[48:51], v[20:23]
v_mfma_f32_16x16x32_bf16 v[24:27], v[208:211], v[48:51], v[24:27]
s_waitcnt vmcnt(22)
ds_read_b128 v[44:47], v7 offset:9216
s_waitcnt lgkmcnt(2)
v_mfma_f32_16x16x32_bf16 v[16:19], v[212:215], v[52:55], v[16:19]
v_mfma_f32_16x16x32_bf16 v[20:23], v[216:219], v[52:55], v[20:23]
v_mfma_f32_16x16x32_bf16 v[24:27], v[220:223], v[52:55], v[24:27]
s_waitcnt vmcnt(21)
ds_read_b128 v[48:51], v7 offset:10240
s_waitcnt lgkmcnt(2)
v_mfma_f32_16x16x32_bf16 v[16:19], v[224:227], v[40:43], v[16:19]
v_mfma_f32_16x16x32_bf16 v[20:23], v[228:231], v[40:43], v[20:23]
v_mfma_f32_16x16x32_bf16 v[24:27], v[232:235], v[40:43], v[24:27]
s_waitcnt vmcnt(20)
ds_read_b128 v[52:55], v7 offset:11264
s_waitcnt lgkmcnt(2)
v_mfma_f32_16x16x32_bf16 v[16:19], v[236:239], v[44:47], v[16:19]
v_mfma_f32_16x16x32_bf16 v[20:23], v[240:243], v[44:47], v[20:23]
v_mfma_f32_16x16x32_bf16 v[24:27], v[244:247], v[44:47], v[24:27]
s_waitcnt vmcnt(19)
ds_read_b128 v[40:43], v7 offset:12288
s_waitcnt lgkmcnt(2)
v_mfma_f32_16x16x32_bf16 v[16:19], v[248:251], v[48:51], v[16:19]
v_mfma_f32_16x16x32_bf16 v[20:23], v[252:255], v[48:51], v[20:23]
v_mfma_f32_16x16x32_bf16 v[24:27], a[0:3], v[48:51], v[24:27]
s_waitcnt vmcnt(18)
ds_read_b128 v[44:47], v7 offset:13312
s_waitcnt lgkmcnt(2)
v_mfma_f32_16x16x32_bf16 v[16:19], a[4:7], v[52:55], v[16:19]
v_mfma_f32_16x16x32_bf16 v[20:23], a[8:11], v[52:55], v[20:23]
v_mfma_f32_16x16x32_bf16 v[24:27], a[12:15], v[52:55], v[24:27]
s_waitcnt vmcnt(17)
ds_read_b128 v[48:51], v7 offset:14336
s_waitcnt lgkmcnt(2)
v_mfma_f32_16x16x32_bf16 v[16:19], a[16:19], v[40:43], v[16:19]
v_mfma_f32_16x16x32_bf16 v[20:23], a[20:23], v[40:43], v[20:23]
v_mfma_f32_16x16x32_bf16 v[24:27], a[24:27], v[40:43], v[24:27]
s_waitcnt vmcnt(16)
ds_read_b128 v[52:55], v7 offset:15360
s_waitcnt lgkmcnt(2)
v_mfma_f32_16x16x32_bf16 v[16:19], a[28:31], v[44:47], v[16:19]
v_mfma_f32_16x16x32_bf16 v[20:23], a[32:35], v[44:47], v[20:23]
v_mfma_f32_16x16x32_bf16 v[24:27], a[36:39], v[44:47], v[24:27]
s_waitcnt vmcnt(15)
ds_read_b128 v[40:43], v7 offset:16384
s_waitcnt lgkmcnt(2)
v_mfma_f32_16x16x32_bf16 v[16:19], a[40:43], v[48:51], v[16:19]
v_mfma_f32_16x16x32_bf16 v[20:23], a[44:47], v[48:51], v[20:23]
v_mfma_f32_16x16x32_bf16 v[24:27], a[48:51], v[48:51], v[24:27]
s_waitcnt vmcnt(14)
ds_read_b128 v[44:47], v7 offset:17408
s_waitcnt lgkmcnt(2)
v_mfma_f32_16x16x32_bf16 v[16:19], a[52:55], v[52:55], v[16:19]
v_mfma_f32_16x16x32_bf16 v[20:23], a[56:59], v[52:55], v[20:23]
v_mfma_f32_16x16x32_bf16 v[24:27], a[60:63], v[52:55], v[24:27]
s_waitcnt vmcnt(13)
ds_read_b128 v[48:51], v7 offset:18432
s_waitcnt lgkmcnt(2)
v_mfma_f32_16x16x32_bf16 v[16:19], a[64:67], v[40:43], v[16:19]
v_mfma_f32_16x16x32_bf16 v[20:23], a[68:71], v[40:43], v[20:23]
v_mfma_f32_16x16x32_bf16 v[24:27], a[72:75], v[40:43], v[24:27]
s_waitcnt vmcnt(12)
ds_read_b128 v[52:55], v7 offset:19456
s_waitcnt lgkmcnt(2)
v_mfma_f32_16x16x32_bf16 v[16:19], a[76:79], v[44:47], v[16:19]
v_mfma_f32_16x16x32_bf16 v[20:23], a[80:83], v[44:47], v[20:23]
v_mfma_f32_16x16x32_bf16 v[24:27], a[84:87], v[44:47], v[24:27]
s_waitcnt vmcnt(11)
ds_read_b128 v[40:43], v7 offset:20480
s_waitcnt lgkmcnt(2)
v_mfma_f32_16x16x32_bf16 v[16:19], a[88:91], v[48:51], v[16:19]
v_mfma_f32_16x16x32_bf16 v[20:23], a[92:95], v[48:51], v[20:23]
v_mfma_f32_16x16x32_bf16 v[24:27], a[96:99], v[48:51], v[24:27]
s_waitcnt vmcnt(10)
ds_read_b128 v[44:47], v7 offset:21504
s_waitcnt lgkmcnt(2)
v_mfma_f32_16x16x32_bf16 v[16:19], a[100:103], v[52:55], v[16:19]
v_mfma_f32_16x16x32_bf16 v[20:23], a[104:107], v[52:55], v[20:23]
v_mfma_f32_16x16x32_bf16 v[24:27], a[108:111], v[52:55], v[24:27]
s_waitcnt vmcnt(9)
ds_read_b128 v[48:51], v7 offset:22528
s_waitcnt lgkmcnt(2)
v_mfma_f32_16x16x32_bf16 v[16:19], a[112:115], v[40:43], v[16:19]
v_mfma_f32_16x16x32_bf16 v[20:23], a[116:119], v[40:43], v[20:23]
v_mfma_f32_16x16x32_bf16 v[24:27], a[120:123], v[40:43], v[24:27]
s_waitcnt vmcnt(8)
ds_read_b128 v[52:55], v7 offset:23552
s_waitcnt lgkmcnt(2)
v_mfma_f32_16x16x32_bf16 v[16:19], a[124:127], v[44:47], v[16:19]
v_mfma_f32_16x16x32_bf16 v[20:23], a[128:131], v[44:47], v[20:23]
v_mfma_f32_16x16x32_bf16 v[24:27], a[132:135], v[44:47], v[24:27]
s_waitcnt vmcnt(7)
ds_read_b128 v[40:43], v7 offset:24576
s_waitcnt lgkmcnt(2)
v_mfma_f32_16x16x32_bf16 v[16:19], a[136:139], v[48:51], v[16:19]
v_mfma_f32_16x16x32_bf16 v[20:23], a[140:143], v[48:51], v[20:23]
v_mfma_f32_16x16x32_bf16 v[24:27], a[144:147], v[48:51], v[24:27]
s_waitcnt vmcnt(6)
ds_read_b128 v[44:47], v7 offset:25600
s_waitcnt lgkmcnt(2)
v_mfma_f32_16x16x32_bf16 v[16:19], a[148:151], v[52:55], v[16:19]
v_mfma_f32_16x16x32_bf16 v[20:23], a[152:155], v[52:55], v[20:23]
v_mfma_f32_16x16x32_bf16 v[24:27], a[156:159], v[52:55], v[24:27]
s_waitcnt vmcnt(5)
ds_read_b128 v[48:51], v7 offset:26624
s_waitcnt lgkmcnt(2)
v_mfma_f32_16x16x32_bf16 v[16:19], a[160:163], v[40:43], v[16:19]
v_mfma_f32_16x16x32_bf16 v[20:23], a[164:167], v[40:43], v[20:23]
v_mfma_f32_16x16x32_bf16 v[24:27], a[168:171], v[40:43], v[24:27]
s_waitcnt vmcnt(4)
ds_read_b128 v[52:55], v7 offset:27648
s_waitcnt lgkmcnt(2)
v_mfma_f32_16x16x32_bf16 v[16:19], a[172:175], v[44:47], v[16:19]
v_mfma_f32_16x16x32_bf16 v[20:23], a[176:179], v[44:47], v[20:23]
v_mfma_f32_16x16x32_bf16 v[24:27], a[180:183], v[44:47], v[24:27]
s_waitcnt vmcnt(3)
ds_read_b128 v[40:43], v7 offset:28672
s_waitcnt lgkmcnt(2)
v_mfma_f32_16x16x32_bf16 v[16:19], a[184:187], v[48:51], v[16:19]
v_mfma_f32_16x16x32_bf16 v[20:23], a[188:191], v[48:51], v[20:23]
v_mfma_f32_16x16x32_bf16 v[24:27], a[192:195], v[48:51], v[24:27]
s_waitcnt vmcnt(2)
ds_read_b128 v[44:47], v7 offset:29696
s_waitcnt lgkmcnt(2)
v_mfma_f32_16x16x32_bf16 v[16:19], a[196:199], v[52:55], v[16:19]
v_mfma_f32_16x16x32_bf16 v[20:23], a[200:203], v[52:55], v[20:23]
v_mfma_f32_16x16x32_bf16 v[24:27], a[204:207], v[52:55], v[24:27]
s_waitcnt vmcnt(1)
ds_read_b128 v[48:51], v7 offset:30720
s_waitcnt lgkmcnt(2)
v_mfma_f32_16x16x32_bf16 v[16:19], a[208:211], v[40:43], v[16:19]
v_mfma_f32_16x16x32_bf16 v[20:23], a[212:215], v[40:43], v[20:23]
v_mfma_f32_16x16x32_bf16 v[24:27], a[216:219], v[40:43], v[24:27]
s_waitcnt vmcnt(0)
ds_read_b128 v[52:55], v7 offset:31744
s_waitcnt lgkmcnt(2)
v_mfma_f32_16x16x32_bf16 v[16:19], a[220:223], v[44:47], v[16:19]
v_mfma_f32_16x16x32_bf16 v[20:23], a[224:227], v[44:47], v[20:23]
v_mfma_f32_16x16x32_bf16 v[24:27], a[228:231], v[44:47], v[24:27]
s_waitcnt lgkmcnt(1)
v_mfma_f32_16x16x32_bf16 v[16:19], a[232:235], v[48:51], v[16:19]
v_mfma_f32_16x16x32_bf16 v[20:23], a[236:239], v[48:51], v[20:23]
v_mfma_f32_16x16x32_bf16 v[24:27], a[240:243], v[48:51], v[24:27]
s_waitcnt lgkmcnt(0)
v_mfma_f32_16x16x32_bf16 v[16:19], a[244:247], v[52:55], v[16:19]
v_mfma_f32_16x16x32_bf16 v[20:23], a[248:251], v[52:55], v[20:23]
v_mfma_f32_16x16x32_bf16 v[24:27], a[252:255], v[52:55], v[24:27]
v_fma_f32 v16, v16, v13, v28
v_fma_f32 v17, v17, v13, v29
v_fma_f32 v18, v18, v13, v30
v_fma_f32 v19, v19, v13, v31
ds_write_b128 v2, v[16:19] offset:0
v_fma_f32 v20, v20, v13, v32
v_fma_f32 v21, v21, v13, v33
v_fma_f32 v22, v22, v13, v34
v_fma_f32 v23, v23, v13, v35
ds_write_b128 v2, v[20:23] offset:1024
v_fma_f32 v24, v24, v13, v36
v_fma_f32 v25, v25, v13, v37
v_fma_f32 v26, v26, v13, v38
v_fma_f32 v27, v27, v13, v39
ds_write_b128 v2, v[24:27] offset:2048
s_waitcnt lgkmcnt(0)
s_barrier
s_cmp_eq_u32 s34, 3
s_cbranch_scc1 L_w_next
ds_read_b128 v[40:43], v14 offset:0
ds_read_b128 v[44:47], v14 offset:3072
ds_read_b128 v[48:51], v14 offset:6144
ds_read_b128 v[52:55], v14 offset:9216
s_waitcnt lgkmcnt(0)
v_pk_add_f32 v[40:41], v[40:41], v[44:45]
v_pk_add_f32 v[42:43], v[42:43], v[46:47]
v_pk_add_f32 v[48:49], v[48:49], v[52:53]
v_pk_add_f32 v[50:51], v[50:51], v[54:55]
v_pk_add_f32 v[40:41], v[40:41], v[48:49]
v_pk_add_f32 v[42:43], v[42:43], v[50:51]
v_cvt_pk_bf16_f32 v60, v40, v41
v_cvt_pk_bf16_f32 v61, v42, v43
buffer_store_dwordx2 v[60:61], v15, s[28:31], s55 offen
L_w_next:
v_xor_b32 v2, 16384, v2
v_xor_b32 v14, 16384, v14
s_add_u32 s55, s55, 147456
s_add_u32 s54, s54, 147456
s_add_u32 s53, s53, 1048576
s_add_u32 s56, s56, 512
s_add_u32 s35, s35, 1
s_cmp_lt_u32 s35, 16
s_cbranch_scc1 L_w_loop
s_waitcnt vmcnt(0)
s_endpgm
L_role_chain:
s_load_dwordx2 s[24:25], s[0:1], 32
s_load_dwordx2 s[8:9], s[0:1], 40
s_load_dwordx2 s[12:13], s[0:1], 48
s_load_dwordx2 s[16:17], s[0:1], 56
s_load_dwordx2 s[20:21], s[0:1], 64
s_load_dwordx2 s[28:29], s[0:1], 96
s_load_dwordx2 s[4:5], s[0:1], 104
s_mov_b32 s26, 9216
s_mov_b32 s27, 0x20000
s_mov_b32 s10, 4718592
s_mov_b32 s11, 0x20000
s_mov_b32 s14, 4718592
s_mov_b32 s15, 0x20000
s_mov_b32 s18, 4718592
s_mov_b32 s19, 0x20000
s_mov_b32 s22, 4718592
s_mov_b32 s23, 0x20000
s_mov_b32 s30, 256
s_mov_b32 s31, 0x20000
s_mov_b32 s6, 268435456
s_mov_b32 s7, 0x20000
v_lshrrev_b32 v1, 6, v0
s_nop 0
v_readfirstlane_b32 s33, v1
s_nop 0
s_cmp_eq_u32 s33, 0
s_cbranch_scc1 L_pro_w0
s_cmp_eq_u32 s33, 2
s_cbranch_scc1 L_pro_w2r
s_cmp_eq_u32 s33, 3
s_cbranch_scc1 L_pro_w3r
s_cmp_lt_u32 s32, 8
s_cbranch_scc1 L_pro_w1r
s_branch L_pro_w1
L_exit:
s_endpgm
L_pro_w0:
v_and_b32 v20, 63, v0
v_and_b32 v21, 15, v0
v_bfe_u32 v22, v0, 4, 2
v_lshlrev_b32 v1, 4, v20
v_add_u32 v2, 16384, v1
v_bfe_u32 v23, v20, 3, 1
v_lshlrev_b32 v26, 3, v23
v_bfe_u32 v23, v20, 4, 2
v_lshl_add_u32 v26, v23, 1, v26
v_bfe_u32 v23, v20, 2, 1
v_add_u32 v26, v26, v23
v_lshlrev_b32 v26, 13, v26
v_and_b32 v23, 3, v20
v_lshl_add_u32 v26, v23, 4, v26
v_lshrrev_b32 v24, 2, v20
v_mul_u32_u24 v27, 1152, v24
v_lshl_add_u32 v27, v23, 4, v27
v_lshrrev_b32 v24, 2, v21
v_lshl_add_u32 v25, v22, 3, v24
v_lshlrev_b32 v28, 6, v25
v_lshl_add_u32 v28, v23, 3, v28
v_add_u32 v28, 16384, v28
v_and_b32 v25, 1, v22
v_lshlrev_b32 v29, 10, v25
v_lshrrev_b32 v25, 1, v22
v_lshl_add_u32 v29, v25, 8, v29
v_and_b32 v25, 1, v24
v_lshl_add_u32 v29, v25, 6, v29
v_lshrrev_b32 v25, 1, v24
v_lshl_add_u32 v29, v25, 3, v29
v_lshl_add_u32 v29, v23, 4, v29
v_add_u32 v29, 16384, v29
s_lshl_b32 s54, s32, 8
s_add_u32 s54, s54, 0
s_mul_i32 s55, s32, 147456
s_waitcnt lgkmcnt(0)
s_add_u32 s56, s54, 524288
s_mov_b32 m0, 28672
s_nop 0
buffer_load_dwordx4 v26, s[8:11], s56 offen lds
s_add_u32 s56, s54, 655360
s_mov_b32 m0, 29696
s_nop 0
buffer_load_dwordx4 v26, s[8:11], s56 offen lds
s_add_u32 s56, s54, 786432
s_mov_b32 m0, 30720
s_nop 0
buffer_load_dwordx4 v26, s[8:11], s56 offen lds
s_add_u32 s56, s54, 917504
s_mov_b32 m0, 31744
s_nop 0
buffer_load_dwordx4 v26, s[8:11], s56 offen lds
s_add_u32 s56, s54, 1048576
s_mov_b32 m0, 32768
s_nop 0
buffer_load_dwordx4 v26, s[8:11], s56 offen lds
s_add_u32 s56, s54, 1179648
s_mov_b32 m0, 33792
s_nop 0
buffer_load_dwordx4 v26, s[8:11], s56 offen lds
s_add_u32 s56, s54, 1310720
s_mov_b32 m0, 34816
s_nop 0
buffer_load_dwordx4 v26, s[8:11], s56 offen lds
s_add_u32 s56, s54, 1441792
s_mov_b32 m0, 35840
s_nop 0
buffer_load_dwordx4 v26, s[8:11], s56 offen lds
s_add_u32 s56, s54, 2621440
s_mov_b32 m0, 36864
s_nop 0
buffer_load_dwordx4 v26, s[8:11], s56 offen lds
s_add_u32 s56, s54, 2752512
s_mov_b32 m0, 37888
s_nop 0
buffer_load_dwordx4 v26, s[8:11], s56 offen lds
s_add_u32 s56, s54, 2883584
s_mov_b32 m0, 38912
s_nop 0
buffer_load_dwordx4 v26, s[8:11], s56 offen lds
s_add_u32 s56, s54, 3014656
s_mov_b32 m0, 39936
s_nop 0
buffer_load_dwordx4 v26, s[8:11], s56 offen lds
s_add_u32 s56, s54, 3145728
s_mov_b32 m0, 40960
s_nop 0
buffer_load_dwordx4 v26, s[8:11], s56 offen lds
s_add_u32 s56, s54, 3276800
s_mov_b32 m0, 41984
s_nop 0
buffer_load_dwordx4 v26, s[8:11], s56 offen lds
s_add_u32 s56, s54, 3407872
s_mov_b32 m0, 43008
s_nop 0
buffer_load_dwordx4 v26, s[8:11], s56 offen lds
s_add_u32 s56, s54, 3538944
s_mov_b32 m0, 44032
s_nop 0
buffer_load_dwordx4 v26, s[8:11], s56 offen lds
s_add_u32 s56, s54, 3670016
s_mov_b32 m0, 45056
s_nop 0
buffer_load_dwordx4 v26, s[8:11], s56 offen lds
s_add_u32 s56, s54, 3801088
s_mov_b32 m0, 46080
s_nop 0
buffer_load_dwordx4 v26, s[8:11], s56 offen lds
s_add_u32 s56, s54, 3932160
s_mov_b32 m0, 47104
s_nop 0
buffer_load_dwordx4 v26, s[8:11], s56 offen lds
s_add_u32 s56, s54, 4063232
s_mov_b32 m0, 48128
s_nop 0
buffer_load_dwordx4 v26, s[8:11], s56 offen lds
s_add_u32 s56, s54, 4194304
s_mov_b32 m0, 49152
s_nop 0
buffer_load_dwordx4 v26, s[8:11], s56 offen lds
s_add_u32 s56, s54, 4325376
s_mov_b32 m0, 50176
s_nop 0
buffer_load_dwordx4 v26, s[8:11], s56 offen lds
s_add_u32 s56, s54, 4456448
s_mov_b32 m0, 51200
s_nop 0
buffer_load_dwordx4 v26, s[8:11], s56 offen lds
s_add_u32 s56, s54, 4587520
s_mov_b32 m0, 52224
s_nop 0
buffer_load_dwordx4 v26, s[8:11], s56 offen lds
s_add_u32 s56, s54, 0
s_mov_b32 m0, 53248
s_nop 0
buffer_load_dwordx4 v26, s[12:15], s56 offen lds
s_add_u32 s56, s54, 131072
s_mov_b32 m0, 54272
s_nop 0
buffer_load_dwordx4 v26, s[12:15], s56 offen lds
s_add_u32 s56, s54, 262144
s_mov_b32 m0, 55296
s_nop 0
buffer_load_dwordx4 v26, s[12:15], s56 offen lds
s_add_u32 s56, s54, 393216
s_mov_b32 m0, 56320
s_nop 0
buffer_load_dwordx4 v26, s[12:15], s56 offen lds
s_add_u32 s56, s54, 524288
s_mov_b32 m0, 16384
s_nop 0
buffer_load_dwordx4 v26, s[12:15], s56 offen lds
s_add_u32 s56, s54, 655360
s_mov_b32 m0, 17408
s_nop 0
buffer_load_dwordx4 v26, s[12:15], s56 offen lds
s_add_u32 s56, s54, 786432
s_mov_b32 m0, 18432
s_nop 0
buffer_load_dwordx4 v26, s[12:15], s56 offen lds
s_add_u32 s56, s54, 917504
s_mov_b32 m0, 19456
s_nop 0
buffer_load_dwordx4 v26, s[12:15], s56 offen lds
s_add_u32 s56, s54, 1048576
s_mov_b32 m0, 20480
s_nop 0
buffer_load_dwordx4 v26, s[12:15], s56 offen lds
s_add_u32 s56, s54, 1179648
s_mov_b32 m0, 21504
s_nop 0
buffer_load_dwordx4 v26, s[12:15], s56 offen lds
s_add_u32 s56, s54, 1310720
s_mov_b32 m0, 22528
s_nop 0
buffer_load_dwordx4 v26, s[12:15], s56 offen lds
s_add_u32 s56, s54, 1441792
s_mov_b32 m0, 23552
s_nop 0
buffer_load_dwordx4 v26, s[12:15], s56 offen lds
v_bfe_u32 v23, v21, 1, 1
v_and_b32 v24, 1, v21
v_lshl_add_u32 v23, v24, 16, v23
v_mul_u32_u24 v23, 0xaaaa, v23
v_add_u32 v0, 0x44444444, v23
v_lshlrev_b32 v3, 3, v20
v_lshrrev_b32 v25, 5, v20
v_lshlrev_b32 v25, 6, v25
v_xor_b32 v3, v3, v25
v_lshrrev_b32 v25, 2, v20
v_and_b32 v4, 3, v21
v_lshl_add_u32 v4, v4, 4, v25
v_lshlrev_b32 v4, 3, v4
v_bfe_u32 v25, v21, 1, 1
v_lshlrev_b32 v23, 6, v25
v_xor_b32 v4, v4, v23
v_and_b32 v23, 2, v22
v_xor_b32 v5, v21, v23
v_lshlrev_b32 v5, 4, v5
v_lshl_add_u32 v5, v25, 10, v5
v_and_b32 v23, 1, v22
v_lshl_add_u32 v5, v23, 3, v5
v_lshlrev_b32 v9, 8, v22
v_lshl_add_u32 v9, v25, 6, v9
v_bfe_u32 v23, v21, 3, 1
v_lshl_add_u32 v9, v23, 7, v9
v_bfe_u32 v23, v21, 2, 1
v_lshl_add_u32 v9, v23, 5, v9
v_and_b32 v23, 1, v21
v_lshl_add_u32 v9, v23, 4, v9
v_lshrrev_b32 v23, 1, v22
v_and_b32 v24, 1, v22
v_and_b32 v25, 7, v21
v_lshrrev_b32 v7, 3, v21
v_lshl_add_u32 v8, v7, 1, v23
v_lshlrev_b32 v8, 12, v8
v_lshl_add_u32 v8, v24, 7, v8
v_and_b32 v25, 4, v21
v_lshl_add_u32 v8, v25, 3, v8
v_and_b32 v25, 1, v21
v_lshl_add_u32 v8, v25, 4, v8
v_bfe_u32 v25, v21, 1, 1
v_lshl_add_u32 v8, v25, 3, v8
s_lshr_b32 s56, s32, 1
s_lshl_b32 s56, s56, 8
s_and_b32 s57, s32, 1
s_lshl_b32 s57, s57, 6
s_add_u32 s56, s56, s57
s_add_u32 s56, s56, 0
v_add_u32 v8, s56, v8
v_and_b32 v7, 12, v21
v_bfe_u32 v25, v21, 1, 1
v_add_u32 v7, v7, v25
v_lshlrev_b32 v7, 4, v7
v_lshl_add_u32 v7, v22, 8, v7
s_mov_b32 s42, 0
s_mov_b32 s43, 65536
s_mov_b32 s44, 131072
s_mov_b32 s45, 196608
s_mov_b32 s46, 262144
s_mov_b32 s47, 294912
s_mov_b32 s48, 299008
s_mov_b32 s49, 303104
s_mov_b32 s50, 0x3e0293ee
s_mov_b32 s51, 0x3e0293ee
s_mov_b32 s52, 0x3f803f80
s_mov_b32 s53, 0x3f803f80
v_and_b32 v11, 3, v21
v_cmp_eq_u32 vcc, 0, v11
s_nop 1
v_cndmask_b32 v11, 0, 1, vcc
s_mov_b32 s34, 0
s_mov_b32 s35, -1
s_mov_b32 s36, 0
s_mov_b32 s41, 2000000
s_lshl_b32 s37, s32, 14
s_add_u32 s39, s37, 17301504
s_add_u32 s37, s37, 16777216
s_mov_b32 s40, 8749056
v_mov_b64 v[36:37], 0
v_mov_b64 v[38:39], 0
s_lshl_b32 s56, s32, 1
s_add_u32 s56, s56, 0
s_cmp_eq_u32 s56, 0
s_cselect_b32 s56, 64, s56
s_mul_i32 s56, s56, 10240
s_add_u32 s56, s56, 8388608
s_add_u32 s57, s56, 4096
v_mov_b32 v40, 0
v_mov_b32 v41, 0
v_mov_b32 v42, 0
v_mov_b32 v43, 0
buffer_store_dwordx4 v[40:43], v1, s[4:7], s56 offen offset:0 sc0 sc1
buffer_store_dwordx4 v[40:43], v1, s[4:7], s56 offen offset:1024 sc0 sc1
buffer_store_dwordx4 v[40:43], v1, s[4:7], s56 offen offset:2048 sc0 sc1
buffer_store_dwordx4 v[40:43], v1, s[4:7], s56 offen offset:3072 sc0 sc1
v_lshlrev_b32 v23, 2, v20
s_lshl_b32 s56, s32, 8
s_add_u32 s56, s56, 327680
buffer_store_dword v36, v23, s[4:7], s56 offen sc0 sc1
s_cmp_ge_u32 s32, 9
s_cbranch_scc1 L_nomem0
v_lshrrev_b32 v23, 2, v21
v_and_b32 v24, 1, v21
v_lshl_add_u32 v23, v23, 1, v24
v_mul_u32_u24 v23, 1152, v23
v_lshl_add_u32 v23, v22, 5, v23
v_bfe_u32 v24, v21, 1, 1
v_lshl_add_u32 v23, v24, 4, v23
s_lshl_b32 s56, s32, 7
buffer_load_dwordx4 v[64:67], v23, s[24:27], s56 offen
s_lshl_b32 s56, s32, 10
s_add_u32 s57, s56, 8388608
s_add_u32 s56, s56, 294912
s_waitcnt vmcnt(0)
v_or_b32 v64, 1, v64
buffer_store_dwordx4 v[64:67], v1, s[4:7], s56 offen sc0 sc1
buffer_store_dwordx4 v[64:67], v1, s[4:7], s57 offen sc0 sc1
L_nomem0:
s_waitcnt vmcnt(0) lgkmcnt(0)
s_barrier
s_getreg_b32 s56, hwreg(HW_REG_XCC_ID)
s_and_b32 s56, s56, 15
s_mul_i32 s57, s56, s56
s_lshl_b32 s57, s57, 18
s_lshl_b32 s56, s56, 8
s_add_u32 s57, s57, s56
s_add_u32 s58, s57, 1
v_mov_b32 v23, s58
v_mov_b32 v24, 0
s_mov_b64 exec, 1
buffer_atomic_add v23, v24, s[28:31], 0 offen sc1
s_mov_b64 exec, -1
ds_read_b64_tr_b16 v[80:81], v28 offset:12288
ds_read_b64_tr_b16 v[82:83], v28 offset:12544
ds_read_b64_tr_b16 v[84:85], v28 offset:14336
ds_read_b64_tr_b16 v[86:87], v28 offset:14592
ds_read_b64_tr_b16 v[88:89], v28 offset:12320
ds_read_b64_tr_b16 v[90:91], v28 offset:12576
ds_read_b64_tr_b16 v[92:93], v28 offset:14368
ds_read_b64_tr_b16 v[94:95], v28 offset:14624
s_waitcnt lgkmcnt(0)
s_add_u32 s56, s54, 1572864
s_mov_b32 m0, 24576
s_nop 0
buffer_load_dwordx4 v26, s[12:15], s56 offen lds
s_add_u32 s56, s54, 1703936
s_mov_b32 m0, 25600
s_nop 0
buffer_load_dwordx4 v26, s[12:15], s56 offen lds
s_add_u32 s56, s54, 1835008
s_mov_b32 m0, 26624
s_nop 0
buffer_load_dwordx4 v26, s[12:15], s56 offen lds
s_add_u32 s56, s54, 1966080
s_mov_b32 m0, 27648
s_nop 0
buffer_load_dwordx4 v26, s[12:15], s56 offen lds
ds_read_b64_tr_b16 v[96:97], v28 offset:16384
ds_read_b64_tr_b16 v[98:99], v28 offset:16640
ds_read_b64_tr_b16 v[100:101], v28 offset:18432
ds_read_b64_tr_b16 v[102:103], v28 offset:18688
ds_read_b64_tr_b16 v[104:105], v28 offset:16416
ds_read_b64_tr_b16 v[106:107], v28 offset:16672
ds_read_b64_tr_b16 v[108:109], v28 offset:18464
ds_read_b64_tr_b16 v[110:111], v28 offset:18720
s_waitcnt lgkmcnt(0)
s_add_u32 s56, s54, 2097152
s_mov_b32 m0, 28672
s_nop 0
buffer_load_dwordx4 v26, s[12:15], s56 offen lds
s_add_u32 s56, s54, 2228224
s_mov_b32 m0, 29696
s_nop 0
buffer_load_dwordx4 v26, s[12:15], s56 offen lds
s_add_u32 s56, s54, 2359296
s_mov_b32 m0, 30720
s_nop 0
buffer_load_dwordx4 v26, s[12:15], s56 offen lds
s_add_u32 s56, s54, 2490368
s_mov_b32 m0, 31744
s_nop 0
buffer_load_dwordx4 v26, s[12:15], s56 offen lds
ds_read_b64_tr_b16 v[112:113], v28 offset:20480
ds_read_b64_tr_b16 v[114:115], v28 offset:20736
ds_read_b64_tr_b16 v[116:117], v28 offset:22528
ds_read_b64_tr_b16 v[118:119], v28 offset:22784
ds_read_b64_tr_b16 v[120:121], v28 offset:20512
ds_read_b64_tr_b16 v[122:123], v28 offset:20768
ds_read_b64_tr_b16 v[124:125], v28 offset:22560
ds_read_b64_tr_b16 v[126:127], v28 offset:22816
s_waitcnt lgkmcnt(0)
s_add_u32 s56, s54, 3145728
s_mov_b32 m0, 32768
s_nop 0
buffer_load_dwordx4 v26, s[12:15], s56 offen lds
s_add_u32 s56, s54, 3276800
s_mov_b32 m0, 33792
s_nop 0
buffer_load_dwordx4 v26, s[12:15], s56 offen lds
s_add_u32 s56, s54, 3407872
s_mov_b32 m0, 34816
s_nop 0
buffer_load_dwordx4 v26, s[12:15], s56 offen lds
s_add_u32 s56, s54, 3538944
s_mov_b32 m0, 35840
s_nop 0
buffer_load_dwordx4 v26, s[12:15], s56 offen lds
ds_read_b64_tr_b16 v[128:129], v28 offset:24576
ds_read_b64_tr_b16 v[130:131], v28 offset:24832
ds_read_b64_tr_b16 v[132:133], v28 offset:26624
ds_read_b64_tr_b16 v[134:135], v28 offset:26880
ds_read_b64_tr_b16 v[136:137], v28 offset:24608
ds_read_b64_tr_b16 v[138:139], v28 offset:24864
ds_read_b64_tr_b16 v[140:141], v28 offset:26656
ds_read_b64_tr_b16 v[142:143], v28 offset:26912
s_waitcnt lgkmcnt(0)
s_add_u32 s56, s54, 3670016
s_mov_b32 m0, 36864
s_nop 0
buffer_load_dwordx4 v26, s[12:15], s56 offen lds
s_add_u32 s56, s54, 3801088
s_mov_b32 m0, 37888
s_nop 0
buffer_load_dwordx4 v26, s[12:15], s56 offen lds
s_add_u32 s56, s54, 3932160
s_mov_b32 m0, 38912
s_nop 0
buffer_load_dwordx4 v26, s[12:15], s56 offen lds
s_add_u32 s56, s54, 4063232
s_mov_b32 m0, 39936
s_nop 0
buffer_load_dwordx4 v26, s[12:15], s56 offen lds
ds_read_b64_tr_b16 v[144:145], v28 offset:28672
ds_read_b64_tr_b16 v[146:147], v28 offset:28928
ds_read_b64_tr_b16 v[148:149], v28 offset:30720
ds_read_b64_tr_b16 v[150:151], v28 offset:30976
ds_read_b64_tr_b16 v[152:153], v28 offset:28704
ds_read_b64_tr_b16 v[154:155], v28 offset:28960
ds_read_b64_tr_b16 v[156:157], v28 offset:30752
ds_read_b64_tr_b16 v[158:159], v28 offset:31008
s_waitcnt lgkmcnt(0)
s_add_u32 s56, s54, 4194304
s_mov_b32 m0, 40960
s_nop 0
buffer_load_dwordx4 v26, s[12:15], s56 offen lds
s_add_u32 s56, s54, 4325376
s_mov_b32 m0, 41984
s_nop 0
buffer_load_dwordx4 v26, s[12:15], s56 offen lds
s_add_u32 s56, s54, 4456448
s_mov_b32 m0, 43008
s_nop 0
buffer_load_dwordx4 v26, s[12:15], s56 offen lds
s_add_u32 s56, s54, 4587520
s_mov_b32 m0, 44032
s_nop 0
buffer_load_dwordx4 v26, s[12:15], s56 offen lds
ds_read_b64_tr_b16 v[160:161], v28 offset:32768
ds_read_b64_tr_b16 v[162:163], v28 offset:33024
ds_read_b64_tr_b16 v[164:165], v28 offset:34816
ds_read_b64_tr_b16 v[166:167], v28 offset:35072
ds_read_b64_tr_b16 v[168:169], v28 offset:32800
ds_read_b64_tr_b16 v[170:171], v28 offset:33056
ds_read_b64_tr_b16 v[172:173], v28 offset:34848
ds_read_b64_tr_b16 v[174:175], v28 offset:35104
s_waitcnt lgkmcnt(0)
s_add_u32 s56, s54, 0
s_mov_b32 m0, 45056
s_nop 0
buffer_load_dwordx4 v26, s[16:19], s56 offen lds
s_add_u32 s56, s54, 131072
s_mov_b32 m0, 46080
s_nop 0
buffer_load_dwordx4 v26, s[16:19], s56 offen lds
s_add_u32 s56, s54, 262144
s_mov_b32 m0, 47104
s_nop 0
buffer_load_dwordx4 v26, s[16:19], s56 offen lds
s_add_u32 s56, s54, 393216
s_mov_b32 m0, 48128
s_nop 0
buffer_load_dwordx4 v26, s[16:19], s56 offen lds
ds_read_b64_tr_b16 v[176:177], v28 offset:36864
ds_read_b64_tr_b16 v[178:179], v28 offset:37120
ds_read_b64_tr_b16 v[180:181], v28 offset:38912
ds_read_b64_tr_b16 v[182:183], v28 offset:39168
ds_read_b64_tr_b16 v[184:185], v28 offset:36896
ds_read_b64_tr_b16 v[186:187], v28 offset:37152
ds_read_b64_tr_b16 v[188:189], v28 offset:38944
ds_read_b64_tr_b16 v[190:191], v28 offset:39200
s_waitcnt lgkmcnt(0)
s_add_u32 s56, s54, 524288
s_mov_b32 m0, 49152
s_nop 0
buffer_load_dwordx4 v26, s[16:19], s56 offen lds
s_add_u32 s56, s54, 655360
s_mov_b32 m0, 50176
s_nop 0
buffer_load_dwordx4 v26, s[16:19], s56 offen lds
s_add_u32 s56, s54, 786432
s_mov_b32 m0, 51200
s_nop 0
buffer_load_dwordx4 v26, s[16:19], s56 offen lds
s_add_u32 s56, s54, 917504
s_mov_b32 m0, 52224
s_nop 0
buffer_load_dwordx4 v26, s[16:19], s56 offen lds
ds_read_b64_tr_b16 v[192:193], v28 offset:0
ds_read_b64_tr_b16 v[194:195], v28 offset:256
ds_read_b64_tr_b16 v[196:197], v28 offset:2048
ds_read_b64_tr_b16 v[198:199], v28 offset:2304
ds_read_b64_tr_b16 v[200:201], v28 offset:32
ds_read_b64_tr_b16 v[202:203], v28 offset:288
ds_read_b64_tr_b16 v[204:205], v28 offset:2080
ds_read_b64_tr_b16 v[206:207], v28 offset:2336
s_waitcnt lgkmcnt(0)
s_add_u32 s56, s54, 1048576
s_mov_b32 m0, 53248
s_nop 0
buffer_load_dwordx4 v26, s[16:19], s56 offen lds
s_add_u32 s56, s54, 1179648
s_mov_b32 m0, 54272
s_nop 0
buffer_load_dwordx4 v26, s[16:19], s56 offen lds
s_add_u32 s56, s54, 1310720
s_mov_b32 m0, 55296
s_nop 0
buffer_load_dwordx4 v26, s[16:19], s56 offen lds
s_add_u32 s56, s54, 1441792
s_mov_b32 m0, 56320
s_nop 0
buffer_load_dwordx4 v26, s[16:19], s56 offen lds
ds_read_b64_tr_b16 v[208:209], v28 offset:4096
ds_read_b64_tr_b16 v[210:211], v28 offset:4352
ds_read_b64_tr_b16 v[212:213], v28 offset:6144
ds_read_b64_tr_b16 v[214:215], v28 offset:6400
ds_read_b64_tr_b16 v[216:217], v28 offset:4128
ds_read_b64_tr_b16 v[218:219], v28 offset:4384
ds_read_b64_tr_b16 v[220:221], v28 offset:6176
ds_read_b64_tr_b16 v[222:223], v28 offset:6432
s_waitcnt lgkmcnt(0)
s_add_u32 s56, s54, 1572864
s_mov_b32 m0, 16384
s_nop 0
buffer_load_dwordx4 v26, s[16:19], s56 offen lds
s_add_u32 s56, s54, 1703936
s_mov_b32 m0, 17408
s_nop 0
buffer_load_dwordx4 v26, s[16:19], s56 offen lds
s_add_u32 s56, s54, 1835008
s_mov_b32 m0, 18432
s_nop 0
buffer_load_dwordx4 v26, s[16:19], s56 offen lds
s_add_u32 s56, s54, 1966080
s_mov_b32 m0, 19456
s_nop 0
buffer_load_dwordx4 v26, s[16:19], s56 offen lds
s_waitcnt vmcnt(32)
ds_read_b64_tr_b16 v[224:225], v28 offset:8192
ds_read_b64_tr_b16 v[226:227], v28 offset:8448
ds_read_b64_tr_b16 v[228:229], v28 offset:10240
ds_read_b64_tr_b16 v[230:231], v28 offset:10496
ds_read_b64_tr_b16 v[232:233], v28 offset:8224
ds_read_b64_tr_b16 v[234:235], v28 offset:8480
ds_read_b64_tr_b16 v[236:237], v28 offset:10272
ds_read_b64_tr_b16 v[238:239], v28 offset:10528
s_waitcnt lgkmcnt(0)
s_add_u32 s56, s54, 2097152
s_mov_b32 m0, 20480
s_nop 0
buffer_load_dwordx4 v26, s[16:19], s56 offen lds
s_add_u32 s56, s54, 2228224
s_mov_b32 m0, 21504
s_nop 0
buffer_load_dwordx4 v26, s[16:19], s56 offen lds
s_add_u32 s56, s54, 2359296
s_mov_b32 m0, 22528
s_nop 0
buffer_load_dwordx4 v26, s[16:19], s56 offen lds
s_add_u32 s56, s54, 2490368
s_mov_b32 m0, 23552
s_nop 0
buffer_load_dwordx4 v26, s[16:19], s56 offen lds
s_waitcnt vmcnt(32)
ds_read_b64_tr_b16 v[240:241], v28 offset:12288
ds_read_b64_tr_b16 v[242:243], v28 offset:12544
ds_read_b64_tr_b16 v[244:245], v28 offset:14336
ds_read_b64_tr_b16 v[246:247], v28 offset:14592
ds_read_b64_tr_b16 v[248:249], v28 offset:12320
ds_read_b64_tr_b16 v[250:251], v28 offset:12576
ds_read_b64_tr_b16 v[252:253], v28 offset:14368
ds_read_b64_tr_b16 v[254:255], v28 offset:14624
s_waitcnt lgkmcnt(0)
s_add_u32 s56, s54, 2621440
s_mov_b32 m0, 24576
s_nop 0
buffer_load_dwordx4 v26, s[16:19], s56 offen lds
s_add_u32 s56, s54, 2752512
s_mov_b32 m0, 25600
s_nop 0
buffer_load_dwordx4 v26, s[16:19], s56 offen lds
s_add_u32 s56, s54, 2883584
s_mov_b32 m0, 26624
s_nop 0
buffer_load_dwordx4 v26, s[16:19], s56 offen lds
s_add_u32 s56, s54, 3014656
s_mov_b32 m0, 27648
s_nop 0
buffer_load_dwordx4 v26, s[16:19], s56 offen lds
s_waitcnt vmcnt(32)
ds_read_b64_tr_b16 a[0:1], v28 offset:16384
ds_read_b64_tr_b16 a[2:3], v28 offset:16640
ds_read_b64_tr_b16 a[4:5], v28 offset:18432
ds_read_b64_tr_b16 a[6:7], v28 offset:18688
ds_read_b64_tr_b16 a[8:9], v28 offset:16416
ds_read_b64_tr_b16 a[10:11], v28 offset:16672
ds_read_b64_tr_b16 a[12:13], v28 offset:18464
ds_read_b64_tr_b16 a[14:15], v28 offset:18720
s_waitcnt lgkmcnt(0)
s_add_u32 s56, s54, 3145728
s_mov_b32 m0, 28672
s_nop 0
buffer_load_dwordx4 v26, s[16:19], s56 offen lds
s_add_u32 s56, s54, 3276800
s_mov_b32 m0, 29696
s_nop 0
buffer_load_dwordx4 v26, s[16:19], s56 offen lds
s_add_u32 s56, s54, 3407872
s_mov_b32 m0, 30720
s_nop 0
buffer_load_dwordx4 v26, s[16:19], s56 offen lds
s_add_u32 s56, s54, 3538944
s_mov_b32 m0, 31744
s_nop 0
buffer_load_dwordx4 v26, s[16:19], s56 offen lds
s_waitcnt vmcnt(32)
ds_read_b64_tr_b16 a[16:17], v28 offset:20480
ds_read_b64_tr_b16 a[18:19], v28 offset:20736
ds_read_b64_tr_b16 a[20:21], v28 offset:22528
ds_read_b64_tr_b16 a[22:23], v28 offset:22784
ds_read_b64_tr_b16 a[24:25], v28 offset:20512
ds_read_b64_tr_b16 a[26:27], v28 offset:20768
ds_read_b64_tr_b16 a[28:29], v28 offset:22560
ds_read_b64_tr_b16 a[30:31], v28 offset:22816
s_waitcnt lgkmcnt(0)
s_add_u32 s56, s54, 3670016
s_mov_b32 m0, 32768
s_nop 0
buffer_load_dwordx4 v26, s[16:19], s56 offen lds
s_add_u32 s56, s54, 3801088
s_mov_b32 m0, 33792
s_nop 0
buffer_load_dwordx4 v26, s[16:19], s56 offen lds
s_add_u32 s56, s54, 3932160
s_mov_b32 m0, 34816
s_nop 0
buffer_load_dwordx4 v26, s[16:19], s56 offen lds
s_add_u32 s56, s54, 4063232
s_mov_b32 m0, 35840
s_nop 0
buffer_load_dwordx4 v26, s[16:19], s56 offen lds
s_waitcnt vmcnt(32)
ds_read_b64_tr_b16 a[32:33], v28 offset:24576
ds_read_b64_tr_b16 a[34:35], v28 offset:24832
ds_read_b64_tr_b16 a[36:37], v28 offset:26624
ds_read_b64_tr_b16 a[38:39], v28 offset:26880
ds_read_b64_tr_b16 a[40:41], v28 offset:24608
ds_read_b64_tr_b16 a[42:43], v28 offset:24864
ds_read_b64_tr_b16 a[44:45], v28 offset:26656
ds_read_b64_tr_b16 a[46:47], v28 offset:26912
s_waitcnt lgkmcnt(0)
s_add_u32 s56, s55, 36864
s_mov_b32 m0, 36864
s_nop 0
buffer_load_dwordx4 v27, s[20:23], s56 offen lds
s_add_u32 s56, s55, 55296
s_mov_b32 m0, 37888
s_nop 0
buffer_load_dwordx4 v27, s[20:23], s56 offen lds
s_add_u32 s56, s55, 110592
s_mov_b32 m0, 38912
s_nop 0
buffer_load_dwordx4 v27, s[20:23], s56 offen lds
s_add_u32 s56, s55, 129024
s_mov_b32 m0, 39936
s_nop 0
buffer_load_dwordx4 v27, s[20:23], s56 offen lds
s_waitcnt vmcnt(32)
ds_read_b64_tr_b16 a[48:49], v28 offset:28672
ds_read_b64_tr_b16 a[50:51], v28 offset:28928
ds_read_b64_tr_b16 a[52:53], v28 offset:30720
ds_read_b64_tr_b16 a[54:55], v28 offset:30976
ds_read_b64_tr_b16 a[56:57], v28 offset:28704
ds_read_b64_tr_b16 a[58:59], v28 offset:28960
ds_read_b64_tr_b16 a[60:61], v28 offset:30752
ds_read_b64_tr_b16 a[62:63], v28 offset:31008
s_waitcnt lgkmcnt(0)
s_add_u32 s56, s55, 37120
s_mov_b32 m0, 40960
s_nop 0
buffer_load_dwordx4 v27, s[20:23], s56 offen lds
s_add_u32 s56, s55, 55552
s_mov_b32 m0, 41984
s_nop 0
buffer_load_dwordx4 v27, s[20:23], s56 offen lds
s_add_u32 s56, s55, 110848
s_mov_b32 m0, 43008
s_nop 0
buffer_load_dwordx4 v27, s[20:23], s56 offen lds
s_add_u32 s56, s55, 129280
s_mov_b32 m0, 44032
s_nop 0
buffer_load_dwordx4 v27, s[20:23], s56 offen lds
s_waitcnt vmcnt(32)
ds_read_b64_tr_b16 a[64:65], v28 offset:32768
ds_read_b64_tr_b16 a[66:67], v28 offset:33024
ds_read_b64_tr_b16 a[68:69], v28 offset:34816
ds_read_b64_tr_b16 a[70:71], v28 offset:35072
ds_read_b64_tr_b16 a[72:73], v28 offset:32800
ds_read_b64_tr_b16 a[74:75], v28 offset:33056
ds_read_b64_tr_b16 a[76:77], v28 offset:34848
ds_read_b64_tr_b16 a[78:79], v28 offset:35104
s_waitcnt lgkmcnt(0)
s_add_u32 s56, s55, 37376
s_mov_b32 m0, 45056
s_nop 0
buffer_load_dwordx4 v27, s[20:23], s56 offen lds
s_add_u32 s56, s55, 55808
s_mov_b32 m0, 46080
s_nop 0
buffer_load_dwordx4 v27, s[20:23], s56 offen lds
s_add_u32 s56, s55, 111104
s_mov_b32 m0, 47104
s_nop 0
buffer_load_dwordx4 v27, s[20:23], s56 offen lds
s_add_u32 s56, s55, 129536
s_mov_b32 m0, 48128
s_nop 0
buffer_load_dwordx4 v27, s[20:23], s56 offen lds
s_waitcnt vmcnt(32)
ds_read_b64_tr_b16 a[80:81], v28 offset:36864
ds_read_b64_tr_b16 a[82:83], v28 offset:37120
ds_read_b64_tr_b16 a[84:85], v28 offset:38912
ds_read_b64_tr_b16 a[86:87], v28 offset:39168
ds_read_b64_tr_b16 a[88:89], v28 offset:36896
ds_read_b64_tr_b16 a[90:91], v28 offset:37152
ds_read_b64_tr_b16 a[92:93], v28 offset:38944
ds_read_b64_tr_b16 a[94:95], v28 offset:39200
s_waitcnt lgkmcnt(0)
s_add_u32 s56, s55, 37632
s_mov_b32 m0, 49152
s_nop 0
buffer_load_dwordx4 v27, s[20:23], s56 offen lds
s_add_u32 s56, s55, 56064
s_mov_b32 m0, 50176
s_nop 0
buffer_load_dwordx4 v27, s[20:23], s56 offen lds
s_add_u32 s56, s55, 111360
s_mov_b32 m0, 51200
s_nop 0
buffer_load_dwordx4 v27, s[20:23], s56 offen lds
s_add_u32 s56, s55, 129792
s_mov_b32 m0, 52224
s_nop 0
buffer_load_dwordx4 v27, s[20:23], s56 offen lds
s_waitcnt vmcnt(32)
ds_read_b64_tr_b16 a[96:97], v28 offset:0
ds_read_b64_tr_b16 a[98:99], v28 offset:256
ds_read_b64_tr_b16 a[100:101], v28 offset:2048
ds_read_b64_tr_b16 a[102:103], v28 offset:2304
ds_read_b64_tr_b16 a[104:105], v28 offset:32
ds_read_b64_tr_b16 a[106:107], v28 offset:288
ds_read_b64_tr_b16 a[108:109], v28 offset:2080
ds_read_b64_tr_b16 a[110:111], v28 offset:2336
s_waitcnt lgkmcnt(0)
s_add_u32 s56, s55, 37888
s_mov_b32 m0, 53248
s_nop 0
buffer_load_dwordx4 v27, s[20:23], s56 offen lds
s_add_u32 s56, s55, 56320
s_mov_b32 m0, 54272
s_nop 0
buffer_load_dwordx4 v27, s[20:23], s56 offen lds
s_add_u32 s56, s55, 111616
s_mov_b32 m0, 55296
s_nop 0
buffer_load_dwordx4 v27, s[20:23], s56 offen lds
s_add_u32 s56, s55, 130048
s_mov_b32 m0, 56320
s_nop 0
buffer_load_dwordx4 v27, s[20:23], s56 offen lds
s_waitcnt vmcnt(32)
ds_read_b64_tr_b16 a[112:113], v28 offset:4096
ds_read_b64_tr_b16 a[114:115], v28 offset:4352
ds_read_b64_tr_b16 a[116:117], v28 offset:6144
ds_read_b64_tr_b16 a[118:119], v28 offset:6400
ds_read_b64_tr_b16 a[120:121], v28 offset:4128
ds_read_b64_tr_b16 a[122:123], v28 offset:4384
ds_read_b64_tr_b16 a[124:125], v28 offset:6176
ds_read_b64_tr_b16 a[126:127], v28 offset:6432
s_waitcnt lgkmcnt(0)
s_add_u32 s56, s54, 0
s_mov_b32 m0, 16384
s_nop 0
buffer_load_dwordx4 v26, s[8:11], s56 offen lds
s_add_u32 s56, s54, 131072
s_mov_b32 m0, 17408
s_nop 0
buffer_load_dwordx4 v26, s[8:11], s56 offen lds
s_add_u32 s56, s54, 262144
s_mov_b32 m0, 18432
s_nop 0
buffer_load_dwordx4 v26, s[8:11], s56 offen lds
s_add_u32 s56, s54, 393216
s_mov_b32 m0, 19456
s_nop 0
buffer_load_dwordx4 v26, s[8:11], s56 offen lds
s_waitcnt vmcnt(32)
ds_read_b64_tr_b16 a[128:129], v28 offset:8192
ds_read_b64_tr_b16 a[130:131], v28 offset:8448
ds_read_b64_tr_b16 a[132:133], v28 offset:10240
ds_read_b64_tr_b16 a[134:135], v28 offset:10496
ds_read_b64_tr_b16 a[136:137], v28 offset:8224
ds_read_b64_tr_b16 a[138:139], v28 offset:8480
ds_read_b64_tr_b16 a[140:141], v28 offset:10272
ds_read_b64_tr_b16 a[142:143], v28 offset:10528
s_waitcnt lgkmcnt(0)
s_add_u32 s56, s54, 1572864
s_mov_b32 m0, 20480
s_nop 0
buffer_load_dwordx4 v26, s[8:11], s56 offen lds
s_add_u32 s56, s54, 1703936
s_mov_b32 m0, 21504
s_nop 0
buffer_load_dwordx4 v26, s[8:11], s56 offen lds
s_add_u32 s56, s54, 1835008
s_mov_b32 m0, 22528
s_nop 0
buffer_load_dwordx4 v26, s[8:11], s56 offen lds
s_add_u32 s56, s54, 1966080
s_mov_b32 m0, 23552
s_nop 0
buffer_load_dwordx4 v26, s[8:11], s56 offen lds
s_waitcnt vmcnt(32)
ds_read_b64_tr_b16 a[144:145], v28 offset:12288
ds_read_b64_tr_b16 a[146:147], v28 offset:12544
ds_read_b64_tr_b16 a[148:149], v28 offset:14336
ds_read_b64_tr_b16 a[150:151], v28 offset:14592
ds_read_b64_tr_b16 a[152:153], v28 offset:12320
ds_read_b64_tr_b16 a[154:155], v28 offset:12576
ds_read_b64_tr_b16 a[156:157], v28 offset:14368
ds_read_b64_tr_b16 a[158:159], v28 offset:14624
s_waitcnt lgkmcnt(0)
s_add_u32 s56, s54, 2097152
s_mov_b32 m0, 24576
s_nop 0
buffer_load_dwordx4 v26, s[8:11], s56 offen lds
s_add_u32 s56, s54, 2228224
s_mov_b32 m0, 25600
s_nop 0
buffer_load_dwordx4 v26, s[8:11], s56 offen lds
s_add_u32 s56, s54, 2359296
s_mov_b32 m0, 26624
s_nop 0
buffer_load_dwordx4 v26, s[8:11], s56 offen lds
s_add_u32 s56, s54, 2490368
s_mov_b32 m0, 27648
s_nop 0
buffer_load_dwordx4 v26, s[8:11], s56 offen lds
s_waitcnt vmcnt(32)
ds_read_b64_tr_b16 a[160:161], v28 offset:16384
ds_read_b64_tr_b16 a[162:163], v28 offset:16640
ds_read_b64_tr_b16 a[164:165], v28 offset:18432
ds_read_b64_tr_b16 a[166:167], v28 offset:18688
ds_read_b64_tr_b16 a[168:169], v28 offset:16416
ds_read_b64_tr_b16 a[170:171], v28 offset:16672
ds_read_b64_tr_b16 a[172:173], v28 offset:18464
ds_read_b64_tr_b16 a[174:175], v28 offset:18720
s_waitcnt lgkmcnt(0)
s_add_u32 s56, s54, 2621440
s_mov_b32 m0, 28672
s_nop 0
buffer_load_dwordx4 v26, s[12:15], s56 offen lds
s_add_u32 s56, s54, 2752512
s_mov_b32 m0, 29696
s_nop 0
buffer_load_dwordx4 v26, s[12:15], s56 offen lds
s_add_u32 s56, s54, 2883584
s_mov_b32 m0, 30720
s_nop 0
buffer_load_dwordx4 v26, s[12:15], s56 offen lds
s_add_u32 s56, s54, 3014656
s_mov_b32 m0, 31744
s_nop 0
buffer_load_dwordx4 v26, s[12:15], s56 offen lds
s_waitcnt vmcnt(32)
ds_read_b64_tr_b16 a[176:177], v29 offset:20480
ds_read_b64_tr_b16 a[178:179], v29 offset:20608
ds_read_b64_tr_b16 a[180:181], v29 offset:20992
ds_read_b64_tr_b16 a[182:183], v29 offset:21120
ds_read_b64_tr_b16 a[184:185], v29 offset:22528
ds_read_b64_tr_b16 a[186:187], v29 offset:22656
ds_read_b64_tr_b16 a[188:189], v29 offset:23040
ds_read_b64_tr_b16 a[190:191], v29 offset:23168
s_waitcnt lgkmcnt(0)
s_add_u32 s56, s54, 4194304
s_mov_b32 m0, 32768
s_nop 0
buffer_load_dwordx4 v26, s[16:19], s56 offen lds
s_add_u32 s56, s54, 4325376
s_mov_b32 m0, 33792
s_nop 0
buffer_load_dwordx4 v26, s[16:19], s56 offen lds
s_add_u32 s56, s54, 4456448
s_mov_b32 m0, 34816
s_nop 0
buffer_load_dwordx4 v26, s[16:19], s56 offen lds
s_add_u32 s56, s54, 4587520
s_mov_b32 m0, 35840
s_nop 0
buffer_load_dwordx4 v26, s[16:19], s56 offen lds
s_waitcnt vmcnt(32)
ds_read_b64_tr_b16 a[192:193], v29 offset:24576
ds_read_b64_tr_b16 a[194:195], v29 offset:24704
ds_read_b64_tr_b16 a[196:197], v29 offset:25088
ds_read_b64_tr_b16 a[198:199], v29 offset:25216
ds_read_b64_tr_b16 a[200:201], v29 offset:26624
ds_read_b64_tr_b16 a[202:203], v29 offset:26752
ds_read_b64_tr_b16 a[204:205], v29 offset:27136
ds_read_b64_tr_b16 a[206:207], v29 offset:27264
s_waitcnt lgkmcnt(0)
s_add_u32 s56, s55, 0
s_mov_b32 m0, 36864
s_nop 0
buffer_load_dwordx4 v27, s[20:23], s56 offen lds
s_add_u32 s56, s55, 18432
s_mov_b32 m0, 37888
s_nop 0
buffer_load_dwordx4 v27, s[20:23], s56 offen lds
s_add_u32 s56, s55, 256
s_mov_b32 m0, 38912
s_nop 0
buffer_load_dwordx4 v27, s[20:23], s56 offen lds
s_add_u32 s56, s55, 18688
s_mov_b32 m0, 39936
s_nop 0
buffer_load_dwordx4 v27, s[20:23], s56 offen lds
s_waitcnt vmcnt(32)
ds_read_b64_tr_b16 a[208:209], v29 offset:28672
ds_read_b64_tr_b16 a[210:211], v29 offset:28800
ds_read_b64_tr_b16 a[212:213], v29 offset:29184
ds_read_b64_tr_b16 a[214:215], v29 offset:29312
ds_read_b64_tr_b16 a[216:217], v29 offset:30720
ds_read_b64_tr_b16 a[218:219], v29 offset:30848
ds_read_b64_tr_b16 a[220:221], v29 offset:31232
ds_read_b64_tr_b16 a[222:223], v29 offset:31360
s_waitcnt lgkmcnt(0)
s_add_u32 s56, s55, 73728
s_mov_b32 m0, 40960
s_nop 0
buffer_load_dwordx4 v27, s[20:23], s56 offen lds
s_add_u32 s56, s55, 92160
s_mov_b32 m0, 41984
s_nop 0
buffer_load_dwordx4 v27, s[20:23], s56 offen lds
s_add_u32 s56, s55, 73984
s_mov_b32 m0, 43008
s_nop 0
buffer_load_dwordx4 v27, s[20:23], s56 offen lds
s_add_u32 s56, s55, 92416
s_mov_b32 m0, 44032
s_nop 0
buffer_load_dwordx4 v27, s[20:23], s56 offen lds
s_waitcnt vmcnt(32)
ds_read_b64_tr_b16 a[224:225], v29 offset:32768
ds_read_b64_tr_b16 a[226:227], v29 offset:32896
ds_read_b64_tr_b16 a[228:229], v29 offset:33280
ds_read_b64_tr_b16 a[230:231], v29 offset:33408
ds_read_b64_tr_b16 a[232:233], v29 offset:34816
ds_read_b64_tr_b16 a[234:235], v29 offset:34944
ds_read_b64_tr_b16 a[236:237], v29 offset:35328
ds_read_b64_tr_b16 a[238:239], v29 offset:35456
s_waitcnt lgkmcnt(0)
s_add_u32 s56, s55, 512
s_mov_b32 m0, 45056
s_nop 0
buffer_load_dwordx4 v27, s[20:23], s56 offen lds
s_add_u32 s56, s55, 18944
s_mov_b32 m0, 46080
s_nop 0
buffer_load_dwordx4 v27, s[20:23], s56 offen lds
s_add_u32 s56, s55, 74240
s_mov_b32 m0, 47104
s_nop 0
buffer_load_dwordx4 v27, s[20:23], s56 offen lds
s_add_u32 s56, s55, 92672
s_mov_b32 m0, 48128
s_nop 0
buffer_load_dwordx4 v27, s[20:23], s56 offen lds
s_waitcnt vmcnt(32)
ds_read_b64_tr_b16 a[240:241], v29 offset:36864
ds_read_b64_tr_b16 a[242:243], v29 offset:36992
ds_read_b64_tr_b16 a[244:245], v29 offset:37376
ds_read_b64_tr_b16 a[246:247], v29 offset:37504
ds_read_b64_tr_b16 a[248:249], v29 offset:38912
ds_read_b64_tr_b16 a[250:251], v29 offset:39040
ds_read_b64_tr_b16 a[252:253], v29 offset:39424
ds_read_b64_tr_b16 a[254:255], v29 offset:39552
s_waitcnt lgkmcnt(0)
s_add_u32 s56, s55, 768
s_mov_b32 m0, 49152
s_nop 0
buffer_load_dwordx4 v27, s[20:23], s56 offen lds
s_add_u32 s56, s55, 19200
s_mov_b32 m0, 50176
s_nop 0
buffer_load_dwordx4 v27, s[20:23], s56 offen lds
s_add_u32 s56, s55, 74496
s_mov_b32 m0, 51200
s_nop 0
buffer_load_dwordx4 v27, s[20:23], s56 offen lds
s_add_u32 s56, s55, 92928
s_mov_b32 m0, 52224
s_nop 0
buffer_load_dwordx4 v27, s[20:23], s56 offen lds
s_waitcnt vmcnt(32)
ds_read_b64_tr_b16 v[44:45], v28 offset:0
ds_read_b64_tr_b16 v[46:47], v28 offset:256
ds_read_b64_tr_b16 v[48:49], v28 offset:2048
ds_read_b64_tr_b16 v[50:51], v28 offset:2304
ds_read_b64_tr_b16 v[52:53], v28 offset:32
ds_read_b64_tr_b16 v[54:55], v28 offset:288
ds_read_b64_tr_b16 v[56:57], v28 offset:2080
ds_read_b64_tr_b16 v[58:59], v28 offset:2336
s_waitcnt lgkmcnt(0)
ds_write_b128 v2, v[44:47] offset:0
ds_write_b128 v2, v[48:51] offset:1024
ds_write_b128 v2, v[52:55] offset:2048
ds_write_b128 v2, v[56:59] offset:3072
s_waitcnt lgkmcnt(0)
s_add_u32 s56, s55, 1024
s_mov_b32 m0, 53248
s_nop 0
buffer_load_dwordx4 v27, s[20:23], s56 offen lds
s_add_u32 s56, s55, 19456
s_mov_b32 m0, 54272
s_nop 0
buffer_load_dwordx4 v27, s[20:23], s56 offen lds
s_add_u32 s56, s55, 74752
s_mov_b32 m0, 55296
s_nop 0
buffer_load_dwordx4 v27, s[20:23], s56 offen lds
s_add_u32 s56, s55, 93184
s_mov_b32 m0, 56320
s_nop 0
buffer_load_dwordx4 v27, s[20:23], s56 offen lds
s_waitcnt vmcnt(32)
ds_read_b64_tr_b16 v[44:45], v28 offset:4096
ds_read_b64_tr_b16 v[46:47], v28 offset:4352
ds_read_b64_tr_b16 v[48:49], v28 offset:6144
ds_read_b64_tr_b16 v[50:51], v28 offset:6400
ds_read_b64_tr_b16 v[52:53], v28 offset:4128
ds_read_b64_tr_b16 v[54:55], v28 offset:4384
ds_read_b64_tr_b16 v[56:57], v28 offset:6176
ds_read_b64_tr_b16 v[58:59], v28 offset:6432
s_waitcnt lgkmcnt(0)
ds_write_b128 v2, v[44:47] offset:4096
ds_write_b128 v2, v[48:51] offset:5120
ds_write_b128 v2, v[52:55] offset:6144
ds_write_b128 v2, v[56:59] offset:7168
s_waitcnt lgkmcnt(0)
s_waitcnt vmcnt(28)
ds_read_b64_tr_b16 v[44:45], v28 offset:8192
ds_read_b64_tr_b16 v[46:47], v28 offset:8448
ds_read_b64_tr_b16 v[48:49], v28 offset:10240
ds_read_b64_tr_b16 v[50:51], v28 offset:10496
ds_read_b64_tr_b16 v[52:53], v28 offset:8224
ds_read_b64_tr_b16 v[54:55], v28 offset:8480
ds_read_b64_tr_b16 v[56:57], v28 offset:10272
ds_read_b64_tr_b16 v[58:59], v28 offset:10528
s_waitcnt lgkmcnt(0)
ds_write_b128 v2, v[44:47] offset:8192
ds_write_b128 v2, v[48:51] offset:9216
ds_write_b128 v2, v[52:55] offset:10240
ds_write_b128 v2, v[56:59] offset:11264
s_waitcnt lgkmcnt(0)
s_waitcnt vmcnt(24)
ds_read_b64_tr_b16 v[44:45], v28 offset:12288
ds_read_b64_tr_b16 v[46:47], v28 offset:12544
ds_read_b64_tr_b16 v[48:49], v28 offset:14336
ds_read_b64_tr_b16 v[50:51], v28 offset:14592
ds_read_b64_tr_b16 v[52:53], v28 offset:12320
ds_read_b64_tr_b16 v[54:55], v28 offset:12576
ds_read_b64_tr_b16 v[56:57], v28 offset:14368
ds_read_b64_tr_b16 v[58:59], v28 offset:14624
s_waitcnt lgkmcnt(0)
ds_write_b128 v2, v[44:47] offset:12288
ds_write_b128 v2, v[48:51] offset:13312
ds_write_b128 v2, v[52:55] offset:14336
ds_write_b128 v2, v[56:59] offset:15360
s_waitcnt lgkmcnt(0)
s_waitcnt vmcnt(20)
ds_read_b64_tr_b16 v[44:45], v28 offset:16384
ds_read_b64_tr_b16 v[46:47], v28 offset:16640
ds_read_b64_tr_b16 v[48:49], v28 offset:18432
ds_read_b64_tr_b16 v[50:51], v28 offset:18688
ds_read_b64_tr_b16 v[52:53], v28 offset:16416
ds_read_b64_tr_b16 v[54:55], v28 offset:16672
ds_read_b64_tr_b16 v[56:57], v28 offset:18464
ds_read_b64_tr_b16 v[58:59], v28 offset:18720
s_waitcnt lgkmcnt(0)
ds_write_b128 v2, v[44:47] offset:16384
ds_write_b128 v2, v[48:51] offset:17408
ds_write_b128 v2, v[52:55] offset:18432
ds_write_b128 v2, v[56:59] offset:19456
s_waitcnt lgkmcnt(0)
s_waitcnt vmcnt(16)
ds_read_b64_tr_b16 v[44:45], v29 offset:20480
ds_read_b64_tr_b16 v[46:47], v29 offset:20608
ds_read_b64_tr_b16 v[48:49], v29 offset:20992
ds_read_b64_tr_b16 v[50:51], v29 offset:21120
ds_read_b64_tr_b16 v[52:53], v29 offset:22528
ds_read_b64_tr_b16 v[54:55], v29 offset:22656
ds_read_b64_tr_b16 v[56:57], v29 offset:23040
ds_read_b64_tr_b16 v[58:59], v29 offset:23168
s_waitcnt lgkmcnt(0)
ds_write_b128 v2, v[44:47] offset:20480
ds_write_b128 v2, v[48:51] offset:21504
ds_write_b128 v2, v[52:55] offset:22528
ds_write_b128 v2, v[56:59] offset:23552
s_waitcnt lgkmcnt(0)
s_waitcnt vmcnt(12)
ds_read_b64_tr_b16 v[44:45], v29 offset:24576
ds_read_b64_tr_b16 v[46:47], v29 offset:24704
ds_read_b64_tr_b16 v[48:49], v29 offset:25088
ds_read_b64_tr_b16 v[50:51], v29 offset:25216
ds_read_b64_tr_b16 v[52:53], v29 offset:26624
ds_read_b64_tr_b16 v[54:55], v29 offset:26752
ds_read_b64_tr_b16 v[56:57], v29 offset:27136
ds_read_b64_tr_b16 v[58:59], v29 offset:27264
s_waitcnt lgkmcnt(0)
ds_write_b128 v2, v[44:47] offset:24576
ds_write_b128 v2, v[48:51] offset:25600
ds_write_b128 v2, v[52:55] offset:26624
ds_write_b128 v2, v[56:59] offset:27648
s_waitcnt lgkmcnt(0)
s_waitcnt vmcnt(8)
ds_read_b64_tr_b16 v[44:45], v29 offset:28672
ds_read_b64_tr_b16 v[46:47], v29 offset:28800
ds_read_b64_tr_b16 v[48:49], v29 offset:29184
ds_read_b64_tr_b16 v[50:51], v29 offset:29312
ds_read_b64_tr_b16 v[52:53], v29 offset:30720
ds_read_b64_tr_b16 v[54:55], v29 offset:30848
ds_read_b64_tr_b16 v[56:57], v29 offset:31232
ds_read_b64_tr_b16 v[58:59], v29 offset:31360
s_waitcnt lgkmcnt(0)
ds_write_b128 v2, v[44:47] offset:28672
ds_write_b128 v2, v[48:51] offset:29696
ds_write_b128 v2, v[52:55] offset:30720
ds_write_b128 v2, v[56:59] offset:31744
s_waitcnt lgkmcnt(0)
s_waitcnt vmcnt(4)
ds_read_b64_tr_b16 v[44:45], v29 offset:32768
ds_read_b64_tr_b16 v[46:47], v29 offset:32896
ds_read_b64_tr_b16 v[48:49], v29 offset:33280
ds_read_b64_tr_b16 v[50:51], v29 offset:33408
ds_read_b64_tr_b16 v[52:53], v29 offset:34816
ds_read_b64_tr_b16 v[54:55], v29 offset:34944
ds_read_b64_tr_b16 v[56:57], v29 offset:35328
ds_read_b64_tr_b16 v[58:59], v29 offset:35456
s_waitcnt lgkmcnt(0)
ds_write_b128 v2, v[44:47] offset:32768
ds_write_b128 v2, v[48:51] offset:33792
ds_write_b128 v2, v[52:55] offset:34816
ds_write_b128 v2, v[56:59] offset:35840
s_waitcnt lgkmcnt(0)
s_waitcnt vmcnt(0)
ds_read_b64_tr_b16 v[44:45], v29 offset:36864
ds_read_b64_tr_b16 v[46:47], v29 offset:36992
ds_read_b64_tr_b16 v[48:49], v29 offset:37376
ds_read_b64_tr_b16 v[50:51], v29 offset:37504
ds_read_b64_tr_b16 v[52:53], v29 offset:38912
ds_read_b64_tr_b16 v[54:55], v29 offset:39040
ds_read_b64_tr_b16 v[56:57], v29 offset:39424
ds_read_b64_tr_b16 v[58:59], v29 offset:39552
s_waitcnt lgkmcnt(0)
ds_write_b128 v2, v[44:47] offset:36864
ds_write_b128 v2, v[48:51] offset:37888
ds_write_b128 v2, v[52:55] offset:38912
ds_write_b128 v2, v[56:59] offset:39936
s_waitcnt lgkmcnt(0)
v_mov_b32 v24, 0
L_rdv_w0:
buffer_load_dword v23, v24, s[28:31], 0 offen sc0 sc1
s_sub_u32 s41, s41, 1
s_cbranch_scc1 L_exit
s_waitcnt vmcnt(0)
v_readfirstlane_b32 s56, v23
s_nop 0
s_and_b32 s57, s56, 0xff
s_cmp_lg_u32 s57, 32
s_cbranch_scc1 L_rdv_w0
s_lshl_b32 s101, s32, 7
s_add_u32 s101, s101, 327680
L_kvw_w0p:
s_load_dwordx16 s[64:79], s[4:5], s101 glc
s_sub_u32 s41, s41, 1
s_cbranch_scc1 L_exit
s_waitcnt lgkmcnt(0)
s_min_u32 s64, s64, s65
s_min_u32 s64, s64, s66
s_min_u32 s64, s64, s67
s_min_u32 s64, s64, s68
s_min_u32 s64, s64, s69
s_min_u32 s64, s64, s70
s_min_u32 s64, s64, s71
s_min_u32 s64, s64, s72
s_min_u32 s64, s64, s73
s_min_u32 s64, s64, s74
s_min_u32 s64, s64, s75
s_min_u32 s64, s64, s76
s_min_u32 s64, s64, s77
s_min_u32 s64, s64, s78
s_min_u32 s64, s64, s79
s_lshl_b32 s100, s64, 2
s_sub_u32 s100, s100, 1
s_cmp_ge_i32 s34, s100
s_cbranch_scc1 L_kvw_w0p
s_barrier
s_mov_b32 m0, 0
s_lshl_b32 s57, s58, 5
s_mov_b32 s0, 0x3f003f00
s_mov_b32 s1, 0x3f003f00
s_mov_b32 s58, 304128
s_cmp_eq_u32 s56, s57
s_cbranch_scc0 L_slow_w0
buffer_load_dwordx4 v[12:15], v9, s[4:7], s37 offen offset:0
buffer_load_dwordx4 v[16:19], v9, s[4:7], s37 offen offset:1024
buffer_load_dwordx4 v[52:55], v1, s[4:7], s37 offen offset:2048
buffer_load_dwordx4 v[56:59], v1, s[4:7], s37 offen offset:3072
v_mov_b64 v[20:21], 0
v_mov_b64 v[22:23], 0
v_mov_b64 v[24:25], 0
v_mov_b64 v[26:27], 0
v_mov_b64 v[28:29], 0
v_mov_b64 v[30:31], 0
v_mov_b64 v[32:33], 0
v_mov_b64 v[34:35], 0
v_mov_b64 v[36:37], 0
v_mov_b64 v[38:39], 0
v_mov_b64 v[40:41], 0
v_mov_b64 v[42:43], 0
ds_read_b128 v[44:47], v2 offset:0
ds_read_b128 v[48:51], v2 offset:1024
v_bfe_u32 v77, v1, 6, 1
v_lshl_add_u32 v77, v77, 3, v1
v_lshlrev_b32 v77, 1, v77
s_mov_b32 s38, 1
s_mov_b32 m0, 1024
s_nop 0
buffer_load_dwordx4 v1, s[4:7], s47 offen offset:0 sc1 lds
buffer_load_dwordx4 v1, s[4:7], s47 offen offset:1024 sc1 lds
buffer_load_dwordx4 v1, s[4:7], s47 offen offset:2048 sc1 lds
buffer_load_dwordx4 v1, s[4:7], s47 offen offset:3072 sc1 lds
s_mov_b32 m0, 5120
s_nop 0
buffer_load_dwordx4 v1, s[4:7], s48 offen offset:0 sc1 lds
buffer_load_dwordx4 v1, s[4:7], s48 offen offset:1024 sc1 lds
buffer_load_dwordx4 v1, s[4:7], s48 offen offset:2048 sc1 lds
buffer_load_dwordx4 v1, s[4:7], s48 offen offset:3072 sc1 lds
s_mov_b32 m0, 9216
s_nop 0
buffer_load_dwordx4 v1, s[4:7], s49 offen offset:0 sc1 lds
s_waitcnt vmcnt(0) lgkmcnt(0)
s_branch L_top_w0f
.p2align 6
L_ex_w0f:
s_add_u32 s34, s34, 1
s_add_u32 s37, s37, 524288
s_add_u32 s39, s39, 524288
s_mul_i32 s40, s34, 10240
s_add_u32 s40, s40, 8093696
s_not_b32 s35, s35
s_not_b32 s36, s36
v_mov_b64 v[20:21], 0
v_mov_b64 v[22:23], 0
v_mov_b64 v[24:25], 0
v_mov_b64 v[26:27], 0
v_mov_b64 v[28:29], 0
v_mov_b64 v[30:31], 0
v_mov_b64 v[32:33], 0
v_mov_b64 v[34:35], 0
v_mov_b64 v[36:37], 0
v_mov_b64 v[38:39], 0
v_mov_b64 v[40:41], 0
v_mov_b64 v[42:43], 0
s_cmp_eq_u32 s34, 63
s_cbranch_scc1 L_done_w0f
ds_read_b128 v[44:47], v2 offset:0
ds_read_b128 v[48:51], v2 offset:1024
v_bfe_u32 v77, v1, 6, 1
v_lshl_add_u32 v77, v77, 3, v1
v_lshlrev_b32 v77, 1, v77
s_barrier
s_cmp_ge_u32 s34, s100
s_cbranch_scc1 L_ev_w0f
L_evb_w0f:
L_top_w0f:
s_barrier
ds_read_b128 v[60:63], v1 offset:1024
ds_read_b128 v[64:67], v1 offset:2048
s_mov_b32 m0, 5120
s_nop 0
buffer_load_dwordx4 v1, s[4:7], s48 offen offset:0 sc1 lds
s_barrier
ds_read_b128 v[68:71], v1 offset:3072
ds_read_b128 v[72:75], v1 offset:4096
L_s0_w0f:
s_waitcnt lgkmcnt(3)
v_smfmac_f32_16x16x64_bf16 v[28:31], v[60:63], v[176:183], v0
v_smfmac_f32_16x16x64_bf16 v[32:35], v[60:63], v[184:191], v0
v_smfmac_f32_16x16x64_bf16 v[36:39], v[60:63], a[48:55], v0
v_smfmac_f32_16x16x64_bf16 v[40:43], v[60:63], a[56:63], v0
s_waitcnt lgkmcnt(2)
v_smfmac_f32_16x16x64_bf16 v[20:23], v[64:67], v[80:87], v0
v_smfmac_f32_16x16x64_bf16 v[20:23], v[60:63], v[44:51], v0
ds_read_b128 v[44:47], v2 offset:2048
buffer_load_dwordx4 v[12:15], v9, s[4:7], s37 offen offset:0
buffer_load_dwordx4 v[16:19], v9, s[4:7], s37 offen offset:1024
buffer_load_dwordx4 v[52:55], v1, s[4:7], s37 offen offset:2048
buffer_load_dwordx4 v[56:59], v1, s[4:7], s37 offen offset:3072
v_smfmac_f32_16x16x64_bf16 v[24:27], v[64:67], v[88:95], v0
ds_read_b128 v[48:51], v2 offset:3072
v_smfmac_f32_16x16x64_bf16 v[28:31], v[64:67], v[192:199], v0
s_waitcnt lgkmcnt(2)
v_bitop3_b32 v6, v60, v64, s35 bitop3:0x7e
v_smfmac_f32_16x16x64_bf16 v[32:35], v[64:67], v[200:207], v0
v_bitop3_b32 v76, v68, v72, s35 bitop3:0x7e
v_smfmac_f32_16x16x64_bf16 v[36:39], v[64:67], a[64:71], v0
v_bitop3_b32 v6, v6, v76, 1 bitop3:0xa8
s_waitcnt lgkmcnt(0)
v_smfmac_f32_16x16x64_bf16 v[24:27], v[60:63], v[44:51], v0
ds_read_b128 v[44:47], v2 offset:4096
v_cmp_ne_u32 vcc, 0, v6
v_smfmac_f32_16x16x64_bf16 v[40:43], v[64:67], a[72:79], v0
ds_read_b128 v[48:51], v2 offset:5120
v_smfmac_f32_16x16x64_bf16 v[20:23], v[68:71], v[96:103], v0
s_cbranch_vccnz L_ra0_w0f
v_smfmac_f32_16x16x64_bf16 v[24:27], v[68:71], v[104:111], v0
s_waitcnt vmcnt(4)
s_barrier
ds_read_b32 v6, v77 offset:8192
v_smfmac_f32_16x16x64_bf16 v[28:31], v[68:71], v[208:215], v0
ds_read_b128 v[60:63], v1 offset:6144
s_waitcnt lgkmcnt(2)
v_smfmac_f32_16x16x64_bf16 v[20:23], v[72:75], v[44:51], v0
ds_read_b128 v[64:67], v1 offset:7168
v_smfmac_f32_16x16x64_bf16 v[32:35], v[68:71], v[216:223], v0
ds_read_b128 v[76:79], v1 offset:5120
v_smfmac_f32_16x16x64_bf16 v[36:39], v[68:71], a[80:87], v0
ds_read_b128 v[44:47], v2 offset:6144
v_smfmac_f32_16x16x64_bf16 v[40:43], v[68:71], a[88:95], v0
ds_read_b128 v[48:51], v2 offset:7168
s_waitcnt lgkmcnt(4)
v_bitop3_b32 v6, v6, v60, s35 bitop3:0x7e
v_smfmac_f32_16x16x64_bf16 v[28:31], v[72:75], v[224:231], v0
ds_read_b128 v[68:71], v1 offset:8192
s_waitcnt lgkmcnt(4)
v_bitop3_b32 v6, v6, v64, s35 bitop3:0xf6
v_smfmac_f32_16x16x64_bf16 v[32:35], v[72:75], v[232:239], v0
s_waitcnt lgkmcnt(3)
v_bitop3_b32 v6, v6, v76, s35 bitop3:0xf6
v_and_b32 v6, 1, v6
v_smfmac_f32_16x16x64_bf16 v[36:39], v[72:75], a[96:103], v0
v_cmp_ne_u32 vcc, 0, v6
s_waitcnt lgkmcnt(1)
v_smfmac_f32_16x16x64_bf16 v[24:27], v[72:75], v[44:51], v0
ds_read_b128 v[44:47], v2 offset:8192
v_lshlrev_b32 v6, 2, v1
v_smfmac_f32_16x16x64_bf16 v[40:43], v[72:75], a[104:111], v0
ds_read_b128 v[72:75], v1 offset:9216
s_cbranch_vccnz L_ra1_w0f
L_a1_w0f:
v_smfmac_f32_16x16x64_bf16 v[20:23], v[60:63], v[112:119], v0
ds_read_b128 v[48:51], v2 offset:9216
v_smfmac_f32_16x16x64_bf16 v[20:23], v[64:67], v[128:135], v0
s_waitcnt lgkmcnt(3)
v_smfmac_f32_16x16x64_bf16 v[20:23], v[68:71], v[144:151], v0
s_waitcnt lgkmcnt(1)
v_smfmac_f32_16x16x64_bf16 v[20:23], v[72:75], v[160:167], v0
s_waitcnt lgkmcnt(0)
v_smfmac_f32_16x16x64_bf16 v[20:23], v[76:79], v[44:51], v0
ds_read_b128 v[44:47], v2 offset:10240
v_smfmac_f32_16x16x64_bf16 v[24:27], v[60:63], v[120:127], v0
ds_read_b128 v[48:51], v2 offset:11264
v_smfmac_f32_16x16x64_bf16 v[24:27], v[64:67], v[136:143], v0
v_add_f32 v20, v20, v22
v_smfmac_f32_16x16x64_bf16 v[24:27], v[68:71], v[152:159], v0
v_add_f32 v21, v21, v23
v_smfmac_f32_16x16x64_bf16 v[24:27], v[72:75], v[168:175], v0
v_cvt_pk_bf16_f32 v22, v20, v21
s_waitcnt lgkmcnt(0)
v_smfmac_f32_16x16x64_bf16 v[24:27], v[76:79], v[44:51], v0
ds_read_b128 v[44:47], v2 offset:12288
v_smfmac_f32_16x16x64_bf16 v[28:31], v[76:79], v[240:247], v0
ds_read_b128 v[48:51], v2 offset:13312
v_smfmac_f32_16x16x64_bf16 v[28:31], v[64:67], a[0:7], v0
v_add_f32 v24, v24, v26
v_add_f32 v25, v25, v27
v_cvt_pk_bf16_f32 v23, v24, v25
v_smfmac_f32_16x16x64_bf16 v[28:31], v[68:71], a[16:23], v0
ds_write_b64 v3, v[22:23] offset:10240
v_smfmac_f32_16x16x64_bf16 v[28:31], v[72:75], a[32:39], v0
s_mov_b32 m0, 0
s_nop 0
buffer_load_dword v6, s[4:7], s39 offen lds
s_waitcnt lgkmcnt(1)
v_smfmac_f32_16x16x64_bf16 v[28:31], v[60:63], v[44:51], v0
ds_read_b128 v[44:47], v2 offset:14336
v_smfmac_f32_16x16x64_bf16 v[32:35], v[76:79], v[248:255], v0
ds_read_b128 v[48:51], v2 offset:15360
s_waitcnt lgkmcnt(2)
s_barrier
v_smfmac_f32_16x16x64_bf16 v[32:35], v[64:67], a[8:15], v0
ds_read_b64_tr_b16 v[20:21], v4 offset:10240
ds_read_b64_tr_b16 v[22:23], v4 offset:10752
v_add_f32 v28, v28, v30
v_smfmac_f32_16x16x64_bf16 v[32:35], v[68:71], a[24:31], v0
ds_read_b64_tr_b16 v[24:25], v4 offset:11264
v_add_f32 v29, v29, v31
v_smfmac_f32_16x16x64_bf16 v[32:35], v[72:75], a[40:47], v0
ds_read_b64_tr_b16 v[26:27], v4 offset:11776
v_cvt_pk_bf16_f32 v30, v28, v29
s_waitcnt lgkmcnt(4)
v_smfmac_f32_16x16x64_bf16 v[32:35], v[60:63], v[44:51], v0
ds_read_b128 v[44:47], v2 offset:18432
s_waitcnt vmcnt(3)
s_waitcnt lgkmcnt(3)
v_mfma_f32_16x16x32_bf16 v[12:15], v[12:15], v[20:23], 0
ds_read_b128 v[48:51], v2 offset:19456
s_waitcnt lgkmcnt(2)
v_mfma_f32_16x16x32_bf16 v[12:15], v[16:19], v[24:27], v[12:15]
v_add_f32 v32, v32, v34
v_add_f32 v33, v33, v35
v_cvt_pk_bf16_f32 v31, v32, v33
ds_write_b64 v3, v[30:31] offset:12288
v_smfmac_f32_16x16x64_bf16 v[36:39], v[76:79], a[112:119], v0
s_nop 2
v_add_f32_dpp v12, v14, v12 quad_perm:[2,3,0,1] row_mask:0xf bank_mask:0xf
v_add_f32_dpp v13, v15, v13 quad_perm:[2,3,0,1] row_mask:0xf bank_mask:0xf
ds_write_b64 v5, v[12:13] offset:14336
v_smfmac_f32_16x16x64_bf16 v[40:43], v[76:79], a[120:127], v0
s_waitcnt lgkmcnt(1)
s_barrier
ds_read_b64_tr_b16 v[28:29], v4 offset:12288
v_smfmac_f32_16x16x64_bf16 v[36:39], v[60:63], a[128:135], v0
ds_read_b64_tr_b16 v[30:31], v4 offset:12800
ds_read_b64_tr_b16 v[32:33], v4 offset:13312
v_smfmac_f32_16x16x64_bf16 v[40:43], v[60:63], a[136:143], v0
ds_read_b64_tr_b16 v[34:35], v4 offset:13824
v_mov_b64 v[76:77], s[52:53]
s_waitcnt lgkmcnt(4)
s_barrier
ds_read_b128 v[12:15], v1 offset:14336
v_smfmac_f32_16x16x64_bf16 v[40:43], v[72:75], v[44:51], v0
ds_read_b128 v[44:47], v2 offset:16384
v_mov_b64 v[78:79], s[52:53]
s_waitcnt lgkmcnt(4)
v_mfma_f32_16x16x32_bf16 v[28:31], v[28:31], v[20:23], 0
ds_read_b128 v[48:51], v2 offset:17408
s_waitcnt lgkmcnt(3)
v_mfma_f32_16x16x32_bf16 v[28:31], v[32:35], v[24:27], v[28:31]
v_smfmac_f32_16x16x64_bf16 v[40:43], v[64:67], a[152:159], v0
s_waitcnt lgkmcnt(2)
v_max3_f32 v17, v12, v13, v14
v_smfmac_f32_16x16x64_bf16 v[36:39], v[64:67], a[144:151], v0
ds_read_b128 v[60:63], v2 offset:22528
v_add_f32_dpp v28, v30, v28 quad_perm:[2,3,0,1] row_mask:0xf bank_mask:0xf
v_add_f32_dpp v29, v31, v29 quad_perm:[2,3,0,1] row_mask:0xf bank_mask:0xf
v_max_f32 v17, v17, v15
v_max_f32 v16, v28, v29
v_mul_f32 v16, s50, v16
v_max_f32_dpp v17, v17, v17 quad_perm:[2,3,0,1] row_mask:0xf bank_mask:0xf
v_smfmac_f32_16x16x64_bf16 v[40:43], v[68:71], a[168:175], v0
ds_read_b128 v[64:67], v2 offset:23552
v_max_f32_dpp v18, v16, v17 quad_perm:[0,1,0,1] row_mask:0xf bank_mask:0xf
v_max_f32_dpp v19, v16, v17 quad_perm:[0,1,0,1] row_mask:0xf bank_mask:0xf
v_smfmac_f32_16x16x64_bf16 v[36:39], v[68:71], a[160:167], v0
ds_read_b128 v[68:71], v2 offset:24576
v_permlane16_swap_b32 v18, v19
v_max_f32 v20, v18, v19
v_max_f32 v21, v18, v19
s_waitcnt lgkmcnt(3)
v_smfmac_f32_16x16x64_bf16 v[36:39], v[72:75], v[44:51], v0
ds_read_b128 v[72:75], v2 offset:25600
v_permlane32_swap_b32 v20, v21
v_max_f32 v20, v20, v21
v_sub_f32 v12, v12, v20
v_sub_f32 v13, v13, v20
v_pk_add_f32 v[14:15], v[14:15], v[20:21] op_sel_hi:[1,0] neg_lo:[0,1] neg_hi:[0,1]
v_exp_f32 v12, v12
v_exp_f32 v13, v13
v_exp_f32 v14, v14
v_exp_f32 v15, v15
v_cvt_pk_bf16_f32 v16, v12, v13
v_cvt_pk_bf16_f32 v17, v14, v15
v_pk_fma_f32 v[28:29], v[28:29], s[50:51], v[20:21] op_sel_hi:[1,1,0] neg_lo:[0,0,1] neg_hi:[0,0,1]
v_mov_b32_dpp v18, v16 quad_perm:[2,3,0,1] row_mask:0xf bank_mask:0xf
v_mov_b32_dpp v19, v17 quad_perm:[2,3,0,1] row_mask:0xf bank_mask:0xf
v_exp_f32 v28, v28
s_waitcnt vmcnt(1)
v_mfma_f32_16x16x32_bf16 v[32:35], v[76:79], v[16:19], 0
v_exp_f32 v29, v29
v_mfma_f32_16x16x32_bf16 v[20:23], v[52:55], v[16:19], 0
v_cvt_pk_bf16_f32 v12, v28, v29
v_cvt_pk_bf16_f32 v13, v28, v29
v_mov_b64 v[14:15], s[0:1]
v_mfma_f32_16x16x32_bf16 v[24:27], v[56:59], v[16:19], 0
v_cvt_pk_bf16_f32 v36, v36, v37
v_cvt_pk_bf16_f32 v37, v38, v39
v_mfma_f32_16x16x16_bf16 v[32:35], v[14:15], v[12:13], v[32:35]
v_cvt_pk_bf16_f32 v38, v40, v41
v_cvt_pk_bf16_f32 v39, v42, v43
v_mfma_f32_16x16x16_bf16 v[20:23], v[36:37], v[12:13], v[20:23]
ds_read_b128 v[44:47], v2 offset:20480
v_mfma_f32_16x16x16_bf16 v[24:27], v[38:39], v[12:13], v[24:27]
ds_read_b128 v[48:51], v2 offset:21504
v_rcp_f32 v32, v32
v_mov_b64 v[28:29], 0
v_mov_b64 v[30:31], 0
v_pk_mul_f32 v[20:21], v[20:21], v[32:33] op_sel_hi:[1,0]
v_pk_mul_f32 v[22:23], v[22:23], v[32:33] op_sel_hi:[1,0]
v_cvt_pk_bf16_f32 v20, v20, v21
v_cvt_pk_bf16_f32 v21, v22, v23
ds_write_b64 v1, v[20:21] offset:5120
v_pk_mul_f32 v[24:25], v[24:25], v[32:33] op_sel_hi:[1,0]
v_pk_mul_f32 v[26:27], v[26:27], v[32:33] op_sel_hi:[1,0]
v_cvt_pk_bf16_f32 v24, v24, v25
v_cvt_pk_bf16_f32 v25, v26, v27
ds_write_b64 v1, v[24:25] offset:5128
v_mov_b64 v[76:77], 0
ds_read_b128 v[12:15], v7 offset:5120
v_mov_b64 v[78:79], 0
v_mov_b64 v[40:41], 0
v_mov_b64 v[42:43], 0
v_mov_b64 v[36:37], 0
v_mov_b64 v[38:39], 0
v_mov_b64 v[32:33], 0
v_mov_b64 v[34:35], 0
s_waitcnt lgkmcnt(1)
s_barrier
ds_read_b128 v[16:19], v7 offset:6144
ds_read_b128 v[52:55], v7 offset:7168
ds_read_b128 v[56:59], v7 offset:8192
s_waitcnt lgkmcnt(3)
v_smfmac_f32_16x16x64_bf16 v[28:31], v[12:15], v[44:51], v0 abid:1
v_smfmac_f32_16x16x64_bf16 v[76:79], v[12:15], v[60:67], v0 abid:1
ds_read_b128 v[44:47], v2 offset:26624
s_waitcnt lgkmcnt(3)
v_smfmac_f32_16x16x64_bf16 v[28:31], v[16:19], a[176:183], v0 abid:1
ds_read_b128 v[48:51], v2 offset:27648
s_waitcnt lgkmcnt(3)
v_smfmac_f32_16x16x64_bf16 v[28:31], v[52:55], v[68:75], v0 abid:1
ds_read_b128 v[60:63], v2 offset:28672
s_waitcnt lgkmcnt(3)
v_smfmac_f32_16x16x64_bf16 v[28:31], v[56:59], a[184:191], v0 abid:1
ds_read_b128 v[64:67], v2 offset:29696
v_smfmac_f32_16x16x64_bf16 v[76:79], v[16:19], a[192:199], v0 abid:1
ds_read_b128 v[68:71], v2 offset:30720
s_waitcnt lgkmcnt(3)
v_smfmac_f32_16x16x64_bf16 v[76:79], v[52:55], v[44:51], v0 abid:1
ds_read_b128 v[72:75], v2 offset:31744
v_cvt_pk_bf16_f32 v28, v28, v29
v_cvt_pk_bf16_f32 v29, v30, v31
v_bfi_b32 v28, 1, s35, v28
buffer_store_dwordx2 v[28:29], v8, s[4:7], s42 offen
v_smfmac_f32_16x16x64_bf16 v[76:79], v[56:59], a[200:207], v0 abid:1
ds_read_b128 v[44:47], v2 offset:32768
s_waitcnt lgkmcnt(3)
v_smfmac_f32_16x16x64_bf16 v[40:43], v[12:15], v[60:67], v0 abid:1
ds_read_b128 v[48:51], v2 offset:33792
v_smfmac_f32_16x16x64_bf16 v[40:43], v[16:19], a[208:215], v0 abid:1
ds_read_b128 v[60:63], v2 offset:34816
v_cvt_pk_bf16_f32 v76, v76, v77
v_cvt_pk_bf16_f32 v77, v78, v79
v_bfi_b32 v76, 1, s35, v76
buffer_store_dwordx2 v[76:77], v8, s[4:7], s43 offen
s_waitcnt lgkmcnt(3)
v_smfmac_f32_16x16x64_bf16 v[40:43], v[52:55], v[68:75], v0 abid:1
ds_read_b128 v[64:67], v2 offset:35840
v_smfmac_f32_16x16x64_bf16 v[40:43], v[56:59], a[216:223], v0 abid:1
ds_read_b128 v[68:71], v2 offset:36864
s_waitcnt lgkmcnt(3)
v_smfmac_f32_16x16x64_bf16 v[36:39], v[12:15], v[44:51], v0 abid:1
ds_read_b128 v[72:75], v2 offset:37888
v_smfmac_f32_16x16x64_bf16 v[36:39], v[16:19], a[224:231], v0 abid:1
ds_read_b128 v[44:47], v2 offset:38912
v_cvt_pk_bf16_f32 v40, v40, v41
s_waitcnt lgkmcnt(3)
v_smfmac_f32_16x16x64_bf16 v[36:39], v[52:55], v[60:67], v0 abid:1
ds_read_b128 v[48:51], v2 offset:39936
v_cvt_pk_bf16_f32 v41, v42, v43
v_smfmac_f32_16x16x64_bf16 v[36:39], v[56:59], a[232:239], v0 abid:1
v_bfi_b32 v40, 1, s35, v40
buffer_store_dwordx2 v[40:41], v8, s[4:7], s44 offen
s_waitcnt lgkmcnt(2)
v_smfmac_f32_16x16x64_bf16 v[32:35], v[12:15], v[68:75], v0 abid:1
v_smfmac_f32_16x16x64_bf16 v[32:35], v[16:19], a[240:247], v0 abid:1
v_cvt_pk_bf16_f32 v36, v36, v37
s_waitcnt lgkmcnt(0)
v_smfmac_f32_16x16x64_bf16 v[32:35], v[52:55], v[44:51], v0 abid:1
v_cvt_pk_bf16_f32 v37, v38, v39
v_smfmac_f32_16x16x64_bf16 v[32:35], v[56:59], a[248:255], v0 abid:1
v_bfi_b32 v36, 1, s35, v36
buffer_store_dwordx2 v[36:37], v8, s[4:7], s45 offen
s_nop 5
v_cvt_pk_bf16_f32 v32, v32, v33
v_cvt_pk_bf16_f32 v33, v34, v35
v_bfi_b32 v32, 1, s35, v32
buffer_store_dwordx2 v[32:33], v8, s[4:7], s46 offen
s_branch L_ex_w0f
L_done_w0f:
s_waitcnt vmcnt(0) lgkmcnt(0)
s_endpgm
L_ra0_w0f:
s_mov_b32 s38, 1
s_mov_b32 m0, 1024
s_nop 0
buffer_load_dwordx4 v1, s[4:7], s47 offen offset:0 sc1 lds
buffer_load_dwordx4 v1, s[4:7], s47 offen offset:1024 sc1 lds
buffer_load_dwordx4 v1, s[4:7], s47 offen offset:2048 sc1 lds
buffer_load_dwordx4 v1, s[4:7], s47 offen offset:3072 sc1 lds
s_sub_u32 s41, s41, 1
s_cbranch_scc1 L_exit
ds_read_b128 v[44:47], v2 offset:0
ds_read_b128 v[48:51], v2 offset:1024
v_mov_b64 v[20:21], 0
v_mov_b64 v[22:23], 0
v_mov_b64 v[24:25], 0
v_mov_b64 v[26:27], 0
v_mov_b64 v[28:29], 0
v_mov_b64 v[30:31], 0
v_mov_b64 v[32:33], 0
v_mov_b64 v[34:35], 0
v_mov_b64 v[36:37], 0
v_mov_b64 v[38:39], 0
v_mov_b64 v[40:41], 0
v_mov_b64 v[42:43], 0
s_waitcnt vmcnt(0)
ds_read_b128 v[60:63], v1 offset:1024
ds_read_b128 v[64:67], v1 offset:2048
ds_read_b128 v[68:71], v1 offset:3072
ds_read_b128 v[72:75], v1 offset:4096
s_branch L_s0_w0f
L_ra1_w0f:
s_mov_b32 s38, 1
s_waitcnt lgkmcnt(0)
s_barrier
s_mov_b32 m0, 5120
s_nop 0
buffer_load_dwordx4 v1, s[4:7], s48 offen offset:0 sc1 lds
s_mov_b32 m0, 9216
s_nop 0
buffer_load_dwordx4 v1, s[4:7], s49 offen offset:0 sc1 lds
s_sub_u32 s41, s41, 1
s_cbranch_scc1 L_exit
s_waitcnt vmcnt(0)
s_barrier
ds_read_b128 v[76:79], v1 offset:5120
ds_read_b128 v[60:63], v1 offset:6144
ds_read_b128 v[64:67], v1 offset:7168
ds_read_b128 v[68:71], v1 offset:8192
ds_read_b128 v[72:75], v1 offset:9216
s_waitcnt lgkmcnt(0)
v_bitop3_b32 v6, v76, v60, s35 bitop3:0x7e
v_bitop3_b32 v6, v6, v64, s35 bitop3:0xf6
v_bitop3_b32 v6, v6, v68, s35 bitop3:0xf6
v_bitop3_b32 v6, v6, v72, s35 bitop3:0xf6
v_and_b32 v6, 1, v6
v_cmp_ne_u32 vcc, 0, v6
v_lshlrev_b32 v6, 2, v1
s_cbranch_vccnz L_ra1_w0f
s_branch L_a1_w0f
L_ev_w0f:

L_kvw_w0f:
s_load_dwordx16 s[64:79], s[4:5], s101 glc
s_sub_u32 s41, s41, 1
s_cbranch_scc1 L_exit
s_waitcnt lgkmcnt(0)
s_min_u32 s64, s64, s65
s_min_u32 s64, s64, s66
s_min_u32 s64, s64, s67
s_min_u32 s64, s64, s68
s_min_u32 s64, s64, s69
s_min_u32 s64, s64, s70
s_min_u32 s64, s64, s71
s_min_u32 s64, s64, s72
s_min_u32 s64, s64, s73
s_min_u32 s64, s64, s74
s_min_u32 s64, s64, s75
s_min_u32 s64, s64, s76
s_min_u32 s64, s64, s77
s_min_u32 s64, s64, s78
s_min_u32 s64, s64, s79
s_lshl_b32 s100, s64, 2
s_sub_u32 s100, s100, 1
s_cmp_ge_i32 s34, s100
s_cbranch_scc1 L_kvw_w0f
s_branch L_evb_w0f
L_slow_w0:
buffer_load_dwordx4 v[12:15], v9, s[4:7], s37 offen offset:0
buffer_load_dwordx4 v[16:19], v9, s[4:7], s37 offen offset:1024
buffer_load_dwordx4 v[52:55], v1, s[4:7], s37 offen offset:2048
buffer_load_dwordx4 v[56:59], v1, s[4:7], s37 offen offset:3072
v_mov_b64 v[20:21], 0
v_mov_b64 v[22:23], 0
v_mov_b64 v[24:25], 0
v_mov_b64 v[26:27], 0
v_mov_b64 v[28:29], 0
v_mov_b64 v[30:31], 0
v_mov_b64 v[32:33], 0
v_mov_b64 v[34:35], 0
v_mov_b64 v[36:37], 0
v_mov_b64 v[38:39], 0
v_mov_b64 v[40:41], 0
v_mov_b64 v[42:43], 0
ds_read_b128 v[44:47], v2 offset:0
ds_read_b128 v[48:51], v2 offset:1024
v_bfe_u32 v77, v1, 6, 1
v_lshl_add_u32 v77, v77, 3, v1
v_lshlrev_b32 v77, 1, v77
s_mov_b32 s38, 1
s_mov_b32 m0, 1024
s_nop 0
buffer_load_dwordx4 v1, s[4:7], s47 offen offset:0 sc0 sc1 lds
buffer_load_dwordx4 v1, s[4:7], s47 offen offset:1024 sc0 sc1 lds
buffer_load_dwordx4 v1, s[4:7], s47 offen offset:2048 sc0 sc1 lds
buffer_load_dwordx4 v1, s[4:7], s47 offen offset:3072 sc0 sc1 lds
s_mov_b32 m0, 5120
s_nop 0
buffer_load_dwordx4 v1, s[4:7], s48 offen offset:0 sc0 sc1 lds
buffer_load_dwordx4 v1, s[4:7], s48 offen offset:1024 sc0 sc1 lds
buffer_load_dwordx4 v1, s[4:7], s48 offen offset:2048 sc0 sc1 lds
buffer_load_dwordx4 v1, s[4:7], s48 offen offset:3072 sc0 sc1 lds
s_mov_b32 m0, 9216
s_nop 0
buffer_load_dwordx4 v1, s[4:7], s49 offen offset:0 sc0 sc1 lds
s_waitcnt vmcnt(0) lgkmcnt(0)
s_branch L_top_w0s
.p2align 6
L_ex_w0s:
s_add_u32 s34, s34, 1
s_add_u32 s37, s37, 524288
s_add_u32 s39, s39, 524288
s_mul_i32 s40, s34, 10240
s_add_u32 s40, s40, 8093696
s_not_b32 s35, s35
s_not_b32 s36, s36
v_mov_b64 v[20:21], 0
v_mov_b64 v[22:23], 0
v_mov_b64 v[24:25], 0
v_mov_b64 v[26:27], 0
v_mov_b64 v[28:29], 0
v_mov_b64 v[30:31], 0
v_mov_b64 v[32:33], 0
v_mov_b64 v[34:35], 0
v_mov_b64 v[36:37], 0
v_mov_b64 v[38:39], 0
v_mov_b64 v[40:41], 0
v_mov_b64 v[42:43], 0
s_cmp_eq_u32 s34, 63
s_cbranch_scc1 L_done_w0s
ds_read_b128 v[44:47], v2 offset:0
ds_read_b128 v[48:51], v2 offset:1024
v_bfe_u32 v77, v1, 6, 1
v_lshl_add_u32 v77, v77, 3, v1
v_lshlrev_b32 v77, 1, v77
s_barrier
s_cmp_ge_u32 s34, s100
s_cbranch_scc1 L_ev_w0s
L_evb_w0s:
L_top_w0s:
s_barrier
ds_read_b128 v[60:63], v1 offset:1024
ds_read_b128 v[64:67], v1 offset:2048
s_mov_b32 m0, 5120
s_nop 0
buffer_load_dwordx4 v1, s[4:7], s48 offen offset:0 sc0 sc1 lds
s_barrier
ds_read_b128 v[68:71], v1 offset:3072
ds_read_b128 v[72:75], v1 offset:4096
L_s0_w0s:
s_waitcnt lgkmcnt(3)
v_smfmac_f32_16x16x64_bf16 v[28:31], v[60:63], v[176:183], v0
v_smfmac_f32_16x16x64_bf16 v[32:35], v[60:63], v[184:191], v0
v_smfmac_f32_16x16x64_bf16 v[36:39], v[60:63], a[48:55], v0
v_smfmac_f32_16x16x64_bf16 v[40:43], v[60:63], a[56:63], v0
s_waitcnt lgkmcnt(2)
v_smfmac_f32_16x16x64_bf16 v[20:23], v[64:67], v[80:87], v0
v_smfmac_f32_16x16x64_bf16 v[20:23], v[60:63], v[44:51], v0
ds_read_b128 v[44:47], v2 offset:2048
buffer_load_dwordx4 v[12:15], v9, s[4:7], s37 offen offset:0
buffer_load_dwordx4 v[16:19], v9, s[4:7], s37 offen offset:1024
buffer_load_dwordx4 v[52:55], v1, s[4:7], s37 offen offset:2048
buffer_load_dwordx4 v[56:59], v1, s[4:7], s37 offen offset:3072
v_smfmac_f32_16x16x64_bf16 v[24:27], v[64:67], v[88:95], v0
ds_read_b128 v[48:51], v2 offset:3072
v_smfmac_f32_16x16x64_bf16 v[28:31], v[64:67], v[192:199], v0
s_waitcnt lgkmcnt(2)
v_bitop3_b32 v6, v60, v64, s35 bitop3:0x7e
v_smfmac_f32_16x16x64_bf16 v[32:35], v[64:67], v[200:207], v0
v_bitop3_b32 v76, v68, v72, s35 bitop3:0x7e
v_smfmac_f32_16x16x64_bf16 v[36:39], v[64:67], a[64:71], v0
v_bitop3_b32 v6, v6, v76, 1 bitop3:0xa8
s_waitcnt lgkmcnt(0)
v_smfmac_f32_16x16x64_bf16 v[24:27], v[60:63], v[44:51], v0
ds_read_b128 v[44:47], v2 offset:4096
v_cmp_ne_u32 vcc, 0, v6
v_smfmac_f32_16x16x64_bf16 v[40:43], v[64:67], a[72:79], v0
ds_read_b128 v[48:51], v2 offset:5120
v_smfmac_f32_16x16x64_bf16 v[20:23], v[68:71], v[96:103], v0
s_cbranch_vccnz L_ra0_w0s
v_smfmac_f32_16x16x64_bf16 v[24:27], v[68:71], v[104:111], v0
s_waitcnt vmcnt(4)
s_barrier
ds_read_b32 v6, v77 offset:8192
v_smfmac_f32_16x16x64_bf16 v[28:31], v[68:71], v[208:215], v0
ds_read_b128 v[60:63], v1 offset:6144
s_waitcnt lgkmcnt(2)
v_smfmac_f32_16x16x64_bf16 v[20:23], v[72:75], v[44:51], v0
ds_read_b128 v[64:67], v1 offset:7168
v_smfmac_f32_16x16x64_bf16 v[32:35], v[68:71], v[216:223], v0
ds_read_b128 v[76:79], v1 offset:5120
v_smfmac_f32_16x16x64_bf16 v[36:39], v[68:71], a[80:87], v0
ds_read_b128 v[44:47], v2 offset:6144
v_smfmac_f32_16x16x64_bf16 v[40:43], v[68:71], a[88:95], v0
ds_read_b128 v[48:51], v2 offset:7168
s_waitcnt lgkmcnt(4)
v_bitop3_b32 v6, v6, v60, s35 bitop3:0x7e
v_smfmac_f32_16x16x64_bf16 v[28:31], v[72:75], v[224:231], v0
ds_read_b128 v[68:71], v1 offset:8192
s_waitcnt lgkmcnt(4)
v_bitop3_b32 v6, v6, v64, s35 bitop3:0xf6
v_smfmac_f32_16x16x64_bf16 v[32:35], v[72:75], v[232:239], v0
s_waitcnt lgkmcnt(3)
v_bitop3_b32 v6, v6, v76, s35 bitop3:0xf6
v_and_b32 v6, 1, v6
v_smfmac_f32_16x16x64_bf16 v[36:39], v[72:75], a[96:103], v0
v_cmp_ne_u32 vcc, 0, v6
s_waitcnt lgkmcnt(1)
v_smfmac_f32_16x16x64_bf16 v[24:27], v[72:75], v[44:51], v0
ds_read_b128 v[44:47], v2 offset:8192
v_lshlrev_b32 v6, 2, v1
v_smfmac_f32_16x16x64_bf16 v[40:43], v[72:75], a[104:111], v0
ds_read_b128 v[72:75], v1 offset:9216
s_cbranch_vccnz L_ra1_w0s
L_a1_w0s:
v_smfmac_f32_16x16x64_bf16 v[20:23], v[60:63], v[112:119], v0
ds_read_b128 v[48:51], v2 offset:9216
v_smfmac_f32_16x16x64_bf16 v[20:23], v[64:67], v[128:135], v0
s_waitcnt lgkmcnt(3)
v_smfmac_f32_16x16x64_bf16 v[20:23], v[68:71], v[144:151], v0
s_waitcnt lgkmcnt(1)
v_smfmac_f32_16x16x64_bf16 v[20:23], v[72:75], v[160:167], v0
s_waitcnt lgkmcnt(0)
v_smfmac_f32_16x16x64_bf16 v[20:23], v[76:79], v[44:51], v0
ds_read_b128 v[44:47], v2 offset:10240
v_smfmac_f32_16x16x64_bf16 v[24:27], v[60:63], v[120:127], v0
ds_read_b128 v[48:51], v2 offset:11264
v_smfmac_f32_16x16x64_bf16 v[24:27], v[64:67], v[136:143], v0
v_add_f32 v20, v20, v22
v_smfmac_f32_16x16x64_bf16 v[24:27], v[68:71], v[152:159], v0
v_add_f32 v21, v21, v23
v_smfmac_f32_16x16x64_bf16 v[24:27], v[72:75], v[168:175], v0
v_cvt_pk_bf16_f32 v22, v20, v21
s_waitcnt lgkmcnt(0)
v_smfmac_f32_16x16x64_bf16 v[24:27], v[76:79], v[44:51], v0
ds_read_b128 v[44:47], v2 offset:12288
v_smfmac_f32_16x16x64_bf16 v[28:31], v[76:79], v[240:247], v0
ds_read_b128 v[48:51], v2 offset:13312
v_smfmac_f32_16x16x64_bf16 v[28:31], v[64:67], a[0:7], v0
v_add_f32 v24, v24, v26
v_add_f32 v25, v25, v27
v_cvt_pk_bf16_f32 v23, v24, v25
v_smfmac_f32_16x16x64_bf16 v[28:31], v[68:71], a[16:23], v0
ds_write_b64 v3, v[22:23] offset:10240
v_smfmac_f32_16x16x64_bf16 v[28:31], v[72:75], a[32:39], v0
s_mov_b32 m0, 0
s_nop 0
buffer_load_dword v6, s[4:7], s39 offen lds
s_waitcnt lgkmcnt(1)
v_smfmac_f32_16x16x64_bf16 v[28:31], v[60:63], v[44:51], v0
ds_read_b128 v[44:47], v2 offset:14336
v_smfmac_f32_16x16x64_bf16 v[32:35], v[76:79], v[248:255], v0
ds_read_b128 v[48:51], v2 offset:15360
s_waitcnt lgkmcnt(2)
s_barrier
v_smfmac_f32_16x16x64_bf16 v[32:35], v[64:67], a[8:15], v0
ds_read_b64_tr_b16 v[20:21], v4 offset:10240
ds_read_b64_tr_b16 v[22:23], v4 offset:10752
v_add_f32 v28, v28, v30
v_smfmac_f32_16x16x64_bf16 v[32:35], v[68:71], a[24:31], v0
ds_read_b64_tr_b16 v[24:25], v4 offset:11264
v_add_f32 v29, v29, v31
v_smfmac_f32_16x16x64_bf16 v[32:35], v[72:75], a[40:47], v0
ds_read_b64_tr_b16 v[26:27], v4 offset:11776
v_cvt_pk_bf16_f32 v30, v28, v29
s_waitcnt lgkmcnt(4)
v_smfmac_f32_16x16x64_bf16 v[32:35], v[60:63], v[44:51], v0
ds_read_b128 v[44:47], v2 offset:18432
s_waitcnt vmcnt(3)
s_waitcnt lgkmcnt(3)
v_mfma_f32_16x16x32_bf16 v[12:15], v[12:15], v[20:23], 0
ds_read_b128 v[48:51], v2 offset:19456
s_waitcnt lgkmcnt(2)
v_mfma_f32_16x16x32_bf16 v[12:15], v[16:19], v[24:27], v[12:15]
v_add_f32 v32, v32, v34
v_add_f32 v33, v33, v35
v_cvt_pk_bf16_f32 v31, v32, v33
ds_write_b64 v3, v[30:31] offset:12288
v_smfmac_f32_16x16x64_bf16 v[36:39], v[76:79], a[112:119], v0
s_nop 2
v_add_f32_dpp v12, v14, v12 quad_perm:[2,3,0,1] row_mask:0xf bank_mask:0xf
v_add_f32_dpp v13, v15, v13 quad_perm:[2,3,0,1] row_mask:0xf bank_mask:0xf
ds_write_b64 v5, v[12:13] offset:14336
v_smfmac_f32_16x16x64_bf16 v[40:43], v[76:79], a[120:127], v0
s_waitcnt lgkmcnt(1)
s_barrier
ds_read_b64_tr_b16 v[28:29], v4 offset:12288
v_smfmac_f32_16x16x64_bf16 v[36:39], v[60:63], a[128:135], v0
ds_read_b64_tr_b16 v[30:31], v4 offset:12800
ds_read_b64_tr_b16 v[32:33], v4 offset:13312
v_smfmac_f32_16x16x64_bf16 v[40:43], v[60:63], a[136:143], v0
ds_read_b64_tr_b16 v[34:35], v4 offset:13824
v_mov_b64 v[76:77], s[52:53]
s_waitcnt lgkmcnt(4)
s_barrier
ds_read_b128 v[12:15], v1 offset:14336
v_smfmac_f32_16x16x64_bf16 v[40:43], v[72:75], v[44:51], v0
ds_read_b128 v[44:47], v2 offset:16384
v_mov_b64 v[78:79], s[52:53]
s_waitcnt lgkmcnt(4)
v_mfma_f32_16x16x32_bf16 v[28:31], v[28:31], v[20:23], 0
ds_read_b128 v[48:51], v2 offset:17408
s_waitcnt lgkmcnt(3)
v_mfma_f32_16x16x32_bf16 v[28:31], v[32:35], v[24:27], v[28:31]
v_smfmac_f32_16x16x64_bf16 v[40:43], v[64:67], a[152:159], v0
s_waitcnt lgkmcnt(2)
v_max3_f32 v17, v12, v13, v14
v_smfmac_f32_16x16x64_bf16 v[36:39], v[64:67], a[144:151], v0
ds_read_b128 v[60:63], v2 offset:22528
v_add_f32_dpp v28, v30, v28 quad_perm:[2,3,0,1] row_mask:0xf bank_mask:0xf
v_add_f32_dpp v29, v31, v29 quad_perm:[2,3,0,1] row_mask:0xf bank_mask:0xf
v_max_f32 v17, v17, v15
v_max_f32 v16, v28, v29
v_mul_f32 v16, s50, v16
v_max_f32_dpp v17, v17, v17 quad_perm:[2,3,0,1] row_mask:0xf bank_mask:0xf
v_smfmac_f32_16x16x64_bf16 v[40:43], v[68:71], a[168:175], v0
ds_read_b128 v[64:67], v2 offset:23552
v_max_f32_dpp v18, v16, v17 quad_perm:[0,1,0,1] row_mask:0xf bank_mask:0xf
v_max_f32_dpp v19, v16, v17 quad_perm:[0,1,0,1] row_mask:0xf bank_mask:0xf
v_smfmac_f32_16x16x64_bf16 v[36:39], v[68:71], a[160:167], v0
ds_read_b128 v[68:71], v2 offset:24576
v_permlane16_swap_b32 v18, v19
v_max_f32 v20, v18, v19
v_max_f32 v21, v18, v19
s_waitcnt lgkmcnt(3)
v_smfmac_f32_16x16x64_bf16 v[36:39], v[72:75], v[44:51], v0
ds_read_b128 v[72:75], v2 offset:25600
v_permlane32_swap_b32 v20, v21
v_max_f32 v20, v20, v21
v_sub_f32 v12, v12, v20
v_sub_f32 v13, v13, v20
v_pk_add_f32 v[14:15], v[14:15], v[20:21] op_sel_hi:[1,0] neg_lo:[0,1] neg_hi:[0,1]
v_exp_f32 v12, v12
v_exp_f32 v13, v13
v_exp_f32 v14, v14
v_exp_f32 v15, v15
v_cvt_pk_bf16_f32 v16, v12, v13
v_cvt_pk_bf16_f32 v17, v14, v15
v_pk_fma_f32 v[28:29], v[28:29], s[50:51], v[20:21] op_sel_hi:[1,1,0] neg_lo:[0,0,1] neg_hi:[0,0,1]
v_mov_b32_dpp v18, v16 quad_perm:[2,3,0,1] row_mask:0xf bank_mask:0xf
v_mov_b32_dpp v19, v17 quad_perm:[2,3,0,1] row_mask:0xf bank_mask:0xf
v_exp_f32 v28, v28
s_waitcnt vmcnt(1)
v_mfma_f32_16x16x32_bf16 v[32:35], v[76:79], v[16:19], 0
v_exp_f32 v29, v29
v_mfma_f32_16x16x32_bf16 v[20:23], v[52:55], v[16:19], 0
v_cvt_pk_bf16_f32 v12, v28, v29
v_cvt_pk_bf16_f32 v13, v28, v29
v_mov_b64 v[14:15], s[0:1]
v_mfma_f32_16x16x32_bf16 v[24:27], v[56:59], v[16:19], 0
v_cvt_pk_bf16_f32 v36, v36, v37
v_cvt_pk_bf16_f32 v37, v38, v39
v_mfma_f32_16x16x16_bf16 v[32:35], v[14:15], v[12:13], v[32:35]
v_cvt_pk_bf16_f32 v38, v40, v41
v_cvt_pk_bf16_f32 v39, v42, v43
v_mfma_f32_16x16x16_bf16 v[20:23], v[36:37], v[12:13], v[20:23]
ds_read_b128 v[44:47], v2 offset:20480
v_mfma_f32_16x16x16_bf16 v[24:27], v[38:39], v[12:13], v[24:27]
ds_read_b128 v[48:51], v2 offset:21504
v_rcp_f32 v32, v32
v_mov_b64 v[28:29], 0
v_mov_b64 v[30:31], 0
v_pk_mul_f32 v[20:21], v[20:21], v[32:33] op_sel_hi:[1,0]
v_pk_mul_f32 v[22:23], v[22:23], v[32:33] op_sel_hi:[1,0]
v_cvt_pk_bf16_f32 v20, v20, v21
v_cvt_pk_bf16_f32 v21, v22, v23
ds_write_b64 v1, v[20:21] offset:5120
v_pk_mul_f32 v[24:25], v[24:25], v[32:33] op_sel_hi:[1,0]
v_pk_mul_f32 v[26:27], v[26:27], v[32:33] op_sel_hi:[1,0]
v_cvt_pk_bf16_f32 v24, v24, v25
v_cvt_pk_bf16_f32 v25, v26, v27
ds_write_b64 v1, v[24:25] offset:5128
v_mov_b64 v[76:77], 0
ds_read_b128 v[12:15], v7 offset:5120
v_mov_b64 v[78:79], 0
v_mov_b64 v[40:41], 0
v_mov_b64 v[42:43], 0
v_mov_b64 v[36:37], 0
v_mov_b64 v[38:39], 0
v_mov_b64 v[32:33], 0
v_mov_b64 v[34:35], 0
s_waitcnt lgkmcnt(1)
s_barrier
ds_read_b128 v[16:19], v7 offset:6144
ds_read_b128 v[52:55], v7 offset:7168
ds_read_b128 v[56:59], v7 offset:8192
s_waitcnt lgkmcnt(3)
v_smfmac_f32_16x16x64_bf16 v[28:31], v[12:15], v[44:51], v0 abid:1
v_smfmac_f32_16x16x64_bf16 v[76:79], v[12:15], v[60:67], v0 abid:1
ds_read_b128 v[44:47], v2 offset:26624
s_waitcnt lgkmcnt(3)
v_smfmac_f32_16x16x64_bf16 v[28:31], v[16:19], a[176:183], v0 abid:1
ds_read_b128 v[48:51], v2 offset:27648
s_waitcnt lgkmcnt(3)
v_smfmac_f32_16x16x64_bf16 v[28:31], v[52:55], v[68:75], v0 abid:1
ds_read_b128 v[60:63], v2 offset:28672
s_waitcnt lgkmcnt(3)
v_smfmac_f32_16x16x64_bf16 v[28:31], v[56:59], a[184:191], v0 abid:1
ds_read_b128 v[64:67], v2 offset:29696
v_smfmac_f32_16x16x64_bf16 v[76:79], v[16:19], a[192:199], v0 abid:1
ds_read_b128 v[68:71], v2 offset:30720
s_waitcnt lgkmcnt(3)
v_smfmac_f32_16x16x64_bf16 v[76:79], v[52:55], v[44:51], v0 abid:1
ds_read_b128 v[72:75], v2 offset:31744
v_cvt_pk_bf16_f32 v28, v28, v29
v_cvt_pk_bf16_f32 v29, v30, v31
v_bfi_b32 v28, 1, s35, v28
buffer_store_dwordx2 v[28:29], v8, s[4:7], s42 offen sc0 sc1
v_smfmac_f32_16x16x64_bf16 v[76:79], v[56:59], a[200:207], v0 abid:1
ds_read_b128 v[44:47], v2 offset:32768
s_waitcnt lgkmcnt(3)
v_smfmac_f32_16x16x64_bf16 v[40:43], v[12:15], v[60:67], v0 abid:1
ds_read_b128 v[48:51], v2 offset:33792
v_smfmac_f32_16x16x64_bf16 v[40:43], v[16:19], a[208:215], v0 abid:1
ds_read_b128 v[60:63], v2 offset:34816
v_cvt_pk_bf16_f32 v76, v76, v77
v_cvt_pk_bf16_f32 v77, v78, v79
v_bfi_b32 v76, 1, s35, v76
buffer_store_dwordx2 v[76:77], v8, s[4:7], s43 offen sc0 sc1
s_waitcnt lgkmcnt(3)
v_smfmac_f32_16x16x64_bf16 v[40:43], v[52:55], v[68:75], v0 abid:1
ds_read_b128 v[64:67], v2 offset:35840
v_smfmac_f32_16x16x64_bf16 v[40:43], v[56:59], a[216:223], v0 abid:1
ds_read_b128 v[68:71], v2 offset:36864
s_waitcnt lgkmcnt(3)
v_smfmac_f32_16x16x64_bf16 v[36:39], v[12:15], v[44:51], v0 abid:1
ds_read_b128 v[72:75], v2 offset:37888
v_smfmac_f32_16x16x64_bf16 v[36:39], v[16:19], a[224:231], v0 abid:1
ds_read_b128 v[44:47], v2 offset:38912
v_cvt_pk_bf16_f32 v40, v40, v41
s_waitcnt lgkmcnt(3)
v_smfmac_f32_16x16x64_bf16 v[36:39], v[52:55], v[60:67], v0 abid:1
ds_read_b128 v[48:51], v2 offset:39936
v_cvt_pk_bf16_f32 v41, v42, v43
v_smfmac_f32_16x16x64_bf16 v[36:39], v[56:59], a[232:239], v0 abid:1
v_bfi_b32 v40, 1, s35, v40
buffer_store_dwordx2 v[40:41], v8, s[4:7], s44 offen sc0 sc1
s_waitcnt lgkmcnt(2)
v_smfmac_f32_16x16x64_bf16 v[32:35], v[12:15], v[68:75], v0 abid:1
v_smfmac_f32_16x16x64_bf16 v[32:35], v[16:19], a[240:247], v0 abid:1
v_cvt_pk_bf16_f32 v36, v36, v37
s_waitcnt lgkmcnt(0)
v_smfmac_f32_16x16x64_bf16 v[32:35], v[52:55], v[44:51], v0 abid:1
v_cvt_pk_bf16_f32 v37, v38, v39
v_smfmac_f32_16x16x64_bf16 v[32:35], v[56:59], a[248:255], v0 abid:1
v_bfi_b32 v36, 1, s35, v36
buffer_store_dwordx2 v[36:37], v8, s[4:7], s45 offen sc0 sc1
s_nop 5
v_cvt_pk_bf16_f32 v32, v32, v33
v_cvt_pk_bf16_f32 v33, v34, v35
v_bfi_b32 v32, 1, s35, v32
buffer_store_dwordx2 v[32:33], v8, s[4:7], s46 offen sc0 sc1
s_branch L_ex_w0s
L_done_w0s:
s_waitcnt vmcnt(0) lgkmcnt(0)
s_endpgm
L_ra0_w0s:
s_mov_b32 s38, 1
s_mov_b32 m0, 1024
s_nop 0
buffer_load_dwordx4 v1, s[4:7], s47 offen offset:0 sc0 sc1 lds
buffer_load_dwordx4 v1, s[4:7], s47 offen offset:1024 sc0 sc1 lds
buffer_load_dwordx4 v1, s[4:7], s47 offen offset:2048 sc0 sc1 lds
buffer_load_dwordx4 v1, s[4:7], s47 offen offset:3072 sc0 sc1 lds
s_sub_u32 s41, s41, 1
s_cbranch_scc1 L_exit
ds_read_b128 v[44:47], v2 offset:0
ds_read_b128 v[48:51], v2 offset:1024
v_mov_b64 v[20:21], 0
v_mov_b64 v[22:23], 0
v_mov_b64 v[24:25], 0
v_mov_b64 v[26:27], 0
v_mov_b64 v[28:29], 0
v_mov_b64 v[30:31], 0
v_mov_b64 v[32:33], 0
v_mov_b64 v[34:35], 0
v_mov_b64 v[36:37], 0
v_mov_b64 v[38:39], 0
v_mov_b64 v[40:41], 0
v_mov_b64 v[42:43], 0
s_waitcnt vmcnt(0)
ds_read_b128 v[60:63], v1 offset:1024
ds_read_b128 v[64:67], v1 offset:2048
ds_read_b128 v[68:71], v1 offset:3072
ds_read_b128 v[72:75], v1 offset:4096
s_branch L_s0_w0s
L_ra1_w0s:
s_mov_b32 s38, 1
s_waitcnt lgkmcnt(0)
s_barrier
s_mov_b32 m0, 5120
s_nop 0
buffer_load_dwordx4 v1, s[4:7], s48 offen offset:0 sc0 sc1 lds
s_mov_b32 m0, 9216
s_nop 0
buffer_load_dwordx4 v1, s[4:7], s49 offen offset:0 sc0 sc1 lds
s_sub_u32 s41, s41, 1
s_cbranch_scc1 L_exit
s_waitcnt vmcnt(0)
s_barrier
ds_read_b128 v[76:79], v1 offset:5120
ds_read_b128 v[60:63], v1 offset:6144
ds_read_b128 v[64:67], v1 offset:7168
ds_read_b128 v[68:71], v1 offset:8192
ds_read_b128 v[72:75], v1 offset:9216
s_waitcnt lgkmcnt(0)
v_bitop3_b32 v6, v76, v60, s35 bitop3:0x7e
v_bitop3_b32 v6, v6, v64, s35 bitop3:0xf6
v_bitop3_b32 v6, v6, v68, s35 bitop3:0xf6
v_bitop3_b32 v6, v6, v72, s35 bitop3:0xf6
v_and_b32 v6, 1, v6
v_cmp_ne_u32 vcc, 0, v6
v_lshlrev_b32 v6, 2, v1
s_cbranch_vccnz L_ra1_w0s
s_branch L_a1_w0s
L_ev_w0s:

L_kvw_w0s:
s_load_dwordx16 s[64:79], s[4:5], s101 glc
s_sub_u32 s41, s41, 1
s_cbranch_scc1 L_exit
s_waitcnt lgkmcnt(0)
s_min_u32 s64, s64, s65
s_min_u32 s64, s64, s66
s_min_u32 s64, s64, s67
s_min_u32 s64, s64, s68
s_min_u32 s64, s64, s69
s_min_u32 s64, s64, s70
s_min_u32 s64, s64, s71
s_min_u32 s64, s64, s72
s_min_u32 s64, s64, s73
s_min_u32 s64, s64, s74
s_min_u32 s64, s64, s75
s_min_u32 s64, s64, s76
s_min_u32 s64, s64, s77
s_min_u32 s64, s64, s78
s_min_u32 s64, s64, s79
s_lshl_b32 s100, s64, 2
s_sub_u32 s100, s100, 1
s_cmp_ge_i32 s34, s100
s_cbranch_scc1 L_kvw_w0s
s_branch L_evb_w0s
L_pro_w1:
v_and_b32 v20, 63, v0
v_and_b32 v21, 15, v0
v_bfe_u32 v22, v0, 4, 2
v_lshlrev_b32 v1, 4, v20
v_add_u32 v2, 57344, v1
v_bfe_u32 v23, v20, 3, 1
v_lshlrev_b32 v26, 3, v23
v_bfe_u32 v23, v20, 4, 2
v_lshl_add_u32 v26, v23, 1, v26
v_bfe_u32 v23, v20, 2, 1
v_add_u32 v26, v26, v23
v_lshlrev_b32 v26, 13, v26
v_and_b32 v23, 3, v20
v_lshl_add_u32 v26, v23, 4, v26
v_lshrrev_b32 v24, 2, v20
v_mul_u32_u24 v27, 1152, v24
v_lshl_add_u32 v27, v23, 4, v27
v_lshrrev_b32 v24, 2, v21
v_lshl_add_u32 v25, v22, 3, v24
v_lshlrev_b32 v28, 6, v25
v_lshl_add_u32 v28, v23, 3, v28
v_add_u32 v28, 57344, v28
v_and_b32 v25, 1, v22
v_lshlrev_b32 v29, 10, v25
v_lshrrev_b32 v25, 1, v22
v_lshl_add_u32 v29, v25, 8, v29
v_and_b32 v25, 1, v24
v_lshl_add_u32 v29, v25, 6, v29
v_lshrrev_b32 v25, 1, v24
v_lshl_add_u32 v29, v25, 3, v29
v_lshl_add_u32 v29, v23, 4, v29
v_add_u32 v29, 57344, v29
s_lshl_b32 s54, s32, 8
s_add_u32 s54, s54, 64
s_mul_i32 s55, s32, 147456
s_waitcnt lgkmcnt(0)
s_add_u32 s56, s54, 524288
s_mov_b32 m0, 69632
s_nop 0
buffer_load_dwordx4 v26, s[8:11], s56 offen lds
s_add_u32 s56, s54, 655360
s_mov_b32 m0, 70656
s_nop 0
buffer_load_dwordx4 v26, s[8:11], s56 offen lds
s_add_u32 s56, s54, 786432
s_mov_b32 m0, 71680
s_nop 0
buffer_load_dwordx4 v26, s[8:11], s56 offen lds
s_add_u32 s56, s54, 917504
s_mov_b32 m0, 72704
s_nop 0
buffer_load_dwordx4 v26, s[8:11], s56 offen lds
s_add_u32 s56, s54, 1048576
s_mov_b32 m0, 73728
s_nop 0
buffer_load_dwordx4 v26, s[8:11], s56 offen lds
s_add_u32 s56, s54, 1179648
s_mov_b32 m0, 74752
s_nop 0
buffer_load_dwordx4 v26, s[8:11], s56 offen lds
s_add_u32 s56, s54, 1310720
s_mov_b32 m0, 75776
s_nop 0
buffer_load_dwordx4 v26, s[8:11], s56 offen lds
s_add_u32 s56, s54, 1441792
s_mov_b32 m0, 76800
s_nop 0
buffer_load_dwordx4 v26, s[8:11], s56 offen lds
s_add_u32 s56, s54, 2621440
s_mov_b32 m0, 77824
s_nop 0
buffer_load_dwordx4 v26, s[8:11], s56 offen lds
s_add_u32 s56, s54, 2752512
s_mov_b32 m0, 78848
s_nop 0
buffer_load_dwordx4 v26, s[8:11], s56 offen lds
s_add_u32 s56, s54, 2883584
s_mov_b32 m0, 79872
s_nop 0
buffer_load_dwordx4 v26, s[8:11], s56 offen lds
s_add_u32 s56, s54, 3014656
s_mov_b32 m0, 80896
s_nop 0
buffer_load_dwordx4 v26, s[8:11], s56 offen lds
s_add_u32 s56, s54, 3145728
s_mov_b32 m0, 81920
s_nop 0
buffer_load_dwordx4 v26, s[8:11], s56 offen lds
s_add_u32 s56, s54, 3276800
s_mov_b32 m0, 82944
s_nop 0
buffer_load_dwordx4 v26, s[8:11], s56 offen lds
s_add_u32 s56, s54, 3407872
s_mov_b32 m0, 83968
s_nop 0
buffer_load_dwordx4 v26, s[8:11], s56 offen lds
s_add_u32 s56, s54, 3538944
s_mov_b32 m0, 84992
s_nop 0
buffer_load_dwordx4 v26, s[8:11], s56 offen lds
s_add_u32 s56, s54, 3670016
s_mov_b32 m0, 86016
s_nop 0
buffer_load_dwordx4 v26, s[8:11], s56 offen lds
s_add_u32 s56, s54, 3801088
s_mov_b32 m0, 87040
s_nop 0
buffer_load_dwordx4 v26, s[8:11], s56 offen lds
s_add_u32 s56, s54, 3932160
s_mov_b32 m0, 88064
s_nop 0
buffer_load_dwordx4 v26, s[8:11], s56 offen lds
s_add_u32 s56, s54, 4063232
s_mov_b32 m0, 89088
s_nop 0
buffer_load_dwordx4 v26, s[8:11], s56 offen lds
s_add_u32 s56, s54, 4194304
s_mov_b32 m0, 90112
s_nop 0
buffer_load_dwordx4 v26, s[8:11], s56 offen lds
s_add_u32 s56, s54, 4325376
s_mov_b32 m0, 91136
s_nop 0
buffer_load_dwordx4 v26, s[8:11], s56 offen lds
s_add_u32 s56, s54, 4456448
s_mov_b32 m0, 92160
s_nop 0
buffer_load_dwordx4 v26, s[8:11], s56 offen lds
s_add_u32 s56, s54, 4587520
s_mov_b32 m0, 93184
s_nop 0
buffer_load_dwordx4 v26, s[8:11], s56 offen lds
s_add_u32 s56, s54, 0
s_mov_b32 m0, 94208
s_nop 0
buffer_load_dwordx4 v26, s[12:15], s56 offen lds
s_add_u32 s56, s54, 131072
s_mov_b32 m0, 95232
s_nop 0
buffer_load_dwordx4 v26, s[12:15], s56 offen lds
s_add_u32 s56, s54, 262144
s_mov_b32 m0, 96256
s_nop 0
buffer_load_dwordx4 v26, s[12:15], s56 offen lds
s_add_u32 s56, s54, 393216
s_mov_b32 m0, 97280
s_nop 0
buffer_load_dwordx4 v26, s[12:15], s56 offen lds
s_add_u32 s56, s54, 524288
s_mov_b32 m0, 57344
s_nop 0
buffer_load_dwordx4 v26, s[12:15], s56 offen lds
s_add_u32 s56, s54, 655360
s_mov_b32 m0, 58368
s_nop 0
buffer_load_dwordx4 v26, s[12:15], s56 offen lds
s_add_u32 s56, s54, 786432
s_mov_b32 m0, 59392
s_nop 0
buffer_load_dwordx4 v26, s[12:15], s56 offen lds
s_add_u32 s56, s54, 917504
s_mov_b32 m0, 60416
s_nop 0
buffer_load_dwordx4 v26, s[12:15], s56 offen lds
s_add_u32 s56, s54, 1048576
s_mov_b32 m0, 61440
s_nop 0
buffer_load_dwordx4 v26, s[12:15], s56 offen lds
s_add_u32 s56, s54, 1179648
s_mov_b32 m0, 62464
s_nop 0
buffer_load_dwordx4 v26, s[12:15], s56 offen lds
s_add_u32 s56, s54, 1310720
s_mov_b32 m0, 63488
s_nop 0
buffer_load_dwordx4 v26, s[12:15], s56 offen lds
s_add_u32 s56, s54, 1441792
s_mov_b32 m0, 64512
s_nop 0
buffer_load_dwordx4 v26, s[12:15], s56 offen lds
v_bfe_u32 v23, v21, 1, 1
v_and_b32 v24, 1, v21
v_lshl_add_u32 v23, v24, 16, v23
v_mul_u32_u24 v23, 0xaaaa, v23
v_add_u32 v0, 0x44444444, v23
v_lshlrev_b32 v3, 3, v20
v_lshrrev_b32 v25, 5, v20
v_lshlrev_b32 v25, 6, v25
v_xor_b32 v3, v3, v25
v_lshrrev_b32 v25, 2, v20
v_and_b32 v4, 3, v21
v_lshl_add_u32 v4, v4, 4, v25
v_lshlrev_b32 v4, 3, v4
v_bfe_u32 v25, v21, 1, 1
v_lshlrev_b32 v23, 6, v25
v_xor_b32 v4, v4, v23
v_and_b32 v23, 2, v22
v_xor_b32 v5, v21, v23
v_lshlrev_b32 v5, 4, v5
v_lshl_add_u32 v5, v25, 10, v5
v_and_b32 v23, 1, v22
v_lshl_add_u32 v5, v23, 3, v5
v_lshlrev_b32 v9, 8, v22
v_lshl_add_u32 v9, v25, 6, v9
v_bfe_u32 v23, v21, 3, 1
v_lshl_add_u32 v9, v23, 7, v9
v_bfe_u32 v23, v21, 2, 1
v_lshl_add_u32 v9, v23, 5, v9
v_and_b32 v23, 1, v21
v_lshl_add_u32 v9, v23, 4, v9
v_lshrrev_b32 v23, 1, v22
v_and_b32 v24, 1, v22
v_and_b32 v25, 7, v21
v_lshrrev_b32 v7, 3, v21
v_lshl_add_u32 v8, v7, 1, v23
v_lshlrev_b32 v8, 12, v8
v_lshl_add_u32 v8, v24, 7, v8
v_and_b32 v25, 4, v21
v_lshl_add_u32 v8, v25, 3, v8
v_and_b32 v25, 1, v21
v_lshl_add_u32 v8, v25, 4, v8
v_bfe_u32 v25, v21, 1, 1
v_lshl_add_u32 v8, v25, 3, v8
s_lshr_b32 s56, s32, 1
s_lshl_b32 s56, s56, 8
s_and_b32 s57, s32, 1
s_lshl_b32 s57, s57, 6
s_add_u32 s56, s56, s57
s_add_u32 s56, s56, 16384
v_add_u32 v8, s56, v8
v_and_b32 v7, 12, v21
v_bfe_u32 v25, v21, 1, 1
v_add_u32 v7, v7, v25
v_lshlrev_b32 v7, 4, v7
v_lshl_add_u32 v7, v22, 8, v7
s_mov_b32 s42, 0
s_mov_b32 s43, 65536
s_mov_b32 s44, 131072
s_mov_b32 s45, 196608
s_mov_b32 s46, 262144
s_mov_b32 s47, 294912
s_mov_b32 s48, 299008
s_mov_b32 s49, 303104
s_mov_b32 s50, 0x3e0293ee
s_mov_b32 s51, 0x3e0293ee
s_mov_b32 s52, 0x3f803f80
s_mov_b32 s53, 0x3f803f80
v_and_b32 v11, 3, v21
v_cmp_eq_u32 vcc, 0, v11
s_nop 1
v_cndmask_b32 v11, 0, 1, vcc
s_mov_b32 s34, 0
s_mov_b32 s35, -1
s_mov_b32 s36, 0
s_mov_b32 s41, 2000000
s_lshl_b32 s37, s32, 14
s_add_u32 s39, s37, 17305600
s_add_u32 s37, s37, 16781312
s_mov_b32 s40, 8749056
v_mov_b64 v[36:37], 0
v_mov_b64 v[38:39], 0
s_lshl_b32 s56, s32, 1
s_add_u32 s56, s56, 0
s_cmp_eq_u32 s56, 0
s_cselect_b32 s56, 64, s56
s_mul_i32 s56, s56, 10240
s_add_u32 s56, s56, 8392704
s_add_u32 s57, s56, 4096
v_mov_b32 v40, 0
v_mov_b32 v41, 0
v_mov_b32 v42, 0
v_mov_b32 v43, 0
buffer_store_dwordx4 v[40:43], v1, s[4:7], s56 offen offset:0 sc0 sc1
buffer_store_dwordx4 v[40:43], v1, s[4:7], s56 offen offset:1024 sc0 sc1
buffer_store_dwordx4 v[40:43], v1, s[4:7], s56 offen offset:2048 sc0 sc1
buffer_store_dwordx4 v[40:43], v1, s[4:7], s56 offen offset:3072 sc0 sc1
buffer_store_dwordx4 v[40:43], v1, s[4:7], s57 offen offset:0 sc0 sc1
s_waitcnt vmcnt(0) lgkmcnt(0)
s_barrier
s_getreg_b32 s56, hwreg(HW_REG_XCC_ID)
s_and_b32 s56, s56, 15
s_mul_i32 s57, s56, s56
s_lshl_b32 s57, s57, 18
s_lshl_b32 s56, s56, 8
s_add_u32 s57, s57, s56
s_add_u32 s58, s57, 1
ds_read_b64_tr_b16 v[80:81], v28 offset:12288
ds_read_b64_tr_b16 v[82:83], v28 offset:12544
ds_read_b64_tr_b16 v[84:85], v28 offset:14336
ds_read_b64_tr_b16 v[86:87], v28 offset:14592
ds_read_b64_tr_b16 v[88:89], v28 offset:12320
ds_read_b64_tr_b16 v[90:91], v28 offset:12576
ds_read_b64_tr_b16 v[92:93], v28 offset:14368
ds_read_b64_tr_b16 v[94:95], v28 offset:14624
s_waitcnt lgkmcnt(0)
s_add_u32 s56, s54, 1572864
s_mov_b32 m0, 65536
s_nop 0
buffer_load_dwordx4 v26, s[12:15], s56 offen lds
s_add_u32 s56, s54, 1703936
s_mov_b32 m0, 66560
s_nop 0
buffer_load_dwordx4 v26, s[12:15], s56 offen lds
s_add_u32 s56, s54, 1835008
s_mov_b32 m0, 67584
s_nop 0
buffer_load_dwordx4 v26, s[12:15], s56 offen lds
s_add_u32 s56, s54, 1966080
s_mov_b32 m0, 68608
s_nop 0
buffer_load_dwordx4 v26, s[12:15], s56 offen lds
ds_read_b64_tr_b16 v[96:97], v28 offset:16384
ds_read_b64_tr_b16 v[98:99], v28 offset:16640
ds_read_b64_tr_b16 v[100:101], v28 offset:18432
ds_read_b64_tr_b16 v[102:103], v28 offset:18688
ds_read_b64_tr_b16 v[104:105], v28 offset:16416
ds_read_b64_tr_b16 v[106:107], v28 offset:16672
ds_read_b64_tr_b16 v[108:109], v28 offset:18464
ds_read_b64_tr_b16 v[110:111], v28 offset:18720
s_waitcnt lgkmcnt(0)
s_add_u32 s56, s54, 2097152
s_mov_b32 m0, 69632
s_nop 0
buffer_load_dwordx4 v26, s[12:15], s56 offen lds
s_add_u32 s56, s54, 2228224
s_mov_b32 m0, 70656
s_nop 0
buffer_load_dwordx4 v26, s[12:15], s56 offen lds
s_add_u32 s56, s54, 2359296
s_mov_b32 m0, 71680
s_nop 0
buffer_load_dwordx4 v26, s[12:15], s56 offen lds
s_add_u32 s56, s54, 2490368
s_mov_b32 m0, 72704
s_nop 0
buffer_load_dwordx4 v26, s[12:15], s56 offen lds
ds_read_b64_tr_b16 v[112:113], v28 offset:20480
ds_read_b64_tr_b16 v[114:115], v28 offset:20736
ds_read_b64_tr_b16 v[116:117], v28 offset:22528
ds_read_b64_tr_b16 v[118:119], v28 offset:22784
ds_read_b64_tr_b16 v[120:121], v28 offset:20512
ds_read_b64_tr_b16 v[122:123], v28 offset:20768
ds_read_b64_tr_b16 v[124:125], v28 offset:22560
ds_read_b64_tr_b16 v[126:127], v28 offset:22816
s_waitcnt lgkmcnt(0)
s_add_u32 s56, s54, 3145728
s_mov_b32 m0, 73728
s_nop 0
buffer_load_dwordx4 v26, s[12:15], s56 offen lds
s_add_u32 s56, s54, 3276800
s_mov_b32 m0, 74752
s_nop 0
buffer_load_dwordx4 v26, s[12:15], s56 offen lds
s_add_u32 s56, s54, 3407872
s_mov_b32 m0, 75776
s_nop 0
buffer_load_dwordx4 v26, s[12:15], s56 offen lds
s_add_u32 s56, s54, 3538944
s_mov_b32 m0, 76800
s_nop 0
buffer_load_dwordx4 v26, s[12:15], s56 offen lds
ds_read_b64_tr_b16 v[128:129], v28 offset:24576
ds_read_b64_tr_b16 v[130:131], v28 offset:24832
ds_read_b64_tr_b16 v[132:133], v28 offset:26624
ds_read_b64_tr_b16 v[134:135], v28 offset:26880
ds_read_b64_tr_b16 v[136:137], v28 offset:24608
ds_read_b64_tr_b16 v[138:139], v28 offset:24864
ds_read_b64_tr_b16 v[140:141], v28 offset:26656
ds_read_b64_tr_b16 v[142:143], v28 offset:26912
s_waitcnt lgkmcnt(0)
s_add_u32 s56, s54, 3670016
s_mov_b32 m0, 77824
s_nop 0
buffer_load_dwordx4 v26, s[12:15], s56 offen lds
s_add_u32 s56, s54, 3801088
s_mov_b32 m0, 78848
s_nop 0
buffer_load_dwordx4 v26, s[12:15], s56 offen lds
s_add_u32 s56, s54, 3932160
s_mov_b32 m0, 79872
s_nop 0
buffer_load_dwordx4 v26, s[12:15], s56 offen lds
s_add_u32 s56, s54, 4063232
s_mov_b32 m0, 80896
s_nop 0
buffer_load_dwordx4 v26, s[12:15], s56 offen lds
ds_read_b64_tr_b16 v[144:145], v28 offset:28672
ds_read_b64_tr_b16 v[146:147], v28 offset:28928
ds_read_b64_tr_b16 v[148:149], v28 offset:30720
ds_read_b64_tr_b16 v[150:151], v28 offset:30976
ds_read_b64_tr_b16 v[152:153], v28 offset:28704
ds_read_b64_tr_b16 v[154:155], v28 offset:28960
ds_read_b64_tr_b16 v[156:157], v28 offset:30752
ds_read_b64_tr_b16 v[158:159], v28 offset:31008
s_waitcnt lgkmcnt(0)
s_add_u32 s56, s54, 4194304
s_mov_b32 m0, 81920
s_nop 0
buffer_load_dwordx4 v26, s[12:15], s56 offen lds
s_add_u32 s56, s54, 4325376
s_mov_b32 m0, 82944
s_nop 0
buffer_load_dwordx4 v26, s[12:15], s56 offen lds
s_add_u32 s56, s54, 4456448
s_mov_b32 m0, 83968
s_nop 0
buffer_load_dwordx4 v26, s[12:15], s56 offen lds
s_add_u32 s56, s54, 4587520
s_mov_b32 m0, 84992
s_nop 0
buffer_load_dwordx4 v26, s[12:15], s56 offen lds
ds_read_b64_tr_b16 v[160:161], v28 offset:32768
ds_read_b64_tr_b16 v[162:163], v28 offset:33024
ds_read_b64_tr_b16 v[164:165], v28 offset:34816
ds_read_b64_tr_b16 v[166:167], v28 offset:35072
ds_read_b64_tr_b16 v[168:169], v28 offset:32800
ds_read_b64_tr_b16 v[170:171], v28 offset:33056
ds_read_b64_tr_b16 v[172:173], v28 offset:34848
ds_read_b64_tr_b16 v[174:175], v28 offset:35104
s_waitcnt lgkmcnt(0)
s_add_u32 s56, s54, 0
s_mov_b32 m0, 86016
s_nop 0
buffer_load_dwordx4 v26, s[16:19], s56 offen lds
s_add_u32 s56, s54, 131072
s_mov_b32 m0, 87040
s_nop 0
buffer_load_dwordx4 v26, s[16:19], s56 offen lds
s_add_u32 s56, s54, 262144
s_mov_b32 m0, 88064
s_nop 0
buffer_load_dwordx4 v26, s[16:19], s56 offen lds
s_add_u32 s56, s54, 393216
s_mov_b32 m0, 89088
s_nop 0
buffer_load_dwordx4 v26, s[16:19], s56 offen lds
ds_read_b64_tr_b16 v[176:177], v28 offset:36864
ds_read_b64_tr_b16 v[178:179], v28 offset:37120
ds_read_b64_tr_b16 v[180:181], v28 offset:38912
ds_read_b64_tr_b16 v[182:183], v28 offset:39168
ds_read_b64_tr_b16 v[184:185], v28 offset:36896
ds_read_b64_tr_b16 v[186:187], v28 offset:37152
ds_read_b64_tr_b16 v[188:189], v28 offset:38944
ds_read_b64_tr_b16 v[190:191], v28 offset:39200
s_waitcnt lgkmcnt(0)
s_add_u32 s56, s54, 524288
s_mov_b32 m0, 90112
s_nop 0
buffer_load_dwordx4 v26, s[16:19], s56 offen lds
s_add_u32 s56, s54, 655360
s_mov_b32 m0, 91136
s_nop 0
buffer_load_dwordx4 v26, s[16:19], s56 offen lds
s_add_u32 s56, s54, 786432
s_mov_b32 m0, 92160
s_nop 0
buffer_load_dwordx4 v26, s[16:19], s56 offen lds
s_add_u32 s56, s54, 917504
s_mov_b32 m0, 93184
s_nop 0
buffer_load_dwordx4 v26, s[16:19], s56 offen lds
ds_read_b64_tr_b16 v[192:193], v28 offset:0
ds_read_b64_tr_b16 v[194:195], v28 offset:256
ds_read_b64_tr_b16 v[196:197], v28 offset:2048
ds_read_b64_tr_b16 v[198:199], v28 offset:2304
ds_read_b64_tr_b16 v[200:201], v28 offset:32
ds_read_b64_tr_b16 v[202:203], v28 offset:288
ds_read_b64_tr_b16 v[204:205], v28 offset:2080
ds_read_b64_tr_b16 v[206:207], v28 offset:2336
s_waitcnt lgkmcnt(0)
s_add_u32 s56, s54, 1048576
s_mov_b32 m0, 94208
s_nop 0
buffer_load_dwordx4 v26, s[16:19], s56 offen lds
s_add_u32 s56, s54, 1179648
s_mov_b32 m0, 95232
s_nop 0
buffer_load_dwordx4 v26, s[16:19], s56 offen lds
s_add_u32 s56, s54, 1310720
s_mov_b32 m0, 96256
s_nop 0
buffer_load_dwordx4 v26, s[16:19], s56 offen lds
s_add_u32 s56, s54, 1441792
s_mov_b32 m0, 97280
s_nop 0
buffer_load_dwordx4 v26, s[16:19], s56 offen lds
ds_read_b64_tr_b16 v[208:209], v28 offset:4096
ds_read_b64_tr_b16 v[210:211], v28 offset:4352
ds_read_b64_tr_b16 v[212:213], v28 offset:6144
ds_read_b64_tr_b16 v[214:215], v28 offset:6400
ds_read_b64_tr_b16 v[216:217], v28 offset:4128
ds_read_b64_tr_b16 v[218:219], v28 offset:4384
ds_read_b64_tr_b16 v[220:221], v28 offset:6176
ds_read_b64_tr_b16 v[222:223], v28 offset:6432
s_waitcnt lgkmcnt(0)
s_add_u32 s56, s54, 1572864
s_mov_b32 m0, 57344
s_nop 0
buffer_load_dwordx4 v26, s[16:19], s56 offen lds
s_add_u32 s56, s54, 1703936
s_mov_b32 m0, 58368
s_nop 0
buffer_load_dwordx4 v26, s[16:19], s56 offen lds
s_add_u32 s56, s54, 1835008
s_mov_b32 m0, 59392
s_nop 0
buffer_load_dwordx4 v26, s[16:19], s56 offen lds
s_add_u32 s56, s54, 1966080
s_mov_b32 m0, 60416
s_nop 0
buffer_load_dwordx4 v26, s[16:19], s56 offen lds
s_waitcnt vmcnt(32)
ds_read_b64_tr_b16 v[224:225], v28 offset:8192
ds_read_b64_tr_b16 v[226:227], v28 offset:8448
ds_read_b64_tr_b16 v[228:229], v28 offset:10240
ds_read_b64_tr_b16 v[230:231], v28 offset:10496
ds_read_b64_tr_b16 v[232:233], v28 offset:8224
ds_read_b64_tr_b16 v[234:235], v28 offset:8480
ds_read_b64_tr_b16 v[236:237], v28 offset:10272
ds_read_b64_tr_b16 v[238:239], v28 offset:10528
s_waitcnt lgkmcnt(0)
s_add_u32 s56, s54, 2097152
s_mov_b32 m0, 61440
s_nop 0
buffer_load_dwordx4 v26, s[16:19], s56 offen lds
s_add_u32 s56, s54, 2228224
s_mov_b32 m0, 62464
s_nop 0
buffer_load_dwordx4 v26, s[16:19], s56 offen lds
s_add_u32 s56, s54, 2359296
s_mov_b32 m0, 63488
s_nop 0
buffer_load_dwordx4 v26, s[16:19], s56 offen lds
s_add_u32 s56, s54, 2490368
s_mov_b32 m0, 64512
s_nop 0
buffer_load_dwordx4 v26, s[16:19], s56 offen lds
s_waitcnt vmcnt(32)
ds_read_b64_tr_b16 v[240:241], v28 offset:12288
ds_read_b64_tr_b16 v[242:243], v28 offset:12544
ds_read_b64_tr_b16 v[244:245], v28 offset:14336
ds_read_b64_tr_b16 v[246:247], v28 offset:14592
ds_read_b64_tr_b16 v[248:249], v28 offset:12320
ds_read_b64_tr_b16 v[250:251], v28 offset:12576
ds_read_b64_tr_b16 v[252:253], v28 offset:14368
ds_read_b64_tr_b16 v[254:255], v28 offset:14624
s_waitcnt lgkmcnt(0)
s_add_u32 s56, s54, 2621440
s_mov_b32 m0, 65536
s_nop 0
buffer_load_dwordx4 v26, s[16:19], s56 offen lds
s_add_u32 s56, s54, 2752512
s_mov_b32 m0, 66560
s_nop 0
buffer_load_dwordx4 v26, s[16:19], s56 offen lds
s_add_u32 s56, s54, 2883584
s_mov_b32 m0, 67584
s_nop 0
buffer_load_dwordx4 v26, s[16:19], s56 offen lds
s_add_u32 s56, s54, 3014656
s_mov_b32 m0, 68608
s_nop 0
buffer_load_dwordx4 v26, s[16:19], s56 offen lds
s_waitcnt vmcnt(32)
ds_read_b64_tr_b16 a[0:1], v28 offset:16384
ds_read_b64_tr_b16 a[2:3], v28 offset:16640
ds_read_b64_tr_b16 a[4:5], v28 offset:18432
ds_read_b64_tr_b16 a[6:7], v28 offset:18688
ds_read_b64_tr_b16 a[8:9], v28 offset:16416
ds_read_b64_tr_b16 a[10:11], v28 offset:16672
ds_read_b64_tr_b16 a[12:13], v28 offset:18464
ds_read_b64_tr_b16 a[14:15], v28 offset:18720
s_waitcnt lgkmcnt(0)
s_add_u32 s56, s54, 3145728
s_mov_b32 m0, 69632
s_nop 0
buffer_load_dwordx4 v26, s[16:19], s56 offen lds
s_add_u32 s56, s54, 3276800
s_mov_b32 m0, 70656
s_nop 0
buffer_load_dwordx4 v26, s[16:19], s56 offen lds
s_add_u32 s56, s54, 3407872
s_mov_b32 m0, 71680
s_nop 0
buffer_load_dwordx4 v26, s[16:19], s56 offen lds
s_add_u32 s56, s54, 3538944
s_mov_b32 m0, 72704
s_nop 0
buffer_load_dwordx4 v26, s[16:19], s56 offen lds
s_waitcnt vmcnt(32)
ds_read_b64_tr_b16 a[16:17], v28 offset:20480
ds_read_b64_tr_b16 a[18:19], v28 offset:20736
ds_read_b64_tr_b16 a[20:21], v28 offset:22528
ds_read_b64_tr_b16 a[22:23], v28 offset:22784
ds_read_b64_tr_b16 a[24:25], v28 offset:20512
ds_read_b64_tr_b16 a[26:27], v28 offset:20768
ds_read_b64_tr_b16 a[28:29], v28 offset:22560
ds_read_b64_tr_b16 a[30:31], v28 offset:22816
s_waitcnt lgkmcnt(0)
s_add_u32 s56, s54, 3670016
s_mov_b32 m0, 73728
s_nop 0
buffer_load_dwordx4 v26, s[16:19], s56 offen lds
s_add_u32 s56, s54, 3801088
s_mov_b32 m0, 74752
s_nop 0
buffer_load_dwordx4 v26, s[16:19], s56 offen lds
s_add_u32 s56, s54, 3932160
s_mov_b32 m0, 75776
s_nop 0
buffer_load_dwordx4 v26, s[16:19], s56 offen lds
s_add_u32 s56, s54, 4063232
s_mov_b32 m0, 76800
s_nop 0
buffer_load_dwordx4 v26, s[16:19], s56 offen lds
s_waitcnt vmcnt(32)
ds_read_b64_tr_b16 a[32:33], v28 offset:24576
ds_read_b64_tr_b16 a[34:35], v28 offset:24832
ds_read_b64_tr_b16 a[36:37], v28 offset:26624
ds_read_b64_tr_b16 a[38:39], v28 offset:26880
ds_read_b64_tr_b16 a[40:41], v28 offset:24608
ds_read_b64_tr_b16 a[42:43], v28 offset:24864
ds_read_b64_tr_b16 a[44:45], v28 offset:26656
ds_read_b64_tr_b16 a[46:47], v28 offset:26912
s_waitcnt lgkmcnt(0)
s_add_u32 s56, s55, 73792
s_mov_b32 m0, 77824
s_nop 0
buffer_load_dwordx4 v27, s[20:23], s56 offen lds
s_add_u32 s56, s55, 92224
s_mov_b32 m0, 78848
s_nop 0
buffer_load_dwordx4 v27, s[20:23], s56 offen lds
s_add_u32 s56, s55, 64
s_mov_b32 m0, 79872
s_nop 0
buffer_load_dwordx4 v27, s[20:23], s56 offen lds
s_add_u32 s56, s55, 18496
s_mov_b32 m0, 80896
s_nop 0
buffer_load_dwordx4 v27, s[20:23], s56 offen lds
s_waitcnt vmcnt(32)
ds_read_b64_tr_b16 a[48:49], v28 offset:28672
ds_read_b64_tr_b16 a[50:51], v28 offset:28928
ds_read_b64_tr_b16 a[52:53], v28 offset:30720
ds_read_b64_tr_b16 a[54:55], v28 offset:30976
ds_read_b64_tr_b16 a[56:57], v28 offset:28704
ds_read_b64_tr_b16 a[58:59], v28 offset:28960
ds_read_b64_tr_b16 a[60:61], v28 offset:30752
ds_read_b64_tr_b16 a[62:63], v28 offset:31008
s_waitcnt lgkmcnt(0)
s_add_u32 s56, s55, 74048
s_mov_b32 m0, 81920
s_nop 0
buffer_load_dwordx4 v27, s[20:23], s56 offen lds
s_add_u32 s56, s55, 92480
s_mov_b32 m0, 82944
s_nop 0
buffer_load_dwordx4 v27, s[20:23], s56 offen lds
s_add_u32 s56, s55, 320
s_mov_b32 m0, 83968
s_nop 0
buffer_load_dwordx4 v27, s[20:23], s56 offen lds
s_add_u32 s56, s55, 18752
s_mov_b32 m0, 84992
s_nop 0
buffer_load_dwordx4 v27, s[20:23], s56 offen lds
s_waitcnt vmcnt(32)
ds_read_b64_tr_b16 a[64:65], v28 offset:32768
ds_read_b64_tr_b16 a[66:67], v28 offset:33024
ds_read_b64_tr_b16 a[68:69], v28 offset:34816
ds_read_b64_tr_b16 a[70:71], v28 offset:35072
ds_read_b64_tr_b16 a[72:73], v28 offset:32800
ds_read_b64_tr_b16 a[74:75], v28 offset:33056
ds_read_b64_tr_b16 a[76:77], v28 offset:34848
ds_read_b64_tr_b16 a[78:79], v28 offset:35104
s_waitcnt lgkmcnt(0)
s_add_u32 s56, s55, 74304
s_mov_b32 m0, 86016
s_nop 0
buffer_load_dwordx4 v27, s[20:23], s56 offen lds
s_add_u32 s56, s55, 92736
s_mov_b32 m0, 87040
s_nop 0
buffer_load_dwordx4 v27, s[20:23], s56 offen lds
s_add_u32 s56, s55, 576
s_mov_b32 m0, 88064
s_nop 0
buffer_load_dwordx4 v27, s[20:23], s56 offen lds
s_add_u32 s56, s55, 19008
s_mov_b32 m0, 89088
s_nop 0
buffer_load_dwordx4 v27, s[20:23], s56 offen lds
s_waitcnt vmcnt(32)
ds_read_b64_tr_b16 a[80:81], v28 offset:36864
ds_read_b64_tr_b16 a[82:83], v28 offset:37120
ds_read_b64_tr_b16 a[84:85], v28 offset:38912
ds_read_b64_tr_b16 a[86:87], v28 offset:39168
ds_read_b64_tr_b16 a[88:89], v28 offset:36896
ds_read_b64_tr_b16 a[90:91], v28 offset:37152
ds_read_b64_tr_b16 a[92:93], v28 offset:38944
ds_read_b64_tr_b16 a[94:95], v28 offset:39200
s_waitcnt lgkmcnt(0)
s_add_u32 s56, s55, 74560
s_mov_b32 m0, 90112
s_nop 0
buffer_load_dwordx4 v27, s[20:23], s56 offen lds
s_add_u32 s56, s55, 92992
s_mov_b32 m0, 91136
s_nop 0
buffer_load_dwordx4 v27, s[20:23], s56 offen lds
s_add_u32 s56, s55, 832
s_mov_b32 m0, 92160
s_nop 0
buffer_load_dwordx4 v27, s[20:23], s56 offen lds
s_add_u32 s56, s55, 19264
s_mov_b32 m0, 93184
s_nop 0
buffer_load_dwordx4 v27, s[20:23], s56 offen lds
s_waitcnt vmcnt(32)
ds_read_b64_tr_b16 a[96:97], v28 offset:0
ds_read_b64_tr_b16 a[98:99], v28 offset:256
ds_read_b64_tr_b16 a[100:101], v28 offset:2048
ds_read_b64_tr_b16 a[102:103], v28 offset:2304
ds_read_b64_tr_b16 a[104:105], v28 offset:32
ds_read_b64_tr_b16 a[106:107], v28 offset:288
ds_read_b64_tr_b16 a[108:109], v28 offset:2080
ds_read_b64_tr_b16 a[110:111], v28 offset:2336
s_waitcnt lgkmcnt(0)
s_add_u32 s56, s55, 74816
s_mov_b32 m0, 94208
s_nop 0
buffer_load_dwordx4 v27, s[20:23], s56 offen lds
s_add_u32 s56, s55, 93248
s_mov_b32 m0, 95232
s_nop 0
buffer_load_dwordx4 v27, s[20:23], s56 offen lds
s_add_u32 s56, s55, 1088
s_mov_b32 m0, 96256
s_nop 0
buffer_load_dwordx4 v27, s[20:23], s56 offen lds
s_add_u32 s56, s55, 19520
s_mov_b32 m0, 97280
s_nop 0
buffer_load_dwordx4 v27, s[20:23], s56 offen lds
s_waitcnt vmcnt(32)
ds_read_b64_tr_b16 a[112:113], v28 offset:4096
ds_read_b64_tr_b16 a[114:115], v28 offset:4352
ds_read_b64_tr_b16 a[116:117], v28 offset:6144
ds_read_b64_tr_b16 a[118:119], v28 offset:6400
ds_read_b64_tr_b16 a[120:121], v28 offset:4128
ds_read_b64_tr_b16 a[122:123], v28 offset:4384
ds_read_b64_tr_b16 a[124:125], v28 offset:6176
ds_read_b64_tr_b16 a[126:127], v28 offset:6432
s_waitcnt lgkmcnt(0)
s_add_u32 s56, s54, 0
s_mov_b32 m0, 57344
s_nop 0
buffer_load_dwordx4 v26, s[8:11], s56 offen lds
s_add_u32 s56, s54, 131072
s_mov_b32 m0, 58368
s_nop 0
buffer_load_dwordx4 v26, s[8:11], s56 offen lds
s_add_u32 s56, s54, 262144
s_mov_b32 m0, 59392
s_nop 0
buffer_load_dwordx4 v26, s[8:11], s56 offen lds
s_add_u32 s56, s54, 393216
s_mov_b32 m0, 60416
s_nop 0
buffer_load_dwordx4 v26, s[8:11], s56 offen lds
s_waitcnt vmcnt(32)
ds_read_b64_tr_b16 a[128:129], v28 offset:8192
ds_read_b64_tr_b16 a[130:131], v28 offset:8448
ds_read_b64_tr_b16 a[132:133], v28 offset:10240
ds_read_b64_tr_b16 a[134:135], v28 offset:10496
ds_read_b64_tr_b16 a[136:137], v28 offset:8224
ds_read_b64_tr_b16 a[138:139], v28 offset:8480
ds_read_b64_tr_b16 a[140:141], v28 offset:10272
ds_read_b64_tr_b16 a[142:143], v28 offset:10528
s_waitcnt lgkmcnt(0)
s_add_u32 s56, s54, 1572864
s_mov_b32 m0, 61440
s_nop 0
buffer_load_dwordx4 v26, s[8:11], s56 offen lds
s_add_u32 s56, s54, 1703936
s_mov_b32 m0, 62464
s_nop 0
buffer_load_dwordx4 v26, s[8:11], s56 offen lds
s_add_u32 s56, s54, 1835008
s_mov_b32 m0, 63488
s_nop 0
buffer_load_dwordx4 v26, s[8:11], s56 offen lds
s_add_u32 s56, s54, 1966080
s_mov_b32 m0, 64512
s_nop 0
buffer_load_dwordx4 v26, s[8:11], s56 offen lds
s_waitcnt vmcnt(32)
ds_read_b64_tr_b16 a[144:145], v28 offset:12288
ds_read_b64_tr_b16 a[146:147], v28 offset:12544
ds_read_b64_tr_b16 a[148:149], v28 offset:14336
ds_read_b64_tr_b16 a[150:151], v28 offset:14592
ds_read_b64_tr_b16 a[152:153], v28 offset:12320
ds_read_b64_tr_b16 a[154:155], v28 offset:12576
ds_read_b64_tr_b16 a[156:157], v28 offset:14368
ds_read_b64_tr_b16 a[158:159], v28 offset:14624
s_waitcnt lgkmcnt(0)
s_add_u32 s56, s54, 2097152
s_mov_b32 m0, 65536
s_nop 0
buffer_load_dwordx4 v26, s[8:11], s56 offen lds
s_add_u32 s56, s54, 2228224
s_mov_b32 m0, 66560
s_nop 0
buffer_load_dwordx4 v26, s[8:11], s56 offen lds
s_add_u32 s56, s54, 2359296
s_mov_b32 m0, 67584
s_nop 0
buffer_load_dwordx4 v26, s[8:11], s56 offen lds
s_add_u32 s56, s54, 2490368
s_mov_b32 m0, 68608
s_nop 0
buffer_load_dwordx4 v26, s[8:11], s56 offen lds
s_waitcnt vmcnt(32)
ds_read_b64_tr_b16 a[160:161], v28 offset:16384
ds_read_b64_tr_b16 a[162:163], v28 offset:16640
ds_read_b64_tr_b16 a[164:165], v28 offset:18432
ds_read_b64_tr_b16 a[166:167], v28 offset:18688
ds_read_b64_tr_b16 a[168:169], v28 offset:16416
ds_read_b64_tr_b16 a[170:171], v28 offset:16672
ds_read_b64_tr_b16 a[172:173], v28 offset:18464
ds_read_b64_tr_b16 a[174:175], v28 offset:18720
s_waitcnt lgkmcnt(0)
s_add_u32 s56, s54, 2621440
s_mov_b32 m0, 69632
s_nop 0
buffer_load_dwordx4 v26, s[12:15], s56 offen lds
s_add_u32 s56, s54, 2752512
s_mov_b32 m0, 70656
s_nop 0
buffer_load_dwordx4 v26, s[12:15], s56 offen lds
s_add_u32 s56, s54, 2883584
s_mov_b32 m0, 71680
s_nop 0
buffer_load_dwordx4 v26, s[12:15], s56 offen lds
s_add_u32 s56, s54, 3014656
s_mov_b32 m0, 72704
s_nop 0
buffer_load_dwordx4 v26, s[12:15], s56 offen lds
s_waitcnt vmcnt(32)
ds_read_b64_tr_b16 a[176:177], v29 offset:20480
ds_read_b64_tr_b16 a[178:179], v29 offset:20608
ds_read_b64_tr_b16 a[180:181], v29 offset:20992
ds_read_b64_tr_b16 a[182:183], v29 offset:21120
ds_read_b64_tr_b16 a[184:185], v29 offset:22528
ds_read_b64_tr_b16 a[186:187], v29 offset:22656
ds_read_b64_tr_b16 a[188:189], v29 offset:23040
ds_read_b64_tr_b16 a[190:191], v29 offset:23168
s_waitcnt lgkmcnt(0)
s_add_u32 s56, s54, 4194304
s_mov_b32 m0, 73728
s_nop 0
buffer_load_dwordx4 v26, s[16:19], s56 offen lds
s_add_u32 s56, s54, 4325376
s_mov_b32 m0, 74752
s_nop 0
buffer_load_dwordx4 v26, s[16:19], s56 offen lds
s_add_u32 s56, s54, 4456448
s_mov_b32 m0, 75776
s_nop 0
buffer_load_dwordx4 v26, s[16:19], s56 offen lds
s_add_u32 s56, s54, 4587520
s_mov_b32 m0, 76800
s_nop 0
buffer_load_dwordx4 v26, s[16:19], s56 offen lds
s_waitcnt vmcnt(32)
ds_read_b64_tr_b16 a[192:193], v29 offset:24576
ds_read_b64_tr_b16 a[194:195], v29 offset:24704
ds_read_b64_tr_b16 a[196:197], v29 offset:25088
ds_read_b64_tr_b16 a[198:199], v29 offset:25216
ds_read_b64_tr_b16 a[200:201], v29 offset:26624
ds_read_b64_tr_b16 a[202:203], v29 offset:26752
ds_read_b64_tr_b16 a[204:205], v29 offset:27136
ds_read_b64_tr_b16 a[206:207], v29 offset:27264
s_waitcnt lgkmcnt(0)
s_add_u32 s56, s55, 36928
s_mov_b32 m0, 77824
s_nop 0
buffer_load_dwordx4 v27, s[20:23], s56 offen lds
s_add_u32 s56, s55, 55360
s_mov_b32 m0, 78848
s_nop 0
buffer_load_dwordx4 v27, s[20:23], s56 offen lds
s_add_u32 s56, s55, 37184
s_mov_b32 m0, 79872
s_nop 0
buffer_load_dwordx4 v27, s[20:23], s56 offen lds
s_add_u32 s56, s55, 55616
s_mov_b32 m0, 80896
s_nop 0
buffer_load_dwordx4 v27, s[20:23], s56 offen lds
s_waitcnt vmcnt(32)
ds_read_b64_tr_b16 a[208:209], v29 offset:28672
ds_read_b64_tr_b16 a[210:211], v29 offset:28800
ds_read_b64_tr_b16 a[212:213], v29 offset:29184
ds_read_b64_tr_b16 a[214:215], v29 offset:29312
ds_read_b64_tr_b16 a[216:217], v29 offset:30720
ds_read_b64_tr_b16 a[218:219], v29 offset:30848
ds_read_b64_tr_b16 a[220:221], v29 offset:31232
ds_read_b64_tr_b16 a[222:223], v29 offset:31360
s_waitcnt lgkmcnt(0)
s_add_u32 s56, s55, 110656
s_mov_b32 m0, 81920
s_nop 0
buffer_load_dwordx4 v27, s[20:23], s56 offen lds
s_add_u32 s56, s55, 129088
s_mov_b32 m0, 82944
s_nop 0
buffer_load_dwordx4 v27, s[20:23], s56 offen lds
s_add_u32 s56, s55, 110912
s_mov_b32 m0, 83968
s_nop 0
buffer_load_dwordx4 v27, s[20:23], s56 offen lds
s_add_u32 s56, s55, 129344
s_mov_b32 m0, 84992
s_nop 0
buffer_load_dwordx4 v27, s[20:23], s56 offen lds
s_waitcnt vmcnt(32)
ds_read_b64_tr_b16 a[224:225], v29 offset:32768
ds_read_b64_tr_b16 a[226:227], v29 offset:32896
ds_read_b64_tr_b16 a[228:229], v29 offset:33280
ds_read_b64_tr_b16 a[230:231], v29 offset:33408
ds_read_b64_tr_b16 a[232:233], v29 offset:34816
ds_read_b64_tr_b16 a[234:235], v29 offset:34944
ds_read_b64_tr_b16 a[236:237], v29 offset:35328
ds_read_b64_tr_b16 a[238:239], v29 offset:35456
s_waitcnt lgkmcnt(0)
s_add_u32 s56, s55, 37440
s_mov_b32 m0, 86016
s_nop 0
buffer_load_dwordx4 v27, s[20:23], s56 offen lds
s_add_u32 s56, s55, 55872
s_mov_b32 m0, 87040
s_nop 0
buffer_load_dwordx4 v27, s[20:23], s56 offen lds
s_add_u32 s56, s55, 111168
s_mov_b32 m0, 88064
s_nop 0
buffer_load_dwordx4 v27, s[20:23], s56 offen lds
s_add_u32 s56, s55, 129600
s_mov_b32 m0, 89088
s_nop 0
buffer_load_dwordx4 v27, s[20:23], s56 offen lds
s_waitcnt vmcnt(32)
ds_read_b64_tr_b16 a[240:241], v29 offset:36864
ds_read_b64_tr_b16 a[242:243], v29 offset:36992
ds_read_b64_tr_b16 a[244:245], v29 offset:37376
ds_read_b64_tr_b16 a[246:247], v29 offset:37504
ds_read_b64_tr_b16 a[248:249], v29 offset:38912
ds_read_b64_tr_b16 a[250:251], v29 offset:39040
ds_read_b64_tr_b16 a[252:253], v29 offset:39424
ds_read_b64_tr_b16 a[254:255], v29 offset:39552
s_waitcnt lgkmcnt(0)
s_add_u32 s56, s55, 37696
s_mov_b32 m0, 90112
s_nop 0
buffer_load_dwordx4 v27, s[20:23], s56 offen lds
s_add_u32 s56, s55, 56128
s_mov_b32 m0, 91136
s_nop 0
buffer_load_dwordx4 v27, s[20:23], s56 offen lds
s_add_u32 s56, s55, 111424
s_mov_b32 m0, 92160
s_nop 0
buffer_load_dwordx4 v27, s[20:23], s56 offen lds
s_add_u32 s56, s55, 129856
s_mov_b32 m0, 93184
s_nop 0
buffer_load_dwordx4 v27, s[20:23], s56 offen lds
s_waitcnt vmcnt(32)
ds_read_b64_tr_b16 v[44:45], v28 offset:0
ds_read_b64_tr_b16 v[46:47], v28 offset:256
ds_read_b64_tr_b16 v[48:49], v28 offset:2048
ds_read_b64_tr_b16 v[50:51], v28 offset:2304
ds_read_b64_tr_b16 v[52:53], v28 offset:32
ds_read_b64_tr_b16 v[54:55], v28 offset:288
ds_read_b64_tr_b16 v[56:57], v28 offset:2080
ds_read_b64_tr_b16 v[58:59], v28 offset:2336
s_waitcnt lgkmcnt(0)
ds_write_b128 v2, v[44:47] offset:0
ds_write_b128 v2, v[48:51] offset:1024
ds_write_b128 v2, v[52:55] offset:2048
ds_write_b128 v2, v[56:59] offset:3072
s_waitcnt lgkmcnt(0)
s_add_u32 s56, s55, 37952
s_mov_b32 m0, 94208
s_nop 0
buffer_load_dwordx4 v27, s[20:23], s56 offen lds
s_add_u32 s56, s55, 56384
s_mov_b32 m0, 95232
s_nop 0
buffer_load_dwordx4 v27, s[20:23], s56 offen lds
s_add_u32 s56, s55, 111680
s_mov_b32 m0, 96256
s_nop 0
buffer_load_dwordx4 v27, s[20:23], s56 offen lds
s_add_u32 s56, s55, 130112
s_mov_b32 m0, 97280
s_nop 0
buffer_load_dwordx4 v27, s[20:23], s56 offen lds
s_waitcnt vmcnt(32)
ds_read_b64_tr_b16 v[44:45], v28 offset:4096
ds_read_b64_tr_b16 v[46:47], v28 offset:4352
ds_read_b64_tr_b16 v[48:49], v28 offset:6144
ds_read_b64_tr_b16 v[50:51], v28 offset:6400
ds_read_b64_tr_b16 v[52:53], v28 offset:4128
ds_read_b64_tr_b16 v[54:55], v28 offset:4384
ds_read_b64_tr_b16 v[56:57], v28 offset:6176
ds_read_b64_tr_b16 v[58:59], v28 offset:6432
s_waitcnt lgkmcnt(0)
ds_write_b128 v2, v[44:47] offset:4096
ds_write_b128 v2, v[48:51] offset:5120
ds_write_b128 v2, v[52:55] offset:6144
ds_write_b128 v2, v[56:59] offset:7168
s_waitcnt lgkmcnt(0)
s_waitcnt vmcnt(28)
ds_read_b64_tr_b16 v[44:45], v28 offset:8192
ds_read_b64_tr_b16 v[46:47], v28 offset:8448
ds_read_b64_tr_b16 v[48:49], v28 offset:10240
ds_read_b64_tr_b16 v[50:51], v28 offset:10496
ds_read_b64_tr_b16 v[52:53], v28 offset:8224
ds_read_b64_tr_b16 v[54:55], v28 offset:8480
ds_read_b64_tr_b16 v[56:57], v28 offset:10272
ds_read_b64_tr_b16 v[58:59], v28 offset:10528
s_waitcnt lgkmcnt(0)
ds_write_b128 v2, v[44:47] offset:8192
ds_write_b128 v2, v[48:51] offset:9216
ds_write_b128 v2, v[52:55] offset:10240
ds_write_b128 v2, v[56:59] offset:11264
s_waitcnt lgkmcnt(0)
s_waitcnt vmcnt(24)
ds_read_b64_tr_b16 v[44:45], v28 offset:12288
ds_read_b64_tr_b16 v[46:47], v28 offset:12544
ds_read_b64_tr_b16 v[48:49], v28 offset:14336
ds_read_b64_tr_b16 v[50:51], v28 offset:14592
ds_read_b64_tr_b16 v[52:53], v28 offset:12320
ds_read_b64_tr_b16 v[54:55], v28 offset:12576
ds_read_b64_tr_b16 v[56:57], v28 offset:14368
ds_read_b64_tr_b16 v[58:59], v28 offset:14624
s_waitcnt lgkmcnt(0)
ds_write_b128 v2, v[44:47] offset:12288
ds_write_b128 v2, v[48:51] offset:13312
ds_write_b128 v2, v[52:55] offset:14336
ds_write_b128 v2, v[56:59] offset:15360
s_waitcnt lgkmcnt(0)
s_waitcnt vmcnt(20)
ds_read_b64_tr_b16 v[44:45], v28 offset:16384
ds_read_b64_tr_b16 v[46:47], v28 offset:16640
ds_read_b64_tr_b16 v[48:49], v28 offset:18432
ds_read_b64_tr_b16 v[50:51], v28 offset:18688
ds_read_b64_tr_b16 v[52:53], v28 offset:16416
ds_read_b64_tr_b16 v[54:55], v28 offset:16672
ds_read_b64_tr_b16 v[56:57], v28 offset:18464
ds_read_b64_tr_b16 v[58:59], v28 offset:18720
s_waitcnt lgkmcnt(0)
ds_write_b128 v2, v[44:47] offset:16384
ds_write_b128 v2, v[48:51] offset:17408
ds_write_b128 v2, v[52:55] offset:18432
ds_write_b128 v2, v[56:59] offset:19456
s_waitcnt lgkmcnt(0)
s_waitcnt vmcnt(16)
ds_read_b64_tr_b16 v[44:45], v29 offset:20480
ds_read_b64_tr_b16 v[46:47], v29 offset:20608
ds_read_b64_tr_b16 v[48:49], v29 offset:20992
ds_read_b64_tr_b16 v[50:51], v29 offset:21120
ds_read_b64_tr_b16 v[52:53], v29 offset:22528
ds_read_b64_tr_b16 v[54:55], v29 offset:22656
ds_read_b64_tr_b16 v[56:57], v29 offset:23040
ds_read_b64_tr_b16 v[58:59], v29 offset:23168
s_waitcnt lgkmcnt(0)
ds_write_b128 v2, v[44:47] offset:20480
ds_write_b128 v2, v[48:51] offset:21504
ds_write_b128 v2, v[52:55] offset:22528
ds_write_b128 v2, v[56:59] offset:23552
s_waitcnt lgkmcnt(0)
s_waitcnt vmcnt(12)
ds_read_b64_tr_b16 v[44:45], v29 offset:24576
ds_read_b64_tr_b16 v[46:47], v29 offset:24704
ds_read_b64_tr_b16 v[48:49], v29 offset:25088
ds_read_b64_tr_b16 v[50:51], v29 offset:25216
ds_read_b64_tr_b16 v[52:53], v29 offset:26624
ds_read_b64_tr_b16 v[54:55], v29 offset:26752
ds_read_b64_tr_b16 v[56:57], v29 offset:27136
ds_read_b64_tr_b16 v[58:59], v29 offset:27264
s_waitcnt lgkmcnt(0)
ds_write_b128 v2, v[44:47] offset:24576
ds_write_b128 v2, v[48:51] offset:25600
ds_write_b128 v2, v[52:55] offset:26624
ds_write_b128 v2, v[56:59] offset:27648
s_waitcnt lgkmcnt(0)
s_waitcnt vmcnt(8)
ds_read_b64_tr_b16 v[44:45], v29 offset:28672
ds_read_b64_tr_b16 v[46:47], v29 offset:28800
ds_read_b64_tr_b16 v[48:49], v29 offset:29184
ds_read_b64_tr_b16 v[50:51], v29 offset:29312
ds_read_b64_tr_b16 v[52:53], v29 offset:30720
ds_read_b64_tr_b16 v[54:55], v29 offset:30848
ds_read_b64_tr_b16 v[56:57], v29 offset:31232
ds_read_b64_tr_b16 v[58:59], v29 offset:31360
s_waitcnt lgkmcnt(0)
ds_write_b128 v2, v[44:47] offset:28672
ds_write_b128 v2, v[48:51] offset:29696
ds_write_b128 v2, v[52:55] offset:30720
ds_write_b128 v2, v[56:59] offset:31744
s_waitcnt lgkmcnt(0)
s_waitcnt vmcnt(4)
ds_read_b64_tr_b16 v[44:45], v29 offset:32768
ds_read_b64_tr_b16 v[46:47], v29 offset:32896
ds_read_b64_tr_b16 v[48:49], v29 offset:33280
ds_read_b64_tr_b16 v[50:51], v29 offset:33408
ds_read_b64_tr_b16 v[52:53], v29 offset:34816
ds_read_b64_tr_b16 v[54:55], v29 offset:34944
ds_read_b64_tr_b16 v[56:57], v29 offset:35328
ds_read_b64_tr_b16 v[58:59], v29 offset:35456
s_waitcnt lgkmcnt(0)
ds_write_b128 v2, v[44:47] offset:32768
ds_write_b128 v2, v[48:51] offset:33792
ds_write_b128 v2, v[52:55] offset:34816
ds_write_b128 v2, v[56:59] offset:35840
s_waitcnt lgkmcnt(0)
s_waitcnt vmcnt(0)
ds_read_b64_tr_b16 v[44:45], v29 offset:36864
ds_read_b64_tr_b16 v[46:47], v29 offset:36992
ds_read_b64_tr_b16 v[48:49], v29 offset:37376
ds_read_b64_tr_b16 v[50:51], v29 offset:37504
ds_read_b64_tr_b16 v[52:53], v29 offset:38912
ds_read_b64_tr_b16 v[54:55], v29 offset:39040
ds_read_b64_tr_b16 v[56:57], v29 offset:39424
ds_read_b64_tr_b16 v[58:59], v29 offset:39552
s_waitcnt lgkmcnt(0)
ds_write_b128 v2, v[44:47] offset:36864
ds_write_b128 v2, v[48:51] offset:37888
ds_write_b128 v2, v[52:55] offset:38912
ds_write_b128 v2, v[56:59] offset:39936
s_waitcnt lgkmcnt(0)
v_mov_b32 v24, 0
L_rdv_w1:
buffer_load_dword v23, v24, s[28:31], 0 offen sc0 sc1
s_sub_u32 s41, s41, 1
s_cbranch_scc1 L_exit
s_waitcnt vmcnt(0)
v_readfirstlane_b32 s56, v23
s_nop 0
s_and_b32 s57, s56, 0xff
s_cmp_lg_u32 s57, 32
s_cbranch_scc1 L_rdv_w1
s_lshl_b32 s101, s32, 7
s_add_u32 s101, s101, 327680
s_barrier
s_mov_b32 m0, 0
s_lshl_b32 s57, s58, 5
s_mov_b32 s0, 0x3f003f00
s_mov_b32 s1, 0x3f003f00
s_mov_b32 s58, 304128
s_cmp_eq_u32 s56, s57
s_cbranch_scc0 L_slow_w1
buffer_load_dwordx4 v[12:15], v9, s[4:7], s37 offen offset:0
buffer_load_dwordx4 v[16:19], v9, s[4:7], s37 offen offset:1024
buffer_load_dwordx4 v[52:55], v1, s[4:7], s37 offen offset:2048
buffer_load_dwordx4 v[56:59], v1, s[4:7], s37 offen offset:3072
v_mov_b64 v[20:21], 0
v_mov_b64 v[22:23], 0
v_mov_b64 v[24:25], 0
v_mov_b64 v[26:27], 0
v_mov_b64 v[28:29], 0
v_mov_b64 v[30:31], 0
v_mov_b64 v[32:33], 0
v_mov_b64 v[34:35], 0
v_mov_b64 v[36:37], 0
v_mov_b64 v[38:39], 0
v_mov_b64 v[40:41], 0
v_mov_b64 v[42:43], 0
ds_read_b128 v[44:47], v2 offset:0
ds_read_b128 v[48:51], v2 offset:1024
v_bfe_u32 v77, v1, 6, 1
v_lshl_add_u32 v77, v77, 3, v1
v_lshlrev_b32 v77, 1, v77
s_mov_b32 s38, 1
s_mov_b32 m0, 1024
s_nop 0
buffer_load_dwordx4 v1, s[4:7], s47 offen offset:0 sc1 lds
buffer_load_dwordx4 v1, s[4:7], s47 offen offset:1024 sc1 lds
buffer_load_dwordx4 v1, s[4:7], s47 offen offset:2048 sc1 lds
buffer_load_dwordx4 v1, s[4:7], s47 offen offset:3072 sc1 lds
s_mov_b32 m0, 5120
s_nop 0
buffer_load_dwordx4 v1, s[4:7], s48 offen offset:0 sc1 lds
buffer_load_dwordx4 v1, s[4:7], s48 offen offset:1024 sc1 lds
buffer_load_dwordx4 v1, s[4:7], s48 offen offset:2048 sc1 lds
buffer_load_dwordx4 v1, s[4:7], s48 offen offset:3072 sc1 lds
s_mov_b32 m0, 9216
s_nop 0
buffer_load_dwordx4 v1, s[4:7], s49 offen offset:0 sc1 lds
s_waitcnt vmcnt(0) lgkmcnt(0)
s_branch L_top_w1f
.p2align 6
L_ex_w1f:
s_add_u32 s34, s34, 1
s_add_u32 s37, s37, 524288
s_add_u32 s39, s39, 524288
s_mul_i32 s40, s34, 10240
s_add_u32 s40, s40, 8093696
s_not_b32 s35, s35
s_not_b32 s36, s36
v_mov_b64 v[20:21], 0
v_mov_b64 v[22:23], 0
v_mov_b64 v[24:25], 0
v_mov_b64 v[26:27], 0
v_mov_b64 v[28:29], 0
v_mov_b64 v[30:31], 0
v_mov_b64 v[32:33], 0
v_mov_b64 v[34:35], 0
v_mov_b64 v[36:37], 0
v_mov_b64 v[38:39], 0
v_mov_b64 v[40:41], 0
v_mov_b64 v[42:43], 0
s_cmp_eq_u32 s34, 63
s_cbranch_scc1 L_done_w1f
ds_read_b128 v[44:47], v2 offset:0
ds_read_b128 v[48:51], v2 offset:1024
v_bfe_u32 v77, v1, 6, 1
v_lshl_add_u32 v77, v77, 3, v1
v_lshlrev_b32 v77, 1, v77
s_barrier
L_top_w1f:
s_barrier
ds_read_b128 v[60:63], v1 offset:1024
ds_read_b128 v[64:67], v1 offset:2048
s_mov_b32 m0, 5120
s_nop 0
buffer_load_dwordx4 v1, s[4:7], s48 offen offset:1024 sc1 lds
s_mov_b32 m0, 9216
s_nop 0
buffer_load_dwordx4 v1, s[4:7], s49 offen offset:0 sc1 lds
s_barrier
ds_read_b128 v[68:71], v1 offset:3072
ds_read_b128 v[72:75], v1 offset:4096
L_s0_w1f:
s_waitcnt lgkmcnt(3)
v_smfmac_f32_16x16x64_bf16 v[28:31], v[60:63], v[176:183], v0
v_smfmac_f32_16x16x64_bf16 v[32:35], v[60:63], v[184:191], v0
v_smfmac_f32_16x16x64_bf16 v[36:39], v[60:63], a[48:55], v0
v_smfmac_f32_16x16x64_bf16 v[40:43], v[60:63], a[56:63], v0
s_waitcnt lgkmcnt(2)
v_smfmac_f32_16x16x64_bf16 v[20:23], v[64:67], v[80:87], v0
v_smfmac_f32_16x16x64_bf16 v[20:23], v[60:63], v[44:51], v0
ds_read_b128 v[44:47], v2 offset:2048
v_smfmac_f32_16x16x64_bf16 v[24:27], v[64:67], v[88:95], v0
ds_read_b128 v[48:51], v2 offset:3072
v_smfmac_f32_16x16x64_bf16 v[28:31], v[64:67], v[192:199], v0
s_waitcnt lgkmcnt(2)
v_bitop3_b32 v6, v60, v64, s35 bitop3:0x7e
buffer_load_dwordx4 v[12:15], v9, s[4:7], s37 offen offset:0
buffer_load_dwordx4 v[16:19], v9, s[4:7], s37 offen offset:1024
buffer_load_dwordx4 v[52:55], v1, s[4:7], s37 offen offset:2048
buffer_load_dwordx4 v[56:59], v1, s[4:7], s37 offen offset:3072
v_smfmac_f32_16x16x64_bf16 v[32:35], v[64:67], v[200:207], v0
v_bitop3_b32 v76, v68, v72, s35 bitop3:0x7e
v_smfmac_f32_16x16x64_bf16 v[36:39], v[64:67], a[64:71], v0
v_bitop3_b32 v6, v6, v76, 1 bitop3:0xa8
s_waitcnt lgkmcnt(0)
v_smfmac_f32_16x16x64_bf16 v[24:27], v[60:63], v[44:51], v0
ds_read_b128 v[44:47], v2 offset:4096
v_cmp_ne_u32 vcc, 0, v6
v_smfmac_f32_16x16x64_bf16 v[40:43], v[64:67], a[72:79], v0
ds_read_b128 v[48:51], v2 offset:5120
v_smfmac_f32_16x16x64_bf16 v[20:23], v[68:71], v[96:103], v0
s_cbranch_vccnz L_ra0_w1f
v_smfmac_f32_16x16x64_bf16 v[24:27], v[68:71], v[104:111], v0
s_waitcnt vmcnt(4)
s_barrier
ds_read_b32 v6, v77 offset:8192
v_smfmac_f32_16x16x64_bf16 v[28:31], v[68:71], v[208:215], v0
ds_read_b128 v[60:63], v1 offset:6144
s_waitcnt lgkmcnt(2)
v_smfmac_f32_16x16x64_bf16 v[20:23], v[72:75], v[44:51], v0
ds_read_b128 v[64:67], v1 offset:7168
v_smfmac_f32_16x16x64_bf16 v[32:35], v[68:71], v[216:223], v0
ds_read_b128 v[76:79], v1 offset:5120
v_smfmac_f32_16x16x64_bf16 v[36:39], v[68:71], a[80:87], v0
ds_read_b128 v[44:47], v2 offset:6144
v_smfmac_f32_16x16x64_bf16 v[40:43], v[68:71], a[88:95], v0
ds_read_b128 v[48:51], v2 offset:7168
s_waitcnt lgkmcnt(4)
v_bitop3_b32 v6, v6, v60, s35 bitop3:0x7e
v_smfmac_f32_16x16x64_bf16 v[28:31], v[72:75], v[224:231], v0
ds_read_b128 v[68:71], v1 offset:8192
s_waitcnt lgkmcnt(4)
v_bitop3_b32 v6, v6, v64, s35 bitop3:0xf6
v_smfmac_f32_16x16x64_bf16 v[32:35], v[72:75], v[232:239], v0
s_waitcnt lgkmcnt(3)
v_bitop3_b32 v6, v6, v76, s35 bitop3:0xf6
v_and_b32 v6, 1, v6
v_smfmac_f32_16x16x64_bf16 v[36:39], v[72:75], a[96:103], v0
v_cmp_ne_u32 vcc, 0, v6
s_waitcnt lgkmcnt(1)
v_smfmac_f32_16x16x64_bf16 v[24:27], v[72:75], v[44:51], v0
ds_read_b128 v[44:47], v2 offset:8192
v_lshlrev_b32 v6, 2, v1
v_smfmac_f32_16x16x64_bf16 v[40:43], v[72:75], a[104:111], v0
ds_read_b128 v[72:75], v1 offset:9216
s_cbranch_vccnz L_ra1_w1f
L_a1_w1f:
v_smfmac_f32_16x16x64_bf16 v[20:23], v[60:63], v[112:119], v0
ds_read_b128 v[48:51], v2 offset:9216
v_smfmac_f32_16x16x64_bf16 v[20:23], v[64:67], v[128:135], v0
s_waitcnt lgkmcnt(3)
v_smfmac_f32_16x16x64_bf16 v[20:23], v[68:71], v[144:151], v0
s_waitcnt lgkmcnt(1)
v_smfmac_f32_16x16x64_bf16 v[20:23], v[72:75], v[160:167], v0
s_waitcnt lgkmcnt(0)
v_smfmac_f32_16x16x64_bf16 v[20:23], v[76:79], v[44:51], v0
ds_read_b128 v[44:47], v2 offset:10240
v_smfmac_f32_16x16x64_bf16 v[24:27], v[60:63], v[120:127], v0
ds_read_b128 v[48:51], v2 offset:11264
v_smfmac_f32_16x16x64_bf16 v[24:27], v[64:67], v[136:143], v0
v_add_f32 v20, v20, v22
v_smfmac_f32_16x16x64_bf16 v[24:27], v[68:71], v[152:159], v0
v_add_f32 v21, v21, v23
v_smfmac_f32_16x16x64_bf16 v[24:27], v[72:75], v[168:175], v0
v_cvt_pk_bf16_f32 v22, v20, v21
s_waitcnt lgkmcnt(0)
v_smfmac_f32_16x16x64_bf16 v[24:27], v[76:79], v[44:51], v0
ds_read_b128 v[44:47], v2 offset:12288
v_smfmac_f32_16x16x64_bf16 v[28:31], v[76:79], v[240:247], v0
ds_read_b128 v[48:51], v2 offset:13312
v_smfmac_f32_16x16x64_bf16 v[28:31], v[64:67], a[0:7], v0
v_add_f32 v24, v24, v26
v_add_f32 v25, v25, v27
v_cvt_pk_bf16_f32 v23, v24, v25
v_smfmac_f32_16x16x64_bf16 v[28:31], v[68:71], a[16:23], v0
ds_write_b64 v3, v[22:23] offset:10752
v_smfmac_f32_16x16x64_bf16 v[28:31], v[72:75], a[32:39], v0
s_mov_b32 m0, 0
s_nop 0
buffer_load_dword v6, s[4:7], s39 offen lds
s_waitcnt lgkmcnt(1)
v_smfmac_f32_16x16x64_bf16 v[28:31], v[60:63], v[44:51], v0
ds_read_b128 v[44:47], v2 offset:14336
v_smfmac_f32_16x16x64_bf16 v[32:35], v[76:79], v[248:255], v0
ds_read_b128 v[48:51], v2 offset:15360
s_waitcnt lgkmcnt(2)
s_barrier
v_smfmac_f32_16x16x64_bf16 v[32:35], v[64:67], a[8:15], v0
ds_read_b64_tr_b16 v[20:21], v4 offset:10240
ds_read_b64_tr_b16 v[22:23], v4 offset:10752
v_add_f32 v28, v28, v30
v_smfmac_f32_16x16x64_bf16 v[32:35], v[68:71], a[24:31], v0
ds_read_b64_tr_b16 v[24:25], v4 offset:11264
v_add_f32 v29, v29, v31
v_smfmac_f32_16x16x64_bf16 v[32:35], v[72:75], a[40:47], v0
ds_read_b64_tr_b16 v[26:27], v4 offset:11776
v_cvt_pk_bf16_f32 v30, v28, v29
s_waitcnt lgkmcnt(4)
v_smfmac_f32_16x16x64_bf16 v[32:35], v[60:63], v[44:51], v0
ds_read_b128 v[44:47], v2 offset:18432
s_waitcnt vmcnt(3)
s_waitcnt lgkmcnt(3)
v_mfma_f32_16x16x32_bf16 v[12:15], v[12:15], v[20:23], 0
ds_read_b128 v[48:51], v2 offset:19456
s_waitcnt lgkmcnt(2)
v_mfma_f32_16x16x32_bf16 v[12:15], v[16:19], v[24:27], v[12:15]
v_add_f32 v32, v32, v34
v_add_f32 v33, v33, v35
v_cvt_pk_bf16_f32 v31, v32, v33
ds_write_b64 v3, v[30:31] offset:12800
v_smfmac_f32_16x16x64_bf16 v[36:39], v[76:79], a[112:119], v0
s_nop 2
v_add_f32_dpp v12, v14, v12 quad_perm:[2,3,0,1] row_mask:0xf bank_mask:0xf
v_add_f32_dpp v13, v15, v13 quad_perm:[2,3,0,1] row_mask:0xf bank_mask:0xf
ds_write_b64 v5, v[12:13] offset:14592
v_smfmac_f32_16x16x64_bf16 v[40:43], v[76:79], a[120:127], v0
s_waitcnt lgkmcnt(1)
s_barrier
ds_read_b64_tr_b16 v[28:29], v4 offset:12288
v_smfmac_f32_16x16x64_bf16 v[36:39], v[60:63], a[128:135], v0
ds_read_b64_tr_b16 v[30:31], v4 offset:12800
ds_read_b64_tr_b16 v[32:33], v4 offset:13312
v_smfmac_f32_16x16x64_bf16 v[40:43], v[60:63], a[136:143], v0
ds_read_b64_tr_b16 v[34:35], v4 offset:13824
v_mov_b64 v[76:77], s[52:53]
s_waitcnt lgkmcnt(4)
s_barrier
ds_read_b128 v[12:15], v1 offset:14336
v_smfmac_f32_16x16x64_bf16 v[40:43], v[72:75], v[44:51], v0
ds_read_b128 v[44:47], v2 offset:16384
v_mov_b64 v[78:79], s[52:53]
s_waitcnt lgkmcnt(4)
v_mfma_f32_16x16x32_bf16 v[28:31], v[28:31], v[20:23], 0
ds_read_b128 v[48:51], v2 offset:17408
s_waitcnt lgkmcnt(3)
v_mfma_f32_16x16x32_bf16 v[28:31], v[32:35], v[24:27], v[28:31]
v_smfmac_f32_16x16x64_bf16 v[40:43], v[64:67], a[152:159], v0
s_waitcnt lgkmcnt(2)
v_max3_f32 v17, v12, v13, v14
v_smfmac_f32_16x16x64_bf16 v[36:39], v[64:67], a[144:151], v0
ds_read_b128 v[60:63], v2 offset:22528
v_add_f32_dpp v28, v30, v28 quad_perm:[2,3,0,1] row_mask:0xf bank_mask:0xf
v_add_f32_dpp v29, v31, v29 quad_perm:[2,3,0,1] row_mask:0xf bank_mask:0xf
v_max_f32 v17, v17, v15
v_max_f32 v16, v28, v29
v_mul_f32 v16, s50, v16
v_max_f32_dpp v17, v17, v17 quad_perm:[2,3,0,1] row_mask:0xf bank_mask:0xf
v_smfmac_f32_16x16x64_bf16 v[40:43], v[68:71], a[168:175], v0
ds_read_b128 v[64:67], v2 offset:23552
v_max_f32_dpp v18, v16, v17 quad_perm:[0,1,0,1] row_mask:0xf bank_mask:0xf
v_max_f32_dpp v19, v16, v17 quad_perm:[0,1,0,1] row_mask:0xf bank_mask:0xf
v_smfmac_f32_16x16x64_bf16 v[36:39], v[68:71], a[160:167], v0
ds_read_b128 v[68:71], v2 offset:24576
v_permlane16_swap_b32 v18, v19
v_max_f32 v20, v18, v19
v_max_f32 v21, v18, v19
s_waitcnt lgkmcnt(3)
v_smfmac_f32_16x16x64_bf16 v[36:39], v[72:75], v[44:51], v0
ds_read_b128 v[72:75], v2 offset:25600
v_permlane32_swap_b32 v20, v21
v_max_f32 v20, v20, v21
v_sub_f32 v12, v12, v20
v_sub_f32 v13, v13, v20
v_pk_add_f32 v[14:15], v[14:15], v[20:21] op_sel_hi:[1,0] neg_lo:[0,1] neg_hi:[0,1]
v_exp_f32 v12, v12
v_exp_f32 v13, v13
v_exp_f32 v14, v14
v_exp_f32 v15, v15
v_cvt_pk_bf16_f32 v16, v12, v13
v_cvt_pk_bf16_f32 v17, v14, v15
v_pk_fma_f32 v[28:29], v[28:29], s[50:51], v[20:21] op_sel_hi:[1,1,0] neg_lo:[0,0,1] neg_hi:[0,0,1]
v_mov_b32_dpp v18, v16 quad_perm:[2,3,0,1] row_mask:0xf bank_mask:0xf
v_mov_b32_dpp v19, v17 quad_perm:[2,3,0,1] row_mask:0xf bank_mask:0xf
v_exp_f32 v28, v28
s_waitcnt vmcnt(1)
v_mfma_f32_16x16x32_bf16 v[32:35], v[76:79], v[16:19], 0
v_exp_f32 v29, v29
v_mfma_f32_16x16x32_bf16 v[20:23], v[52:55], v[16:19], 0
v_cvt_pk_bf16_f32 v12, v28, v29
v_cvt_pk_bf16_f32 v13, v28, v29
v_mov_b64 v[14:15], s[0:1]
v_mfma_f32_16x16x32_bf16 v[24:27], v[56:59], v[16:19], 0
v_cvt_pk_bf16_f32 v36, v36, v37
v_cvt_pk_bf16_f32 v37, v38, v39
v_mfma_f32_16x16x16_bf16 v[32:35], v[14:15], v[12:13], v[32:35]
v_cvt_pk_bf16_f32 v38, v40, v41
v_cvt_pk_bf16_f32 v39, v42, v43
v_mfma_f32_16x16x16_bf16 v[20:23], v[36:37], v[12:13], v[20:23]
ds_read_b128 v[44:47], v2 offset:20480
v_mfma_f32_16x16x16_bf16 v[24:27], v[38:39], v[12:13], v[24:27]
ds_read_b128 v[48:51], v2 offset:21504
v_rcp_f32 v32, v32
v_mov_b64 v[28:29], 0
v_mov_b64 v[30:31], 0
v_pk_mul_f32 v[20:21], v[20:21], v[32:33] op_sel_hi:[1,0]
v_pk_mul_f32 v[22:23], v[22:23], v[32:33] op_sel_hi:[1,0]
v_cvt_pk_bf16_f32 v20, v20, v21
v_cvt_pk_bf16_f32 v21, v22, v23
ds_write_b64 v1, v[20:21] offset:6144
v_pk_mul_f32 v[24:25], v[24:25], v[32:33] op_sel_hi:[1,0]
v_pk_mul_f32 v[26:27], v[26:27], v[32:33] op_sel_hi:[1,0]
v_cvt_pk_bf16_f32 v24, v24, v25
v_cvt_pk_bf16_f32 v25, v26, v27
ds_write_b64 v1, v[24:25] offset:6152
v_mov_b64 v[76:77], 0
ds_read_b128 v[12:15], v7 offset:6144
v_mov_b64 v[78:79], 0
v_mov_b64 v[40:41], 0
v_mov_b64 v[42:43], 0
v_mov_b64 v[36:37], 0
v_mov_b64 v[38:39], 0
v_mov_b64 v[32:33], 0
v_mov_b64 v[34:35], 0
s_waitcnt lgkmcnt(1)
s_barrier
ds_read_b128 v[16:19], v7 offset:7168
ds_read_b128 v[52:55], v7 offset:8192
ds_read_b128 v[56:59], v7 offset:5120
s_waitcnt lgkmcnt(3)
v_smfmac_f32_16x16x64_bf16 v[28:31], v[12:15], v[44:51], v0 abid:1
v_smfmac_f32_16x16x64_bf16 v[76:79], v[12:15], v[60:67], v0 abid:1
ds_read_b128 v[44:47], v2 offset:26624
s_waitcnt lgkmcnt(3)
v_smfmac_f32_16x16x64_bf16 v[28:31], v[16:19], a[176:183], v0 abid:1
ds_read_b128 v[48:51], v2 offset:27648
s_waitcnt lgkmcnt(3)
v_smfmac_f32_16x16x64_bf16 v[28:31], v[52:55], v[68:75], v0 abid:1
ds_read_b128 v[60:63], v2 offset:28672
s_waitcnt lgkmcnt(3)
v_smfmac_f32_16x16x64_bf16 v[28:31], v[56:59], a[184:191], v0 abid:1
ds_read_b128 v[64:67], v2 offset:29696
v_smfmac_f32_16x16x64_bf16 v[76:79], v[16:19], a[192:199], v0 abid:1
ds_read_b128 v[68:71], v2 offset:30720
s_waitcnt lgkmcnt(3)
v_smfmac_f32_16x16x64_bf16 v[76:79], v[52:55], v[44:51], v0 abid:1
ds_read_b128 v[72:75], v2 offset:31744
v_cvt_pk_bf16_f32 v28, v28, v29
v_cvt_pk_bf16_f32 v29, v30, v31
v_bfi_b32 v28, 1, s35, v28
buffer_store_dwordx2 v[28:29], v8, s[4:7], s42 offen
v_smfmac_f32_16x16x64_bf16 v[76:79], v[56:59], a[200:207], v0 abid:1
ds_read_b128 v[44:47], v2 offset:32768
s_waitcnt lgkmcnt(3)
v_smfmac_f32_16x16x64_bf16 v[40:43], v[12:15], v[60:67], v0 abid:1
ds_read_b128 v[48:51], v2 offset:33792
v_smfmac_f32_16x16x64_bf16 v[40:43], v[16:19], a[208:215], v0 abid:1
ds_read_b128 v[60:63], v2 offset:34816
v_cvt_pk_bf16_f32 v76, v76, v77
v_cvt_pk_bf16_f32 v77, v78, v79
v_bfi_b32 v76, 1, s35, v76
buffer_store_dwordx2 v[76:77], v8, s[4:7], s43 offen
s_waitcnt lgkmcnt(3)
v_smfmac_f32_16x16x64_bf16 v[40:43], v[52:55], v[68:75], v0 abid:1
ds_read_b128 v[64:67], v2 offset:35840
v_smfmac_f32_16x16x64_bf16 v[40:43], v[56:59], a[216:223], v0 abid:1
ds_read_b128 v[68:71], v2 offset:36864
s_waitcnt lgkmcnt(3)
v_smfmac_f32_16x16x64_bf16 v[36:39], v[12:15], v[44:51], v0 abid:1
ds_read_b128 v[72:75], v2 offset:37888
v_smfmac_f32_16x16x64_bf16 v[36:39], v[16:19], a[224:231], v0 abid:1
ds_read_b128 v[44:47], v2 offset:38912
v_cvt_pk_bf16_f32 v40, v40, v41
s_waitcnt lgkmcnt(3)
v_smfmac_f32_16x16x64_bf16 v[36:39], v[52:55], v[60:67], v0 abid:1
ds_read_b128 v[48:51], v2 offset:39936
v_cvt_pk_bf16_f32 v41, v42, v43
v_smfmac_f32_16x16x64_bf16 v[36:39], v[56:59], a[232:239], v0 abid:1
v_bfi_b32 v40, 1, s35, v40
buffer_store_dwordx2 v[40:41], v8, s[4:7], s44 offen
s_waitcnt lgkmcnt(2)
v_smfmac_f32_16x16x64_bf16 v[32:35], v[12:15], v[68:75], v0 abid:1
v_smfmac_f32_16x16x64_bf16 v[32:35], v[16:19], a[240:247], v0 abid:1
v_cvt_pk_bf16_f32 v36, v36, v37
s_waitcnt lgkmcnt(0)
v_smfmac_f32_16x16x64_bf16 v[32:35], v[52:55], v[44:51], v0 abid:1
v_cvt_pk_bf16_f32 v37, v38, v39
v_smfmac_f32_16x16x64_bf16 v[32:35], v[56:59], a[248:255], v0 abid:1
v_bfi_b32 v36, 1, s35, v36
buffer_store_dwordx2 v[36:37], v8, s[4:7], s45 offen
s_nop 5
v_cvt_pk_bf16_f32 v32, v32, v33
v_cvt_pk_bf16_f32 v33, v34, v35
v_bfi_b32 v32, 1, s35, v32
buffer_store_dwordx2 v[32:33], v8, s[4:7], s46 offen
s_branch L_ex_w1f
L_done_w1f:
s_waitcnt vmcnt(0) lgkmcnt(0)
s_endpgm
L_ra0_w1f:
s_mov_b32 s38, 1
s_mov_b32 m0, 1024
s_nop 0
buffer_load_dwordx4 v1, s[4:7], s47 offen offset:0 sc1 lds
buffer_load_dwordx4 v1, s[4:7], s47 offen offset:1024 sc1 lds
buffer_load_dwordx4 v1, s[4:7], s47 offen offset:2048 sc1 lds
buffer_load_dwordx4 v1, s[4:7], s47 offen offset:3072 sc1 lds
s_sub_u32 s41, s41, 1
s_cbranch_scc1 L_exit
ds_read_b128 v[44:47], v2 offset:0
ds_read_b128 v[48:51], v2 offset:1024
v_mov_b64 v[20:21], 0
v_mov_b64 v[22:23], 0
v_mov_b64 v[24:25], 0
v_mov_b64 v[26:27], 0
v_mov_b64 v[28:29], 0
v_mov_b64 v[30:31], 0
v_mov_b64 v[32:33], 0
v_mov_b64 v[34:35], 0
v_mov_b64 v[36:37], 0
v_mov_b64 v[38:39], 0
v_mov_b64 v[40:41], 0
v_mov_b64 v[42:43], 0
s_waitcnt vmcnt(0)
ds_read_b128 v[60:63], v1 offset:1024
ds_read_b128 v[64:67], v1 offset:2048
ds_read_b128 v[68:71], v1 offset:3072
ds_read_b128 v[72:75], v1 offset:4096
s_branch L_s0_w1f
L_ra1_w1f:
s_mov_b32 s38, 1
s_waitcnt lgkmcnt(0)
s_barrier
s_mov_b32 m0, 5120
s_nop 0
buffer_load_dwordx4 v1, s[4:7], s48 offen offset:1024 sc1 lds
s_sub_u32 s41, s41, 1
s_cbranch_scc1 L_exit
s_waitcnt vmcnt(0)
s_barrier
ds_read_b128 v[76:79], v1 offset:5120
ds_read_b128 v[60:63], v1 offset:6144
ds_read_b128 v[64:67], v1 offset:7168
ds_read_b128 v[68:71], v1 offset:8192
ds_read_b128 v[72:75], v1 offset:9216
s_waitcnt lgkmcnt(0)
v_bitop3_b32 v6, v76, v60, s35 bitop3:0x7e
v_bitop3_b32 v6, v6, v64, s35 bitop3:0xf6
v_bitop3_b32 v6, v6, v68, s35 bitop3:0xf6
v_bitop3_b32 v6, v6, v72, s35 bitop3:0xf6
v_and_b32 v6, 1, v6
v_cmp_ne_u32 vcc, 0, v6
v_lshlrev_b32 v6, 2, v1
s_cbranch_vccnz L_ra1_w1f
s_branch L_a1_w1f
L_slow_w1:
buffer_load_dwordx4 v[12:15], v9, s[4:7], s37 offen offset:0
buffer_load_dwordx4 v[16:19], v9, s[4:7], s37 offen offset:1024
buffer_load_dwordx4 v[52:55], v1, s[4:7], s37 offen offset:2048
buffer_load_dwordx4 v[56:59], v1, s[4:7], s37 offen offset:3072
v_mov_b64 v[20:21], 0
v_mov_b64 v[22:23], 0
v_mov_b64 v[24:25], 0
v_mov_b64 v[26:27], 0
v_mov_b64 v[28:29], 0
v_mov_b64 v[30:31], 0
v_mov_b64 v[32:33], 0
v_mov_b64 v[34:35], 0
v_mov_b64 v[36:37], 0
v_mov_b64 v[38:39], 0
v_mov_b64 v[40:41], 0
v_mov_b64 v[42:43], 0
ds_read_b128 v[44:47], v2 offset:0
ds_read_b128 v[48:51], v2 offset:1024
v_bfe_u32 v77, v1, 6, 1
v_lshl_add_u32 v77, v77, 3, v1
v_lshlrev_b32 v77, 1, v77
s_mov_b32 s38, 1
s_mov_b32 m0, 1024
s_nop 0
buffer_load_dwordx4 v1, s[4:7], s47 offen offset:0 sc0 sc1 lds
buffer_load_dwordx4 v1, s[4:7], s47 offen offset:1024 sc0 sc1 lds
buffer_load_dwordx4 v1, s[4:7], s47 offen offset:2048 sc0 sc1 lds
buffer_load_dwordx4 v1, s[4:7], s47 offen offset:3072 sc0 sc1 lds
s_mov_b32 m0, 5120
s_nop 0
buffer_load_dwordx4 v1, s[4:7], s48 offen offset:0 sc0 sc1 lds
buffer_load_dwordx4 v1, s[4:7], s48 offen offset:1024 sc0 sc1 lds
buffer_load_dwordx4 v1, s[4:7], s48 offen offset:2048 sc0 sc1 lds
buffer_load_dwordx4 v1, s[4:7], s48 offen offset:3072 sc0 sc1 lds
s_mov_b32 m0, 9216
s_nop 0
buffer_load_dwordx4 v1, s[4:7], s49 offen offset:0 sc0 sc1 lds
s_waitcnt vmcnt(0) lgkmcnt(0)
s_branch L_top_w1s
.p2align 6
L_ex_w1s:
s_add_u32 s34, s34, 1
s_add_u32 s37, s37, 524288
s_add_u32 s39, s39, 524288
s_mul_i32 s40, s34, 10240
s_add_u32 s40, s40, 8093696
s_not_b32 s35, s35
s_not_b32 s36, s36
v_mov_b64 v[20:21], 0
v_mov_b64 v[22:23], 0
v_mov_b64 v[24:25], 0
v_mov_b64 v[26:27], 0
v_mov_b64 v[28:29], 0
v_mov_b64 v[30:31], 0
v_mov_b64 v[32:33], 0
v_mov_b64 v[34:35], 0
v_mov_b64 v[36:37], 0
v_mov_b64 v[38:39], 0
v_mov_b64 v[40:41], 0
v_mov_b64 v[42:43], 0
s_cmp_eq_u32 s34, 63
s_cbranch_scc1 L_done_w1s
ds_read_b128 v[44:47], v2 offset:0
ds_read_b128 v[48:51], v2 offset:1024
v_bfe_u32 v77, v1, 6, 1
v_lshl_add_u32 v77, v77, 3, v1
v_lshlrev_b32 v77, 1, v77
s_barrier
L_top_w1s:
s_barrier
ds_read_b128 v[60:63], v1 offset:1024
ds_read_b128 v[64:67], v1 offset:2048
s_mov_b32 m0, 5120
s_nop 0
buffer_load_dwordx4 v1, s[4:7], s48 offen offset:1024 sc0 sc1 lds
s_mov_b32 m0, 9216
s_nop 0
buffer_load_dwordx4 v1, s[4:7], s49 offen offset:0 sc0 sc1 lds
s_barrier
ds_read_b128 v[68:71], v1 offset:3072
ds_read_b128 v[72:75], v1 offset:4096
L_s0_w1s:
s_waitcnt lgkmcnt(3)
v_smfmac_f32_16x16x64_bf16 v[28:31], v[60:63], v[176:183], v0
v_smfmac_f32_16x16x64_bf16 v[32:35], v[60:63], v[184:191], v0
v_smfmac_f32_16x16x64_bf16 v[36:39], v[60:63], a[48:55], v0
v_smfmac_f32_16x16x64_bf16 v[40:43], v[60:63], a[56:63], v0
s_waitcnt lgkmcnt(2)
v_smfmac_f32_16x16x64_bf16 v[20:23], v[64:67], v[80:87], v0
v_smfmac_f32_16x16x64_bf16 v[20:23], v[60:63], v[44:51], v0
ds_read_b128 v[44:47], v2 offset:2048
v_smfmac_f32_16x16x64_bf16 v[24:27], v[64:67], v[88:95], v0
ds_read_b128 v[48:51], v2 offset:3072
v_smfmac_f32_16x16x64_bf16 v[28:31], v[64:67], v[192:199], v0
s_waitcnt lgkmcnt(2)
v_bitop3_b32 v6, v60, v64, s35 bitop3:0x7e
buffer_load_dwordx4 v[12:15], v9, s[4:7], s37 offen offset:0
buffer_load_dwordx4 v[16:19], v9, s[4:7], s37 offen offset:1024
buffer_load_dwordx4 v[52:55], v1, s[4:7], s37 offen offset:2048
buffer_load_dwordx4 v[56:59], v1, s[4:7], s37 offen offset:3072
v_smfmac_f32_16x16x64_bf16 v[32:35], v[64:67], v[200:207], v0
v_bitop3_b32 v76, v68, v72, s35 bitop3:0x7e
v_smfmac_f32_16x16x64_bf16 v[36:39], v[64:67], a[64:71], v0
v_bitop3_b32 v6, v6, v76, 1 bitop3:0xa8
s_waitcnt lgkmcnt(0)
v_smfmac_f32_16x16x64_bf16 v[24:27], v[60:63], v[44:51], v0
ds_read_b128 v[44:47], v2 offset:4096
v_cmp_ne_u32 vcc, 0, v6
v_smfmac_f32_16x16x64_bf16 v[40:43], v[64:67], a[72:79], v0
ds_read_b128 v[48:51], v2 offset:5120
v_smfmac_f32_16x16x64_bf16 v[20:23], v[68:71], v[96:103], v0
s_cbranch_vccnz L_ra0_w1s
v_smfmac_f32_16x16x64_bf16 v[24:27], v[68:71], v[104:111], v0
s_waitcnt vmcnt(4)
s_barrier
ds_read_b32 v6, v77 offset:8192
v_smfmac_f32_16x16x64_bf16 v[28:31], v[68:71], v[208:215], v0
ds_read_b128 v[60:63], v1 offset:6144
s_waitcnt lgkmcnt(2)
v_smfmac_f32_16x16x64_bf16 v[20:23], v[72:75], v[44:51], v0
ds_read_b128 v[64:67], v1 offset:7168
v_smfmac_f32_16x16x64_bf16 v[32:35], v[68:71], v[216:223], v0
ds_read_b128 v[76:79], v1 offset:5120
v_smfmac_f32_16x16x64_bf16 v[36:39], v[68:71], a[80:87], v0
ds_read_b128 v[44:47], v2 offset:6144
v_smfmac_f32_16x16x64_bf16 v[40:43], v[68:71], a[88:95], v0
ds_read_b128 v[48:51], v2 offset:7168
s_waitcnt lgkmcnt(4)
v_bitop3_b32 v6, v6, v60, s35 bitop3:0x7e
v_smfmac_f32_16x16x64_bf16 v[28:31], v[72:75], v[224:231], v0
ds_read_b128 v[68:71], v1 offset:8192
s_waitcnt lgkmcnt(4)
v_bitop3_b32 v6, v6, v64, s35 bitop3:0xf6
v_smfmac_f32_16x16x64_bf16 v[32:35], v[72:75], v[232:239], v0
s_waitcnt lgkmcnt(3)
v_bitop3_b32 v6, v6, v76, s35 bitop3:0xf6
v_and_b32 v6, 1, v6
v_smfmac_f32_16x16x64_bf16 v[36:39], v[72:75], a[96:103], v0
v_cmp_ne_u32 vcc, 0, v6
s_waitcnt lgkmcnt(1)
v_smfmac_f32_16x16x64_bf16 v[24:27], v[72:75], v[44:51], v0
ds_read_b128 v[44:47], v2 offset:8192
v_lshlrev_b32 v6, 2, v1
v_smfmac_f32_16x16x64_bf16 v[40:43], v[72:75], a[104:111], v0
ds_read_b128 v[72:75], v1 offset:9216
s_cbranch_vccnz L_ra1_w1s
L_a1_w1s:
v_smfmac_f32_16x16x64_bf16 v[20:23], v[60:63], v[112:119], v0
ds_read_b128 v[48:51], v2 offset:9216
v_smfmac_f32_16x16x64_bf16 v[20:23], v[64:67], v[128:135], v0
s_waitcnt lgkmcnt(3)
v_smfmac_f32_16x16x64_bf16 v[20:23], v[68:71], v[144:151], v0
s_waitcnt lgkmcnt(1)
v_smfmac_f32_16x16x64_bf16 v[20:23], v[72:75], v[160:167], v0
s_waitcnt lgkmcnt(0)
v_smfmac_f32_16x16x64_bf16 v[20:23], v[76:79], v[44:51], v0
ds_read_b128 v[44:47], v2 offset:10240
v_smfmac_f32_16x16x64_bf16 v[24:27], v[60:63], v[120:127], v0
ds_read_b128 v[48:51], v2 offset:11264
v_smfmac_f32_16x16x64_bf16 v[24:27], v[64:67], v[136:143], v0
v_add_f32 v20, v20, v22
v_smfmac_f32_16x16x64_bf16 v[24:27], v[68:71], v[152:159], v0
v_add_f32 v21, v21, v23
v_smfmac_f32_16x16x64_bf16 v[24:27], v[72:75], v[168:175], v0
v_cvt_pk_bf16_f32 v22, v20, v21
s_waitcnt lgkmcnt(0)
v_smfmac_f32_16x16x64_bf16 v[24:27], v[76:79], v[44:51], v0
ds_read_b128 v[44:47], v2 offset:12288
v_smfmac_f32_16x16x64_bf16 v[28:31], v[76:79], v[240:247], v0
ds_read_b128 v[48:51], v2 offset:13312
v_smfmac_f32_16x16x64_bf16 v[28:31], v[64:67], a[0:7], v0
v_add_f32 v24, v24, v26
v_add_f32 v25, v25, v27
v_cvt_pk_bf16_f32 v23, v24, v25
v_smfmac_f32_16x16x64_bf16 v[28:31], v[68:71], a[16:23], v0
ds_write_b64 v3, v[22:23] offset:10752
v_smfmac_f32_16x16x64_bf16 v[28:31], v[72:75], a[32:39], v0
s_mov_b32 m0, 0
s_nop 0
buffer_load_dword v6, s[4:7], s39 offen lds
s_waitcnt lgkmcnt(1)
v_smfmac_f32_16x16x64_bf16 v[28:31], v[60:63], v[44:51], v0
ds_read_b128 v[44:47], v2 offset:14336
v_smfmac_f32_16x16x64_bf16 v[32:35], v[76:79], v[248:255], v0
ds_read_b128 v[48:51], v2 offset:15360
s_waitcnt lgkmcnt(2)
s_barrier
v_smfmac_f32_16x16x64_bf16 v[32:35], v[64:67], a[8:15], v0
ds_read_b64_tr_b16 v[20:21], v4 offset:10240
ds_read_b64_tr_b16 v[22:23], v4 offset:10752
v_add_f32 v28, v28, v30
v_smfmac_f32_16x16x64_bf16 v[32:35], v[68:71], a[24:31], v0
ds_read_b64_tr_b16 v[24:25], v4 offset:11264
v_add_f32 v29, v29, v31
v_smfmac_f32_16x16x64_bf16 v[32:35], v[72:75], a[40:47], v0
ds_read_b64_tr_b16 v[26:27], v4 offset:11776
v_cvt_pk_bf16_f32 v30, v28, v29
s_waitcnt lgkmcnt(4)
v_smfmac_f32_16x16x64_bf16 v[32:35], v[60:63], v[44:51], v0
ds_read_b128 v[44:47], v2 offset:18432
s_waitcnt vmcnt(3)
s_waitcnt lgkmcnt(3)
v_mfma_f32_16x16x32_bf16 v[12:15], v[12:15], v[20:23], 0
ds_read_b128 v[48:51], v2 offset:19456
s_waitcnt lgkmcnt(2)
v_mfma_f32_16x16x32_bf16 v[12:15], v[16:19], v[24:27], v[12:15]
v_add_f32 v32, v32, v34
v_add_f32 v33, v33, v35
v_cvt_pk_bf16_f32 v31, v32, v33
ds_write_b64 v3, v[30:31] offset:12800
v_smfmac_f32_16x16x64_bf16 v[36:39], v[76:79], a[112:119], v0
s_nop 2
v_add_f32_dpp v12, v14, v12 quad_perm:[2,3,0,1] row_mask:0xf bank_mask:0xf
v_add_f32_dpp v13, v15, v13 quad_perm:[2,3,0,1] row_mask:0xf bank_mask:0xf
ds_write_b64 v5, v[12:13] offset:14592
v_smfmac_f32_16x16x64_bf16 v[40:43], v[76:79], a[120:127], v0
s_waitcnt lgkmcnt(1)
s_barrier
ds_read_b64_tr_b16 v[28:29], v4 offset:12288
v_smfmac_f32_16x16x64_bf16 v[36:39], v[60:63], a[128:135], v0
ds_read_b64_tr_b16 v[30:31], v4 offset:12800
ds_read_b64_tr_b16 v[32:33], v4 offset:13312
v_smfmac_f32_16x16x64_bf16 v[40:43], v[60:63], a[136:143], v0
ds_read_b64_tr_b16 v[34:35], v4 offset:13824
v_mov_b64 v[76:77], s[52:53]
s_waitcnt lgkmcnt(4)
s_barrier
ds_read_b128 v[12:15], v1 offset:14336
v_smfmac_f32_16x16x64_bf16 v[40:43], v[72:75], v[44:51], v0
ds_read_b128 v[44:47], v2 offset:16384
v_mov_b64 v[78:79], s[52:53]
s_waitcnt lgkmcnt(4)
v_mfma_f32_16x16x32_bf16 v[28:31], v[28:31], v[20:23], 0
ds_read_b128 v[48:51], v2 offset:17408
s_waitcnt lgkmcnt(3)
v_mfma_f32_16x16x32_bf16 v[28:31], v[32:35], v[24:27], v[28:31]
v_smfmac_f32_16x16x64_bf16 v[40:43], v[64:67], a[152:159], v0
s_waitcnt lgkmcnt(2)
v_max3_f32 v17, v12, v13, v14
v_smfmac_f32_16x16x64_bf16 v[36:39], v[64:67], a[144:151], v0
ds_read_b128 v[60:63], v2 offset:22528
v_add_f32_dpp v28, v30, v28 quad_perm:[2,3,0,1] row_mask:0xf bank_mask:0xf
v_add_f32_dpp v29, v31, v29 quad_perm:[2,3,0,1] row_mask:0xf bank_mask:0xf
v_max_f32 v17, v17, v15
v_max_f32 v16, v28, v29
v_mul_f32 v16, s50, v16
v_max_f32_dpp v17, v17, v17 quad_perm:[2,3,0,1] row_mask:0xf bank_mask:0xf
v_smfmac_f32_16x16x64_bf16 v[40:43], v[68:71], a[168:175], v0
ds_read_b128 v[64:67], v2 offset:23552
v_max_f32_dpp v18, v16, v17 quad_perm:[0,1,0,1] row_mask:0xf bank_mask:0xf
v_max_f32_dpp v19, v16, v17 quad_perm:[0,1,0,1] row_mask:0xf bank_mask:0xf
v_smfmac_f32_16x16x64_bf16 v[36:39], v[68:71], a[160:167], v0
ds_read_b128 v[68:71], v2 offset:24576
v_permlane16_swap_b32 v18, v19
v_max_f32 v20, v18, v19
v_max_f32 v21, v18, v19
s_waitcnt lgkmcnt(3)
v_smfmac_f32_16x16x64_bf16 v[36:39], v[72:75], v[44:51], v0
ds_read_b128 v[72:75], v2 offset:25600
v_permlane32_swap_b32 v20, v21
v_max_f32 v20, v20, v21
v_sub_f32 v12, v12, v20
v_sub_f32 v13, v13, v20
v_pk_add_f32 v[14:15], v[14:15], v[20:21] op_sel_hi:[1,0] neg_lo:[0,1] neg_hi:[0,1]
v_exp_f32 v12, v12
v_exp_f32 v13, v13
v_exp_f32 v14, v14
v_exp_f32 v15, v15
v_cvt_pk_bf16_f32 v16, v12, v13
v_cvt_pk_bf16_f32 v17, v14, v15
v_pk_fma_f32 v[28:29], v[28:29], s[50:51], v[20:21] op_sel_hi:[1,1,0] neg_lo:[0,0,1] neg_hi:[0,0,1]
v_mov_b32_dpp v18, v16 quad_perm:[2,3,0,1] row_mask:0xf bank_mask:0xf
v_mov_b32_dpp v19, v17 quad_perm:[2,3,0,1] row_mask:0xf bank_mask:0xf
v_exp_f32 v28, v28
s_waitcnt vmcnt(1)
v_mfma_f32_16x16x32_bf16 v[32:35], v[76:79], v[16:19], 0
v_exp_f32 v29, v29
v_mfma_f32_16x16x32_bf16 v[20:23], v[52:55], v[16:19], 0
v_cvt_pk_bf16_f32 v12, v28, v29
v_cvt_pk_bf16_f32 v13, v28, v29
v_mov_b64 v[14:15], s[0:1]
v_mfma_f32_16x16x32_bf16 v[24:27], v[56:59], v[16:19], 0
v_cvt_pk_bf16_f32 v36, v36, v37
v_cvt_pk_bf16_f32 v37, v38, v39
v_mfma_f32_16x16x16_bf16 v[32:35], v[14:15], v[12:13], v[32:35]
v_cvt_pk_bf16_f32 v38, v40, v41
v_cvt_pk_bf16_f32 v39, v42, v43
v_mfma_f32_16x16x16_bf16 v[20:23], v[36:37], v[12:13], v[20:23]
ds_read_b128 v[44:47], v2 offset:20480
v_mfma_f32_16x16x16_bf16 v[24:27], v[38:39], v[12:13], v[24:27]
ds_read_b128 v[48:51], v2 offset:21504
v_rcp_f32 v32, v32
v_mov_b64 v[28:29], 0
v_mov_b64 v[30:31], 0
v_pk_mul_f32 v[20:21], v[20:21], v[32:33] op_sel_hi:[1,0]
v_pk_mul_f32 v[22:23], v[22:23], v[32:33] op_sel_hi:[1,0]
v_cvt_pk_bf16_f32 v20, v20, v21
v_cvt_pk_bf16_f32 v21, v22, v23
ds_write_b64 v1, v[20:21] offset:6144
v_pk_mul_f32 v[24:25], v[24:25], v[32:33] op_sel_hi:[1,0]
v_pk_mul_f32 v[26:27], v[26:27], v[32:33] op_sel_hi:[1,0]
v_cvt_pk_bf16_f32 v24, v24, v25
v_cvt_pk_bf16_f32 v25, v26, v27
ds_write_b64 v1, v[24:25] offset:6152
v_mov_b64 v[76:77], 0
ds_read_b128 v[12:15], v7 offset:6144
v_mov_b64 v[78:79], 0
v_mov_b64 v[40:41], 0
v_mov_b64 v[42:43], 0
v_mov_b64 v[36:37], 0
v_mov_b64 v[38:39], 0
v_mov_b64 v[32:33], 0
v_mov_b64 v[34:35], 0
s_waitcnt lgkmcnt(1)
s_barrier
ds_read_b128 v[16:19], v7 offset:7168
ds_read_b128 v[52:55], v7 offset:8192
ds_read_b128 v[56:59], v7 offset:5120
s_waitcnt lgkmcnt(3)
v_smfmac_f32_16x16x64_bf16 v[28:31], v[12:15], v[44:51], v0 abid:1
v_smfmac_f32_16x16x64_bf16 v[76:79], v[12:15], v[60:67], v0 abid:1
ds_read_b128 v[44:47], v2 offset:26624
s_waitcnt lgkmcnt(3)
v_smfmac_f32_16x16x64_bf16 v[28:31], v[16:19], a[176:183], v0 abid:1
ds_read_b128 v[48:51], v2 offset:27648
s_waitcnt lgkmcnt(3)
v_smfmac_f32_16x16x64_bf16 v[28:31], v[52:55], v[68:75], v0 abid:1
ds_read_b128 v[60:63], v2 offset:28672
s_waitcnt lgkmcnt(3)
v_smfmac_f32_16x16x64_bf16 v[28:31], v[56:59], a[184:191], v0 abid:1
ds_read_b128 v[64:67], v2 offset:29696
v_smfmac_f32_16x16x64_bf16 v[76:79], v[16:19], a[192:199], v0 abid:1
ds_read_b128 v[68:71], v2 offset:30720
s_waitcnt lgkmcnt(3)
v_smfmac_f32_16x16x64_bf16 v[76:79], v[52:55], v[44:51], v0 abid:1
ds_read_b128 v[72:75], v2 offset:31744
v_cvt_pk_bf16_f32 v28, v28, v29
v_cvt_pk_bf16_f32 v29, v30, v31
v_bfi_b32 v28, 1, s35, v28
buffer_store_dwordx2 v[28:29], v8, s[4:7], s42 offen sc0 sc1
v_smfmac_f32_16x16x64_bf16 v[76:79], v[56:59], a[200:207], v0 abid:1
ds_read_b128 v[44:47], v2 offset:32768
s_waitcnt lgkmcnt(3)
v_smfmac_f32_16x16x64_bf16 v[40:43], v[12:15], v[60:67], v0 abid:1
ds_read_b128 v[48:51], v2 offset:33792
v_smfmac_f32_16x16x64_bf16 v[40:43], v[16:19], a[208:215], v0 abid:1
ds_read_b128 v[60:63], v2 offset:34816
v_cvt_pk_bf16_f32 v76, v76, v77
v_cvt_pk_bf16_f32 v77, v78, v79
v_bfi_b32 v76, 1, s35, v76
buffer_store_dwordx2 v[76:77], v8, s[4:7], s43 offen sc0 sc1
s_waitcnt lgkmcnt(3)
v_smfmac_f32_16x16x64_bf16 v[40:43], v[52:55], v[68:75], v0 abid:1
ds_read_b128 v[64:67], v2 offset:35840
v_smfmac_f32_16x16x64_bf16 v[40:43], v[56:59], a[216:223], v0 abid:1
ds_read_b128 v[68:71], v2 offset:36864
s_waitcnt lgkmcnt(3)
v_smfmac_f32_16x16x64_bf16 v[36:39], v[12:15], v[44:51], v0 abid:1
ds_read_b128 v[72:75], v2 offset:37888
v_smfmac_f32_16x16x64_bf16 v[36:39], v[16:19], a[224:231], v0 abid:1
ds_read_b128 v[44:47], v2 offset:38912
v_cvt_pk_bf16_f32 v40, v40, v41
s_waitcnt lgkmcnt(3)
v_smfmac_f32_16x16x64_bf16 v[36:39], v[52:55], v[60:67], v0 abid:1
ds_read_b128 v[48:51], v2 offset:39936
v_cvt_pk_bf16_f32 v41, v42, v43
v_smfmac_f32_16x16x64_bf16 v[36:39], v[56:59], a[232:239], v0 abid:1
v_bfi_b32 v40, 1, s35, v40
buffer_store_dwordx2 v[40:41], v8, s[4:7], s44 offen sc0 sc1
s_waitcnt lgkmcnt(2)
v_smfmac_f32_16x16x64_bf16 v[32:35], v[12:15], v[68:75], v0 abid:1
v_smfmac_f32_16x16x64_bf16 v[32:35], v[16:19], a[240:247], v0 abid:1
v_cvt_pk_bf16_f32 v36, v36, v37
s_waitcnt lgkmcnt(0)
v_smfmac_f32_16x16x64_bf16 v[32:35], v[52:55], v[44:51], v0 abid:1
v_cvt_pk_bf16_f32 v37, v38, v39
v_smfmac_f32_16x16x64_bf16 v[32:35], v[56:59], a[248:255], v0 abid:1
v_bfi_b32 v36, 1, s35, v36
buffer_store_dwordx2 v[36:37], v8, s[4:7], s45 offen sc0 sc1
s_nop 5
v_cvt_pk_bf16_f32 v32, v32, v33
v_cvt_pk_bf16_f32 v33, v34, v35
v_bfi_b32 v32, 1, s35, v32
buffer_store_dwordx2 v[32:33], v8, s[4:7], s46 offen sc0 sc1
s_branch L_ex_w1s
L_done_w1s:
s_waitcnt vmcnt(0) lgkmcnt(0)
s_endpgm
L_ra0_w1s:
s_mov_b32 s38, 1
s_mov_b32 m0, 1024
s_nop 0
buffer_load_dwordx4 v1, s[4:7], s47 offen offset:0 sc0 sc1 lds
buffer_load_dwordx4 v1, s[4:7], s47 offen offset:1024 sc0 sc1 lds
buffer_load_dwordx4 v1, s[4:7], s47 offen offset:2048 sc0 sc1 lds
buffer_load_dwordx4 v1, s[4:7], s47 offen offset:3072 sc0 sc1 lds
s_sub_u32 s41, s41, 1
s_cbranch_scc1 L_exit
ds_read_b128 v[44:47], v2 offset:0
ds_read_b128 v[48:51], v2 offset:1024
v_mov_b64 v[20:21], 0
v_mov_b64 v[22:23], 0
v_mov_b64 v[24:25], 0
v_mov_b64 v[26:27], 0
v_mov_b64 v[28:29], 0
v_mov_b64 v[30:31], 0
v_mov_b64 v[32:33], 0
v_mov_b64 v[34:35], 0
v_mov_b64 v[36:37], 0
v_mov_b64 v[38:39], 0
v_mov_b64 v[40:41], 0
v_mov_b64 v[42:43], 0
s_waitcnt vmcnt(0)
ds_read_b128 v[60:63], v1 offset:1024
ds_read_b128 v[64:67], v1 offset:2048
ds_read_b128 v[68:71], v1 offset:3072
ds_read_b128 v[72:75], v1 offset:4096
s_branch L_s0_w1s
L_ra1_w1s:
s_mov_b32 s38, 1
s_waitcnt lgkmcnt(0)
s_barrier
s_mov_b32 m0, 5120
s_nop 0
buffer_load_dwordx4 v1, s[4:7], s48 offen offset:1024 sc0 sc1 lds
s_sub_u32 s41, s41, 1
s_cbranch_scc1 L_exit
s_waitcnt vmcnt(0)
s_barrier
ds_read_b128 v[76:79], v1 offset:5120
ds_read_b128 v[60:63], v1 offset:6144
ds_read_b128 v[64:67], v1 offset:7168
ds_read_b128 v[68:71], v1 offset:8192
ds_read_b128 v[72:75], v1 offset:9216
s_waitcnt lgkmcnt(0)
v_bitop3_b32 v6, v76, v60, s35 bitop3:0x7e
v_bitop3_b32 v6, v6, v64, s35 bitop3:0xf6
v_bitop3_b32 v6, v6, v68, s35 bitop3:0xf6
v_bitop3_b32 v6, v6, v72, s35 bitop3:0xf6
v_and_b32 v6, 1, v6
v_cmp_ne_u32 vcc, 0, v6
v_lshlrev_b32 v6, 2, v1
s_cbranch_vccnz L_ra1_w1s
s_branch L_a1_w1s
L_pro_w1r:
v_and_b32 v20, 63, v0
v_and_b32 v21, 15, v0
v_bfe_u32 v22, v0, 4, 2
v_lshlrev_b32 v1, 4, v20
v_add_u32 v2, 57344, v1
v_bfe_u32 v23, v20, 3, 1
v_lshlrev_b32 v26, 3, v23
v_bfe_u32 v23, v20, 4, 2
v_lshl_add_u32 v26, v23, 1, v26
v_bfe_u32 v23, v20, 2, 1
v_add_u32 v26, v26, v23
v_lshlrev_b32 v26, 13, v26
v_and_b32 v23, 3, v20
v_lshl_add_u32 v26, v23, 4, v26
v_lshrrev_b32 v24, 2, v20
v_mul_u32_u24 v27, 1152, v24
v_lshl_add_u32 v27, v23, 4, v27
v_lshrrev_b32 v24, 2, v21
v_lshl_add_u32 v25, v22, 3, v24
v_lshlrev_b32 v28, 6, v25
v_lshl_add_u32 v28, v23, 3, v28
v_add_u32 v28, 57344, v28
v_and_b32 v25, 1, v22
v_lshlrev_b32 v29, 10, v25
v_lshrrev_b32 v25, 1, v22
v_lshl_add_u32 v29, v25, 8, v29
v_and_b32 v25, 1, v24
v_lshl_add_u32 v29, v25, 6, v29
v_lshrrev_b32 v25, 1, v24
v_lshl_add_u32 v29, v25, 3, v29
v_lshl_add_u32 v29, v23, 4, v29
v_add_u32 v29, 57344, v29
s_lshl_b32 s54, s32, 8
s_add_u32 s54, s54, 64
s_mul_i32 s55, s32, 147456
s_waitcnt lgkmcnt(0)
s_add_u32 s56, s54, 524288
s_mov_b32 m0, 69632
s_nop 0
buffer_load_dwordx4 v26, s[8:11], s56 offen lds
s_add_u32 s56, s54, 655360
s_mov_b32 m0, 70656
s_nop 0
buffer_load_dwordx4 v26, s[8:11], s56 offen lds
s_add_u32 s56, s54, 786432
s_mov_b32 m0, 71680
s_nop 0
buffer_load_dwordx4 v26, s[8:11], s56 offen lds
s_add_u32 s56, s54, 917504
s_mov_b32 m0, 72704
s_nop 0
buffer_load_dwordx4 v26, s[8:11], s56 offen lds
s_add_u32 s56, s54, 1048576
s_mov_b32 m0, 73728
s_nop 0
buffer_load_dwordx4 v26, s[8:11], s56 offen lds
s_add_u32 s56, s54, 1179648
s_mov_b32 m0, 74752
s_nop 0
buffer_load_dwordx4 v26, s[8:11], s56 offen lds
s_add_u32 s56, s54, 1310720
s_mov_b32 m0, 75776
s_nop 0
buffer_load_dwordx4 v26, s[8:11], s56 offen lds
s_add_u32 s56, s54, 1441792
s_mov_b32 m0, 76800
s_nop 0
buffer_load_dwordx4 v26, s[8:11], s56 offen lds
s_add_u32 s56, s54, 2621440
s_mov_b32 m0, 77824
s_nop 0
buffer_load_dwordx4 v26, s[8:11], s56 offen lds
s_add_u32 s56, s54, 2752512
s_mov_b32 m0, 78848
s_nop 0
buffer_load_dwordx4 v26, s[8:11], s56 offen lds
s_add_u32 s56, s54, 2883584
s_mov_b32 m0, 79872
s_nop 0
buffer_load_dwordx4 v26, s[8:11], s56 offen lds
s_add_u32 s56, s54, 3014656
s_mov_b32 m0, 80896
s_nop 0
buffer_load_dwordx4 v26, s[8:11], s56 offen lds
s_add_u32 s56, s54, 3145728
s_mov_b32 m0, 81920
s_nop 0
buffer_load_dwordx4 v26, s[8:11], s56 offen lds
s_add_u32 s56, s54, 3276800
s_mov_b32 m0, 82944
s_nop 0
buffer_load_dwordx4 v26, s[8:11], s56 offen lds
s_add_u32 s56, s54, 3407872
s_mov_b32 m0, 83968
s_nop 0
buffer_load_dwordx4 v26, s[8:11], s56 offen lds
s_add_u32 s56, s54, 3538944
s_mov_b32 m0, 84992
s_nop 0
buffer_load_dwordx4 v26, s[8:11], s56 offen lds
s_add_u32 s56, s54, 3670016
s_mov_b32 m0, 86016
s_nop 0
buffer_load_dwordx4 v26, s[8:11], s56 offen lds
s_add_u32 s56, s54, 3801088
s_mov_b32 m0, 87040
s_nop 0
buffer_load_dwordx4 v26, s[8:11], s56 offen lds
s_add_u32 s56, s54, 3932160
s_mov_b32 m0, 88064
s_nop 0
buffer_load_dwordx4 v26, s[8:11], s56 offen lds
s_add_u32 s56, s54, 4063232
s_mov_b32 m0, 89088
s_nop 0
buffer_load_dwordx4 v26, s[8:11], s56 offen lds
s_add_u32 s56, s54, 4194304
s_mov_b32 m0, 90112
s_nop 0
buffer_load_dwordx4 v26, s[8:11], s56 offen lds
s_add_u32 s56, s54, 4325376
s_mov_b32 m0, 91136
s_nop 0
buffer_load_dwordx4 v26, s[8:11], s56 offen lds
s_add_u32 s56, s54, 4456448
s_mov_b32 m0, 92160
s_nop 0
buffer_load_dwordx4 v26, s[8:11], s56 offen lds
s_add_u32 s56, s54, 4587520
s_mov_b32 m0, 93184
s_nop 0
buffer_load_dwordx4 v26, s[8:11], s56 offen lds
s_add_u32 s56, s54, 0
s_mov_b32 m0, 94208
s_nop 0
buffer_load_dwordx4 v26, s[12:15], s56 offen lds
s_add_u32 s56, s54, 131072
s_mov_b32 m0, 95232
s_nop 0
buffer_load_dwordx4 v26, s[12:15], s56 offen lds
s_add_u32 s56, s54, 262144
s_mov_b32 m0, 96256
s_nop 0
buffer_load_dwordx4 v26, s[12:15], s56 offen lds
s_add_u32 s56, s54, 393216
s_mov_b32 m0, 97280
s_nop 0
buffer_load_dwordx4 v26, s[12:15], s56 offen lds
s_add_u32 s56, s54, 524288
s_mov_b32 m0, 57344
s_nop 0
buffer_load_dwordx4 v26, s[12:15], s56 offen lds
s_add_u32 s56, s54, 655360
s_mov_b32 m0, 58368
s_nop 0
buffer_load_dwordx4 v26, s[12:15], s56 offen lds
s_add_u32 s56, s54, 786432
s_mov_b32 m0, 59392
s_nop 0
buffer_load_dwordx4 v26, s[12:15], s56 offen lds
s_add_u32 s56, s54, 917504
s_mov_b32 m0, 60416
s_nop 0
buffer_load_dwordx4 v26, s[12:15], s56 offen lds
s_add_u32 s56, s54, 1048576
s_mov_b32 m0, 61440
s_nop 0
buffer_load_dwordx4 v26, s[12:15], s56 offen lds
s_add_u32 s56, s54, 1179648
s_mov_b32 m0, 62464
s_nop 0
buffer_load_dwordx4 v26, s[12:15], s56 offen lds
s_add_u32 s56, s54, 1310720
s_mov_b32 m0, 63488
s_nop 0
buffer_load_dwordx4 v26, s[12:15], s56 offen lds
s_add_u32 s56, s54, 1441792
s_mov_b32 m0, 64512
s_nop 0
buffer_load_dwordx4 v26, s[12:15], s56 offen lds
v_bfe_u32 v23, v21, 1, 1
v_and_b32 v24, 1, v21
v_lshl_add_u32 v23, v24, 16, v23
v_mul_u32_u24 v23, 0xaaaa, v23
v_add_u32 v0, 0x44444444, v23
v_lshlrev_b32 v3, 3, v20
v_lshrrev_b32 v25, 5, v20
v_lshlrev_b32 v25, 6, v25
v_xor_b32 v3, v3, v25
v_lshrrev_b32 v25, 2, v20
v_and_b32 v4, 3, v21
v_lshl_add_u32 v4, v4, 4, v25
v_lshlrev_b32 v4, 3, v4
v_bfe_u32 v25, v21, 1, 1
v_lshlrev_b32 v23, 6, v25
v_xor_b32 v4, v4, v23
v_and_b32 v23, 2, v22
v_xor_b32 v5, v21, v23
v_lshlrev_b32 v5, 4, v5
v_lshl_add_u32 v5, v25, 10, v5
v_and_b32 v23, 1, v22
v_lshl_add_u32 v5, v23, 3, v5
v_lshlrev_b32 v9, 8, v22
v_lshl_add_u32 v9, v25, 6, v9
v_bfe_u32 v23, v21, 3, 1
v_lshl_add_u32 v9, v23, 7, v9
v_bfe_u32 v23, v21, 2, 1
v_lshl_add_u32 v9, v23, 5, v9
v_and_b32 v23, 1, v21
v_lshl_add_u32 v9, v23, 4, v9
v_lshrrev_b32 v23, 1, v22
v_and_b32 v24, 1, v22
v_and_b32 v25, 7, v21
v_lshrrev_b32 v7, 3, v21
v_lshl_add_u32 v8, v7, 1, v23
v_lshlrev_b32 v8, 12, v8
v_lshl_add_u32 v8, v24, 7, v8
v_and_b32 v25, 4, v21
v_lshl_add_u32 v8, v25, 3, v8
v_and_b32 v25, 1, v21
v_lshl_add_u32 v8, v25, 4, v8
v_bfe_u32 v25, v21, 1, 1
v_lshl_add_u32 v8, v25, 3, v8
s_lshr_b32 s56, s32, 1
s_lshl_b32 s56, s56, 8
s_and_b32 s57, s32, 1
s_lshl_b32 s57, s57, 6
s_add_u32 s56, s56, s57
s_add_u32 s56, s56, 16384
v_add_u32 v8, s56, v8
v_and_b32 v7, 12, v21
v_bfe_u32 v25, v21, 1, 1
v_add_u32 v7, v7, v25
v_lshlrev_b32 v7, 4, v7
v_lshl_add_u32 v7, v22, 8, v7
s_mov_b32 s42, 0
s_mov_b32 s43, 65536
s_mov_b32 s44, 131072
s_mov_b32 s45, 196608
s_mov_b32 s46, 262144
s_mov_b32 s47, 294912
s_mov_b32 s48, 299008
s_mov_b32 s49, 303104
s_mov_b32 s50, 0x3e0293ee
s_mov_b32 s51, 0x3e0293ee
s_mov_b32 s52, 0x3f803f80
s_mov_b32 s53, 0x3f803f80
v_and_b32 v11, 3, v21
v_cmp_eq_u32 vcc, 0, v11
s_nop 1
v_cndmask_b32 v11, 0, 1, vcc
s_mov_b32 s34, 0
s_mov_b32 s35, -1
s_mov_b32 s36, 0
s_mov_b32 s41, 2000000
s_lshl_b32 s37, s32, 14
s_add_u32 s39, s37, 17305600
s_add_u32 s37, s37, 16781312
s_mov_b32 s40, 8749056
v_mov_b64 v[36:37], 0
v_mov_b64 v[38:39], 0
s_lshl_b32 s56, s32, 1
s_add_u32 s56, s56, 0
s_cmp_eq_u32 s56, 0
s_cselect_b32 s56, 64, s56
s_mul_i32 s56, s56, 10240
s_add_u32 s56, s56, 8392704
s_add_u32 s57, s56, 4096
v_mov_b32 v40, 0
v_mov_b32 v41, 0
v_mov_b32 v42, 0
v_mov_b32 v43, 0
buffer_store_dwordx4 v[40:43], v1, s[4:7], s56 offen offset:0 sc0 sc1
buffer_store_dwordx4 v[40:43], v1, s[4:7], s56 offen offset:1024 sc0 sc1
buffer_store_dwordx4 v[40:43], v1, s[4:7], s56 offen offset:2048 sc0 sc1
buffer_store_dwordx4 v[40:43], v1, s[4:7], s56 offen offset:3072 sc0 sc1
buffer_store_dwordx4 v[40:43], v1, s[4:7], s57 offen offset:0 sc0 sc1
s_add_u32 s56, s32, 64
s_lshl_b32 s3, s56, 12
v_and_b32 v23, 1, v21
v_bfe_u32 v24, v21, 2, 1
v_bfe_u32 v25, v21, 1, 1
s_lshl_b32 s57, s56, 7
s_add_u32 s57, s57, 294912
v_and_b32 v10, 7, v21
v_lshlrev_b32 v10, 2, v10
v_lshl_add_u32 v10, v22, 5, v10
v_add_u32 v10, s57, v10
s_lshl_b32 s33, s56, 2
s_add_u32 s33, s33, 304128
v_mov_b32 v30, -1
s_mov_b64 exec, 1
buffer_store_dword v30, v1, s[4:7], s33 offen sc0 sc1
s_mov_b64 exec, -1
v_lshl_add_u32 v23, v23, 1, v24
v_lshlrev_b32 v25, 4, v25
v_mov_b32 v24, 0x3f80
v_lshlrev_b32 v24, v25, v24
v_cmp_eq_u32 vcc, 0, v23
s_nop 1
v_cndmask_b32 v76, 0, v24, vcc
v_cmp_eq_u32 vcc, 1, v23
s_nop 1
v_cndmask_b32 v77, 0, v24, vcc
v_cmp_eq_u32 vcc, 2, v23
s_nop 1
v_cndmask_b32 v78, 0, v24, vcc
v_cmp_eq_u32 vcc, 3, v23
s_nop 1
v_cndmask_b32 v79, 0, v24, vcc
buffer_store_dwordx4 v[36:39], v9, s[4:7], s3 offen offset:0 sc0 sc1
buffer_store_dwordx4 v[36:39], v9, s[4:7], s3 offen offset:1024 sc0 sc1
buffer_store_dwordx4 v[36:39], v9, s[4:7], s3 offen offset:2048 sc0 sc1
buffer_store_dwordx4 v[36:39], v9, s[4:7], s3 offen offset:3072 sc0 sc1
s_waitcnt vmcnt(0) lgkmcnt(0)
s_barrier
s_getreg_b32 s56, hwreg(HW_REG_XCC_ID)
s_and_b32 s56, s56, 15
s_mul_i32 s57, s56, s56
s_lshl_b32 s57, s57, 18
s_lshl_b32 s56, s56, 8
s_add_u32 s57, s57, s56
s_add_u32 s58, s57, 1
ds_read_b64_tr_b16 v[80:81], v28 offset:12288
ds_read_b64_tr_b16 v[82:83], v28 offset:12544
ds_read_b64_tr_b16 v[84:85], v28 offset:14336
ds_read_b64_tr_b16 v[86:87], v28 offset:14592
ds_read_b64_tr_b16 v[88:89], v28 offset:12320
ds_read_b64_tr_b16 v[90:91], v28 offset:12576
ds_read_b64_tr_b16 v[92:93], v28 offset:14368
ds_read_b64_tr_b16 v[94:95], v28 offset:14624
s_waitcnt lgkmcnt(0)
s_add_u32 s56, s54, 1572864
s_mov_b32 m0, 65536
s_nop 0
buffer_load_dwordx4 v26, s[12:15], s56 offen lds
s_add_u32 s56, s54, 1703936
s_mov_b32 m0, 66560
s_nop 0
buffer_load_dwordx4 v26, s[12:15], s56 offen lds
s_add_u32 s56, s54, 1835008
s_mov_b32 m0, 67584
s_nop 0
buffer_load_dwordx4 v26, s[12:15], s56 offen lds
s_add_u32 s56, s54, 1966080
s_mov_b32 m0, 68608
s_nop 0
buffer_load_dwordx4 v26, s[12:15], s56 offen lds
ds_read_b64_tr_b16 v[96:97], v28 offset:16384
ds_read_b64_tr_b16 v[98:99], v28 offset:16640
ds_read_b64_tr_b16 v[100:101], v28 offset:18432
ds_read_b64_tr_b16 v[102:103], v28 offset:18688
ds_read_b64_tr_b16 v[104:105], v28 offset:16416
ds_read_b64_tr_b16 v[106:107], v28 offset:16672
ds_read_b64_tr_b16 v[108:109], v28 offset:18464
ds_read_b64_tr_b16 v[110:111], v28 offset:18720
s_waitcnt lgkmcnt(0)
s_add_u32 s56, s54, 2097152
s_mov_b32 m0, 69632
s_nop 0
buffer_load_dwordx4 v26, s[12:15], s56 offen lds
s_add_u32 s56, s54, 2228224
s_mov_b32 m0, 70656
s_nop 0
buffer_load_dwordx4 v26, s[12:15], s56 offen lds
s_add_u32 s56, s54, 2359296
s_mov_b32 m0, 71680
s_nop 0
buffer_load_dwordx4 v26, s[12:15], s56 offen lds
s_add_u32 s56, s54, 2490368
s_mov_b32 m0, 72704
s_nop 0
buffer_load_dwordx4 v26, s[12:15], s56 offen lds
ds_read_b64_tr_b16 v[112:113], v28 offset:20480
ds_read_b64_tr_b16 v[114:115], v28 offset:20736
ds_read_b64_tr_b16 v[116:117], v28 offset:22528
ds_read_b64_tr_b16 v[118:119], v28 offset:22784
ds_read_b64_tr_b16 v[120:121], v28 offset:20512
ds_read_b64_tr_b16 v[122:123], v28 offset:20768
ds_read_b64_tr_b16 v[124:125], v28 offset:22560
ds_read_b64_tr_b16 v[126:127], v28 offset:22816
s_waitcnt lgkmcnt(0)
s_add_u32 s56, s54, 3145728
s_mov_b32 m0, 73728
s_nop 0
buffer_load_dwordx4 v26, s[12:15], s56 offen lds
s_add_u32 s56, s54, 3276800
s_mov_b32 m0, 74752
s_nop 0
buffer_load_dwordx4 v26, s[12:15], s56 offen lds
s_add_u32 s56, s54, 3407872
s_mov_b32 m0, 75776
s_nop 0
buffer_load_dwordx4 v26, s[12:15], s56 offen lds
s_add_u32 s56, s54, 3538944
s_mov_b32 m0, 76800
s_nop 0
buffer_load_dwordx4 v26, s[12:15], s56 offen lds
ds_read_b64_tr_b16 v[128:129], v28 offset:24576
ds_read_b64_tr_b16 v[130:131], v28 offset:24832
ds_read_b64_tr_b16 v[132:133], v28 offset:26624
ds_read_b64_tr_b16 v[134:135], v28 offset:26880
ds_read_b64_tr_b16 v[136:137], v28 offset:24608
ds_read_b64_tr_b16 v[138:139], v28 offset:24864
ds_read_b64_tr_b16 v[140:141], v28 offset:26656
ds_read_b64_tr_b16 v[142:143], v28 offset:26912
s_waitcnt lgkmcnt(0)
s_add_u32 s56, s54, 3670016
s_mov_b32 m0, 77824
s_nop 0
buffer_load_dwordx4 v26, s[12:15], s56 offen lds
s_add_u32 s56, s54, 3801088
s_mov_b32 m0, 78848
s_nop 0
buffer_load_dwordx4 v26, s[12:15], s56 offen lds
s_add_u32 s56, s54, 3932160
s_mov_b32 m0, 79872
s_nop 0
buffer_load_dwordx4 v26, s[12:15], s56 offen lds
s_add_u32 s56, s54, 4063232
s_mov_b32 m0, 80896
s_nop 0
buffer_load_dwordx4 v26, s[12:15], s56 offen lds
ds_read_b64_tr_b16 v[144:145], v28 offset:28672
ds_read_b64_tr_b16 v[146:147], v28 offset:28928
ds_read_b64_tr_b16 v[148:149], v28 offset:30720
ds_read_b64_tr_b16 v[150:151], v28 offset:30976
ds_read_b64_tr_b16 v[152:153], v28 offset:28704
ds_read_b64_tr_b16 v[154:155], v28 offset:28960
ds_read_b64_tr_b16 v[156:157], v28 offset:30752
ds_read_b64_tr_b16 v[158:159], v28 offset:31008
s_waitcnt lgkmcnt(0)
s_add_u32 s56, s54, 4194304
s_mov_b32 m0, 81920
s_nop 0
buffer_load_dwordx4 v26, s[12:15], s56 offen lds
s_add_u32 s56, s54, 4325376
s_mov_b32 m0, 82944
s_nop 0
buffer_load_dwordx4 v26, s[12:15], s56 offen lds
s_add_u32 s56, s54, 4456448
s_mov_b32 m0, 83968
s_nop 0
buffer_load_dwordx4 v26, s[12:15], s56 offen lds
s_add_u32 s56, s54, 4587520
s_mov_b32 m0, 84992
s_nop 0
buffer_load_dwordx4 v26, s[12:15], s56 offen lds
ds_read_b64_tr_b16 v[160:161], v28 offset:32768
ds_read_b64_tr_b16 v[162:163], v28 offset:33024
ds_read_b64_tr_b16 v[164:165], v28 offset:34816
ds_read_b64_tr_b16 v[166:167], v28 offset:35072
ds_read_b64_tr_b16 v[168:169], v28 offset:32800
ds_read_b64_tr_b16 v[170:171], v28 offset:33056
ds_read_b64_tr_b16 v[172:173], v28 offset:34848
ds_read_b64_tr_b16 v[174:175], v28 offset:35104
s_waitcnt lgkmcnt(0)
s_add_u32 s56, s54, 0
s_mov_b32 m0, 86016
s_nop 0
buffer_load_dwordx4 v26, s[16:19], s56 offen lds
s_add_u32 s56, s54, 131072
s_mov_b32 m0, 87040
s_nop 0
buffer_load_dwordx4 v26, s[16:19], s56 offen lds
s_add_u32 s56, s54, 262144
s_mov_b32 m0, 88064
s_nop 0
buffer_load_dwordx4 v26, s[16:19], s56 offen lds
s_add_u32 s56, s54, 393216
s_mov_b32 m0, 89088
s_nop 0
buffer_load_dwordx4 v26, s[16:19], s56 offen lds
ds_read_b64_tr_b16 v[176:177], v28 offset:36864
ds_read_b64_tr_b16 v[178:179], v28 offset:37120
ds_read_b64_tr_b16 v[180:181], v28 offset:38912
ds_read_b64_tr_b16 v[182:183], v28 offset:39168
ds_read_b64_tr_b16 v[184:185], v28 offset:36896
ds_read_b64_tr_b16 v[186:187], v28 offset:37152
ds_read_b64_tr_b16 v[188:189], v28 offset:38944
ds_read_b64_tr_b16 v[190:191], v28 offset:39200
s_waitcnt lgkmcnt(0)
s_add_u32 s56, s54, 524288
s_mov_b32 m0, 90112
s_nop 0
buffer_load_dwordx4 v26, s[16:19], s56 offen lds
s_add_u32 s56, s54, 655360
s_mov_b32 m0, 91136
s_nop 0
buffer_load_dwordx4 v26, s[16:19], s56 offen lds
s_add_u32 s56, s54, 786432
s_mov_b32 m0, 92160
s_nop 0
buffer_load_dwordx4 v26, s[16:19], s56 offen lds
s_add_u32 s56, s54, 917504
s_mov_b32 m0, 93184
s_nop 0
buffer_load_dwordx4 v26, s[16:19], s56 offen lds
ds_read_b64_tr_b16 v[192:193], v28 offset:0
ds_read_b64_tr_b16 v[194:195], v28 offset:256
ds_read_b64_tr_b16 v[196:197], v28 offset:2048
ds_read_b64_tr_b16 v[198:199], v28 offset:2304
ds_read_b64_tr_b16 v[200:201], v28 offset:32
ds_read_b64_tr_b16 v[202:203], v28 offset:288
ds_read_b64_tr_b16 v[204:205], v28 offset:2080
ds_read_b64_tr_b16 v[206:207], v28 offset:2336
s_waitcnt lgkmcnt(0)
s_add_u32 s56, s54, 1048576
s_mov_b32 m0, 94208
s_nop 0
buffer_load_dwordx4 v26, s[16:19], s56 offen lds
s_add_u32 s56, s54, 1179648
s_mov_b32 m0, 95232
s_nop 0
buffer_load_dwordx4 v26, s[16:19], s56 offen lds
s_add_u32 s56, s54, 1310720
s_mov_b32 m0, 96256
s_nop 0
buffer_load_dwordx4 v26, s[16:19], s56 offen lds
s_add_u32 s56, s54, 1441792
s_mov_b32 m0, 97280
s_nop 0
buffer_load_dwordx4 v26, s[16:19], s56 offen lds
ds_read_b64_tr_b16 v[208:209], v28 offset:4096
ds_read_b64_tr_b16 v[210:211], v28 offset:4352
ds_read_b64_tr_b16 v[212:213], v28 offset:6144
ds_read_b64_tr_b16 v[214:215], v28 offset:6400
ds_read_b64_tr_b16 v[216:217], v28 offset:4128
ds_read_b64_tr_b16 v[218:219], v28 offset:4384
ds_read_b64_tr_b16 v[220:221], v28 offset:6176
ds_read_b64_tr_b16 v[222:223], v28 offset:6432
s_waitcnt lgkmcnt(0)
s_add_u32 s56, s54, 1572864
s_mov_b32 m0, 57344
s_nop 0
buffer_load_dwordx4 v26, s[16:19], s56 offen lds
s_add_u32 s56, s54, 1703936
s_mov_b32 m0, 58368
s_nop 0
buffer_load_dwordx4 v26, s[16:19], s56 offen lds
s_add_u32 s56, s54, 1835008
s_mov_b32 m0, 59392
s_nop 0
buffer_load_dwordx4 v26, s[16:19], s56 offen lds
s_add_u32 s56, s54, 1966080
s_mov_b32 m0, 60416
s_nop 0
buffer_load_dwordx4 v26, s[16:19], s56 offen lds
s_waitcnt vmcnt(32)
ds_read_b64_tr_b16 v[224:225], v28 offset:8192
ds_read_b64_tr_b16 v[226:227], v28 offset:8448
ds_read_b64_tr_b16 v[228:229], v28 offset:10240
ds_read_b64_tr_b16 v[230:231], v28 offset:10496
ds_read_b64_tr_b16 v[232:233], v28 offset:8224
ds_read_b64_tr_b16 v[234:235], v28 offset:8480
ds_read_b64_tr_b16 v[236:237], v28 offset:10272
ds_read_b64_tr_b16 v[238:239], v28 offset:10528
s_waitcnt lgkmcnt(0)
s_add_u32 s56, s54, 2097152
s_mov_b32 m0, 61440
s_nop 0
buffer_load_dwordx4 v26, s[16:19], s56 offen lds
s_add_u32 s56, s54, 2228224
s_mov_b32 m0, 62464
s_nop 0
buffer_load_dwordx4 v26, s[16:19], s56 offen lds
s_add_u32 s56, s54, 2359296
s_mov_b32 m0, 63488
s_nop 0
buffer_load_dwordx4 v26, s[16:19], s56 offen lds
s_add_u32 s56, s54, 2490368
s_mov_b32 m0, 64512
s_nop 0
buffer_load_dwordx4 v26, s[16:19], s56 offen lds
s_waitcnt vmcnt(32)
ds_read_b64_tr_b16 v[240:241], v28 offset:12288
ds_read_b64_tr_b16 v[242:243], v28 offset:12544
ds_read_b64_tr_b16 v[244:245], v28 offset:14336
ds_read_b64_tr_b16 v[246:247], v28 offset:14592
ds_read_b64_tr_b16 v[248:249], v28 offset:12320
ds_read_b64_tr_b16 v[250:251], v28 offset:12576
ds_read_b64_tr_b16 v[252:253], v28 offset:14368
ds_read_b64_tr_b16 v[254:255], v28 offset:14624
s_waitcnt lgkmcnt(0)
s_add_u32 s56, s54, 2621440
s_mov_b32 m0, 65536
s_nop 0
buffer_load_dwordx4 v26, s[16:19], s56 offen lds
s_add_u32 s56, s54, 2752512
s_mov_b32 m0, 66560
s_nop 0
buffer_load_dwordx4 v26, s[16:19], s56 offen lds
s_add_u32 s56, s54, 2883584
s_mov_b32 m0, 67584
s_nop 0
buffer_load_dwordx4 v26, s[16:19], s56 offen lds
s_add_u32 s56, s54, 3014656
s_mov_b32 m0, 68608
s_nop 0
buffer_load_dwordx4 v26, s[16:19], s56 offen lds
s_waitcnt vmcnt(32)
ds_read_b64_tr_b16 a[0:1], v28 offset:16384
ds_read_b64_tr_b16 a[2:3], v28 offset:16640
ds_read_b64_tr_b16 a[4:5], v28 offset:18432
ds_read_b64_tr_b16 a[6:7], v28 offset:18688
ds_read_b64_tr_b16 a[8:9], v28 offset:16416
ds_read_b64_tr_b16 a[10:11], v28 offset:16672
ds_read_b64_tr_b16 a[12:13], v28 offset:18464
ds_read_b64_tr_b16 a[14:15], v28 offset:18720
s_waitcnt lgkmcnt(0)
s_add_u32 s56, s54, 3145728
s_mov_b32 m0, 69632
s_nop 0
buffer_load_dwordx4 v26, s[16:19], s56 offen lds
s_add_u32 s56, s54, 3276800
s_mov_b32 m0, 70656
s_nop 0
buffer_load_dwordx4 v26, s[16:19], s56 offen lds
s_add_u32 s56, s54, 3407872
s_mov_b32 m0, 71680
s_nop 0
buffer_load_dwordx4 v26, s[16:19], s56 offen lds
s_add_u32 s56, s54, 3538944
s_mov_b32 m0, 72704
s_nop 0
buffer_load_dwordx4 v26, s[16:19], s56 offen lds
s_waitcnt vmcnt(32)
ds_read_b64_tr_b16 a[16:17], v28 offset:20480
ds_read_b64_tr_b16 a[18:19], v28 offset:20736
ds_read_b64_tr_b16 a[20:21], v28 offset:22528
ds_read_b64_tr_b16 a[22:23], v28 offset:22784
ds_read_b64_tr_b16 a[24:25], v28 offset:20512
ds_read_b64_tr_b16 a[26:27], v28 offset:20768
ds_read_b64_tr_b16 a[28:29], v28 offset:22560
ds_read_b64_tr_b16 a[30:31], v28 offset:22816
s_waitcnt lgkmcnt(0)
s_add_u32 s56, s54, 3670016
s_mov_b32 m0, 73728
s_nop 0
buffer_load_dwordx4 v26, s[16:19], s56 offen lds
s_add_u32 s56, s54, 3801088
s_mov_b32 m0, 74752
s_nop 0
buffer_load_dwordx4 v26, s[16:19], s56 offen lds
s_add_u32 s56, s54, 3932160
s_mov_b32 m0, 75776
s_nop 0
buffer_load_dwordx4 v26, s[16:19], s56 offen lds
s_add_u32 s56, s54, 4063232
s_mov_b32 m0, 76800
s_nop 0
buffer_load_dwordx4 v26, s[16:19], s56 offen lds
s_waitcnt vmcnt(32)
ds_read_b64_tr_b16 a[32:33], v28 offset:24576
ds_read_b64_tr_b16 a[34:35], v28 offset:24832
ds_read_b64_tr_b16 a[36:37], v28 offset:26624
ds_read_b64_tr_b16 a[38:39], v28 offset:26880
ds_read_b64_tr_b16 a[40:41], v28 offset:24608
ds_read_b64_tr_b16 a[42:43], v28 offset:24864
ds_read_b64_tr_b16 a[44:45], v28 offset:26656
ds_read_b64_tr_b16 a[46:47], v28 offset:26912
s_waitcnt lgkmcnt(0)
s_add_u32 s56, s55, 73792
s_mov_b32 m0, 77824
s_nop 0
buffer_load_dwordx4 v27, s[20:23], s56 offen lds
s_add_u32 s56, s55, 92224
s_mov_b32 m0, 78848
s_nop 0
buffer_load_dwordx4 v27, s[20:23], s56 offen lds
s_add_u32 s56, s55, 64
s_mov_b32 m0, 79872
s_nop 0
buffer_load_dwordx4 v27, s[20:23], s56 offen lds
s_add_u32 s56, s55, 18496
s_mov_b32 m0, 80896
s_nop 0
buffer_load_dwordx4 v27, s[20:23], s56 offen lds
s_waitcnt vmcnt(32)
ds_read_b64_tr_b16 a[48:49], v28 offset:28672
ds_read_b64_tr_b16 a[50:51], v28 offset:28928
ds_read_b64_tr_b16 a[52:53], v28 offset:30720
ds_read_b64_tr_b16 a[54:55], v28 offset:30976
ds_read_b64_tr_b16 a[56:57], v28 offset:28704
ds_read_b64_tr_b16 a[58:59], v28 offset:28960
ds_read_b64_tr_b16 a[60:61], v28 offset:30752
ds_read_b64_tr_b16 a[62:63], v28 offset:31008
s_waitcnt lgkmcnt(0)
s_add_u32 s56, s55, 74048
s_mov_b32 m0, 81920
s_nop 0
buffer_load_dwordx4 v27, s[20:23], s56 offen lds
s_add_u32 s56, s55, 92480
s_mov_b32 m0, 82944
s_nop 0
buffer_load_dwordx4 v27, s[20:23], s56 offen lds
s_add_u32 s56, s55, 320
s_mov_b32 m0, 83968
s_nop 0
buffer_load_dwordx4 v27, s[20:23], s56 offen lds
s_add_u32 s56, s55, 18752
s_mov_b32 m0, 84992
s_nop 0
buffer_load_dwordx4 v27, s[20:23], s56 offen lds
s_waitcnt vmcnt(32)
ds_read_b64_tr_b16 a[64:65], v28 offset:32768
ds_read_b64_tr_b16 a[66:67], v28 offset:33024
ds_read_b64_tr_b16 a[68:69], v28 offset:34816
ds_read_b64_tr_b16 a[70:71], v28 offset:35072
ds_read_b64_tr_b16 a[72:73], v28 offset:32800
ds_read_b64_tr_b16 a[74:75], v28 offset:33056
ds_read_b64_tr_b16 a[76:77], v28 offset:34848
ds_read_b64_tr_b16 a[78:79], v28 offset:35104
s_waitcnt lgkmcnt(0)
s_add_u32 s56, s55, 74304
s_mov_b32 m0, 86016
s_nop 0
buffer_load_dwordx4 v27, s[20:23], s56 offen lds
s_add_u32 s56, s55, 92736
s_mov_b32 m0, 87040
s_nop 0
buffer_load_dwordx4 v27, s[20:23], s56 offen lds
s_add_u32 s56, s55, 576
s_mov_b32 m0, 88064
s_nop 0
buffer_load_dwordx4 v27, s[20:23], s56 offen lds
s_add_u32 s56, s55, 19008
s_mov_b32 m0, 89088
s_nop 0
buffer_load_dwordx4 v27, s[20:23], s56 offen lds
s_waitcnt vmcnt(32)
ds_read_b64_tr_b16 a[80:81], v28 offset:36864
ds_read_b64_tr_b16 a[82:83], v28 offset:37120
ds_read_b64_tr_b16 a[84:85], v28 offset:38912
ds_read_b64_tr_b16 a[86:87], v28 offset:39168
ds_read_b64_tr_b16 a[88:89], v28 offset:36896
ds_read_b64_tr_b16 a[90:91], v28 offset:37152
ds_read_b64_tr_b16 a[92:93], v28 offset:38944
ds_read_b64_tr_b16 a[94:95], v28 offset:39200
s_waitcnt lgkmcnt(0)
s_add_u32 s56, s55, 74560
s_mov_b32 m0, 90112
s_nop 0
buffer_load_dwordx4 v27, s[20:23], s56 offen lds
s_add_u32 s56, s55, 92992
s_mov_b32 m0, 91136
s_nop 0
buffer_load_dwordx4 v27, s[20:23], s56 offen lds
s_add_u32 s56, s55, 832
s_mov_b32 m0, 92160
s_nop 0
buffer_load_dwordx4 v27, s[20:23], s56 offen lds
s_add_u32 s56, s55, 19264
s_mov_b32 m0, 93184
s_nop 0
buffer_load_dwordx4 v27, s[20:23], s56 offen lds
s_waitcnt vmcnt(32)
ds_read_b64_tr_b16 a[96:97], v28 offset:0
ds_read_b64_tr_b16 a[98:99], v28 offset:256
ds_read_b64_tr_b16 a[100:101], v28 offset:2048
ds_read_b64_tr_b16 a[102:103], v28 offset:2304
ds_read_b64_tr_b16 a[104:105], v28 offset:32
ds_read_b64_tr_b16 a[106:107], v28 offset:288
ds_read_b64_tr_b16 a[108:109], v28 offset:2080
ds_read_b64_tr_b16 a[110:111], v28 offset:2336
s_waitcnt lgkmcnt(0)
s_add_u32 s56, s55, 74816
s_mov_b32 m0, 94208
s_nop 0
buffer_load_dwordx4 v27, s[20:23], s56 offen lds
s_add_u32 s56, s55, 93248
s_mov_b32 m0, 95232
s_nop 0
buffer_load_dwordx4 v27, s[20:23], s56 offen lds
s_add_u32 s56, s55, 1088
s_mov_b32 m0, 96256
s_nop 0
buffer_load_dwordx4 v27, s[20:23], s56 offen lds
s_add_u32 s56, s55, 19520
s_mov_b32 m0, 97280
s_nop 0
buffer_load_dwordx4 v27, s[20:23], s56 offen lds
s_waitcnt vmcnt(32)
ds_read_b64_tr_b16 a[112:113], v28 offset:4096
ds_read_b64_tr_b16 a[114:115], v28 offset:4352
ds_read_b64_tr_b16 a[116:117], v28 offset:6144
ds_read_b64_tr_b16 a[118:119], v28 offset:6400
ds_read_b64_tr_b16 a[120:121], v28 offset:4128
ds_read_b64_tr_b16 a[122:123], v28 offset:4384
ds_read_b64_tr_b16 a[124:125], v28 offset:6176
ds_read_b64_tr_b16 a[126:127], v28 offset:6432
s_waitcnt lgkmcnt(0)
s_add_u32 s56, s54, 0
s_mov_b32 m0, 57344
s_nop 0
buffer_load_dwordx4 v26, s[8:11], s56 offen lds
s_add_u32 s56, s54, 131072
s_mov_b32 m0, 58368
s_nop 0
buffer_load_dwordx4 v26, s[8:11], s56 offen lds
s_add_u32 s56, s54, 262144
s_mov_b32 m0, 59392
s_nop 0
buffer_load_dwordx4 v26, s[8:11], s56 offen lds
s_add_u32 s56, s54, 393216
s_mov_b32 m0, 60416
s_nop 0
buffer_load_dwordx4 v26, s[8:11], s56 offen lds
s_waitcnt vmcnt(32)
ds_read_b64_tr_b16 a[128:129], v28 offset:8192
ds_read_b64_tr_b16 a[130:131], v28 offset:8448
ds_read_b64_tr_b16 a[132:133], v28 offset:10240
ds_read_b64_tr_b16 a[134:135], v28 offset:10496
ds_read_b64_tr_b16 a[136:137], v28 offset:8224
ds_read_b64_tr_b16 a[138:139], v28 offset:8480
ds_read_b64_tr_b16 a[140:141], v28 offset:10272
ds_read_b64_tr_b16 a[142:143], v28 offset:10528
s_waitcnt lgkmcnt(0)
s_add_u32 s56, s54, 1572864
s_mov_b32 m0, 61440
s_nop 0
buffer_load_dwordx4 v26, s[8:11], s56 offen lds
s_add_u32 s56, s54, 1703936
s_mov_b32 m0, 62464
s_nop 0
buffer_load_dwordx4 v26, s[8:11], s56 offen lds
s_add_u32 s56, s54, 1835008
s_mov_b32 m0, 63488
s_nop 0
buffer_load_dwordx4 v26, s[8:11], s56 offen lds
s_add_u32 s56, s54, 1966080
s_mov_b32 m0, 64512
s_nop 0
buffer_load_dwordx4 v26, s[8:11], s56 offen lds
s_waitcnt vmcnt(32)
ds_read_b64_tr_b16 a[144:145], v28 offset:12288
ds_read_b64_tr_b16 a[146:147], v28 offset:12544
ds_read_b64_tr_b16 a[148:149], v28 offset:14336
ds_read_b64_tr_b16 a[150:151], v28 offset:14592
ds_read_b64_tr_b16 a[152:153], v28 offset:12320
ds_read_b64_tr_b16 a[154:155], v28 offset:12576
ds_read_b64_tr_b16 a[156:157], v28 offset:14368
ds_read_b64_tr_b16 a[158:159], v28 offset:14624
s_waitcnt lgkmcnt(0)
s_add_u32 s56, s54, 2097152
s_mov_b32 m0, 65536
s_nop 0
buffer_load_dwordx4 v26, s[8:11], s56 offen lds
s_add_u32 s56, s54, 2228224
s_mov_b32 m0, 66560
s_nop 0
buffer_load_dwordx4 v26, s[8:11], s56 offen lds
s_add_u32 s56, s54, 2359296
s_mov_b32 m0, 67584
s_nop 0
buffer_load_dwordx4 v26, s[8:11], s56 offen lds
s_add_u32 s56, s54, 2490368
s_mov_b32 m0, 68608
s_nop 0
buffer_load_dwordx4 v26, s[8:11], s56 offen lds
s_waitcnt vmcnt(32)
ds_read_b64_tr_b16 a[160:161], v28 offset:16384
ds_read_b64_tr_b16 a[162:163], v28 offset:16640
ds_read_b64_tr_b16 a[164:165], v28 offset:18432
ds_read_b64_tr_b16 a[166:167], v28 offset:18688
ds_read_b64_tr_b16 a[168:169], v28 offset:16416
ds_read_b64_tr_b16 a[170:171], v28 offset:16672
ds_read_b64_tr_b16 a[172:173], v28 offset:18464
ds_read_b64_tr_b16 a[174:175], v28 offset:18720
s_waitcnt lgkmcnt(0)
s_add_u32 s56, s54, 2621440
s_mov_b32 m0, 69632
s_nop 0
buffer_load_dwordx4 v26, s[12:15], s56 offen lds
s_add_u32 s56, s54, 2752512
s_mov_b32 m0, 70656
s_nop 0
buffer_load_dwordx4 v26, s[12:15], s56 offen lds
s_add_u32 s56, s54, 2883584
s_mov_b32 m0, 71680
s_nop 0
buffer_load_dwordx4 v26, s[12:15], s56 offen lds
s_add_u32 s56, s54, 3014656
s_mov_b32 m0, 72704
s_nop 0
buffer_load_dwordx4 v26, s[12:15], s56 offen lds
s_waitcnt vmcnt(32)
ds_read_b64_tr_b16 a[176:177], v29 offset:20480
ds_read_b64_tr_b16 a[178:179], v29 offset:20608
ds_read_b64_tr_b16 a[180:181], v29 offset:20992
ds_read_b64_tr_b16 a[182:183], v29 offset:21120
ds_read_b64_tr_b16 a[184:185], v29 offset:22528
ds_read_b64_tr_b16 a[186:187], v29 offset:22656
ds_read_b64_tr_b16 a[188:189], v29 offset:23040
ds_read_b64_tr_b16 a[190:191], v29 offset:23168
s_waitcnt lgkmcnt(0)
s_add_u32 s56, s54, 4194304
s_mov_b32 m0, 73728
s_nop 0
buffer_load_dwordx4 v26, s[16:19], s56 offen lds
s_add_u32 s56, s54, 4325376
s_mov_b32 m0, 74752
s_nop 0
buffer_load_dwordx4 v26, s[16:19], s56 offen lds
s_add_u32 s56, s54, 4456448
s_mov_b32 m0, 75776
s_nop 0
buffer_load_dwordx4 v26, s[16:19], s56 offen lds
s_add_u32 s56, s54, 4587520
s_mov_b32 m0, 76800
s_nop 0
buffer_load_dwordx4 v26, s[16:19], s56 offen lds
s_waitcnt vmcnt(32)
ds_read_b64_tr_b16 a[192:193], v29 offset:24576
ds_read_b64_tr_b16 a[194:195], v29 offset:24704
ds_read_b64_tr_b16 a[196:197], v29 offset:25088
ds_read_b64_tr_b16 a[198:199], v29 offset:25216
ds_read_b64_tr_b16 a[200:201], v29 offset:26624
ds_read_b64_tr_b16 a[202:203], v29 offset:26752
ds_read_b64_tr_b16 a[204:205], v29 offset:27136
ds_read_b64_tr_b16 a[206:207], v29 offset:27264
s_waitcnt lgkmcnt(0)
s_add_u32 s56, s55, 36928
s_mov_b32 m0, 77824
s_nop 0
buffer_load_dwordx4 v27, s[20:23], s56 offen lds
s_add_u32 s56, s55, 55360
s_mov_b32 m0, 78848
s_nop 0
buffer_load_dwordx4 v27, s[20:23], s56 offen lds
s_add_u32 s56, s55, 37184
s_mov_b32 m0, 79872
s_nop 0
buffer_load_dwordx4 v27, s[20:23], s56 offen lds
s_add_u32 s56, s55, 55616
s_mov_b32 m0, 80896
s_nop 0
buffer_load_dwordx4 v27, s[20:23], s56 offen lds
s_waitcnt vmcnt(32)
ds_read_b64_tr_b16 a[208:209], v29 offset:28672
ds_read_b64_tr_b16 a[210:211], v29 offset:28800
ds_read_b64_tr_b16 a[212:213], v29 offset:29184
ds_read_b64_tr_b16 a[214:215], v29 offset:29312
ds_read_b64_tr_b16 a[216:217], v29 offset:30720
ds_read_b64_tr_b16 a[218:219], v29 offset:30848
ds_read_b64_tr_b16 a[220:221], v29 offset:31232
ds_read_b64_tr_b16 a[222:223], v29 offset:31360
s_waitcnt lgkmcnt(0)
s_add_u32 s56, s55, 110656
s_mov_b32 m0, 81920
s_nop 0
buffer_load_dwordx4 v27, s[20:23], s56 offen lds
s_add_u32 s56, s55, 129088
s_mov_b32 m0, 82944
s_nop 0
buffer_load_dwordx4 v27, s[20:23], s56 offen lds
s_add_u32 s56, s55, 110912
s_mov_b32 m0, 83968
s_nop 0
buffer_load_dwordx4 v27, s[20:23], s56 offen lds
s_add_u32 s56, s55, 129344
s_mov_b32 m0, 84992
s_nop 0
buffer_load_dwordx4 v27, s[20:23], s56 offen lds
s_waitcnt vmcnt(32)
ds_read_b64_tr_b16 a[224:225], v29 offset:32768
ds_read_b64_tr_b16 a[226:227], v29 offset:32896
ds_read_b64_tr_b16 a[228:229], v29 offset:33280
ds_read_b64_tr_b16 a[230:231], v29 offset:33408
ds_read_b64_tr_b16 a[232:233], v29 offset:34816
ds_read_b64_tr_b16 a[234:235], v29 offset:34944
ds_read_b64_tr_b16 a[236:237], v29 offset:35328
ds_read_b64_tr_b16 a[238:239], v29 offset:35456
s_waitcnt lgkmcnt(0)
s_add_u32 s56, s55, 37440
s_mov_b32 m0, 86016
s_nop 0
buffer_load_dwordx4 v27, s[20:23], s56 offen lds
s_add_u32 s56, s55, 55872
s_mov_b32 m0, 87040
s_nop 0
buffer_load_dwordx4 v27, s[20:23], s56 offen lds
s_add_u32 s56, s55, 111168
s_mov_b32 m0, 88064
s_nop 0
buffer_load_dwordx4 v27, s[20:23], s56 offen lds
s_add_u32 s56, s55, 129600
s_mov_b32 m0, 89088
s_nop 0
buffer_load_dwordx4 v27, s[20:23], s56 offen lds
s_waitcnt vmcnt(32)
ds_read_b64_tr_b16 a[240:241], v29 offset:36864
ds_read_b64_tr_b16 a[242:243], v29 offset:36992
ds_read_b64_tr_b16 a[244:245], v29 offset:37376
ds_read_b64_tr_b16 a[246:247], v29 offset:37504
ds_read_b64_tr_b16 a[248:249], v29 offset:38912
ds_read_b64_tr_b16 a[250:251], v29 offset:39040
ds_read_b64_tr_b16 a[252:253], v29 offset:39424
ds_read_b64_tr_b16 a[254:255], v29 offset:39552
s_waitcnt lgkmcnt(0)
s_add_u32 s56, s55, 37696
s_mov_b32 m0, 90112
s_nop 0
buffer_load_dwordx4 v27, s[20:23], s56 offen lds
s_add_u32 s56, s55, 56128
s_mov_b32 m0, 91136
s_nop 0
buffer_load_dwordx4 v27, s[20:23], s56 offen lds
s_add_u32 s56, s55, 111424
s_mov_b32 m0, 92160
s_nop 0
buffer_load_dwordx4 v27, s[20:23], s56 offen lds
s_add_u32 s56, s55, 129856
s_mov_b32 m0, 93184
s_nop 0
buffer_load_dwordx4 v27, s[20:23], s56 offen lds
s_waitcnt vmcnt(32)
ds_read_b64_tr_b16 v[44:45], v28 offset:0
ds_read_b64_tr_b16 v[46:47], v28 offset:256
ds_read_b64_tr_b16 v[48:49], v28 offset:2048
ds_read_b64_tr_b16 v[50:51], v28 offset:2304
ds_read_b64_tr_b16 v[52:53], v28 offset:32
ds_read_b64_tr_b16 v[54:55], v28 offset:288
ds_read_b64_tr_b16 v[56:57], v28 offset:2080
ds_read_b64_tr_b16 v[58:59], v28 offset:2336
s_waitcnt lgkmcnt(0)
ds_write_b128 v2, v[44:47] offset:0
ds_write_b128 v2, v[48:51] offset:1024
ds_write_b128 v2, v[52:55] offset:2048
ds_write_b128 v2, v[56:59] offset:3072
s_waitcnt lgkmcnt(0)
s_add_u32 s56, s55, 37952
s_mov_b32 m0, 94208
s_nop 0
buffer_load_dwordx4 v27, s[20:23], s56 offen lds
s_add_u32 s56, s55, 56384
s_mov_b32 m0, 95232
s_nop 0
buffer_load_dwordx4 v27, s[20:23], s56 offen lds
s_add_u32 s56, s55, 111680
s_mov_b32 m0, 96256
s_nop 0
buffer_load_dwordx4 v27, s[20:23], s56 offen lds
s_add_u32 s56, s55, 130112
s_mov_b32 m0, 97280
s_nop 0
buffer_load_dwordx4 v27, s[20:23], s56 offen lds
s_waitcnt vmcnt(32)
ds_read_b64_tr_b16 v[44:45], v28 offset:4096
ds_read_b64_tr_b16 v[46:47], v28 offset:4352
ds_read_b64_tr_b16 v[48:49], v28 offset:6144
ds_read_b64_tr_b16 v[50:51], v28 offset:6400
ds_read_b64_tr_b16 v[52:53], v28 offset:4128
ds_read_b64_tr_b16 v[54:55], v28 offset:4384
ds_read_b64_tr_b16 v[56:57], v28 offset:6176
ds_read_b64_tr_b16 v[58:59], v28 offset:6432
s_waitcnt lgkmcnt(0)
ds_write_b128 v2, v[44:47] offset:4096
ds_write_b128 v2, v[48:51] offset:5120
ds_write_b128 v2, v[52:55] offset:6144
ds_write_b128 v2, v[56:59] offset:7168
s_waitcnt lgkmcnt(0)
s_waitcnt vmcnt(28)
ds_read_b64_tr_b16 v[44:45], v28 offset:8192
ds_read_b64_tr_b16 v[46:47], v28 offset:8448
ds_read_b64_tr_b16 v[48:49], v28 offset:10240
ds_read_b64_tr_b16 v[50:51], v28 offset:10496
ds_read_b64_tr_b16 v[52:53], v28 offset:8224
ds_read_b64_tr_b16 v[54:55], v28 offset:8480
ds_read_b64_tr_b16 v[56:57], v28 offset:10272
ds_read_b64_tr_b16 v[58:59], v28 offset:10528
s_waitcnt lgkmcnt(0)
ds_write_b128 v2, v[44:47] offset:8192
ds_write_b128 v2, v[48:51] offset:9216
ds_write_b128 v2, v[52:55] offset:10240
ds_write_b128 v2, v[56:59] offset:11264
s_waitcnt lgkmcnt(0)
s_waitcnt vmcnt(24)
ds_read_b64_tr_b16 v[44:45], v28 offset:12288
ds_read_b64_tr_b16 v[46:47], v28 offset:12544
ds_read_b64_tr_b16 v[48:49], v28 offset:14336
ds_read_b64_tr_b16 v[50:51], v28 offset:14592
ds_read_b64_tr_b16 v[52:53], v28 offset:12320
ds_read_b64_tr_b16 v[54:55], v28 offset:12576
ds_read_b64_tr_b16 v[56:57], v28 offset:14368
ds_read_b64_tr_b16 v[58:59], v28 offset:14624
s_waitcnt lgkmcnt(0)
ds_write_b128 v2, v[44:47] offset:12288
ds_write_b128 v2, v[48:51] offset:13312
ds_write_b128 v2, v[52:55] offset:14336
ds_write_b128 v2, v[56:59] offset:15360
s_waitcnt lgkmcnt(0)
s_waitcnt vmcnt(20)
ds_read_b64_tr_b16 v[44:45], v28 offset:16384
ds_read_b64_tr_b16 v[46:47], v28 offset:16640
ds_read_b64_tr_b16 v[48:49], v28 offset:18432
ds_read_b64_tr_b16 v[50:51], v28 offset:18688
ds_read_b64_tr_b16 v[52:53], v28 offset:16416
ds_read_b64_tr_b16 v[54:55], v28 offset:16672
ds_read_b64_tr_b16 v[56:57], v28 offset:18464
ds_read_b64_tr_b16 v[58:59], v28 offset:18720
s_waitcnt lgkmcnt(0)
ds_write_b128 v2, v[44:47] offset:16384
ds_write_b128 v2, v[48:51] offset:17408
ds_write_b128 v2, v[52:55] offset:18432
ds_write_b128 v2, v[56:59] offset:19456
s_waitcnt lgkmcnt(0)
s_waitcnt vmcnt(16)
ds_read_b64_tr_b16 v[44:45], v29 offset:20480
ds_read_b64_tr_b16 v[46:47], v29 offset:20608
ds_read_b64_tr_b16 v[48:49], v29 offset:20992
ds_read_b64_tr_b16 v[50:51], v29 offset:21120
ds_read_b64_tr_b16 v[52:53], v29 offset:22528
ds_read_b64_tr_b16 v[54:55], v29 offset:22656
ds_read_b64_tr_b16 v[56:57], v29 offset:23040
ds_read_b64_tr_b16 v[58:59], v29 offset:23168
s_waitcnt lgkmcnt(0)
ds_write_b128 v2, v[44:47] offset:20480
ds_write_b128 v2, v[48:51] offset:21504
ds_write_b128 v2, v[52:55] offset:22528
ds_write_b128 v2, v[56:59] offset:23552
s_waitcnt lgkmcnt(0)
s_waitcnt vmcnt(12)
ds_read_b64_tr_b16 v[44:45], v29 offset:24576
ds_read_b64_tr_b16 v[46:47], v29 offset:24704
ds_read_b64_tr_b16 v[48:49], v29 offset:25088
ds_read_b64_tr_b16 v[50:51], v29 offset:25216
ds_read_b64_tr_b16 v[52:53], v29 offset:26624
ds_read_b64_tr_b16 v[54:55], v29 offset:26752
ds_read_b64_tr_b16 v[56:57], v29 offset:27136
ds_read_b64_tr_b16 v[58:59], v29 offset:27264
s_waitcnt lgkmcnt(0)
ds_write_b128 v2, v[44:47] offset:24576
ds_write_b128 v2, v[48:51] offset:25600
ds_write_b128 v2, v[52:55] offset:26624
ds_write_b128 v2, v[56:59] offset:27648
s_waitcnt lgkmcnt(0)
s_waitcnt vmcnt(8)
ds_read_b64_tr_b16 v[44:45], v29 offset:28672
ds_read_b64_tr_b16 v[46:47], v29 offset:28800
ds_read_b64_tr_b16 v[48:49], v29 offset:29184
ds_read_b64_tr_b16 v[50:51], v29 offset:29312
ds_read_b64_tr_b16 v[52:53], v29 offset:30720
ds_read_b64_tr_b16 v[54:55], v29 offset:30848
ds_read_b64_tr_b16 v[56:57], v29 offset:31232
ds_read_b64_tr_b16 v[58:59], v29 offset:31360
s_waitcnt lgkmcnt(0)
ds_write_b128 v2, v[44:47] offset:28672
ds_write_b128 v2, v[48:51] offset:29696
ds_write_b128 v2, v[52:55] offset:30720
ds_write_b128 v2, v[56:59] offset:31744
s_waitcnt lgkmcnt(0)
s_waitcnt vmcnt(4)
ds_read_b64_tr_b16 v[44:45], v29 offset:32768
ds_read_b64_tr_b16 v[46:47], v29 offset:32896
ds_read_b64_tr_b16 v[48:49], v29 offset:33280
ds_read_b64_tr_b16 v[50:51], v29 offset:33408
ds_read_b64_tr_b16 v[52:53], v29 offset:34816
ds_read_b64_tr_b16 v[54:55], v29 offset:34944
ds_read_b64_tr_b16 v[56:57], v29 offset:35328
ds_read_b64_tr_b16 v[58:59], v29 offset:35456
s_waitcnt lgkmcnt(0)
ds_write_b128 v2, v[44:47] offset:32768
ds_write_b128 v2, v[48:51] offset:33792
ds_write_b128 v2, v[52:55] offset:34816
ds_write_b128 v2, v[56:59] offset:35840
s_waitcnt lgkmcnt(0)
s_waitcnt vmcnt(0)
ds_read_b64_tr_b16 v[44:45], v29 offset:36864
ds_read_b64_tr_b16 v[46:47], v29 offset:36992
ds_read_b64_tr_b16 v[48:49], v29 offset:37376
ds_read_b64_tr_b16 v[50:51], v29 offset:37504
ds_read_b64_tr_b16 v[52:53], v29 offset:38912
ds_read_b64_tr_b16 v[54:55], v29 offset:39040
ds_read_b64_tr_b16 v[56:57], v29 offset:39424
ds_read_b64_tr_b16 v[58:59], v29 offset:39552
s_waitcnt lgkmcnt(0)
ds_write_b128 v2, v[44:47] offset:36864
ds_write_b128 v2, v[48:51] offset:37888
ds_write_b128 v2, v[52:55] offset:38912
ds_write_b128 v2, v[56:59] offset:39936
s_waitcnt lgkmcnt(0)
v_mov_b32 v24, 0
L_rdv_w1r:
buffer_load_dword v23, v24, s[28:31], 0 offen sc0 sc1
s_sub_u32 s41, s41, 1
s_cbranch_scc1 L_exit
s_waitcnt vmcnt(0)
v_readfirstlane_b32 s56, v23
s_nop 0
s_and_b32 s57, s56, 0xff
s_cmp_lg_u32 s57, 32
s_cbranch_scc1 L_rdv_w1r
s_lshl_b32 s101, s32, 7
s_add_u32 s101, s101, 327680
s_barrier
s_mov_b32 m0, 0
s_lshl_b32 s57, s58, 5
s_mov_b32 s0, 0x3f003f00
s_mov_b32 s1, 0x3f003f00
s_mov_b32 s58, 304128
s_cmp_eq_u32 s56, s57
s_cbranch_scc0 L_slow_w1r
buffer_load_dwordx4 v[12:15], v9, s[4:7], s37 offen offset:0
buffer_load_dwordx4 v[16:19], v9, s[4:7], s37 offen offset:1024
buffer_load_dwordx4 v[52:55], v1, s[4:7], s37 offen offset:2048
buffer_load_dwordx4 v[56:59], v1, s[4:7], s37 offen offset:3072
v_mov_b64 v[20:21], 0
v_mov_b64 v[22:23], 0
v_mov_b64 v[24:25], 0
v_mov_b64 v[26:27], 0
v_mov_b64 v[28:29], 0
v_mov_b64 v[30:31], 0
v_mov_b64 v[32:33], 0
v_mov_b64 v[34:35], 0
v_mov_b64 v[36:37], 0
v_mov_b64 v[38:39], 0
v_mov_b64 v[40:41], 0
v_mov_b64 v[42:43], 0
ds_read_b128 v[44:47], v2 offset:0
ds_read_b128 v[48:51], v2 offset:1024
v_bfe_u32 v77, v1, 6, 1
v_lshl_add_u32 v77, v77, 3, v1
v_lshlrev_b32 v77, 1, v77
s_mov_b32 s38, 1
s_mov_b32 m0, 1024
s_nop 0
buffer_load_dwordx4 v1, s[4:7], s47 offen offset:0 sc1 lds
buffer_load_dwordx4 v1, s[4:7], s47 offen offset:1024 sc1 lds
buffer_load_dwordx4 v1, s[4:7], s47 offen offset:2048 sc1 lds
buffer_load_dwordx4 v1, s[4:7], s47 offen offset:3072 sc1 lds
s_mov_b32 m0, 5120
s_nop 0
buffer_load_dwordx4 v1, s[4:7], s48 offen offset:0 sc1 lds
buffer_load_dwordx4 v1, s[4:7], s48 offen offset:1024 sc1 lds
buffer_load_dwordx4 v1, s[4:7], s48 offen offset:2048 sc1 lds
buffer_load_dwordx4 v1, s[4:7], s48 offen offset:3072 sc1 lds
s_mov_b32 m0, 9216
s_nop 0
buffer_load_dwordx4 v1, s[4:7], s49 offen offset:0 sc1 lds
s_waitcnt vmcnt(0) lgkmcnt(0)
s_branch L_top_w1rf
.p2align 6
L_ex_w1rf:
v_and_b32 v6, 0x70, v1
ds_read_b128 v[76:79], v6 offset:256
s_add_u32 s34, s34, 1
s_add_u32 s37, s37, 524288
s_add_u32 s39, s39, 524288
s_mul_i32 s40, s34, 10240
s_add_u32 s40, s40, 8093696
s_not_b32 s35, s35
s_not_b32 s36, s36
ds_read_b128 v[44:47], v2 offset:0
ds_read_b128 v[48:51], v2 offset:1024
s_barrier
s_waitcnt vmcnt(0)
v_mov_b64 v[20:21], 0
v_mov_b64 v[22:23], 0
v_mov_b64 v[24:25], 0
v_mov_b64 v[26:27], 0
v_mov_b64 v[28:29], 0
v_mov_b64 v[30:31], 0
v_mov_b64 v[32:33], 0
v_mov_b64 v[34:35], 0
v_mov_b64 v[36:37], 0
v_mov_b64 v[38:39], 0
v_mov_b64 v[40:41], 0
v_mov_b64 v[42:43], 0
buffer_load_dwordx4 v[60:63], v9, s[4:7], s3 offen offset:0 sc1
buffer_load_dwordx4 v[64:67], v9, s[4:7], s3 offen offset:1024 sc1
buffer_load_dwordx4 v[68:71], v9, s[4:7], s3 offen offset:2048 sc1
buffer_load_dwordx4 v[72:75], v9, s[4:7], s3 offen offset:3072 sc1
s_waitcnt lgkmcnt(2)
s_waitcnt vmcnt(3)
L_r_w1rf:
v_mfma_f32_16x16x32_bf16 v[52:55], v[60:63], v[76:79], 0
s_waitcnt vmcnt(2)
v_mfma_f32_16x16x32_bf16 v[52:55], v[64:67], v[76:79], v[52:55]
v_bitop3_b32 v56, v60, v64, s36 bitop3:0x7e
s_waitcnt vmcnt(1)
v_mfma_f32_16x16x32_bf16 v[52:55], v[68:71], v[76:79], v[52:55]
s_waitcnt vmcnt(0)
v_mfma_f32_16x16x32_bf16 v[52:55], v[72:75], v[76:79], v[52:55]
v_bitop3_b32 v57, v68, v72, s36 bitop3:0x7e
v_bitop3_b32 v56, v56, v57, 1 bitop3:0xa8
v_cmp_ne_u32 vcc, 0, v56
s_cmp_eq_u32 s34, 63
s_nop 3
v_pk_add_f32 v[52:53], v[52:53], v[54:55]
v_cvt_pk_bf16_f32 v56, v52, v53
v_bfi_b32 v56, v11, s35, v56
s_cbranch_vccnz L_rr_w1rf
buffer_store_dword v56, v10, s[4:7], 0 offen
v_mov_b32 v79, v56
s_cbranch_scc1 L_done_w1rf
v_bfe_u32 v77, v1, 6, 1
v_lshl_add_u32 v77, v77, 3, v1
v_lshlrev_b32 v77, 1, v77
L_top_w1rf:
s_barrier
ds_read_b128 v[60:63], v1 offset:1024
ds_read_b128 v[64:67], v1 offset:2048
s_mov_b32 m0, 5120
s_nop 0
buffer_load_dwordx4 v1, s[4:7], s48 offen offset:1024 sc1 lds
s_mov_b32 m0, 9216
s_nop 0
buffer_load_dwordx4 v1, s[4:7], s49 offen offset:0 sc1 lds
s_barrier
ds_read_b128 v[68:71], v1 offset:3072
ds_read_b128 v[72:75], v1 offset:4096
L_s0_w1rf:
s_waitcnt lgkmcnt(3)
v_smfmac_f32_16x16x64_bf16 v[28:31], v[60:63], v[176:183], v0
v_smfmac_f32_16x16x64_bf16 v[32:35], v[60:63], v[184:191], v0
v_smfmac_f32_16x16x64_bf16 v[36:39], v[60:63], a[48:55], v0
v_smfmac_f32_16x16x64_bf16 v[40:43], v[60:63], a[56:63], v0
s_waitcnt lgkmcnt(2)
v_smfmac_f32_16x16x64_bf16 v[20:23], v[64:67], v[80:87], v0
v_smfmac_f32_16x16x64_bf16 v[20:23], v[60:63], v[44:51], v0
ds_read_b128 v[44:47], v2 offset:2048
v_smfmac_f32_16x16x64_bf16 v[24:27], v[64:67], v[88:95], v0
ds_read_b128 v[48:51], v2 offset:3072
v_smfmac_f32_16x16x64_bf16 v[28:31], v[64:67], v[192:199], v0
s_waitcnt lgkmcnt(2)
v_bitop3_b32 v6, v60, v64, s35 bitop3:0x7e
buffer_load_dwordx4 v[12:15], v9, s[4:7], s37 offen offset:0
buffer_load_dwordx4 v[16:19], v9, s[4:7], s37 offen offset:1024
buffer_load_dwordx4 v[52:55], v1, s[4:7], s37 offen offset:2048
buffer_load_dwordx4 v[56:59], v1, s[4:7], s37 offen offset:3072
v_smfmac_f32_16x16x64_bf16 v[32:35], v[64:67], v[200:207], v0
v_bitop3_b32 v76, v68, v72, s35 bitop3:0x7e
v_smfmac_f32_16x16x64_bf16 v[36:39], v[64:67], a[64:71], v0
v_bitop3_b32 v6, v6, v76, 1 bitop3:0xa8
s_waitcnt lgkmcnt(0)
v_smfmac_f32_16x16x64_bf16 v[24:27], v[60:63], v[44:51], v0
ds_read_b128 v[44:47], v2 offset:4096
v_cmp_ne_u32 vcc, 0, v6
v_smfmac_f32_16x16x64_bf16 v[40:43], v[64:67], a[72:79], v0
ds_read_b128 v[48:51], v2 offset:5120
v_smfmac_f32_16x16x64_bf16 v[20:23], v[68:71], v[96:103], v0
s_cbranch_vccnz L_ra0_w1rf
v_smfmac_f32_16x16x64_bf16 v[24:27], v[68:71], v[104:111], v0
s_waitcnt vmcnt(4)
s_barrier
ds_read_b32 v6, v77 offset:8192
buffer_store_dword v79, v10, s[4:7], s40 offen sc0 sc1
v_smfmac_f32_16x16x64_bf16 v[28:31], v[68:71], v[208:215], v0
ds_read_b128 v[60:63], v1 offset:6144
s_waitcnt lgkmcnt(2)
v_smfmac_f32_16x16x64_bf16 v[20:23], v[72:75], v[44:51], v0
ds_read_b128 v[64:67], v1 offset:7168
v_smfmac_f32_16x16x64_bf16 v[32:35], v[68:71], v[216:223], v0
ds_read_b128 v[76:79], v1 offset:5120
v_smfmac_f32_16x16x64_bf16 v[36:39], v[68:71], a[80:87], v0
ds_read_b128 v[44:47], v2 offset:6144
v_smfmac_f32_16x16x64_bf16 v[40:43], v[68:71], a[88:95], v0
ds_read_b128 v[48:51], v2 offset:7168
s_waitcnt lgkmcnt(4)
v_bitop3_b32 v6, v6, v60, s35 bitop3:0x7e
v_smfmac_f32_16x16x64_bf16 v[28:31], v[72:75], v[224:231], v0
ds_read_b128 v[68:71], v1 offset:8192
s_waitcnt lgkmcnt(4)
v_bitop3_b32 v6, v6, v64, s35 bitop3:0xf6
v_smfmac_f32_16x16x64_bf16 v[32:35], v[72:75], v[232:239], v0
s_waitcnt lgkmcnt(3)
v_bitop3_b32 v6, v6, v76, s35 bitop3:0xf6
v_and_b32 v6, 1, v6
v_smfmac_f32_16x16x64_bf16 v[36:39], v[72:75], a[96:103], v0
v_cmp_ne_u32 vcc, 0, v6
s_waitcnt lgkmcnt(1)
v_smfmac_f32_16x16x64_bf16 v[24:27], v[72:75], v[44:51], v0
ds_read_b128 v[44:47], v2 offset:8192
v_lshlrev_b32 v6, 2, v1
v_smfmac_f32_16x16x64_bf16 v[40:43], v[72:75], a[104:111], v0
ds_read_b128 v[72:75], v1 offset:9216
s_cbranch_vccnz L_ra1_w1rf
L_a1_w1rf:
v_smfmac_f32_16x16x64_bf16 v[20:23], v[60:63], v[112:119], v0
ds_read_b128 v[48:51], v2 offset:9216
v_smfmac_f32_16x16x64_bf16 v[20:23], v[64:67], v[128:135], v0
s_waitcnt lgkmcnt(3)
v_smfmac_f32_16x16x64_bf16 v[20:23], v[68:71], v[144:151], v0
s_waitcnt lgkmcnt(1)
v_smfmac_f32_16x16x64_bf16 v[20:23], v[72:75], v[160:167], v0
s_waitcnt lgkmcnt(0)
v_smfmac_f32_16x16x64_bf16 v[20:23], v[76:79], v[44:51], v0
ds_read_b128 v[44:47], v2 offset:10240
v_smfmac_f32_16x16x64_bf16 v[24:27], v[60:63], v[120:127], v0
ds_read_b128 v[48:51], v2 offset:11264
v_smfmac_f32_16x16x64_bf16 v[24:27], v[64:67], v[136:143], v0
v_add_f32 v20, v20, v22
v_smfmac_f32_16x16x64_bf16 v[24:27], v[68:71], v[152:159], v0
v_add_f32 v21, v21, v23
v_smfmac_f32_16x16x64_bf16 v[24:27], v[72:75], v[168:175], v0
v_cvt_pk_bf16_f32 v22, v20, v21
s_waitcnt lgkmcnt(0)
v_smfmac_f32_16x16x64_bf16 v[24:27], v[76:79], v[44:51], v0
ds_read_b128 v[44:47], v2 offset:12288
v_smfmac_f32_16x16x64_bf16 v[28:31], v[76:79], v[240:247], v0
ds_read_b128 v[48:51], v2 offset:13312
v_smfmac_f32_16x16x64_bf16 v[28:31], v[64:67], a[0:7], v0
v_add_f32 v24, v24, v26
v_add_f32 v25, v25, v27
v_cvt_pk_bf16_f32 v23, v24, v25
v_smfmac_f32_16x16x64_bf16 v[28:31], v[68:71], a[16:23], v0
ds_write_b64 v3, v[22:23] offset:10752
v_smfmac_f32_16x16x64_bf16 v[28:31], v[72:75], a[32:39], v0
s_mov_b32 m0, 0
s_nop 0
buffer_load_dword v6, s[4:7], s39 offen lds
s_waitcnt lgkmcnt(1)
v_smfmac_f32_16x16x64_bf16 v[28:31], v[60:63], v[44:51], v0
ds_read_b128 v[44:47], v2 offset:14336
v_smfmac_f32_16x16x64_bf16 v[32:35], v[76:79], v[248:255], v0
ds_read_b128 v[48:51], v2 offset:15360
s_waitcnt lgkmcnt(2)
s_barrier
v_smfmac_f32_16x16x64_bf16 v[32:35], v[64:67], a[8:15], v0
ds_read_b64_tr_b16 v[20:21], v4 offset:10240
ds_read_b64_tr_b16 v[22:23], v4 offset:10752
v_add_f32 v28, v28, v30
v_smfmac_f32_16x16x64_bf16 v[32:35], v[68:71], a[24:31], v0
ds_read_b64_tr_b16 v[24:25], v4 offset:11264
v_add_f32 v29, v29, v31
v_smfmac_f32_16x16x64_bf16 v[32:35], v[72:75], a[40:47], v0
ds_read_b64_tr_b16 v[26:27], v4 offset:11776
v_cvt_pk_bf16_f32 v30, v28, v29
s_waitcnt lgkmcnt(4)
v_smfmac_f32_16x16x64_bf16 v[32:35], v[60:63], v[44:51], v0
ds_read_b128 v[44:47], v2 offset:18432
s_waitcnt vmcnt(4)
s_waitcnt lgkmcnt(3)
v_mfma_f32_16x16x32_bf16 v[12:15], v[12:15], v[20:23], 0
ds_read_b128 v[48:51], v2 offset:19456
s_waitcnt lgkmcnt(2)
v_mfma_f32_16x16x32_bf16 v[12:15], v[16:19], v[24:27], v[12:15]
v_add_f32 v32, v32, v34
v_add_f32 v33, v33, v35
v_cvt_pk_bf16_f32 v31, v32, v33
ds_write_b64 v3, v[30:31] offset:12800
v_smfmac_f32_16x16x64_bf16 v[36:39], v[76:79], a[112:119], v0
s_nop 2
v_add_f32_dpp v12, v14, v12 quad_perm:[2,3,0,1] row_mask:0xf bank_mask:0xf
v_add_f32_dpp v13, v15, v13 quad_perm:[2,3,0,1] row_mask:0xf bank_mask:0xf
ds_write_b64 v5, v[12:13] offset:14592
v_smfmac_f32_16x16x64_bf16 v[40:43], v[76:79], a[120:127], v0
s_waitcnt lgkmcnt(1)
s_barrier
ds_read_b64_tr_b16 v[28:29], v4 offset:12288
v_smfmac_f32_16x16x64_bf16 v[36:39], v[60:63], a[128:135], v0
ds_read_b64_tr_b16 v[30:31], v4 offset:12800
ds_read_b64_tr_b16 v[32:33], v4 offset:13312
v_smfmac_f32_16x16x64_bf16 v[40:43], v[60:63], a[136:143], v0
ds_read_b64_tr_b16 v[34:35], v4 offset:13824
v_mov_b64 v[76:77], s[52:53]
s_waitcnt lgkmcnt(4)
s_barrier
ds_read_b128 v[12:15], v1 offset:14336
v_smfmac_f32_16x16x64_bf16 v[40:43], v[72:75], v[44:51], v0
ds_read_b128 v[44:47], v2 offset:16384
v_mov_b64 v[78:79], s[52:53]
s_waitcnt lgkmcnt(4)
v_mfma_f32_16x16x32_bf16 v[28:31], v[28:31], v[20:23], 0
ds_read_b128 v[48:51], v2 offset:17408
s_waitcnt lgkmcnt(3)
v_mfma_f32_16x16x32_bf16 v[28:31], v[32:35], v[24:27], v[28:31]
v_smfmac_f32_16x16x64_bf16 v[40:43], v[64:67], a[152:159], v0
s_waitcnt lgkmcnt(2)
v_max3_f32 v17, v12, v13, v14
v_smfmac_f32_16x16x64_bf16 v[36:39], v[64:67], a[144:151], v0
ds_read_b128 v[60:63], v2 offset:22528
v_add_f32_dpp v28, v30, v28 quad_perm:[2,3,0,1] row_mask:0xf bank_mask:0xf
v_add_f32_dpp v29, v31, v29 quad_perm:[2,3,0,1] row_mask:0xf bank_mask:0xf
v_max_f32 v17, v17, v15
v_max_f32 v16, v28, v29
v_mul_f32 v16, s50, v16
v_max_f32_dpp v17, v17, v17 quad_perm:[2,3,0,1] row_mask:0xf bank_mask:0xf
v_smfmac_f32_16x16x64_bf16 v[40:43], v[68:71], a[168:175], v0
ds_read_b128 v[64:67], v2 offset:23552
v_max_f32_dpp v18, v16, v17 quad_perm:[0,1,0,1] row_mask:0xf bank_mask:0xf
v_max_f32_dpp v19, v16, v17 quad_perm:[0,1,0,1] row_mask:0xf bank_mask:0xf
v_smfmac_f32_16x16x64_bf16 v[36:39], v[68:71], a[160:167], v0
ds_read_b128 v[68:71], v2 offset:24576
v_permlane16_swap_b32 v18, v19
v_max_f32 v20, v18, v19
v_max_f32 v21, v18, v19
s_waitcnt lgkmcnt(3)
v_smfmac_f32_16x16x64_bf16 v[36:39], v[72:75], v[44:51], v0
ds_read_b128 v[72:75], v2 offset:25600
v_permlane32_swap_b32 v20, v21
v_max_f32 v20, v20, v21
v_sub_f32 v12, v12, v20
v_sub_f32 v13, v13, v20
v_pk_add_f32 v[14:15], v[14:15], v[20:21] op_sel_hi:[1,0] neg_lo:[0,1] neg_hi:[0,1]
v_exp_f32 v12, v12
v_exp_f32 v13, v13
v_exp_f32 v14, v14
v_exp_f32 v15, v15
v_cvt_pk_bf16_f32 v16, v12, v13
v_cvt_pk_bf16_f32 v17, v14, v15
v_pk_fma_f32 v[28:29], v[28:29], s[50:51], v[20:21] op_sel_hi:[1,1,0] neg_lo:[0,0,1] neg_hi:[0,0,1]
v_mov_b32_dpp v18, v16 quad_perm:[2,3,0,1] row_mask:0xf bank_mask:0xf
v_mov_b32_dpp v19, v17 quad_perm:[2,3,0,1] row_mask:0xf bank_mask:0xf
v_exp_f32 v28, v28
s_waitcnt vmcnt(2)
v_mfma_f32_16x16x32_bf16 v[32:35], v[76:79], v[16:19], 0
v_exp_f32 v29, v29
v_mfma_f32_16x16x32_bf16 v[20:23], v[52:55], v[16:19], 0
v_cvt_pk_bf16_f32 v12, v28, v29
v_cvt_pk_bf16_f32 v13, v28, v29
v_mov_b64 v[14:15], s[0:1]
v_mfma_f32_16x16x32_bf16 v[24:27], v[56:59], v[16:19], 0
v_cvt_pk_bf16_f32 v36, v36, v37
v_cvt_pk_bf16_f32 v37, v38, v39
v_mfma_f32_16x16x16_bf16 v[32:35], v[14:15], v[12:13], v[32:35]
v_cvt_pk_bf16_f32 v38, v40, v41
v_cvt_pk_bf16_f32 v39, v42, v43
v_mfma_f32_16x16x16_bf16 v[20:23], v[36:37], v[12:13], v[20:23]
ds_read_b128 v[44:47], v2 offset:20480
v_mfma_f32_16x16x16_bf16 v[24:27], v[38:39], v[12:13], v[24:27]
ds_read_b128 v[48:51], v2 offset:21504
v_rcp_f32 v32, v32
v_mov_b64 v[28:29], 0
v_mov_b64 v[30:31], 0
v_pk_mul_f32 v[20:21], v[20:21], v[32:33] op_sel_hi:[1,0]
v_pk_mul_f32 v[22:23], v[22:23], v[32:33] op_sel_hi:[1,0]
v_cvt_pk_bf16_f32 v20, v20, v21
v_cvt_pk_bf16_f32 v21, v22, v23
ds_write_b64 v1, v[20:21] offset:6144
v_pk_mul_f32 v[24:25], v[24:25], v[32:33] op_sel_hi:[1,0]
v_pk_mul_f32 v[26:27], v[26:27], v[32:33] op_sel_hi:[1,0]
v_cvt_pk_bf16_f32 v24, v24, v25
v_cvt_pk_bf16_f32 v25, v26, v27
ds_write_b64 v1, v[24:25] offset:6152
v_mov_b64 v[76:77], 0
ds_read_b128 v[12:15], v7 offset:6144
v_mov_b64 v[78:79], 0
v_mov_b64 v[40:41], 0
v_mov_b64 v[42:43], 0
v_mov_b64 v[36:37], 0
v_mov_b64 v[38:39], 0
v_mov_b64 v[32:33], 0
v_mov_b64 v[34:35], 0
s_waitcnt lgkmcnt(1)
s_barrier
ds_read_b128 v[16:19], v7 offset:7168
ds_read_b128 v[52:55], v7 offset:8192
ds_read_b128 v[56:59], v7 offset:5120
s_waitcnt lgkmcnt(3)
v_smfmac_f32_16x16x64_bf16 v[28:31], v[12:15], v[44:51], v0 abid:1
v_smfmac_f32_16x16x64_bf16 v[76:79], v[12:15], v[60:67], v0 abid:1
ds_read_b128 v[44:47], v2 offset:26624
s_waitcnt lgkmcnt(3)
v_smfmac_f32_16x16x64_bf16 v[28:31], v[16:19], a[176:183], v0 abid:1
ds_read_b128 v[48:51], v2 offset:27648
s_waitcnt lgkmcnt(3)
v_smfmac_f32_16x16x64_bf16 v[28:31], v[52:55], v[68:75], v0 abid:1
ds_read_b128 v[60:63], v2 offset:28672
s_waitcnt lgkmcnt(3)
v_smfmac_f32_16x16x64_bf16 v[28:31], v[56:59], a[184:191], v0 abid:1
ds_read_b128 v[64:67], v2 offset:29696
v_smfmac_f32_16x16x64_bf16 v[76:79], v[16:19], a[192:199], v0 abid:1
ds_read_b128 v[68:71], v2 offset:30720
s_waitcnt lgkmcnt(3)
v_smfmac_f32_16x16x64_bf16 v[76:79], v[52:55], v[44:51], v0 abid:1
ds_read_b128 v[72:75], v2 offset:31744
v_cvt_pk_bf16_f32 v28, v28, v29
v_cvt_pk_bf16_f32 v29, v30, v31
v_bfi_b32 v28, 1, s35, v28
buffer_store_dwordx2 v[28:29], v8, s[4:7], s42 offen
v_smfmac_f32_16x16x64_bf16 v[76:79], v[56:59], a[200:207], v0 abid:1
ds_read_b128 v[44:47], v2 offset:32768
s_waitcnt lgkmcnt(3)
v_smfmac_f32_16x16x64_bf16 v[40:43], v[12:15], v[60:67], v0 abid:1
ds_read_b128 v[48:51], v2 offset:33792
v_smfmac_f32_16x16x64_bf16 v[40:43], v[16:19], a[208:215], v0 abid:1
ds_read_b128 v[60:63], v2 offset:34816
v_cvt_pk_bf16_f32 v76, v76, v77
v_cvt_pk_bf16_f32 v77, v78, v79
v_bfi_b32 v76, 1, s35, v76
buffer_store_dwordx2 v[76:77], v8, s[4:7], s43 offen
s_waitcnt lgkmcnt(3)
v_smfmac_f32_16x16x64_bf16 v[40:43], v[52:55], v[68:75], v0 abid:1
ds_read_b128 v[64:67], v2 offset:35840
v_smfmac_f32_16x16x64_bf16 v[40:43], v[56:59], a[216:223], v0 abid:1
ds_read_b128 v[68:71], v2 offset:36864
s_waitcnt lgkmcnt(3)
v_smfmac_f32_16x16x64_bf16 v[36:39], v[12:15], v[44:51], v0 abid:1
ds_read_b128 v[72:75], v2 offset:37888
v_smfmac_f32_16x16x64_bf16 v[36:39], v[16:19], a[224:231], v0 abid:1
ds_read_b128 v[44:47], v2 offset:38912
v_cvt_pk_bf16_f32 v40, v40, v41
s_waitcnt lgkmcnt(3)
v_smfmac_f32_16x16x64_bf16 v[36:39], v[52:55], v[60:67], v0 abid:1
ds_read_b128 v[48:51], v2 offset:39936
v_cvt_pk_bf16_f32 v41, v42, v43
v_smfmac_f32_16x16x64_bf16 v[36:39], v[56:59], a[232:239], v0 abid:1
v_bfi_b32 v40, 1, s35, v40
buffer_store_dwordx2 v[40:41], v8, s[4:7], s44 offen
s_waitcnt lgkmcnt(2)
v_smfmac_f32_16x16x64_bf16 v[32:35], v[12:15], v[68:75], v0 abid:1
v_smfmac_f32_16x16x64_bf16 v[32:35], v[16:19], a[240:247], v0 abid:1
v_cvt_pk_bf16_f32 v36, v36, v37
s_waitcnt lgkmcnt(0)
v_smfmac_f32_16x16x64_bf16 v[32:35], v[52:55], v[44:51], v0 abid:1
v_cvt_pk_bf16_f32 v37, v38, v39
v_smfmac_f32_16x16x64_bf16 v[32:35], v[56:59], a[248:255], v0 abid:1
v_bfi_b32 v36, 1, s35, v36
buffer_store_dwordx2 v[36:37], v8, s[4:7], s45 offen
s_nop 5
v_cvt_pk_bf16_f32 v32, v32, v33
v_cvt_pk_bf16_f32 v33, v34, v35
v_bfi_b32 v32, 1, s35, v32
buffer_store_dwordx2 v[32:33], v8, s[4:7], s46 offen
s_branch L_ex_w1rf
L_done_w1rf:
buffer_store_dword v79, v10, s[4:7], s40 offen sc0 sc1
s_waitcnt vmcnt(0) lgkmcnt(0)
s_endpgm
L_ra0_w1rf:
s_mov_b32 s38, 1
s_mov_b32 m0, 1024
s_nop 0
buffer_load_dwordx4 v1, s[4:7], s47 offen offset:0 sc1 lds
buffer_load_dwordx4 v1, s[4:7], s47 offen offset:1024 sc1 lds
buffer_load_dwordx4 v1, s[4:7], s47 offen offset:2048 sc1 lds
buffer_load_dwordx4 v1, s[4:7], s47 offen offset:3072 sc1 lds
s_sub_u32 s41, s41, 1
s_cbranch_scc1 L_exit
ds_read_b128 v[44:47], v2 offset:0
ds_read_b128 v[48:51], v2 offset:1024
v_mov_b64 v[20:21], 0
v_mov_b64 v[22:23], 0
v_mov_b64 v[24:25], 0
v_mov_b64 v[26:27], 0
v_mov_b64 v[28:29], 0
v_mov_b64 v[30:31], 0
v_mov_b64 v[32:33], 0
v_mov_b64 v[34:35], 0
v_mov_b64 v[36:37], 0
v_mov_b64 v[38:39], 0
v_mov_b64 v[40:41], 0
v_mov_b64 v[42:43], 0
s_waitcnt vmcnt(0)
ds_read_b128 v[60:63], v1 offset:1024
ds_read_b128 v[64:67], v1 offset:2048
ds_read_b128 v[68:71], v1 offset:3072
ds_read_b128 v[72:75], v1 offset:4096
s_branch L_s0_w1rf
L_ra1_w1rf:
s_mov_b32 s38, 1
s_waitcnt lgkmcnt(0)
s_barrier
s_mov_b32 m0, 5120
s_nop 0
buffer_load_dwordx4 v1, s[4:7], s48 offen offset:1024 sc1 lds
s_sub_u32 s41, s41, 1
s_cbranch_scc1 L_exit
s_waitcnt vmcnt(0)
s_barrier
ds_read_b128 v[76:79], v1 offset:5120
ds_read_b128 v[60:63], v1 offset:6144
ds_read_b128 v[64:67], v1 offset:7168
ds_read_b128 v[68:71], v1 offset:8192
ds_read_b128 v[72:75], v1 offset:9216
s_waitcnt lgkmcnt(0)
v_bitop3_b32 v6, v76, v60, s35 bitop3:0x7e
v_bitop3_b32 v6, v6, v64, s35 bitop3:0xf6
v_bitop3_b32 v6, v6, v68, s35 bitop3:0xf6
v_bitop3_b32 v6, v6, v72, s35 bitop3:0xf6
v_and_b32 v6, 1, v6
v_cmp_ne_u32 vcc, 0, v6
v_lshlrev_b32 v6, 2, v1
s_cbranch_vccnz L_ra1_w1rf
s_branch L_a1_w1rf
L_rr_w1rf:
buffer_load_dwordx4 v[60:63], v9, s[4:7], s3 offen offset:0 sc1
buffer_load_dwordx4 v[64:67], v9, s[4:7], s3 offen offset:1024 sc1
buffer_load_dwordx4 v[68:71], v9, s[4:7], s3 offen offset:2048 sc1
buffer_load_dwordx4 v[72:75], v9, s[4:7], s3 offen offset:3072 sc1
s_sub_u32 s41, s41, 1
s_cbranch_scc1 L_exit
s_waitcnt vmcnt(0)
s_branch L_r_w1rf
L_slow_w1r:
buffer_load_dwordx4 v[12:15], v9, s[4:7], s37 offen offset:0
buffer_load_dwordx4 v[16:19], v9, s[4:7], s37 offen offset:1024
buffer_load_dwordx4 v[52:55], v1, s[4:7], s37 offen offset:2048
buffer_load_dwordx4 v[56:59], v1, s[4:7], s37 offen offset:3072
v_mov_b64 v[20:21], 0
v_mov_b64 v[22:23], 0
v_mov_b64 v[24:25], 0
v_mov_b64 v[26:27], 0
v_mov_b64 v[28:29], 0
v_mov_b64 v[30:31], 0
v_mov_b64 v[32:33], 0
v_mov_b64 v[34:35], 0
v_mov_b64 v[36:37], 0
v_mov_b64 v[38:39], 0
v_mov_b64 v[40:41], 0
v_mov_b64 v[42:43], 0
ds_read_b128 v[44:47], v2 offset:0
ds_read_b128 v[48:51], v2 offset:1024
v_bfe_u32 v77, v1, 6, 1
v_lshl_add_u32 v77, v77, 3, v1
v_lshlrev_b32 v77, 1, v77
s_mov_b32 s38, 1
s_mov_b32 m0, 1024
s_nop 0
buffer_load_dwordx4 v1, s[4:7], s47 offen offset:0 sc0 sc1 lds
buffer_load_dwordx4 v1, s[4:7], s47 offen offset:1024 sc0 sc1 lds
buffer_load_dwordx4 v1, s[4:7], s47 offen offset:2048 sc0 sc1 lds
buffer_load_dwordx4 v1, s[4:7], s47 offen offset:3072 sc0 sc1 lds
s_mov_b32 m0, 5120
s_nop 0
buffer_load_dwordx4 v1, s[4:7], s48 offen offset:0 sc0 sc1 lds
buffer_load_dwordx4 v1, s[4:7], s48 offen offset:1024 sc0 sc1 lds
buffer_load_dwordx4 v1, s[4:7], s48 offen offset:2048 sc0 sc1 lds
buffer_load_dwordx4 v1, s[4:7], s48 offen offset:3072 sc0 sc1 lds
s_mov_b32 m0, 9216
s_nop 0
buffer_load_dwordx4 v1, s[4:7], s49 offen offset:0 sc0 sc1 lds
s_waitcnt vmcnt(0) lgkmcnt(0)
s_branch L_top_w1rs
.p2align 6
L_ex_w1rs:
v_and_b32 v6, 0x70, v1
ds_read_b128 v[76:79], v6 offset:256
s_add_u32 s34, s34, 1
s_add_u32 s37, s37, 524288
s_add_u32 s39, s39, 524288
s_mul_i32 s40, s34, 10240
s_add_u32 s40, s40, 8093696
s_not_b32 s35, s35
s_not_b32 s36, s36
ds_read_b128 v[44:47], v2 offset:0
ds_read_b128 v[48:51], v2 offset:1024
s_barrier
s_waitcnt vmcnt(0)
v_mov_b64 v[20:21], 0
v_mov_b64 v[22:23], 0
v_mov_b64 v[24:25], 0
v_mov_b64 v[26:27], 0
v_mov_b64 v[28:29], 0
v_mov_b64 v[30:31], 0
v_mov_b64 v[32:33], 0
v_mov_b64 v[34:35], 0
v_mov_b64 v[36:37], 0
v_mov_b64 v[38:39], 0
v_mov_b64 v[40:41], 0
v_mov_b64 v[42:43], 0
buffer_load_dwordx4 v[60:63], v9, s[4:7], s3 offen offset:0 sc0 sc1
buffer_load_dwordx4 v[64:67], v9, s[4:7], s3 offen offset:1024 sc0 sc1
buffer_load_dwordx4 v[68:71], v9, s[4:7], s3 offen offset:2048 sc0 sc1
buffer_load_dwordx4 v[72:75], v9, s[4:7], s3 offen offset:3072 sc0 sc1
s_waitcnt lgkmcnt(2)
s_waitcnt vmcnt(3)
L_r_w1rs:
v_mfma_f32_16x16x32_bf16 v[52:55], v[60:63], v[76:79], 0
s_waitcnt vmcnt(2)
v_mfma_f32_16x16x32_bf16 v[52:55], v[64:67], v[76:79], v[52:55]
v_bitop3_b32 v56, v60, v64, s36 bitop3:0x7e
s_waitcnt vmcnt(1)
v_mfma_f32_16x16x32_bf16 v[52:55], v[68:71], v[76:79], v[52:55]
s_waitcnt vmcnt(0)
v_mfma_f32_16x16x32_bf16 v[52:55], v[72:75], v[76:79], v[52:55]
v_bitop3_b32 v57, v68, v72, s36 bitop3:0x7e
v_bitop3_b32 v56, v56, v57, 1 bitop3:0xa8
v_cmp_ne_u32 vcc, 0, v56
s_cmp_eq_u32 s34, 63
s_nop 3
v_pk_add_f32 v[52:53], v[52:53], v[54:55]
v_cvt_pk_bf16_f32 v56, v52, v53
v_bfi_b32 v56, v11, s35, v56
s_cbranch_vccnz L_rr_w1rs
buffer_store_dword v56, v10, s[4:7], 0 offen sc0 sc1
v_mov_b32 v79, v56
s_cbranch_scc1 L_done_w1rs
v_bfe_u32 v77, v1, 6, 1
v_lshl_add_u32 v77, v77, 3, v1
v_lshlrev_b32 v77, 1, v77
L_top_w1rs:
s_barrier
ds_read_b128 v[60:63], v1 offset:1024
ds_read_b128 v[64:67], v1 offset:2048
s_mov_b32 m0, 5120
s_nop 0
buffer_load_dwordx4 v1, s[4:7], s48 offen offset:1024 sc0 sc1 lds
s_mov_b32 m0, 9216
s_nop 0
buffer_load_dwordx4 v1, s[4:7], s49 offen offset:0 sc0 sc1 lds
s_barrier
ds_read_b128 v[68:71], v1 offset:3072
ds_read_b128 v[72:75], v1 offset:4096
L_s0_w1rs:
s_waitcnt lgkmcnt(3)
v_smfmac_f32_16x16x64_bf16 v[28:31], v[60:63], v[176:183], v0
v_smfmac_f32_16x16x64_bf16 v[32:35], v[60:63], v[184:191], v0
v_smfmac_f32_16x16x64_bf16 v[36:39], v[60:63], a[48:55], v0
v_smfmac_f32_16x16x64_bf16 v[40:43], v[60:63], a[56:63], v0
s_waitcnt lgkmcnt(2)
v_smfmac_f32_16x16x64_bf16 v[20:23], v[64:67], v[80:87], v0
v_smfmac_f32_16x16x64_bf16 v[20:23], v[60:63], v[44:51], v0
ds_read_b128 v[44:47], v2 offset:2048
v_smfmac_f32_16x16x64_bf16 v[24:27], v[64:67], v[88:95], v0
ds_read_b128 v[48:51], v2 offset:3072
v_smfmac_f32_16x16x64_bf16 v[28:31], v[64:67], v[192:199], v0
s_waitcnt lgkmcnt(2)
v_bitop3_b32 v6, v60, v64, s35 bitop3:0x7e
buffer_load_dwordx4 v[12:15], v9, s[4:7], s37 offen offset:0
buffer_load_dwordx4 v[16:19], v9, s[4:7], s37 offen offset:1024
buffer_load_dwordx4 v[52:55], v1, s[4:7], s37 offen offset:2048
buffer_load_dwordx4 v[56:59], v1, s[4:7], s37 offen offset:3072
v_smfmac_f32_16x16x64_bf16 v[32:35], v[64:67], v[200:207], v0
v_bitop3_b32 v76, v68, v72, s35 bitop3:0x7e
v_smfmac_f32_16x16x64_bf16 v[36:39], v[64:67], a[64:71], v0
v_bitop3_b32 v6, v6, v76, 1 bitop3:0xa8
s_waitcnt lgkmcnt(0)
v_smfmac_f32_16x16x64_bf16 v[24:27], v[60:63], v[44:51], v0
ds_read_b128 v[44:47], v2 offset:4096
v_cmp_ne_u32 vcc, 0, v6
v_smfmac_f32_16x16x64_bf16 v[40:43], v[64:67], a[72:79], v0
ds_read_b128 v[48:51], v2 offset:5120
v_smfmac_f32_16x16x64_bf16 v[20:23], v[68:71], v[96:103], v0
s_cbranch_vccnz L_ra0_w1rs
v_smfmac_f32_16x16x64_bf16 v[24:27], v[68:71], v[104:111], v0
s_waitcnt vmcnt(4)
s_barrier
ds_read_b32 v6, v77 offset:8192
buffer_store_dword v79, v10, s[4:7], s40 offen sc0 sc1
v_smfmac_f32_16x16x64_bf16 v[28:31], v[68:71], v[208:215], v0
ds_read_b128 v[60:63], v1 offset:6144
s_waitcnt lgkmcnt(2)
v_smfmac_f32_16x16x64_bf16 v[20:23], v[72:75], v[44:51], v0
ds_read_b128 v[64:67], v1 offset:7168
v_smfmac_f32_16x16x64_bf16 v[32:35], v[68:71], v[216:223], v0
ds_read_b128 v[76:79], v1 offset:5120
v_smfmac_f32_16x16x64_bf16 v[36:39], v[68:71], a[80:87], v0
ds_read_b128 v[44:47], v2 offset:6144
v_smfmac_f32_16x16x64_bf16 v[40:43], v[68:71], a[88:95], v0
ds_read_b128 v[48:51], v2 offset:7168
s_waitcnt lgkmcnt(4)
v_bitop3_b32 v6, v6, v60, s35 bitop3:0x7e
v_smfmac_f32_16x16x64_bf16 v[28:31], v[72:75], v[224:231], v0
ds_read_b128 v[68:71], v1 offset:8192
s_waitcnt lgkmcnt(4)
v_bitop3_b32 v6, v6, v64, s35 bitop3:0xf6
v_smfmac_f32_16x16x64_bf16 v[32:35], v[72:75], v[232:239], v0
s_waitcnt lgkmcnt(3)
v_bitop3_b32 v6, v6, v76, s35 bitop3:0xf6
v_and_b32 v6, 1, v6
v_smfmac_f32_16x16x64_bf16 v[36:39], v[72:75], a[96:103], v0
v_cmp_ne_u32 vcc, 0, v6
s_waitcnt lgkmcnt(1)
v_smfmac_f32_16x16x64_bf16 v[24:27], v[72:75], v[44:51], v0
ds_read_b128 v[44:47], v2 offset:8192
v_lshlrev_b32 v6, 2, v1
v_smfmac_f32_16x16x64_bf16 v[40:43], v[72:75], a[104:111], v0
ds_read_b128 v[72:75], v1 offset:9216
s_cbranch_vccnz L_ra1_w1rs
L_a1_w1rs:
v_smfmac_f32_16x16x64_bf16 v[20:23], v[60:63], v[112:119], v0
ds_read_b128 v[48:51], v2 offset:9216
v_smfmac_f32_16x16x64_bf16 v[20:23], v[64:67], v[128:135], v0
s_waitcnt lgkmcnt(3)
v_smfmac_f32_16x16x64_bf16 v[20:23], v[68:71], v[144:151], v0
s_waitcnt lgkmcnt(1)
v_smfmac_f32_16x16x64_bf16 v[20:23], v[72:75], v[160:167], v0
s_waitcnt lgkmcnt(0)
v_smfmac_f32_16x16x64_bf16 v[20:23], v[76:79], v[44:51], v0
ds_read_b128 v[44:47], v2 offset:10240
v_smfmac_f32_16x16x64_bf16 v[24:27], v[60:63], v[120:127], v0
ds_read_b128 v[48:51], v2 offset:11264
v_smfmac_f32_16x16x64_bf16 v[24:27], v[64:67], v[136:143], v0
v_add_f32 v20, v20, v22
v_smfmac_f32_16x16x64_bf16 v[24:27], v[68:71], v[152:159], v0
v_add_f32 v21, v21, v23
v_smfmac_f32_16x16x64_bf16 v[24:27], v[72:75], v[168:175], v0
v_cvt_pk_bf16_f32 v22, v20, v21
s_waitcnt lgkmcnt(0)
v_smfmac_f32_16x16x64_bf16 v[24:27], v[76:79], v[44:51], v0
ds_read_b128 v[44:47], v2 offset:12288
v_smfmac_f32_16x16x64_bf16 v[28:31], v[76:79], v[240:247], v0
ds_read_b128 v[48:51], v2 offset:13312
v_smfmac_f32_16x16x64_bf16 v[28:31], v[64:67], a[0:7], v0
v_add_f32 v24, v24, v26
v_add_f32 v25, v25, v27
v_cvt_pk_bf16_f32 v23, v24, v25
v_smfmac_f32_16x16x64_bf16 v[28:31], v[68:71], a[16:23], v0
ds_write_b64 v3, v[22:23] offset:10752
v_smfmac_f32_16x16x64_bf16 v[28:31], v[72:75], a[32:39], v0
s_mov_b32 m0, 0
s_nop 0
buffer_load_dword v6, s[4:7], s39 offen lds
s_waitcnt lgkmcnt(1)
v_smfmac_f32_16x16x64_bf16 v[28:31], v[60:63], v[44:51], v0
ds_read_b128 v[44:47], v2 offset:14336
v_smfmac_f32_16x16x64_bf16 v[32:35], v[76:79], v[248:255], v0
ds_read_b128 v[48:51], v2 offset:15360
s_waitcnt lgkmcnt(2)
s_barrier
v_smfmac_f32_16x16x64_bf16 v[32:35], v[64:67], a[8:15], v0
ds_read_b64_tr_b16 v[20:21], v4 offset:10240
ds_read_b64_tr_b16 v[22:23], v4 offset:10752
v_add_f32 v28, v28, v30
v_smfmac_f32_16x16x64_bf16 v[32:35], v[68:71], a[24:31], v0
ds_read_b64_tr_b16 v[24:25], v4 offset:11264
v_add_f32 v29, v29, v31
v_smfmac_f32_16x16x64_bf16 v[32:35], v[72:75], a[40:47], v0
ds_read_b64_tr_b16 v[26:27], v4 offset:11776
v_cvt_pk_bf16_f32 v30, v28, v29
s_waitcnt lgkmcnt(4)
v_smfmac_f32_16x16x64_bf16 v[32:35], v[60:63], v[44:51], v0
ds_read_b128 v[44:47], v2 offset:18432
s_waitcnt vmcnt(4)
s_waitcnt lgkmcnt(3)
v_mfma_f32_16x16x32_bf16 v[12:15], v[12:15], v[20:23], 0
ds_read_b128 v[48:51], v2 offset:19456
s_waitcnt lgkmcnt(2)
v_mfma_f32_16x16x32_bf16 v[12:15], v[16:19], v[24:27], v[12:15]
v_add_f32 v32, v32, v34
v_add_f32 v33, v33, v35
v_cvt_pk_bf16_f32 v31, v32, v33
ds_write_b64 v3, v[30:31] offset:12800
v_smfmac_f32_16x16x64_bf16 v[36:39], v[76:79], a[112:119], v0
s_nop 2
v_add_f32_dpp v12, v14, v12 quad_perm:[2,3,0,1] row_mask:0xf bank_mask:0xf
v_add_f32_dpp v13, v15, v13 quad_perm:[2,3,0,1] row_mask:0xf bank_mask:0xf
ds_write_b64 v5, v[12:13] offset:14592
v_smfmac_f32_16x16x64_bf16 v[40:43], v[76:79], a[120:127], v0
s_waitcnt lgkmcnt(1)
s_barrier
ds_read_b64_tr_b16 v[28:29], v4 offset:12288
v_smfmac_f32_16x16x64_bf16 v[36:39], v[60:63], a[128:135], v0
ds_read_b64_tr_b16 v[30:31], v4 offset:12800
ds_read_b64_tr_b16 v[32:33], v4 offset:13312
v_smfmac_f32_16x16x64_bf16 v[40:43], v[60:63], a[136:143], v0
ds_read_b64_tr_b16 v[34:35], v4 offset:13824
v_mov_b64 v[76:77], s[52:53]
s_waitcnt lgkmcnt(4)
s_barrier
ds_read_b128 v[12:15], v1 offset:14336
v_smfmac_f32_16x16x64_bf16 v[40:43], v[72:75], v[44:51], v0
ds_read_b128 v[44:47], v2 offset:16384
v_mov_b64 v[78:79], s[52:53]
s_waitcnt lgkmcnt(4)
v_mfma_f32_16x16x32_bf16 v[28:31], v[28:31], v[20:23], 0
ds_read_b128 v[48:51], v2 offset:17408
s_waitcnt lgkmcnt(3)
v_mfma_f32_16x16x32_bf16 v[28:31], v[32:35], v[24:27], v[28:31]
v_smfmac_f32_16x16x64_bf16 v[40:43], v[64:67], a[152:159], v0
s_waitcnt lgkmcnt(2)
v_max3_f32 v17, v12, v13, v14
v_smfmac_f32_16x16x64_bf16 v[36:39], v[64:67], a[144:151], v0
ds_read_b128 v[60:63], v2 offset:22528
v_add_f32_dpp v28, v30, v28 quad_perm:[2,3,0,1] row_mask:0xf bank_mask:0xf
v_add_f32_dpp v29, v31, v29 quad_perm:[2,3,0,1] row_mask:0xf bank_mask:0xf
v_max_f32 v17, v17, v15
v_max_f32 v16, v28, v29
v_mul_f32 v16, s50, v16
v_max_f32_dpp v17, v17, v17 quad_perm:[2,3,0,1] row_mask:0xf bank_mask:0xf
v_smfmac_f32_16x16x64_bf16 v[40:43], v[68:71], a[168:175], v0
ds_read_b128 v[64:67], v2 offset:23552
v_max_f32_dpp v18, v16, v17 quad_perm:[0,1,0,1] row_mask:0xf bank_mask:0xf
v_max_f32_dpp v19, v16, v17 quad_perm:[0,1,0,1] row_mask:0xf bank_mask:0xf
v_smfmac_f32_16x16x64_bf16 v[36:39], v[68:71], a[160:167], v0
ds_read_b128 v[68:71], v2 offset:24576
v_permlane16_swap_b32 v18, v19
v_max_f32 v20, v18, v19
v_max_f32 v21, v18, v19
s_waitcnt lgkmcnt(3)
v_smfmac_f32_16x16x64_bf16 v[36:39], v[72:75], v[44:51], v0
ds_read_b128 v[72:75], v2 offset:25600
v_permlane32_swap_b32 v20, v21
v_max_f32 v20, v20, v21
v_sub_f32 v12, v12, v20
v_sub_f32 v13, v13, v20
v_pk_add_f32 v[14:15], v[14:15], v[20:21] op_sel_hi:[1,0] neg_lo:[0,1] neg_hi:[0,1]
v_exp_f32 v12, v12
v_exp_f32 v13, v13
v_exp_f32 v14, v14
v_exp_f32 v15, v15
v_cvt_pk_bf16_f32 v16, v12, v13
v_cvt_pk_bf16_f32 v17, v14, v15
v_pk_fma_f32 v[28:29], v[28:29], s[50:51], v[20:21] op_sel_hi:[1,1,0] neg_lo:[0,0,1] neg_hi:[0,0,1]
v_mov_b32_dpp v18, v16 quad_perm:[2,3,0,1] row_mask:0xf bank_mask:0xf
v_mov_b32_dpp v19, v17 quad_perm:[2,3,0,1] row_mask:0xf bank_mask:0xf
v_exp_f32 v28, v28
s_waitcnt vmcnt(2)
v_mfma_f32_16x16x32_bf16 v[32:35], v[76:79], v[16:19], 0
v_exp_f32 v29, v29
v_mfma_f32_16x16x32_bf16 v[20:23], v[52:55], v[16:19], 0
v_cvt_pk_bf16_f32 v12, v28, v29
v_cvt_pk_bf16_f32 v13, v28, v29
v_mov_b64 v[14:15], s[0:1]
v_mfma_f32_16x16x32_bf16 v[24:27], v[56:59], v[16:19], 0
v_cvt_pk_bf16_f32 v36, v36, v37
v_cvt_pk_bf16_f32 v37, v38, v39
v_mfma_f32_16x16x16_bf16 v[32:35], v[14:15], v[12:13], v[32:35]
v_cvt_pk_bf16_f32 v38, v40, v41
v_cvt_pk_bf16_f32 v39, v42, v43
v_mfma_f32_16x16x16_bf16 v[20:23], v[36:37], v[12:13], v[20:23]
ds_read_b128 v[44:47], v2 offset:20480
v_mfma_f32_16x16x16_bf16 v[24:27], v[38:39], v[12:13], v[24:27]
ds_read_b128 v[48:51], v2 offset:21504
v_rcp_f32 v32, v32
v_mov_b64 v[28:29], 0
v_mov_b64 v[30:31], 0
v_pk_mul_f32 v[20:21], v[20:21], v[32:33] op_sel_hi:[1,0]
v_pk_mul_f32 v[22:23], v[22:23], v[32:33] op_sel_hi:[1,0]
v_cvt_pk_bf16_f32 v20, v20, v21
v_cvt_pk_bf16_f32 v21, v22, v23
ds_write_b64 v1, v[20:21] offset:6144
v_pk_mul_f32 v[24:25], v[24:25], v[32:33] op_sel_hi:[1,0]
v_pk_mul_f32 v[26:27], v[26:27], v[32:33] op_sel_hi:[1,0]
v_cvt_pk_bf16_f32 v24, v24, v25
v_cvt_pk_bf16_f32 v25, v26, v27
ds_write_b64 v1, v[24:25] offset:6152
v_mov_b64 v[76:77], 0
ds_read_b128 v[12:15], v7 offset:6144
v_mov_b64 v[78:79], 0
v_mov_b64 v[40:41], 0
v_mov_b64 v[42:43], 0
v_mov_b64 v[36:37], 0
v_mov_b64 v[38:39], 0
v_mov_b64 v[32:33], 0
v_mov_b64 v[34:35], 0
s_waitcnt lgkmcnt(1)
s_barrier
ds_read_b128 v[16:19], v7 offset:7168
ds_read_b128 v[52:55], v7 offset:8192
ds_read_b128 v[56:59], v7 offset:5120
s_waitcnt lgkmcnt(3)
v_smfmac_f32_16x16x64_bf16 v[28:31], v[12:15], v[44:51], v0 abid:1
v_smfmac_f32_16x16x64_bf16 v[76:79], v[12:15], v[60:67], v0 abid:1
ds_read_b128 v[44:47], v2 offset:26624
s_waitcnt lgkmcnt(3)
v_smfmac_f32_16x16x64_bf16 v[28:31], v[16:19], a[176:183], v0 abid:1
ds_read_b128 v[48:51], v2 offset:27648
s_waitcnt lgkmcnt(3)
v_smfmac_f32_16x16x64_bf16 v[28:31], v[52:55], v[68:75], v0 abid:1
ds_read_b128 v[60:63], v2 offset:28672
s_waitcnt lgkmcnt(3)
v_smfmac_f32_16x16x64_bf16 v[28:31], v[56:59], a[184:191], v0 abid:1
ds_read_b128 v[64:67], v2 offset:29696
v_smfmac_f32_16x16x64_bf16 v[76:79], v[16:19], a[192:199], v0 abid:1
ds_read_b128 v[68:71], v2 offset:30720
s_waitcnt lgkmcnt(3)
v_smfmac_f32_16x16x64_bf16 v[76:79], v[52:55], v[44:51], v0 abid:1
ds_read_b128 v[72:75], v2 offset:31744
v_cvt_pk_bf16_f32 v28, v28, v29
v_cvt_pk_bf16_f32 v29, v30, v31
v_bfi_b32 v28, 1, s35, v28
buffer_store_dwordx2 v[28:29], v8, s[4:7], s42 offen sc0 sc1
v_smfmac_f32_16x16x64_bf16 v[76:79], v[56:59], a[200:207], v0 abid:1
ds_read_b128 v[44:47], v2 offset:32768
s_waitcnt lgkmcnt(3)
v_smfmac_f32_16x16x64_bf16 v[40:43], v[12:15], v[60:67], v0 abid:1
ds_read_b128 v[48:51], v2 offset:33792
v_smfmac_f32_16x16x64_bf16 v[40:43], v[16:19], a[208:215], v0 abid:1
ds_read_b128 v[60:63], v2 offset:34816
v_cvt_pk_bf16_f32 v76, v76, v77
v_cvt_pk_bf16_f32 v77, v78, v79
v_bfi_b32 v76, 1, s35, v76
buffer_store_dwordx2 v[76:77], v8, s[4:7], s43 offen sc0 sc1
s_waitcnt lgkmcnt(3)
v_smfmac_f32_16x16x64_bf16 v[40:43], v[52:55], v[68:75], v0 abid:1
ds_read_b128 v[64:67], v2 offset:35840
v_smfmac_f32_16x16x64_bf16 v[40:43], v[56:59], a[216:223], v0 abid:1
ds_read_b128 v[68:71], v2 offset:36864
s_waitcnt lgkmcnt(3)
v_smfmac_f32_16x16x64_bf16 v[36:39], v[12:15], v[44:51], v0 abid:1
ds_read_b128 v[72:75], v2 offset:37888
v_smfmac_f32_16x16x64_bf16 v[36:39], v[16:19], a[224:231], v0 abid:1
ds_read_b128 v[44:47], v2 offset:38912
v_cvt_pk_bf16_f32 v40, v40, v41
s_waitcnt lgkmcnt(3)
v_smfmac_f32_16x16x64_bf16 v[36:39], v[52:55], v[60:67], v0 abid:1
ds_read_b128 v[48:51], v2 offset:39936
v_cvt_pk_bf16_f32 v41, v42, v43
v_smfmac_f32_16x16x64_bf16 v[36:39], v[56:59], a[232:239], v0 abid:1
v_bfi_b32 v40, 1, s35, v40
buffer_store_dwordx2 v[40:41], v8, s[4:7], s44 offen sc0 sc1
s_waitcnt lgkmcnt(2)
v_smfmac_f32_16x16x64_bf16 v[32:35], v[12:15], v[68:75], v0 abid:1
v_smfmac_f32_16x16x64_bf16 v[32:35], v[16:19], a[240:247], v0 abid:1
v_cvt_pk_bf16_f32 v36, v36, v37
s_waitcnt lgkmcnt(0)
v_smfmac_f32_16x16x64_bf16 v[32:35], v[52:55], v[44:51], v0 abid:1
v_cvt_pk_bf16_f32 v37, v38, v39
v_smfmac_f32_16x16x64_bf16 v[32:35], v[56:59], a[248:255], v0 abid:1
v_bfi_b32 v36, 1, s35, v36
buffer_store_dwordx2 v[36:37], v8, s[4:7], s45 offen sc0 sc1
s_nop 5
v_cvt_pk_bf16_f32 v32, v32, v33
v_cvt_pk_bf16_f32 v33, v34, v35
v_bfi_b32 v32, 1, s35, v32
buffer_store_dwordx2 v[32:33], v8, s[4:7], s46 offen sc0 sc1
s_branch L_ex_w1rs
L_done_w1rs:
buffer_store_dword v79, v10, s[4:7], s40 offen sc0 sc1
s_waitcnt vmcnt(0) lgkmcnt(0)
s_endpgm
L_ra0_w1rs:
s_mov_b32 s38, 1
s_mov_b32 m0, 1024
s_nop 0
buffer_load_dwordx4 v1, s[4:7], s47 offen offset:0 sc0 sc1 lds
buffer_load_dwordx4 v1, s[4:7], s47 offen offset:1024 sc0 sc1 lds
buffer_load_dwordx4 v1, s[4:7], s47 offen offset:2048 sc0 sc1 lds
buffer_load_dwordx4 v1, s[4:7], s47 offen offset:3072 sc0 sc1 lds
s_sub_u32 s41, s41, 1
s_cbranch_scc1 L_exit
ds_read_b128 v[44:47], v2 offset:0
ds_read_b128 v[48:51], v2 offset:1024
v_mov_b64 v[20:21], 0
v_mov_b64 v[22:23], 0
v_mov_b64 v[24:25], 0
v_mov_b64 v[26:27], 0
v_mov_b64 v[28:29], 0
v_mov_b64 v[30:31], 0
v_mov_b64 v[32:33], 0
v_mov_b64 v[34:35], 0
v_mov_b64 v[36:37], 0
v_mov_b64 v[38:39], 0
v_mov_b64 v[40:41], 0
v_mov_b64 v[42:43], 0
s_waitcnt vmcnt(0)
ds_read_b128 v[60:63], v1 offset:1024
ds_read_b128 v[64:67], v1 offset:2048
ds_read_b128 v[68:71], v1 offset:3072
ds_read_b128 v[72:75], v1 offset:4096
s_branch L_s0_w1rs
L_ra1_w1rs:
s_mov_b32 s38, 1
s_waitcnt lgkmcnt(0)
s_barrier
s_mov_b32 m0, 5120
s_nop 0
buffer_load_dwordx4 v1, s[4:7], s48 offen offset:1024 sc0 sc1 lds
s_sub_u32 s41, s41, 1
s_cbranch_scc1 L_exit
s_waitcnt vmcnt(0)
s_barrier
ds_read_b128 v[76:79], v1 offset:5120
ds_read_b128 v[60:63], v1 offset:6144
ds_read_b128 v[64:67], v1 offset:7168
ds_read_b128 v[68:71], v1 offset:8192
ds_read_b128 v[72:75], v1 offset:9216
s_waitcnt lgkmcnt(0)
v_bitop3_b32 v6, v76, v60, s35 bitop3:0x7e
v_bitop3_b32 v6, v6, v64, s35 bitop3:0xf6
v_bitop3_b32 v6, v6, v68, s35 bitop3:0xf6
v_bitop3_b32 v6, v6, v72, s35 bitop3:0xf6
v_and_b32 v6, 1, v6
v_cmp_ne_u32 vcc, 0, v6
v_lshlrev_b32 v6, 2, v1
s_cbranch_vccnz L_ra1_w1rs
s_branch L_a1_w1rs
L_rr_w1rs:
buffer_load_dwordx4 v[60:63], v9, s[4:7], s3 offen offset:0 sc0 sc1
buffer_load_dwordx4 v[64:67], v9, s[4:7], s3 offen offset:1024 sc0 sc1
buffer_load_dwordx4 v[68:71], v9, s[4:7], s3 offen offset:2048 sc0 sc1
buffer_load_dwordx4 v[72:75], v9, s[4:7], s3 offen offset:3072 sc0 sc1
s_sub_u32 s41, s41, 1
s_cbranch_scc1 L_exit
s_waitcnt vmcnt(0)
s_branch L_r_w1rs
L_pro_w2r:
v_and_b32 v20, 63, v0
v_and_b32 v21, 15, v0
v_bfe_u32 v22, v0, 4, 2
v_lshlrev_b32 v1, 4, v20
v_add_u32 v2, 98304, v1
v_bfe_u32 v23, v20, 3, 1
v_lshlrev_b32 v26, 3, v23
v_bfe_u32 v23, v20, 4, 2
v_lshl_add_u32 v26, v23, 1, v26
v_bfe_u32 v23, v20, 2, 1
v_add_u32 v26, v26, v23
v_lshlrev_b32 v26, 13, v26
v_and_b32 v23, 3, v20
v_lshl_add_u32 v26, v23, 4, v26
v_lshrrev_b32 v24, 2, v20
v_mul_u32_u24 v27, 1152, v24
v_lshl_add_u32 v27, v23, 4, v27
v_lshrrev_b32 v24, 2, v21
v_lshl_add_u32 v25, v22, 3, v24
v_lshlrev_b32 v28, 6, v25
v_lshl_add_u32 v28, v23, 3, v28
v_add_u32 v28, 98304, v28
v_and_b32 v25, 1, v22
v_lshlrev_b32 v29, 10, v25
v_lshrrev_b32 v25, 1, v22
v_lshl_add_u32 v29, v25, 8, v29
v_and_b32 v25, 1, v24
v_lshl_add_u32 v29, v25, 6, v29
v_lshrrev_b32 v25, 1, v24
v_lshl_add_u32 v29, v25, 3, v29
v_lshl_add_u32 v29, v23, 4, v29
v_add_u32 v29, 98304, v29
s_lshl_b32 s54, s32, 8
s_add_u32 s54, s54, 128
s_mul_i32 s55, s32, 147456
s_waitcnt lgkmcnt(0)
s_add_u32 s56, s54, 524288
s_mov_b32 m0, 118784
s_nop 0
buffer_load_dwordx4 v26, s[8:11], s56 offen lds
s_add_u32 s56, s54, 655360
s_mov_b32 m0, 119808
s_nop 0
buffer_load_dwordx4 v26, s[8:11], s56 offen lds
s_add_u32 s56, s54, 786432
s_mov_b32 m0, 120832
s_nop 0
buffer_load_dwordx4 v26, s[8:11], s56 offen lds
s_add_u32 s56, s54, 917504
s_mov_b32 m0, 121856
s_nop 0
buffer_load_dwordx4 v26, s[8:11], s56 offen lds
s_add_u32 s56, s54, 1048576
s_mov_b32 m0, 122880
s_nop 0
buffer_load_dwordx4 v26, s[8:11], s56 offen lds
s_add_u32 s56, s54, 1179648
s_mov_b32 m0, 123904
s_nop 0
buffer_load_dwordx4 v26, s[8:11], s56 offen lds
s_add_u32 s56, s54, 1310720
s_mov_b32 m0, 124928
s_nop 0
buffer_load_dwordx4 v26, s[8:11], s56 offen lds
s_add_u32 s56, s54, 1441792
s_mov_b32 m0, 125952
s_nop 0
buffer_load_dwordx4 v26, s[8:11], s56 offen lds
s_add_u32 s56, s54, 2621440
s_mov_b32 m0, 126976
s_nop 0
buffer_load_dwordx4 v26, s[8:11], s56 offen lds
s_add_u32 s56, s54, 2752512
s_mov_b32 m0, 128000
s_nop 0
buffer_load_dwordx4 v26, s[8:11], s56 offen lds
s_add_u32 s56, s54, 2883584
s_mov_b32 m0, 129024
s_nop 0
buffer_load_dwordx4 v26, s[8:11], s56 offen lds
s_add_u32 s56, s54, 3014656
s_mov_b32 m0, 130048
s_nop 0
buffer_load_dwordx4 v26, s[8:11], s56 offen lds
s_add_u32 s56, s54, 3145728
s_mov_b32 m0, 98304
s_nop 0
buffer_load_dwordx4 v26, s[8:11], s56 offen lds
s_add_u32 s56, s54, 3276800
s_mov_b32 m0, 99328
s_nop 0
buffer_load_dwordx4 v26, s[8:11], s56 offen lds
s_add_u32 s56, s54, 3407872
s_mov_b32 m0, 100352
s_nop 0
buffer_load_dwordx4 v26, s[8:11], s56 offen lds
s_add_u32 s56, s54, 3538944
s_mov_b32 m0, 101376
s_nop 0
buffer_load_dwordx4 v26, s[8:11], s56 offen lds
s_add_u32 s56, s54, 3670016
s_mov_b32 m0, 102400
s_nop 0
buffer_load_dwordx4 v26, s[8:11], s56 offen lds
s_add_u32 s56, s54, 3801088
s_mov_b32 m0, 103424
s_nop 0
buffer_load_dwordx4 v26, s[8:11], s56 offen lds
s_add_u32 s56, s54, 3932160
s_mov_b32 m0, 104448
s_nop 0
buffer_load_dwordx4 v26, s[8:11], s56 offen lds
s_add_u32 s56, s54, 4063232
s_mov_b32 m0, 105472
s_nop 0
buffer_load_dwordx4 v26, s[8:11], s56 offen lds
s_add_u32 s56, s54, 4194304
s_mov_b32 m0, 106496
s_nop 0
buffer_load_dwordx4 v26, s[8:11], s56 offen lds
s_add_u32 s56, s54, 4325376
s_mov_b32 m0, 107520
s_nop 0
buffer_load_dwordx4 v26, s[8:11], s56 offen lds
s_add_u32 s56, s54, 4456448
s_mov_b32 m0, 108544
s_nop 0
buffer_load_dwordx4 v26, s[8:11], s56 offen lds
s_add_u32 s56, s54, 4587520
s_mov_b32 m0, 109568
s_nop 0
buffer_load_dwordx4 v26, s[8:11], s56 offen lds
s_add_u32 s56, s54, 0
s_mov_b32 m0, 110592
s_nop 0
buffer_load_dwordx4 v26, s[12:15], s56 offen lds
s_add_u32 s56, s54, 131072
s_mov_b32 m0, 111616
s_nop 0
buffer_load_dwordx4 v26, s[12:15], s56 offen lds
s_add_u32 s56, s54, 262144
s_mov_b32 m0, 112640
s_nop 0
buffer_load_dwordx4 v26, s[12:15], s56 offen lds
s_add_u32 s56, s54, 393216
s_mov_b32 m0, 113664
s_nop 0
buffer_load_dwordx4 v26, s[12:15], s56 offen lds
v_bfe_u32 v23, v21, 1, 1
v_and_b32 v24, 1, v21
v_lshl_add_u32 v23, v24, 16, v23
v_mul_u32_u24 v23, 0xaaaa, v23
v_add_u32 v0, 0x44444444, v23
v_lshlrev_b32 v3, 3, v20
v_lshrrev_b32 v25, 5, v20
v_lshlrev_b32 v25, 6, v25
v_xor_b32 v3, v3, v25
v_lshrrev_b32 v25, 2, v20
v_and_b32 v4, 3, v21
v_lshl_add_u32 v4, v4, 4, v25
v_lshlrev_b32 v4, 3, v4
v_bfe_u32 v25, v21, 1, 1
v_lshlrev_b32 v23, 6, v25
v_xor_b32 v4, v4, v23
v_and_b32 v23, 2, v22
v_xor_b32 v5, v21, v23
v_lshlrev_b32 v5, 4, v5
v_lshl_add_u32 v5, v25, 10, v5
v_and_b32 v23, 1, v22
v_lshl_add_u32 v5, v23, 3, v5
v_lshlrev_b32 v9, 8, v22
v_lshl_add_u32 v9, v25, 6, v9
v_bfe_u32 v23, v21, 3, 1
v_lshl_add_u32 v9, v23, 7, v9
v_bfe_u32 v23, v21, 2, 1
v_lshl_add_u32 v9, v23, 5, v9
v_and_b32 v23, 1, v21
v_lshl_add_u32 v9, v23, 4, v9
v_lshrrev_b32 v23, 1, v22
v_and_b32 v24, 1, v22
v_and_b32 v25, 7, v21
v_lshrrev_b32 v7, 3, v21
v_lshl_add_u32 v8, v7, 1, v23
v_lshlrev_b32 v8, 12, v8
v_lshl_add_u32 v8, v24, 7, v8
v_and_b32 v25, 4, v21
v_lshl_add_u32 v8, v25, 3, v8
v_and_b32 v25, 1, v21
v_lshl_add_u32 v8, v25, 4, v8
v_bfe_u32 v25, v21, 1, 1
v_lshl_add_u32 v8, v25, 3, v8
s_lshr_b32 s56, s32, 1
s_lshl_b32 s56, s56, 8
s_and_b32 s57, s32, 1
s_lshl_b32 s57, s57, 6
s_add_u32 s56, s56, s57
s_add_u32 s56, s56, 32768
v_add_u32 v8, s56, v8
v_and_b32 v7, 12, v21
v_bfe_u32 v25, v21, 1, 1
v_add_u32 v7, v7, v25
v_lshlrev_b32 v7, 4, v7
v_lshl_add_u32 v7, v22, 8, v7
s_mov_b32 s42, 0
s_mov_b32 s43, 65536
s_mov_b32 s44, 131072
s_mov_b32 s45, 196608
s_mov_b32 s46, 262144
s_mov_b32 s47, 294912
s_mov_b32 s48, 299008
s_mov_b32 s49, 303104
s_mov_b32 s50, 0x3e0293ee
s_mov_b32 s51, 0x3e0293ee
s_mov_b32 s52, 0x3f803f80
s_mov_b32 s53, 0x3f803f80
v_and_b32 v11, 3, v21
v_cmp_eq_u32 vcc, 0, v11
s_nop 1
v_cndmask_b32 v11, 0, 1, vcc
s_mov_b32 s34, 0
s_mov_b32 s35, -1
s_mov_b32 s36, 0
s_mov_b32 s41, 2000000
s_lshl_b32 s37, s32, 14
s_add_u32 s39, s37, 17309696
s_add_u32 s37, s37, 16785408
s_mov_b32 s40, 8749056
v_mov_b64 v[36:37], 0
v_mov_b64 v[38:39], 0
s_lshl_b32 s56, s32, 1
s_add_u32 s56, s56, 1
s_cmp_eq_u32 s56, 0
s_cselect_b32 s56, 64, s56
s_mul_i32 s56, s56, 10240
s_add_u32 s56, s56, 8388608
s_add_u32 s57, s56, 4096
v_mov_b32 v40, 1
v_mov_b32 v41, 1
v_mov_b32 v42, 1
v_mov_b32 v43, 1
buffer_store_dwordx4 v[40:43], v1, s[4:7], s56 offen offset:0 sc0 sc1
buffer_store_dwordx4 v[40:43], v1, s[4:7], s56 offen offset:1024 sc0 sc1
buffer_store_dwordx4 v[40:43], v1, s[4:7], s56 offen offset:2048 sc0 sc1
buffer_store_dwordx4 v[40:43], v1, s[4:7], s56 offen offset:3072 sc0 sc1
s_add_u32 s56, s32, 0
s_lshl_b32 s3, s56, 12
v_and_b32 v23, 1, v21
v_bfe_u32 v24, v21, 2, 1
v_bfe_u32 v25, v21, 1, 1
s_lshl_b32 s57, s56, 7
s_add_u32 s57, s57, 294912
v_and_b32 v10, 7, v21
v_lshlrev_b32 v10, 2, v10
v_lshl_add_u32 v10, v22, 5, v10
v_add_u32 v10, s57, v10
s_lshl_b32 s33, s56, 2
s_add_u32 s33, s33, 304128
v_mov_b32 v30, -1
s_mov_b64 exec, 1
buffer_store_dword v30, v1, s[4:7], s33 offen sc0 sc1
s_mov_b64 exec, -1
v_lshl_add_u32 v23, v23, 1, v24
v_lshlrev_b32 v25, 4, v25
v_mov_b32 v24, 0x3f80
v_lshlrev_b32 v24, v25, v24
v_cmp_eq_u32 vcc, 0, v23
s_nop 1
v_cndmask_b32 v76, 0, v24, vcc
v_cmp_eq_u32 vcc, 1, v23
s_nop 1
v_cndmask_b32 v77, 0, v24, vcc
v_cmp_eq_u32 vcc, 2, v23
s_nop 1
v_cndmask_b32 v78, 0, v24, vcc
v_cmp_eq_u32 vcc, 3, v23
s_nop 1
v_cndmask_b32 v79, 0, v24, vcc
v_and_b32 v23, 0x70, v1
ds_write_b128 v23, v[76:79] offset:256
buffer_store_dwordx4 v[36:39], v9, s[4:7], s3 offen offset:0 sc0 sc1
buffer_store_dwordx4 v[36:39], v9, s[4:7], s3 offen offset:1024 sc0 sc1
buffer_store_dwordx4 v[36:39], v9, s[4:7], s3 offen offset:2048 sc0 sc1
buffer_store_dwordx4 v[36:39], v9, s[4:7], s3 offen offset:3072 sc0 sc1
s_waitcnt vmcnt(0) lgkmcnt(0)
s_barrier
s_getreg_b32 s56, hwreg(HW_REG_XCC_ID)
s_and_b32 s56, s56, 15
s_mul_i32 s57, s56, s56
s_lshl_b32 s57, s57, 18
s_lshl_b32 s56, s56, 8
s_add_u32 s57, s57, s56
s_add_u32 s58, s57, 1
ds_read_b64_tr_b16 v[80:81], v28 offset:20480
ds_read_b64_tr_b16 v[82:83], v28 offset:20736
ds_read_b64_tr_b16 v[84:85], v28 offset:22528
ds_read_b64_tr_b16 v[86:87], v28 offset:22784
ds_read_b64_tr_b16 v[88:89], v28 offset:20512
ds_read_b64_tr_b16 v[90:91], v28 offset:20768
ds_read_b64_tr_b16 v[92:93], v28 offset:22560
ds_read_b64_tr_b16 v[94:95], v28 offset:22816
s_waitcnt lgkmcnt(0)
s_add_u32 s56, s54, 524288
s_mov_b32 m0, 114688
s_nop 0
buffer_load_dwordx4 v26, s[12:15], s56 offen lds
s_add_u32 s56, s54, 655360
s_mov_b32 m0, 115712
s_nop 0
buffer_load_dwordx4 v26, s[12:15], s56 offen lds
s_add_u32 s56, s54, 786432
s_mov_b32 m0, 116736
s_nop 0
buffer_load_dwordx4 v26, s[12:15], s56 offen lds
s_add_u32 s56, s54, 917504
s_mov_b32 m0, 117760
s_nop 0
buffer_load_dwordx4 v26, s[12:15], s56 offen lds
ds_read_b64_tr_b16 v[96:97], v28 offset:24576
ds_read_b64_tr_b16 v[98:99], v28 offset:24832
ds_read_b64_tr_b16 v[100:101], v28 offset:26624
ds_read_b64_tr_b16 v[102:103], v28 offset:26880
ds_read_b64_tr_b16 v[104:105], v28 offset:24608
ds_read_b64_tr_b16 v[106:107], v28 offset:24864
ds_read_b64_tr_b16 v[108:109], v28 offset:26656
ds_read_b64_tr_b16 v[110:111], v28 offset:26912
s_waitcnt lgkmcnt(0)
s_add_u32 s56, s54, 1048576
s_mov_b32 m0, 118784
s_nop 0
buffer_load_dwordx4 v26, s[12:15], s56 offen lds
s_add_u32 s56, s54, 1179648
s_mov_b32 m0, 119808
s_nop 0
buffer_load_dwordx4 v26, s[12:15], s56 offen lds
s_add_u32 s56, s54, 1310720
s_mov_b32 m0, 120832
s_nop 0
buffer_load_dwordx4 v26, s[12:15], s56 offen lds
s_add_u32 s56, s54, 1441792
s_mov_b32 m0, 121856
s_nop 0
buffer_load_dwordx4 v26, s[12:15], s56 offen lds
ds_read_b64_tr_b16 v[112:113], v28 offset:28672
ds_read_b64_tr_b16 v[114:115], v28 offset:28928
ds_read_b64_tr_b16 v[116:117], v28 offset:30720
ds_read_b64_tr_b16 v[118:119], v28 offset:30976
ds_read_b64_tr_b16 v[120:121], v28 offset:28704
ds_read_b64_tr_b16 v[122:123], v28 offset:28960
ds_read_b64_tr_b16 v[124:125], v28 offset:30752
ds_read_b64_tr_b16 v[126:127], v28 offset:31008
s_waitcnt lgkmcnt(0)
s_add_u32 s56, s54, 1572864
s_mov_b32 m0, 122880
s_nop 0
buffer_load_dwordx4 v26, s[12:15], s56 offen lds
s_add_u32 s56, s54, 1703936
s_mov_b32 m0, 123904
s_nop 0
buffer_load_dwordx4 v26, s[12:15], s56 offen lds
s_add_u32 s56, s54, 1835008
s_mov_b32 m0, 124928
s_nop 0
buffer_load_dwordx4 v26, s[12:15], s56 offen lds
s_add_u32 s56, s54, 1966080
s_mov_b32 m0, 125952
s_nop 0
buffer_load_dwordx4 v26, s[12:15], s56 offen lds
ds_read_b64_tr_b16 v[128:129], v28 offset:0
ds_read_b64_tr_b16 v[130:131], v28 offset:256
ds_read_b64_tr_b16 v[132:133], v28 offset:2048
ds_read_b64_tr_b16 v[134:135], v28 offset:2304
ds_read_b64_tr_b16 v[136:137], v28 offset:32
ds_read_b64_tr_b16 v[138:139], v28 offset:288
ds_read_b64_tr_b16 v[140:141], v28 offset:2080
ds_read_b64_tr_b16 v[142:143], v28 offset:2336
s_waitcnt lgkmcnt(0)
s_add_u32 s56, s54, 2097152
s_mov_b32 m0, 126976
s_nop 0
buffer_load_dwordx4 v26, s[12:15], s56 offen lds
s_add_u32 s56, s54, 2228224
s_mov_b32 m0, 128000
s_nop 0
buffer_load_dwordx4 v26, s[12:15], s56 offen lds
s_add_u32 s56, s54, 2359296
s_mov_b32 m0, 129024
s_nop 0
buffer_load_dwordx4 v26, s[12:15], s56 offen lds
s_add_u32 s56, s54, 2490368
s_mov_b32 m0, 130048
s_nop 0
buffer_load_dwordx4 v26, s[12:15], s56 offen lds
ds_read_b64_tr_b16 v[144:145], v28 offset:4096
ds_read_b64_tr_b16 v[146:147], v28 offset:4352
ds_read_b64_tr_b16 v[148:149], v28 offset:6144
ds_read_b64_tr_b16 v[150:151], v28 offset:6400
ds_read_b64_tr_b16 v[152:153], v28 offset:4128
ds_read_b64_tr_b16 v[154:155], v28 offset:4384
ds_read_b64_tr_b16 v[156:157], v28 offset:6176
ds_read_b64_tr_b16 v[158:159], v28 offset:6432
s_waitcnt lgkmcnt(0)
s_add_u32 s56, s54, 3145728
s_mov_b32 m0, 98304
s_nop 0
buffer_load_dwordx4 v26, s[12:15], s56 offen lds
s_add_u32 s56, s54, 3276800
s_mov_b32 m0, 99328
s_nop 0
buffer_load_dwordx4 v26, s[12:15], s56 offen lds
s_add_u32 s56, s54, 3407872
s_mov_b32 m0, 100352
s_nop 0
buffer_load_dwordx4 v26, s[12:15], s56 offen lds
s_add_u32 s56, s54, 3538944
s_mov_b32 m0, 101376
s_nop 0
buffer_load_dwordx4 v26, s[12:15], s56 offen lds
ds_read_b64_tr_b16 v[160:161], v28 offset:8192
ds_read_b64_tr_b16 v[162:163], v28 offset:8448
ds_read_b64_tr_b16 v[164:165], v28 offset:10240
ds_read_b64_tr_b16 v[166:167], v28 offset:10496
ds_read_b64_tr_b16 v[168:169], v28 offset:8224
ds_read_b64_tr_b16 v[170:171], v28 offset:8480
ds_read_b64_tr_b16 v[172:173], v28 offset:10272
ds_read_b64_tr_b16 v[174:175], v28 offset:10528
s_waitcnt lgkmcnt(0)
s_add_u32 s56, s54, 3670016
s_mov_b32 m0, 102400
s_nop 0
buffer_load_dwordx4 v26, s[12:15], s56 offen lds
s_add_u32 s56, s54, 3801088
s_mov_b32 m0, 103424
s_nop 0
buffer_load_dwordx4 v26, s[12:15], s56 offen lds
s_add_u32 s56, s54, 3932160
s_mov_b32 m0, 104448
s_nop 0
buffer_load_dwordx4 v26, s[12:15], s56 offen lds
s_add_u32 s56, s54, 4063232
s_mov_b32 m0, 105472
s_nop 0
buffer_load_dwordx4 v26, s[12:15], s56 offen lds
ds_read_b64_tr_b16 v[176:177], v28 offset:12288
ds_read_b64_tr_b16 v[178:179], v28 offset:12544
ds_read_b64_tr_b16 v[180:181], v28 offset:14336
ds_read_b64_tr_b16 v[182:183], v28 offset:14592
ds_read_b64_tr_b16 v[184:185], v28 offset:12320
ds_read_b64_tr_b16 v[186:187], v28 offset:12576
ds_read_b64_tr_b16 v[188:189], v28 offset:14368
ds_read_b64_tr_b16 v[190:191], v28 offset:14624
s_waitcnt lgkmcnt(0)
s_add_u32 s56, s54, 4194304
s_mov_b32 m0, 106496
s_nop 0
buffer_load_dwordx4 v26, s[12:15], s56 offen lds
s_add_u32 s56, s54, 4325376
s_mov_b32 m0, 107520
s_nop 0
buffer_load_dwordx4 v26, s[12:15], s56 offen lds
s_add_u32 s56, s54, 4456448
s_mov_b32 m0, 108544
s_nop 0
buffer_load_dwordx4 v26, s[12:15], s56 offen lds
s_add_u32 s56, s54, 4587520
s_mov_b32 m0, 109568
s_nop 0
buffer_load_dwordx4 v26, s[12:15], s56 offen lds
s_waitcnt vmcnt(24)
ds_read_b64_tr_b16 v[192:193], v28 offset:16384
ds_read_b64_tr_b16 v[194:195], v28 offset:16640
ds_read_b64_tr_b16 v[196:197], v28 offset:18432
ds_read_b64_tr_b16 v[198:199], v28 offset:18688
ds_read_b64_tr_b16 v[200:201], v28 offset:16416
ds_read_b64_tr_b16 v[202:203], v28 offset:16672
ds_read_b64_tr_b16 v[204:205], v28 offset:18464
ds_read_b64_tr_b16 v[206:207], v28 offset:18720
s_waitcnt lgkmcnt(0)
s_add_u32 s56, s54, 0
s_mov_b32 m0, 110592
s_nop 0
buffer_load_dwordx4 v26, s[16:19], s56 offen lds
s_add_u32 s56, s54, 131072
s_mov_b32 m0, 111616
s_nop 0
buffer_load_dwordx4 v26, s[16:19], s56 offen lds
s_add_u32 s56, s54, 262144
s_mov_b32 m0, 112640
s_nop 0
buffer_load_dwordx4 v26, s[16:19], s56 offen lds
s_add_u32 s56, s54, 393216
s_mov_b32 m0, 113664
s_nop 0
buffer_load_dwordx4 v26, s[16:19], s56 offen lds
s_waitcnt vmcnt(24)
ds_read_b64_tr_b16 v[208:209], v28 offset:20480
ds_read_b64_tr_b16 v[210:211], v28 offset:20736
ds_read_b64_tr_b16 v[212:213], v28 offset:22528
ds_read_b64_tr_b16 v[214:215], v28 offset:22784
ds_read_b64_tr_b16 v[216:217], v28 offset:20512
ds_read_b64_tr_b16 v[218:219], v28 offset:20768
ds_read_b64_tr_b16 v[220:221], v28 offset:22560
ds_read_b64_tr_b16 v[222:223], v28 offset:22816
s_waitcnt lgkmcnt(0)
s_add_u32 s56, s54, 524288
s_mov_b32 m0, 114688
s_nop 0
buffer_load_dwordx4 v26, s[16:19], s56 offen lds
s_add_u32 s56, s54, 655360
s_mov_b32 m0, 115712
s_nop 0
buffer_load_dwordx4 v26, s[16:19], s56 offen lds
s_add_u32 s56, s54, 786432
s_mov_b32 m0, 116736
s_nop 0
buffer_load_dwordx4 v26, s[16:19], s56 offen lds
s_add_u32 s56, s54, 917504
s_mov_b32 m0, 117760
s_nop 0
buffer_load_dwordx4 v26, s[16:19], s56 offen lds
s_waitcnt vmcnt(24)
ds_read_b64_tr_b16 v[224:225], v28 offset:24576
ds_read_b64_tr_b16 v[226:227], v28 offset:24832
ds_read_b64_tr_b16 v[228:229], v28 offset:26624
ds_read_b64_tr_b16 v[230:231], v28 offset:26880
ds_read_b64_tr_b16 v[232:233], v28 offset:24608
ds_read_b64_tr_b16 v[234:235], v28 offset:24864
ds_read_b64_tr_b16 v[236:237], v28 offset:26656
ds_read_b64_tr_b16 v[238:239], v28 offset:26912
s_waitcnt lgkmcnt(0)
s_add_u32 s56, s54, 1048576
s_mov_b32 m0, 118784
s_nop 0
buffer_load_dwordx4 v26, s[16:19], s56 offen lds
s_add_u32 s56, s54, 1179648
s_mov_b32 m0, 119808
s_nop 0
buffer_load_dwordx4 v26, s[16:19], s56 offen lds
s_add_u32 s56, s54, 1310720
s_mov_b32 m0, 120832
s_nop 0
buffer_load_dwordx4 v26, s[16:19], s56 offen lds
s_add_u32 s56, s54, 1441792
s_mov_b32 m0, 121856
s_nop 0
buffer_load_dwordx4 v26, s[16:19], s56 offen lds
s_waitcnt vmcnt(24)
ds_read_b64_tr_b16 v[240:241], v28 offset:28672
ds_read_b64_tr_b16 v[242:243], v28 offset:28928
ds_read_b64_tr_b16 v[244:245], v28 offset:30720
ds_read_b64_tr_b16 v[246:247], v28 offset:30976
ds_read_b64_tr_b16 v[248:249], v28 offset:28704
ds_read_b64_tr_b16 v[250:251], v28 offset:28960
ds_read_b64_tr_b16 v[252:253], v28 offset:30752
ds_read_b64_tr_b16 v[254:255], v28 offset:31008
s_waitcnt lgkmcnt(0)
s_add_u32 s56, s54, 1572864
s_mov_b32 m0, 122880
s_nop 0
buffer_load_dwordx4 v26, s[16:19], s56 offen lds
s_add_u32 s56, s54, 1703936
s_mov_b32 m0, 123904
s_nop 0
buffer_load_dwordx4 v26, s[16:19], s56 offen lds
s_add_u32 s56, s54, 1835008
s_mov_b32 m0, 124928
s_nop 0
buffer_load_dwordx4 v26, s[16:19], s56 offen lds
s_add_u32 s56, s54, 1966080
s_mov_b32 m0, 125952
s_nop 0
buffer_load_dwordx4 v26, s[16:19], s56 offen lds
s_waitcnt vmcnt(24)
ds_read_b64_tr_b16 a[0:1], v28 offset:0
ds_read_b64_tr_b16 a[2:3], v28 offset:256
ds_read_b64_tr_b16 a[4:5], v28 offset:2048
ds_read_b64_tr_b16 a[6:7], v28 offset:2304
ds_read_b64_tr_b16 a[8:9], v28 offset:32
ds_read_b64_tr_b16 a[10:11], v28 offset:288
ds_read_b64_tr_b16 a[12:13], v28 offset:2080
ds_read_b64_tr_b16 a[14:15], v28 offset:2336
s_waitcnt lgkmcnt(0)
s_add_u32 s56, s54, 2097152
s_mov_b32 m0, 126976
s_nop 0
buffer_load_dwordx4 v26, s[16:19], s56 offen lds
s_add_u32 s56, s54, 2228224
s_mov_b32 m0, 128000
s_nop 0
buffer_load_dwordx4 v26, s[16:19], s56 offen lds
s_add_u32 s56, s54, 2359296
s_mov_b32 m0, 129024
s_nop 0
buffer_load_dwordx4 v26, s[16:19], s56 offen lds
s_add_u32 s56, s54, 2490368
s_mov_b32 m0, 130048
s_nop 0
buffer_load_dwordx4 v26, s[16:19], s56 offen lds
s_waitcnt vmcnt(24)
ds_read_b64_tr_b16 a[16:17], v28 offset:4096
ds_read_b64_tr_b16 a[18:19], v28 offset:4352
ds_read_b64_tr_b16 a[20:21], v28 offset:6144
ds_read_b64_tr_b16 a[22:23], v28 offset:6400
ds_read_b64_tr_b16 a[24:25], v28 offset:4128
ds_read_b64_tr_b16 a[26:27], v28 offset:4384
ds_read_b64_tr_b16 a[28:29], v28 offset:6176
ds_read_b64_tr_b16 a[30:31], v28 offset:6432
s_waitcnt lgkmcnt(0)
s_add_u32 s56, s54, 2621440
s_mov_b32 m0, 98304
s_nop 0
buffer_load_dwordx4 v26, s[16:19], s56 offen lds
s_add_u32 s56, s54, 2752512
s_mov_b32 m0, 99328
s_nop 0
buffer_load_dwordx4 v26, s[16:19], s56 offen lds
s_add_u32 s56, s54, 2883584
s_mov_b32 m0, 100352
s_nop 0
buffer_load_dwordx4 v26, s[16:19], s56 offen lds
s_add_u32 s56, s54, 3014656
s_mov_b32 m0, 101376
s_nop 0
buffer_load_dwordx4 v26, s[16:19], s56 offen lds
s_waitcnt vmcnt(24)
ds_read_b64_tr_b16 a[32:33], v28 offset:8192
ds_read_b64_tr_b16 a[34:35], v28 offset:8448
ds_read_b64_tr_b16 a[36:37], v28 offset:10240
ds_read_b64_tr_b16 a[38:39], v28 offset:10496
ds_read_b64_tr_b16 a[40:41], v28 offset:8224
ds_read_b64_tr_b16 a[42:43], v28 offset:8480
ds_read_b64_tr_b16 a[44:45], v28 offset:10272
ds_read_b64_tr_b16 a[46:47], v28 offset:10528
s_waitcnt lgkmcnt(0)
s_add_u32 s56, s54, 3145728
s_mov_b32 m0, 102400
s_nop 0
buffer_load_dwordx4 v26, s[16:19], s56 offen lds
s_add_u32 s56, s54, 3276800
s_mov_b32 m0, 103424
s_nop 0
buffer_load_dwordx4 v26, s[16:19], s56 offen lds
s_add_u32 s56, s54, 3407872
s_mov_b32 m0, 104448
s_nop 0
buffer_load_dwordx4 v26, s[16:19], s56 offen lds
s_add_u32 s56, s54, 3538944
s_mov_b32 m0, 105472
s_nop 0
buffer_load_dwordx4 v26, s[16:19], s56 offen lds
s_waitcnt vmcnt(24)
ds_read_b64_tr_b16 a[48:49], v28 offset:12288
ds_read_b64_tr_b16 a[50:51], v28 offset:12544
ds_read_b64_tr_b16 a[52:53], v28 offset:14336
ds_read_b64_tr_b16 a[54:55], v28 offset:14592
ds_read_b64_tr_b16 a[56:57], v28 offset:12320
ds_read_b64_tr_b16 a[58:59], v28 offset:12576
ds_read_b64_tr_b16 a[60:61], v28 offset:14368
ds_read_b64_tr_b16 a[62:63], v28 offset:14624
s_waitcnt lgkmcnt(0)
s_add_u32 s56, s54, 3670016
s_mov_b32 m0, 106496
s_nop 0
buffer_load_dwordx4 v26, s[16:19], s56 offen lds
s_add_u32 s56, s54, 3801088
s_mov_b32 m0, 107520
s_nop 0
buffer_load_dwordx4 v26, s[16:19], s56 offen lds
s_add_u32 s56, s54, 3932160
s_mov_b32 m0, 108544
s_nop 0
buffer_load_dwordx4 v26, s[16:19], s56 offen lds
s_add_u32 s56, s54, 4063232
s_mov_b32 m0, 109568
s_nop 0
buffer_load_dwordx4 v26, s[16:19], s56 offen lds
s_waitcnt vmcnt(24)
ds_read_b64_tr_b16 a[64:65], v28 offset:16384
ds_read_b64_tr_b16 a[66:67], v28 offset:16640
ds_read_b64_tr_b16 a[68:69], v28 offset:18432
ds_read_b64_tr_b16 a[70:71], v28 offset:18688
ds_read_b64_tr_b16 a[72:73], v28 offset:16416
ds_read_b64_tr_b16 a[74:75], v28 offset:16672
ds_read_b64_tr_b16 a[76:77], v28 offset:18464
ds_read_b64_tr_b16 a[78:79], v28 offset:18720
s_waitcnt lgkmcnt(0)
s_add_u32 s56, s55, 110720
s_mov_b32 m0, 110592
s_nop 0
buffer_load_dwordx4 v27, s[20:23], s56 offen lds
s_add_u32 s56, s55, 129152
s_mov_b32 m0, 111616
s_nop 0
buffer_load_dwordx4 v27, s[20:23], s56 offen lds
s_add_u32 s56, s55, 36992
s_mov_b32 m0, 112640
s_nop 0
buffer_load_dwordx4 v27, s[20:23], s56 offen lds
s_add_u32 s56, s55, 55424
s_mov_b32 m0, 113664
s_nop 0
buffer_load_dwordx4 v27, s[20:23], s56 offen lds
s_waitcnt vmcnt(24)
ds_read_b64_tr_b16 a[80:81], v28 offset:20480
ds_read_b64_tr_b16 a[82:83], v28 offset:20736
ds_read_b64_tr_b16 a[84:85], v28 offset:22528
ds_read_b64_tr_b16 a[86:87], v28 offset:22784
ds_read_b64_tr_b16 a[88:89], v28 offset:20512
ds_read_b64_tr_b16 a[90:91], v28 offset:20768
ds_read_b64_tr_b16 a[92:93], v28 offset:22560
ds_read_b64_tr_b16 a[94:95], v28 offset:22816
s_waitcnt lgkmcnt(0)
s_add_u32 s56, s55, 110976
s_mov_b32 m0, 114688
s_nop 0
buffer_load_dwordx4 v27, s[20:23], s56 offen lds
s_add_u32 s56, s55, 129408
s_mov_b32 m0, 115712
s_nop 0
buffer_load_dwordx4 v27, s[20:23], s56 offen lds
s_add_u32 s56, s55, 37248
s_mov_b32 m0, 116736
s_nop 0
buffer_load_dwordx4 v27, s[20:23], s56 offen lds
s_add_u32 s56, s55, 55680
s_mov_b32 m0, 117760
s_nop 0
buffer_load_dwordx4 v27, s[20:23], s56 offen lds
s_waitcnt vmcnt(24)
ds_read_b64_tr_b16 a[96:97], v28 offset:24576
ds_read_b64_tr_b16 a[98:99], v28 offset:24832
ds_read_b64_tr_b16 a[100:101], v28 offset:26624
ds_read_b64_tr_b16 a[102:103], v28 offset:26880
ds_read_b64_tr_b16 a[104:105], v28 offset:24608
ds_read_b64_tr_b16 a[106:107], v28 offset:24864
ds_read_b64_tr_b16 a[108:109], v28 offset:26656
ds_read_b64_tr_b16 a[110:111], v28 offset:26912
s_waitcnt lgkmcnt(0)
s_add_u32 s56, s55, 74368
s_mov_b32 m0, 118784
s_nop 0
buffer_load_dwordx4 v27, s[20:23], s56 offen lds
s_add_u32 s56, s55, 92800
s_mov_b32 m0, 119808
s_nop 0
buffer_load_dwordx4 v27, s[20:23], s56 offen lds
s_add_u32 s56, s55, 111232
s_mov_b32 m0, 120832
s_nop 0
buffer_load_dwordx4 v27, s[20:23], s56 offen lds
s_add_u32 s56, s55, 129664
s_mov_b32 m0, 121856
s_nop 0
buffer_load_dwordx4 v27, s[20:23], s56 offen lds
s_waitcnt vmcnt(24)
ds_read_b64_tr_b16 a[112:113], v28 offset:28672
ds_read_b64_tr_b16 a[114:115], v28 offset:28928
ds_read_b64_tr_b16 a[116:117], v28 offset:30720
ds_read_b64_tr_b16 a[118:119], v28 offset:30976
ds_read_b64_tr_b16 a[120:121], v28 offset:28704
ds_read_b64_tr_b16 a[122:123], v28 offset:28960
ds_read_b64_tr_b16 a[124:125], v28 offset:30752
ds_read_b64_tr_b16 a[126:127], v28 offset:31008
s_waitcnt lgkmcnt(0)
s_add_u32 s56, s55, 640
s_mov_b32 m0, 122880
s_nop 0
buffer_load_dwordx4 v27, s[20:23], s56 offen lds
s_add_u32 s56, s55, 19072
s_mov_b32 m0, 123904
s_nop 0
buffer_load_dwordx4 v27, s[20:23], s56 offen lds
s_add_u32 s56, s55, 37504
s_mov_b32 m0, 124928
s_nop 0
buffer_load_dwordx4 v27, s[20:23], s56 offen lds
s_add_u32 s56, s55, 55936
s_mov_b32 m0, 125952
s_nop 0
buffer_load_dwordx4 v27, s[20:23], s56 offen lds
s_waitcnt vmcnt(24)
ds_read_b64_tr_b16 a[128:129], v28 offset:0
ds_read_b64_tr_b16 a[130:131], v28 offset:256
ds_read_b64_tr_b16 a[132:133], v28 offset:2048
ds_read_b64_tr_b16 a[134:135], v28 offset:2304
ds_read_b64_tr_b16 a[136:137], v28 offset:32
ds_read_b64_tr_b16 a[138:139], v28 offset:288
ds_read_b64_tr_b16 a[140:141], v28 offset:2080
ds_read_b64_tr_b16 a[142:143], v28 offset:2336
s_waitcnt lgkmcnt(0)
s_add_u32 s56, s55, 111488
s_mov_b32 m0, 126976
s_nop 0
buffer_load_dwordx4 v27, s[20:23], s56 offen lds
s_add_u32 s56, s55, 129920
s_mov_b32 m0, 128000
s_nop 0
buffer_load_dwordx4 v27, s[20:23], s56 offen lds
s_add_u32 s56, s55, 37760
s_mov_b32 m0, 129024
s_nop 0
buffer_load_dwordx4 v27, s[20:23], s56 offen lds
s_add_u32 s56, s55, 56192
s_mov_b32 m0, 130048
s_nop 0
buffer_load_dwordx4 v27, s[20:23], s56 offen lds
s_waitcnt vmcnt(24)
ds_read_b64_tr_b16 a[144:145], v28 offset:4096
ds_read_b64_tr_b16 a[146:147], v28 offset:4352
ds_read_b64_tr_b16 a[148:149], v28 offset:6144
ds_read_b64_tr_b16 a[150:151], v28 offset:6400
ds_read_b64_tr_b16 a[152:153], v28 offset:4128
ds_read_b64_tr_b16 a[154:155], v28 offset:4384
ds_read_b64_tr_b16 a[156:157], v28 offset:6176
ds_read_b64_tr_b16 a[158:159], v28 offset:6432
s_waitcnt lgkmcnt(0)
s_add_u32 s56, s54, 0
s_mov_b32 m0, 98304
s_nop 0
buffer_load_dwordx4 v26, s[8:11], s56 offen lds
s_add_u32 s56, s54, 131072
s_mov_b32 m0, 99328
s_nop 0
buffer_load_dwordx4 v26, s[8:11], s56 offen lds
s_add_u32 s56, s54, 262144
s_mov_b32 m0, 100352
s_nop 0
buffer_load_dwordx4 v26, s[8:11], s56 offen lds
s_add_u32 s56, s54, 393216
s_mov_b32 m0, 101376
s_nop 0
buffer_load_dwordx4 v26, s[8:11], s56 offen lds
s_waitcnt vmcnt(24)
ds_read_b64_tr_b16 a[160:161], v28 offset:8192
ds_read_b64_tr_b16 a[162:163], v28 offset:8448
ds_read_b64_tr_b16 a[164:165], v28 offset:10240
ds_read_b64_tr_b16 a[166:167], v28 offset:10496
ds_read_b64_tr_b16 a[168:169], v28 offset:8224
ds_read_b64_tr_b16 a[170:171], v28 offset:8480
ds_read_b64_tr_b16 a[172:173], v28 offset:10272
ds_read_b64_tr_b16 a[174:175], v28 offset:10528
s_waitcnt lgkmcnt(0)
s_add_u32 s56, s54, 1572864
s_mov_b32 m0, 102400
s_nop 0
buffer_load_dwordx4 v26, s[8:11], s56 offen lds
s_add_u32 s56, s54, 1703936
s_mov_b32 m0, 103424
s_nop 0
buffer_load_dwordx4 v26, s[8:11], s56 offen lds
s_add_u32 s56, s54, 1835008
s_mov_b32 m0, 104448
s_nop 0
buffer_load_dwordx4 v26, s[8:11], s56 offen lds
s_add_u32 s56, s54, 1966080
s_mov_b32 m0, 105472
s_nop 0
buffer_load_dwordx4 v26, s[8:11], s56 offen lds
s_waitcnt vmcnt(24)
ds_read_b64_tr_b16 a[176:177], v29 offset:12288
ds_read_b64_tr_b16 a[178:179], v29 offset:12416
ds_read_b64_tr_b16 a[180:181], v29 offset:12800
ds_read_b64_tr_b16 a[182:183], v29 offset:12928
ds_read_b64_tr_b16 a[184:185], v29 offset:14336
ds_read_b64_tr_b16 a[186:187], v29 offset:14464
ds_read_b64_tr_b16 a[188:189], v29 offset:14848
ds_read_b64_tr_b16 a[190:191], v29 offset:14976
s_waitcnt lgkmcnt(0)
s_add_u32 s56, s54, 2097152
s_mov_b32 m0, 106496
s_nop 0
buffer_load_dwordx4 v26, s[8:11], s56 offen lds
s_add_u32 s56, s54, 2228224
s_mov_b32 m0, 107520
s_nop 0
buffer_load_dwordx4 v26, s[8:11], s56 offen lds
s_add_u32 s56, s54, 2359296
s_mov_b32 m0, 108544
s_nop 0
buffer_load_dwordx4 v26, s[8:11], s56 offen lds
s_add_u32 s56, s54, 2490368
s_mov_b32 m0, 109568
s_nop 0
buffer_load_dwordx4 v26, s[8:11], s56 offen lds
s_waitcnt vmcnt(24)
ds_read_b64_tr_b16 a[192:193], v29 offset:16384
ds_read_b64_tr_b16 a[194:195], v29 offset:16512
ds_read_b64_tr_b16 a[196:197], v29 offset:16896
ds_read_b64_tr_b16 a[198:199], v29 offset:17024
ds_read_b64_tr_b16 a[200:201], v29 offset:18432
ds_read_b64_tr_b16 a[202:203], v29 offset:18560
ds_read_b64_tr_b16 a[204:205], v29 offset:18944
ds_read_b64_tr_b16 a[206:207], v29 offset:19072
s_waitcnt lgkmcnt(0)
s_add_u32 s56, s54, 2621440
s_mov_b32 m0, 110592
s_nop 0
buffer_load_dwordx4 v26, s[12:15], s56 offen lds
s_add_u32 s56, s54, 2752512
s_mov_b32 m0, 111616
s_nop 0
buffer_load_dwordx4 v26, s[12:15], s56 offen lds
s_add_u32 s56, s54, 2883584
s_mov_b32 m0, 112640
s_nop 0
buffer_load_dwordx4 v26, s[12:15], s56 offen lds
s_add_u32 s56, s54, 3014656
s_mov_b32 m0, 113664
s_nop 0
buffer_load_dwordx4 v26, s[12:15], s56 offen lds
s_waitcnt vmcnt(24)
ds_read_b64_tr_b16 a[208:209], v29 offset:20480
ds_read_b64_tr_b16 a[210:211], v29 offset:20608
ds_read_b64_tr_b16 a[212:213], v29 offset:20992
ds_read_b64_tr_b16 a[214:215], v29 offset:21120
ds_read_b64_tr_b16 a[216:217], v29 offset:22528
ds_read_b64_tr_b16 a[218:219], v29 offset:22656
ds_read_b64_tr_b16 a[220:221], v29 offset:23040
ds_read_b64_tr_b16 a[222:223], v29 offset:23168
s_waitcnt lgkmcnt(0)
s_add_u32 s56, s54, 4194304
s_mov_b32 m0, 114688
s_nop 0
buffer_load_dwordx4 v26, s[16:19], s56 offen lds
s_add_u32 s56, s54, 4325376
s_mov_b32 m0, 115712
s_nop 0
buffer_load_dwordx4 v26, s[16:19], s56 offen lds
s_add_u32 s56, s54, 4456448
s_mov_b32 m0, 116736
s_nop 0
buffer_load_dwordx4 v26, s[16:19], s56 offen lds
s_add_u32 s56, s54, 4587520
s_mov_b32 m0, 117760
s_nop 0
buffer_load_dwordx4 v26, s[16:19], s56 offen lds
s_waitcnt vmcnt(24)
ds_read_b64_tr_b16 a[224:225], v29 offset:24576
ds_read_b64_tr_b16 a[226:227], v29 offset:24704
ds_read_b64_tr_b16 a[228:229], v29 offset:25088
ds_read_b64_tr_b16 a[230:231], v29 offset:25216
ds_read_b64_tr_b16 a[232:233], v29 offset:26624
ds_read_b64_tr_b16 a[234:235], v29 offset:26752
ds_read_b64_tr_b16 a[236:237], v29 offset:27136
ds_read_b64_tr_b16 a[238:239], v29 offset:27264
s_waitcnt lgkmcnt(0)
s_add_u32 s56, s55, 73856
s_mov_b32 m0, 118784
s_nop 0
buffer_load_dwordx4 v27, s[20:23], s56 offen lds
s_add_u32 s56, s55, 92288
s_mov_b32 m0, 119808
s_nop 0
buffer_load_dwordx4 v27, s[20:23], s56 offen lds
s_add_u32 s56, s55, 74112
s_mov_b32 m0, 120832
s_nop 0
buffer_load_dwordx4 v27, s[20:23], s56 offen lds
s_add_u32 s56, s55, 92544
s_mov_b32 m0, 121856
s_nop 0
buffer_load_dwordx4 v27, s[20:23], s56 offen lds
s_waitcnt vmcnt(24)
ds_read_b64_tr_b16 a[240:241], v29 offset:28672
ds_read_b64_tr_b16 a[242:243], v29 offset:28800
ds_read_b64_tr_b16 a[244:245], v29 offset:29184
ds_read_b64_tr_b16 a[246:247], v29 offset:29312
ds_read_b64_tr_b16 a[248:249], v29 offset:30720
ds_read_b64_tr_b16 a[250:251], v29 offset:30848
ds_read_b64_tr_b16 a[252:253], v29 offset:31232
ds_read_b64_tr_b16 a[254:255], v29 offset:31360
s_waitcnt lgkmcnt(0)
s_add_u32 s56, s55, 128
s_mov_b32 m0, 122880
s_nop 0
buffer_load_dwordx4 v27, s[20:23], s56 offen lds
s_add_u32 s56, s55, 18560
s_mov_b32 m0, 123904
s_nop 0
buffer_load_dwordx4 v27, s[20:23], s56 offen lds
s_add_u32 s56, s55, 384
s_mov_b32 m0, 124928
s_nop 0
buffer_load_dwordx4 v27, s[20:23], s56 offen lds
s_add_u32 s56, s55, 18816
s_mov_b32 m0, 125952
s_nop 0
buffer_load_dwordx4 v27, s[20:23], s56 offen lds
s_waitcnt vmcnt(24)
ds_read_b64_tr_b16 v[44:45], v28 offset:0
ds_read_b64_tr_b16 v[46:47], v28 offset:256
ds_read_b64_tr_b16 v[48:49], v28 offset:2048
ds_read_b64_tr_b16 v[50:51], v28 offset:2304
ds_read_b64_tr_b16 v[52:53], v28 offset:32
ds_read_b64_tr_b16 v[54:55], v28 offset:288
ds_read_b64_tr_b16 v[56:57], v28 offset:2080
ds_read_b64_tr_b16 v[58:59], v28 offset:2336
s_waitcnt lgkmcnt(0)
ds_write_b128 v2, v[44:47] offset:0
ds_write_b128 v2, v[48:51] offset:1024
ds_write_b128 v2, v[52:55] offset:2048
ds_write_b128 v2, v[56:59] offset:3072
s_waitcnt lgkmcnt(0)
s_add_u32 s56, s55, 74624
s_mov_b32 m0, 126976
s_nop 0
buffer_load_dwordx4 v27, s[20:23], s56 offen lds
s_add_u32 s56, s55, 93056
s_mov_b32 m0, 128000
s_nop 0
buffer_load_dwordx4 v27, s[20:23], s56 offen lds
s_add_u32 s56, s55, 896
s_mov_b32 m0, 129024
s_nop 0
buffer_load_dwordx4 v27, s[20:23], s56 offen lds
s_add_u32 s56, s55, 19328
s_mov_b32 m0, 130048
s_nop 0
buffer_load_dwordx4 v27, s[20:23], s56 offen lds
s_waitcnt vmcnt(24)
ds_read_b64_tr_b16 v[44:45], v28 offset:4096
ds_read_b64_tr_b16 v[46:47], v28 offset:4352
ds_read_b64_tr_b16 v[48:49], v28 offset:6144
ds_read_b64_tr_b16 v[50:51], v28 offset:6400
ds_read_b64_tr_b16 v[52:53], v28 offset:4128
ds_read_b64_tr_b16 v[54:55], v28 offset:4384
ds_read_b64_tr_b16 v[56:57], v28 offset:6176
ds_read_b64_tr_b16 v[58:59], v28 offset:6432
s_waitcnt lgkmcnt(0)
ds_write_b128 v2, v[44:47] offset:4096
ds_write_b128 v2, v[48:51] offset:5120
ds_write_b128 v2, v[52:55] offset:6144
ds_write_b128 v2, v[56:59] offset:7168
s_waitcnt lgkmcnt(0)
s_waitcnt vmcnt(20)
ds_read_b64_tr_b16 v[44:45], v28 offset:8192
ds_read_b64_tr_b16 v[46:47], v28 offset:8448
ds_read_b64_tr_b16 v[48:49], v28 offset:10240
ds_read_b64_tr_b16 v[50:51], v28 offset:10496
ds_read_b64_tr_b16 v[52:53], v28 offset:8224
ds_read_b64_tr_b16 v[54:55], v28 offset:8480
ds_read_b64_tr_b16 v[56:57], v28 offset:10272
ds_read_b64_tr_b16 v[58:59], v28 offset:10528
s_waitcnt lgkmcnt(0)
ds_write_b128 v2, v[44:47] offset:8192
ds_write_b128 v2, v[48:51] offset:9216
ds_write_b128 v2, v[52:55] offset:10240
ds_write_b128 v2, v[56:59] offset:11264
s_waitcnt lgkmcnt(0)
s_waitcnt vmcnt(16)
ds_read_b64_tr_b16 v[44:45], v28 offset:12288
ds_read_b64_tr_b16 v[46:47], v28 offset:12544
ds_read_b64_tr_b16 v[48:49], v28 offset:14336
ds_read_b64_tr_b16 v[50:51], v28 offset:14592
ds_read_b64_tr_b16 v[52:53], v28 offset:12320
ds_read_b64_tr_b16 v[54:55], v28 offset:12576
ds_read_b64_tr_b16 v[56:57], v28 offset:14368
ds_read_b64_tr_b16 v[58:59], v28 offset:14624
s_waitcnt lgkmcnt(0)
ds_write_b128 v2, v[44:47] offset:12288
ds_write_b128 v2, v[48:51] offset:13312
ds_write_b128 v2, v[52:55] offset:14336
ds_write_b128 v2, v[56:59] offset:15360
s_waitcnt lgkmcnt(0)
s_waitcnt vmcnt(12)
ds_read_b64_tr_b16 v[44:45], v28 offset:16384
ds_read_b64_tr_b16 v[46:47], v28 offset:16640
ds_read_b64_tr_b16 v[48:49], v28 offset:18432
ds_read_b64_tr_b16 v[50:51], v28 offset:18688
ds_read_b64_tr_b16 v[52:53], v28 offset:16416
ds_read_b64_tr_b16 v[54:55], v28 offset:16672
ds_read_b64_tr_b16 v[56:57], v28 offset:18464
ds_read_b64_tr_b16 v[58:59], v28 offset:18720
s_waitcnt lgkmcnt(0)
ds_write_b128 v2, v[44:47] offset:16384
ds_write_b128 v2, v[48:51] offset:17408
ds_write_b128 v2, v[52:55] offset:18432
ds_write_b128 v2, v[56:59] offset:19456
s_waitcnt lgkmcnt(0)
s_waitcnt vmcnt(8)
ds_read_b64_tr_b16 v[44:45], v29 offset:20480
ds_read_b64_tr_b16 v[46:47], v29 offset:20608
ds_read_b64_tr_b16 v[48:49], v29 offset:20992
ds_read_b64_tr_b16 v[50:51], v29 offset:21120
ds_read_b64_tr_b16 v[52:53], v29 offset:22528
ds_read_b64_tr_b16 v[54:55], v29 offset:22656
ds_read_b64_tr_b16 v[56:57], v29 offset:23040
ds_read_b64_tr_b16 v[58:59], v29 offset:23168
s_waitcnt lgkmcnt(0)
ds_write_b128 v2, v[44:47] offset:20480
ds_write_b128 v2, v[48:51] offset:21504
ds_write_b128 v2, v[52:55] offset:22528
ds_write_b128 v2, v[56:59] offset:23552
s_waitcnt lgkmcnt(0)
s_waitcnt vmcnt(4)
ds_read_b64_tr_b16 v[44:45], v29 offset:24576
ds_read_b64_tr_b16 v[46:47], v29 offset:24704
ds_read_b64_tr_b16 v[48:49], v29 offset:25088
ds_read_b64_tr_b16 v[50:51], v29 offset:25216
ds_read_b64_tr_b16 v[52:53], v29 offset:26624
ds_read_b64_tr_b16 v[54:55], v29 offset:26752
ds_read_b64_tr_b16 v[56:57], v29 offset:27136
ds_read_b64_tr_b16 v[58:59], v29 offset:27264
s_waitcnt lgkmcnt(0)
ds_write_b128 v2, v[44:47] offset:24576
ds_write_b128 v2, v[48:51] offset:25600
ds_write_b128 v2, v[52:55] offset:26624
ds_write_b128 v2, v[56:59] offset:27648
s_waitcnt lgkmcnt(0)
s_waitcnt vmcnt(0)
ds_read_b64_tr_b16 v[44:45], v29 offset:28672
ds_read_b64_tr_b16 v[46:47], v29 offset:28800
ds_read_b64_tr_b16 v[48:49], v29 offset:29184
ds_read_b64_tr_b16 v[50:51], v29 offset:29312
ds_read_b64_tr_b16 v[52:53], v29 offset:30720
ds_read_b64_tr_b16 v[54:55], v29 offset:30848
ds_read_b64_tr_b16 v[56:57], v29 offset:31232
ds_read_b64_tr_b16 v[58:59], v29 offset:31360
s_waitcnt lgkmcnt(0)
ds_write_b128 v2, v[44:47] offset:28672
ds_write_b128 v2, v[48:51] offset:29696
ds_write_b128 v2, v[52:55] offset:30720
ds_write_b128 v2, v[56:59] offset:31744
s_waitcnt lgkmcnt(0)
v_mov_b32 v24, 0
L_rdv_w2r:
buffer_load_dword v23, v24, s[28:31], 0 offen sc0 sc1
s_sub_u32 s41, s41, 1
s_cbranch_scc1 L_exit
s_waitcnt vmcnt(0)
v_readfirstlane_b32 s56, v23
s_nop 0
s_and_b32 s57, s56, 0xff
s_cmp_lg_u32 s57, 32
s_cbranch_scc1 L_rdv_w2r
s_lshl_b32 s101, s32, 7
s_add_u32 s101, s101, 327680
s_barrier
s_mov_b32 m0, 0
s_lshl_b32 s57, s58, 5
s_mov_b32 s0, 0x3f003f00
s_mov_b32 s1, 0x3f003f00
s_mov_b32 s58, 304128
s_cmp_eq_u32 s56, s57
s_cbranch_scc0 L_slow_w2r
buffer_load_dwordx4 v[12:15], v9, s[4:7], s37 offen offset:0
buffer_load_dwordx4 v[16:19], v9, s[4:7], s37 offen offset:1024
buffer_load_dwordx4 v[52:55], v1, s[4:7], s37 offen offset:2048
buffer_load_dwordx4 v[56:59], v1, s[4:7], s37 offen offset:3072
v_mov_b64 v[20:21], 0
v_mov_b64 v[22:23], 0
v_mov_b64 v[24:25], 0
v_mov_b64 v[26:27], 0
v_mov_b64 v[28:29], 0
v_mov_b64 v[30:31], 0
v_mov_b64 v[32:33], 0
v_mov_b64 v[34:35], 0
v_mov_b64 v[36:37], 0
v_mov_b64 v[38:39], 0
v_mov_b64 v[40:41], 0
v_mov_b64 v[42:43], 0
ds_read_b128 v[44:47], v2 offset:0
ds_read_b128 v[48:51], v2 offset:1024
v_bfe_u32 v77, v1, 6, 1
v_lshl_add_u32 v77, v77, 3, v1
v_lshlrev_b32 v77, 1, v77
s_mov_b32 s38, 1
s_mov_b32 m0, 1024
s_nop 0
buffer_load_dwordx4 v1, s[4:7], s47 offen offset:0 sc1 lds
buffer_load_dwordx4 v1, s[4:7], s47 offen offset:1024 sc1 lds
buffer_load_dwordx4 v1, s[4:7], s47 offen offset:2048 sc1 lds
buffer_load_dwordx4 v1, s[4:7], s47 offen offset:3072 sc1 lds
s_mov_b32 m0, 5120
s_nop 0
buffer_load_dwordx4 v1, s[4:7], s48 offen offset:0 sc1 lds
buffer_load_dwordx4 v1, s[4:7], s48 offen offset:1024 sc1 lds
buffer_load_dwordx4 v1, s[4:7], s48 offen offset:2048 sc1 lds
buffer_load_dwordx4 v1, s[4:7], s48 offen offset:3072 sc1 lds
s_mov_b32 m0, 9216
s_nop 0
buffer_load_dwordx4 v1, s[4:7], s49 offen offset:0 sc1 lds
s_waitcnt vmcnt(0) lgkmcnt(0)
s_branch L_top_w2rf
.p2align 6
L_ex_w2rf:
v_and_b32 v6, 0x70, v1
ds_read_b128 v[76:79], v6 offset:256
s_add_u32 s34, s34, 1
s_add_u32 s37, s37, 524288
s_add_u32 s39, s39, 524288
s_mul_i32 s40, s34, 10240
s_add_u32 s40, s40, 8093696
s_not_b32 s35, s35
s_not_b32 s36, s36
ds_read_b128 v[44:47], v2 offset:0
ds_read_b128 v[48:51], v2 offset:1024
v_bfe_u32 v6, v1, 2, 7
v_mov_b32 v12, s36
v_mov_b32 v13, s35
s_mov_b32 m0, 1024
s_waitcnt vmcnt(2)
buffer_load_dwordx4 v[60:63], v9, s[4:7], s3 offen offset:0 sc1
buffer_load_dwordx4 v[64:67], v9, s[4:7], s3 offen offset:1024 sc1
buffer_load_dwordx4 v[68:71], v9, s[4:7], s3 offen offset:2048 sc1
buffer_load_dwordx4 v[72:75], v9, s[4:7], s3 offen offset:3072 sc1
s_barrier
s_waitcnt lgkmcnt(2)
s_waitcnt vmcnt(3)
L_r_w2rf:
v_mfma_f32_16x16x32_bf16 v[52:55], v[60:63], v[76:79], 0
s_waitcnt vmcnt(2)
v_mfma_f32_16x16x32_bf16 v[52:55], v[64:67], v[76:79], v[52:55]
v_bitop3_b32 v56, v60, v64, s36 bitop3:0x7e
s_waitcnt vmcnt(1)
v_mfma_f32_16x16x32_bf16 v[52:55], v[68:71], v[76:79], v[52:55]
s_waitcnt vmcnt(0)
v_mfma_f32_16x16x32_bf16 v[52:55], v[72:75], v[76:79], v[52:55]
v_bitop3_b32 v57, v68, v72, s36 bitop3:0x7e
v_bitop3_b32 v56, v56, v57, 1 bitop3:0xa8
v_cmp_ne_u32 vcc, 0, v56
s_cmp_eq_u32 s34, 63
s_nop 3
v_pk_add_f32 v[52:53], v[52:53], v[54:55]
v_cvt_pk_bf16_f32 v56, v52, v53
v_bfi_b32 v56, v11, s35, v56
s_cbranch_vccnz L_rr_w2rf
buffer_store_dword v56, v10, s[4:7], 0 offen
v_mov_b32 v79, v56
s_cbranch_scc1 L_done_w2rf
s_mov_b64 exec, 1
buffer_store_dword v13, v1, s[4:7], s33 offen
s_mov_b64 exec, -1
v_mov_b64 v[20:21], 0
v_mov_b64 v[22:23], 0
v_mov_b64 v[24:25], 0
v_mov_b64 v[26:27], 0
v_mov_b64 v[28:29], 0
v_mov_b64 v[30:31], 0
v_mov_b64 v[32:33], 0
v_mov_b64 v[34:35], 0
v_mov_b64 v[36:37], 0
v_mov_b64 v[38:39], 0
v_mov_b64 v[40:41], 0
v_mov_b64 v[42:43], 0
v_bfe_u32 v77, v1, 6, 1
v_lshl_add_u32 v77, v77, 3, v1
v_lshlrev_b32 v77, 1, v77
L_sp_w2rf:
buffer_load_dword v12, v6, s[4:7], s58 offen sc1
s_sub_u32 s41, s41, 1
s_cbranch_scc1 L_exit
buffer_load_dwordx4 v1, s[4:7], s47 offen offset:0 sc1 lds
buffer_load_dwordx4 v1, s[4:7], s47 offen offset:1024 sc1 lds
buffer_load_dwordx4 v1, s[4:7], s47 offen offset:2048 sc1 lds
buffer_load_dwordx4 v1, s[4:7], s47 offen offset:3072 sc1 lds
s_waitcnt vmcnt(9)
v_cmp_ne_u32 vcc, s35, v12
s_cbranch_vccnz L_sp_w2rf
L_top_w2rf:
s_waitcnt vmcnt(7)
s_barrier
ds_read_b128 v[60:63], v1 offset:1024
ds_read_b128 v[64:67], v1 offset:2048
s_mov_b32 m0, 5120
s_nop 0
buffer_load_dwordx4 v1, s[4:7], s48 offen offset:2048 sc1 lds
s_waitcnt vmcnt(6)
s_barrier
ds_read_b128 v[68:71], v1 offset:3072
ds_read_b128 v[72:75], v1 offset:4096
L_s0_w2rf:
s_waitcnt lgkmcnt(3)
v_smfmac_f32_16x16x64_bf16 v[28:31], v[60:63], v[176:183], v0
v_smfmac_f32_16x16x64_bf16 v[32:35], v[60:63], v[184:191], v0
v_smfmac_f32_16x16x64_bf16 v[36:39], v[60:63], a[48:55], v0
v_smfmac_f32_16x16x64_bf16 v[40:43], v[60:63], a[56:63], v0
s_waitcnt lgkmcnt(2)
v_smfmac_f32_16x16x64_bf16 v[20:23], v[64:67], v[80:87], v0
v_smfmac_f32_16x16x64_bf16 v[20:23], v[60:63], v[44:51], v0
ds_read_b128 v[44:47], v2 offset:2048
v_smfmac_f32_16x16x64_bf16 v[24:27], v[64:67], v[88:95], v0
ds_read_b128 v[48:51], v2 offset:3072
v_smfmac_f32_16x16x64_bf16 v[28:31], v[64:67], v[192:199], v0
s_waitcnt lgkmcnt(2)
v_bitop3_b32 v6, v60, v64, s35 bitop3:0x7e
v_smfmac_f32_16x16x64_bf16 v[32:35], v[64:67], v[200:207], v0
v_bitop3_b32 v76, v68, v72, s35 bitop3:0x7e
buffer_load_dwordx4 v[12:15], v9, s[4:7], s37 offen offset:0
buffer_load_dwordx4 v[16:19], v9, s[4:7], s37 offen offset:1024
buffer_load_dwordx4 v[52:55], v1, s[4:7], s37 offen offset:2048
buffer_load_dwordx4 v[56:59], v1, s[4:7], s37 offen offset:3072
v_smfmac_f32_16x16x64_bf16 v[36:39], v[64:67], a[64:71], v0
v_bitop3_b32 v6, v6, v76, 1 bitop3:0xa8
s_waitcnt lgkmcnt(0)
v_smfmac_f32_16x16x64_bf16 v[24:27], v[60:63], v[44:51], v0
ds_read_b128 v[44:47], v2 offset:4096
v_cmp_ne_u32 vcc, 0, v6
v_smfmac_f32_16x16x64_bf16 v[40:43], v[64:67], a[72:79], v0
ds_read_b128 v[48:51], v2 offset:5120
v_smfmac_f32_16x16x64_bf16 v[20:23], v[68:71], v[96:103], v0
s_cbranch_vccnz L_ra0_w2rf
v_smfmac_f32_16x16x64_bf16 v[24:27], v[68:71], v[104:111], v0
s_waitcnt vmcnt(4)
s_barrier
ds_read_b32 v6, v77 offset:8192
buffer_store_dword v79, v10, s[4:7], s40 offen sc0 sc1
v_smfmac_f32_16x16x64_bf16 v[28:31], v[68:71], v[208:215], v0
ds_read_b128 v[60:63], v1 offset:6144
s_waitcnt lgkmcnt(2)
v_smfmac_f32_16x16x64_bf16 v[20:23], v[72:75], v[44:51], v0
ds_read_b128 v[64:67], v1 offset:7168
v_smfmac_f32_16x16x64_bf16 v[32:35], v[68:71], v[216:223], v0
ds_read_b128 v[76:79], v1 offset:5120
v_smfmac_f32_16x16x64_bf16 v[36:39], v[68:71], a[80:87], v0
ds_read_b128 v[44:47], v2 offset:6144
v_smfmac_f32_16x16x64_bf16 v[40:43], v[68:71], a[88:95], v0
ds_read_b128 v[48:51], v2 offset:7168
s_waitcnt lgkmcnt(4)
v_bitop3_b32 v6, v6, v60, s35 bitop3:0x7e
v_smfmac_f32_16x16x64_bf16 v[28:31], v[72:75], v[224:231], v0
ds_read_b128 v[68:71], v1 offset:8192
s_waitcnt lgkmcnt(4)
v_bitop3_b32 v6, v6, v64, s35 bitop3:0xf6
v_smfmac_f32_16x16x64_bf16 v[32:35], v[72:75], v[232:239], v0
s_waitcnt lgkmcnt(3)
v_bitop3_b32 v6, v6, v76, s35 bitop3:0xf6
v_and_b32 v6, 1, v6
v_smfmac_f32_16x16x64_bf16 v[36:39], v[72:75], a[96:103], v0
v_cmp_ne_u32 vcc, 0, v6
s_waitcnt lgkmcnt(1)
v_smfmac_f32_16x16x64_bf16 v[24:27], v[72:75], v[44:51], v0
ds_read_b128 v[44:47], v2 offset:8192
v_lshlrev_b32 v6, 2, v1
v_smfmac_f32_16x16x64_bf16 v[40:43], v[72:75], a[104:111], v0
ds_read_b128 v[72:75], v1 offset:9216
s_cbranch_vccnz L_ra1_w2rf
L_a1_w2rf:
v_smfmac_f32_16x16x64_bf16 v[20:23], v[60:63], v[112:119], v0
ds_read_b128 v[48:51], v2 offset:9216
v_smfmac_f32_16x16x64_bf16 v[20:23], v[64:67], v[128:135], v0
s_waitcnt lgkmcnt(3)
v_smfmac_f32_16x16x64_bf16 v[20:23], v[68:71], v[144:151], v0
s_waitcnt lgkmcnt(1)
v_smfmac_f32_16x16x64_bf16 v[20:23], v[72:75], v[160:167], v0
s_waitcnt lgkmcnt(0)
v_smfmac_f32_16x16x64_bf16 v[20:23], v[76:79], v[44:51], v0
ds_read_b128 v[44:47], v2 offset:10240
v_smfmac_f32_16x16x64_bf16 v[24:27], v[60:63], v[120:127], v0
ds_read_b128 v[48:51], v2 offset:11264
v_smfmac_f32_16x16x64_bf16 v[24:27], v[64:67], v[136:143], v0
v_add_f32 v20, v20, v22
v_smfmac_f32_16x16x64_bf16 v[24:27], v[68:71], v[152:159], v0
v_add_f32 v21, v21, v23
v_smfmac_f32_16x16x64_bf16 v[24:27], v[72:75], v[168:175], v0
v_cvt_pk_bf16_f32 v22, v20, v21
s_waitcnt lgkmcnt(0)
v_smfmac_f32_16x16x64_bf16 v[24:27], v[76:79], v[44:51], v0
ds_read_b128 v[44:47], v2 offset:12288
v_smfmac_f32_16x16x64_bf16 v[28:31], v[76:79], v[240:247], v0
ds_read_b128 v[48:51], v2 offset:13312
v_smfmac_f32_16x16x64_bf16 v[28:31], v[64:67], a[0:7], v0
v_add_f32 v24, v24, v26
v_add_f32 v25, v25, v27
v_cvt_pk_bf16_f32 v23, v24, v25
v_smfmac_f32_16x16x64_bf16 v[28:31], v[68:71], a[16:23], v0
ds_write_b64 v3, v[22:23] offset:11264
v_smfmac_f32_16x16x64_bf16 v[28:31], v[72:75], a[32:39], v0
s_mov_b32 m0, 0
s_nop 0
buffer_load_dword v6, s[4:7], s39 offen lds
s_waitcnt lgkmcnt(1)
v_smfmac_f32_16x16x64_bf16 v[28:31], v[60:63], v[44:51], v0
ds_read_b128 v[44:47], v2 offset:14336
v_smfmac_f32_16x16x64_bf16 v[32:35], v[76:79], v[248:255], v0
ds_read_b128 v[48:51], v2 offset:15360
s_waitcnt lgkmcnt(2)
s_barrier
v_smfmac_f32_16x16x64_bf16 v[32:35], v[64:67], a[8:15], v0
ds_read_b64_tr_b16 v[20:21], v4 offset:10240
ds_read_b64_tr_b16 v[22:23], v4 offset:10752
v_add_f32 v28, v28, v30
v_smfmac_f32_16x16x64_bf16 v[32:35], v[68:71], a[24:31], v0
ds_read_b64_tr_b16 v[24:25], v4 offset:11264
v_add_f32 v29, v29, v31
v_smfmac_f32_16x16x64_bf16 v[32:35], v[72:75], a[40:47], v0
ds_read_b64_tr_b16 v[26:27], v4 offset:11776
v_cvt_pk_bf16_f32 v30, v28, v29
s_waitcnt lgkmcnt(4)
v_smfmac_f32_16x16x64_bf16 v[32:35], v[60:63], v[44:51], v0
ds_read_b128 v[44:47], v2 offset:18432
s_waitcnt vmcnt(4)
s_waitcnt lgkmcnt(3)
v_mfma_f32_16x16x32_bf16 v[12:15], v[12:15], v[20:23], 0
ds_read_b128 v[48:51], v2 offset:19456
s_waitcnt lgkmcnt(2)
v_mfma_f32_16x16x32_bf16 v[12:15], v[16:19], v[24:27], v[12:15]
v_add_f32 v32, v32, v34
v_add_f32 v33, v33, v35
v_cvt_pk_bf16_f32 v31, v32, v33
ds_write_b64 v3, v[30:31] offset:13312
v_smfmac_f32_16x16x64_bf16 v[36:39], v[76:79], a[112:119], v0
s_nop 2
v_add_f32_dpp v12, v14, v12 quad_perm:[2,3,0,1] row_mask:0xf bank_mask:0xf
v_add_f32_dpp v13, v15, v13 quad_perm:[2,3,0,1] row_mask:0xf bank_mask:0xf
ds_write_b64 v5, v[12:13] offset:14848
v_smfmac_f32_16x16x64_bf16 v[40:43], v[76:79], a[120:127], v0
s_waitcnt lgkmcnt(1)
s_barrier
ds_read_b64_tr_b16 v[28:29], v4 offset:12288
v_smfmac_f32_16x16x64_bf16 v[36:39], v[60:63], a[128:135], v0
ds_read_b64_tr_b16 v[30:31], v4 offset:12800
ds_read_b64_tr_b16 v[32:33], v4 offset:13312
v_smfmac_f32_16x16x64_bf16 v[40:43], v[60:63], a[136:143], v0
ds_read_b64_tr_b16 v[34:35], v4 offset:13824
v_mov_b64 v[76:77], s[52:53]
s_waitcnt lgkmcnt(4)
s_barrier
ds_read_b128 v[12:15], v1 offset:14336
v_smfmac_f32_16x16x64_bf16 v[40:43], v[72:75], v[44:51], v0
ds_read_b128 v[44:47], v2 offset:16384
v_mov_b64 v[78:79], s[52:53]
s_waitcnt lgkmcnt(4)
v_mfma_f32_16x16x32_bf16 v[28:31], v[28:31], v[20:23], 0
ds_read_b128 v[48:51], v2 offset:17408
s_waitcnt lgkmcnt(3)
v_mfma_f32_16x16x32_bf16 v[28:31], v[32:35], v[24:27], v[28:31]
v_smfmac_f32_16x16x64_bf16 v[40:43], v[64:67], a[152:159], v0
s_waitcnt lgkmcnt(2)
v_max3_f32 v17, v12, v13, v14
v_smfmac_f32_16x16x64_bf16 v[36:39], v[64:67], a[144:151], v0
ds_read_b128 v[60:63], v2 offset:22528
v_add_f32_dpp v28, v30, v28 quad_perm:[2,3,0,1] row_mask:0xf bank_mask:0xf
v_add_f32_dpp v29, v31, v29 quad_perm:[2,3,0,1] row_mask:0xf bank_mask:0xf
v_max_f32 v17, v17, v15
v_max_f32 v16, v28, v29
v_mul_f32 v16, s50, v16
v_max_f32_dpp v17, v17, v17 quad_perm:[2,3,0,1] row_mask:0xf bank_mask:0xf
v_smfmac_f32_16x16x64_bf16 v[40:43], v[68:71], a[168:175], v0
ds_read_b128 v[64:67], v2 offset:23552
v_max_f32_dpp v18, v16, v17 quad_perm:[0,1,0,1] row_mask:0xf bank_mask:0xf
v_max_f32_dpp v19, v16, v17 quad_perm:[0,1,0,1] row_mask:0xf bank_mask:0xf
v_smfmac_f32_16x16x64_bf16 v[36:39], v[68:71], a[160:167], v0
ds_read_b128 v[68:71], v2 offset:24576
v_permlane16_swap_b32 v18, v19
v_max_f32 v20, v18, v19
v_max_f32 v21, v18, v19
s_waitcnt lgkmcnt(3)
v_smfmac_f32_16x16x64_bf16 v[36:39], v[72:75], v[44:51], v0
ds_read_b128 v[72:75], v2 offset:25600
v_permlane32_swap_b32 v20, v21
v_max_f32 v20, v20, v21
v_sub_f32 v12, v12, v20
v_sub_f32 v13, v13, v20
v_pk_add_f32 v[14:15], v[14:15], v[20:21] op_sel_hi:[1,0] neg_lo:[0,1] neg_hi:[0,1]
v_exp_f32 v12, v12
v_exp_f32 v13, v13
v_exp_f32 v14, v14
v_exp_f32 v15, v15
v_cvt_pk_bf16_f32 v16, v12, v13
v_cvt_pk_bf16_f32 v17, v14, v15
v_pk_fma_f32 v[28:29], v[28:29], s[50:51], v[20:21] op_sel_hi:[1,1,0] neg_lo:[0,0,1] neg_hi:[0,0,1]
v_mov_b32_dpp v18, v16 quad_perm:[2,3,0,1] row_mask:0xf bank_mask:0xf
v_mov_b32_dpp v19, v17 quad_perm:[2,3,0,1] row_mask:0xf bank_mask:0xf
v_exp_f32 v28, v28
s_waitcnt vmcnt(2)
v_mfma_f32_16x16x32_bf16 v[32:35], v[76:79], v[16:19], 0
v_exp_f32 v29, v29
v_mfma_f32_16x16x32_bf16 v[20:23], v[52:55], v[16:19], 0
v_cvt_pk_bf16_f32 v12, v28, v29
v_cvt_pk_bf16_f32 v13, v28, v29
v_mov_b64 v[14:15], s[0:1]
v_mfma_f32_16x16x32_bf16 v[24:27], v[56:59], v[16:19], 0
v_cvt_pk_bf16_f32 v36, v36, v37
v_cvt_pk_bf16_f32 v37, v38, v39
v_mfma_f32_16x16x16_bf16 v[32:35], v[14:15], v[12:13], v[32:35]
v_cvt_pk_bf16_f32 v38, v40, v41
v_cvt_pk_bf16_f32 v39, v42, v43
v_mfma_f32_16x16x16_bf16 v[20:23], v[36:37], v[12:13], v[20:23]
ds_read_b128 v[44:47], v2 offset:20480
v_mfma_f32_16x16x16_bf16 v[24:27], v[38:39], v[12:13], v[24:27]
ds_read_b128 v[48:51], v2 offset:21504
v_rcp_f32 v32, v32
v_mov_b64 v[28:29], 0
v_mov_b64 v[30:31], 0
v_pk_mul_f32 v[20:21], v[20:21], v[32:33] op_sel_hi:[1,0]
v_pk_mul_f32 v[22:23], v[22:23], v[32:33] op_sel_hi:[1,0]
v_cvt_pk_bf16_f32 v20, v20, v21
v_cvt_pk_bf16_f32 v21, v22, v23
ds_write_b64 v1, v[20:21] offset:7168
v_pk_mul_f32 v[24:25], v[24:25], v[32:33] op_sel_hi:[1,0]
v_pk_mul_f32 v[26:27], v[26:27], v[32:33] op_sel_hi:[1,0]
v_cvt_pk_bf16_f32 v24, v24, v25
v_cvt_pk_bf16_f32 v25, v26, v27
ds_write_b64 v1, v[24:25] offset:7176
v_mov_b64 v[76:77], 0
ds_read_b128 v[12:15], v7 offset:7168
v_mov_b64 v[78:79], 0
v_mov_b64 v[40:41], 0
v_mov_b64 v[42:43], 0
v_mov_b64 v[36:37], 0
v_mov_b64 v[38:39], 0
v_mov_b64 v[32:33], 0
v_mov_b64 v[34:35], 0
s_waitcnt lgkmcnt(1)
s_barrier
ds_read_b128 v[16:19], v7 offset:8192
ds_read_b128 v[52:55], v7 offset:5120
ds_read_b128 v[56:59], v7 offset:6144
s_waitcnt lgkmcnt(3)
v_smfmac_f32_16x16x64_bf16 v[28:31], v[12:15], v[44:51], v0 abid:1
v_smfmac_f32_16x16x64_bf16 v[76:79], v[12:15], v[60:67], v0 abid:1
ds_read_b128 v[44:47], v2 offset:26624
s_waitcnt lgkmcnt(3)
v_smfmac_f32_16x16x64_bf16 v[28:31], v[16:19], a[176:183], v0 abid:1
ds_read_b128 v[48:51], v2 offset:27648
s_waitcnt lgkmcnt(3)
v_smfmac_f32_16x16x64_bf16 v[28:31], v[52:55], v[68:75], v0 abid:1
ds_read_b128 v[60:63], v2 offset:28672
s_waitcnt lgkmcnt(3)
v_smfmac_f32_16x16x64_bf16 v[28:31], v[56:59], a[184:191], v0 abid:1
ds_read_b128 v[64:67], v2 offset:29696
v_smfmac_f32_16x16x64_bf16 v[76:79], v[16:19], a[192:199], v0 abid:1
ds_read_b128 v[68:71], v2 offset:30720
s_waitcnt lgkmcnt(3)
v_smfmac_f32_16x16x64_bf16 v[76:79], v[52:55], v[44:51], v0 abid:1
ds_read_b128 v[72:75], v2 offset:31744
v_cvt_pk_bf16_f32 v28, v28, v29
v_cvt_pk_bf16_f32 v29, v30, v31
v_bfi_b32 v28, 1, s35, v28
buffer_store_dwordx2 v[28:29], v8, s[4:7], s42 offen
v_smfmac_f32_16x16x64_bf16 v[76:79], v[56:59], a[200:207], v0 abid:1
v_smfmac_f32_16x16x64_bf16 v[40:43], v[12:15], a[208:215], v0 abid:1
v_smfmac_f32_16x16x64_bf16 v[40:43], v[16:19], a[216:223], v0 abid:1
v_cvt_pk_bf16_f32 v76, v76, v77
v_cvt_pk_bf16_f32 v77, v78, v79
v_bfi_b32 v76, 1, s35, v76
buffer_store_dwordx2 v[76:77], v8, s[4:7], s43 offen
v_smfmac_f32_16x16x64_bf16 v[40:43], v[52:55], a[224:231], v0 abid:1
v_smfmac_f32_16x16x64_bf16 v[40:43], v[56:59], a[232:239], v0 abid:1
s_waitcnt lgkmcnt(2)
v_smfmac_f32_16x16x64_bf16 v[36:39], v[12:15], v[60:67], v0 abid:1
v_smfmac_f32_16x16x64_bf16 v[36:39], v[16:19], a[240:247], v0 abid:1
v_cvt_pk_bf16_f32 v40, v40, v41
s_waitcnt lgkmcnt(0)
v_smfmac_f32_16x16x64_bf16 v[36:39], v[52:55], v[68:75], v0 abid:1
v_cvt_pk_bf16_f32 v41, v42, v43
v_smfmac_f32_16x16x64_bf16 v[36:39], v[56:59], a[248:255], v0 abid:1
v_bfi_b32 v40, 1, s35, v40
buffer_store_dwordx2 v[40:41], v8, s[4:7], s44 offen
s_nop 5
v_cvt_pk_bf16_f32 v36, v36, v37
v_cvt_pk_bf16_f32 v37, v38, v39
v_bfi_b32 v36, 1, s35, v36
buffer_store_dwordx2 v[36:37], v8, s[4:7], s45 offen
s_branch L_ex_w2rf
L_done_w2rf:
buffer_store_dword v79, v10, s[4:7], s40 offen sc0 sc1
s_waitcnt vmcnt(0) lgkmcnt(0)
s_endpgm
L_ra0_w2rf:
s_mov_b32 s38, 1
s_mov_b32 m0, 1024
s_nop 0
buffer_load_dwordx4 v1, s[4:7], s47 offen offset:0 sc1 lds
buffer_load_dwordx4 v1, s[4:7], s47 offen offset:1024 sc1 lds
buffer_load_dwordx4 v1, s[4:7], s47 offen offset:2048 sc1 lds
buffer_load_dwordx4 v1, s[4:7], s47 offen offset:3072 sc1 lds
s_sub_u32 s41, s41, 1
s_cbranch_scc1 L_exit
ds_read_b128 v[44:47], v2 offset:0
ds_read_b128 v[48:51], v2 offset:1024
v_mov_b64 v[20:21], 0
v_mov_b64 v[22:23], 0
v_mov_b64 v[24:25], 0
v_mov_b64 v[26:27], 0
v_mov_b64 v[28:29], 0
v_mov_b64 v[30:31], 0
v_mov_b64 v[32:33], 0
v_mov_b64 v[34:35], 0
v_mov_b64 v[36:37], 0
v_mov_b64 v[38:39], 0
v_mov_b64 v[40:41], 0
v_mov_b64 v[42:43], 0
s_waitcnt vmcnt(0)
ds_read_b128 v[60:63], v1 offset:1024
ds_read_b128 v[64:67], v1 offset:2048
ds_read_b128 v[68:71], v1 offset:3072
ds_read_b128 v[72:75], v1 offset:4096
s_branch L_s0_w2rf
L_ra1_w2rf:
s_mov_b32 s38, 1
s_waitcnt lgkmcnt(0)
s_barrier
s_mov_b32 m0, 5120
s_nop 0
buffer_load_dwordx4 v1, s[4:7], s48 offen offset:2048 sc1 lds
s_sub_u32 s41, s41, 1
s_cbranch_scc1 L_exit
s_waitcnt vmcnt(0)
s_barrier
ds_read_b128 v[76:79], v1 offset:5120
ds_read_b128 v[60:63], v1 offset:6144
ds_read_b128 v[64:67], v1 offset:7168
ds_read_b128 v[68:71], v1 offset:8192
ds_read_b128 v[72:75], v1 offset:9216
s_waitcnt lgkmcnt(0)
v_bitop3_b32 v6, v76, v60, s35 bitop3:0x7e
v_bitop3_b32 v6, v6, v64, s35 bitop3:0xf6
v_bitop3_b32 v6, v6, v68, s35 bitop3:0xf6
v_bitop3_b32 v6, v6, v72, s35 bitop3:0xf6
v_and_b32 v6, 1, v6
v_cmp_ne_u32 vcc, 0, v6
v_lshlrev_b32 v6, 2, v1
s_cbranch_vccnz L_ra1_w2rf
s_branch L_a1_w2rf
L_rr_w2rf:
buffer_load_dwordx4 v[60:63], v9, s[4:7], s3 offen offset:0 sc1
buffer_load_dwordx4 v[64:67], v9, s[4:7], s3 offen offset:1024 sc1
buffer_load_dwordx4 v[68:71], v9, s[4:7], s3 offen offset:2048 sc1
buffer_load_dwordx4 v[72:75], v9, s[4:7], s3 offen offset:3072 sc1
s_sub_u32 s41, s41, 1
s_cbranch_scc1 L_exit
s_waitcnt vmcnt(0)
s_branch L_r_w2rf
L_slow_w2r:
buffer_load_dwordx4 v[12:15], v9, s[4:7], s37 offen offset:0
buffer_load_dwordx4 v[16:19], v9, s[4:7], s37 offen offset:1024
buffer_load_dwordx4 v[52:55], v1, s[4:7], s37 offen offset:2048
buffer_load_dwordx4 v[56:59], v1, s[4:7], s37 offen offset:3072
v_mov_b64 v[20:21], 0
v_mov_b64 v[22:23], 0
v_mov_b64 v[24:25], 0
v_mov_b64 v[26:27], 0
v_mov_b64 v[28:29], 0
v_mov_b64 v[30:31], 0
v_mov_b64 v[32:33], 0
v_mov_b64 v[34:35], 0
v_mov_b64 v[36:37], 0
v_mov_b64 v[38:39], 0
v_mov_b64 v[40:41], 0
v_mov_b64 v[42:43], 0
ds_read_b128 v[44:47], v2 offset:0
ds_read_b128 v[48:51], v2 offset:1024
v_bfe_u32 v77, v1, 6, 1
v_lshl_add_u32 v77, v77, 3, v1
v_lshlrev_b32 v77, 1, v77
s_mov_b32 s38, 1
s_mov_b32 m0, 1024
s_nop 0
buffer_load_dwordx4 v1, s[4:7], s47 offen offset:0 sc0 sc1 lds
buffer_load_dwordx4 v1, s[4:7], s47 offen offset:1024 sc0 sc1 lds
buffer_load_dwordx4 v1, s[4:7], s47 offen offset:2048 sc0 sc1 lds
buffer_load_dwordx4 v1, s[4:7], s47 offen offset:3072 sc0 sc1 lds
s_mov_b32 m0, 5120
s_nop 0
buffer_load_dwordx4 v1, s[4:7], s48 offen offset:0 sc0 sc1 lds
buffer_load_dwordx4 v1, s[4:7], s48 offen offset:1024 sc0 sc1 lds
buffer_load_dwordx4 v1, s[4:7], s48 offen offset:2048 sc0 sc1 lds
buffer_load_dwordx4 v1, s[4:7], s48 offen offset:3072 sc0 sc1 lds
s_mov_b32 m0, 9216
s_nop 0
buffer_load_dwordx4 v1, s[4:7], s49 offen offset:0 sc0 sc1 lds
s_waitcnt vmcnt(0) lgkmcnt(0)
s_branch L_top_w2rs
.p2align 6
L_ex_w2rs:
v_and_b32 v6, 0x70, v1
ds_read_b128 v[76:79], v6 offset:256
s_add_u32 s34, s34, 1
s_add_u32 s37, s37, 524288
s_add_u32 s39, s39, 524288
s_mul_i32 s40, s34, 10240
s_add_u32 s40, s40, 8093696
s_not_b32 s35, s35
s_not_b32 s36, s36
ds_read_b128 v[44:47], v2 offset:0
ds_read_b128 v[48:51], v2 offset:1024
v_bfe_u32 v6, v1, 2, 7
v_mov_b32 v12, s36
v_mov_b32 v13, s35
s_mov_b32 m0, 1024
s_waitcnt vmcnt(2)
buffer_load_dwordx4 v[60:63], v9, s[4:7], s3 offen offset:0 sc0 sc1
buffer_load_dwordx4 v[64:67], v9, s[4:7], s3 offen offset:1024 sc0 sc1
buffer_load_dwordx4 v[68:71], v9, s[4:7], s3 offen offset:2048 sc0 sc1
buffer_load_dwordx4 v[72:75], v9, s[4:7], s3 offen offset:3072 sc0 sc1
s_barrier
s_waitcnt lgkmcnt(2)
s_waitcnt vmcnt(3)
L_r_w2rs:
v_mfma_f32_16x16x32_bf16 v[52:55], v[60:63], v[76:79], 0
s_waitcnt vmcnt(2)
v_mfma_f32_16x16x32_bf16 v[52:55], v[64:67], v[76:79], v[52:55]
v_bitop3_b32 v56, v60, v64, s36 bitop3:0x7e
s_waitcnt vmcnt(1)
v_mfma_f32_16x16x32_bf16 v[52:55], v[68:71], v[76:79], v[52:55]
s_waitcnt vmcnt(0)
v_mfma_f32_16x16x32_bf16 v[52:55], v[72:75], v[76:79], v[52:55]
v_bitop3_b32 v57, v68, v72, s36 bitop3:0x7e
v_bitop3_b32 v56, v56, v57, 1 bitop3:0xa8
v_cmp_ne_u32 vcc, 0, v56
s_cmp_eq_u32 s34, 63
s_nop 3
v_pk_add_f32 v[52:53], v[52:53], v[54:55]
v_cvt_pk_bf16_f32 v56, v52, v53
v_bfi_b32 v56, v11, s35, v56
s_cbranch_vccnz L_rr_w2rs
buffer_store_dword v56, v10, s[4:7], 0 offen sc0 sc1
v_mov_b32 v79, v56
s_cbranch_scc1 L_done_w2rs
s_mov_b64 exec, 1
buffer_store_dword v13, v1, s[4:7], s33 offen sc0 sc1
s_mov_b64 exec, -1
v_mov_b64 v[20:21], 0
v_mov_b64 v[22:23], 0
v_mov_b64 v[24:25], 0
v_mov_b64 v[26:27], 0
v_mov_b64 v[28:29], 0
v_mov_b64 v[30:31], 0
v_mov_b64 v[32:33], 0
v_mov_b64 v[34:35], 0
v_mov_b64 v[36:37], 0
v_mov_b64 v[38:39], 0
v_mov_b64 v[40:41], 0
v_mov_b64 v[42:43], 0
v_bfe_u32 v77, v1, 6, 1
v_lshl_add_u32 v77, v77, 3, v1
v_lshlrev_b32 v77, 1, v77
L_sp_w2rs:
buffer_load_dword v12, v6, s[4:7], s58 offen sc0 sc1
s_sub_u32 s41, s41, 1
s_cbranch_scc1 L_exit
buffer_load_dwordx4 v1, s[4:7], s47 offen offset:0 sc0 sc1 lds
buffer_load_dwordx4 v1, s[4:7], s47 offen offset:1024 sc0 sc1 lds
buffer_load_dwordx4 v1, s[4:7], s47 offen offset:2048 sc0 sc1 lds
buffer_load_dwordx4 v1, s[4:7], s47 offen offset:3072 sc0 sc1 lds
s_waitcnt vmcnt(4)
v_cmp_ne_u32 vcc, s35, v12
s_cbranch_vccnz L_sp_w2rs
L_top_w2rs:
s_waitcnt vmcnt(2)
s_barrier
ds_read_b128 v[60:63], v1 offset:1024
ds_read_b128 v[64:67], v1 offset:2048
s_mov_b32 m0, 5120
s_nop 0
buffer_load_dwordx4 v1, s[4:7], s48 offen offset:2048 sc0 sc1 lds
s_waitcnt vmcnt(1)
s_barrier
ds_read_b128 v[68:71], v1 offset:3072
ds_read_b128 v[72:75], v1 offset:4096
L_s0_w2rs:
s_waitcnt lgkmcnt(3)
v_smfmac_f32_16x16x64_bf16 v[28:31], v[60:63], v[176:183], v0
v_smfmac_f32_16x16x64_bf16 v[32:35], v[60:63], v[184:191], v0
v_smfmac_f32_16x16x64_bf16 v[36:39], v[60:63], a[48:55], v0
v_smfmac_f32_16x16x64_bf16 v[40:43], v[60:63], a[56:63], v0
s_waitcnt lgkmcnt(2)
v_smfmac_f32_16x16x64_bf16 v[20:23], v[64:67], v[80:87], v0
v_smfmac_f32_16x16x64_bf16 v[20:23], v[60:63], v[44:51], v0
ds_read_b128 v[44:47], v2 offset:2048
v_smfmac_f32_16x16x64_bf16 v[24:27], v[64:67], v[88:95], v0
ds_read_b128 v[48:51], v2 offset:3072
v_smfmac_f32_16x16x64_bf16 v[28:31], v[64:67], v[192:199], v0
s_waitcnt lgkmcnt(2)
v_bitop3_b32 v6, v60, v64, s35 bitop3:0x7e
v_smfmac_f32_16x16x64_bf16 v[32:35], v[64:67], v[200:207], v0
v_bitop3_b32 v76, v68, v72, s35 bitop3:0x7e
buffer_load_dwordx4 v[12:15], v9, s[4:7], s37 offen offset:0
buffer_load_dwordx4 v[16:19], v9, s[4:7], s37 offen offset:1024
buffer_load_dwordx4 v[52:55], v1, s[4:7], s37 offen offset:2048
buffer_load_dwordx4 v[56:59], v1, s[4:7], s37 offen offset:3072
v_smfmac_f32_16x16x64_bf16 v[36:39], v[64:67], a[64:71], v0
v_bitop3_b32 v6, v6, v76, 1 bitop3:0xa8
s_waitcnt lgkmcnt(0)
v_smfmac_f32_16x16x64_bf16 v[24:27], v[60:63], v[44:51], v0
ds_read_b128 v[44:47], v2 offset:4096
v_cmp_ne_u32 vcc, 0, v6
v_smfmac_f32_16x16x64_bf16 v[40:43], v[64:67], a[72:79], v0
ds_read_b128 v[48:51], v2 offset:5120
v_smfmac_f32_16x16x64_bf16 v[20:23], v[68:71], v[96:103], v0
s_cbranch_vccnz L_ra0_w2rs
v_smfmac_f32_16x16x64_bf16 v[24:27], v[68:71], v[104:111], v0
s_waitcnt vmcnt(4)
s_barrier
ds_read_b32 v6, v77 offset:8192
buffer_store_dword v79, v10, s[4:7], s40 offen sc0 sc1
v_smfmac_f32_16x16x64_bf16 v[28:31], v[68:71], v[208:215], v0
ds_read_b128 v[60:63], v1 offset:6144
s_waitcnt lgkmcnt(2)
v_smfmac_f32_16x16x64_bf16 v[20:23], v[72:75], v[44:51], v0
ds_read_b128 v[64:67], v1 offset:7168
v_smfmac_f32_16x16x64_bf16 v[32:35], v[68:71], v[216:223], v0
ds_read_b128 v[76:79], v1 offset:5120
v_smfmac_f32_16x16x64_bf16 v[36:39], v[68:71], a[80:87], v0
ds_read_b128 v[44:47], v2 offset:6144
v_smfmac_f32_16x16x64_bf16 v[40:43], v[68:71], a[88:95], v0
ds_read_b128 v[48:51], v2 offset:7168
s_waitcnt lgkmcnt(4)
v_bitop3_b32 v6, v6, v60, s35 bitop3:0x7e
v_smfmac_f32_16x16x64_bf16 v[28:31], v[72:75], v[224:231], v0
ds_read_b128 v[68:71], v1 offset:8192
s_waitcnt lgkmcnt(4)
v_bitop3_b32 v6, v6, v64, s35 bitop3:0xf6
v_smfmac_f32_16x16x64_bf16 v[32:35], v[72:75], v[232:239], v0
s_waitcnt lgkmcnt(3)
v_bitop3_b32 v6, v6, v76, s35 bitop3:0xf6
v_and_b32 v6, 1, v6
v_smfmac_f32_16x16x64_bf16 v[36:39], v[72:75], a[96:103], v0
v_cmp_ne_u32 vcc, 0, v6
s_waitcnt lgkmcnt(1)
v_smfmac_f32_16x16x64_bf16 v[24:27], v[72:75], v[44:51], v0
ds_read_b128 v[44:47], v2 offset:8192
v_lshlrev_b32 v6, 2, v1
v_smfmac_f32_16x16x64_bf16 v[40:43], v[72:75], a[104:111], v0
ds_read_b128 v[72:75], v1 offset:9216
s_cbranch_vccnz L_ra1_w2rs
L_a1_w2rs:
v_smfmac_f32_16x16x64_bf16 v[20:23], v[60:63], v[112:119], v0
ds_read_b128 v[48:51], v2 offset:9216
v_smfmac_f32_16x16x64_bf16 v[20:23], v[64:67], v[128:135], v0
s_waitcnt lgkmcnt(3)
v_smfmac_f32_16x16x64_bf16 v[20:23], v[68:71], v[144:151], v0
s_waitcnt lgkmcnt(1)
v_smfmac_f32_16x16x64_bf16 v[20:23], v[72:75], v[160:167], v0
s_waitcnt lgkmcnt(0)
v_smfmac_f32_16x16x64_bf16 v[20:23], v[76:79], v[44:51], v0
ds_read_b128 v[44:47], v2 offset:10240
v_smfmac_f32_16x16x64_bf16 v[24:27], v[60:63], v[120:127], v0
ds_read_b128 v[48:51], v2 offset:11264
v_smfmac_f32_16x16x64_bf16 v[24:27], v[64:67], v[136:143], v0
v_add_f32 v20, v20, v22
v_smfmac_f32_16x16x64_bf16 v[24:27], v[68:71], v[152:159], v0
v_add_f32 v21, v21, v23
v_smfmac_f32_16x16x64_bf16 v[24:27], v[72:75], v[168:175], v0
v_cvt_pk_bf16_f32 v22, v20, v21
s_waitcnt lgkmcnt(0)
v_smfmac_f32_16x16x64_bf16 v[24:27], v[76:79], v[44:51], v0
ds_read_b128 v[44:47], v2 offset:12288
v_smfmac_f32_16x16x64_bf16 v[28:31], v[76:79], v[240:247], v0
ds_read_b128 v[48:51], v2 offset:13312
v_smfmac_f32_16x16x64_bf16 v[28:31], v[64:67], a[0:7], v0
v_add_f32 v24, v24, v26
v_add_f32 v25, v25, v27
v_cvt_pk_bf16_f32 v23, v24, v25
v_smfmac_f32_16x16x64_bf16 v[28:31], v[68:71], a[16:23], v0
ds_write_b64 v3, v[22:23] offset:11264
v_smfmac_f32_16x16x64_bf16 v[28:31], v[72:75], a[32:39], v0
s_mov_b32 m0, 0
s_nop 0
buffer_load_dword v6, s[4:7], s39 offen lds
s_waitcnt lgkmcnt(1)
v_smfmac_f32_16x16x64_bf16 v[28:31], v[60:63], v[44:51], v0
ds_read_b128 v[44:47], v2 offset:14336
v_smfmac_f32_16x16x64_bf16 v[32:35], v[76:79], v[248:255], v0
ds_read_b128 v[48:51], v2 offset:15360
s_waitcnt lgkmcnt(2)
s_barrier
v_smfmac_f32_16x16x64_bf16 v[32:35], v[64:67], a[8:15], v0
ds_read_b64_tr_b16 v[20:21], v4 offset:10240
ds_read_b64_tr_b16 v[22:23], v4 offset:10752
v_add_f32 v28, v28, v30
v_smfmac_f32_16x16x64_bf16 v[32:35], v[68:71], a[24:31], v0
ds_read_b64_tr_b16 v[24:25], v4 offset:11264
v_add_f32 v29, v29, v31
v_smfmac_f32_16x16x64_bf16 v[32:35], v[72:75], a[40:47], v0
ds_read_b64_tr_b16 v[26:27], v4 offset:11776
v_cvt_pk_bf16_f32 v30, v28, v29
s_waitcnt lgkmcnt(4)
v_smfmac_f32_16x16x64_bf16 v[32:35], v[60:63], v[44:51], v0
ds_read_b128 v[44:47], v2 offset:18432
s_waitcnt vmcnt(4)
s_waitcnt lgkmcnt(3)
v_mfma_f32_16x16x32_bf16 v[12:15], v[12:15], v[20:23], 0
ds_read_b128 v[48:51], v2 offset:19456
s_waitcnt lgkmcnt(2)
v_mfma_f32_16x16x32_bf16 v[12:15], v[16:19], v[24:27], v[12:15]
v_add_f32 v32, v32, v34
v_add_f32 v33, v33, v35
v_cvt_pk_bf16_f32 v31, v32, v33
ds_write_b64 v3, v[30:31] offset:13312
v_smfmac_f32_16x16x64_bf16 v[36:39], v[76:79], a[112:119], v0
s_nop 2
v_add_f32_dpp v12, v14, v12 quad_perm:[2,3,0,1] row_mask:0xf bank_mask:0xf
v_add_f32_dpp v13, v15, v13 quad_perm:[2,3,0,1] row_mask:0xf bank_mask:0xf
ds_write_b64 v5, v[12:13] offset:14848
v_smfmac_f32_16x16x64_bf16 v[40:43], v[76:79], a[120:127], v0
s_waitcnt lgkmcnt(1)
s_barrier
ds_read_b64_tr_b16 v[28:29], v4 offset:12288
v_smfmac_f32_16x16x64_bf16 v[36:39], v[60:63], a[128:135], v0
ds_read_b64_tr_b16 v[30:31], v4 offset:12800
ds_read_b64_tr_b16 v[32:33], v4 offset:13312
v_smfmac_f32_16x16x64_bf16 v[40:43], v[60:63], a[136:143], v0
ds_read_b64_tr_b16 v[34:35], v4 offset:13824
v_mov_b64 v[76:77], s[52:53]
s_waitcnt lgkmcnt(4)
s_barrier
ds_read_b128 v[12:15], v1 offset:14336
v_smfmac_f32_16x16x64_bf16 v[40:43], v[72:75], v[44:51], v0
ds_read_b128 v[44:47], v2 offset:16384
v_mov_b64 v[78:79], s[52:53]
s_waitcnt lgkmcnt(4)
v_mfma_f32_16x16x32_bf16 v[28:31], v[28:31], v[20:23], 0
ds_read_b128 v[48:51], v2 offset:17408
s_waitcnt lgkmcnt(3)
v_mfma_f32_16x16x32_bf16 v[28:31], v[32:35], v[24:27], v[28:31]
v_smfmac_f32_16x16x64_bf16 v[40:43], v[64:67], a[152:159], v0
s_waitcnt lgkmcnt(2)
v_max3_f32 v17, v12, v13, v14
v_smfmac_f32_16x16x64_bf16 v[36:39], v[64:67], a[144:151], v0
ds_read_b128 v[60:63], v2 offset:22528
v_add_f32_dpp v28, v30, v28 quad_perm:[2,3,0,1] row_mask:0xf bank_mask:0xf
v_add_f32_dpp v29, v31, v29 quad_perm:[2,3,0,1] row_mask:0xf bank_mask:0xf
v_max_f32 v17, v17, v15
v_max_f32 v16, v28, v29
v_mul_f32 v16, s50, v16
v_max_f32_dpp v17, v17, v17 quad_perm:[2,3,0,1] row_mask:0xf bank_mask:0xf
v_smfmac_f32_16x16x64_bf16 v[40:43], v[68:71], a[168:175], v0
ds_read_b128 v[64:67], v2 offset:23552
v_max_f32_dpp v18, v16, v17 quad_perm:[0,1,0,1] row_mask:0xf bank_mask:0xf
v_max_f32_dpp v19, v16, v17 quad_perm:[0,1,0,1] row_mask:0xf bank_mask:0xf
v_smfmac_f32_16x16x64_bf16 v[36:39], v[68:71], a[160:167], v0
ds_read_b128 v[68:71], v2 offset:24576
v_permlane16_swap_b32 v18, v19
v_max_f32 v20, v18, v19
v_max_f32 v21, v18, v19
s_waitcnt lgkmcnt(3)
v_smfmac_f32_16x16x64_bf16 v[36:39], v[72:75], v[44:51], v0
ds_read_b128 v[72:75], v2 offset:25600
v_permlane32_swap_b32 v20, v21
v_max_f32 v20, v20, v21
v_sub_f32 v12, v12, v20
v_sub_f32 v13, v13, v20
v_pk_add_f32 v[14:15], v[14:15], v[20:21] op_sel_hi:[1,0] neg_lo:[0,1] neg_hi:[0,1]
v_exp_f32 v12, v12
v_exp_f32 v13, v13
v_exp_f32 v14, v14
v_exp_f32 v15, v15
v_cvt_pk_bf16_f32 v16, v12, v13
v_cvt_pk_bf16_f32 v17, v14, v15
v_pk_fma_f32 v[28:29], v[28:29], s[50:51], v[20:21] op_sel_hi:[1,1,0] neg_lo:[0,0,1] neg_hi:[0,0,1]
v_mov_b32_dpp v18, v16 quad_perm:[2,3,0,1] row_mask:0xf bank_mask:0xf
v_mov_b32_dpp v19, v17 quad_perm:[2,3,0,1] row_mask:0xf bank_mask:0xf
v_exp_f32 v28, v28
s_waitcnt vmcnt(2)
v_mfma_f32_16x16x32_bf16 v[32:35], v[76:79], v[16:19], 0
v_exp_f32 v29, v29
v_mfma_f32_16x16x32_bf16 v[20:23], v[52:55], v[16:19], 0
v_cvt_pk_bf16_f32 v12, v28, v29
v_cvt_pk_bf16_f32 v13, v28, v29
v_mov_b64 v[14:15], s[0:1]
v_mfma_f32_16x16x32_bf16 v[24:27], v[56:59], v[16:19], 0
v_cvt_pk_bf16_f32 v36, v36, v37
v_cvt_pk_bf16_f32 v37, v38, v39
v_mfma_f32_16x16x16_bf16 v[32:35], v[14:15], v[12:13], v[32:35]
v_cvt_pk_bf16_f32 v38, v40, v41
v_cvt_pk_bf16_f32 v39, v42, v43
v_mfma_f32_16x16x16_bf16 v[20:23], v[36:37], v[12:13], v[20:23]
ds_read_b128 v[44:47], v2 offset:20480
v_mfma_f32_16x16x16_bf16 v[24:27], v[38:39], v[12:13], v[24:27]
ds_read_b128 v[48:51], v2 offset:21504
v_rcp_f32 v32, v32
v_mov_b64 v[28:29], 0
v_mov_b64 v[30:31], 0
v_pk_mul_f32 v[20:21], v[20:21], v[32:33] op_sel_hi:[1,0]
v_pk_mul_f32 v[22:23], v[22:23], v[32:33] op_sel_hi:[1,0]
v_cvt_pk_bf16_f32 v20, v20, v21
v_cvt_pk_bf16_f32 v21, v22, v23
ds_write_b64 v1, v[20:21] offset:7168
v_pk_mul_f32 v[24:25], v[24:25], v[32:33] op_sel_hi:[1,0]
v_pk_mul_f32 v[26:27], v[26:27], v[32:33] op_sel_hi:[1,0]
v_cvt_pk_bf16_f32 v24, v24, v25
v_cvt_pk_bf16_f32 v25, v26, v27
ds_write_b64 v1, v[24:25] offset:7176
v_mov_b64 v[76:77], 0
ds_read_b128 v[12:15], v7 offset:7168
v_mov_b64 v[78:79], 0
v_mov_b64 v[40:41], 0
v_mov_b64 v[42:43], 0
v_mov_b64 v[36:37], 0
v_mov_b64 v[38:39], 0
v_mov_b64 v[32:33], 0
v_mov_b64 v[34:35], 0
s_waitcnt lgkmcnt(1)
s_barrier
ds_read_b128 v[16:19], v7 offset:8192
ds_read_b128 v[52:55], v7 offset:5120
ds_read_b128 v[56:59], v7 offset:6144
s_waitcnt lgkmcnt(3)
v_smfmac_f32_16x16x64_bf16 v[28:31], v[12:15], v[44:51], v0 abid:1
v_smfmac_f32_16x16x64_bf16 v[76:79], v[12:15], v[60:67], v0 abid:1
ds_read_b128 v[44:47], v2 offset:26624
s_waitcnt lgkmcnt(3)
v_smfmac_f32_16x16x64_bf16 v[28:31], v[16:19], a[176:183], v0 abid:1
ds_read_b128 v[48:51], v2 offset:27648
s_waitcnt lgkmcnt(3)
v_smfmac_f32_16x16x64_bf16 v[28:31], v[52:55], v[68:75], v0 abid:1
ds_read_b128 v[60:63], v2 offset:28672
s_waitcnt lgkmcnt(3)
v_smfmac_f32_16x16x64_bf16 v[28:31], v[56:59], a[184:191], v0 abid:1
ds_read_b128 v[64:67], v2 offset:29696
v_smfmac_f32_16x16x64_bf16 v[76:79], v[16:19], a[192:199], v0 abid:1
ds_read_b128 v[68:71], v2 offset:30720
s_waitcnt lgkmcnt(3)
v_smfmac_f32_16x16x64_bf16 v[76:79], v[52:55], v[44:51], v0 abid:1
ds_read_b128 v[72:75], v2 offset:31744
v_cvt_pk_bf16_f32 v28, v28, v29
v_cvt_pk_bf16_f32 v29, v30, v31
v_bfi_b32 v28, 1, s35, v28
buffer_store_dwordx2 v[28:29], v8, s[4:7], s42 offen sc0 sc1
v_smfmac_f32_16x16x64_bf16 v[76:79], v[56:59], a[200:207], v0 abid:1
v_smfmac_f32_16x16x64_bf16 v[40:43], v[12:15], a[208:215], v0 abid:1
v_smfmac_f32_16x16x64_bf16 v[40:43], v[16:19], a[216:223], v0 abid:1
v_cvt_pk_bf16_f32 v76, v76, v77
v_cvt_pk_bf16_f32 v77, v78, v79
v_bfi_b32 v76, 1, s35, v76
buffer_store_dwordx2 v[76:77], v8, s[4:7], s43 offen sc0 sc1
v_smfmac_f32_16x16x64_bf16 v[40:43], v[52:55], a[224:231], v0 abid:1
v_smfmac_f32_16x16x64_bf16 v[40:43], v[56:59], a[232:239], v0 abid:1
s_waitcnt lgkmcnt(2)
v_smfmac_f32_16x16x64_bf16 v[36:39], v[12:15], v[60:67], v0 abid:1
v_smfmac_f32_16x16x64_bf16 v[36:39], v[16:19], a[240:247], v0 abid:1
v_cvt_pk_bf16_f32 v40, v40, v41
s_waitcnt lgkmcnt(0)
v_smfmac_f32_16x16x64_bf16 v[36:39], v[52:55], v[68:75], v0 abid:1
v_cvt_pk_bf16_f32 v41, v42, v43
v_smfmac_f32_16x16x64_bf16 v[36:39], v[56:59], a[248:255], v0 abid:1
v_bfi_b32 v40, 1, s35, v40
buffer_store_dwordx2 v[40:41], v8, s[4:7], s44 offen sc0 sc1
s_nop 5
v_cvt_pk_bf16_f32 v36, v36, v37
v_cvt_pk_bf16_f32 v37, v38, v39
v_bfi_b32 v36, 1, s35, v36
buffer_store_dwordx2 v[36:37], v8, s[4:7], s45 offen sc0 sc1
s_branch L_ex_w2rs
L_done_w2rs:
buffer_store_dword v79, v10, s[4:7], s40 offen sc0 sc1
s_waitcnt vmcnt(0) lgkmcnt(0)
s_endpgm
L_ra0_w2rs:
s_mov_b32 s38, 1
s_mov_b32 m0, 1024
s_nop 0
buffer_load_dwordx4 v1, s[4:7], s47 offen offset:0 sc0 sc1 lds
buffer_load_dwordx4 v1, s[4:7], s47 offen offset:1024 sc0 sc1 lds
buffer_load_dwordx4 v1, s[4:7], s47 offen offset:2048 sc0 sc1 lds
buffer_load_dwordx4 v1, s[4:7], s47 offen offset:3072 sc0 sc1 lds
s_sub_u32 s41, s41, 1
s_cbranch_scc1 L_exit
ds_read_b128 v[44:47], v2 offset:0
ds_read_b128 v[48:51], v2 offset:1024
v_mov_b64 v[20:21], 0
v_mov_b64 v[22:23], 0
v_mov_b64 v[24:25], 0
v_mov_b64 v[26:27], 0
v_mov_b64 v[28:29], 0
v_mov_b64 v[30:31], 0
v_mov_b64 v[32:33], 0
v_mov_b64 v[34:35], 0
v_mov_b64 v[36:37], 0
v_mov_b64 v[38:39], 0
v_mov_b64 v[40:41], 0
v_mov_b64 v[42:43], 0
s_waitcnt vmcnt(0)
ds_read_b128 v[60:63], v1 offset:1024
ds_read_b128 v[64:67], v1 offset:2048
ds_read_b128 v[68:71], v1 offset:3072
ds_read_b128 v[72:75], v1 offset:4096
s_branch L_s0_w2rs
L_ra1_w2rs:
s_mov_b32 s38, 1
s_waitcnt lgkmcnt(0)
s_barrier
s_mov_b32 m0, 5120
s_nop 0
buffer_load_dwordx4 v1, s[4:7], s48 offen offset:2048 sc0 sc1 lds
s_sub_u32 s41, s41, 1
s_cbranch_scc1 L_exit
s_waitcnt vmcnt(0)
s_barrier
ds_read_b128 v[76:79], v1 offset:5120
ds_read_b128 v[60:63], v1 offset:6144
ds_read_b128 v[64:67], v1 offset:7168
ds_read_b128 v[68:71], v1 offset:8192
ds_read_b128 v[72:75], v1 offset:9216
s_waitcnt lgkmcnt(0)
v_bitop3_b32 v6, v76, v60, s35 bitop3:0x7e
v_bitop3_b32 v6, v6, v64, s35 bitop3:0xf6
v_bitop3_b32 v6, v6, v68, s35 bitop3:0xf6
v_bitop3_b32 v6, v6, v72, s35 bitop3:0xf6
v_and_b32 v6, 1, v6
v_cmp_ne_u32 vcc, 0, v6
v_lshlrev_b32 v6, 2, v1
s_cbranch_vccnz L_ra1_w2rs
s_branch L_a1_w2rs
L_rr_w2rs:
buffer_load_dwordx4 v[60:63], v9, s[4:7], s3 offen offset:0 sc0 sc1
buffer_load_dwordx4 v[64:67], v9, s[4:7], s3 offen offset:1024 sc0 sc1
buffer_load_dwordx4 v[68:71], v9, s[4:7], s3 offen offset:2048 sc0 sc1
buffer_load_dwordx4 v[72:75], v9, s[4:7], s3 offen offset:3072 sc0 sc1
s_sub_u32 s41, s41, 1
s_cbranch_scc1 L_exit
s_waitcnt vmcnt(0)
s_branch L_r_w2rs
L_pro_w3r:
v_and_b32 v20, 63, v0
v_and_b32 v21, 15, v0
v_bfe_u32 v22, v0, 4, 2
v_lshlrev_b32 v1, 4, v20
v_add_u32 v2, 131072, v1
v_bfe_u32 v23, v20, 3, 1
v_lshlrev_b32 v26, 3, v23
v_bfe_u32 v23, v20, 4, 2
v_lshl_add_u32 v26, v23, 1, v26
v_bfe_u32 v23, v20, 2, 1
v_add_u32 v26, v26, v23
v_lshlrev_b32 v26, 13, v26
v_and_b32 v23, 3, v20
v_lshl_add_u32 v26, v23, 4, v26
v_lshrrev_b32 v24, 2, v20
v_mul_u32_u24 v27, 1152, v24
v_lshl_add_u32 v27, v23, 4, v27
v_lshrrev_b32 v24, 2, v21
v_lshl_add_u32 v25, v22, 3, v24
v_lshlrev_b32 v28, 6, v25
v_lshl_add_u32 v28, v23, 3, v28
v_add_u32 v28, 131072, v28
v_and_b32 v25, 1, v22
v_lshlrev_b32 v29, 10, v25
v_lshrrev_b32 v25, 1, v22
v_lshl_add_u32 v29, v25, 8, v29
v_and_b32 v25, 1, v24
v_lshl_add_u32 v29, v25, 6, v29
v_lshrrev_b32 v25, 1, v24
v_lshl_add_u32 v29, v25, 3, v29
v_lshl_add_u32 v29, v23, 4, v29
v_add_u32 v29, 131072, v29
s_lshl_b32 s54, s32, 8
s_add_u32 s54, s54, 192
s_mul_i32 s55, s32, 147456
s_waitcnt lgkmcnt(0)
s_add_u32 s56, s54, 524288
s_mov_b32 m0, 151552
s_nop 0
buffer_load_dwordx4 v26, s[8:11], s56 offen lds
s_add_u32 s56, s54, 655360
s_mov_b32 m0, 152576
s_nop 0
buffer_load_dwordx4 v26, s[8:11], s56 offen lds
s_add_u32 s56, s54, 786432
s_mov_b32 m0, 153600
s_nop 0
buffer_load_dwordx4 v26, s[8:11], s56 offen lds
s_add_u32 s56, s54, 917504
s_mov_b32 m0, 154624
s_nop 0
buffer_load_dwordx4 v26, s[8:11], s56 offen lds
s_add_u32 s56, s54, 1048576
s_mov_b32 m0, 155648
s_nop 0
buffer_load_dwordx4 v26, s[8:11], s56 offen lds
s_add_u32 s56, s54, 1179648
s_mov_b32 m0, 156672
s_nop 0
buffer_load_dwordx4 v26, s[8:11], s56 offen lds
s_add_u32 s56, s54, 1310720
s_mov_b32 m0, 157696
s_nop 0
buffer_load_dwordx4 v26, s[8:11], s56 offen lds
s_add_u32 s56, s54, 1441792
s_mov_b32 m0, 158720
s_nop 0
buffer_load_dwordx4 v26, s[8:11], s56 offen lds
s_add_u32 s56, s54, 2621440
s_mov_b32 m0, 159744
s_nop 0
buffer_load_dwordx4 v26, s[8:11], s56 offen lds
s_add_u32 s56, s54, 2752512
s_mov_b32 m0, 160768
s_nop 0
buffer_load_dwordx4 v26, s[8:11], s56 offen lds
s_add_u32 s56, s54, 2883584
s_mov_b32 m0, 161792
s_nop 0
buffer_load_dwordx4 v26, s[8:11], s56 offen lds
s_add_u32 s56, s54, 3014656
s_mov_b32 m0, 162816
s_nop 0
buffer_load_dwordx4 v26, s[8:11], s56 offen lds
s_add_u32 s56, s54, 3145728
s_mov_b32 m0, 131072
s_nop 0
buffer_load_dwordx4 v26, s[8:11], s56 offen lds
s_add_u32 s56, s54, 3276800
s_mov_b32 m0, 132096
s_nop 0
buffer_load_dwordx4 v26, s[8:11], s56 offen lds
s_add_u32 s56, s54, 3407872
s_mov_b32 m0, 133120
s_nop 0
buffer_load_dwordx4 v26, s[8:11], s56 offen lds
s_add_u32 s56, s54, 3538944
s_mov_b32 m0, 134144
s_nop 0
buffer_load_dwordx4 v26, s[8:11], s56 offen lds
s_add_u32 s56, s54, 3670016
s_mov_b32 m0, 135168
s_nop 0
buffer_load_dwordx4 v26, s[8:11], s56 offen lds
s_add_u32 s56, s54, 3801088
s_mov_b32 m0, 136192
s_nop 0
buffer_load_dwordx4 v26, s[8:11], s56 offen lds
s_add_u32 s56, s54, 3932160
s_mov_b32 m0, 137216
s_nop 0
buffer_load_dwordx4 v26, s[8:11], s56 offen lds
s_add_u32 s56, s54, 4063232
s_mov_b32 m0, 138240
s_nop 0
buffer_load_dwordx4 v26, s[8:11], s56 offen lds
s_add_u32 s56, s54, 4194304
s_mov_b32 m0, 139264
s_nop 0
buffer_load_dwordx4 v26, s[8:11], s56 offen lds
s_add_u32 s56, s54, 4325376
s_mov_b32 m0, 140288
s_nop 0
buffer_load_dwordx4 v26, s[8:11], s56 offen lds
s_add_u32 s56, s54, 4456448
s_mov_b32 m0, 141312
s_nop 0
buffer_load_dwordx4 v26, s[8:11], s56 offen lds
s_add_u32 s56, s54, 4587520
s_mov_b32 m0, 142336
s_nop 0
buffer_load_dwordx4 v26, s[8:11], s56 offen lds
s_add_u32 s56, s54, 0
s_mov_b32 m0, 143360
s_nop 0
buffer_load_dwordx4 v26, s[12:15], s56 offen lds
s_add_u32 s56, s54, 131072
s_mov_b32 m0, 144384
s_nop 0
buffer_load_dwordx4 v26, s[12:15], s56 offen lds
s_add_u32 s56, s54, 262144
s_mov_b32 m0, 145408
s_nop 0
buffer_load_dwordx4 v26, s[12:15], s56 offen lds
s_add_u32 s56, s54, 393216
s_mov_b32 m0, 146432
s_nop 0
buffer_load_dwordx4 v26, s[12:15], s56 offen lds
v_bfe_u32 v23, v21, 1, 1
v_and_b32 v24, 1, v21
v_lshl_add_u32 v23, v24, 16, v23
v_mul_u32_u24 v23, 0xaaaa, v23
v_add_u32 v0, 0x44444444, v23
v_lshlrev_b32 v3, 3, v20
v_lshrrev_b32 v25, 5, v20
v_lshlrev_b32 v25, 6, v25
v_xor_b32 v3, v3, v25
v_lshrrev_b32 v25, 2, v20
v_and_b32 v4, 3, v21
v_lshl_add_u32 v4, v4, 4, v25
v_lshlrev_b32 v4, 3, v4
v_bfe_u32 v25, v21, 1, 1
v_lshlrev_b32 v23, 6, v25
v_xor_b32 v4, v4, v23
v_and_b32 v23, 2, v22
v_xor_b32 v5, v21, v23
v_lshlrev_b32 v5, 4, v5
v_lshl_add_u32 v5, v25, 10, v5
v_and_b32 v23, 1, v22
v_lshl_add_u32 v5, v23, 3, v5
v_lshlrev_b32 v9, 8, v22
v_lshl_add_u32 v9, v25, 6, v9
v_bfe_u32 v23, v21, 3, 1
v_lshl_add_u32 v9, v23, 7, v9
v_bfe_u32 v23, v21, 2, 1
v_lshl_add_u32 v9, v23, 5, v9
v_and_b32 v23, 1, v21
v_lshl_add_u32 v9, v23, 4, v9
v_lshrrev_b32 v23, 1, v22
v_and_b32 v24, 1, v22
v_and_b32 v25, 7, v21
v_lshrrev_b32 v7, 3, v21
v_lshl_add_u32 v8, v7, 1, v23
v_lshlrev_b32 v8, 12, v8
v_lshl_add_u32 v8, v24, 7, v8
v_and_b32 v25, 4, v21
v_lshl_add_u32 v8, v25, 3, v8
v_and_b32 v25, 1, v21
v_lshl_add_u32 v8, v25, 4, v8
v_bfe_u32 v25, v21, 1, 1
v_lshl_add_u32 v8, v25, 3, v8
s_lshr_b32 s56, s32, 1
s_lshl_b32 s56, s56, 8
s_and_b32 s57, s32, 1
s_lshl_b32 s57, s57, 6
s_add_u32 s56, s56, s57
s_add_u32 s56, s56, 49152
v_add_u32 v8, s56, v8
v_and_b32 v7, 12, v21
v_bfe_u32 v25, v21, 1, 1
v_add_u32 v7, v7, v25
v_lshlrev_b32 v7, 4, v7
v_lshl_add_u32 v7, v22, 8, v7
s_mov_b32 s42, 0
s_mov_b32 s43, 65536
s_mov_b32 s44, 131072
s_mov_b32 s45, 196608
s_mov_b32 s46, 262144
s_mov_b32 s47, 294912
s_mov_b32 s48, 299008
s_mov_b32 s49, 303104
s_mov_b32 s50, 0x3e0293ee
s_mov_b32 s51, 0x3e0293ee
s_mov_b32 s52, 0x3f803f80
s_mov_b32 s53, 0x3f803f80
v_and_b32 v11, 3, v21
v_cmp_eq_u32 vcc, 0, v11
s_nop 1
v_cndmask_b32 v11, 0, 1, vcc
s_mov_b32 s34, 0
s_mov_b32 s35, -1
s_mov_b32 s36, 0
s_mov_b32 s41, 2000000
s_lshl_b32 s37, s32, 14
s_add_u32 s39, s37, 17313792
s_add_u32 s37, s37, 16789504
s_mov_b32 s40, 8749056
v_mov_b64 v[36:37], 0
v_mov_b64 v[38:39], 0
s_lshl_b32 s56, s32, 1
s_add_u32 s56, s56, 1
s_cmp_eq_u32 s56, 0
s_cselect_b32 s56, 64, s56
s_mul_i32 s56, s56, 10240
s_add_u32 s56, s56, 8392704
s_add_u32 s57, s56, 4096
v_mov_b32 v40, 1
v_mov_b32 v41, 1
v_mov_b32 v42, 1
v_mov_b32 v43, 1
buffer_store_dwordx4 v[40:43], v1, s[4:7], s56 offen offset:0 sc0 sc1
buffer_store_dwordx4 v[40:43], v1, s[4:7], s56 offen offset:1024 sc0 sc1
buffer_store_dwordx4 v[40:43], v1, s[4:7], s56 offen offset:2048 sc0 sc1
buffer_store_dwordx4 v[40:43], v1, s[4:7], s56 offen offset:3072 sc0 sc1
buffer_store_dwordx4 v[40:43], v1, s[4:7], s57 offen offset:0 sc0 sc1
s_add_u32 s56, s32, 32
s_lshl_b32 s3, s56, 12
v_and_b32 v23, 1, v21
v_bfe_u32 v24, v21, 2, 1
v_bfe_u32 v25, v21, 1, 1
s_lshl_b32 s57, s56, 7
s_add_u32 s57, s57, 294912
v_and_b32 v10, 7, v21
v_lshlrev_b32 v10, 2, v10
v_lshl_add_u32 v10, v22, 5, v10
v_add_u32 v10, s57, v10
s_lshl_b32 s33, s56, 2
s_add_u32 s33, s33, 304128
v_mov_b32 v30, -1
s_mov_b64 exec, 1
buffer_store_dword v30, v1, s[4:7], s33 offen sc0 sc1
s_mov_b64 exec, -1
v_lshl_add_u32 v23, v23, 1, v24
v_lshlrev_b32 v25, 4, v25
v_mov_b32 v24, 0x3f80
v_lshlrev_b32 v24, v25, v24
v_cmp_eq_u32 vcc, 0, v23
s_nop 1
v_cndmask_b32 v76, 0, v24, vcc
v_cmp_eq_u32 vcc, 1, v23
s_nop 1
v_cndmask_b32 v77, 0, v24, vcc
v_cmp_eq_u32 vcc, 2, v23
s_nop 1
v_cndmask_b32 v78, 0, v24, vcc
v_cmp_eq_u32 vcc, 3, v23
s_nop 1
v_cndmask_b32 v79, 0, v24, vcc
buffer_store_dwordx4 v[36:39], v9, s[4:7], s3 offen offset:0 sc0 sc1
buffer_store_dwordx4 v[36:39], v9, s[4:7], s3 offen offset:1024 sc0 sc1
buffer_store_dwordx4 v[36:39], v9, s[4:7], s3 offen offset:2048 sc0 sc1
buffer_store_dwordx4 v[36:39], v9, s[4:7], s3 offen offset:3072 sc0 sc1
s_waitcnt vmcnt(0) lgkmcnt(0)
s_barrier
s_getreg_b32 s56, hwreg(HW_REG_XCC_ID)
s_and_b32 s56, s56, 15
s_mul_i32 s57, s56, s56
s_lshl_b32 s57, s57, 18
s_lshl_b32 s56, s56, 8
s_add_u32 s57, s57, s56
s_add_u32 s58, s57, 1
ds_read_b64_tr_b16 v[80:81], v28 offset:20480
ds_read_b64_tr_b16 v[82:83], v28 offset:20736
ds_read_b64_tr_b16 v[84:85], v28 offset:22528
ds_read_b64_tr_b16 v[86:87], v28 offset:22784
ds_read_b64_tr_b16 v[88:89], v28 offset:20512
ds_read_b64_tr_b16 v[90:91], v28 offset:20768
ds_read_b64_tr_b16 v[92:93], v28 offset:22560
ds_read_b64_tr_b16 v[94:95], v28 offset:22816
s_waitcnt lgkmcnt(0)
s_add_u32 s56, s54, 524288
s_mov_b32 m0, 147456
s_nop 0
buffer_load_dwordx4 v26, s[12:15], s56 offen lds
s_add_u32 s56, s54, 655360
s_mov_b32 m0, 148480
s_nop 0
buffer_load_dwordx4 v26, s[12:15], s56 offen lds
s_add_u32 s56, s54, 786432
s_mov_b32 m0, 149504
s_nop 0
buffer_load_dwordx4 v26, s[12:15], s56 offen lds
s_add_u32 s56, s54, 917504
s_mov_b32 m0, 150528
s_nop 0
buffer_load_dwordx4 v26, s[12:15], s56 offen lds
ds_read_b64_tr_b16 v[96:97], v28 offset:24576
ds_read_b64_tr_b16 v[98:99], v28 offset:24832
ds_read_b64_tr_b16 v[100:101], v28 offset:26624
ds_read_b64_tr_b16 v[102:103], v28 offset:26880
ds_read_b64_tr_b16 v[104:105], v28 offset:24608
ds_read_b64_tr_b16 v[106:107], v28 offset:24864
ds_read_b64_tr_b16 v[108:109], v28 offset:26656
ds_read_b64_tr_b16 v[110:111], v28 offset:26912
s_waitcnt lgkmcnt(0)
s_add_u32 s56, s54, 1048576
s_mov_b32 m0, 151552
s_nop 0
buffer_load_dwordx4 v26, s[12:15], s56 offen lds
s_add_u32 s56, s54, 1179648
s_mov_b32 m0, 152576
s_nop 0
buffer_load_dwordx4 v26, s[12:15], s56 offen lds
s_add_u32 s56, s54, 1310720
s_mov_b32 m0, 153600
s_nop 0
buffer_load_dwordx4 v26, s[12:15], s56 offen lds
s_add_u32 s56, s54, 1441792
s_mov_b32 m0, 154624
s_nop 0
buffer_load_dwordx4 v26, s[12:15], s56 offen lds
ds_read_b64_tr_b16 v[112:113], v28 offset:28672
ds_read_b64_tr_b16 v[114:115], v28 offset:28928
ds_read_b64_tr_b16 v[116:117], v28 offset:30720
ds_read_b64_tr_b16 v[118:119], v28 offset:30976
ds_read_b64_tr_b16 v[120:121], v28 offset:28704
ds_read_b64_tr_b16 v[122:123], v28 offset:28960
ds_read_b64_tr_b16 v[124:125], v28 offset:30752
ds_read_b64_tr_b16 v[126:127], v28 offset:31008
s_waitcnt lgkmcnt(0)
s_add_u32 s56, s54, 1572864
s_mov_b32 m0, 155648
s_nop 0
buffer_load_dwordx4 v26, s[12:15], s56 offen lds
s_add_u32 s56, s54, 1703936
s_mov_b32 m0, 156672
s_nop 0
buffer_load_dwordx4 v26, s[12:15], s56 offen lds
s_add_u32 s56, s54, 1835008
s_mov_b32 m0, 157696
s_nop 0
buffer_load_dwordx4 v26, s[12:15], s56 offen lds
s_add_u32 s56, s54, 1966080
s_mov_b32 m0, 158720
s_nop 0
buffer_load_dwordx4 v26, s[12:15], s56 offen lds
ds_read_b64_tr_b16 v[128:129], v28 offset:0
ds_read_b64_tr_b16 v[130:131], v28 offset:256
ds_read_b64_tr_b16 v[132:133], v28 offset:2048
ds_read_b64_tr_b16 v[134:135], v28 offset:2304
ds_read_b64_tr_b16 v[136:137], v28 offset:32
ds_read_b64_tr_b16 v[138:139], v28 offset:288
ds_read_b64_tr_b16 v[140:141], v28 offset:2080
ds_read_b64_tr_b16 v[142:143], v28 offset:2336
s_waitcnt lgkmcnt(0)
s_add_u32 s56, s54, 2097152
s_mov_b32 m0, 159744
s_nop 0
buffer_load_dwordx4 v26, s[12:15], s56 offen lds
s_add_u32 s56, s54, 2228224
s_mov_b32 m0, 160768
s_nop 0
buffer_load_dwordx4 v26, s[12:15], s56 offen lds
s_add_u32 s56, s54, 2359296
s_mov_b32 m0, 161792
s_nop 0
buffer_load_dwordx4 v26, s[12:15], s56 offen lds
s_add_u32 s56, s54, 2490368
s_mov_b32 m0, 162816
s_nop 0
buffer_load_dwordx4 v26, s[12:15], s56 offen lds
ds_read_b64_tr_b16 v[144:145], v28 offset:4096
ds_read_b64_tr_b16 v[146:147], v28 offset:4352
ds_read_b64_tr_b16 v[148:149], v28 offset:6144
ds_read_b64_tr_b16 v[150:151], v28 offset:6400
ds_read_b64_tr_b16 v[152:153], v28 offset:4128
ds_read_b64_tr_b16 v[154:155], v28 offset:4384
ds_read_b64_tr_b16 v[156:157], v28 offset:6176
ds_read_b64_tr_b16 v[158:159], v28 offset:6432
s_waitcnt lgkmcnt(0)
s_add_u32 s56, s54, 3145728
s_mov_b32 m0, 131072
s_nop 0
buffer_load_dwordx4 v26, s[12:15], s56 offen lds
s_add_u32 s56, s54, 3276800
s_mov_b32 m0, 132096
s_nop 0
buffer_load_dwordx4 v26, s[12:15], s56 offen lds
s_add_u32 s56, s54, 3407872
s_mov_b32 m0, 133120
s_nop 0
buffer_load_dwordx4 v26, s[12:15], s56 offen lds
s_add_u32 s56, s54, 3538944
s_mov_b32 m0, 134144
s_nop 0
buffer_load_dwordx4 v26, s[12:15], s56 offen lds
ds_read_b64_tr_b16 v[160:161], v28 offset:8192
ds_read_b64_tr_b16 v[162:163], v28 offset:8448
ds_read_b64_tr_b16 v[164:165], v28 offset:10240
ds_read_b64_tr_b16 v[166:167], v28 offset:10496
ds_read_b64_tr_b16 v[168:169], v28 offset:8224
ds_read_b64_tr_b16 v[170:171], v28 offset:8480
ds_read_b64_tr_b16 v[172:173], v28 offset:10272
ds_read_b64_tr_b16 v[174:175], v28 offset:10528
s_waitcnt lgkmcnt(0)
s_add_u32 s56, s54, 3670016
s_mov_b32 m0, 135168
s_nop 0
buffer_load_dwordx4 v26, s[12:15], s56 offen lds
s_add_u32 s56, s54, 3801088
s_mov_b32 m0, 136192
s_nop 0
buffer_load_dwordx4 v26, s[12:15], s56 offen lds
s_add_u32 s56, s54, 3932160
s_mov_b32 m0, 137216
s_nop 0
buffer_load_dwordx4 v26, s[12:15], s56 offen lds
s_add_u32 s56, s54, 4063232
s_mov_b32 m0, 138240
s_nop 0
buffer_load_dwordx4 v26, s[12:15], s56 offen lds
ds_read_b64_tr_b16 v[176:177], v28 offset:12288
ds_read_b64_tr_b16 v[178:179], v28 offset:12544
ds_read_b64_tr_b16 v[180:181], v28 offset:14336
ds_read_b64_tr_b16 v[182:183], v28 offset:14592
ds_read_b64_tr_b16 v[184:185], v28 offset:12320
ds_read_b64_tr_b16 v[186:187], v28 offset:12576
ds_read_b64_tr_b16 v[188:189], v28 offset:14368
ds_read_b64_tr_b16 v[190:191], v28 offset:14624
s_waitcnt lgkmcnt(0)
s_add_u32 s56, s54, 4194304
s_mov_b32 m0, 139264
s_nop 0
buffer_load_dwordx4 v26, s[12:15], s56 offen lds
s_add_u32 s56, s54, 4325376
s_mov_b32 m0, 140288
s_nop 0
buffer_load_dwordx4 v26, s[12:15], s56 offen lds
s_add_u32 s56, s54, 4456448
s_mov_b32 m0, 141312
s_nop 0
buffer_load_dwordx4 v26, s[12:15], s56 offen lds
s_add_u32 s56, s54, 4587520
s_mov_b32 m0, 142336
s_nop 0
buffer_load_dwordx4 v26, s[12:15], s56 offen lds
s_waitcnt vmcnt(24)
ds_read_b64_tr_b16 v[192:193], v28 offset:16384
ds_read_b64_tr_b16 v[194:195], v28 offset:16640
ds_read_b64_tr_b16 v[196:197], v28 offset:18432
ds_read_b64_tr_b16 v[198:199], v28 offset:18688
ds_read_b64_tr_b16 v[200:201], v28 offset:16416
ds_read_b64_tr_b16 v[202:203], v28 offset:16672
ds_read_b64_tr_b16 v[204:205], v28 offset:18464
ds_read_b64_tr_b16 v[206:207], v28 offset:18720
s_waitcnt lgkmcnt(0)
s_add_u32 s56, s54, 0
s_mov_b32 m0, 143360
s_nop 0
buffer_load_dwordx4 v26, s[16:19], s56 offen lds
s_add_u32 s56, s54, 131072
s_mov_b32 m0, 144384
s_nop 0
buffer_load_dwordx4 v26, s[16:19], s56 offen lds
s_add_u32 s56, s54, 262144
s_mov_b32 m0, 145408
s_nop 0
buffer_load_dwordx4 v26, s[16:19], s56 offen lds
s_add_u32 s56, s54, 393216
s_mov_b32 m0, 146432
s_nop 0
buffer_load_dwordx4 v26, s[16:19], s56 offen lds
s_waitcnt vmcnt(24)
ds_read_b64_tr_b16 v[208:209], v28 offset:20480
ds_read_b64_tr_b16 v[210:211], v28 offset:20736
ds_read_b64_tr_b16 v[212:213], v28 offset:22528
ds_read_b64_tr_b16 v[214:215], v28 offset:22784
ds_read_b64_tr_b16 v[216:217], v28 offset:20512
ds_read_b64_tr_b16 v[218:219], v28 offset:20768
ds_read_b64_tr_b16 v[220:221], v28 offset:22560
ds_read_b64_tr_b16 v[222:223], v28 offset:22816
s_waitcnt lgkmcnt(0)
s_add_u32 s56, s54, 524288
s_mov_b32 m0, 147456
s_nop 0
buffer_load_dwordx4 v26, s[16:19], s56 offen lds
s_add_u32 s56, s54, 655360
s_mov_b32 m0, 148480
s_nop 0
buffer_load_dwordx4 v26, s[16:19], s56 offen lds
s_add_u32 s56, s54, 786432
s_mov_b32 m0, 149504
s_nop 0
buffer_load_dwordx4 v26, s[16:19], s56 offen lds
s_add_u32 s56, s54, 917504
s_mov_b32 m0, 150528
s_nop 0
buffer_load_dwordx4 v26, s[16:19], s56 offen lds
s_waitcnt vmcnt(24)
ds_read_b64_tr_b16 v[224:225], v28 offset:24576
ds_read_b64_tr_b16 v[226:227], v28 offset:24832
ds_read_b64_tr_b16 v[228:229], v28 offset:26624
ds_read_b64_tr_b16 v[230:231], v28 offset:26880
ds_read_b64_tr_b16 v[232:233], v28 offset:24608
ds_read_b64_tr_b16 v[234:235], v28 offset:24864
ds_read_b64_tr_b16 v[236:237], v28 offset:26656
ds_read_b64_tr_b16 v[238:239], v28 offset:26912
s_waitcnt lgkmcnt(0)
s_add_u32 s56, s54, 1048576
s_mov_b32 m0, 151552
s_nop 0
buffer_load_dwordx4 v26, s[16:19], s56 offen lds
s_add_u32 s56, s54, 1179648
s_mov_b32 m0, 152576
s_nop 0
buffer_load_dwordx4 v26, s[16:19], s56 offen lds
s_add_u32 s56, s54, 1310720
s_mov_b32 m0, 153600
s_nop 0
buffer_load_dwordx4 v26, s[16:19], s56 offen lds
s_add_u32 s56, s54, 1441792
s_mov_b32 m0, 154624
s_nop 0
buffer_load_dwordx4 v26, s[16:19], s56 offen lds
s_waitcnt vmcnt(24)
ds_read_b64_tr_b16 v[240:241], v28 offset:28672
ds_read_b64_tr_b16 v[242:243], v28 offset:28928
ds_read_b64_tr_b16 v[244:245], v28 offset:30720
ds_read_b64_tr_b16 v[246:247], v28 offset:30976
ds_read_b64_tr_b16 v[248:249], v28 offset:28704
ds_read_b64_tr_b16 v[250:251], v28 offset:28960
ds_read_b64_tr_b16 v[252:253], v28 offset:30752
ds_read_b64_tr_b16 v[254:255], v28 offset:31008
s_waitcnt lgkmcnt(0)
s_add_u32 s56, s54, 1572864
s_mov_b32 m0, 155648
s_nop 0
buffer_load_dwordx4 v26, s[16:19], s56 offen lds
s_add_u32 s56, s54, 1703936
s_mov_b32 m0, 156672
s_nop 0
buffer_load_dwordx4 v26, s[16:19], s56 offen lds
s_add_u32 s56, s54, 1835008
s_mov_b32 m0, 157696
s_nop 0
buffer_load_dwordx4 v26, s[16:19], s56 offen lds
s_add_u32 s56, s54, 1966080
s_mov_b32 m0, 158720
s_nop 0
buffer_load_dwordx4 v26, s[16:19], s56 offen lds
s_waitcnt vmcnt(24)
ds_read_b64_tr_b16 a[0:1], v28 offset:0
ds_read_b64_tr_b16 a[2:3], v28 offset:256
ds_read_b64_tr_b16 a[4:5], v28 offset:2048
ds_read_b64_tr_b16 a[6:7], v28 offset:2304
ds_read_b64_tr_b16 a[8:9], v28 offset:32
ds_read_b64_tr_b16 a[10:11], v28 offset:288
ds_read_b64_tr_b16 a[12:13], v28 offset:2080
ds_read_b64_tr_b16 a[14:15], v28 offset:2336
s_waitcnt lgkmcnt(0)
s_add_u32 s56, s54, 2097152
s_mov_b32 m0, 159744
s_nop 0
buffer_load_dwordx4 v26, s[16:19], s56 offen lds
s_add_u32 s56, s54, 2228224
s_mov_b32 m0, 160768
s_nop 0
buffer_load_dwordx4 v26, s[16:19], s56 offen lds
s_add_u32 s56, s54, 2359296
s_mov_b32 m0, 161792
s_nop 0
buffer_load_dwordx4 v26, s[16:19], s56 offen lds
s_add_u32 s56, s54, 2490368
s_mov_b32 m0, 162816
s_nop 0
buffer_load_dwordx4 v26, s[16:19], s56 offen lds
s_waitcnt vmcnt(24)
ds_read_b64_tr_b16 a[16:17], v28 offset:4096
ds_read_b64_tr_b16 a[18:19], v28 offset:4352
ds_read_b64_tr_b16 a[20:21], v28 offset:6144
ds_read_b64_tr_b16 a[22:23], v28 offset:6400
ds_read_b64_tr_b16 a[24:25], v28 offset:4128
ds_read_b64_tr_b16 a[26:27], v28 offset:4384
ds_read_b64_tr_b16 a[28:29], v28 offset:6176
ds_read_b64_tr_b16 a[30:31], v28 offset:6432
s_waitcnt lgkmcnt(0)
s_add_u32 s56, s54, 2621440
s_mov_b32 m0, 131072
s_nop 0
buffer_load_dwordx4 v26, s[16:19], s56 offen lds
s_add_u32 s56, s54, 2752512
s_mov_b32 m0, 132096
s_nop 0
buffer_load_dwordx4 v26, s[16:19], s56 offen lds
s_add_u32 s56, s54, 2883584
s_mov_b32 m0, 133120
s_nop 0
buffer_load_dwordx4 v26, s[16:19], s56 offen lds
s_add_u32 s56, s54, 3014656
s_mov_b32 m0, 134144
s_nop 0
buffer_load_dwordx4 v26, s[16:19], s56 offen lds
s_waitcnt vmcnt(24)
ds_read_b64_tr_b16 a[32:33], v28 offset:8192
ds_read_b64_tr_b16 a[34:35], v28 offset:8448
ds_read_b64_tr_b16 a[36:37], v28 offset:10240
ds_read_b64_tr_b16 a[38:39], v28 offset:10496
ds_read_b64_tr_b16 a[40:41], v28 offset:8224
ds_read_b64_tr_b16 a[42:43], v28 offset:8480
ds_read_b64_tr_b16 a[44:45], v28 offset:10272
ds_read_b64_tr_b16 a[46:47], v28 offset:10528
s_waitcnt lgkmcnt(0)
s_add_u32 s56, s54, 3145728
s_mov_b32 m0, 135168
s_nop 0
buffer_load_dwordx4 v26, s[16:19], s56 offen lds
s_add_u32 s56, s54, 3276800
s_mov_b32 m0, 136192
s_nop 0
buffer_load_dwordx4 v26, s[16:19], s56 offen lds
s_add_u32 s56, s54, 3407872
s_mov_b32 m0, 137216
s_nop 0
buffer_load_dwordx4 v26, s[16:19], s56 offen lds
s_add_u32 s56, s54, 3538944
s_mov_b32 m0, 138240
s_nop 0
buffer_load_dwordx4 v26, s[16:19], s56 offen lds
s_waitcnt vmcnt(24)
ds_read_b64_tr_b16 a[48:49], v28 offset:12288
ds_read_b64_tr_b16 a[50:51], v28 offset:12544
ds_read_b64_tr_b16 a[52:53], v28 offset:14336
ds_read_b64_tr_b16 a[54:55], v28 offset:14592
ds_read_b64_tr_b16 a[56:57], v28 offset:12320
ds_read_b64_tr_b16 a[58:59], v28 offset:12576
ds_read_b64_tr_b16 a[60:61], v28 offset:14368
ds_read_b64_tr_b16 a[62:63], v28 offset:14624
s_waitcnt lgkmcnt(0)
s_add_u32 s56, s54, 3670016
s_mov_b32 m0, 139264
s_nop 0
buffer_load_dwordx4 v26, s[16:19], s56 offen lds
s_add_u32 s56, s54, 3801088
s_mov_b32 m0, 140288
s_nop 0
buffer_load_dwordx4 v26, s[16:19], s56 offen lds
s_add_u32 s56, s54, 3932160
s_mov_b32 m0, 141312
s_nop 0
buffer_load_dwordx4 v26, s[16:19], s56 offen lds
s_add_u32 s56, s54, 4063232
s_mov_b32 m0, 142336
s_nop 0
buffer_load_dwordx4 v26, s[16:19], s56 offen lds
s_waitcnt vmcnt(24)
ds_read_b64_tr_b16 a[64:65], v28 offset:16384
ds_read_b64_tr_b16 a[66:67], v28 offset:16640
ds_read_b64_tr_b16 a[68:69], v28 offset:18432
ds_read_b64_tr_b16 a[70:71], v28 offset:18688
ds_read_b64_tr_b16 a[72:73], v28 offset:16416
ds_read_b64_tr_b16 a[74:75], v28 offset:16672
ds_read_b64_tr_b16 a[76:77], v28 offset:18464
ds_read_b64_tr_b16 a[78:79], v28 offset:18720
s_waitcnt lgkmcnt(0)
s_add_u32 s56, s55, 192
s_mov_b32 m0, 143360
s_nop 0
buffer_load_dwordx4 v27, s[20:23], s56 offen lds
s_add_u32 s56, s55, 18624
s_mov_b32 m0, 144384
s_nop 0
buffer_load_dwordx4 v27, s[20:23], s56 offen lds
s_add_u32 s56, s55, 73920
s_mov_b32 m0, 145408
s_nop 0
buffer_load_dwordx4 v27, s[20:23], s56 offen lds
s_add_u32 s56, s55, 92352
s_mov_b32 m0, 146432
s_nop 0
buffer_load_dwordx4 v27, s[20:23], s56 offen lds
s_waitcnt vmcnt(24)
ds_read_b64_tr_b16 a[80:81], v28 offset:20480
ds_read_b64_tr_b16 a[82:83], v28 offset:20736
ds_read_b64_tr_b16 a[84:85], v28 offset:22528
ds_read_b64_tr_b16 a[86:87], v28 offset:22784
ds_read_b64_tr_b16 a[88:89], v28 offset:20512
ds_read_b64_tr_b16 a[90:91], v28 offset:20768
ds_read_b64_tr_b16 a[92:93], v28 offset:22560
ds_read_b64_tr_b16 a[94:95], v28 offset:22816
s_waitcnt lgkmcnt(0)
s_add_u32 s56, s55, 448
s_mov_b32 m0, 147456
s_nop 0
buffer_load_dwordx4 v27, s[20:23], s56 offen lds
s_add_u32 s56, s55, 18880
s_mov_b32 m0, 148480
s_nop 0
buffer_load_dwordx4 v27, s[20:23], s56 offen lds
s_add_u32 s56, s55, 74176
s_mov_b32 m0, 149504
s_nop 0
buffer_load_dwordx4 v27, s[20:23], s56 offen lds
s_add_u32 s56, s55, 92608
s_mov_b32 m0, 150528
s_nop 0
buffer_load_dwordx4 v27, s[20:23], s56 offen lds
s_waitcnt vmcnt(24)
ds_read_b64_tr_b16 a[96:97], v28 offset:24576
ds_read_b64_tr_b16 a[98:99], v28 offset:24832
ds_read_b64_tr_b16 a[100:101], v28 offset:26624
ds_read_b64_tr_b16 a[102:103], v28 offset:26880
ds_read_b64_tr_b16 a[104:105], v28 offset:24608
ds_read_b64_tr_b16 a[106:107], v28 offset:24864
ds_read_b64_tr_b16 a[108:109], v28 offset:26656
ds_read_b64_tr_b16 a[110:111], v28 offset:26912
s_waitcnt lgkmcnt(0)
s_add_u32 s56, s55, 111296
s_mov_b32 m0, 151552
s_nop 0
buffer_load_dwordx4 v27, s[20:23], s56 offen lds
s_add_u32 s56, s55, 129728
s_mov_b32 m0, 152576
s_nop 0
buffer_load_dwordx4 v27, s[20:23], s56 offen lds
s_add_u32 s56, s55, 704
s_mov_b32 m0, 153600
s_nop 0
buffer_load_dwordx4 v27, s[20:23], s56 offen lds
s_add_u32 s56, s55, 19136
s_mov_b32 m0, 154624
s_nop 0
buffer_load_dwordx4 v27, s[20:23], s56 offen lds
s_waitcnt vmcnt(24)
ds_read_b64_tr_b16 a[112:113], v28 offset:28672
ds_read_b64_tr_b16 a[114:115], v28 offset:28928
ds_read_b64_tr_b16 a[116:117], v28 offset:30720
ds_read_b64_tr_b16 a[118:119], v28 offset:30976
ds_read_b64_tr_b16 a[120:121], v28 offset:28704
ds_read_b64_tr_b16 a[122:123], v28 offset:28960
ds_read_b64_tr_b16 a[124:125], v28 offset:30752
ds_read_b64_tr_b16 a[126:127], v28 offset:31008
s_waitcnt lgkmcnt(0)
s_add_u32 s56, s55, 37568
s_mov_b32 m0, 155648
s_nop 0
buffer_load_dwordx4 v27, s[20:23], s56 offen lds
s_add_u32 s56, s55, 56000
s_mov_b32 m0, 156672
s_nop 0
buffer_load_dwordx4 v27, s[20:23], s56 offen lds
s_add_u32 s56, s55, 74432
s_mov_b32 m0, 157696
s_nop 0
buffer_load_dwordx4 v27, s[20:23], s56 offen lds
s_add_u32 s56, s55, 92864
s_mov_b32 m0, 158720
s_nop 0
buffer_load_dwordx4 v27, s[20:23], s56 offen lds
s_waitcnt vmcnt(24)
ds_read_b64_tr_b16 a[128:129], v28 offset:0
ds_read_b64_tr_b16 a[130:131], v28 offset:256
ds_read_b64_tr_b16 a[132:133], v28 offset:2048
ds_read_b64_tr_b16 a[134:135], v28 offset:2304
ds_read_b64_tr_b16 a[136:137], v28 offset:32
ds_read_b64_tr_b16 a[138:139], v28 offset:288
ds_read_b64_tr_b16 a[140:141], v28 offset:2080
ds_read_b64_tr_b16 a[142:143], v28 offset:2336
s_waitcnt lgkmcnt(0)
s_add_u32 s56, s55, 960
s_mov_b32 m0, 159744
s_nop 0
buffer_load_dwordx4 v27, s[20:23], s56 offen lds
s_add_u32 s56, s55, 19392
s_mov_b32 m0, 160768
s_nop 0
buffer_load_dwordx4 v27, s[20:23], s56 offen lds
s_add_u32 s56, s55, 74688
s_mov_b32 m0, 161792
s_nop 0
buffer_load_dwordx4 v27, s[20:23], s56 offen lds
s_add_u32 s56, s55, 93120
s_mov_b32 m0, 162816
s_nop 0
buffer_load_dwordx4 v27, s[20:23], s56 offen lds
s_waitcnt vmcnt(24)
ds_read_b64_tr_b16 a[144:145], v28 offset:4096
ds_read_b64_tr_b16 a[146:147], v28 offset:4352
ds_read_b64_tr_b16 a[148:149], v28 offset:6144
ds_read_b64_tr_b16 a[150:151], v28 offset:6400
ds_read_b64_tr_b16 a[152:153], v28 offset:4128
ds_read_b64_tr_b16 a[154:155], v28 offset:4384
ds_read_b64_tr_b16 a[156:157], v28 offset:6176
ds_read_b64_tr_b16 a[158:159], v28 offset:6432
s_waitcnt lgkmcnt(0)
s_add_u32 s56, s54, 0
s_mov_b32 m0, 131072
s_nop 0
buffer_load_dwordx4 v26, s[8:11], s56 offen lds
s_add_u32 s56, s54, 131072
s_mov_b32 m0, 132096
s_nop 0
buffer_load_dwordx4 v26, s[8:11], s56 offen lds
s_add_u32 s56, s54, 262144
s_mov_b32 m0, 133120
s_nop 0
buffer_load_dwordx4 v26, s[8:11], s56 offen lds
s_add_u32 s56, s54, 393216
s_mov_b32 m0, 134144
s_nop 0
buffer_load_dwordx4 v26, s[8:11], s56 offen lds
s_waitcnt vmcnt(24)
ds_read_b64_tr_b16 a[160:161], v28 offset:8192
ds_read_b64_tr_b16 a[162:163], v28 offset:8448
ds_read_b64_tr_b16 a[164:165], v28 offset:10240
ds_read_b64_tr_b16 a[166:167], v28 offset:10496
ds_read_b64_tr_b16 a[168:169], v28 offset:8224
ds_read_b64_tr_b16 a[170:171], v28 offset:8480
ds_read_b64_tr_b16 a[172:173], v28 offset:10272
ds_read_b64_tr_b16 a[174:175], v28 offset:10528
s_waitcnt lgkmcnt(0)
s_add_u32 s56, s54, 1572864
s_mov_b32 m0, 135168
s_nop 0
buffer_load_dwordx4 v26, s[8:11], s56 offen lds
s_add_u32 s56, s54, 1703936
s_mov_b32 m0, 136192
s_nop 0
buffer_load_dwordx4 v26, s[8:11], s56 offen lds
s_add_u32 s56, s54, 1835008
s_mov_b32 m0, 137216
s_nop 0
buffer_load_dwordx4 v26, s[8:11], s56 offen lds
s_add_u32 s56, s54, 1966080
s_mov_b32 m0, 138240
s_nop 0
buffer_load_dwordx4 v26, s[8:11], s56 offen lds
s_waitcnt vmcnt(24)
ds_read_b64_tr_b16 a[176:177], v29 offset:12288
ds_read_b64_tr_b16 a[178:179], v29 offset:12416
ds_read_b64_tr_b16 a[180:181], v29 offset:12800
ds_read_b64_tr_b16 a[182:183], v29 offset:12928
ds_read_b64_tr_b16 a[184:185], v29 offset:14336
ds_read_b64_tr_b16 a[186:187], v29 offset:14464
ds_read_b64_tr_b16 a[188:189], v29 offset:14848
ds_read_b64_tr_b16 a[190:191], v29 offset:14976
s_waitcnt lgkmcnt(0)
s_add_u32 s56, s54, 2097152
s_mov_b32 m0, 139264
s_nop 0
buffer_load_dwordx4 v26, s[8:11], s56 offen lds
s_add_u32 s56, s54, 2228224
s_mov_b32 m0, 140288
s_nop 0
buffer_load_dwordx4 v26, s[8:11], s56 offen lds
s_add_u32 s56, s54, 2359296
s_mov_b32 m0, 141312
s_nop 0
buffer_load_dwordx4 v26, s[8:11], s56 offen lds
s_add_u32 s56, s54, 2490368
s_mov_b32 m0, 142336
s_nop 0
buffer_load_dwordx4 v26, s[8:11], s56 offen lds
s_waitcnt vmcnt(24)
ds_read_b64_tr_b16 a[192:193], v29 offset:16384
ds_read_b64_tr_b16 a[194:195], v29 offset:16512
ds_read_b64_tr_b16 a[196:197], v29 offset:16896
ds_read_b64_tr_b16 a[198:199], v29 offset:17024
ds_read_b64_tr_b16 a[200:201], v29 offset:18432
ds_read_b64_tr_b16 a[202:203], v29 offset:18560
ds_read_b64_tr_b16 a[204:205], v29 offset:18944
ds_read_b64_tr_b16 a[206:207], v29 offset:19072
s_waitcnt lgkmcnt(0)
s_add_u32 s56, s54, 2621440
s_mov_b32 m0, 143360
s_nop 0
buffer_load_dwordx4 v26, s[12:15], s56 offen lds
s_add_u32 s56, s54, 2752512
s_mov_b32 m0, 144384
s_nop 0
buffer_load_dwordx4 v26, s[12:15], s56 offen lds
s_add_u32 s56, s54, 2883584
s_mov_b32 m0, 145408
s_nop 0
buffer_load_dwordx4 v26, s[12:15], s56 offen lds
s_add_u32 s56, s54, 3014656
s_mov_b32 m0, 146432
s_nop 0
buffer_load_dwordx4 v26, s[12:15], s56 offen lds
s_waitcnt vmcnt(24)
ds_read_b64_tr_b16 a[208:209], v29 offset:20480
ds_read_b64_tr_b16 a[210:211], v29 offset:20608
ds_read_b64_tr_b16 a[212:213], v29 offset:20992
ds_read_b64_tr_b16 a[214:215], v29 offset:21120
ds_read_b64_tr_b16 a[216:217], v29 offset:22528
ds_read_b64_tr_b16 a[218:219], v29 offset:22656
ds_read_b64_tr_b16 a[220:221], v29 offset:23040
ds_read_b64_tr_b16 a[222:223], v29 offset:23168
s_waitcnt lgkmcnt(0)
s_add_u32 s56, s54, 4194304
s_mov_b32 m0, 147456
s_nop 0
buffer_load_dwordx4 v26, s[16:19], s56 offen lds
s_add_u32 s56, s54, 4325376
s_mov_b32 m0, 148480
s_nop 0
buffer_load_dwordx4 v26, s[16:19], s56 offen lds
s_add_u32 s56, s54, 4456448
s_mov_b32 m0, 149504
s_nop 0
buffer_load_dwordx4 v26, s[16:19], s56 offen lds
s_add_u32 s56, s54, 4587520
s_mov_b32 m0, 150528
s_nop 0
buffer_load_dwordx4 v26, s[16:19], s56 offen lds
s_waitcnt vmcnt(24)
ds_read_b64_tr_b16 a[224:225], v29 offset:24576
ds_read_b64_tr_b16 a[226:227], v29 offset:24704
ds_read_b64_tr_b16 a[228:229], v29 offset:25088
ds_read_b64_tr_b16 a[230:231], v29 offset:25216
ds_read_b64_tr_b16 a[232:233], v29 offset:26624
ds_read_b64_tr_b16 a[234:235], v29 offset:26752
ds_read_b64_tr_b16 a[236:237], v29 offset:27136
ds_read_b64_tr_b16 a[238:239], v29 offset:27264
s_waitcnt lgkmcnt(0)
s_add_u32 s56, s55, 110784
s_mov_b32 m0, 151552
s_nop 0
buffer_load_dwordx4 v27, s[20:23], s56 offen lds
s_add_u32 s56, s55, 129216
s_mov_b32 m0, 152576
s_nop 0
buffer_load_dwordx4 v27, s[20:23], s56 offen lds
s_add_u32 s56, s55, 111040
s_mov_b32 m0, 153600
s_nop 0
buffer_load_dwordx4 v27, s[20:23], s56 offen lds
s_add_u32 s56, s55, 129472
s_mov_b32 m0, 154624
s_nop 0
buffer_load_dwordx4 v27, s[20:23], s56 offen lds
s_waitcnt vmcnt(24)
ds_read_b64_tr_b16 a[240:241], v29 offset:28672
ds_read_b64_tr_b16 a[242:243], v29 offset:28800
ds_read_b64_tr_b16 a[244:245], v29 offset:29184
ds_read_b64_tr_b16 a[246:247], v29 offset:29312
ds_read_b64_tr_b16 a[248:249], v29 offset:30720
ds_read_b64_tr_b16 a[250:251], v29 offset:30848
ds_read_b64_tr_b16 a[252:253], v29 offset:31232
ds_read_b64_tr_b16 a[254:255], v29 offset:31360
s_waitcnt lgkmcnt(0)
s_add_u32 s56, s55, 37056
s_mov_b32 m0, 155648
s_nop 0
buffer_load_dwordx4 v27, s[20:23], s56 offen lds
s_add_u32 s56, s55, 55488
s_mov_b32 m0, 156672
s_nop 0
buffer_load_dwordx4 v27, s[20:23], s56 offen lds
s_add_u32 s56, s55, 37312
s_mov_b32 m0, 157696
s_nop 0
buffer_load_dwordx4 v27, s[20:23], s56 offen lds
s_add_u32 s56, s55, 55744
s_mov_b32 m0, 158720
s_nop 0
buffer_load_dwordx4 v27, s[20:23], s56 offen lds
s_waitcnt vmcnt(24)
ds_read_b64_tr_b16 v[44:45], v28 offset:0
ds_read_b64_tr_b16 v[46:47], v28 offset:256
ds_read_b64_tr_b16 v[48:49], v28 offset:2048
ds_read_b64_tr_b16 v[50:51], v28 offset:2304
ds_read_b64_tr_b16 v[52:53], v28 offset:32
ds_read_b64_tr_b16 v[54:55], v28 offset:288
ds_read_b64_tr_b16 v[56:57], v28 offset:2080
ds_read_b64_tr_b16 v[58:59], v28 offset:2336
s_waitcnt lgkmcnt(0)
ds_write_b128 v2, v[44:47] offset:0
ds_write_b128 v2, v[48:51] offset:1024
ds_write_b128 v2, v[52:55] offset:2048
ds_write_b128 v2, v[56:59] offset:3072
s_waitcnt lgkmcnt(0)
s_add_u32 s56, s55, 111552
s_mov_b32 m0, 159744
s_nop 0
buffer_load_dwordx4 v27, s[20:23], s56 offen lds
s_add_u32 s56, s55, 129984
s_mov_b32 m0, 160768
s_nop 0
buffer_load_dwordx4 v27, s[20:23], s56 offen lds
s_add_u32 s56, s55, 37824
s_mov_b32 m0, 161792
s_nop 0
buffer_load_dwordx4 v27, s[20:23], s56 offen lds
s_add_u32 s56, s55, 56256
s_mov_b32 m0, 162816
s_nop 0
buffer_load_dwordx4 v27, s[20:23], s56 offen lds
s_waitcnt vmcnt(24)
ds_read_b64_tr_b16 v[44:45], v28 offset:4096
ds_read_b64_tr_b16 v[46:47], v28 offset:4352
ds_read_b64_tr_b16 v[48:49], v28 offset:6144
ds_read_b64_tr_b16 v[50:51], v28 offset:6400
ds_read_b64_tr_b16 v[52:53], v28 offset:4128
ds_read_b64_tr_b16 v[54:55], v28 offset:4384
ds_read_b64_tr_b16 v[56:57], v28 offset:6176
ds_read_b64_tr_b16 v[58:59], v28 offset:6432
s_waitcnt lgkmcnt(0)
ds_write_b128 v2, v[44:47] offset:4096
ds_write_b128 v2, v[48:51] offset:5120
ds_write_b128 v2, v[52:55] offset:6144
ds_write_b128 v2, v[56:59] offset:7168
s_waitcnt lgkmcnt(0)
s_waitcnt vmcnt(20)
ds_read_b64_tr_b16 v[44:45], v28 offset:8192
ds_read_b64_tr_b16 v[46:47], v28 offset:8448
ds_read_b64_tr_b16 v[48:49], v28 offset:10240
ds_read_b64_tr_b16 v[50:51], v28 offset:10496
ds_read_b64_tr_b16 v[52:53], v28 offset:8224
ds_read_b64_tr_b16 v[54:55], v28 offset:8480
ds_read_b64_tr_b16 v[56:57], v28 offset:10272
ds_read_b64_tr_b16 v[58:59], v28 offset:10528
s_waitcnt lgkmcnt(0)
ds_write_b128 v2, v[44:47] offset:8192
ds_write_b128 v2, v[48:51] offset:9216
ds_write_b128 v2, v[52:55] offset:10240
ds_write_b128 v2, v[56:59] offset:11264
s_waitcnt lgkmcnt(0)
s_waitcnt vmcnt(16)
ds_read_b64_tr_b16 v[44:45], v28 offset:12288
ds_read_b64_tr_b16 v[46:47], v28 offset:12544
ds_read_b64_tr_b16 v[48:49], v28 offset:14336
ds_read_b64_tr_b16 v[50:51], v28 offset:14592
ds_read_b64_tr_b16 v[52:53], v28 offset:12320
ds_read_b64_tr_b16 v[54:55], v28 offset:12576
ds_read_b64_tr_b16 v[56:57], v28 offset:14368
ds_read_b64_tr_b16 v[58:59], v28 offset:14624
s_waitcnt lgkmcnt(0)
ds_write_b128 v2, v[44:47] offset:12288
ds_write_b128 v2, v[48:51] offset:13312
ds_write_b128 v2, v[52:55] offset:14336
ds_write_b128 v2, v[56:59] offset:15360
s_waitcnt lgkmcnt(0)
s_waitcnt vmcnt(12)
ds_read_b64_tr_b16 v[44:45], v28 offset:16384
ds_read_b64_tr_b16 v[46:47], v28 offset:16640
ds_read_b64_tr_b16 v[48:49], v28 offset:18432
ds_read_b64_tr_b16 v[50:51], v28 offset:18688
ds_read_b64_tr_b16 v[52:53], v28 offset:16416
ds_read_b64_tr_b16 v[54:55], v28 offset:16672
ds_read_b64_tr_b16 v[56:57], v28 offset:18464
ds_read_b64_tr_b16 v[58:59], v28 offset:18720
s_waitcnt lgkmcnt(0)
ds_write_b128 v2, v[44:47] offset:16384
ds_write_b128 v2, v[48:51] offset:17408
ds_write_b128 v2, v[52:55] offset:18432
ds_write_b128 v2, v[56:59] offset:19456
s_waitcnt lgkmcnt(0)
s_waitcnt vmcnt(8)
ds_read_b64_tr_b16 v[44:45], v29 offset:20480
ds_read_b64_tr_b16 v[46:47], v29 offset:20608
ds_read_b64_tr_b16 v[48:49], v29 offset:20992
ds_read_b64_tr_b16 v[50:51], v29 offset:21120
ds_read_b64_tr_b16 v[52:53], v29 offset:22528
ds_read_b64_tr_b16 v[54:55], v29 offset:22656
ds_read_b64_tr_b16 v[56:57], v29 offset:23040
ds_read_b64_tr_b16 v[58:59], v29 offset:23168
s_waitcnt lgkmcnt(0)
ds_write_b128 v2, v[44:47] offset:20480
ds_write_b128 v2, v[48:51] offset:21504
ds_write_b128 v2, v[52:55] offset:22528
ds_write_b128 v2, v[56:59] offset:23552
s_waitcnt lgkmcnt(0)
s_waitcnt vmcnt(4)
ds_read_b64_tr_b16 v[44:45], v29 offset:24576
ds_read_b64_tr_b16 v[46:47], v29 offset:24704
ds_read_b64_tr_b16 v[48:49], v29 offset:25088
ds_read_b64_tr_b16 v[50:51], v29 offset:25216
ds_read_b64_tr_b16 v[52:53], v29 offset:26624
ds_read_b64_tr_b16 v[54:55], v29 offset:26752
ds_read_b64_tr_b16 v[56:57], v29 offset:27136
ds_read_b64_tr_b16 v[58:59], v29 offset:27264
s_waitcnt lgkmcnt(0)
ds_write_b128 v2, v[44:47] offset:24576
ds_write_b128 v2, v[48:51] offset:25600
ds_write_b128 v2, v[52:55] offset:26624
ds_write_b128 v2, v[56:59] offset:27648
s_waitcnt lgkmcnt(0)
s_waitcnt vmcnt(0)
ds_read_b64_tr_b16 v[44:45], v29 offset:28672
ds_read_b64_tr_b16 v[46:47], v29 offset:28800
ds_read_b64_tr_b16 v[48:49], v29 offset:29184
ds_read_b64_tr_b16 v[50:51], v29 offset:29312
ds_read_b64_tr_b16 v[52:53], v29 offset:30720
ds_read_b64_tr_b16 v[54:55], v29 offset:30848
ds_read_b64_tr_b16 v[56:57], v29 offset:31232
ds_read_b64_tr_b16 v[58:59], v29 offset:31360
s_waitcnt lgkmcnt(0)
ds_write_b128 v2, v[44:47] offset:28672
ds_write_b128 v2, v[48:51] offset:29696
ds_write_b128 v2, v[52:55] offset:30720
ds_write_b128 v2, v[56:59] offset:31744
s_waitcnt lgkmcnt(0)
v_mov_b32 v24, 0
L_rdv_w3r:
buffer_load_dword v23, v24, s[28:31], 0 offen sc0 sc1
s_sub_u32 s41, s41, 1
s_cbranch_scc1 L_exit
s_waitcnt vmcnt(0)
v_readfirstlane_b32 s56, v23
s_nop 0
s_and_b32 s57, s56, 0xff
s_cmp_lg_u32 s57, 32
s_cbranch_scc1 L_rdv_w3r
s_lshl_b32 s101, s32, 7
s_add_u32 s101, s101, 327680
s_barrier
s_mov_b32 m0, 0
s_lshl_b32 s57, s58, 5
s_mov_b32 s0, 0x3f003f00
s_mov_b32 s1, 0x3f003f00
s_mov_b32 s58, 304128
s_cmp_eq_u32 s56, s57
s_cbranch_scc0 L_slow_w3r
buffer_load_dwordx4 v[12:15], v9, s[4:7], s37 offen offset:0
buffer_load_dwordx4 v[16:19], v9, s[4:7], s37 offen offset:1024
buffer_load_dwordx4 v[52:55], v1, s[4:7], s37 offen offset:2048
buffer_load_dwordx4 v[56:59], v1, s[4:7], s37 offen offset:3072
v_mov_b64 v[20:21], 0
v_mov_b64 v[22:23], 0
v_mov_b64 v[24:25], 0
v_mov_b64 v[26:27], 0
v_mov_b64 v[28:29], 0
v_mov_b64 v[30:31], 0
v_mov_b64 v[32:33], 0
v_mov_b64 v[34:35], 0
v_mov_b64 v[36:37], 0
v_mov_b64 v[38:39], 0
v_mov_b64 v[40:41], 0
v_mov_b64 v[42:43], 0
ds_read_b128 v[44:47], v2 offset:0
ds_read_b128 v[48:51], v2 offset:1024
v_bfe_u32 v77, v1, 6, 1
v_lshl_add_u32 v77, v77, 3, v1
v_lshlrev_b32 v77, 1, v77
s_mov_b32 s38, 1
s_mov_b32 m0, 1024
s_nop 0
buffer_load_dwordx4 v1, s[4:7], s47 offen offset:0 sc1 lds
buffer_load_dwordx4 v1, s[4:7], s47 offen offset:1024 sc1 lds
buffer_load_dwordx4 v1, s[4:7], s47 offen offset:2048 sc1 lds
buffer_load_dwordx4 v1, s[4:7], s47 offen offset:3072 sc1 lds
s_mov_b32 m0, 5120
s_nop 0
buffer_load_dwordx4 v1, s[4:7], s48 offen offset:0 sc1 lds
buffer_load_dwordx4 v1, s[4:7], s48 offen offset:1024 sc1 lds
buffer_load_dwordx4 v1, s[4:7], s48 offen offset:2048 sc1 lds
buffer_load_dwordx4 v1, s[4:7], s48 offen offset:3072 sc1 lds
s_mov_b32 m0, 9216
s_nop 0
buffer_load_dwordx4 v1, s[4:7], s49 offen offset:0 sc1 lds
s_waitcnt vmcnt(0) lgkmcnt(0)
s_branch L_top_w3rf
.p2align 6
L_ex_w3rf:
v_and_b32 v6, 0x70, v1
ds_read_b128 v[76:79], v6 offset:256
s_add_u32 s34, s34, 1
s_add_u32 s37, s37, 524288
s_add_u32 s39, s39, 524288
s_mul_i32 s40, s34, 10240
s_add_u32 s40, s40, 8093696
s_not_b32 s35, s35
s_not_b32 s36, s36
ds_read_b128 v[44:47], v2 offset:0
ds_read_b128 v[48:51], v2 offset:1024
s_barrier
s_waitcnt vmcnt(0)
v_mov_b64 v[20:21], 0
v_mov_b64 v[22:23], 0
v_mov_b64 v[24:25], 0
v_mov_b64 v[26:27], 0
v_mov_b64 v[28:29], 0
v_mov_b64 v[30:31], 0
v_mov_b64 v[32:33], 0
v_mov_b64 v[34:35], 0
v_mov_b64 v[36:37], 0
v_mov_b64 v[38:39], 0
v_mov_b64 v[40:41], 0
v_mov_b64 v[42:43], 0
buffer_load_dwordx4 v[60:63], v9, s[4:7], s3 offen offset:0 sc1
buffer_load_dwordx4 v[64:67], v9, s[4:7], s3 offen offset:1024 sc1
buffer_load_dwordx4 v[68:71], v9, s[4:7], s3 offen offset:2048 sc1
buffer_load_dwordx4 v[72:75], v9, s[4:7], s3 offen offset:3072 sc1
s_waitcnt lgkmcnt(2)
s_waitcnt vmcnt(3)
L_r_w3rf:
v_mfma_f32_16x16x32_bf16 v[52:55], v[60:63], v[76:79], 0
s_waitcnt vmcnt(2)
v_mfma_f32_16x16x32_bf16 v[52:55], v[64:67], v[76:79], v[52:55]
v_bitop3_b32 v56, v60, v64, s36 bitop3:0x7e
s_waitcnt vmcnt(1)
v_mfma_f32_16x16x32_bf16 v[52:55], v[68:71], v[76:79], v[52:55]
s_waitcnt vmcnt(0)
v_mfma_f32_16x16x32_bf16 v[52:55], v[72:75], v[76:79], v[52:55]
v_bitop3_b32 v57, v68, v72, s36 bitop3:0x7e
v_bitop3_b32 v56, v56, v57, 1 bitop3:0xa8
v_cmp_ne_u32 vcc, 0, v56
s_cmp_eq_u32 s34, 63
s_nop 3
v_pk_add_f32 v[52:53], v[52:53], v[54:55]
v_cvt_pk_bf16_f32 v56, v52, v53
v_bfi_b32 v56, v11, s35, v56
s_cbranch_vccnz L_rr_w3rf
buffer_store_dword v56, v10, s[4:7], 0 offen
v_mov_b32 v79, v56
s_cbranch_scc1 L_done_w3rf
v_bfe_u32 v77, v1, 6, 1
v_lshl_add_u32 v77, v77, 3, v1
v_lshlrev_b32 v77, 1, v77
L_top_w3rf:
s_barrier
ds_read_b128 v[60:63], v1 offset:1024
ds_read_b128 v[64:67], v1 offset:2048
s_mov_b32 m0, 5120
s_nop 0
buffer_load_dwordx4 v1, s[4:7], s48 offen offset:3072 sc1 lds
s_barrier
ds_read_b128 v[68:71], v1 offset:3072
ds_read_b128 v[72:75], v1 offset:4096
L_s0_w3rf:
s_waitcnt lgkmcnt(3)
v_smfmac_f32_16x16x64_bf16 v[28:31], v[60:63], v[176:183], v0
v_smfmac_f32_16x16x64_bf16 v[32:35], v[60:63], v[184:191], v0
v_smfmac_f32_16x16x64_bf16 v[36:39], v[60:63], a[48:55], v0
v_smfmac_f32_16x16x64_bf16 v[40:43], v[60:63], a[56:63], v0
s_waitcnt lgkmcnt(2)
v_smfmac_f32_16x16x64_bf16 v[20:23], v[64:67], v[80:87], v0
v_smfmac_f32_16x16x64_bf16 v[20:23], v[60:63], v[44:51], v0
ds_read_b128 v[44:47], v2 offset:2048
v_smfmac_f32_16x16x64_bf16 v[24:27], v[64:67], v[88:95], v0
ds_read_b128 v[48:51], v2 offset:3072
v_smfmac_f32_16x16x64_bf16 v[28:31], v[64:67], v[192:199], v0
s_waitcnt lgkmcnt(2)
v_bitop3_b32 v6, v60, v64, s35 bitop3:0x7e
v_smfmac_f32_16x16x64_bf16 v[32:35], v[64:67], v[200:207], v0
v_bitop3_b32 v76, v68, v72, s35 bitop3:0x7e
v_smfmac_f32_16x16x64_bf16 v[36:39], v[64:67], a[64:71], v0
v_bitop3_b32 v6, v6, v76, 1 bitop3:0xa8
s_waitcnt lgkmcnt(0)
v_smfmac_f32_16x16x64_bf16 v[24:27], v[60:63], v[44:51], v0
ds_read_b128 v[44:47], v2 offset:4096
v_cmp_ne_u32 vcc, 0, v6
buffer_load_dwordx4 v[12:15], v9, s[4:7], s37 offen offset:0
buffer_load_dwordx4 v[16:19], v9, s[4:7], s37 offen offset:1024
buffer_load_dwordx4 v[52:55], v1, s[4:7], s37 offen offset:2048
buffer_load_dwordx4 v[56:59], v1, s[4:7], s37 offen offset:3072
v_smfmac_f32_16x16x64_bf16 v[40:43], v[64:67], a[72:79], v0
ds_read_b128 v[48:51], v2 offset:5120
v_smfmac_f32_16x16x64_bf16 v[20:23], v[68:71], v[96:103], v0
s_cbranch_vccnz L_ra0_w3rf
v_smfmac_f32_16x16x64_bf16 v[24:27], v[68:71], v[104:111], v0
s_waitcnt vmcnt(4)
s_barrier
ds_read_b32 v6, v77 offset:8192
buffer_store_dword v79, v10, s[4:7], s40 offen sc0 sc1
v_smfmac_f32_16x16x64_bf16 v[28:31], v[68:71], v[208:215], v0
ds_read_b128 v[60:63], v1 offset:6144
s_waitcnt lgkmcnt(2)
v_smfmac_f32_16x16x64_bf16 v[20:23], v[72:75], v[44:51], v0
ds_read_b128 v[64:67], v1 offset:7168
v_smfmac_f32_16x16x64_bf16 v[32:35], v[68:71], v[216:223], v0
ds_read_b128 v[76:79], v1 offset:5120
v_smfmac_f32_16x16x64_bf16 v[36:39], v[68:71], a[80:87], v0
ds_read_b128 v[44:47], v2 offset:6144
v_smfmac_f32_16x16x64_bf16 v[40:43], v[68:71], a[88:95], v0
ds_read_b128 v[48:51], v2 offset:7168
s_waitcnt lgkmcnt(4)
v_bitop3_b32 v6, v6, v60, s35 bitop3:0x7e
v_smfmac_f32_16x16x64_bf16 v[28:31], v[72:75], v[224:231], v0
ds_read_b128 v[68:71], v1 offset:8192
s_waitcnt lgkmcnt(4)
v_bitop3_b32 v6, v6, v64, s35 bitop3:0xf6
v_smfmac_f32_16x16x64_bf16 v[32:35], v[72:75], v[232:239], v0
s_waitcnt lgkmcnt(3)
v_bitop3_b32 v6, v6, v76, s35 bitop3:0xf6
v_and_b32 v6, 1, v6
v_smfmac_f32_16x16x64_bf16 v[36:39], v[72:75], a[96:103], v0
v_cmp_ne_u32 vcc, 0, v6
s_waitcnt lgkmcnt(1)
v_smfmac_f32_16x16x64_bf16 v[24:27], v[72:75], v[44:51], v0
ds_read_b128 v[44:47], v2 offset:8192
v_lshlrev_b32 v6, 2, v1
v_smfmac_f32_16x16x64_bf16 v[40:43], v[72:75], a[104:111], v0
ds_read_b128 v[72:75], v1 offset:9216
s_cbranch_vccnz L_ra1_w3rf
L_a1_w3rf:
v_smfmac_f32_16x16x64_bf16 v[20:23], v[60:63], v[112:119], v0
ds_read_b128 v[48:51], v2 offset:9216
v_smfmac_f32_16x16x64_bf16 v[20:23], v[64:67], v[128:135], v0
s_waitcnt lgkmcnt(3)
v_smfmac_f32_16x16x64_bf16 v[20:23], v[68:71], v[144:151], v0
s_waitcnt lgkmcnt(1)
v_smfmac_f32_16x16x64_bf16 v[20:23], v[72:75], v[160:167], v0
s_waitcnt lgkmcnt(0)
v_smfmac_f32_16x16x64_bf16 v[20:23], v[76:79], v[44:51], v0
ds_read_b128 v[44:47], v2 offset:10240
v_smfmac_f32_16x16x64_bf16 v[24:27], v[60:63], v[120:127], v0
ds_read_b128 v[48:51], v2 offset:11264
v_smfmac_f32_16x16x64_bf16 v[24:27], v[64:67], v[136:143], v0
v_add_f32 v20, v20, v22
v_smfmac_f32_16x16x64_bf16 v[24:27], v[68:71], v[152:159], v0
v_add_f32 v21, v21, v23
v_smfmac_f32_16x16x64_bf16 v[24:27], v[72:75], v[168:175], v0
v_cvt_pk_bf16_f32 v22, v20, v21
s_waitcnt lgkmcnt(0)
v_smfmac_f32_16x16x64_bf16 v[24:27], v[76:79], v[44:51], v0
ds_read_b128 v[44:47], v2 offset:12288
v_smfmac_f32_16x16x64_bf16 v[28:31], v[76:79], v[240:247], v0
ds_read_b128 v[48:51], v2 offset:13312
v_smfmac_f32_16x16x64_bf16 v[28:31], v[64:67], a[0:7], v0
v_add_f32 v24, v24, v26
v_add_f32 v25, v25, v27
v_cvt_pk_bf16_f32 v23, v24, v25
v_smfmac_f32_16x16x64_bf16 v[28:31], v[68:71], a[16:23], v0
ds_write_b64 v3, v[22:23] offset:11776
v_smfmac_f32_16x16x64_bf16 v[28:31], v[72:75], a[32:39], v0
s_mov_b32 m0, 0
s_nop 0
buffer_load_dword v6, s[4:7], s39 offen lds
s_waitcnt lgkmcnt(1)
v_smfmac_f32_16x16x64_bf16 v[28:31], v[60:63], v[44:51], v0
ds_read_b128 v[44:47], v2 offset:14336
v_smfmac_f32_16x16x64_bf16 v[32:35], v[76:79], v[248:255], v0
ds_read_b128 v[48:51], v2 offset:15360
s_waitcnt lgkmcnt(2)
s_barrier
v_smfmac_f32_16x16x64_bf16 v[32:35], v[64:67], a[8:15], v0
ds_read_b64_tr_b16 v[20:21], v4 offset:10240
ds_read_b64_tr_b16 v[22:23], v4 offset:10752
v_add_f32 v28, v28, v30
v_smfmac_f32_16x16x64_bf16 v[32:35], v[68:71], a[24:31], v0
ds_read_b64_tr_b16 v[24:25], v4 offset:11264
v_add_f32 v29, v29, v31
v_smfmac_f32_16x16x64_bf16 v[32:35], v[72:75], a[40:47], v0
ds_read_b64_tr_b16 v[26:27], v4 offset:11776
v_cvt_pk_bf16_f32 v30, v28, v29
s_waitcnt lgkmcnt(4)
v_smfmac_f32_16x16x64_bf16 v[32:35], v[60:63], v[44:51], v0
ds_read_b128 v[44:47], v2 offset:18432
s_waitcnt vmcnt(4)
s_waitcnt lgkmcnt(3)
v_mfma_f32_16x16x32_bf16 v[12:15], v[12:15], v[20:23], 0
ds_read_b128 v[48:51], v2 offset:19456
s_waitcnt lgkmcnt(2)
v_mfma_f32_16x16x32_bf16 v[12:15], v[16:19], v[24:27], v[12:15]
v_add_f32 v32, v32, v34
v_add_f32 v33, v33, v35
v_cvt_pk_bf16_f32 v31, v32, v33
ds_write_b64 v3, v[30:31] offset:13824
v_smfmac_f32_16x16x64_bf16 v[36:39], v[76:79], a[112:119], v0
s_nop 2
v_add_f32_dpp v12, v14, v12 quad_perm:[2,3,0,1] row_mask:0xf bank_mask:0xf
v_add_f32_dpp v13, v15, v13 quad_perm:[2,3,0,1] row_mask:0xf bank_mask:0xf
ds_write_b64 v5, v[12:13] offset:15104
v_smfmac_f32_16x16x64_bf16 v[40:43], v[76:79], a[120:127], v0
s_waitcnt lgkmcnt(1)
s_barrier
ds_read_b64_tr_b16 v[28:29], v4 offset:12288
v_smfmac_f32_16x16x64_bf16 v[36:39], v[60:63], a[128:135], v0
ds_read_b64_tr_b16 v[30:31], v4 offset:12800
ds_read_b64_tr_b16 v[32:33], v4 offset:13312
v_smfmac_f32_16x16x64_bf16 v[40:43], v[60:63], a[136:143], v0
ds_read_b64_tr_b16 v[34:35], v4 offset:13824
v_mov_b64 v[76:77], s[52:53]
s_waitcnt lgkmcnt(4)
s_barrier
ds_read_b128 v[12:15], v1 offset:14336
v_smfmac_f32_16x16x64_bf16 v[40:43], v[72:75], v[44:51], v0
ds_read_b128 v[44:47], v2 offset:16384
v_mov_b64 v[78:79], s[52:53]
s_waitcnt lgkmcnt(4)
v_mfma_f32_16x16x32_bf16 v[28:31], v[28:31], v[20:23], 0
ds_read_b128 v[48:51], v2 offset:17408
s_waitcnt lgkmcnt(3)
v_mfma_f32_16x16x32_bf16 v[28:31], v[32:35], v[24:27], v[28:31]
v_smfmac_f32_16x16x64_bf16 v[40:43], v[64:67], a[152:159], v0
s_waitcnt lgkmcnt(2)
v_max3_f32 v17, v12, v13, v14
v_smfmac_f32_16x16x64_bf16 v[36:39], v[64:67], a[144:151], v0
ds_read_b128 v[60:63], v2 offset:22528
v_add_f32_dpp v28, v30, v28 quad_perm:[2,3,0,1] row_mask:0xf bank_mask:0xf
v_add_f32_dpp v29, v31, v29 quad_perm:[2,3,0,1] row_mask:0xf bank_mask:0xf
v_max_f32 v17, v17, v15
v_max_f32 v16, v28, v29
v_mul_f32 v16, s50, v16
v_max_f32_dpp v17, v17, v17 quad_perm:[2,3,0,1] row_mask:0xf bank_mask:0xf
v_smfmac_f32_16x16x64_bf16 v[40:43], v[68:71], a[168:175], v0
ds_read_b128 v[64:67], v2 offset:23552
v_max_f32_dpp v18, v16, v17 quad_perm:[0,1,0,1] row_mask:0xf bank_mask:0xf
v_max_f32_dpp v19, v16, v17 quad_perm:[0,1,0,1] row_mask:0xf bank_mask:0xf
v_smfmac_f32_16x16x64_bf16 v[36:39], v[68:71], a[160:167], v0
ds_read_b128 v[68:71], v2 offset:24576
v_permlane16_swap_b32 v18, v19
v_max_f32 v20, v18, v19
v_max_f32 v21, v18, v19
s_waitcnt lgkmcnt(3)
v_smfmac_f32_16x16x64_bf16 v[36:39], v[72:75], v[44:51], v0
ds_read_b128 v[72:75], v2 offset:25600
v_permlane32_swap_b32 v20, v21
v_max_f32 v20, v20, v21
v_sub_f32 v12, v12, v20
v_sub_f32 v13, v13, v20
v_pk_add_f32 v[14:15], v[14:15], v[20:21] op_sel_hi:[1,0] neg_lo:[0,1] neg_hi:[0,1]
v_exp_f32 v12, v12
v_exp_f32 v13, v13
v_exp_f32 v14, v14
v_exp_f32 v15, v15
v_cvt_pk_bf16_f32 v16, v12, v13
v_cvt_pk_bf16_f32 v17, v14, v15
v_pk_fma_f32 v[28:29], v[28:29], s[50:51], v[20:21] op_sel_hi:[1,1,0] neg_lo:[0,0,1] neg_hi:[0,0,1]
v_mov_b32_dpp v18, v16 quad_perm:[2,3,0,1] row_mask:0xf bank_mask:0xf
v_mov_b32_dpp v19, v17 quad_perm:[2,3,0,1] row_mask:0xf bank_mask:0xf
v_exp_f32 v28, v28
s_waitcnt vmcnt(2)
v_mfma_f32_16x16x32_bf16 v[32:35], v[76:79], v[16:19], 0
v_exp_f32 v29, v29
v_mfma_f32_16x16x32_bf16 v[20:23], v[52:55], v[16:19], 0
v_cvt_pk_bf16_f32 v12, v28, v29
v_cvt_pk_bf16_f32 v13, v28, v29
v_mov_b64 v[14:15], s[0:1]
v_mfma_f32_16x16x32_bf16 v[24:27], v[56:59], v[16:19], 0
v_cvt_pk_bf16_f32 v36, v36, v37
v_cvt_pk_bf16_f32 v37, v38, v39
v_mfma_f32_16x16x16_bf16 v[32:35], v[14:15], v[12:13], v[32:35]
v_cvt_pk_bf16_f32 v38, v40, v41
v_cvt_pk_bf16_f32 v39, v42, v43
v_mfma_f32_16x16x16_bf16 v[20:23], v[36:37], v[12:13], v[20:23]
ds_read_b128 v[44:47], v2 offset:20480
v_mfma_f32_16x16x16_bf16 v[24:27], v[38:39], v[12:13], v[24:27]
ds_read_b128 v[48:51], v2 offset:21504
v_rcp_f32 v32, v32
v_mov_b64 v[28:29], 0
v_mov_b64 v[30:31], 0
v_pk_mul_f32 v[20:21], v[20:21], v[32:33] op_sel_hi:[1,0]
v_pk_mul_f32 v[22:23], v[22:23], v[32:33] op_sel_hi:[1,0]
v_cvt_pk_bf16_f32 v20, v20, v21
v_cvt_pk_bf16_f32 v21, v22, v23
ds_write_b64 v1, v[20:21] offset:8192
v_pk_mul_f32 v[24:25], v[24:25], v[32:33] op_sel_hi:[1,0]
v_pk_mul_f32 v[26:27], v[26:27], v[32:33] op_sel_hi:[1,0]
v_cvt_pk_bf16_f32 v24, v24, v25
v_cvt_pk_bf16_f32 v25, v26, v27
ds_write_b64 v1, v[24:25] offset:8200
v_mov_b64 v[76:77], 0
ds_read_b128 v[12:15], v7 offset:8192
v_mov_b64 v[78:79], 0
v_mov_b64 v[40:41], 0
v_mov_b64 v[42:43], 0
v_mov_b64 v[36:37], 0
v_mov_b64 v[38:39], 0
v_mov_b64 v[32:33], 0
v_mov_b64 v[34:35], 0
s_waitcnt lgkmcnt(1)
s_barrier
ds_read_b128 v[16:19], v7 offset:5120
ds_read_b128 v[52:55], v7 offset:6144
ds_read_b128 v[56:59], v7 offset:7168
s_waitcnt lgkmcnt(3)
v_smfmac_f32_16x16x64_bf16 v[28:31], v[12:15], v[44:51], v0 abid:1
v_smfmac_f32_16x16x64_bf16 v[76:79], v[12:15], v[60:67], v0 abid:1
ds_read_b128 v[44:47], v2 offset:26624
s_waitcnt lgkmcnt(3)
v_smfmac_f32_16x16x64_bf16 v[28:31], v[16:19], a[176:183], v0 abid:1
ds_read_b128 v[48:51], v2 offset:27648
s_waitcnt lgkmcnt(3)
v_smfmac_f32_16x16x64_bf16 v[28:31], v[52:55], v[68:75], v0 abid:1
ds_read_b128 v[60:63], v2 offset:28672
s_waitcnt lgkmcnt(3)
v_smfmac_f32_16x16x64_bf16 v[28:31], v[56:59], a[184:191], v0 abid:1
ds_read_b128 v[64:67], v2 offset:29696
v_smfmac_f32_16x16x64_bf16 v[76:79], v[16:19], a[192:199], v0 abid:1
ds_read_b128 v[68:71], v2 offset:30720
s_waitcnt lgkmcnt(3)
v_smfmac_f32_16x16x64_bf16 v[76:79], v[52:55], v[44:51], v0 abid:1
ds_read_b128 v[72:75], v2 offset:31744
v_cvt_pk_bf16_f32 v28, v28, v29
v_cvt_pk_bf16_f32 v29, v30, v31
v_bfi_b32 v28, 1, s35, v28
buffer_store_dwordx2 v[28:29], v8, s[4:7], s42 offen
v_smfmac_f32_16x16x64_bf16 v[76:79], v[56:59], a[200:207], v0 abid:1
v_smfmac_f32_16x16x64_bf16 v[40:43], v[12:15], a[208:215], v0 abid:1
v_smfmac_f32_16x16x64_bf16 v[40:43], v[16:19], a[216:223], v0 abid:1
v_cvt_pk_bf16_f32 v76, v76, v77
v_cvt_pk_bf16_f32 v77, v78, v79
v_bfi_b32 v76, 1, s35, v76
buffer_store_dwordx2 v[76:77], v8, s[4:7], s43 offen
v_smfmac_f32_16x16x64_bf16 v[40:43], v[52:55], a[224:231], v0 abid:1
v_smfmac_f32_16x16x64_bf16 v[40:43], v[56:59], a[232:239], v0 abid:1
s_waitcnt lgkmcnt(2)
v_smfmac_f32_16x16x64_bf16 v[36:39], v[12:15], v[60:67], v0 abid:1
v_smfmac_f32_16x16x64_bf16 v[36:39], v[16:19], a[240:247], v0 abid:1
v_cvt_pk_bf16_f32 v40, v40, v41
s_waitcnt lgkmcnt(0)
v_smfmac_f32_16x16x64_bf16 v[36:39], v[52:55], v[68:75], v0 abid:1
v_cvt_pk_bf16_f32 v41, v42, v43
v_smfmac_f32_16x16x64_bf16 v[36:39], v[56:59], a[248:255], v0 abid:1
v_bfi_b32 v40, 1, s35, v40
buffer_store_dwordx2 v[40:41], v8, s[4:7], s44 offen
s_nop 5
v_cvt_pk_bf16_f32 v36, v36, v37
v_cvt_pk_bf16_f32 v37, v38, v39
v_bfi_b32 v36, 1, s35, v36
buffer_store_dwordx2 v[36:37], v8, s[4:7], s45 offen
s_branch L_ex_w3rf
L_done_w3rf:
buffer_store_dword v79, v10, s[4:7], s40 offen sc0 sc1
s_waitcnt vmcnt(0) lgkmcnt(0)
s_endpgm
L_ra0_w3rf:
s_mov_b32 s38, 1
s_mov_b32 m0, 1024
s_nop 0
buffer_load_dwordx4 v1, s[4:7], s47 offen offset:0 sc1 lds
buffer_load_dwordx4 v1, s[4:7], s47 offen offset:1024 sc1 lds
buffer_load_dwordx4 v1, s[4:7], s47 offen offset:2048 sc1 lds
buffer_load_dwordx4 v1, s[4:7], s47 offen offset:3072 sc1 lds
s_sub_u32 s41, s41, 1
s_cbranch_scc1 L_exit
ds_read_b128 v[44:47], v2 offset:0
ds_read_b128 v[48:51], v2 offset:1024
v_mov_b64 v[20:21], 0
v_mov_b64 v[22:23], 0
v_mov_b64 v[24:25], 0
v_mov_b64 v[26:27], 0
v_mov_b64 v[28:29], 0
v_mov_b64 v[30:31], 0
v_mov_b64 v[32:33], 0
v_mov_b64 v[34:35], 0
v_mov_b64 v[36:37], 0
v_mov_b64 v[38:39], 0
v_mov_b64 v[40:41], 0
v_mov_b64 v[42:43], 0
s_waitcnt vmcnt(0)
ds_read_b128 v[60:63], v1 offset:1024
ds_read_b128 v[64:67], v1 offset:2048
ds_read_b128 v[68:71], v1 offset:3072
ds_read_b128 v[72:75], v1 offset:4096
s_branch L_s0_w3rf
L_ra1_w3rf:
s_mov_b32 s38, 1
s_waitcnt lgkmcnt(0)
s_barrier
s_mov_b32 m0, 5120
s_nop 0
buffer_load_dwordx4 v1, s[4:7], s48 offen offset:3072 sc1 lds
s_sub_u32 s41, s41, 1
s_cbranch_scc1 L_exit
s_waitcnt vmcnt(0)
s_barrier
ds_read_b128 v[76:79], v1 offset:5120
ds_read_b128 v[60:63], v1 offset:6144
ds_read_b128 v[64:67], v1 offset:7168
ds_read_b128 v[68:71], v1 offset:8192
ds_read_b128 v[72:75], v1 offset:9216
s_waitcnt lgkmcnt(0)
v_bitop3_b32 v6, v76, v60, s35 bitop3:0x7e
v_bitop3_b32 v6, v6, v64, s35 bitop3:0xf6
v_bitop3_b32 v6, v6, v68, s35 bitop3:0xf6
v_bitop3_b32 v6, v6, v72, s35 bitop3:0xf6
v_and_b32 v6, 1, v6
v_cmp_ne_u32 vcc, 0, v6
v_lshlrev_b32 v6, 2, v1
s_cbranch_vccnz L_ra1_w3rf
s_branch L_a1_w3rf
L_rr_w3rf:
buffer_load_dwordx4 v[60:63], v9, s[4:7], s3 offen offset:0 sc1
buffer_load_dwordx4 v[64:67], v9, s[4:7], s3 offen offset:1024 sc1
buffer_load_dwordx4 v[68:71], v9, s[4:7], s3 offen offset:2048 sc1
buffer_load_dwordx4 v[72:75], v9, s[4:7], s3 offen offset:3072 sc1
s_sub_u32 s41, s41, 1
s_cbranch_scc1 L_exit
s_waitcnt vmcnt(0)
s_branch L_r_w3rf
L_slow_w3r:
buffer_load_dwordx4 v[12:15], v9, s[4:7], s37 offen offset:0
buffer_load_dwordx4 v[16:19], v9, s[4:7], s37 offen offset:1024
buffer_load_dwordx4 v[52:55], v1, s[4:7], s37 offen offset:2048
buffer_load_dwordx4 v[56:59], v1, s[4:7], s37 offen offset:3072
v_mov_b64 v[20:21], 0
v_mov_b64 v[22:23], 0
v_mov_b64 v[24:25], 0
v_mov_b64 v[26:27], 0
v_mov_b64 v[28:29], 0
v_mov_b64 v[30:31], 0
v_mov_b64 v[32:33], 0
v_mov_b64 v[34:35], 0
v_mov_b64 v[36:37], 0
v_mov_b64 v[38:39], 0
v_mov_b64 v[40:41], 0
v_mov_b64 v[42:43], 0
ds_read_b128 v[44:47], v2 offset:0
ds_read_b128 v[48:51], v2 offset:1024
v_bfe_u32 v77, v1, 6, 1
v_lshl_add_u32 v77, v77, 3, v1
v_lshlrev_b32 v77, 1, v77
s_mov_b32 s38, 1
s_mov_b32 m0, 1024
s_nop 0
buffer_load_dwordx4 v1, s[4:7], s47 offen offset:0 sc0 sc1 lds
buffer_load_dwordx4 v1, s[4:7], s47 offen offset:1024 sc0 sc1 lds
buffer_load_dwordx4 v1, s[4:7], s47 offen offset:2048 sc0 sc1 lds
buffer_load_dwordx4 v1, s[4:7], s47 offen offset:3072 sc0 sc1 lds
s_mov_b32 m0, 5120
s_nop 0
buffer_load_dwordx4 v1, s[4:7], s48 offen offset:0 sc0 sc1 lds
buffer_load_dwordx4 v1, s[4:7], s48 offen offset:1024 sc0 sc1 lds
buffer_load_dwordx4 v1, s[4:7], s48 offen offset:2048 sc0 sc1 lds
buffer_load_dwordx4 v1, s[4:7], s48 offen offset:3072 sc0 sc1 lds
s_mov_b32 m0, 9216
s_nop 0
buffer_load_dwordx4 v1, s[4:7], s49 offen offset:0 sc0 sc1 lds
s_waitcnt vmcnt(0) lgkmcnt(0)
s_branch L_top_w3rs
.p2align 6
L_ex_w3rs:
v_and_b32 v6, 0x70, v1
ds_read_b128 v[76:79], v6 offset:256
s_add_u32 s34, s34, 1
s_add_u32 s37, s37, 524288
s_add_u32 s39, s39, 524288
s_mul_i32 s40, s34, 10240
s_add_u32 s40, s40, 8093696
s_not_b32 s35, s35
s_not_b32 s36, s36
ds_read_b128 v[44:47], v2 offset:0
ds_read_b128 v[48:51], v2 offset:1024
s_barrier
s_waitcnt vmcnt(0)
v_mov_b64 v[20:21], 0
v_mov_b64 v[22:23], 0
v_mov_b64 v[24:25], 0
v_mov_b64 v[26:27], 0
v_mov_b64 v[28:29], 0
v_mov_b64 v[30:31], 0
v_mov_b64 v[32:33], 0
v_mov_b64 v[34:35], 0
v_mov_b64 v[36:37], 0
v_mov_b64 v[38:39], 0
v_mov_b64 v[40:41], 0
v_mov_b64 v[42:43], 0
buffer_load_dwordx4 v[60:63], v9, s[4:7], s3 offen offset:0 sc0 sc1
buffer_load_dwordx4 v[64:67], v9, s[4:7], s3 offen offset:1024 sc0 sc1
buffer_load_dwordx4 v[68:71], v9, s[4:7], s3 offen offset:2048 sc0 sc1
buffer_load_dwordx4 v[72:75], v9, s[4:7], s3 offen offset:3072 sc0 sc1
s_waitcnt lgkmcnt(2)
s_waitcnt vmcnt(3)
L_r_w3rs:
v_mfma_f32_16x16x32_bf16 v[52:55], v[60:63], v[76:79], 0
s_waitcnt vmcnt(2)
v_mfma_f32_16x16x32_bf16 v[52:55], v[64:67], v[76:79], v[52:55]
v_bitop3_b32 v56, v60, v64, s36 bitop3:0x7e
s_waitcnt vmcnt(1)
v_mfma_f32_16x16x32_bf16 v[52:55], v[68:71], v[76:79], v[52:55]
s_waitcnt vmcnt(0)
v_mfma_f32_16x16x32_bf16 v[52:55], v[72:75], v[76:79], v[52:55]
v_bitop3_b32 v57, v68, v72, s36 bitop3:0x7e
v_bitop3_b32 v56, v56, v57, 1 bitop3:0xa8
v_cmp_ne_u32 vcc, 0, v56
s_cmp_eq_u32 s34, 63
s_nop 3
v_pk_add_f32 v[52:53], v[52:53], v[54:55]
v_cvt_pk_bf16_f32 v56, v52, v53
v_bfi_b32 v56, v11, s35, v56
s_cbranch_vccnz L_rr_w3rs
buffer_store_dword v56, v10, s[4:7], 0 offen sc0 sc1
v_mov_b32 v79, v56
s_cbranch_scc1 L_done_w3rs
v_bfe_u32 v77, v1, 6, 1
v_lshl_add_u32 v77, v77, 3, v1
v_lshlrev_b32 v77, 1, v77
L_top_w3rs:
s_barrier
ds_read_b128 v[60:63], v1 offset:1024
ds_read_b128 v[64:67], v1 offset:2048
s_mov_b32 m0, 5120
s_nop 0
buffer_load_dwordx4 v1, s[4:7], s48 offen offset:3072 sc0 sc1 lds
s_barrier
ds_read_b128 v[68:71], v1 offset:3072
ds_read_b128 v[72:75], v1 offset:4096
L_s0_w3rs:
s_waitcnt lgkmcnt(3)
v_smfmac_f32_16x16x64_bf16 v[28:31], v[60:63], v[176:183], v0
v_smfmac_f32_16x16x64_bf16 v[32:35], v[60:63], v[184:191], v0
v_smfmac_f32_16x16x64_bf16 v[36:39], v[60:63], a[48:55], v0
v_smfmac_f32_16x16x64_bf16 v[40:43], v[60:63], a[56:63], v0
s_waitcnt lgkmcnt(2)
v_smfmac_f32_16x16x64_bf16 v[20:23], v[64:67], v[80:87], v0
v_smfmac_f32_16x16x64_bf16 v[20:23], v[60:63], v[44:51], v0
ds_read_b128 v[44:47], v2 offset:2048
v_smfmac_f32_16x16x64_bf16 v[24:27], v[64:67], v[88:95], v0
ds_read_b128 v[48:51], v2 offset:3072
v_smfmac_f32_16x16x64_bf16 v[28:31], v[64:67], v[192:199], v0
s_waitcnt lgkmcnt(2)
v_bitop3_b32 v6, v60, v64, s35 bitop3:0x7e
v_smfmac_f32_16x16x64_bf16 v[32:35], v[64:67], v[200:207], v0
v_bitop3_b32 v76, v68, v72, s35 bitop3:0x7e
v_smfmac_f32_16x16x64_bf16 v[36:39], v[64:67], a[64:71], v0
v_bitop3_b32 v6, v6, v76, 1 bitop3:0xa8
s_waitcnt lgkmcnt(0)
v_smfmac_f32_16x16x64_bf16 v[24:27], v[60:63], v[44:51], v0
ds_read_b128 v[44:47], v2 offset:4096
v_cmp_ne_u32 vcc, 0, v6
buffer_load_dwordx4 v[12:15], v9, s[4:7], s37 offen offset:0
buffer_load_dwordx4 v[16:19], v9, s[4:7], s37 offen offset:1024
buffer_load_dwordx4 v[52:55], v1, s[4:7], s37 offen offset:2048
buffer_load_dwordx4 v[56:59], v1, s[4:7], s37 offen offset:3072
v_smfmac_f32_16x16x64_bf16 v[40:43], v[64:67], a[72:79], v0
ds_read_b128 v[48:51], v2 offset:5120
v_smfmac_f32_16x16x64_bf16 v[20:23], v[68:71], v[96:103], v0
s_cbranch_vccnz L_ra0_w3rs
v_smfmac_f32_16x16x64_bf16 v[24:27], v[68:71], v[104:111], v0
s_waitcnt vmcnt(4)
s_barrier
ds_read_b32 v6, v77 offset:8192
buffer_store_dword v79, v10, s[4:7], s40 offen sc0 sc1
v_smfmac_f32_16x16x64_bf16 v[28:31], v[68:71], v[208:215], v0
ds_read_b128 v[60:63], v1 offset:6144
s_waitcnt lgkmcnt(2)
v_smfmac_f32_16x16x64_bf16 v[20:23], v[72:75], v[44:51], v0
ds_read_b128 v[64:67], v1 offset:7168
v_smfmac_f32_16x16x64_bf16 v[32:35], v[68:71], v[216:223], v0
ds_read_b128 v[76:79], v1 offset:5120
v_smfmac_f32_16x16x64_bf16 v[36:39], v[68:71], a[80:87], v0
ds_read_b128 v[44:47], v2 offset:6144
v_smfmac_f32_16x16x64_bf16 v[40:43], v[68:71], a[88:95], v0
ds_read_b128 v[48:51], v2 offset:7168
s_waitcnt lgkmcnt(4)
v_bitop3_b32 v6, v6, v60, s35 bitop3:0x7e
v_smfmac_f32_16x16x64_bf16 v[28:31], v[72:75], v[224:231], v0
ds_read_b128 v[68:71], v1 offset:8192
s_waitcnt lgkmcnt(4)
v_bitop3_b32 v6, v6, v64, s35 bitop3:0xf6
v_smfmac_f32_16x16x64_bf16 v[32:35], v[72:75], v[232:239], v0
s_waitcnt lgkmcnt(3)
v_bitop3_b32 v6, v6, v76, s35 bitop3:0xf6
v_and_b32 v6, 1, v6
v_smfmac_f32_16x16x64_bf16 v[36:39], v[72:75], a[96:103], v0
v_cmp_ne_u32 vcc, 0, v6
s_waitcnt lgkmcnt(1)
v_smfmac_f32_16x16x64_bf16 v[24:27], v[72:75], v[44:51], v0
ds_read_b128 v[44:47], v2 offset:8192
v_lshlrev_b32 v6, 2, v1
v_smfmac_f32_16x16x64_bf16 v[40:43], v[72:75], a[104:111], v0
ds_read_b128 v[72:75], v1 offset:9216
s_cbranch_vccnz L_ra1_w3rs
L_a1_w3rs:
v_smfmac_f32_16x16x64_bf16 v[20:23], v[60:63], v[112:119], v0
ds_read_b128 v[48:51], v2 offset:9216
v_smfmac_f32_16x16x64_bf16 v[20:23], v[64:67], v[128:135], v0
s_waitcnt lgkmcnt(3)
v_smfmac_f32_16x16x64_bf16 v[20:23], v[68:71], v[144:151], v0
s_waitcnt lgkmcnt(1)
v_smfmac_f32_16x16x64_bf16 v[20:23], v[72:75], v[160:167], v0
s_waitcnt lgkmcnt(0)
v_smfmac_f32_16x16x64_bf16 v[20:23], v[76:79], v[44:51], v0
ds_read_b128 v[44:47], v2 offset:10240
v_smfmac_f32_16x16x64_bf16 v[24:27], v[60:63], v[120:127], v0
ds_read_b128 v[48:51], v2 offset:11264
v_smfmac_f32_16x16x64_bf16 v[24:27], v[64:67], v[136:143], v0
v_add_f32 v20, v20, v22
v_smfmac_f32_16x16x64_bf16 v[24:27], v[68:71], v[152:159], v0
v_add_f32 v21, v21, v23
v_smfmac_f32_16x16x64_bf16 v[24:27], v[72:75], v[168:175], v0
v_cvt_pk_bf16_f32 v22, v20, v21
s_waitcnt lgkmcnt(0)
v_smfmac_f32_16x16x64_bf16 v[24:27], v[76:79], v[44:51], v0
ds_read_b128 v[44:47], v2 offset:12288
v_smfmac_f32_16x16x64_bf16 v[28:31], v[76:79], v[240:247], v0
ds_read_b128 v[48:51], v2 offset:13312
v_smfmac_f32_16x16x64_bf16 v[28:31], v[64:67], a[0:7], v0
v_add_f32 v24, v24, v26
v_add_f32 v25, v25, v27
v_cvt_pk_bf16_f32 v23, v24, v25
v_smfmac_f32_16x16x64_bf16 v[28:31], v[68:71], a[16:23], v0
ds_write_b64 v3, v[22:23] offset:11776
v_smfmac_f32_16x16x64_bf16 v[28:31], v[72:75], a[32:39], v0
s_mov_b32 m0, 0
s_nop 0
buffer_load_dword v6, s[4:7], s39 offen lds
s_waitcnt lgkmcnt(1)
v_smfmac_f32_16x16x64_bf16 v[28:31], v[60:63], v[44:51], v0
ds_read_b128 v[44:47], v2 offset:14336
v_smfmac_f32_16x16x64_bf16 v[32:35], v[76:79], v[248:255], v0
ds_read_b128 v[48:51], v2 offset:15360
s_waitcnt lgkmcnt(2)
s_barrier
v_smfmac_f32_16x16x64_bf16 v[32:35], v[64:67], a[8:15], v0
ds_read_b64_tr_b16 v[20:21], v4 offset:10240
ds_read_b64_tr_b16 v[22:23], v4 offset:10752
v_add_f32 v28, v28, v30
v_smfmac_f32_16x16x64_bf16 v[32:35], v[68:71], a[24:31], v0
ds_read_b64_tr_b16 v[24:25], v4 offset:11264
v_add_f32 v29, v29, v31
v_smfmac_f32_16x16x64_bf16 v[32:35], v[72:75], a[40:47], v0
ds_read_b64_tr_b16 v[26:27], v4 offset:11776
v_cvt_pk_bf16_f32 v30, v28, v29
s_waitcnt lgkmcnt(4)
v_smfmac_f32_16x16x64_bf16 v[32:35], v[60:63], v[44:51], v0
ds_read_b128 v[44:47], v2 offset:18432
s_waitcnt vmcnt(4)
s_waitcnt lgkmcnt(3)
v_mfma_f32_16x16x32_bf16 v[12:15], v[12:15], v[20:23], 0
ds_read_b128 v[48:51], v2 offset:19456
s_waitcnt lgkmcnt(2)
v_mfma_f32_16x16x32_bf16 v[12:15], v[16:19], v[24:27], v[12:15]
v_add_f32 v32, v32, v34
v_add_f32 v33, v33, v35
v_cvt_pk_bf16_f32 v31, v32, v33
ds_write_b64 v3, v[30:31] offset:13824
v_smfmac_f32_16x16x64_bf16 v[36:39], v[76:79], a[112:119], v0
s_nop 2
v_add_f32_dpp v12, v14, v12 quad_perm:[2,3,0,1] row_mask:0xf bank_mask:0xf
v_add_f32_dpp v13, v15, v13 quad_perm:[2,3,0,1] row_mask:0xf bank_mask:0xf
ds_write_b64 v5, v[12:13] offset:15104
v_smfmac_f32_16x16x64_bf16 v[40:43], v[76:79], a[120:127], v0
s_waitcnt lgkmcnt(1)
s_barrier
ds_read_b64_tr_b16 v[28:29], v4 offset:12288
v_smfmac_f32_16x16x64_bf16 v[36:39], v[60:63], a[128:135], v0
ds_read_b64_tr_b16 v[30:31], v4 offset:12800
ds_read_b64_tr_b16 v[32:33], v4 offset:13312
v_smfmac_f32_16x16x64_bf16 v[40:43], v[60:63], a[136:143], v0
ds_read_b64_tr_b16 v[34:35], v4 offset:13824
v_mov_b64 v[76:77], s[52:53]
s_waitcnt lgkmcnt(4)
s_barrier
ds_read_b128 v[12:15], v1 offset:14336
v_smfmac_f32_16x16x64_bf16 v[40:43], v[72:75], v[44:51], v0
ds_read_b128 v[44:47], v2 offset:16384
v_mov_b64 v[78:79], s[52:53]
s_waitcnt lgkmcnt(4)
v_mfma_f32_16x16x32_bf16 v[28:31], v[28:31], v[20:23], 0
ds_read_b128 v[48:51], v2 offset:17408
s_waitcnt lgkmcnt(3)
v_mfma_f32_16x16x32_bf16 v[28:31], v[32:35], v[24:27], v[28:31]
v_smfmac_f32_16x16x64_bf16 v[40:43], v[64:67], a[152:159], v0
s_waitcnt lgkmcnt(2)
v_max3_f32 v17, v12, v13, v14
v_smfmac_f32_16x16x64_bf16 v[36:39], v[64:67], a[144:151], v0
ds_read_b128 v[60:63], v2 offset:22528
v_add_f32_dpp v28, v30, v28 quad_perm:[2,3,0,1] row_mask:0xf bank_mask:0xf
v_add_f32_dpp v29, v31, v29 quad_perm:[2,3,0,1] row_mask:0xf bank_mask:0xf
v_max_f32 v17, v17, v15
v_max_f32 v16, v28, v29
v_mul_f32 v16, s50, v16
v_max_f32_dpp v17, v17, v17 quad_perm:[2,3,0,1] row_mask:0xf bank_mask:0xf
v_smfmac_f32_16x16x64_bf16 v[40:43], v[68:71], a[168:175], v0
ds_read_b128 v[64:67], v2 offset:23552
v_max_f32_dpp v18, v16, v17 quad_perm:[0,1,0,1] row_mask:0xf bank_mask:0xf
v_max_f32_dpp v19, v16, v17 quad_perm:[0,1,0,1] row_mask:0xf bank_mask:0xf
v_smfmac_f32_16x16x64_bf16 v[36:39], v[68:71], a[160:167], v0
ds_read_b128 v[68:71], v2 offset:24576
v_permlane16_swap_b32 v18, v19
v_max_f32 v20, v18, v19
v_max_f32 v21, v18, v19
s_waitcnt lgkmcnt(3)
v_smfmac_f32_16x16x64_bf16 v[36:39], v[72:75], v[44:51], v0
ds_read_b128 v[72:75], v2 offset:25600
v_permlane32_swap_b32 v20, v21
v_max_f32 v20, v20, v21
v_sub_f32 v12, v12, v20
v_sub_f32 v13, v13, v20
v_pk_add_f32 v[14:15], v[14:15], v[20:21] op_sel_hi:[1,0] neg_lo:[0,1] neg_hi:[0,1]
v_exp_f32 v12, v12
v_exp_f32 v13, v13
v_exp_f32 v14, v14
v_exp_f32 v15, v15
v_cvt_pk_bf16_f32 v16, v12, v13
v_cvt_pk_bf16_f32 v17, v14, v15
v_pk_fma_f32 v[28:29], v[28:29], s[50:51], v[20:21] op_sel_hi:[1,1,0] neg_lo:[0,0,1] neg_hi:[0,0,1]
v_mov_b32_dpp v18, v16 quad_perm:[2,3,0,1] row_mask:0xf bank_mask:0xf
v_mov_b32_dpp v19, v17 quad_perm:[2,3,0,1] row_mask:0xf bank_mask:0xf
v_exp_f32 v28, v28
s_waitcnt vmcnt(2)
v_mfma_f32_16x16x32_bf16 v[32:35], v[76:79], v[16:19], 0
v_exp_f32 v29, v29
v_mfma_f32_16x16x32_bf16 v[20:23], v[52:55], v[16:19], 0
v_cvt_pk_bf16_f32 v12, v28, v29
v_cvt_pk_bf16_f32 v13, v28, v29
v_mov_b64 v[14:15], s[0:1]
v_mfma_f32_16x16x32_bf16 v[24:27], v[56:59], v[16:19], 0
v_cvt_pk_bf16_f32 v36, v36, v37
v_cvt_pk_bf16_f32 v37, v38, v39
v_mfma_f32_16x16x16_bf16 v[32:35], v[14:15], v[12:13], v[32:35]
v_cvt_pk_bf16_f32 v38, v40, v41
v_cvt_pk_bf16_f32 v39, v42, v43
v_mfma_f32_16x16x16_bf16 v[20:23], v[36:37], v[12:13], v[20:23]
ds_read_b128 v[44:47], v2 offset:20480
v_mfma_f32_16x16x16_bf16 v[24:27], v[38:39], v[12:13], v[24:27]
ds_read_b128 v[48:51], v2 offset:21504
v_rcp_f32 v32, v32
v_mov_b64 v[28:29], 0
v_mov_b64 v[30:31], 0
v_pk_mul_f32 v[20:21], v[20:21], v[32:33] op_sel_hi:[1,0]
v_pk_mul_f32 v[22:23], v[22:23], v[32:33] op_sel_hi:[1,0]
v_cvt_pk_bf16_f32 v20, v20, v21
v_cvt_pk_bf16_f32 v21, v22, v23
ds_write_b64 v1, v[20:21] offset:8192
v_pk_mul_f32 v[24:25], v[24:25], v[32:33] op_sel_hi:[1,0]
v_pk_mul_f32 v[26:27], v[26:27], v[32:33] op_sel_hi:[1,0]
v_cvt_pk_bf16_f32 v24, v24, v25
v_cvt_pk_bf16_f32 v25, v26, v27
ds_write_b64 v1, v[24:25] offset:8200
v_mov_b64 v[76:77], 0
ds_read_b128 v[12:15], v7 offset:8192
v_mov_b64 v[78:79], 0
v_mov_b64 v[40:41], 0
v_mov_b64 v[42:43], 0
v_mov_b64 v[36:37], 0
v_mov_b64 v[38:39], 0
v_mov_b64 v[32:33], 0
v_mov_b64 v[34:35], 0
s_waitcnt lgkmcnt(1)
s_barrier
ds_read_b128 v[16:19], v7 offset:5120
ds_read_b128 v[52:55], v7 offset:6144
ds_read_b128 v[56:59], v7 offset:7168
s_waitcnt lgkmcnt(3)
v_smfmac_f32_16x16x64_bf16 v[28:31], v[12:15], v[44:51], v0 abid:1
v_smfmac_f32_16x16x64_bf16 v[76:79], v[12:15], v[60:67], v0 abid:1
ds_read_b128 v[44:47], v2 offset:26624
s_waitcnt lgkmcnt(3)
v_smfmac_f32_16x16x64_bf16 v[28:31], v[16:19], a[176:183], v0 abid:1
ds_read_b128 v[48:51], v2 offset:27648
s_waitcnt lgkmcnt(3)
v_smfmac_f32_16x16x64_bf16 v[28:31], v[52:55], v[68:75], v0 abid:1
ds_read_b128 v[60:63], v2 offset:28672
s_waitcnt lgkmcnt(3)
v_smfmac_f32_16x16x64_bf16 v[28:31], v[56:59], a[184:191], v0 abid:1
ds_read_b128 v[64:67], v2 offset:29696
v_smfmac_f32_16x16x64_bf16 v[76:79], v[16:19], a[192:199], v0 abid:1
ds_read_b128 v[68:71], v2 offset:30720
s_waitcnt lgkmcnt(3)
v_smfmac_f32_16x16x64_bf16 v[76:79], v[52:55], v[44:51], v0 abid:1
ds_read_b128 v[72:75], v2 offset:31744
v_cvt_pk_bf16_f32 v28, v28, v29
v_cvt_pk_bf16_f32 v29, v30, v31
v_bfi_b32 v28, 1, s35, v28
buffer_store_dwordx2 v[28:29], v8, s[4:7], s42 offen sc0 sc1
v_smfmac_f32_16x16x64_bf16 v[76:79], v[56:59], a[200:207], v0 abid:1
v_smfmac_f32_16x16x64_bf16 v[40:43], v[12:15], a[208:215], v0 abid:1
v_smfmac_f32_16x16x64_bf16 v[40:43], v[16:19], a[216:223], v0 abid:1
v_cvt_pk_bf16_f32 v76, v76, v77
v_cvt_pk_bf16_f32 v77, v78, v79
v_bfi_b32 v76, 1, s35, v76
buffer_store_dwordx2 v[76:77], v8, s[4:7], s43 offen sc0 sc1
v_smfmac_f32_16x16x64_bf16 v[40:43], v[52:55], a[224:231], v0 abid:1
v_smfmac_f32_16x16x64_bf16 v[40:43], v[56:59], a[232:239], v0 abid:1
s_waitcnt lgkmcnt(2)
v_smfmac_f32_16x16x64_bf16 v[36:39], v[12:15], v[60:67], v0 abid:1
v_smfmac_f32_16x16x64_bf16 v[36:39], v[16:19], a[240:247], v0 abid:1
v_cvt_pk_bf16_f32 v40, v40, v41
s_waitcnt lgkmcnt(0)
v_smfmac_f32_16x16x64_bf16 v[36:39], v[52:55], v[68:75], v0 abid:1
v_cvt_pk_bf16_f32 v41, v42, v43
v_smfmac_f32_16x16x64_bf16 v[36:39], v[56:59], a[248:255], v0 abid:1
v_bfi_b32 v40, 1, s35, v40
buffer_store_dwordx2 v[40:41], v8, s[4:7], s44 offen sc0 sc1
s_nop 5
v_cvt_pk_bf16_f32 v36, v36, v37
v_cvt_pk_bf16_f32 v37, v38, v39
v_bfi_b32 v36, 1, s35, v36
buffer_store_dwordx2 v[36:37], v8, s[4:7], s45 offen sc0 sc1
s_branch L_ex_w3rs
L_done_w3rs:
buffer_store_dword v79, v10, s[4:7], s40 offen sc0 sc1
s_waitcnt vmcnt(0) lgkmcnt(0)
s_endpgm
L_ra0_w3rs:
s_mov_b32 s38, 1
s_mov_b32 m0, 1024
s_nop 0
buffer_load_dwordx4 v1, s[4:7], s47 offen offset:0 sc0 sc1 lds
buffer_load_dwordx4 v1, s[4:7], s47 offen offset:1024 sc0 sc1 lds
buffer_load_dwordx4 v1, s[4:7], s47 offen offset:2048 sc0 sc1 lds
buffer_load_dwordx4 v1, s[4:7], s47 offen offset:3072 sc0 sc1 lds
s_sub_u32 s41, s41, 1
s_cbranch_scc1 L_exit
ds_read_b128 v[44:47], v2 offset:0
ds_read_b128 v[48:51], v2 offset:1024
v_mov_b64 v[20:21], 0
v_mov_b64 v[22:23], 0
v_mov_b64 v[24:25], 0
v_mov_b64 v[26:27], 0
v_mov_b64 v[28:29], 0
v_mov_b64 v[30:31], 0
v_mov_b64 v[32:33], 0
v_mov_b64 v[34:35], 0
v_mov_b64 v[36:37], 0
v_mov_b64 v[38:39], 0
v_mov_b64 v[40:41], 0
v_mov_b64 v[42:43], 0
s_waitcnt vmcnt(0)
ds_read_b128 v[60:63], v1 offset:1024
ds_read_b128 v[64:67], v1 offset:2048
ds_read_b128 v[68:71], v1 offset:3072
ds_read_b128 v[72:75], v1 offset:4096
s_branch L_s0_w3rs
L_ra1_w3rs:
s_mov_b32 s38, 1
s_waitcnt lgkmcnt(0)
s_barrier
s_mov_b32 m0, 5120
s_nop 0
buffer_load_dwordx4 v1, s[4:7], s48 offen offset:3072 sc0 sc1 lds
s_sub_u32 s41, s41, 1
s_cbranch_scc1 L_exit
s_waitcnt vmcnt(0)
s_barrier
ds_read_b128 v[76:79], v1 offset:5120
ds_read_b128 v[60:63], v1 offset:6144
ds_read_b128 v[64:67], v1 offset:7168
ds_read_b128 v[68:71], v1 offset:8192
ds_read_b128 v[72:75], v1 offset:9216
s_waitcnt lgkmcnt(0)
v_bitop3_b32 v6, v76, v60, s35 bitop3:0x7e
v_bitop3_b32 v6, v6, v64, s35 bitop3:0xf6
v_bitop3_b32 v6, v6, v68, s35 bitop3:0xf6
v_bitop3_b32 v6, v6, v72, s35 bitop3:0xf6
v_and_b32 v6, 1, v6
v_cmp_ne_u32 vcc, 0, v6
v_lshlrev_b32 v6, 2, v1
s_cbranch_vccnz L_ra1_w3rs
s_branch L_a1_w3rs
L_rr_w3rs:
buffer_load_dwordx4 v[60:63], v9, s[4:7], s3 offen offset:0 sc0 sc1
buffer_load_dwordx4 v[64:67], v9, s[4:7], s3 offen offset:1024 sc0 sc1
buffer_load_dwordx4 v[68:71], v9, s[4:7], s3 offen offset:2048 sc0 sc1
buffer_load_dwordx4 v[72:75], v9, s[4:7], s3 offen offset:3072 sc0 sc1
s_sub_u32 s41, s41, 1
s_cbranch_scc1 L_exit
s_waitcnt vmcnt(0)
s_branch L_r_w3rs
s_endpgm

.section .rodata,"a"
.p2align 6
.amdhsa_kernel gated_mix__sliding_local_dilated__memory_aug_recurrent_mem_tr__prompt_kernel
  .amdhsa_next_free_vgpr 512
  .amdhsa_next_free_sgpr 102
  .amdhsa_accum_offset 256
  .amdhsa_group_segment_fixed_size 0
  .amdhsa_kernarg_size 112
  .amdhsa_user_sgpr_count 2
  .amdhsa_user_sgpr_kernarg_segment_ptr 1
  .amdhsa_system_sgpr_workgroup_id_x 1
  .amdhsa_float_denorm_mode_32 3
.end_amdhsa_kernel
```

```asm
; @launch grid=(256,1,1) block=(256,1,1) lds=163840
.amdgcn_target "amdgcn-amd-amdhsa--gfx950"
.text
.globl gated_mix__sliding_local_dilated__memory_aug_recurrent_mem_tr__prompt_kernel
.p2align 8
.type gated_mix__sliding_local_dilated__memory_aug_recurrent_mem_tr__prompt_kernel,@function
gated_mix__sliding_local_dilated__memory_aug_recurrent_mem_tr__prompt_kernel:

s_cmp_ge_u32 s2, 256
s_cbranch_scc1 L_exit_w
s_and_b32 s3, s2, 7
s_lshr_b32 s32, s2, 3
s_cmp_eq_u32 s3, 0
s_cbranch_scc1 L_role_chain
s_cmp_ge_u32 s3, 5
s_cbranch_scc1 L_pre_aw
s_lshr_b32 s33, s32, 3
s_and_b32 s32, s32, 7
s_sub_u32 s3, s3, 1
s_lshl_b32 s3, s3, 3
s_add_u32 s32, s32, s3
s_branch L_role_q
L_pre_aw:
s_sub_u32 s3, s3, 5
s_lshl_b32 s49, s3, 5
s_add_u32 s49, s49, s32
s_lshr_b32 s33, s49, 3
s_and_b32 s32, s32, 7
s_mul_i32 s48, s49, 43
s_lshr_b32 s48, s48, 9
s_mul_i32 s3, s48, 12
s_sub_u32 s49, s49, s3
s_branch L_role_aw
L_exit_w:
s_endpgm
L_role_q:
s_load_dwordx2 s[4:5], s[0:1], 104
s_mov_b32 s6, 268435456
s_mov_b32 s7, 0x20000
s_load_dwordx2 s[8:9], s[0:1], 0
s_mov_b32 s10, 2359296
s_mov_b32 s11, 0x20000
s_load_dwordx2 s[12:13], s[0:1], 40
s_mov_b32 s14, 4718592
s_mov_b32 s15, 0x20000
s_load_dwordx2 s[16:17], s[0:1], 48
s_mov_b32 s18, 4718592
s_mov_b32 s19, 0x20000
s_load_dwordx2 s[20:21], s[0:1], 56
s_mov_b32 s22, 4718592
s_mov_b32 s23, 0x20000
s_load_dwordx2 s[24:25], s[0:1], 96
s_mov_b32 s26, 256
s_mov_b32 s27, 0x20000
v_and_b32 v9, 63, v0
v_and_b32 v10, 15, v0
v_bfe_u32 v11, v0, 4, 2
v_lshrrev_b32 v1, 6, v0
s_nop 0
v_readfirstlane_b32 s34, v1
v_lshrrev_b32 v12, 2, v9
v_mul_u32_u24 v2, 1152, v12
v_lshrrev_b32 v12, 5, v9
v_lshlrev_b32 v12, 1, v12
v_and_b32 v13, 3, v9
v_xor_b32 v12, v12, v13
v_lshl_add_u32 v2, v12, 4, v2
v_lshrrev_b32 v12, 3, v10
v_lshlrev_b32 v12, 1, v12
v_xor_b32 v12, v12, v11
v_lshlrev_b32 v12, 4, v12
v_lshl_add_u32 v3, v10, 6, v12
v_lshlrev_b32 v12, 13, v11
v_lshlrev_b32 v5, 1, v11
v_xor_b32 v5, v5, v10
v_lshl_add_u32 v5, v5, 4, v12
v_xor_b32 v6, 128, v5
v_lshlrev_b32 v1, 4, v9
s_mul_i32 s38, s34, 20480
s_add_u32 s38, s38, 73728
s_lshl_b32 s39, s32, 8
s_lshl_b32 s40, s34, 17
s_add_u32 s39, s39, s40
s_lshl_b32 s43, s33, 1
s_and_b32 s41, s34, 1
s_add_u32 s43, s43, s41
s_mul_i32 s43, s43, 18432
s_lshr_b32 s41, s34, 1
s_lshl_b32 s41, s41, 6
s_add_u32 s43, s43, s41
s_lshl_b32 s44, s34, 10
s_mov_b32 s36, 400000
s_mov_b32 s46, 0x3e0293ee
s_mov_b32 s47, 0x3e0293ee
v_mov_b32 v8, 0
v_lshrrev_b32 v12, 2, v10
v_lshlrev_b32 v4, 12, v12
v_lshl_add_u32 v4, v11, 8, v4
v_and_b32 v12, 3, v10
v_lshl_add_u32 v4, v12, 4, v4
s_waitcnt lgkmcnt(0)
s_add_u32 s37, s39, 0
s_add_u32 m0, s38, 0
s_nop 0
buffer_load_dwordx4 v5, s[12:15], s37 offen lds
s_add_u32 s37, s39, 32768
s_add_u32 m0, s38, 1024
s_nop 0
buffer_load_dwordx4 v5, s[12:15], s37 offen lds
s_add_u32 s37, s39, 65536
s_add_u32 m0, s38, 2048
s_nop 0
buffer_load_dwordx4 v6, s[12:15], s37 offen lds
s_add_u32 s37, s39, 98304
s_add_u32 m0, s38, 3072
s_nop 0
buffer_load_dwordx4 v6, s[12:15], s37 offen lds
s_add_u32 s37, s39, 524288
s_add_u32 m0, s38, 4096
s_nop 0
buffer_load_dwordx4 v5, s[12:15], s37 offen lds
s_add_u32 s37, s39, 557056
s_add_u32 m0, s38, 5120
s_nop 0
buffer_load_dwordx4 v5, s[12:15], s37 offen lds
s_add_u32 s37, s39, 589824
s_add_u32 m0, s38, 6144
s_nop 0
buffer_load_dwordx4 v6, s[12:15], s37 offen lds
s_add_u32 s37, s39, 622592
s_add_u32 m0, s38, 7168
s_nop 0
buffer_load_dwordx4 v6, s[12:15], s37 offen lds
s_add_u32 s37, s39, 1048576
s_add_u32 m0, s38, 8192
s_nop 0
buffer_load_dwordx4 v5, s[12:15], s37 offen lds
s_add_u32 s37, s39, 1081344
s_add_u32 m0, s38, 9216
s_nop 0
buffer_load_dwordx4 v5, s[12:15], s37 offen lds
s_add_u32 s37, s39, 1114112
s_add_u32 m0, s38, 10240
s_nop 0
buffer_load_dwordx4 v6, s[12:15], s37 offen lds
s_add_u32 s37, s39, 1146880
s_add_u32 m0, s38, 11264
s_nop 0
buffer_load_dwordx4 v6, s[12:15], s37 offen lds
s_add_u32 s37, s39, 1572864
s_add_u32 m0, s38, 12288
s_nop 0
buffer_load_dwordx4 v5, s[12:15], s37 offen lds
s_add_u32 s37, s39, 1605632
s_add_u32 m0, s38, 13312
s_nop 0
buffer_load_dwordx4 v5, s[12:15], s37 offen lds
s_add_u32 s37, s39, 1638400
s_add_u32 m0, s38, 14336
s_nop 0
buffer_load_dwordx4 v6, s[12:15], s37 offen lds
s_add_u32 s37, s39, 1671168
s_add_u32 m0, s38, 15360
s_nop 0
buffer_load_dwordx4 v6, s[12:15], s37 offen lds
s_add_u32 s37, s39, 2097152
s_add_u32 m0, s38, 16384
s_nop 0
buffer_load_dwordx4 v5, s[12:15], s37 offen lds
s_add_u32 s37, s39, 2129920
s_add_u32 m0, s38, 17408
s_nop 0
buffer_load_dwordx4 v5, s[12:15], s37 offen lds
s_add_u32 s37, s39, 2162688
s_add_u32 m0, s38, 18432
s_nop 0
buffer_load_dwordx4 v6, s[12:15], s37 offen lds
s_add_u32 s37, s39, 2195456
s_add_u32 m0, s38, 19456
s_nop 0
buffer_load_dwordx4 v6, s[12:15], s37 offen lds
s_add_u32 s37, s43, 0
s_add_u32 m0, s44, 0
s_nop 0
buffer_load_dwordx4 v2, s[8:11], s37 offen lds
s_add_u32 s37, s43, 128
s_add_u32 m0, s44, 4096
s_nop 0
buffer_load_dwordx4 v2, s[8:11], s37 offen lds
s_add_u32 s37, s43, 256
s_add_u32 m0, s44, 8192
s_nop 0
buffer_load_dwordx4 v2, s[8:11], s37 offen lds
s_add_u32 s37, s43, 384
s_add_u32 m0, s44, 12288
s_nop 0
buffer_load_dwordx4 v2, s[8:11], s37 offen lds
s_add_u32 s37, s43, 512
s_add_u32 m0, s44, 16384
s_nop 0
buffer_load_dwordx4 v2, s[8:11], s37 offen lds
s_add_u32 s37, s43, 640
s_add_u32 m0, s44, 20480
s_nop 0
buffer_load_dwordx4 v2, s[8:11], s37 offen lds
s_add_u32 s37, s43, 768
s_add_u32 m0, s44, 24576
s_nop 0
buffer_load_dwordx4 v2, s[8:11], s37 offen lds
s_add_u32 s37, s43, 896
s_add_u32 m0, s44, 28672
s_nop 0
buffer_load_dwordx4 v2, s[8:11], s37 offen lds
s_add_u32 s37, s43, 1024
s_add_u32 m0, s44, 32768
s_nop 0
buffer_load_dwordx4 v2, s[8:11], s37 offen lds
s_lshr_b32 s40, s34, 1
s_lshl_b32 s40, s40, 3
s_and_b32 s41, s34, 1
s_lshl_b32 s41, s41, 1
s_add_u32 s40, s40, s41
s_add_u32 s40, s40, 0
s_lshl_b32 s41, s34, 2
s_add_u32 s41, s41, 0
v_and_b32 v12, 1, v11
v_lshrrev_b32 v13, 2, v10
v_lshl_add_u32 v12, v12, 2, v13
v_lshlrev_b32 v12, 1, v12
v_bfe_u32 v16, v10, 1, 1
v_add_u32 v16, s40, v16
v_xor_b32 v16, v16, v12
v_lshlrev_b32 v16, 4, v16
v_lshl_add_u32 v16, v13, 8, v16
v_and_b32 v12, 1, v11
v_lshl_add_u32 v16, v12, 11, v16
v_and_b32 v12, 1, v10
v_lshl_add_u32 v16, v12, 3, v16
v_lshrrev_b32 v12, 1, v11
v_mul_u32_u24 v12, 20480, v12
v_add_u32 v12, 73728, v12
v_add_u32 v16, v16, v12
v_and_b32 v12, 1, v11
v_lshrrev_b32 v13, 2, v10
v_lshl_add_u32 v12, v12, 2, v13
v_lshlrev_b32 v12, 1, v12
v_bfe_u32 v20, v10, 1, 1
v_add_u32 v20, s41, v20
v_xor_b32 v20, v20, v12
v_lshlrev_b32 v20, 4, v20
v_lshl_add_u32 v20, v13, 8, v20
v_and_b32 v12, 1, v11
v_lshl_add_u32 v20, v12, 11, v20
v_and_b32 v12, 1, v10
v_lshl_add_u32 v20, v12, 3, v20
v_lshrrev_b32 v12, 1, v11
v_mul_u32_u24 v12, 20480, v12
v_add_u32 v12, 73728, v12
v_add_u32 v20, v20, v12
v_and_b32 v12, 1, v11
v_lshrrev_b32 v13, 2, v10
v_lshl_add_u32 v12, v12, 2, v13
v_lshlrev_b32 v12, 1, v12
v_bfe_u32 v18, v10, 1, 1
v_add_u32 v18, s40, v18
v_xor_b32 v18, v18, v12
v_lshlrev_b32 v18, 4, v18
v_lshl_add_u32 v18, v13, 8, v18
v_and_b32 v12, 1, v11
v_lshl_add_u32 v18, v12, 11, v18
v_and_b32 v12, 1, v10
v_lshl_add_u32 v18, v12, 3, v18
v_lshrrev_b32 v12, 1, v11
v_mul_u32_u24 v12, 20480, v12
v_add_u32 v12, 114688, v12
v_add_u32 v18, v18, v12
v_and_b32 v12, 1, v11
v_lshrrev_b32 v13, 2, v10
v_lshl_add_u32 v12, v12, 2, v13
v_lshlrev_b32 v12, 1, v12
v_bfe_u32 v22, v10, 1, 1
v_add_u32 v22, s41, v22
v_xor_b32 v22, v22, v12
v_lshlrev_b32 v22, 4, v22
v_lshl_add_u32 v22, v13, 8, v22
v_and_b32 v12, 1, v11
v_lshl_add_u32 v22, v12, 11, v22
v_and_b32 v12, 1, v10
v_lshl_add_u32 v22, v12, 3, v22
v_lshrrev_b32 v12, 1, v11
v_mul_u32_u24 v12, 20480, v12
v_add_u32 v12, 114688, v12
v_add_u32 v22, v22, v12
s_lshr_b32 s40, s34, 1
s_lshl_b32 s40, s40, 3
s_and_b32 s41, s34, 1
s_lshl_b32 s41, s41, 1
s_add_u32 s40, s40, s41
s_add_u32 s40, s40, 4
s_lshl_b32 s41, s34, 2
s_add_u32 s41, s41, 2
v_and_b32 v12, 1, v11
v_lshrrev_b32 v13, 2, v10
v_lshl_add_u32 v12, v12, 2, v13
v_lshlrev_b32 v12, 1, v12
v_bfe_u32 v17, v10, 1, 1
v_add_u32 v17, s40, v17
v_xor_b32 v17, v17, v12
v_lshlrev_b32 v17, 4, v17
v_lshl_add_u32 v17, v13, 8, v17
v_and_b32 v12, 1, v11
v_lshl_add_u32 v17, v12, 11, v17
v_and_b32 v12, 1, v10
v_lshl_add_u32 v17, v12, 3, v17
v_lshrrev_b32 v12, 1, v11
v_mul_u32_u24 v12, 20480, v12
v_add_u32 v12, 73728, v12
v_add_u32 v17, v17, v12
v_and_b32 v12, 1, v11
v_lshrrev_b32 v13, 2, v10
v_lshl_add_u32 v12, v12, 2, v13
v_lshlrev_b32 v12, 1, v12
v_bfe_u32 v21, v10, 1, 1
v_add_u32 v21, s41, v21
v_xor_b32 v21, v21, v12
v_lshlrev_b32 v21, 4, v21
v_lshl_add_u32 v21, v13, 8, v21
v_and_b32 v12, 1, v11
v_lshl_add_u32 v21, v12, 11, v21
v_and_b32 v12, 1, v10
v_lshl_add_u32 v21, v12, 3, v21
v_lshrrev_b32 v12, 1, v11
v_mul_u32_u24 v12, 20480, v12
v_add_u32 v12, 73728, v12
v_add_u32 v21, v21, v12
v_and_b32 v12, 1, v11
v_lshrrev_b32 v13, 2, v10
v_lshl_add_u32 v12, v12, 2, v13
v_lshlrev_b32 v12, 1, v12
v_bfe_u32 v19, v10, 1, 1
v_add_u32 v19, s40, v19
v_xor_b32 v19, v19, v12
v_lshlrev_b32 v19, 4, v19
v_lshl_add_u32 v19, v13, 8, v19
v_and_b32 v12, 1, v11
v_lshl_add_u32 v19, v12, 11, v19
v_and_b32 v12, 1, v10
v_lshl_add_u32 v19, v12, 3, v19
v_lshrrev_b32 v12, 1, v11
v_mul_u32_u24 v12, 20480, v12
v_add_u32 v12, 114688, v12
v_add_u32 v19, v19, v12
v_and_b32 v12, 1, v11
v_lshrrev_b32 v13, 2, v10
v_lshl_add_u32 v12, v12, 2, v13
v_lshlrev_b32 v12, 1, v12
v_bfe_u32 v23, v10, 1, 1
v_add_u32 v23, s41, v23
v_xor_b32 v23, v23, v12
v_lshlrev_b32 v23, 4, v23
v_lshl_add_u32 v23, v13, 8, v23
v_and_b32 v12, 1, v11
v_lshl_add_u32 v23, v12, 11, v23
v_and_b32 v12, 1, v10
v_lshl_add_u32 v23, v12, 3, v23
v_lshrrev_b32 v12, 1, v11
v_mul_u32_u24 v12, 20480, v12
v_add_u32 v12, 114688, v12
v_add_u32 v23, v23, v12
s_waitcnt vmcnt(25)
s_barrier
ds_read_b64_tr_b16 v[80:81], v16 offset:0
ds_read_b64_tr_b16 v[82:83], v16 offset:1024
ds_read_b64_tr_b16 v[84:85], v18 offset:0
ds_read_b64_tr_b16 v[86:87], v18 offset:1024
ds_read_b64_tr_b16 v[152:153], v17 offset:0
ds_read_b64_tr_b16 v[154:155], v17 offset:1024
ds_read_b64_tr_b16 v[156:157], v19 offset:0
ds_read_b64_tr_b16 v[158:159], v19 offset:1024
s_waitcnt lgkmcnt(0)
s_waitcnt vmcnt(21)
s_barrier
s_add_u32 s37, s39, 2621440
s_add_u32 m0, s38, 0
s_nop 0
buffer_load_dwordx4 v5, s[12:15], s37 offen lds
s_add_u32 s37, s39, 2654208
s_add_u32 m0, s38, 1024
s_nop 0
buffer_load_dwordx4 v5, s[12:15], s37 offen lds
s_add_u32 s37, s39, 2686976
s_add_u32 m0, s38, 2048
s_nop 0
buffer_load_dwordx4 v6, s[12:15], s37 offen lds
s_add_u32 s37, s39, 2719744
s_add_u32 m0, s38, 3072
s_nop 0
buffer_load_dwordx4 v6, s[12:15], s37 offen lds
ds_read_b64_tr_b16 v[88:89], v16 offset:4096
ds_read_b64_tr_b16 v[90:91], v16 offset:5120
ds_read_b64_tr_b16 v[92:93], v18 offset:4096
ds_read_b64_tr_b16 v[94:95], v18 offset:5120
ds_read_b64_tr_b16 v[160:161], v17 offset:4096
ds_read_b64_tr_b16 v[162:163], v17 offset:5120
ds_read_b64_tr_b16 v[164:165], v19 offset:4096
ds_read_b64_tr_b16 v[166:167], v19 offset:5120
s_waitcnt lgkmcnt(0)
s_waitcnt vmcnt(21)
s_barrier
s_add_u32 s37, s39, 3145728
s_add_u32 m0, s38, 4096
s_nop 0
buffer_load_dwordx4 v5, s[12:15], s37 offen lds
s_add_u32 s37, s39, 3178496
s_add_u32 m0, s38, 5120
s_nop 0
buffer_load_dwordx4 v5, s[12:15], s37 offen lds
s_add_u32 s37, s39, 3211264
s_add_u32 m0, s38, 6144
s_nop 0
buffer_load_dwordx4 v6, s[12:15], s37 offen lds
s_add_u32 s37, s39, 3244032
s_add_u32 m0, s38, 7168
s_nop 0
buffer_load_dwordx4 v6, s[12:15], s37 offen lds
ds_read_b64_tr_b16 v[96:97], v16 offset:8192
ds_read_b64_tr_b16 v[98:99], v16 offset:9216
ds_read_b64_tr_b16 v[100:101], v18 offset:8192
ds_read_b64_tr_b16 v[102:103], v18 offset:9216
ds_read_b64_tr_b16 v[168:169], v17 offset:8192
ds_read_b64_tr_b16 v[170:171], v17 offset:9216
ds_read_b64_tr_b16 v[172:173], v19 offset:8192
ds_read_b64_tr_b16 v[174:175], v19 offset:9216
s_waitcnt lgkmcnt(0)
s_waitcnt vmcnt(21)
s_barrier
s_add_u32 s37, s39, 3670016
s_add_u32 m0, s38, 8192
s_nop 0
buffer_load_dwordx4 v5, s[12:15], s37 offen lds
s_add_u32 s37, s39, 3702784
s_add_u32 m0, s38, 9216
s_nop 0
buffer_load_dwordx4 v5, s[12:15], s37 offen lds
s_add_u32 s37, s39, 3735552
s_add_u32 m0, s38, 10240
s_nop 0
buffer_load_dwordx4 v6, s[12:15], s37 offen lds
s_add_u32 s37, s39, 3768320
s_add_u32 m0, s38, 11264
s_nop 0
buffer_load_dwordx4 v6, s[12:15], s37 offen lds
ds_read_b64_tr_b16 v[104:105], v16 offset:12288
ds_read_b64_tr_b16 v[106:107], v16 offset:13312
ds_read_b64_tr_b16 v[108:109], v18 offset:12288
ds_read_b64_tr_b16 v[110:111], v18 offset:13312
ds_read_b64_tr_b16 v[176:177], v17 offset:12288
ds_read_b64_tr_b16 v[178:179], v17 offset:13312
ds_read_b64_tr_b16 v[180:181], v19 offset:12288
ds_read_b64_tr_b16 v[182:183], v19 offset:13312
s_waitcnt lgkmcnt(0)
s_waitcnt vmcnt(21)
s_barrier
s_add_u32 s37, s39, 4194304
s_add_u32 m0, s38, 12288
s_nop 0
buffer_load_dwordx4 v5, s[12:15], s37 offen lds
s_add_u32 s37, s39, 4227072
s_add_u32 m0, s38, 13312
s_nop 0
buffer_load_dwordx4 v5, s[12:15], s37 offen lds
s_add_u32 s37, s39, 4259840
s_add_u32 m0, s38, 14336
s_nop 0
buffer_load_dwordx4 v6, s[12:15], s37 offen lds
s_add_u32 s37, s39, 4292608
s_add_u32 m0, s38, 15360
s_nop 0
buffer_load_dwordx4 v6, s[12:15], s37 offen lds
ds_read_b64_tr_b16 v[112:113], v16 offset:16384
ds_read_b64_tr_b16 v[114:115], v16 offset:17408
ds_read_b64_tr_b16 v[116:117], v18 offset:16384
ds_read_b64_tr_b16 v[118:119], v18 offset:17408
ds_read_b64_tr_b16 v[184:185], v17 offset:16384
ds_read_b64_tr_b16 v[186:187], v17 offset:17408
ds_read_b64_tr_b16 v[188:189], v19 offset:16384
ds_read_b64_tr_b16 v[190:191], v19 offset:17408
s_waitcnt lgkmcnt(0)
s_waitcnt vmcnt(12)
s_barrier
s_add_u32 s37, s39, 0
s_add_u32 m0, s38, 16384
s_nop 0
buffer_load_dwordx4 v5, s[16:19], s37 offen lds
s_add_u32 s37, s39, 32768
s_add_u32 m0, s38, 17408
s_nop 0
buffer_load_dwordx4 v5, s[16:19], s37 offen lds
s_add_u32 s37, s39, 65536
s_add_u32 m0, s38, 18432
s_nop 0
buffer_load_dwordx4 v6, s[16:19], s37 offen lds
s_add_u32 s37, s39, 98304
s_add_u32 m0, s38, 19456
s_nop 0
buffer_load_dwordx4 v6, s[16:19], s37 offen lds
ds_read_b64_tr_b16 v[120:121], v16 offset:0
ds_read_b64_tr_b16 v[122:123], v16 offset:1024
ds_read_b64_tr_b16 v[124:125], v18 offset:0
ds_read_b64_tr_b16 v[126:127], v18 offset:1024
ds_read_b64_tr_b16 v[192:193], v17 offset:0
ds_read_b64_tr_b16 v[194:195], v17 offset:1024
ds_read_b64_tr_b16 v[196:197], v19 offset:0
ds_read_b64_tr_b16 v[198:199], v19 offset:1024
s_waitcnt lgkmcnt(0)
s_waitcnt vmcnt(12)
s_barrier
s_add_u32 s37, s39, 524288
s_add_u32 m0, s38, 0
s_nop 0
buffer_load_dwordx4 v5, s[16:19], s37 offen lds
s_add_u32 s37, s39, 557056
s_add_u32 m0, s38, 1024
s_nop 0
buffer_load_dwordx4 v5, s[16:19], s37 offen lds
s_add_u32 s37, s39, 589824
s_add_u32 m0, s38, 2048
s_nop 0
buffer_load_dwordx4 v6, s[16:19], s37 offen lds
s_add_u32 s37, s39, 622592
s_add_u32 m0, s38, 3072
s_nop 0
buffer_load_dwordx4 v6, s[16:19], s37 offen lds
ds_read_b64_tr_b16 v[128:129], v16 offset:4096
ds_read_b64_tr_b16 v[130:131], v16 offset:5120
ds_read_b64_tr_b16 v[132:133], v18 offset:4096
ds_read_b64_tr_b16 v[134:135], v18 offset:5120
ds_read_b64_tr_b16 v[200:201], v17 offset:4096
ds_read_b64_tr_b16 v[202:203], v17 offset:5120
ds_read_b64_tr_b16 v[204:205], v19 offset:4096
ds_read_b64_tr_b16 v[206:207], v19 offset:5120
s_waitcnt lgkmcnt(0)
s_waitcnt vmcnt(12)
s_barrier
s_add_u32 s37, s39, 1048576
s_add_u32 m0, s38, 4096
s_nop 0
buffer_load_dwordx4 v5, s[16:19], s37 offen lds
s_add_u32 s37, s39, 1081344
s_add_u32 m0, s38, 5120
s_nop 0
buffer_load_dwordx4 v5, s[16:19], s37 offen lds
s_add_u32 s37, s39, 1114112
s_add_u32 m0, s38, 6144
s_nop 0
buffer_load_dwordx4 v6, s[16:19], s37 offen lds
s_add_u32 s37, s39, 1146880
s_add_u32 m0, s38, 7168
s_nop 0
buffer_load_dwordx4 v6, s[16:19], s37 offen lds
ds_read_b64_tr_b16 v[136:137], v16 offset:8192
ds_read_b64_tr_b16 v[138:139], v16 offset:9216
ds_read_b64_tr_b16 v[140:141], v18 offset:8192
ds_read_b64_tr_b16 v[142:143], v18 offset:9216
ds_read_b64_tr_b16 v[208:209], v17 offset:8192
ds_read_b64_tr_b16 v[210:211], v17 offset:9216
ds_read_b64_tr_b16 v[212:213], v19 offset:8192
ds_read_b64_tr_b16 v[214:215], v19 offset:9216
s_waitcnt lgkmcnt(0)
s_waitcnt vmcnt(12)
s_barrier
s_add_u32 s37, s39, 1572864
s_add_u32 m0, s38, 8192
s_nop 0
buffer_load_dwordx4 v5, s[16:19], s37 offen lds
s_add_u32 s37, s39, 1605632
s_add_u32 m0, s38, 9216
s_nop 0
buffer_load_dwordx4 v5, s[16:19], s37 offen lds
s_add_u32 s37, s39, 1638400
s_add_u32 m0, s38, 10240
s_nop 0
buffer_load_dwordx4 v6, s[16:19], s37 offen lds
s_add_u32 s37, s39, 1671168
s_add_u32 m0, s38, 11264
s_nop 0
buffer_load_dwordx4 v6, s[16:19], s37 offen lds
ds_read_b64_tr_b16 v[144:145], v16 offset:12288
ds_read_b64_tr_b16 v[146:147], v16 offset:13312
ds_read_b64_tr_b16 v[148:149], v18 offset:12288
ds_read_b64_tr_b16 v[150:151], v18 offset:13312
ds_read_b64_tr_b16 v[216:217], v17 offset:12288
ds_read_b64_tr_b16 v[218:219], v17 offset:13312
ds_read_b64_tr_b16 v[220:221], v19 offset:12288
ds_read_b64_tr_b16 v[222:223], v19 offset:13312
s_waitcnt lgkmcnt(0)
s_waitcnt vmcnt(12)
s_barrier
s_add_u32 s37, s39, 2097152
s_add_u32 m0, s38, 12288
s_nop 0
buffer_load_dwordx4 v5, s[16:19], s37 offen lds
s_add_u32 s37, s39, 2129920
s_add_u32 m0, s38, 13312
s_nop 0
buffer_load_dwordx4 v5, s[16:19], s37 offen lds
s_add_u32 s37, s39, 2162688
s_add_u32 m0, s38, 14336
s_nop 0
buffer_load_dwordx4 v6, s[16:19], s37 offen lds
s_add_u32 s37, s39, 2195456
s_add_u32 m0, s38, 15360
s_nop 0
buffer_load_dwordx4 v6, s[16:19], s37 offen lds
ds_read_b64_tr_b16 v[224:225], v16 offset:16384
ds_read_b64_tr_b16 v[226:227], v16 offset:17408
ds_read_b64_tr_b16 v[228:229], v18 offset:16384
ds_read_b64_tr_b16 v[230:231], v18 offset:17408
ds_read_b64_tr_b16 a[40:41], v17 offset:16384
ds_read_b64_tr_b16 a[42:43], v17 offset:17408
ds_read_b64_tr_b16 a[44:45], v19 offset:16384
ds_read_b64_tr_b16 a[46:47], v19 offset:17408
s_waitcnt lgkmcnt(0)
s_waitcnt vmcnt(12)
s_barrier
s_add_u32 s37, s39, 2621440
s_add_u32 m0, s38, 16384
s_nop 0
buffer_load_dwordx4 v5, s[16:19], s37 offen lds
s_add_u32 s37, s39, 2654208
s_add_u32 m0, s38, 17408
s_nop 0
buffer_load_dwordx4 v5, s[16:19], s37 offen lds
s_add_u32 s37, s39, 2686976
s_add_u32 m0, s38, 18432
s_nop 0
buffer_load_dwordx4 v6, s[16:19], s37 offen lds
s_add_u32 s37, s39, 2719744
s_add_u32 m0, s38, 19456
s_nop 0
buffer_load_dwordx4 v6, s[16:19], s37 offen lds
ds_read_b64_tr_b16 v[232:233], v16 offset:0
ds_read_b64_tr_b16 v[234:235], v16 offset:1024
ds_read_b64_tr_b16 v[236:237], v18 offset:0
ds_read_b64_tr_b16 v[238:239], v18 offset:1024
ds_read_b64_tr_b16 a[48:49], v17 offset:0
ds_read_b64_tr_b16 a[50:51], v17 offset:1024
ds_read_b64_tr_b16 a[52:53], v19 offset:0
ds_read_b64_tr_b16 a[54:55], v19 offset:1024
s_waitcnt lgkmcnt(0)
s_waitcnt vmcnt(12)
s_barrier
s_add_u32 s37, s39, 3145728
s_add_u32 m0, s38, 0
s_nop 0
buffer_load_dwordx4 v5, s[16:19], s37 offen lds
s_add_u32 s37, s39, 3178496
s_add_u32 m0, s38, 1024
s_nop 0
buffer_load_dwordx4 v5, s[16:19], s37 offen lds
s_add_u32 s37, s39, 3211264
s_add_u32 m0, s38, 2048
s_nop 0
buffer_load_dwordx4 v6, s[16:19], s37 offen lds
s_add_u32 s37, s39, 3244032
s_add_u32 m0, s38, 3072
s_nop 0
buffer_load_dwordx4 v6, s[16:19], s37 offen lds
ds_read_b64_tr_b16 v[240:241], v16 offset:4096
ds_read_b64_tr_b16 v[242:243], v16 offset:5120
ds_read_b64_tr_b16 v[244:245], v18 offset:4096
ds_read_b64_tr_b16 v[246:247], v18 offset:5120
ds_read_b64_tr_b16 a[56:57], v17 offset:4096
ds_read_b64_tr_b16 a[58:59], v17 offset:5120
ds_read_b64_tr_b16 a[60:61], v19 offset:4096
ds_read_b64_tr_b16 a[62:63], v19 offset:5120
s_waitcnt lgkmcnt(0)
s_waitcnt vmcnt(12)
s_barrier
s_add_u32 s37, s39, 3670016
s_add_u32 m0, s38, 4096
s_nop 0
buffer_load_dwordx4 v5, s[16:19], s37 offen lds
s_add_u32 s37, s39, 3702784
s_add_u32 m0, s38, 5120
s_nop 0
buffer_load_dwordx4 v5, s[16:19], s37 offen lds
s_add_u32 s37, s39, 3735552
s_add_u32 m0, s38, 6144
s_nop 0
buffer_load_dwordx4 v6, s[16:19], s37 offen lds
s_add_u32 s37, s39, 3768320
s_add_u32 m0, s38, 7168
s_nop 0
buffer_load_dwordx4 v6, s[16:19], s37 offen lds
ds_read_b64_tr_b16 v[248:249], v16 offset:8192
ds_read_b64_tr_b16 v[250:251], v16 offset:9216
ds_read_b64_tr_b16 v[252:253], v18 offset:8192
ds_read_b64_tr_b16 v[254:255], v18 offset:9216
ds_read_b64_tr_b16 a[64:65], v17 offset:8192
ds_read_b64_tr_b16 a[66:67], v17 offset:9216
ds_read_b64_tr_b16 a[68:69], v19 offset:8192
ds_read_b64_tr_b16 a[70:71], v19 offset:9216
s_waitcnt lgkmcnt(0)
s_waitcnt vmcnt(12)
s_barrier
s_add_u32 s37, s39, 4194304
s_add_u32 m0, s38, 8192
s_nop 0
buffer_load_dwordx4 v5, s[16:19], s37 offen lds
s_add_u32 s37, s39, 4227072
s_add_u32 m0, s38, 9216
s_nop 0
buffer_load_dwordx4 v5, s[16:19], s37 offen lds
s_add_u32 s37, s39, 4259840
s_add_u32 m0, s38, 10240
s_nop 0
buffer_load_dwordx4 v6, s[16:19], s37 offen lds
s_add_u32 s37, s39, 4292608
s_add_u32 m0, s38, 11264
s_nop 0
buffer_load_dwordx4 v6, s[16:19], s37 offen lds
ds_read_b64_tr_b16 a[0:1], v16 offset:12288
ds_read_b64_tr_b16 a[2:3], v16 offset:13312
ds_read_b64_tr_b16 a[4:5], v18 offset:12288
ds_read_b64_tr_b16 a[6:7], v18 offset:13312
ds_read_b64_tr_b16 a[72:73], v17 offset:12288
ds_read_b64_tr_b16 a[74:75], v17 offset:13312
ds_read_b64_tr_b16 a[76:77], v19 offset:12288
ds_read_b64_tr_b16 a[78:79], v19 offset:13312
s_waitcnt lgkmcnt(0)
s_waitcnt vmcnt(12)
s_barrier
s_add_u32 s37, s39, 0
s_add_u32 m0, s38, 12288
s_nop 0
buffer_load_dwordx4 v5, s[20:23], s37 offen lds
s_add_u32 s37, s39, 32768
s_add_u32 m0, s38, 13312
s_nop 0
buffer_load_dwordx4 v5, s[20:23], s37 offen lds
s_add_u32 s37, s39, 65536
s_add_u32 m0, s38, 14336
s_nop 0
buffer_load_dwordx4 v6, s[20:23], s37 offen lds
s_add_u32 s37, s39, 98304
s_add_u32 m0, s38, 15360
s_nop 0
buffer_load_dwordx4 v6, s[20:23], s37 offen lds
ds_read_b64_tr_b16 a[8:9], v16 offset:16384
ds_read_b64_tr_b16 a[10:11], v16 offset:17408
ds_read_b64_tr_b16 a[12:13], v18 offset:16384
ds_read_b64_tr_b16 a[14:15], v18 offset:17408
ds_read_b64_tr_b16 a[80:81], v17 offset:16384
ds_read_b64_tr_b16 a[82:83], v17 offset:17408
ds_read_b64_tr_b16 a[84:85], v19 offset:16384
ds_read_b64_tr_b16 a[86:87], v19 offset:17408
s_waitcnt lgkmcnt(0)
s_waitcnt vmcnt(12)
s_barrier
s_add_u32 s37, s39, 524288
s_add_u32 m0, s38, 16384
s_nop 0
buffer_load_dwordx4 v5, s[20:23], s37 offen lds
s_add_u32 s37, s39, 557056
s_add_u32 m0, s38, 17408
s_nop 0
buffer_load_dwordx4 v5, s[20:23], s37 offen lds
s_add_u32 s37, s39, 589824
s_add_u32 m0, s38, 18432
s_nop 0
buffer_load_dwordx4 v6, s[20:23], s37 offen lds
s_add_u32 s37, s39, 622592
s_add_u32 m0, s38, 19456
s_nop 0
buffer_load_dwordx4 v6, s[20:23], s37 offen lds
ds_read_b64_tr_b16 a[16:17], v16 offset:0
ds_read_b64_tr_b16 a[18:19], v16 offset:1024
ds_read_b64_tr_b16 a[20:21], v18 offset:0
ds_read_b64_tr_b16 a[22:23], v18 offset:1024
ds_read_b64_tr_b16 a[88:89], v17 offset:0
ds_read_b64_tr_b16 a[90:91], v17 offset:1024
ds_read_b64_tr_b16 a[92:93], v19 offset:0
ds_read_b64_tr_b16 a[94:95], v19 offset:1024
s_waitcnt lgkmcnt(0)
s_waitcnt vmcnt(12)
s_barrier
s_add_u32 s37, s39, 1048576
s_add_u32 m0, s38, 0
s_nop 0
buffer_load_dwordx4 v5, s[20:23], s37 offen lds
s_add_u32 s37, s39, 1081344
s_add_u32 m0, s38, 1024
s_nop 0
buffer_load_dwordx4 v5, s[20:23], s37 offen lds
s_add_u32 s37, s39, 1114112
s_add_u32 m0, s38, 2048
s_nop 0
buffer_load_dwordx4 v6, s[20:23], s37 offen lds
s_add_u32 s37, s39, 1146880
s_add_u32 m0, s38, 3072
s_nop 0
buffer_load_dwordx4 v6, s[20:23], s37 offen lds
ds_read_b64_tr_b16 a[24:25], v16 offset:4096
ds_read_b64_tr_b16 a[26:27], v16 offset:5120
ds_read_b64_tr_b16 a[28:29], v18 offset:4096
ds_read_b64_tr_b16 a[30:31], v18 offset:5120
ds_read_b64_tr_b16 a[96:97], v17 offset:4096
ds_read_b64_tr_b16 a[98:99], v17 offset:5120
ds_read_b64_tr_b16 a[100:101], v19 offset:4096
ds_read_b64_tr_b16 a[102:103], v19 offset:5120
s_waitcnt lgkmcnt(0)
s_waitcnt vmcnt(12)
s_barrier
s_add_u32 s37, s39, 1572864
s_add_u32 m0, s38, 4096
s_nop 0
buffer_load_dwordx4 v5, s[20:23], s37 offen lds
s_add_u32 s37, s39, 1605632
s_add_u32 m0, s38, 5120
s_nop 0
buffer_load_dwordx4 v5, s[20:23], s37 offen lds
s_add_u32 s37, s39, 1638400
s_add_u32 m0, s38, 6144
s_nop 0
buffer_load_dwordx4 v6, s[20:23], s37 offen lds
s_add_u32 s37, s39, 1671168
s_add_u32 m0, s38, 7168
s_nop 0
buffer_load_dwordx4 v6, s[20:23], s37 offen lds
ds_read_b64_tr_b16 a[32:33], v16 offset:8192
ds_read_b64_tr_b16 a[34:35], v16 offset:9216
ds_read_b64_tr_b16 a[36:37], v18 offset:8192
ds_read_b64_tr_b16 a[38:39], v18 offset:9216
ds_read_b64_tr_b16 a[104:105], v17 offset:8192
ds_read_b64_tr_b16 a[106:107], v17 offset:9216
ds_read_b64_tr_b16 a[108:109], v19 offset:8192
ds_read_b64_tr_b16 a[110:111], v19 offset:9216
s_waitcnt lgkmcnt(0)
s_waitcnt vmcnt(12)
s_barrier
s_add_u32 s37, s39, 2097152
s_add_u32 m0, s38, 8192
s_nop 0
buffer_load_dwordx4 v5, s[20:23], s37 offen lds
s_add_u32 s37, s39, 2129920
s_add_u32 m0, s38, 9216
s_nop 0
buffer_load_dwordx4 v5, s[20:23], s37 offen lds
s_add_u32 s37, s39, 2162688
s_add_u32 m0, s38, 10240
s_nop 0
buffer_load_dwordx4 v6, s[20:23], s37 offen lds
s_add_u32 s37, s39, 2195456
s_add_u32 m0, s38, 11264
s_nop 0
buffer_load_dwordx4 v6, s[20:23], s37 offen lds
ds_read_b64_tr_b16 a[112:113], v20 offset:12288
ds_read_b64_tr_b16 a[114:115], v20 offset:13312
ds_read_b64_tr_b16 a[116:117], v22 offset:12288
ds_read_b64_tr_b16 a[118:119], v22 offset:13312
ds_read_b64_tr_b16 a[184:185], v21 offset:12288
ds_read_b64_tr_b16 a[186:187], v21 offset:13312
ds_read_b64_tr_b16 a[188:189], v23 offset:12288
ds_read_b64_tr_b16 a[190:191], v23 offset:13312
s_waitcnt lgkmcnt(0)
s_waitcnt vmcnt(12)
s_barrier
s_add_u32 s37, s39, 2621440
s_add_u32 m0, s38, 12288
s_nop 0
buffer_load_dwordx4 v5, s[20:23], s37 offen lds
s_add_u32 s37, s39, 2654208
s_add_u32 m0, s38, 13312
s_nop 0
buffer_load_dwordx4 v5, s[20:23], s37 offen lds
s_add_u32 s37, s39, 2686976
s_add_u32 m0, s38, 14336
s_nop 0
buffer_load_dwordx4 v6, s[20:23], s37 offen lds
s_add_u32 s37, s39, 2719744
s_add_u32 m0, s38, 15360
s_nop 0
buffer_load_dwordx4 v6, s[20:23], s37 offen lds
ds_read_b64_tr_b16 a[120:121], v20 offset:16384
ds_read_b64_tr_b16 a[122:123], v20 offset:17408
ds_read_b64_tr_b16 a[124:125], v22 offset:16384
ds_read_b64_tr_b16 a[126:127], v22 offset:17408
ds_read_b64_tr_b16 a[192:193], v21 offset:16384
ds_read_b64_tr_b16 a[194:195], v21 offset:17408
ds_read_b64_tr_b16 a[196:197], v23 offset:16384
ds_read_b64_tr_b16 a[198:199], v23 offset:17408
s_waitcnt lgkmcnt(0)
s_waitcnt vmcnt(12)
s_barrier
s_add_u32 s37, s39, 3145728
s_add_u32 m0, s38, 16384
s_nop 0
buffer_load_dwordx4 v5, s[20:23], s37 offen lds
s_add_u32 s37, s39, 3178496
s_add_u32 m0, s38, 17408
s_nop 0
buffer_load_dwordx4 v5, s[20:23], s37 offen lds
s_add_u32 s37, s39, 3211264
s_add_u32 m0, s38, 18432
s_nop 0
buffer_load_dwordx4 v6, s[20:23], s37 offen lds
s_add_u32 s37, s39, 3244032
s_add_u32 m0, s38, 19456
s_nop 0
buffer_load_dwordx4 v6, s[20:23], s37 offen lds
ds_read_b64_tr_b16 a[128:129], v20 offset:0
ds_read_b64_tr_b16 a[130:131], v20 offset:1024
ds_read_b64_tr_b16 a[132:133], v22 offset:0
ds_read_b64_tr_b16 a[134:135], v22 offset:1024
ds_read_b64_tr_b16 a[200:201], v21 offset:0
ds_read_b64_tr_b16 a[202:203], v21 offset:1024
ds_read_b64_tr_b16 a[204:205], v23 offset:0
ds_read_b64_tr_b16 a[206:207], v23 offset:1024
s_waitcnt lgkmcnt(0)
s_waitcnt vmcnt(12)
s_barrier
s_add_u32 s37, s39, 3670016
s_add_u32 m0, s38, 0
s_nop 0
buffer_load_dwordx4 v5, s[20:23], s37 offen lds
s_add_u32 s37, s39, 3702784
s_add_u32 m0, s38, 1024
s_nop 0
buffer_load_dwordx4 v5, s[20:23], s37 offen lds
s_add_u32 s37, s39, 3735552
s_add_u32 m0, s38, 2048
s_nop 0
buffer_load_dwordx4 v6, s[20:23], s37 offen lds
s_add_u32 s37, s39, 3768320
s_add_u32 m0, s38, 3072
s_nop 0
buffer_load_dwordx4 v6, s[20:23], s37 offen lds
ds_read_b64_tr_b16 a[136:137], v20 offset:4096
ds_read_b64_tr_b16 a[138:139], v20 offset:5120
ds_read_b64_tr_b16 a[140:141], v22 offset:4096
ds_read_b64_tr_b16 a[142:143], v22 offset:5120
ds_read_b64_tr_b16 a[208:209], v21 offset:4096
ds_read_b64_tr_b16 a[210:211], v21 offset:5120
ds_read_b64_tr_b16 a[212:213], v23 offset:4096
ds_read_b64_tr_b16 a[214:215], v23 offset:5120
s_waitcnt lgkmcnt(0)
s_waitcnt vmcnt(12)
s_barrier
s_add_u32 s37, s39, 4194304
s_add_u32 m0, s38, 4096
s_nop 0
buffer_load_dwordx4 v5, s[20:23], s37 offen lds
s_add_u32 s37, s39, 4227072
s_add_u32 m0, s38, 5120
s_nop 0
buffer_load_dwordx4 v5, s[20:23], s37 offen lds
s_add_u32 s37, s39, 4259840
s_add_u32 m0, s38, 6144
s_nop 0
buffer_load_dwordx4 v6, s[20:23], s37 offen lds
s_add_u32 s37, s39, 4292608
s_add_u32 m0, s38, 7168
s_nop 0
buffer_load_dwordx4 v6, s[20:23], s37 offen lds
ds_read_b64_tr_b16 a[144:145], v20 offset:8192
ds_read_b64_tr_b16 a[146:147], v20 offset:9216
ds_read_b64_tr_b16 a[148:149], v22 offset:8192
ds_read_b64_tr_b16 a[150:151], v22 offset:9216
ds_read_b64_tr_b16 a[216:217], v21 offset:8192
ds_read_b64_tr_b16 a[218:219], v21 offset:9216
ds_read_b64_tr_b16 a[220:221], v23 offset:8192
ds_read_b64_tr_b16 a[222:223], v23 offset:9216
s_waitcnt lgkmcnt(0)
s_waitcnt vmcnt(12)
s_barrier
ds_read_b64_tr_b16 a[152:153], v20 offset:12288
ds_read_b64_tr_b16 a[154:155], v20 offset:13312
ds_read_b64_tr_b16 a[156:157], v22 offset:12288
ds_read_b64_tr_b16 a[158:159], v22 offset:13312
ds_read_b64_tr_b16 a[224:225], v21 offset:12288
ds_read_b64_tr_b16 a[226:227], v21 offset:13312
ds_read_b64_tr_b16 a[228:229], v23 offset:12288
ds_read_b64_tr_b16 a[230:231], v23 offset:13312
s_waitcnt lgkmcnt(0)
s_waitcnt vmcnt(8)
s_barrier
ds_read_b64_tr_b16 a[160:161], v20 offset:16384
ds_read_b64_tr_b16 a[162:163], v20 offset:17408
ds_read_b64_tr_b16 a[164:165], v22 offset:16384
ds_read_b64_tr_b16 a[166:167], v22 offset:17408
ds_read_b64_tr_b16 a[232:233], v21 offset:16384
ds_read_b64_tr_b16 a[234:235], v21 offset:17408
ds_read_b64_tr_b16 a[236:237], v23 offset:16384
ds_read_b64_tr_b16 a[238:239], v23 offset:17408
s_waitcnt lgkmcnt(0)
s_waitcnt vmcnt(4)
s_barrier
ds_read_b64_tr_b16 a[168:169], v20 offset:0
ds_read_b64_tr_b16 a[170:171], v20 offset:1024
ds_read_b64_tr_b16 a[172:173], v22 offset:0
ds_read_b64_tr_b16 a[174:175], v22 offset:1024
ds_read_b64_tr_b16 a[240:241], v21 offset:0
ds_read_b64_tr_b16 a[242:243], v21 offset:1024
ds_read_b64_tr_b16 a[244:245], v23 offset:0
ds_read_b64_tr_b16 a[246:247], v23 offset:1024
s_waitcnt lgkmcnt(0)
s_waitcnt vmcnt(0)
s_barrier
ds_read_b64_tr_b16 a[176:177], v20 offset:4096
ds_read_b64_tr_b16 a[178:179], v20 offset:5120
ds_read_b64_tr_b16 a[180:181], v22 offset:4096
ds_read_b64_tr_b16 a[182:183], v22 offset:5120
ds_read_b64_tr_b16 a[248:249], v21 offset:4096
ds_read_b64_tr_b16 a[250:251], v21 offset:5120
ds_read_b64_tr_b16 a[252:253], v23 offset:4096
ds_read_b64_tr_b16 a[254:255], v23 offset:5120
s_waitcnt lgkmcnt(0)
s_lshl_b32 s42, s33, 5
s_add_u32 s42, s42, s32
s_lshl_b32 s39, s42, 13
s_lshl_b32 s37, s34, 11
s_add_u32 s39, s39, s37
s_add_u32 s39, s39, 50331648
s_lshl_b32 s40, s42, 14
s_add_u32 s40, s40, 16777216
s_lshl_b32 s37, s34, 12
s_add_u32 s41, s40, s37
s_lshr_b32 s37, s34, 1
s_lshl_b32 s37, s37, 10
s_add_u32 s40, s40, s37
s_and_b32 s37, s34, 1
s_lshl_b32 s37, s37, 6
s_add_u32 s40, s40, s37
s_mov_b32 s35, 0
s_mov_b32 s48, 36864
s_lshl_b32 s49, s32, 5
s_lshl_b32 s37, s33, 2
s_add_u32 s49, s49, s37
s_add_u32 s49, s49, s34
s_lshl_b32 s49, s49, 2
s_add_u32 s49, s49, 327680
s_branch L_q_init_in
L_q_init:
s_sleep 4
L_q_init_in:
buffer_load_dword v12, v8, s[24:27], 0 offen offset:0 sc0 sc1
s_sub_u32 s36, s36, 1
s_cbranch_scc1 L_exit_w
s_waitcnt vmcnt(0)
v_readfirstlane_b32 s37, v12
s_nop 0
s_and_b32 s37, s37, 0xff
s_cmp_eq_u32 s37, 32
s_cbranch_scc0 L_q_init
.p2align 6
L_q_loop:
s_waitcnt vmcnt(7)
s_barrier
s_add_u32 s43, s43, 147456
s_add_u32 s44, s44, s48
ds_read_b128 v[64:67], v3 offset:0
ds_read_b128 v[68:71], v3 offset:1024
ds_read_b128 v[72:75], v3 offset:2048
ds_read_b128 v[76:79], v3 offset:3072
s_waitcnt lgkmcnt(2)
v_mfma_f32_16x16x32_bf16 v[16:19], v[80:83], v[64:67], 0
v_mfma_f32_16x16x32_bf16 v[20:23], v[80:83], v[68:71], 0
v_mfma_f32_16x16x32_bf16 v[24:27], v[152:155], v[64:67], 0
v_mfma_f32_16x16x32_bf16 v[28:31], v[152:155], v[68:71], 0
s_add_u32 s37, s43, 0
s_add_u32 m0, s44, 0
s_nop 0
buffer_load_dwordx4 v2, s[8:11], s37 offen lds
v_mfma_f32_16x16x32_bf16 v[32:35], v[224:227], v[64:67], 0
v_mfma_f32_16x16x32_bf16 v[36:39], v[224:227], v[68:71], 0
v_mfma_f32_16x16x32_bf16 v[40:43], a[40:43], v[64:67], 0
v_mfma_f32_16x16x32_bf16 v[44:47], a[40:43], v[68:71], 0
v_mfma_f32_16x16x32_bf16 v[48:51], v[64:67], a[112:115], 0
v_mfma_f32_16x16x32_bf16 v[52:55], v[68:71], a[112:115], 0
v_mfma_f32_16x16x32_bf16 v[56:59], v[64:67], a[184:187], 0
v_mfma_f32_16x16x32_bf16 v[60:63], v[68:71], a[184:187], 0
ds_read_b128 v[64:67], v3 offset:4096
ds_read_b128 v[68:71], v3 offset:5120
s_waitcnt lgkmcnt(2)
v_mfma_f32_16x16x32_bf16 v[16:19], v[84:87], v[72:75], v[16:19]
v_mfma_f32_16x16x32_bf16 v[20:23], v[84:87], v[76:79], v[20:23]
v_mfma_f32_16x16x32_bf16 v[24:27], v[156:159], v[72:75], v[24:27]
v_mfma_f32_16x16x32_bf16 v[28:31], v[156:159], v[76:79], v[28:31]
s_add_u32 s37, s43, 128
s_add_u32 m0, s44, 4096
s_nop 0
buffer_load_dwordx4 v2, s[8:11], s37 offen lds
v_mfma_f32_16x16x32_bf16 v[32:35], v[228:231], v[72:75], v[32:35]
v_mfma_f32_16x16x32_bf16 v[36:39], v[228:231], v[76:79], v[36:39]
v_mfma_f32_16x16x32_bf16 v[40:43], a[44:47], v[72:75], v[40:43]
v_mfma_f32_16x16x32_bf16 v[44:47], a[44:47], v[76:79], v[44:47]
v_mfma_f32_16x16x32_bf16 v[48:51], v[72:75], a[116:119], v[48:51]
v_mfma_f32_16x16x32_bf16 v[52:55], v[76:79], a[116:119], v[52:55]
v_mfma_f32_16x16x32_bf16 v[56:59], v[72:75], a[188:191], v[56:59]
v_mfma_f32_16x16x32_bf16 v[60:63], v[76:79], a[188:191], v[60:63]
ds_read_b128 v[72:75], v3 offset:6144
ds_read_b128 v[76:79], v3 offset:7168
s_waitcnt lgkmcnt(2)
v_mfma_f32_16x16x32_bf16 v[16:19], v[88:91], v[64:67], v[16:19]
v_mfma_f32_16x16x32_bf16 v[20:23], v[88:91], v[68:71], v[20:23]
v_mfma_f32_16x16x32_bf16 v[24:27], v[160:163], v[64:67], v[24:27]
v_mfma_f32_16x16x32_bf16 v[28:31], v[160:163], v[68:71], v[28:31]
s_add_u32 s37, s43, 256
s_add_u32 m0, s44, 8192
s_nop 0
buffer_load_dwordx4 v2, s[8:11], s37 offen lds
v_mfma_f32_16x16x32_bf16 v[32:35], v[232:235], v[64:67], v[32:35]
v_mfma_f32_16x16x32_bf16 v[36:39], v[232:235], v[68:71], v[36:39]
v_mfma_f32_16x16x32_bf16 v[40:43], a[48:51], v[64:67], v[40:43]
v_mfma_f32_16x16x32_bf16 v[44:47], a[48:51], v[68:71], v[44:47]
v_mfma_f32_16x16x32_bf16 v[48:51], v[64:67], a[120:123], v[48:51]
v_mfma_f32_16x16x32_bf16 v[52:55], v[68:71], a[120:123], v[52:55]
v_mfma_f32_16x16x32_bf16 v[56:59], v[64:67], a[192:195], v[56:59]
v_mfma_f32_16x16x32_bf16 v[60:63], v[68:71], a[192:195], v[60:63]
ds_read_b128 v[64:67], v3 offset:8192
ds_read_b128 v[68:71], v3 offset:9216
s_waitcnt lgkmcnt(2)
v_mfma_f32_16x16x32_bf16 v[16:19], v[92:95], v[72:75], v[16:19]
v_mfma_f32_16x16x32_bf16 v[20:23], v[92:95], v[76:79], v[20:23]
v_mfma_f32_16x16x32_bf16 v[24:27], v[164:167], v[72:75], v[24:27]
v_mfma_f32_16x16x32_bf16 v[28:31], v[164:167], v[76:79], v[28:31]
s_add_u32 s37, s43, 384
s_add_u32 m0, s44, 12288
s_nop 0
buffer_load_dwordx4 v2, s[8:11], s37 offen lds
v_mfma_f32_16x16x32_bf16 v[32:35], v[236:239], v[72:75], v[32:35]
v_mfma_f32_16x16x32_bf16 v[36:39], v[236:239], v[76:79], v[36:39]
v_mfma_f32_16x16x32_bf16 v[40:43], a[52:55], v[72:75], v[40:43]
v_mfma_f32_16x16x32_bf16 v[44:47], a[52:55], v[76:79], v[44:47]
v_mfma_f32_16x16x32_bf16 v[48:51], v[72:75], a[124:127], v[48:51]
v_mfma_f32_16x16x32_bf16 v[52:55], v[76:79], a[124:127], v[52:55]
v_mfma_f32_16x16x32_bf16 v[56:59], v[72:75], a[196:199], v[56:59]
v_mfma_f32_16x16x32_bf16 v[60:63], v[76:79], a[196:199], v[60:63]
ds_read_b128 v[72:75], v3 offset:10240
ds_read_b128 v[76:79], v3 offset:11264
s_waitcnt lgkmcnt(2)
v_mfma_f32_16x16x32_bf16 v[16:19], v[96:99], v[64:67], v[16:19]
v_mfma_f32_16x16x32_bf16 v[20:23], v[96:99], v[68:71], v[20:23]
v_mfma_f32_16x16x32_bf16 v[24:27], v[168:171], v[64:67], v[24:27]
v_mfma_f32_16x16x32_bf16 v[28:31], v[168:171], v[68:71], v[28:31]
s_add_u32 s37, s43, 512
s_add_u32 m0, s44, 16384
s_nop 0
buffer_load_dwordx4 v2, s[8:11], s37 offen lds
v_mfma_f32_16x16x32_bf16 v[32:35], v[240:243], v[64:67], v[32:35]
v_mfma_f32_16x16x32_bf16 v[36:39], v[240:243], v[68:71], v[36:39]
v_mfma_f32_16x16x32_bf16 v[40:43], a[56:59], v[64:67], v[40:43]
v_mfma_f32_16x16x32_bf16 v[44:47], a[56:59], v[68:71], v[44:47]
v_mfma_f32_16x16x32_bf16 v[48:51], v[64:67], a[128:131], v[48:51]
v_mfma_f32_16x16x32_bf16 v[52:55], v[68:71], a[128:131], v[52:55]
v_mfma_f32_16x16x32_bf16 v[56:59], v[64:67], a[200:203], v[56:59]
v_mfma_f32_16x16x32_bf16 v[60:63], v[68:71], a[200:203], v[60:63]
ds_read_b128 v[64:67], v3 offset:12288
ds_read_b128 v[68:71], v3 offset:13312
s_waitcnt lgkmcnt(2)
v_mfma_f32_16x16x32_bf16 v[16:19], v[100:103], v[72:75], v[16:19]
v_mfma_f32_16x16x32_bf16 v[20:23], v[100:103], v[76:79], v[20:23]
v_mfma_f32_16x16x32_bf16 v[24:27], v[172:175], v[72:75], v[24:27]
v_mfma_f32_16x16x32_bf16 v[28:31], v[172:175], v[76:79], v[28:31]
s_add_u32 s37, s43, 640
s_add_u32 m0, s44, 20480
s_nop 0
buffer_load_dwordx4 v2, s[8:11], s37 offen lds
v_mfma_f32_16x16x32_bf16 v[32:35], v[244:247], v[72:75], v[32:35]
v_mfma_f32_16x16x32_bf16 v[36:39], v[244:247], v[76:79], v[36:39]
v_mfma_f32_16x16x32_bf16 v[40:43], a[60:63], v[72:75], v[40:43]
v_mfma_f32_16x16x32_bf16 v[44:47], a[60:63], v[76:79], v[44:47]
v_mfma_f32_16x16x32_bf16 v[48:51], v[72:75], a[132:135], v[48:51]
v_mfma_f32_16x16x32_bf16 v[52:55], v[76:79], a[132:135], v[52:55]
v_mfma_f32_16x16x32_bf16 v[56:59], v[72:75], a[204:207], v[56:59]
v_mfma_f32_16x16x32_bf16 v[60:63], v[76:79], a[204:207], v[60:63]
ds_read_b128 v[72:75], v3 offset:14336
ds_read_b128 v[76:79], v3 offset:15360
s_waitcnt lgkmcnt(2)
v_mfma_f32_16x16x32_bf16 v[16:19], v[104:107], v[64:67], v[16:19]
v_mfma_f32_16x16x32_bf16 v[20:23], v[104:107], v[68:71], v[20:23]
v_mfma_f32_16x16x32_bf16 v[24:27], v[176:179], v[64:67], v[24:27]
v_mfma_f32_16x16x32_bf16 v[28:31], v[176:179], v[68:71], v[28:31]
s_add_u32 s37, s43, 768
s_add_u32 m0, s44, 24576
s_nop 0
buffer_load_dwordx4 v2, s[8:11], s37 offen lds
v_mfma_f32_16x16x32_bf16 v[32:35], v[248:251], v[64:67], v[32:35]
v_mfma_f32_16x16x32_bf16 v[36:39], v[248:251], v[68:71], v[36:39]
v_mfma_f32_16x16x32_bf16 v[40:43], a[64:67], v[64:67], v[40:43]
v_mfma_f32_16x16x32_bf16 v[44:47], a[64:67], v[68:71], v[44:47]
v_mfma_f32_16x16x32_bf16 v[48:51], v[64:67], a[136:139], v[48:51]
v_mfma_f32_16x16x32_bf16 v[52:55], v[68:71], a[136:139], v[52:55]
v_mfma_f32_16x16x32_bf16 v[56:59], v[64:67], a[208:211], v[56:59]
v_mfma_f32_16x16x32_bf16 v[60:63], v[68:71], a[208:211], v[60:63]
ds_read_b128 v[64:67], v3 offset:16384
ds_read_b128 v[68:71], v3 offset:17408
s_waitcnt lgkmcnt(2)
v_mfma_f32_16x16x32_bf16 v[16:19], v[108:111], v[72:75], v[16:19]
v_mfma_f32_16x16x32_bf16 v[20:23], v[108:111], v[76:79], v[20:23]
v_mfma_f32_16x16x32_bf16 v[24:27], v[180:183], v[72:75], v[24:27]
v_mfma_f32_16x16x32_bf16 v[28:31], v[180:183], v[76:79], v[28:31]
s_add_u32 s37, s43, 896
s_add_u32 m0, s44, 28672
s_nop 0
buffer_load_dwordx4 v2, s[8:11], s37 offen lds
v_mfma_f32_16x16x32_bf16 v[32:35], v[252:255], v[72:75], v[32:35]
v_mfma_f32_16x16x32_bf16 v[36:39], v[252:255], v[76:79], v[36:39]
v_mfma_f32_16x16x32_bf16 v[40:43], a[68:71], v[72:75], v[40:43]
v_mfma_f32_16x16x32_bf16 v[44:47], a[68:71], v[76:79], v[44:47]
v_mfma_f32_16x16x32_bf16 v[48:51], v[72:75], a[140:143], v[48:51]
v_mfma_f32_16x16x32_bf16 v[52:55], v[76:79], a[140:143], v[52:55]
v_mfma_f32_16x16x32_bf16 v[56:59], v[72:75], a[212:215], v[56:59]
v_mfma_f32_16x16x32_bf16 v[60:63], v[76:79], a[212:215], v[60:63]
ds_read_b128 v[72:75], v3 offset:18432
ds_read_b128 v[76:79], v3 offset:19456
s_waitcnt lgkmcnt(2)
v_mfma_f32_16x16x32_bf16 v[16:19], v[112:115], v[64:67], v[16:19]
v_mfma_f32_16x16x32_bf16 v[20:23], v[112:115], v[68:71], v[20:23]
v_mfma_f32_16x16x32_bf16 v[24:27], v[184:187], v[64:67], v[24:27]
v_mfma_f32_16x16x32_bf16 v[28:31], v[184:187], v[68:71], v[28:31]
s_add_u32 s37, s43, 1024
s_add_u32 m0, s44, 32768
s_nop 0
buffer_load_dwordx4 v2, s[8:11], s37 offen lds
v_mfma_f32_16x16x32_bf16 v[32:35], a[0:3], v[64:67], v[32:35]
v_mfma_f32_16x16x32_bf16 v[36:39], a[0:3], v[68:71], v[36:39]
v_mfma_f32_16x16x32_bf16 v[40:43], a[72:75], v[64:67], v[40:43]
v_mfma_f32_16x16x32_bf16 v[44:47], a[72:75], v[68:71], v[44:47]
v_mfma_f32_16x16x32_bf16 v[48:51], v[64:67], a[144:147], v[48:51]
v_mfma_f32_16x16x32_bf16 v[52:55], v[68:71], a[144:147], v[52:55]
v_mfma_f32_16x16x32_bf16 v[56:59], v[64:67], a[216:219], v[56:59]
v_mfma_f32_16x16x32_bf16 v[60:63], v[68:71], a[216:219], v[60:63]
ds_read_b128 v[64:67], v3 offset:20480
ds_read_b128 v[68:71], v3 offset:21504
s_waitcnt lgkmcnt(2)
v_mfma_f32_16x16x32_bf16 v[16:19], v[116:119], v[72:75], v[16:19]
v_mfma_f32_16x16x32_bf16 v[20:23], v[116:119], v[76:79], v[20:23]
v_mfma_f32_16x16x32_bf16 v[24:27], v[188:191], v[72:75], v[24:27]
v_mfma_f32_16x16x32_bf16 v[28:31], v[188:191], v[76:79], v[28:31]
v_mfma_f32_16x16x32_bf16 v[32:35], a[4:7], v[72:75], v[32:35]
v_mfma_f32_16x16x32_bf16 v[36:39], a[4:7], v[76:79], v[36:39]
v_mfma_f32_16x16x32_bf16 v[40:43], a[76:79], v[72:75], v[40:43]
v_mfma_f32_16x16x32_bf16 v[44:47], a[76:79], v[76:79], v[44:47]
v_mfma_f32_16x16x32_bf16 v[48:51], v[72:75], a[148:151], v[48:51]
v_mfma_f32_16x16x32_bf16 v[52:55], v[76:79], a[148:151], v[52:55]
v_mfma_f32_16x16x32_bf16 v[56:59], v[72:75], a[220:223], v[56:59]
v_mfma_f32_16x16x32_bf16 v[60:63], v[76:79], a[220:223], v[60:63]
ds_read_b128 v[72:75], v3 offset:22528
ds_read_b128 v[76:79], v3 offset:23552
s_waitcnt lgkmcnt(2)
v_mfma_f32_16x16x32_bf16 v[16:19], v[120:123], v[64:67], v[16:19]
v_mfma_f32_16x16x32_bf16 v[20:23], v[120:123], v[68:71], v[20:23]
v_mfma_f32_16x16x32_bf16 v[24:27], v[192:195], v[64:67], v[24:27]
v_mfma_f32_16x16x32_bf16 v[28:31], v[192:195], v[68:71], v[28:31]
s_waitcnt vmcnt(9)
v_mov_b32 v12, s35
s_mov_b64 exec, 1
buffer_store_dword v12, v8, s[4:7], s49 offen sc0 sc1
s_mov_b64 exec, -1
v_mfma_f32_16x16x32_bf16 v[32:35], a[8:11], v[64:67], v[32:35]
v_mfma_f32_16x16x32_bf16 v[36:39], a[8:11], v[68:71], v[36:39]
v_mfma_f32_16x16x32_bf16 v[40:43], a[80:83], v[64:67], v[40:43]
v_mfma_f32_16x16x32_bf16 v[44:47], a[80:83], v[68:71], v[44:47]
v_mfma_f32_16x16x32_bf16 v[48:51], v[64:67], a[152:155], v[48:51]
v_mfma_f32_16x16x32_bf16 v[52:55], v[68:71], a[152:155], v[52:55]
v_mfma_f32_16x16x32_bf16 v[56:59], v[64:67], a[224:227], v[56:59]
v_mfma_f32_16x16x32_bf16 v[60:63], v[68:71], a[224:227], v[60:63]
ds_read_b128 v[64:67], v3 offset:24576
ds_read_b128 v[68:71], v3 offset:25600
s_waitcnt lgkmcnt(2)
v_mfma_f32_16x16x32_bf16 v[16:19], v[124:127], v[72:75], v[16:19]
v_mfma_f32_16x16x32_bf16 v[20:23], v[124:127], v[76:79], v[20:23]
v_mfma_f32_16x16x32_bf16 v[24:27], v[196:199], v[72:75], v[24:27]
v_mfma_f32_16x16x32_bf16 v[28:31], v[196:199], v[76:79], v[28:31]
v_mfma_f32_16x16x32_bf16 v[32:35], a[12:15], v[72:75], v[32:35]
v_mfma_f32_16x16x32_bf16 v[36:39], a[12:15], v[76:79], v[36:39]
v_mfma_f32_16x16x32_bf16 v[40:43], a[84:87], v[72:75], v[40:43]
v_mfma_f32_16x16x32_bf16 v[44:47], a[84:87], v[76:79], v[44:47]
v_mfma_f32_16x16x32_bf16 v[48:51], v[72:75], a[156:159], v[48:51]
v_mfma_f32_16x16x32_bf16 v[52:55], v[76:79], a[156:159], v[52:55]
v_mfma_f32_16x16x32_bf16 v[56:59], v[72:75], a[228:231], v[56:59]
v_mfma_f32_16x16x32_bf16 v[60:63], v[76:79], a[228:231], v[60:63]
ds_read_b128 v[72:75], v3 offset:26624
ds_read_b128 v[76:79], v3 offset:27648
s_waitcnt lgkmcnt(2)
v_mfma_f32_16x16x32_bf16 v[16:19], v[128:131], v[64:67], v[16:19]
v_mfma_f32_16x16x32_bf16 v[20:23], v[128:131], v[68:71], v[20:23]
v_mfma_f32_16x16x32_bf16 v[24:27], v[200:203], v[64:67], v[24:27]
v_mfma_f32_16x16x32_bf16 v[28:31], v[200:203], v[68:71], v[28:31]
v_mfma_f32_16x16x32_bf16 v[32:35], a[16:19], v[64:67], v[32:35]
v_mfma_f32_16x16x32_bf16 v[36:39], a[16:19], v[68:71], v[36:39]
v_mfma_f32_16x16x32_bf16 v[40:43], a[88:91], v[64:67], v[40:43]
v_mfma_f32_16x16x32_bf16 v[44:47], a[88:91], v[68:71], v[44:47]
v_mfma_f32_16x16x32_bf16 v[48:51], v[64:67], a[160:163], v[48:51]
v_mfma_f32_16x16x32_bf16 v[52:55], v[68:71], a[160:163], v[52:55]
v_mfma_f32_16x16x32_bf16 v[56:59], v[64:67], a[232:235], v[56:59]
v_mfma_f32_16x16x32_bf16 v[60:63], v[68:71], a[232:235], v[60:63]
ds_read_b128 v[64:67], v3 offset:28672
ds_read_b128 v[68:71], v3 offset:29696
s_waitcnt lgkmcnt(2)
v_mfma_f32_16x16x32_bf16 v[16:19], v[132:135], v[72:75], v[16:19]
v_mfma_f32_16x16x32_bf16 v[20:23], v[132:135], v[76:79], v[20:23]
v_mfma_f32_16x16x32_bf16 v[24:27], v[204:207], v[72:75], v[24:27]
v_mfma_f32_16x16x32_bf16 v[28:31], v[204:207], v[76:79], v[28:31]
v_mfma_f32_16x16x32_bf16 v[32:35], a[20:23], v[72:75], v[32:35]
v_mfma_f32_16x16x32_bf16 v[36:39], a[20:23], v[76:79], v[36:39]
v_mfma_f32_16x16x32_bf16 v[40:43], a[92:95], v[72:75], v[40:43]
v_mfma_f32_16x16x32_bf16 v[44:47], a[92:95], v[76:79], v[44:47]
v_mfma_f32_16x16x32_bf16 v[48:51], v[72:75], a[164:167], v[48:51]
v_mfma_f32_16x16x32_bf16 v[52:55], v[76:79], a[164:167], v[52:55]
v_mfma_f32_16x16x32_bf16 v[56:59], v[72:75], a[236:239], v[56:59]
v_mfma_f32_16x16x32_bf16 v[60:63], v[76:79], a[236:239], v[60:63]
ds_read_b128 v[72:75], v3 offset:30720
ds_read_b128 v[76:79], v3 offset:31744
s_waitcnt lgkmcnt(2)
v_mfma_f32_16x16x32_bf16 v[16:19], v[136:139], v[64:67], v[16:19]
v_mfma_f32_16x16x32_bf16 v[20:23], v[136:139], v[68:71], v[20:23]
v_mfma_f32_16x16x32_bf16 v[24:27], v[208:211], v[64:67], v[24:27]
v_mfma_f32_16x16x32_bf16 v[28:31], v[208:211], v[68:71], v[28:31]
v_mfma_f32_16x16x32_bf16 v[32:35], a[24:27], v[64:67], v[32:35]
v_mfma_f32_16x16x32_bf16 v[36:39], a[24:27], v[68:71], v[36:39]
v_mfma_f32_16x16x32_bf16 v[40:43], a[96:99], v[64:67], v[40:43]
v_mfma_f32_16x16x32_bf16 v[44:47], a[96:99], v[68:71], v[44:47]
v_mfma_f32_16x16x32_bf16 v[48:51], v[64:67], a[168:171], v[48:51]
v_mfma_f32_16x16x32_bf16 v[52:55], v[68:71], a[168:171], v[52:55]
v_mfma_f32_16x16x32_bf16 v[56:59], v[64:67], a[240:243], v[56:59]
v_mfma_f32_16x16x32_bf16 v[60:63], v[68:71], a[240:243], v[60:63]
ds_read_b128 v[64:67], v3 offset:32768
ds_read_b128 v[68:71], v3 offset:33792
s_waitcnt lgkmcnt(2)
v_mfma_f32_16x16x32_bf16 v[16:19], v[140:143], v[72:75], v[16:19]
v_mfma_f32_16x16x32_bf16 v[20:23], v[140:143], v[76:79], v[20:23]
v_mfma_f32_16x16x32_bf16 v[24:27], v[212:215], v[72:75], v[24:27]
v_mfma_f32_16x16x32_bf16 v[28:31], v[212:215], v[76:79], v[28:31]
v_mfma_f32_16x16x32_bf16 v[32:35], a[28:31], v[72:75], v[32:35]
v_mfma_f32_16x16x32_bf16 v[36:39], a[28:31], v[76:79], v[36:39]
v_mfma_f32_16x16x32_bf16 v[40:43], a[100:103], v[72:75], v[40:43]
v_mfma_f32_16x16x32_bf16 v[44:47], a[100:103], v[76:79], v[44:47]
v_mfma_f32_16x16x32_bf16 v[48:51], v[72:75], a[172:175], v[48:51]
v_mfma_f32_16x16x32_bf16 v[52:55], v[76:79], a[172:175], v[52:55]
v_mfma_f32_16x16x32_bf16 v[56:59], v[72:75], a[244:247], v[56:59]
v_mfma_f32_16x16x32_bf16 v[60:63], v[76:79], a[244:247], v[60:63]
ds_read_b128 v[72:75], v3 offset:34816
ds_read_b128 v[76:79], v3 offset:35840
s_waitcnt lgkmcnt(2)
v_mfma_f32_16x16x32_bf16 v[16:19], v[144:147], v[64:67], v[16:19]
v_mfma_f32_16x16x32_bf16 v[20:23], v[144:147], v[68:71], v[20:23]
v_mfma_f32_16x16x32_bf16 v[24:27], v[216:219], v[64:67], v[24:27]
v_mfma_f32_16x16x32_bf16 v[28:31], v[216:219], v[68:71], v[28:31]
v_mfma_f32_16x16x32_bf16 v[32:35], a[32:35], v[64:67], v[32:35]
v_mfma_f32_16x16x32_bf16 v[36:39], a[32:35], v[68:71], v[36:39]
v_mfma_f32_16x16x32_bf16 v[40:43], a[104:107], v[64:67], v[40:43]
v_mfma_f32_16x16x32_bf16 v[44:47], a[104:107], v[68:71], v[44:47]
v_mfma_f32_16x16x32_bf16 v[48:51], v[64:67], a[176:179], v[48:51]
v_mfma_f32_16x16x32_bf16 v[52:55], v[68:71], a[176:179], v[52:55]
v_mfma_f32_16x16x32_bf16 v[56:59], v[64:67], a[248:251], v[56:59]
v_mfma_f32_16x16x32_bf16 v[60:63], v[68:71], a[248:251], v[60:63]
s_waitcnt lgkmcnt(0)
v_mfma_f32_16x16x32_bf16 v[16:19], v[148:151], v[72:75], v[16:19]
v_mfma_f32_16x16x32_bf16 v[20:23], v[148:151], v[76:79], v[20:23]
v_mfma_f32_16x16x32_bf16 v[24:27], v[220:223], v[72:75], v[24:27]
v_mfma_f32_16x16x32_bf16 v[28:31], v[220:223], v[76:79], v[28:31]
v_mfma_f32_16x16x32_bf16 v[32:35], a[36:39], v[72:75], v[32:35]
v_mfma_f32_16x16x32_bf16 v[36:39], a[36:39], v[76:79], v[36:39]
v_mfma_f32_16x16x32_bf16 v[40:43], a[108:111], v[72:75], v[40:43]
v_mfma_f32_16x16x32_bf16 v[44:47], a[108:111], v[76:79], v[44:47]
v_mfma_f32_16x16x32_bf16 v[48:51], v[72:75], a[180:183], v[48:51]
v_mfma_f32_16x16x32_bf16 v[52:55], v[76:79], a[180:183], v[52:55]
v_mfma_f32_16x16x32_bf16 v[56:59], v[72:75], a[252:255], v[56:59]
v_mfma_f32_16x16x32_bf16 v[60:63], v[76:79], a[252:255], v[60:63]
v_add_u32 v3, s48, v3
s_sub_u32 s48, 0, s48
v_cvt_pk_bf16_f32 v64, v16, v17
v_cvt_pk_bf16_f32 v65, v18, v19
v_cvt_pk_bf16_f32 v66, v24, v25
v_cvt_pk_bf16_f32 v67, v26, v27
buffer_store_dwordx4 v[64:67], v1, s[4:7], s39 offen offset:0
v_cvt_pk_bf16_f32 v68, v20, v21
v_cvt_pk_bf16_f32 v69, v22, v23
v_cvt_pk_bf16_f32 v70, v28, v29
v_cvt_pk_bf16_f32 v71, v30, v31
buffer_store_dwordx4 v[68:71], v1, s[4:7], s39 offen offset:1024
v_pk_mul_f32 v[32:33], v[32:33], s[46:47]
v_pk_mul_f32 v[34:35], v[34:35], s[46:47]
v_pk_mul_f32 v[36:37], v[36:37], s[46:47]
v_pk_mul_f32 v[38:39], v[38:39], s[46:47]
v_pk_mul_f32 v[40:41], v[40:41], s[46:47]
v_pk_mul_f32 v[42:43], v[42:43], s[46:47]
v_pk_mul_f32 v[44:45], v[44:45], s[46:47]
v_pk_mul_f32 v[46:47], v[46:47], s[46:47]
v_cvt_pk_bf16_f32 v72, v32, v33
v_cvt_pk_bf16_f32 v73, v34, v35
v_cvt_pk_bf16_f32 v74, v40, v41
v_cvt_pk_bf16_f32 v75, v42, v43
buffer_store_dwordx4 v[72:75], v4, s[4:7], s40 offen offset:0 sc0 sc1
v_cvt_pk_bf16_f32 v76, v36, v37
v_cvt_pk_bf16_f32 v77, v38, v39
v_cvt_pk_bf16_f32 v78, v44, v45
v_cvt_pk_bf16_f32 v79, v46, v47
buffer_store_dwordx4 v[76:79], v4, s[4:7], s40 offen offset:128 sc0 sc1
v_cvt_pk_bf16_f32 v16, v48, v49
v_cvt_pk_bf16_f32 v17, v50, v51
v_cvt_pk_bf16_f32 v18, v52, v53
v_cvt_pk_bf16_f32 v19, v54, v55
buffer_store_dwordx4 v[16:19], v1, s[4:7], s41 offen offset:2048 sc0 sc1
v_cvt_pk_bf16_f32 v20, v56, v57
v_cvt_pk_bf16_f32 v21, v58, v59
v_cvt_pk_bf16_f32 v22, v60, v61
v_cvt_pk_bf16_f32 v23, v62, v63
buffer_store_dwordx4 v[20:23], v1, s[4:7], s41 offen offset:3072 sc0 sc1
s_add_u32 s39, s39, 1048576
s_add_u32 s40, s40, 2097152
s_add_u32 s41, s41, 2097152
s_add_u32 s35, s35, 1
s_cmp_lg_u32 s35, 1
s_cbranch_scc1 L_q_n1
s_waitcnt vmcnt(0)
v_mov_b32 v12, s35
s_mov_b64 exec, 1
buffer_store_dword v12, v8, s[4:7], s49 offen sc0 sc1
s_mov_b64 exec, -1
s_waitcnt vmcnt(0)
L_q_n1:
s_cmp_lt_u32 s35, 16
s_cbranch_scc1 L_q_loop
s_waitcnt vmcnt(0)
v_mov_b32 v12, s35
s_mov_b64 exec, 1
buffer_store_dword v12, v8, s[4:7], s49 offen sc0 sc1
s_mov_b64 exec, -1
s_barrier
s_lshr_b32 s37, s34, 1
s_and_b32 s38, s34, 1
s_lshl_b32 s50, s42, 13
s_lshl_b32 s39, s37, 10
s_add_u32 s50, s50, s39
s_add_u32 s50, s50, 50331648
s_lshl_b32 s52, s42, 14
s_add_u32 s52, s52, 16777216
s_lshl_b32 s39, s38, 13
s_add_u32 s53, s52, s39
s_mul_i32 s55, s33, 10240
s_add_u32 s55, s55, 8388608
s_and_b32 s59, s33, 1
s_sub_u32 s59, s59, 1
s_lshl_b32 s39, s33, 1
s_add_u32 s39, s39, s37
s_lshl_b32 s56, s39, 6
s_lshl_b32 s40, s32, 1
s_add_u32 s40, s40, s38
s_add_u32 s56, s56, s40
s_lshl_b32 s58, s56, 2
s_add_u32 s58, s58, 331776
s_lshl_b32 s56, s56, 11
s_add_u32 s56, s56, 67108864
s_mov_b32 s35, 0
s_lshl_b32 s37, s37, 4
v_add_u32 v12, s37, v10
v_lshlrev_b32 v13, 2, v11
v_sub_u32 v12, v12, v13
v_mov_b32 v13, 0xf149f2ca
v_cmp_le_i32 vcc, 0, v12
s_nop 1
v_cndmask_b32 v80, v13, v8, vcc
v_cmp_le_i32 vcc, 1, v12
s_nop 1
v_cndmask_b32 v81, v13, v8, vcc
v_cmp_le_i32 vcc, 2, v12
s_nop 1
v_cndmask_b32 v82, v13, v8, vcc
v_cmp_le_i32 vcc, 3, v12
s_nop 1
v_cndmask_b32 v83, v13, v8, vcc
v_cmp_le_i32 vcc, 16, v12
s_nop 1
v_cndmask_b32 v84, v13, v8, vcc
v_cmp_le_i32 vcc, 17, v12
s_nop 1
v_cndmask_b32 v85, v13, v8, vcc
v_cmp_le_i32 vcc, 18, v12
s_nop 1
v_cndmask_b32 v86, v13, v8, vcc
v_cmp_le_i32 vcc, 19, v12
s_nop 1
v_cndmask_b32 v87, v13, v8, vcc
v_cmp_gt_u32 vcc, 2, v11
s_nop 1
v_cndmask_b32 v88, v13, v8, vcc
v_cndmask_b32 v89, v13, v8, vcc
v_cndmask_b32 v90, v13, v8, vcc
v_cndmask_b32 v91, v13, v8, vcc
v_mov_b32 v92, 0x3f803f80
v_mov_b32 v93, 0x3f803f80
v_mov_b32 v94, 0x3f803f80
v_mov_b32 v95, 0x3f803f80
v_lshrrev_b32 v12, 1, v11
v_lshlrev_b32 v14, 8, v12
v_and_b32 v12, 1, v11
v_lshl_add_u32 v14, v12, 5, v14
v_bfe_u32 v12, v10, 1, 2
v_lshl_add_u32 v14, v12, 6, v14
v_and_b32 v12, 1, v10
v_lshl_add_u32 v14, v12, 4, v14
s_lshl_b32 s37, s34, 8
v_lshl_add_u32 v15, v9, 2, s37
s_lshl_b32 s37, s34, 10
v_add_u32 v6, s37, v1
s_lshl_b32 s38, s38, 11
v_add_u32 v3, s38, v1
v_and_b32 v12, 3, v10
v_cmp_eq_u32 vcc, 0, v12
s_nop 1
v_cndmask_b32 v5, 0, 1, vcc
L_at_loop:
s_add_u32 s51, s50, 4096
s_add_u32 s54, s53, 4096
s_add_u32 s60, s55, 4096
s_add_u32 s57, s55, 8192
buffer_load_dwordx4 v[16:19], v1, s[4:7], s50 offen offset:0
buffer_load_dwordx4 v[32:35], v4, s[4:7], s52 offen offset:0 sc1
buffer_load_dwordx4 v[48:51], v4, s[4:7], s52 offen offset:128 sc1
buffer_load_dwordx4 v[20:23], v1, s[4:7], s50 offen offset:2048
buffer_load_dwordx4 v[36:39], v4, s[4:7], s52 offen offset:64 sc1
buffer_load_dwordx4 v[52:55], v4, s[4:7], s52 offen offset:192 sc1
buffer_load_dwordx4 v[24:27], v1, s[4:7], s51 offen offset:0
buffer_load_dwordx4 v[40:43], v4, s[4:7], s52 offen offset:1024 sc1
buffer_load_dwordx4 v[56:59], v4, s[4:7], s52 offen offset:1152 sc1
buffer_load_dwordx4 v[28:31], v1, s[4:7], s51 offen offset:2048
buffer_load_dwordx4 v[44:47], v4, s[4:7], s52 offen offset:1088 sc1
buffer_load_dwordx4 v[60:63], v4, s[4:7], s52 offen offset:1216 sc1
buffer_load_dwordx4 v[64:67], v1, s[4:7], s53 offen offset:2048 sc1
buffer_load_dwordx4 v[68:71], v1, s[4:7], s53 offen offset:3072 sc1
buffer_load_dwordx4 v[72:75], v1, s[4:7], s54 offen offset:2048 sc1
buffer_load_dwordx4 v[76:79], v1, s[4:7], s54 offen offset:3072 sc1
s_waitcnt vmcnt(13)
v_mfma_f32_16x16x32_bf16 v[96:99], v[32:35], v[16:19], v[80:83]
v_mfma_f32_16x16x32_bf16 v[100:103], v[48:51], v[16:19], v[84:87]
s_waitcnt vmcnt(10)
v_mfma_f32_16x16x32_bf16 v[96:99], v[36:39], v[20:23], v[96:99]
v_mfma_f32_16x16x32_bf16 v[100:103], v[52:55], v[20:23], v[100:103]
s_waitcnt vmcnt(7)
v_mfma_f32_16x16x32_bf16 v[96:99], v[40:43], v[24:27], v[96:99]
v_mfma_f32_16x16x32_bf16 v[100:103], v[56:59], v[24:27], v[100:103]
s_waitcnt vmcnt(4)
v_mfma_f32_16x16x32_bf16 v[96:99], v[44:47], v[28:31], v[96:99]
v_mfma_f32_16x16x32_bf16 v[100:103], v[60:63], v[28:31], v[100:103]
s_nop 3
v_max3_f32 v160, v96, v97, v98
s_nop 2
v_max3_f32 v160, v160, v99, v100
v_max3_f32 v160, v160, v101, v102
v_max_f32 v160, v160, v103
s_branch L_at_in
L_at_poll:
s_sleep 2
L_at_in:
buffer_load_dwordx4 v[164:167], v6, s[4:7], s55 offen sc0 sc1
buffer_load_dwordx4 v[168:171], v6, s[4:7], s60 offen sc0 sc1
buffer_load_dword v172, v15, s[4:7], s57 offen sc0 sc1
s_sub_u32 s36, s36, 1
s_cbranch_scc1 L_exit_w
s_waitcnt vmcnt(0)
v_bitop3_b32 v12, v164, v168, s59 bitop3:0x7e
v_bitop3_b32 v13, v172, s59, v5 bitop3:0x28
v_and_or_b32 v12, v12, 1, v13
v_cmp_ne_u32 vcc, 0, v12
s_cbranch_vccnz L_at_poll
ds_write_b128 v6, v[164:167]
ds_write_b128 v6, v[168:171] offset:4096
ds_write_b32 v15, v172 offset:8192
s_waitcnt lgkmcnt(0)
s_barrier
ds_read_b128 v[176:179], v14 offset:0
ds_read_b128 v[180:183], v14 offset:512
ds_read_b128 v[184:187], v14 offset:1024
ds_read_b128 v[188:191], v14 offset:1536
s_waitcnt lgkmcnt(3)
v_mfma_f32_16x16x32_bf16 v[192:195], v[224:227], v[176:179], 0
v_mfma_f32_16x16x32_bf16 v[196:199], a[40:43], v[176:179], 0
v_mfma_f32_16x16x32_bf16 v[200:203], v[176:179], a[112:115], 0
v_mfma_f32_16x16x32_bf16 v[204:207], v[176:179], a[184:187], 0
ds_read_b128 v[176:179], v14 offset:2048
s_waitcnt lgkmcnt(3)
v_mfma_f32_16x16x32_bf16 v[192:195], v[228:231], v[180:183], v[192:195]
v_mfma_f32_16x16x32_bf16 v[196:199], a[44:47], v[180:183], v[196:199]
v_mfma_f32_16x16x32_bf16 v[200:203], v[180:183], a[116:119], v[200:203]
v_mfma_f32_16x16x32_bf16 v[204:207], v[180:183], a[188:191], v[204:207]
ds_read_b128 v[180:183], v14 offset:2560
s_waitcnt lgkmcnt(3)
v_mfma_f32_16x16x32_bf16 v[192:195], v[232:235], v[184:187], v[192:195]
v_mfma_f32_16x16x32_bf16 v[196:199], a[48:51], v[184:187], v[196:199]
v_mfma_f32_16x16x32_bf16 v[200:203], v[184:187], a[120:123], v[200:203]
v_mfma_f32_16x16x32_bf16 v[204:207], v[184:187], a[192:195], v[204:207]
ds_read_b128 v[184:187], v14 offset:3072
s_waitcnt lgkmcnt(3)
v_mfma_f32_16x16x32_bf16 v[192:195], v[236:239], v[188:191], v[192:195]
v_mfma_f32_16x16x32_bf16 v[196:199], a[52:55], v[188:191], v[196:199]
v_mfma_f32_16x16x32_bf16 v[200:203], v[188:191], a[124:127], v[200:203]
v_mfma_f32_16x16x32_bf16 v[204:207], v[188:191], a[196:199], v[204:207]
ds_read_b128 v[188:191], v14 offset:3584
s_waitcnt lgkmcnt(3)
v_mfma_f32_16x16x32_bf16 v[192:195], v[240:243], v[176:179], v[192:195]
v_mfma_f32_16x16x32_bf16 v[196:199], a[56:59], v[176:179], v[196:199]
v_mfma_f32_16x16x32_bf16 v[200:203], v[176:179], a[128:131], v[200:203]
v_mfma_f32_16x16x32_bf16 v[204:207], v[176:179], a[200:203], v[204:207]
ds_read_b128 v[176:179], v14 offset:4096
s_waitcnt lgkmcnt(3)
v_mfma_f32_16x16x32_bf16 v[192:195], v[244:247], v[180:183], v[192:195]
v_mfma_f32_16x16x32_bf16 v[196:199], a[60:63], v[180:183], v[196:199]
v_mfma_f32_16x16x32_bf16 v[200:203], v[180:183], a[132:135], v[200:203]
v_mfma_f32_16x16x32_bf16 v[204:207], v[180:183], a[204:207], v[204:207]
ds_read_b128 v[180:183], v14 offset:4608
s_waitcnt lgkmcnt(3)
v_mfma_f32_16x16x32_bf16 v[192:195], v[248:251], v[184:187], v[192:195]
v_mfma_f32_16x16x32_bf16 v[196:199], a[64:67], v[184:187], v[196:199]
v_mfma_f32_16x16x32_bf16 v[200:203], v[184:187], a[136:139], v[200:203]
v_mfma_f32_16x16x32_bf16 v[204:207], v[184:187], a[208:211], v[204:207]
ds_read_b128 v[184:187], v14 offset:5120
s_waitcnt lgkmcnt(3)
v_mfma_f32_16x16x32_bf16 v[192:195], v[252:255], v[188:191], v[192:195]
v_mfma_f32_16x16x32_bf16 v[196:199], a[68:71], v[188:191], v[196:199]
v_mfma_f32_16x16x32_bf16 v[200:203], v[188:191], a[140:143], v[200:203]
v_mfma_f32_16x16x32_bf16 v[204:207], v[188:191], a[212:215], v[204:207]
ds_read_b128 v[188:191], v14 offset:5632
s_waitcnt lgkmcnt(3)
v_mfma_f32_16x16x32_bf16 v[192:195], a[0:3], v[176:179], v[192:195]
v_mfma_f32_16x16x32_bf16 v[196:199], a[72:75], v[176:179], v[196:199]
v_mfma_f32_16x16x32_bf16 v[200:203], v[176:179], a[144:147], v[200:203]
v_mfma_f32_16x16x32_bf16 v[204:207], v[176:179], a[216:219], v[204:207]
ds_read_b128 v[176:179], v14 offset:6144
s_waitcnt lgkmcnt(3)
v_mfma_f32_16x16x32_bf16 v[192:195], a[4:7], v[180:183], v[192:195]
v_mfma_f32_16x16x32_bf16 v[196:199], a[76:79], v[180:183], v[196:199]
v_mfma_f32_16x16x32_bf16 v[200:203], v[180:183], a[148:151], v[200:203]
v_mfma_f32_16x16x32_bf16 v[204:207], v[180:183], a[220:223], v[204:207]
ds_read_b128 v[180:183], v14 offset:6656
s_waitcnt lgkmcnt(3)
v_mfma_f32_16x16x32_bf16 v[192:195], a[8:11], v[184:187], v[192:195]
v_mfma_f32_16x16x32_bf16 v[196:199], a[80:83], v[184:187], v[196:199]
v_mfma_f32_16x16x32_bf16 v[200:203], v[184:187], a[152:155], v[200:203]
v_mfma_f32_16x16x32_bf16 v[204:207], v[184:187], a[224:227], v[204:207]
ds_read_b128 v[184:187], v14 offset:7168
s_waitcnt lgkmcnt(3)
v_mfma_f32_16x16x32_bf16 v[192:195], a[12:15], v[188:191], v[192:195]
v_mfma_f32_16x16x32_bf16 v[196:199], a[84:87], v[188:191], v[196:199]
v_mfma_f32_16x16x32_bf16 v[200:203], v[188:191], a[156:159], v[200:203]
v_mfma_f32_16x16x32_bf16 v[204:207], v[188:191], a[228:231], v[204:207]
ds_read_b128 v[188:191], v14 offset:7680
s_waitcnt lgkmcnt(3)
v_mfma_f32_16x16x32_bf16 v[192:195], a[16:19], v[176:179], v[192:195]
v_mfma_f32_16x16x32_bf16 v[196:199], a[88:91], v[176:179], v[196:199]
v_mfma_f32_16x16x32_bf16 v[200:203], v[176:179], a[160:163], v[200:203]
v_mfma_f32_16x16x32_bf16 v[204:207], v[176:179], a[232:235], v[204:207]
ds_read_b128 v[176:179], v14 offset:8192
s_waitcnt lgkmcnt(3)
v_mfma_f32_16x16x32_bf16 v[192:195], a[20:23], v[180:183], v[192:195]
v_mfma_f32_16x16x32_bf16 v[196:199], a[92:95], v[180:183], v[196:199]
v_mfma_f32_16x16x32_bf16 v[200:203], v[180:183], a[164:167], v[200:203]
v_mfma_f32_16x16x32_bf16 v[204:207], v[180:183], a[236:239], v[204:207]
ds_read_b128 v[180:183], v14 offset:8704
s_waitcnt lgkmcnt(3)
v_mfma_f32_16x16x32_bf16 v[192:195], a[24:27], v[184:187], v[192:195]
v_mfma_f32_16x16x32_bf16 v[196:199], a[96:99], v[184:187], v[196:199]
v_mfma_f32_16x16x32_bf16 v[200:203], v[184:187], a[168:171], v[200:203]
v_mfma_f32_16x16x32_bf16 v[204:207], v[184:187], a[240:243], v[204:207]
s_waitcnt lgkmcnt(2)
v_mfma_f32_16x16x32_bf16 v[192:195], a[28:31], v[188:191], v[192:195]
v_mfma_f32_16x16x32_bf16 v[196:199], a[100:103], v[188:191], v[196:199]
v_mfma_f32_16x16x32_bf16 v[200:203], v[188:191], a[172:175], v[200:203]
v_mfma_f32_16x16x32_bf16 v[204:207], v[188:191], a[244:247], v[204:207]
s_waitcnt lgkmcnt(1)
v_mfma_f32_16x16x32_bf16 v[192:195], a[32:35], v[176:179], v[192:195]
v_mfma_f32_16x16x32_bf16 v[196:199], a[104:107], v[176:179], v[196:199]
v_mfma_f32_16x16x32_bf16 v[200:203], v[176:179], a[176:179], v[200:203]
v_mfma_f32_16x16x32_bf16 v[204:207], v[176:179], a[248:251], v[204:207]
s_waitcnt lgkmcnt(0)
v_mfma_f32_16x16x32_bf16 v[192:195], a[36:39], v[180:183], v[192:195]
v_mfma_f32_16x16x32_bf16 v[196:199], a[108:111], v[180:183], v[196:199]
v_mfma_f32_16x16x32_bf16 v[200:203], v[180:183], a[180:183], v[200:203]
v_mfma_f32_16x16x32_bf16 v[204:207], v[180:183], a[252:255], v[204:207]
v_mul_f32 v192, s46, v192
v_mul_f32 v193, s46, v193
v_mul_f32 v194, s46, v194
v_mul_f32 v195, s46, v195
v_mul_f32 v196, s46, v196
v_mul_f32 v197, s46, v197
v_mul_f32 v198, s46, v198
v_mul_f32 v199, s46, v199
v_cvt_pk_bf16_f32 v208, v192, v193
v_cvt_pk_bf16_f32 v209, v194, v195
v_cvt_pk_bf16_f32 v210, v196, v197
v_cvt_pk_bf16_f32 v211, v198, v199
ds_write_b128 v6, v[208:211] offset:9216
v_cvt_pk_bf16_f32 v212, v200, v201
v_cvt_pk_bf16_f32 v213, v202, v203
v_cvt_pk_bf16_f32 v214, v204, v205
v_cvt_pk_bf16_f32 v215, v206, v207
ds_write_b128 v6, v[212:215] offset:13312
s_waitcnt lgkmcnt(0)
s_barrier
ds_read_b128 v[108:111], v1 offset:9216
ds_read_b128 v[112:115], v1 offset:10240
ds_read_b128 v[116:119], v1 offset:11264
ds_read_b128 v[120:123], v1 offset:12288
ds_read_b128 v[124:127], v3 offset:13312
ds_read_b128 v[128:131], v3 offset:14336
s_waitcnt lgkmcnt(5)
v_mfma_f32_16x16x32_bf16 v[104:107], v[108:111], v[16:19], v[88:91]
s_waitcnt lgkmcnt(4)
v_mfma_f32_16x16x32_bf16 v[104:107], v[112:115], v[20:23], v[104:107]
s_waitcnt lgkmcnt(3)
v_mfma_f32_16x16x32_bf16 v[104:107], v[116:119], v[24:27], v[104:107]
s_waitcnt lgkmcnt(2)
v_mfma_f32_16x16x32_bf16 v[104:107], v[120:123], v[28:31], v[104:107]
s_nop 7
v_max3_f32 v160, v160, v104, v105
v_max3_f32 v161, v160, v106, v107
v_max3_f32 v160, v160, v106, v107
s_nop 1
v_permlane16_swap_b32 v160, v161
v_max_f32 v162, v160, v161
v_max_f32 v163, v160, v161
s_nop 1
v_permlane32_swap_b32 v162, v163
v_max_f32 v160, v162, v163
v_pk_add_f32 v[96:97], v[96:97], v[160:161] op_sel_hi:[1,0] neg_lo:[0,1] neg_hi:[0,1]
v_pk_add_f32 v[98:99], v[98:99], v[160:161] op_sel_hi:[1,0] neg_lo:[0,1] neg_hi:[0,1]
v_pk_add_f32 v[100:101], v[100:101], v[160:161] op_sel_hi:[1,0] neg_lo:[0,1] neg_hi:[0,1]
v_pk_add_f32 v[102:103], v[102:103], v[160:161] op_sel_hi:[1,0] neg_lo:[0,1] neg_hi:[0,1]
v_pk_add_f32 v[104:105], v[104:105], v[160:161] op_sel_hi:[1,0] neg_lo:[0,1] neg_hi:[0,1]
v_pk_add_f32 v[106:107], v[106:107], v[160:161] op_sel_hi:[1,0] neg_lo:[0,1] neg_hi:[0,1]
v_exp_f32 v96, v96
v_exp_f32 v97, v97
v_exp_f32 v98, v98
v_exp_f32 v99, v99
v_exp_f32 v100, v100
v_exp_f32 v101, v101
v_exp_f32 v102, v102
v_exp_f32 v103, v103
v_exp_f32 v104, v104
v_exp_f32 v105, v105
v_exp_f32 v106, v106
v_exp_f32 v107, v107
v_cvt_pk_bf16_f32 v132, v96, v97
v_cvt_pk_bf16_f32 v133, v98, v99
v_cvt_pk_bf16_f32 v134, v100, v101
v_cvt_pk_bf16_f32 v135, v102, v103
v_cvt_pk_bf16_f32 v136, v104, v105
v_cvt_pk_bf16_f32 v137, v106, v107
v_mfma_f32_16x16x32_bf16 v[156:159], v[92:95], v[132:135], 0
v_mfma_f32_16x16x32_bf16 v[140:143], v[64:67], v[132:135], 0
v_mfma_f32_16x16x32_bf16 v[144:147], v[68:71], v[132:135], 0
v_mfma_f32_16x16x32_bf16 v[148:151], v[72:75], v[132:135], 0
v_mfma_f32_16x16x32_bf16 v[152:155], v[76:79], v[132:135], 0
s_waitcnt lgkmcnt(0)
v_mfma_f32_16x16x16_bf16 v[156:159], v[92:93], v[136:137], v[156:159]
v_mfma_f32_16x16x16_bf16 v[140:143], v[124:125], v[136:137], v[140:143]
v_mfma_f32_16x16x16_bf16 v[144:147], v[126:127], v[136:137], v[144:147]
v_mfma_f32_16x16x16_bf16 v[148:151], v[128:129], v[136:137], v[148:151]
v_mfma_f32_16x16x16_bf16 v[152:155], v[130:131], v[136:137], v[152:155]
v_rcp_f32 v156, v156
s_nop 0
v_mul_f32 v140, v140, v156
v_mul_f32 v141, v141, v156
v_mul_f32 v142, v142, v156
v_mul_f32 v143, v143, v156
v_mul_f32 v144, v144, v156
v_mul_f32 v145, v145, v156
v_mul_f32 v146, v146, v156
v_mul_f32 v147, v147, v156
v_cvt_pk_bf16_f32 v140, v140, v141
v_cvt_pk_bf16_f32 v141, v142, v143
v_cvt_pk_bf16_f32 v142, v144, v145
v_cvt_pk_bf16_f32 v143, v146, v147
buffer_store_dwordx4 v[140:143], v1, s[4:7], s56 offen offset:0 sc0 sc1
v_mul_f32 v148, v148, v156
v_mul_f32 v149, v149, v156
v_mul_f32 v150, v150, v156
v_mul_f32 v151, v151, v156
v_mul_f32 v152, v152, v156
v_mul_f32 v153, v153, v156
v_mul_f32 v154, v154, v156
v_mul_f32 v155, v155, v156
v_cvt_pk_bf16_f32 v148, v148, v149
v_cvt_pk_bf16_f32 v149, v150, v151
v_cvt_pk_bf16_f32 v150, v152, v153
v_cvt_pk_bf16_f32 v151, v154, v155
buffer_store_dwordx4 v[148:151], v1, s[4:7], s56 offen offset:1024 sc0 sc1
s_add_u32 s35, s35, 1
v_mov_b32 v13, s35
s_add_u32 s50, s50, 1048576
s_add_u32 s52, s52, 2097152
s_add_u32 s53, s53, 2097152
s_add_u32 s55, s55, 40960
s_add_u32 s56, s56, 1048576
s_waitcnt vmcnt(0)
s_mov_b64 exec, 1
buffer_store_dword v13, v8, s[4:7], s58 offen sc0 sc1
s_mov_b64 exec, -1
s_cmp_lt_u32 s35, 16
s_cbranch_scc1 L_at_loop
s_waitcnt vmcnt(0)
s_endpgm
L_role_aw:
s_load_dwordx2 s[4:5], s[0:1], 104
s_mov_b32 s6, 268435456
s_mov_b32 s7, 0x20000
s_load_dwordx2 s[8:9], s[0:1], 0
s_mov_b32 s10, 2359296
s_mov_b32 s11, 0x20000
s_load_dwordx2 s[12:13], s[0:1], 8
s_mov_b32 s14, 1990656
s_mov_b32 s15, 0x20000
s_load_dwordx2 s[16:17], s[0:1], 16
s_mov_b32 s18, 663552
s_mov_b32 s19, 0x20000
s_load_dwordx2 s[20:21], s[0:1], 64
s_mov_b32 s22, 4718592
s_mov_b32 s23, 0x20000
s_load_dwordx2 s[24:25], s[0:1], 96
s_mov_b32 s26, 256
s_mov_b32 s27, 0x20000
s_load_dwordx2 s[28:29], s[0:1], 88
s_mov_b32 s30, 2359296
s_mov_b32 s31, 0x20000
s_load_dwordx2 s[64:65], s[0:1], 80
s_mov_b32 s66, 1152
s_mov_b32 s67, 0x20000
s_load_dwordx2 s[68:69], s[0:1], 40
s_mov_b32 s70, 4718592
s_mov_b32 s71, 0x20000
s_load_dwordx2 s[72:73], s[0:1], 48
s_mov_b32 s74, 4718592
s_mov_b32 s75, 0x20000
s_load_dwordx2 s[76:77], s[0:1], 56
s_mov_b32 s78, 4718592
s_mov_b32 s79, 0x20000
s_mul_i32 s37, s48, 12
s_add_u32 s37, s37, s49
s_lshl_b32 s37, s37, 15
s_add_u32 s38, s37, 3145728
v_lshlrev_b32 v2, 7, v0
s_waitcnt lgkmcnt(0)
buffer_load_dword v64, v2, s[68:71], s37 offen
buffer_load_dword v65, v2, s[68:71], s38 offen
buffer_load_dword v66, v2, s[72:75], s37 offen
buffer_load_dword v67, v2, s[72:75], s38 offen
buffer_load_dword v68, v2, s[76:79], s37 offen
buffer_load_dword v69, v2, s[76:79], s38 offen
buffer_load_dword v70, v2, s[20:23], s37 offen
buffer_load_dword v71, v2, s[20:23], s38 offen
v_and_b32 v9, 63, v0
v_and_b32 v10, 15, v0
v_bfe_u32 v11, v0, 4, 2
v_lshrrev_b32 v1, 6, v0
s_nop 0
v_readfirstlane_b32 s34, v1
v_lshrrev_b32 v12, 2, v9
v_mul_u32_u24 v2, 1152, v12
v_lshrrev_b32 v12, 5, v9
v_lshlrev_b32 v12, 1, v12
v_and_b32 v13, 3, v9
v_xor_b32 v12, v12, v13
v_lshl_add_u32 v2, v12, 4, v2
v_lshrrev_b32 v12, 3, v10
v_lshlrev_b32 v12, 1, v12
v_xor_b32 v12, v12, v11
v_lshlrev_b32 v12, 4, v12
v_lshl_add_u32 v3, v10, 6, v12
v_lshrrev_b32 v12, 2, v10
v_lshl_add_u32 v12, v11, 3, v12
v_mul_u32_u24 v7, 64, v12
v_and_b32 v12, 3, v10
v_lshl_add_u32 v7, v12, 3, v7
v_lshlrev_b32 v1, 4, v9
s_mul_i32 s38, s34, 20480
s_add_u32 s38, s38, 73728
v_add_u32 v7, s38, v7
v_mov_b32 v8, 0
s_lshl_b32 s37, s34, 3
s_add_u32 s37, s37, 0
v_and_b32 v12, 3, v9
v_add_u32 v12, s37, v12
v_min_u32 v12, 26, v12
v_mul_u32_u24 v13, 57, v12
v_lshrrev_b32 v13, 9, v13
v_mul_u32_u24 v13, 1008, v13
v_lshl_add_u32 v13, v12, 4, v13
v_lshrrev_b32 v12, 2, v9
v_mul_u32_u24 v12, 3456, v12
v_add_u32 v5, v12, v13
s_lshl_b32 s37, s34, 3
s_add_u32 s37, s37, 4
v_and_b32 v12, 3, v9
v_add_u32 v12, s37, v12
v_min_u32 v12, 26, v12
v_mul_u32_u24 v13, 57, v12
v_lshrrev_b32 v13, 9, v13
v_mul_u32_u24 v13, 1008, v13
v_lshl_add_u32 v13, v12, 4, v13
v_lshrrev_b32 v12, 2, v9
v_mul_u32_u24 v12, 3456, v12
v_add_u32 v6, v12, v13
s_mul_i32 s39, s32, 144
s_mul_i32 s40, s33, 11
s_and_b32 s41, s34, 1
s_add_u32 s40, s40, s41
s_sub_u32 s40, s40, 1
s_max_i32 s41, s40, 0
s_lshr_b32 s42, s34, 1
s_lshl_b32 s42, s42, 6
s_mul_i32 s43, s41, 18432
s_add_u32 s43, s43, s42
s_mul_i32 s40, s40, 18432
s_add_u32 s40, s40, s42
s_lshl_b32 s44, s34, 10
s_mov_b32 s36, 400000
v_mul_u32_u24 v4, 456, v10
v_lshl_add_u32 v4, v11, 3, v4
s_lshl_b32 s37, s34, 7
s_add_u32 s37, s37, 73728
v_add_u32 v4, s37, v4
v_lshlrev_b32 v14, 2, v10
v_add_u32 v14, 161280, v14
s_waitcnt lgkmcnt(0)
s_add_u32 s37, s39, 0
s_add_u32 m0, s38, 0
s_nop 0
buffer_load_dwordx4 v5, s[12:15], s37 offen lds
s_add_u32 s37, s39, 55296
s_add_u32 m0, s38, 1024
s_nop 0
buffer_load_dwordx4 v5, s[12:15], s37 offen lds
s_add_u32 s37, s39, 110592
s_add_u32 m0, s38, 2048
s_nop 0
buffer_load_dwordx4 v5, s[12:15], s37 offen lds
s_add_u32 s37, s39, 165888
s_add_u32 m0, s38, 3072
s_nop 0
buffer_load_dwordx4 v5, s[12:15], s37 offen lds
s_add_u32 s37, s39, 221184
s_add_u32 m0, s38, 4096
s_nop 0
buffer_load_dwordx4 v5, s[12:15], s37 offen lds
s_add_u32 s37, s39, 276480
s_add_u32 m0, s38, 5120
s_nop 0
buffer_load_dwordx4 v5, s[12:15], s37 offen lds
s_add_u32 s37, s39, 331776
s_add_u32 m0, s38, 6144
s_nop 0
buffer_load_dwordx4 v5, s[12:15], s37 offen lds
s_add_u32 s37, s39, 387072
s_add_u32 m0, s38, 7168
s_nop 0
buffer_load_dwordx4 v5, s[12:15], s37 offen lds
s_add_u32 s37, s39, 442368
s_add_u32 m0, s38, 8192
s_nop 0
buffer_load_dwordx4 v5, s[12:15], s37 offen lds
s_add_u32 s37, s39, 497664
s_add_u32 m0, s38, 9216
s_nop 0
buffer_load_dwordx4 v5, s[12:15], s37 offen lds
s_add_u32 s37, s39, 552960
s_add_u32 m0, s38, 10240
s_nop 0
buffer_load_dwordx4 v5, s[12:15], s37 offen lds
s_add_u32 s37, s39, 608256
s_add_u32 m0, s38, 11264
s_nop 0
buffer_load_dwordx4 v5, s[12:15], s37 offen lds
s_add_u32 s37, s39, 663552
s_add_u32 m0, s38, 12288
s_nop 0
buffer_load_dwordx4 v5, s[12:15], s37 offen lds
s_add_u32 s37, s39, 718848
s_add_u32 m0, s38, 13312
s_nop 0
buffer_load_dwordx4 v5, s[12:15], s37 offen lds
s_add_u32 s37, s39, 774144
s_add_u32 m0, s38, 14336
s_nop 0
buffer_load_dwordx4 v5, s[12:15], s37 offen lds
s_add_u32 s37, s39, 829440
s_add_u32 m0, s38, 15360
s_nop 0
buffer_load_dwordx4 v5, s[12:15], s37 offen lds
s_add_u32 s37, s43, 0
s_add_u32 m0, s44, 0
s_nop 0
buffer_load_dwordx4 v2, s[8:11], s37 offen lds
s_add_u32 s37, s43, 128
s_add_u32 m0, s44, 4096
s_nop 0
buffer_load_dwordx4 v2, s[8:11], s37 offen lds
s_add_u32 s37, s43, 256
s_add_u32 m0, s44, 8192
s_nop 0
buffer_load_dwordx4 v2, s[8:11], s37 offen lds
s_add_u32 s37, s43, 384
s_add_u32 m0, s44, 12288
s_nop 0
buffer_load_dwordx4 v2, s[8:11], s37 offen lds
s_add_u32 s37, s43, 512
s_add_u32 m0, s44, 16384
s_nop 0
buffer_load_dwordx4 v2, s[8:11], s37 offen lds
s_add_u32 s37, s43, 640
s_add_u32 m0, s44, 20480
s_nop 0
buffer_load_dwordx4 v2, s[8:11], s37 offen lds
s_add_u32 s37, s43, 768
s_add_u32 m0, s44, 24576
s_nop 0
buffer_load_dwordx4 v2, s[8:11], s37 offen lds
s_add_u32 s37, s43, 896
s_add_u32 m0, s44, 28672
s_nop 0
buffer_load_dwordx4 v2, s[8:11], s37 offen lds
s_add_u32 s37, s43, 1024
s_add_u32 m0, s44, 32768
s_nop 0
buffer_load_dwordx4 v2, s[8:11], s37 offen lds
s_waitcnt vmcnt(21)
ds_read_b64_tr_b16 v[80:81], v7 offset:0
ds_read_b64_tr_b16 v[82:83], v7 offset:256
ds_read_b64_tr_b16 v[84:85], v7 offset:2048
ds_read_b64_tr_b16 v[86:87], v7 offset:2304
ds_read_b64_tr_b16 v[152:153], v7 offset:32
ds_read_b64_tr_b16 v[154:155], v7 offset:288
ds_read_b64_tr_b16 v[156:157], v7 offset:2080
ds_read_b64_tr_b16 v[158:159], v7 offset:2336
s_waitcnt lgkmcnt(0)
s_add_u32 s37, s39, 884736
s_add_u32 m0, s38, 16384
s_nop 0
buffer_load_dwordx4 v5, s[12:15], s37 offen lds
s_add_u32 s37, s39, 940032
s_add_u32 m0, s38, 17408
s_nop 0
buffer_load_dwordx4 v5, s[12:15], s37 offen lds
s_add_u32 s37, s39, 995328
s_add_u32 m0, s38, 18432
s_nop 0
buffer_load_dwordx4 v5, s[12:15], s37 offen lds
s_add_u32 s37, s39, 1050624
s_add_u32 m0, s38, 19456
s_nop 0
buffer_load_dwordx4 v5, s[12:15], s37 offen lds
s_waitcnt vmcnt(21)
ds_read_b64_tr_b16 v[88:89], v7 offset:4096
ds_read_b64_tr_b16 v[90:91], v7 offset:4352
ds_read_b64_tr_b16 v[92:93], v7 offset:6144
ds_read_b64_tr_b16 v[94:95], v7 offset:6400
ds_read_b64_tr_b16 v[160:161], v7 offset:4128
ds_read_b64_tr_b16 v[162:163], v7 offset:4384
ds_read_b64_tr_b16 v[164:165], v7 offset:6176
ds_read_b64_tr_b16 v[166:167], v7 offset:6432
s_waitcnt lgkmcnt(0)
s_add_u32 s37, s39, 1105920
s_add_u32 m0, s38, 0
s_nop 0
buffer_load_dwordx4 v5, s[12:15], s37 offen lds
s_add_u32 s37, s39, 1161216
s_add_u32 m0, s38, 1024
s_nop 0
buffer_load_dwordx4 v5, s[12:15], s37 offen lds
s_add_u32 s37, s39, 1216512
s_add_u32 m0, s38, 2048
s_nop 0
buffer_load_dwordx4 v5, s[12:15], s37 offen lds
s_add_u32 s37, s39, 1271808
s_add_u32 m0, s38, 3072
s_nop 0
buffer_load_dwordx4 v5, s[12:15], s37 offen lds
s_waitcnt vmcnt(21)
ds_read_b64_tr_b16 v[96:97], v7 offset:8192
ds_read_b64_tr_b16 v[98:99], v7 offset:8448
ds_read_b64_tr_b16 v[100:101], v7 offset:10240
ds_read_b64_tr_b16 v[102:103], v7 offset:10496
ds_read_b64_tr_b16 v[168:169], v7 offset:8224
ds_read_b64_tr_b16 v[170:171], v7 offset:8480
ds_read_b64_tr_b16 v[172:173], v7 offset:10272
ds_read_b64_tr_b16 v[174:175], v7 offset:10528
s_waitcnt lgkmcnt(0)
s_add_u32 s37, s39, 1327104
s_add_u32 m0, s38, 4096
s_nop 0
buffer_load_dwordx4 v5, s[12:15], s37 offen lds
s_add_u32 s37, s39, 1382400
s_add_u32 m0, s38, 5120
s_nop 0
buffer_load_dwordx4 v5, s[12:15], s37 offen lds
s_add_u32 s37, s39, 1437696
s_add_u32 m0, s38, 6144
s_nop 0
buffer_load_dwordx4 v5, s[12:15], s37 offen lds
s_add_u32 s37, s39, 1492992
s_add_u32 m0, s38, 7168
s_nop 0
buffer_load_dwordx4 v5, s[12:15], s37 offen lds
s_waitcnt vmcnt(21)
ds_read_b64_tr_b16 v[104:105], v7 offset:12288
ds_read_b64_tr_b16 v[106:107], v7 offset:12544
ds_read_b64_tr_b16 v[108:109], v7 offset:14336
ds_read_b64_tr_b16 v[110:111], v7 offset:14592
ds_read_b64_tr_b16 v[176:177], v7 offset:12320
ds_read_b64_tr_b16 v[178:179], v7 offset:12576
ds_read_b64_tr_b16 v[180:181], v7 offset:14368
ds_read_b64_tr_b16 v[182:183], v7 offset:14624
s_waitcnt lgkmcnt(0)
s_add_u32 s37, s39, 1548288
s_add_u32 m0, s38, 8192
s_nop 0
buffer_load_dwordx4 v5, s[12:15], s37 offen lds
s_add_u32 s37, s39, 1603584
s_add_u32 m0, s38, 9216
s_nop 0
buffer_load_dwordx4 v5, s[12:15], s37 offen lds
s_add_u32 s37, s39, 1658880
s_add_u32 m0, s38, 10240
s_nop 0
buffer_load_dwordx4 v5, s[12:15], s37 offen lds
s_add_u32 s37, s39, 1714176
s_add_u32 m0, s38, 11264
s_nop 0
buffer_load_dwordx4 v5, s[12:15], s37 offen lds
s_waitcnt vmcnt(12)
ds_read_b64_tr_b16 v[112:113], v7 offset:16384
ds_read_b64_tr_b16 v[114:115], v7 offset:16640
ds_read_b64_tr_b16 v[116:117], v7 offset:18432
ds_read_b64_tr_b16 v[118:119], v7 offset:18688
ds_read_b64_tr_b16 v[184:185], v7 offset:16416
ds_read_b64_tr_b16 v[186:187], v7 offset:16672
ds_read_b64_tr_b16 v[188:189], v7 offset:18464
ds_read_b64_tr_b16 v[190:191], v7 offset:18720
s_waitcnt lgkmcnt(0)
s_add_u32 s37, s39, 1769472
s_add_u32 m0, s38, 12288
s_nop 0
buffer_load_dwordx4 v5, s[12:15], s37 offen lds
s_add_u32 s37, s39, 1824768
s_add_u32 m0, s38, 13312
s_nop 0
buffer_load_dwordx4 v5, s[12:15], s37 offen lds
s_add_u32 s37, s39, 1880064
s_add_u32 m0, s38, 14336
s_nop 0
buffer_load_dwordx4 v5, s[12:15], s37 offen lds
s_add_u32 s37, s39, 1935360
s_add_u32 m0, s38, 15360
s_nop 0
buffer_load_dwordx4 v5, s[12:15], s37 offen lds
s_waitcnt vmcnt(12)
ds_read_b64_tr_b16 v[120:121], v7 offset:0
ds_read_b64_tr_b16 v[122:123], v7 offset:256
ds_read_b64_tr_b16 v[124:125], v7 offset:2048
ds_read_b64_tr_b16 v[126:127], v7 offset:2304
ds_read_b64_tr_b16 v[192:193], v7 offset:32
ds_read_b64_tr_b16 v[194:195], v7 offset:288
ds_read_b64_tr_b16 v[196:197], v7 offset:2080
ds_read_b64_tr_b16 v[198:199], v7 offset:2336
s_waitcnt lgkmcnt(0)
s_add_u32 s37, s39, 0
s_add_u32 m0, s38, 16384
s_nop 0
buffer_load_dwordx4 v6, s[12:15], s37 offen lds
s_add_u32 s37, s39, 55296
s_add_u32 m0, s38, 17408
s_nop 0
buffer_load_dwordx4 v6, s[12:15], s37 offen lds
s_add_u32 s37, s39, 110592
s_add_u32 m0, s38, 18432
s_nop 0
buffer_load_dwordx4 v6, s[12:15], s37 offen lds
s_add_u32 s37, s39, 165888
s_add_u32 m0, s38, 19456
s_nop 0
buffer_load_dwordx4 v6, s[12:15], s37 offen lds
s_waitcnt vmcnt(12)
ds_read_b64_tr_b16 v[128:129], v7 offset:4096
ds_read_b64_tr_b16 v[130:131], v7 offset:4352
ds_read_b64_tr_b16 v[132:133], v7 offset:6144
ds_read_b64_tr_b16 v[134:135], v7 offset:6400
ds_read_b64_tr_b16 v[200:201], v7 offset:4128
ds_read_b64_tr_b16 v[202:203], v7 offset:4384
ds_read_b64_tr_b16 v[204:205], v7 offset:6176
ds_read_b64_tr_b16 v[206:207], v7 offset:6432
s_waitcnt lgkmcnt(0)
s_add_u32 s37, s39, 221184
s_add_u32 m0, s38, 0
s_nop 0
buffer_load_dwordx4 v6, s[12:15], s37 offen lds
s_add_u32 s37, s39, 276480
s_add_u32 m0, s38, 1024
s_nop 0
buffer_load_dwordx4 v6, s[12:15], s37 offen lds
s_add_u32 s37, s39, 331776
s_add_u32 m0, s38, 2048
s_nop 0
buffer_load_dwordx4 v6, s[12:15], s37 offen lds
s_add_u32 s37, s39, 387072
s_add_u32 m0, s38, 3072
s_nop 0
buffer_load_dwordx4 v6, s[12:15], s37 offen lds
s_waitcnt vmcnt(12)
ds_read_b64_tr_b16 v[136:137], v7 offset:8192
ds_read_b64_tr_b16 v[138:139], v7 offset:8448
ds_read_b64_tr_b16 v[140:141], v7 offset:10240
ds_read_b64_tr_b16 v[142:143], v7 offset:10496
ds_read_b64_tr_b16 v[208:209], v7 offset:8224
ds_read_b64_tr_b16 v[210:211], v7 offset:8480
ds_read_b64_tr_b16 v[212:213], v7 offset:10272
ds_read_b64_tr_b16 v[214:215], v7 offset:10528
s_waitcnt lgkmcnt(0)
s_add_u32 s37, s39, 442368
s_add_u32 m0, s38, 4096
s_nop 0
buffer_load_dwordx4 v6, s[12:15], s37 offen lds
s_add_u32 s37, s39, 497664
s_add_u32 m0, s38, 5120
s_nop 0
buffer_load_dwordx4 v6, s[12:15], s37 offen lds
s_add_u32 s37, s39, 552960
s_add_u32 m0, s38, 6144
s_nop 0
buffer_load_dwordx4 v6, s[12:15], s37 offen lds
s_add_u32 s37, s39, 608256
s_add_u32 m0, s38, 7168
s_nop 0
buffer_load_dwordx4 v6, s[12:15], s37 offen lds
s_waitcnt vmcnt(12)
ds_read_b64_tr_b16 v[144:145], v7 offset:12288
ds_read_b64_tr_b16 v[146:147], v7 offset:12544
ds_read_b64_tr_b16 v[148:149], v7 offset:14336
ds_read_b64_tr_b16 v[150:151], v7 offset:14592
ds_read_b64_tr_b16 v[216:217], v7 offset:12320
ds_read_b64_tr_b16 v[218:219], v7 offset:12576
ds_read_b64_tr_b16 v[220:221], v7 offset:14368
ds_read_b64_tr_b16 v[222:223], v7 offset:14624
s_waitcnt lgkmcnt(0)
s_add_u32 s37, s39, 663552
s_add_u32 m0, s38, 8192
s_nop 0
buffer_load_dwordx4 v6, s[12:15], s37 offen lds
s_add_u32 s37, s39, 718848
s_add_u32 m0, s38, 9216
s_nop 0
buffer_load_dwordx4 v6, s[12:15], s37 offen lds
s_add_u32 s37, s39, 774144
s_add_u32 m0, s38, 10240
s_nop 0
buffer_load_dwordx4 v6, s[12:15], s37 offen lds
s_add_u32 s37, s39, 829440
s_add_u32 m0, s38, 11264
s_nop 0
buffer_load_dwordx4 v6, s[12:15], s37 offen lds
s_waitcnt vmcnt(12)
ds_read_b64_tr_b16 v[224:225], v7 offset:16384
ds_read_b64_tr_b16 v[226:227], v7 offset:16640
ds_read_b64_tr_b16 v[228:229], v7 offset:18432
ds_read_b64_tr_b16 v[230:231], v7 offset:18688
ds_read_b64_tr_b16 a[40:41], v7 offset:16416
ds_read_b64_tr_b16 a[42:43], v7 offset:16672
ds_read_b64_tr_b16 a[44:45], v7 offset:18464
ds_read_b64_tr_b16 a[46:47], v7 offset:18720
s_waitcnt lgkmcnt(0)
s_add_u32 s37, s39, 884736
s_add_u32 m0, s38, 12288
s_nop 0
buffer_load_dwordx4 v6, s[12:15], s37 offen lds
s_add_u32 s37, s39, 940032
s_add_u32 m0, s38, 13312
s_nop 0
buffer_load_dwordx4 v6, s[12:15], s37 offen lds
s_add_u32 s37, s39, 995328
s_add_u32 m0, s38, 14336
s_nop 0
buffer_load_dwordx4 v6, s[12:15], s37 offen lds
s_add_u32 s37, s39, 1050624
s_add_u32 m0, s38, 15360
s_nop 0
buffer_load_dwordx4 v6, s[12:15], s37 offen lds
s_waitcnt vmcnt(12)
ds_read_b64_tr_b16 v[232:233], v7 offset:0
ds_read_b64_tr_b16 v[234:235], v7 offset:256
ds_read_b64_tr_b16 v[236:237], v7 offset:2048
ds_read_b64_tr_b16 v[238:239], v7 offset:2304
ds_read_b64_tr_b16 a[48:49], v7 offset:32
ds_read_b64_tr_b16 a[50:51], v7 offset:288
ds_read_b64_tr_b16 a[52:53], v7 offset:2080
ds_read_b64_tr_b16 a[54:55], v7 offset:2336
s_waitcnt lgkmcnt(0)
s_add_u32 s37, s39, 1105920
s_add_u32 m0, s38, 16384
s_nop 0
buffer_load_dwordx4 v6, s[12:15], s37 offen lds
s_add_u32 s37, s39, 1161216
s_add_u32 m0, s38, 17408
s_nop 0
buffer_load_dwordx4 v6, s[12:15], s37 offen lds
s_add_u32 s37, s39, 1216512
s_add_u32 m0, s38, 18432
s_nop 0
buffer_load_dwordx4 v6, s[12:15], s37 offen lds
s_add_u32 s37, s39, 1271808
s_add_u32 m0, s38, 19456
s_nop 0
buffer_load_dwordx4 v6, s[12:15], s37 offen lds
s_waitcnt vmcnt(12)
ds_read_b64_tr_b16 v[240:241], v7 offset:4096
ds_read_b64_tr_b16 v[242:243], v7 offset:4352
ds_read_b64_tr_b16 v[244:245], v7 offset:6144
ds_read_b64_tr_b16 v[246:247], v7 offset:6400
ds_read_b64_tr_b16 a[56:57], v7 offset:4128
ds_read_b64_tr_b16 a[58:59], v7 offset:4384
ds_read_b64_tr_b16 a[60:61], v7 offset:6176
ds_read_b64_tr_b16 a[62:63], v7 offset:6432
s_waitcnt lgkmcnt(0)
s_add_u32 s37, s39, 1327104
s_add_u32 m0, s38, 0
s_nop 0
buffer_load_dwordx4 v6, s[12:15], s37 offen lds
s_add_u32 s37, s39, 1382400
s_add_u32 m0, s38, 1024
s_nop 0
buffer_load_dwordx4 v6, s[12:15], s37 offen lds
s_add_u32 s37, s39, 1437696
s_add_u32 m0, s38, 2048
s_nop 0
buffer_load_dwordx4 v6, s[12:15], s37 offen lds
s_add_u32 s37, s39, 1492992
s_add_u32 m0, s38, 3072
s_nop 0
buffer_load_dwordx4 v6, s[12:15], s37 offen lds
s_waitcnt vmcnt(12)
ds_read_b64_tr_b16 v[248:249], v7 offset:8192
ds_read_b64_tr_b16 v[250:251], v7 offset:8448
ds_read_b64_tr_b16 v[252:253], v7 offset:10240
ds_read_b64_tr_b16 v[254:255], v7 offset:10496
ds_read_b64_tr_b16 a[64:65], v7 offset:8224
ds_read_b64_tr_b16 a[66:67], v7 offset:8480
ds_read_b64_tr_b16 a[68:69], v7 offset:10272
ds_read_b64_tr_b16 a[70:71], v7 offset:10528
s_waitcnt lgkmcnt(0)
s_add_u32 s37, s39, 1548288
s_add_u32 m0, s38, 4096
s_nop 0
buffer_load_dwordx4 v6, s[12:15], s37 offen lds
s_add_u32 s37, s39, 1603584
s_add_u32 m0, s38, 5120
s_nop 0
buffer_load_dwordx4 v6, s[12:15], s37 offen lds
s_add_u32 s37, s39, 1658880
s_add_u32 m0, s38, 6144
s_nop 0
buffer_load_dwordx4 v6, s[12:15], s37 offen lds
s_add_u32 s37, s39, 1714176
s_add_u32 m0, s38, 7168
s_nop 0
buffer_load_dwordx4 v6, s[12:15], s37 offen lds
s_waitcnt vmcnt(12)
ds_read_b64_tr_b16 a[0:1], v7 offset:12288
ds_read_b64_tr_b16 a[2:3], v7 offset:12544
ds_read_b64_tr_b16 a[4:5], v7 offset:14336
ds_read_b64_tr_b16 a[6:7], v7 offset:14592
ds_read_b64_tr_b16 a[72:73], v7 offset:12320
ds_read_b64_tr_b16 a[74:75], v7 offset:12576
ds_read_b64_tr_b16 a[76:77], v7 offset:14368
ds_read_b64_tr_b16 a[78:79], v7 offset:14624
s_waitcnt lgkmcnt(0)
s_add_u32 s37, s39, 1769472
s_add_u32 m0, s38, 8192
s_nop 0
buffer_load_dwordx4 v6, s[12:15], s37 offen lds
s_add_u32 s37, s39, 1824768
s_add_u32 m0, s38, 9216
s_nop 0
buffer_load_dwordx4 v6, s[12:15], s37 offen lds
s_add_u32 s37, s39, 1880064
s_add_u32 m0, s38, 10240
s_nop 0
buffer_load_dwordx4 v6, s[12:15], s37 offen lds
s_add_u32 s37, s39, 1935360
s_add_u32 m0, s38, 11264
s_nop 0
buffer_load_dwordx4 v6, s[12:15], s37 offen lds
s_waitcnt vmcnt(12)
ds_read_b64_tr_b16 a[8:9], v7 offset:16384
ds_read_b64_tr_b16 a[10:11], v7 offset:16640
ds_read_b64_tr_b16 a[12:13], v7 offset:18432
ds_read_b64_tr_b16 a[14:15], v7 offset:18688
ds_read_b64_tr_b16 a[80:81], v7 offset:16416
ds_read_b64_tr_b16 a[82:83], v7 offset:16672
ds_read_b64_tr_b16 a[84:85], v7 offset:18464
ds_read_b64_tr_b16 a[86:87], v7 offset:18720
s_waitcnt lgkmcnt(0)
s_waitcnt vmcnt(8)
ds_read_b64_tr_b16 a[16:17], v7 offset:0
ds_read_b64_tr_b16 a[18:19], v7 offset:256
ds_read_b64_tr_b16 a[20:21], v7 offset:2048
ds_read_b64_tr_b16 a[22:23], v7 offset:2304
ds_read_b64_tr_b16 a[88:89], v7 offset:32
ds_read_b64_tr_b16 a[90:91], v7 offset:288
ds_read_b64_tr_b16 a[92:93], v7 offset:2080
ds_read_b64_tr_b16 a[94:95], v7 offset:2336
s_waitcnt lgkmcnt(0)
s_waitcnt vmcnt(4)
ds_read_b64_tr_b16 a[24:25], v7 offset:4096
ds_read_b64_tr_b16 a[26:27], v7 offset:4352
ds_read_b64_tr_b16 a[28:29], v7 offset:6144
ds_read_b64_tr_b16 a[30:31], v7 offset:6400
ds_read_b64_tr_b16 a[96:97], v7 offset:4128
ds_read_b64_tr_b16 a[98:99], v7 offset:4384
ds_read_b64_tr_b16 a[100:101], v7 offset:6176
ds_read_b64_tr_b16 a[102:103], v7 offset:6432
s_waitcnt lgkmcnt(0)
s_waitcnt vmcnt(0)
ds_read_b64_tr_b16 a[32:33], v7 offset:8192
ds_read_b64_tr_b16 a[34:35], v7 offset:8448
ds_read_b64_tr_b16 a[36:37], v7 offset:10240
ds_read_b64_tr_b16 a[38:39], v7 offset:10496
ds_read_b64_tr_b16 a[104:105], v7 offset:8224
ds_read_b64_tr_b16 a[106:107], v7 offset:8480
ds_read_b64_tr_b16 a[108:109], v7 offset:10272
ds_read_b64_tr_b16 a[110:111], v7 offset:10528
s_waitcnt lgkmcnt(0)
s_cmp_lg_u32 s34, 3
s_cbranch_scc1 L_a_nogate
v_lshlrev_b32 v12, 4, v11
buffer_load_dwordx4 v[224:227], v12, s[64:67], 0 offen offset:0
buffer_load_dwordx4 v[228:231], v12, s[64:67], 0 offen offset:64
buffer_load_dwordx4 v[232:235], v12, s[64:67], 0 offen offset:128
buffer_load_dwordx4 v[236:239], v12, s[64:67], 0 offen offset:192
buffer_load_dwordx4 v[240:243], v12, s[64:67], 0 offen offset:256
buffer_load_dwordx4 v[244:247], v12, s[64:67], 0 offen offset:320
buffer_load_dwordx4 v[248:251], v12, s[64:67], 0 offen offset:384
buffer_load_dwordx4 v[252:255], v12, s[64:67], 0 offen offset:448
buffer_load_dwordx4 a[0:3], v12, s[64:67], 0 offen offset:512
buffer_load_dwordx4 a[4:7], v12, s[64:67], 0 offen offset:576
buffer_load_dwordx4 a[8:11], v12, s[64:67], 0 offen offset:640
buffer_load_dwordx4 a[12:15], v12, s[64:67], 0 offen offset:704
buffer_load_dwordx4 a[16:19], v12, s[64:67], 0 offen offset:768
buffer_load_dwordx4 a[20:23], v12, s[64:67], 0 offen offset:832
buffer_load_dwordx4 a[24:27], v12, s[64:67], 0 offen offset:896
buffer_load_dwordx4 a[28:31], v12, s[64:67], 0 offen offset:960
buffer_load_dwordx4 a[32:35], v12, s[64:67], 0 offen offset:1024
buffer_load_dwordx4 a[36:39], v12, s[64:67], 0 offen offset:1088
L_a_nogate:
s_mov_b32 s43, s40
s_mov_b32 s35, 0
s_mov_b32 s50, 36864
.p2align 6
L_a_loop:
s_waitcnt vmcnt(0)
s_barrier
s_add_u32 s43, s43, 36864
s_add_u32 s44, s44, s50
ds_read_b128 v[64:67], v3 offset:0
ds_read_b128 v[68:71], v3 offset:1024
ds_read_b128 v[72:75], v3 offset:2048
ds_read_b128 v[76:79], v3 offset:3072
s_waitcnt lgkmcnt(2)
v_mfma_f32_16x16x32_bf16 v[16:19], v[80:83], v[64:67], 0
v_mfma_f32_16x16x32_bf16 v[20:23], v[80:83], v[68:71], 0
v_mfma_f32_16x16x32_bf16 v[24:27], v[152:155], v[64:67], 0
v_mfma_f32_16x16x32_bf16 v[28:31], v[152:155], v[68:71], 0
s_add_u32 s37, s43, 0
s_add_u32 m0, s44, 0
s_nop 0
buffer_load_dwordx4 v2, s[8:11], s37 offen lds
v_mfma_f32_16x16x32_bf16 v[32:35], v[224:227], v[64:67], 0
v_mfma_f32_16x16x32_bf16 v[36:39], v[224:227], v[68:71], 0
v_mfma_f32_16x16x32_bf16 v[40:43], a[40:43], v[64:67], 0
v_mfma_f32_16x16x32_bf16 v[44:47], a[40:43], v[68:71], 0
ds_read_b128 v[64:67], v3 offset:4096
ds_read_b128 v[68:71], v3 offset:5120
s_waitcnt lgkmcnt(2)
v_mfma_f32_16x16x32_bf16 v[16:19], v[84:87], v[72:75], v[16:19]
v_mfma_f32_16x16x32_bf16 v[20:23], v[84:87], v[76:79], v[20:23]
v_mfma_f32_16x16x32_bf16 v[24:27], v[156:159], v[72:75], v[24:27]
v_mfma_f32_16x16x32_bf16 v[28:31], v[156:159], v[76:79], v[28:31]
s_add_u32 s37, s43, 128
s_add_u32 m0, s44, 4096
s_nop 0
buffer_load_dwordx4 v2, s[8:11], s37 offen lds
v_mfma_f32_16x16x32_bf16 v[32:35], v[228:231], v[72:75], v[32:35]
v_mfma_f32_16x16x32_bf16 v[36:39], v[228:231], v[76:79], v[36:39]
v_mfma_f32_16x16x32_bf16 v[40:43], a[44:47], v[72:75], v[40:43]
v_mfma_f32_16x16x32_bf16 v[44:47], a[44:47], v[76:79], v[44:47]
ds_read_b128 v[72:75], v3 offset:6144
ds_read_b128 v[76:79], v3 offset:7168
s_waitcnt lgkmcnt(2)
v_mfma_f32_16x16x32_bf16 v[16:19], v[88:91], v[64:67], v[16:19]
v_mfma_f32_16x16x32_bf16 v[20:23], v[88:91], v[68:71], v[20:23]
v_mfma_f32_16x16x32_bf16 v[24:27], v[160:163], v[64:67], v[24:27]
v_mfma_f32_16x16x32_bf16 v[28:31], v[160:163], v[68:71], v[28:31]
s_add_u32 s37, s43, 256
s_add_u32 m0, s44, 8192
s_nop 0
buffer_load_dwordx4 v2, s[8:11], s37 offen lds
v_mfma_f32_16x16x32_bf16 v[32:35], v[232:235], v[64:67], v[32:35]
v_mfma_f32_16x16x32_bf16 v[36:39], v[232:235], v[68:71], v[36:39]
v_mfma_f32_16x16x32_bf16 v[40:43], a[48:51], v[64:67], v[40:43]
v_mfma_f32_16x16x32_bf16 v[44:47], a[48:51], v[68:71], v[44:47]
ds_read_b128 v[64:67], v3 offset:8192
ds_read_b128 v[68:71], v3 offset:9216
s_waitcnt lgkmcnt(2)
v_mfma_f32_16x16x32_bf16 v[16:19], v[92:95], v[72:75], v[16:19]
v_mfma_f32_16x16x32_bf16 v[20:23], v[92:95], v[76:79], v[20:23]
v_mfma_f32_16x16x32_bf16 v[24:27], v[164:167], v[72:75], v[24:27]
v_mfma_f32_16x16x32_bf16 v[28:31], v[164:167], v[76:79], v[28:31]
s_add_u32 s37, s43, 384
s_add_u32 m0, s44, 12288
s_nop 0
buffer_load_dwordx4 v2, s[8:11], s37 offen lds
v_mfma_f32_16x16x32_bf16 v[32:35], v[236:239], v[72:75], v[32:35]
v_mfma_f32_16x16x32_bf16 v[36:39], v[236:239], v[76:79], v[36:39]
v_mfma_f32_16x16x32_bf16 v[40:43], a[52:55], v[72:75], v[40:43]
v_mfma_f32_16x16x32_bf16 v[44:47], a[52:55], v[76:79], v[44:47]
ds_read_b128 v[72:75], v3 offset:10240
ds_read_b128 v[76:79], v3 offset:11264
s_waitcnt lgkmcnt(2)
v_mfma_f32_16x16x32_bf16 v[16:19], v[96:99], v[64:67], v[16:19]
v_mfma_f32_16x16x32_bf16 v[20:23], v[96:99], v[68:71], v[20:23]
v_mfma_f32_16x16x32_bf16 v[24:27], v[168:171], v[64:67], v[24:27]
v_mfma_f32_16x16x32_bf16 v[28:31], v[168:171], v[68:71], v[28:31]
s_add_u32 s37, s43, 512
s_add_u32 m0, s44, 16384
s_nop 0
buffer_load_dwordx4 v2, s[8:11], s37 offen lds
v_mfma_f32_16x16x32_bf16 v[32:35], v[240:243], v[64:67], v[32:35]
v_mfma_f32_16x16x32_bf16 v[36:39], v[240:243], v[68:71], v[36:39]
v_mfma_f32_16x16x32_bf16 v[40:43], a[56:59], v[64:67], v[40:43]
v_mfma_f32_16x16x32_bf16 v[44:47], a[56:59], v[68:71], v[44:47]
ds_read_b128 v[64:67], v3 offset:12288
ds_read_b128 v[68:71], v3 offset:13312
s_waitcnt lgkmcnt(2)
v_mfma_f32_16x16x32_bf16 v[16:19], v[100:103], v[72:75], v[16:19]
v_mfma_f32_16x16x32_bf16 v[20:23], v[100:103], v[76:79], v[20:23]
v_mfma_f32_16x16x32_bf16 v[24:27], v[172:175], v[72:75], v[24:27]
v_mfma_f32_16x16x32_bf16 v[28:31], v[172:175], v[76:79], v[28:31]
s_add_u32 s37, s43, 640
s_add_u32 m0, s44, 20480
s_nop 0
buffer_load_dwordx4 v2, s[8:11], s37 offen lds
v_mfma_f32_16x16x32_bf16 v[32:35], v[244:247], v[72:75], v[32:35]
v_mfma_f32_16x16x32_bf16 v[36:39], v[244:247], v[76:79], v[36:39]
v_mfma_f32_16x16x32_bf16 v[40:43], a[60:63], v[72:75], v[40:43]
v_mfma_f32_16x16x32_bf16 v[44:47], a[60:63], v[76:79], v[44:47]
ds_read_b128 v[72:75], v3 offset:14336
ds_read_b128 v[76:79], v3 offset:15360
s_waitcnt lgkmcnt(2)
v_mfma_f32_16x16x32_bf16 v[16:19], v[104:107], v[64:67], v[16:19]
v_mfma_f32_16x16x32_bf16 v[20:23], v[104:107], v[68:71], v[20:23]
v_mfma_f32_16x16x32_bf16 v[24:27], v[176:179], v[64:67], v[24:27]
v_mfma_f32_16x16x32_bf16 v[28:31], v[176:179], v[68:71], v[28:31]
s_add_u32 s37, s43, 768
s_add_u32 m0, s44, 24576
s_nop 0
buffer_load_dwordx4 v2, s[8:11], s37 offen lds
v_mfma_f32_16x16x32_bf16 v[32:35], v[248:251], v[64:67], v[32:35]
v_mfma_f32_16x16x32_bf16 v[36:39], v[248:251], v[68:71], v[36:39]
v_mfma_f32_16x16x32_bf16 v[40:43], a[64:67], v[64:67], v[40:43]
v_mfma_f32_16x16x32_bf16 v[44:47], a[64:67], v[68:71], v[44:47]
ds_read_b128 v[64:67], v3 offset:16384
ds_read_b128 v[68:71], v3 offset:17408
s_waitcnt lgkmcnt(2)
v_mfma_f32_16x16x32_bf16 v[16:19], v[108:111], v[72:75], v[16:19]
v_mfma_f32_16x16x32_bf16 v[20:23], v[108:111], v[76:79], v[20:23]
v_mfma_f32_16x16x32_bf16 v[24:27], v[180:183], v[72:75], v[24:27]
v_mfma_f32_16x16x32_bf16 v[28:31], v[180:183], v[76:79], v[28:31]
s_add_u32 s37, s43, 896
s_add_u32 m0, s44, 28672
s_nop 0
buffer_load_dwordx4 v2, s[8:11], s37 offen lds
v_mfma_f32_16x16x32_bf16 v[32:35], v[252:255], v[72:75], v[32:35]
v_mfma_f32_16x16x32_bf16 v[36:39], v[252:255], v[76:79], v[36:39]
v_mfma_f32_16x16x32_bf16 v[40:43], a[68:71], v[72:75], v[40:43]
v_mfma_f32_16x16x32_bf16 v[44:47], a[68:71], v[76:79], v[44:47]
ds_read_b128 v[72:75], v3 offset:18432
ds_read_b128 v[76:79], v3 offset:19456
s_waitcnt lgkmcnt(2)
v_mfma_f32_16x16x32_bf16 v[16:19], v[112:115], v[64:67], v[16:19]
v_mfma_f32_16x16x32_bf16 v[20:23], v[112:115], v[68:71], v[20:23]
v_mfma_f32_16x16x32_bf16 v[24:27], v[184:187], v[64:67], v[24:27]
v_mfma_f32_16x16x32_bf16 v[28:31], v[184:187], v[68:71], v[28:31]
s_add_u32 s37, s43, 1024
s_add_u32 m0, s44, 32768
s_nop 0
buffer_load_dwordx4 v2, s[8:11], s37 offen lds
v_mfma_f32_16x16x32_bf16 v[32:35], a[0:3], v[64:67], v[32:35]
v_mfma_f32_16x16x32_bf16 v[36:39], a[0:3], v[68:71], v[36:39]
v_mfma_f32_16x16x32_bf16 v[40:43], a[72:75], v[64:67], v[40:43]
v_mfma_f32_16x16x32_bf16 v[44:47], a[72:75], v[68:71], v[44:47]
ds_read_b128 v[64:67], v3 offset:20480
ds_read_b128 v[68:71], v3 offset:21504
s_waitcnt lgkmcnt(2)
v_mfma_f32_16x16x32_bf16 v[16:19], v[116:119], v[72:75], v[16:19]
v_mfma_f32_16x16x32_bf16 v[20:23], v[116:119], v[76:79], v[20:23]
v_mfma_f32_16x16x32_bf16 v[24:27], v[188:191], v[72:75], v[24:27]
v_mfma_f32_16x16x32_bf16 v[28:31], v[188:191], v[76:79], v[28:31]
v_mfma_f32_16x16x32_bf16 v[32:35], a[4:7], v[72:75], v[32:35]
v_mfma_f32_16x16x32_bf16 v[36:39], a[4:7], v[76:79], v[36:39]
v_mfma_f32_16x16x32_bf16 v[40:43], a[76:79], v[72:75], v[40:43]
v_mfma_f32_16x16x32_bf16 v[44:47], a[76:79], v[76:79], v[44:47]
ds_read_b128 v[72:75], v3 offset:22528
ds_read_b128 v[76:79], v3 offset:23552
s_waitcnt lgkmcnt(2)
v_mfma_f32_16x16x32_bf16 v[16:19], v[120:123], v[64:67], v[16:19]
v_mfma_f32_16x16x32_bf16 v[20:23], v[120:123], v[68:71], v[20:23]
v_mfma_f32_16x16x32_bf16 v[24:27], v[192:195], v[64:67], v[24:27]
v_mfma_f32_16x16x32_bf16 v[28:31], v[192:195], v[68:71], v[28:31]
v_mfma_f32_16x16x32_bf16 v[32:35], a[8:11], v[64:67], v[32:35]
v_mfma_f32_16x16x32_bf16 v[36:39], a[8:11], v[68:71], v[36:39]
v_mfma_f32_16x16x32_bf16 v[40:43], a[80:83], v[64:67], v[40:43]
v_mfma_f32_16x16x32_bf16 v[44:47], a[80:83], v[68:71], v[44:47]
ds_read_b128 v[64:67], v3 offset:24576
ds_read_b128 v[68:71], v3 offset:25600
s_waitcnt lgkmcnt(2)
v_mfma_f32_16x16x32_bf16 v[16:19], v[124:127], v[72:75], v[16:19]
v_mfma_f32_16x16x32_bf16 v[20:23], v[124:127], v[76:79], v[20:23]
v_mfma_f32_16x16x32_bf16 v[24:27], v[196:199], v[72:75], v[24:27]
v_mfma_f32_16x16x32_bf16 v[28:31], v[196:199], v[76:79], v[28:31]
v_mfma_f32_16x16x32_bf16 v[32:35], a[12:15], v[72:75], v[32:35]
v_mfma_f32_16x16x32_bf16 v[36:39], a[12:15], v[76:79], v[36:39]
v_mfma_f32_16x16x32_bf16 v[40:43], a[84:87], v[72:75], v[40:43]
v_mfma_f32_16x16x32_bf16 v[44:47], a[84:87], v[76:79], v[44:47]
ds_read_b128 v[72:75], v3 offset:26624
ds_read_b128 v[76:79], v3 offset:27648
s_waitcnt lgkmcnt(2)
v_mfma_f32_16x16x32_bf16 v[16:19], v[128:131], v[64:67], v[16:19]
v_mfma_f32_16x16x32_bf16 v[20:23], v[128:131], v[68:71], v[20:23]
v_mfma_f32_16x16x32_bf16 v[24:27], v[200:203], v[64:67], v[24:27]
v_mfma_f32_16x16x32_bf16 v[28:31], v[200:203], v[68:71], v[28:31]
v_mfma_f32_16x16x32_bf16 v[32:35], a[16:19], v[64:67], v[32:35]
v_mfma_f32_16x16x32_bf16 v[36:39], a[16:19], v[68:71], v[36:39]
v_mfma_f32_16x16x32_bf16 v[40:43], a[88:91], v[64:67], v[40:43]
v_mfma_f32_16x16x32_bf16 v[44:47], a[88:91], v[68:71], v[44:47]
ds_read_b128 v[64:67], v3 offset:28672
ds_read_b128 v[68:71], v3 offset:29696
s_waitcnt lgkmcnt(2)
v_mfma_f32_16x16x32_bf16 v[16:19], v[132:135], v[72:75], v[16:19]
v_mfma_f32_16x16x32_bf16 v[20:23], v[132:135], v[76:79], v[20:23]
v_mfma_f32_16x16x32_bf16 v[24:27], v[204:207], v[72:75], v[24:27]
v_mfma_f32_16x16x32_bf16 v[28:31], v[204:207], v[76:79], v[28:31]
v_mfma_f32_16x16x32_bf16 v[32:35], a[20:23], v[72:75], v[32:35]
v_mfma_f32_16x16x32_bf16 v[36:39], a[20:23], v[76:79], v[36:39]
v_mfma_f32_16x16x32_bf16 v[40:43], a[92:95], v[72:75], v[40:43]
v_mfma_f32_16x16x32_bf16 v[44:47], a[92:95], v[76:79], v[44:47]
ds_read_b128 v[72:75], v3 offset:30720
ds_read_b128 v[76:79], v3 offset:31744
s_waitcnt lgkmcnt(2)
v_mfma_f32_16x16x32_bf16 v[16:19], v[136:139], v[64:67], v[16:19]
v_mfma_f32_16x16x32_bf16 v[20:23], v[136:139], v[68:71], v[20:23]
v_mfma_f32_16x16x32_bf16 v[24:27], v[208:211], v[64:67], v[24:27]
v_mfma_f32_16x16x32_bf16 v[28:31], v[208:211], v[68:71], v[28:31]
v_mfma_f32_16x16x32_bf16 v[32:35], a[24:27], v[64:67], v[32:35]
v_mfma_f32_16x16x32_bf16 v[36:39], a[24:27], v[68:71], v[36:39]
v_mfma_f32_16x16x32_bf16 v[40:43], a[96:99], v[64:67], v[40:43]
v_mfma_f32_16x16x32_bf16 v[44:47], a[96:99], v[68:71], v[44:47]
ds_read_b128 v[64:67], v3 offset:32768
ds_read_b128 v[68:71], v3 offset:33792
s_waitcnt lgkmcnt(2)
v_mfma_f32_16x16x32_bf16 v[16:19], v[140:143], v[72:75], v[16:19]
v_mfma_f32_16x16x32_bf16 v[20:23], v[140:143], v[76:79], v[20:23]
v_mfma_f32_16x16x32_bf16 v[24:27], v[212:215], v[72:75], v[24:27]
v_mfma_f32_16x16x32_bf16 v[28:31], v[212:215], v[76:79], v[28:31]
v_mfma_f32_16x16x32_bf16 v[32:35], a[28:31], v[72:75], v[32:35]
v_mfma_f32_16x16x32_bf16 v[36:39], a[28:31], v[76:79], v[36:39]
v_mfma_f32_16x16x32_bf16 v[40:43], a[100:103], v[72:75], v[40:43]
v_mfma_f32_16x16x32_bf16 v[44:47], a[100:103], v[76:79], v[44:47]
ds_read_b128 v[72:75], v3 offset:34816
ds_read_b128 v[76:79], v3 offset:35840
s_waitcnt lgkmcnt(2)
v_mfma_f32_16x16x32_bf16 v[16:19], v[144:147], v[64:67], v[16:19]
v_mfma_f32_16x16x32_bf16 v[20:23], v[144:147], v[68:71], v[20:23]
v_mfma_f32_16x16x32_bf16 v[24:27], v[216:219], v[64:67], v[24:27]
v_mfma_f32_16x16x32_bf16 v[28:31], v[216:219], v[68:71], v[28:31]
v_mfma_f32_16x16x32_bf16 v[32:35], a[32:35], v[64:67], v[32:35]
v_mfma_f32_16x16x32_bf16 v[36:39], a[32:35], v[68:71], v[36:39]
v_mfma_f32_16x16x32_bf16 v[40:43], a[104:107], v[64:67], v[40:43]
v_mfma_f32_16x16x32_bf16 v[44:47], a[104:107], v[68:71], v[44:47]
s_waitcnt lgkmcnt(0)
v_mfma_f32_16x16x32_bf16 v[16:19], v[148:151], v[72:75], v[16:19]
v_mfma_f32_16x16x32_bf16 v[20:23], v[148:151], v[76:79], v[20:23]
v_mfma_f32_16x16x32_bf16 v[24:27], v[220:223], v[72:75], v[24:27]
v_mfma_f32_16x16x32_bf16 v[28:31], v[220:223], v[76:79], v[28:31]
v_mfma_f32_16x16x32_bf16 v[32:35], a[36:39], v[72:75], v[32:35]
v_mfma_f32_16x16x32_bf16 v[36:39], a[36:39], v[76:79], v[36:39]
v_mfma_f32_16x16x32_bf16 v[40:43], a[108:111], v[72:75], v[40:43]
v_mfma_f32_16x16x32_bf16 v[44:47], a[108:111], v[76:79], v[44:47]
v_add_u32 v3, s50, v3
s_sub_u32 s50, 0, s50
v_cvt_pk_bf16_f32 v16, v16, v17
v_cvt_pk_bf16_f32 v17, v18, v19
ds_write_b64 v4, v[16:17] offset:0
v_cvt_pk_bf16_f32 v20, v20, v21
v_cvt_pk_bf16_f32 v21, v22, v23
ds_write_b64 v4, v[20:21] offset:7296
v_cvt_pk_bf16_f32 v24, v24, v25
v_cvt_pk_bf16_f32 v25, v26, v27
ds_write_b64 v4, v[24:25] offset:32
v_cvt_pk_bf16_f32 v28, v28, v29
v_cvt_pk_bf16_f32 v29, v30, v31
ds_write_b64 v4, v[28:29] offset:7328
s_cmp_eq_u32 s34, 3
s_cbranch_scc1 L_a_gate
v_cvt_pk_bf16_f32 v32, v32, v33
v_cvt_pk_bf16_f32 v33, v34, v35
ds_write_b64 v4, v[32:33] offset:64
v_cvt_pk_bf16_f32 v36, v36, v37
v_cvt_pk_bf16_f32 v37, v38, v39
ds_write_b64 v4, v[36:37] offset:7360
v_cvt_pk_bf16_f32 v40, v40, v41
v_cvt_pk_bf16_f32 v41, v42, v43
ds_write_b64 v4, v[40:41] offset:96
v_cvt_pk_bf16_f32 v44, v44, v45
v_cvt_pk_bf16_f32 v45, v46, v47
ds_write_b64 v4, v[44:45] offset:7392
s_branch L_a_nog2
L_a_gate:
ds_write_b32 v14, v32
ds_write_b32 v14, v36 offset:64
L_a_nog2:
v_add_u32 v4, 14592, v4
v_add_u32 v14, 128, v14
s_add_u32 s35, s35, 1
s_cmp_lt_u32 s35, 6
s_cbranch_scc1 L_a_loop
s_waitcnt vmcnt(0) lgkmcnt(0)
s_barrier
s_mov_b32 s35, 0
s_mul_i32 s39, s34, 36
s_add_u32 s39, s39, 73728
s_mul_i32 s40, s33, 176
s_mov_b32 s41, 0x3eae1a93
s_mov_b32 s42, 0xbfb8aa3b
L_la_loop:
v_add_u32 v12, s35, v9
v_min_u32 v12, 175, v12
v_add_u32 v2, s40, v12
v_add_u32 v12, 16, v12
v_mul_u32_u24 v14, 456, v12
v_add_u32 v14, s39, v14
v_lshlrev_b32 v12, 2, v12
v_add_u32 v12, 161280, v12
ds_read_b32 v3, v12
ds_read2_b32 v[16:17], v14 offset0:0 offset1:1
ds_read2_b32 v[18:19], v14 offset0:2 offset1:3
ds_read2_b32 v[20:21], v14 offset0:4 offset1:5
ds_read2_b32 v[22:23], v14 offset0:6 offset1:7
ds_read_b32 v24, v14 offset:32
v_subrev_u32 v15, 0, v14
ds_read2_b32 v[26:27], v15 offset0:36 offset1:37
ds_read2_b32 v[28:29], v15 offset0:38 offset1:39
ds_read2_b32 v[30:31], v15 offset0:40 offset1:41
ds_read2_b32 v[32:33], v15 offset0:42 offset1:43
ds_read_b32 v34, v15 offset:176
v_subrev_u32 v15, 912, v14
ds_read2_b32 v[36:37], v15 offset0:36 offset1:37
ds_read2_b32 v[38:39], v15 offset0:38 offset1:39
ds_read2_b32 v[40:41], v15 offset0:40 offset1:41
ds_read2_b32 v[42:43], v15 offset0:42 offset1:43
ds_read_b32 v44, v15 offset:176
s_waitcnt lgkmcnt(5)
v_dot2_f32_bf16 v176, v16, v26, 0
v_dot2_f32_bf16 v176, v17, v27, v176
v_dot2_f32_bf16 v176, v18, v28, v176
v_dot2_f32_bf16 v176, v19, v29, v176
v_dot2_f32_bf16 v176, v20, v30, v176
v_dot2_f32_bf16 v176, v21, v31, v176
v_dot2_f32_bf16 v176, v22, v32, v176
v_dot2_f32_bf16 v176, v23, v33, v176
v_dot2_f32_bf16 v176, v24, v34, v176
v_subrev_u32 v15, 1824, v14
ds_read2_b32 v[46:47], v15 offset0:36 offset1:37
ds_read2_b32 v[48:49], v15 offset0:38 offset1:39
ds_read2_b32 v[50:51], v15 offset0:40 offset1:41
ds_read2_b32 v[52:53], v15 offset0:42 offset1:43
ds_read_b32 v54, v15 offset:176
s_waitcnt lgkmcnt(5)
v_dot2_f32_bf16 v177, v16, v36, 0
v_dot2_f32_bf16 v177, v17, v37, v177
v_dot2_f32_bf16 v177, v18, v38, v177
v_dot2_f32_bf16 v177, v19, v39, v177
v_dot2_f32_bf16 v177, v20, v40, v177
v_dot2_f32_bf16 v177, v21, v41, v177
v_dot2_f32_bf16 v177, v22, v42, v177
v_dot2_f32_bf16 v177, v23, v43, v177
v_dot2_f32_bf16 v177, v24, v44, v177
v_subrev_u32 v15, 2736, v14
ds_read2_b32 v[56:57], v15 offset0:36 offset1:37
ds_read2_b32 v[58:59], v15 offset0:38 offset1:39
ds_read2_b32 v[60:61], v15 offset0:40 offset1:41
ds_read2_b32 v[62:63], v15 offset0:42 offset1:43
ds_read_b32 v64, v15 offset:176
s_waitcnt lgkmcnt(5)
v_dot2_f32_bf16 v178, v16, v46, 0
v_dot2_f32_bf16 v178, v17, v47, v178
v_dot2_f32_bf16 v178, v18, v48, v178
v_dot2_f32_bf16 v178, v19, v49, v178
v_dot2_f32_bf16 v178, v20, v50, v178
v_dot2_f32_bf16 v178, v21, v51, v178
v_dot2_f32_bf16 v178, v22, v52, v178
v_dot2_f32_bf16 v178, v23, v53, v178
v_dot2_f32_bf16 v178, v24, v54, v178
v_subrev_u32 v15, 3648, v14
ds_read2_b32 v[26:27], v15 offset0:36 offset1:37
ds_read2_b32 v[28:29], v15 offset0:38 offset1:39
ds_read2_b32 v[30:31], v15 offset0:40 offset1:41
ds_read2_b32 v[32:33], v15 offset0:42 offset1:43
ds_read_b32 v34, v15 offset:176
s_waitcnt lgkmcnt(5)
v_dot2_f32_bf16 v179, v16, v56, 0
v_dot2_f32_bf16 v179, v17, v57, v179
v_dot2_f32_bf16 v179, v18, v58, v179
v_dot2_f32_bf16 v179, v19, v59, v179
v_dot2_f32_bf16 v179, v20, v60, v179
v_dot2_f32_bf16 v179, v21, v61, v179
v_dot2_f32_bf16 v179, v22, v62, v179
v_dot2_f32_bf16 v179, v23, v63, v179
v_dot2_f32_bf16 v179, v24, v64, v179
v_subrev_u32 v15, 4560, v14
ds_read2_b32 v[36:37], v15 offset0:36 offset1:37
ds_read2_b32 v[38:39], v15 offset0:38 offset1:39
ds_read2_b32 v[40:41], v15 offset0:40 offset1:41
ds_read2_b32 v[42:43], v15 offset0:42 offset1:43
ds_read_b32 v44, v15 offset:176
s_waitcnt lgkmcnt(5)
v_dot2_f32_bf16 v180, v16, v26, 0
v_dot2_f32_bf16 v180, v17, v27, v180
v_dot2_f32_bf16 v180, v18, v28, v180
v_dot2_f32_bf16 v180, v19, v29, v180
v_dot2_f32_bf16 v180, v20, v30, v180
v_dot2_f32_bf16 v180, v21, v31, v180
v_dot2_f32_bf16 v180, v22, v32, v180
v_dot2_f32_bf16 v180, v23, v33, v180
v_dot2_f32_bf16 v180, v24, v34, v180
v_subrev_u32 v15, 5472, v14
ds_read2_b32 v[46:47], v15 offset0:36 offset1:37
ds_read2_b32 v[48:49], v15 offset0:38 offset1:39
ds_read2_b32 v[50:51], v15 offset0:40 offset1:41
ds_read2_b32 v[52:53], v15 offset0:42 offset1:43
ds_read_b32 v54, v15 offset:176
s_waitcnt lgkmcnt(5)
v_dot2_f32_bf16 v181, v16, v36, 0
v_dot2_f32_bf16 v181, v17, v37, v181
v_dot2_f32_bf16 v181, v18, v38, v181
v_dot2_f32_bf16 v181, v19, v39, v181
v_dot2_f32_bf16 v181, v20, v40, v181
v_dot2_f32_bf16 v181, v21, v41, v181
v_dot2_f32_bf16 v181, v22, v42, v181
v_dot2_f32_bf16 v181, v23, v43, v181
v_dot2_f32_bf16 v181, v24, v44, v181
v_subrev_u32 v15, 6384, v14
ds_read2_b32 v[56:57], v15 offset0:36 offset1:37
ds_read2_b32 v[58:59], v15 offset0:38 offset1:39
ds_read2_b32 v[60:61], v15 offset0:40 offset1:41
ds_read2_b32 v[62:63], v15 offset0:42 offset1:43
ds_read_b32 v64, v15 offset:176
s_waitcnt lgkmcnt(5)
v_dot2_f32_bf16 v182, v16, v46, 0
v_dot2_f32_bf16 v182, v17, v47, v182
v_dot2_f32_bf16 v182, v18, v48, v182
v_dot2_f32_bf16 v182, v19, v49, v182
v_dot2_f32_bf16 v182, v20, v50, v182
v_dot2_f32_bf16 v182, v21, v51, v182
v_dot2_f32_bf16 v182, v22, v52, v182
v_dot2_f32_bf16 v182, v23, v53, v182
v_dot2_f32_bf16 v182, v24, v54, v182
s_waitcnt lgkmcnt(0)
v_dot2_f32_bf16 v183, v16, v56, 0
v_dot2_f32_bf16 v183, v17, v57, v183
v_dot2_f32_bf16 v183, v18, v58, v183
v_dot2_f32_bf16 v183, v19, v59, v183
v_dot2_f32_bf16 v183, v20, v60, v183
v_dot2_f32_bf16 v183, v21, v61, v183
v_dot2_f32_bf16 v183, v22, v62, v183
v_dot2_f32_bf16 v183, v23, v63, v183
v_dot2_f32_bf16 v183, v24, v64, v183
v_subrev_u32 v15, 0, v14
ds_read2_b32 v[100:101], v15 offset0:72 offset1:73
ds_read2_b32 v[102:103], v15 offset0:74 offset1:75
ds_read2_b32 v[104:105], v15 offset0:76 offset1:77
ds_read2_b32 v[106:107], v15 offset0:78 offset1:79
ds_read_b32 v108, v15 offset:320
v_subrev_u32 v15, 912, v14
ds_read2_b32 v[110:111], v15 offset0:72 offset1:73
ds_read2_b32 v[112:113], v15 offset0:74 offset1:75
ds_read2_b32 v[114:115], v15 offset0:76 offset1:77
ds_read2_b32 v[116:117], v15 offset0:78 offset1:79
ds_read_b32 v118, v15 offset:320
v_mov_b32 v13, 0xf149f2ca
v_mul_f32 v176, s41, v176
v_mul_f32 v177, s41, v177
v_mul_f32 v178, s41, v178
v_mul_f32 v179, s41, v179
v_mul_f32 v180, s41, v180
v_mul_f32 v181, s41, v181
v_mul_f32 v182, s41, v182
v_mul_f32 v183, s41, v183
v_cmp_le_u32 vcc, 2, v2
s_nop 1
v_cndmask_b32 v177, v13, v177, vcc
v_cmp_le_u32 vcc, 4, v2
s_nop 1
v_cndmask_b32 v178, v13, v178, vcc
v_cmp_le_u32 vcc, 6, v2
s_nop 1
v_cndmask_b32 v179, v13, v179, vcc
v_cmp_le_u32 vcc, 8, v2
s_nop 1
v_cndmask_b32 v180, v13, v180, vcc
v_cmp_le_u32 vcc, 10, v2
s_nop 1
v_cndmask_b32 v181, v13, v181, vcc
v_cmp_le_u32 vcc, 12, v2
s_nop 1
v_cndmask_b32 v182, v13, v182, vcc
v_cmp_le_u32 vcc, 14, v2
s_nop 1
v_cndmask_b32 v183, v13, v183, vcc
v_max3_f32 v12, v176, v177, v178
v_max3_f32 v12, v12, v179, v180
v_max3_f32 v12, v12, v181, v182
v_max_f32 v12, v12, v183
v_sub_f32 v176, v176, v12
v_sub_f32 v177, v177, v12
v_sub_f32 v178, v178, v12
v_sub_f32 v179, v179, v12
v_sub_f32 v180, v180, v12
v_sub_f32 v181, v181, v12
v_sub_f32 v182, v182, v12
v_sub_f32 v183, v183, v12
v_exp_f32 v176, v176
v_exp_f32 v177, v177
v_exp_f32 v178, v178
v_exp_f32 v179, v179
v_exp_f32 v180, v180
v_exp_f32 v181, v181
v_exp_f32 v182, v182
v_exp_f32 v183, v183
v_cvt_pk_bf16_f32 v204, v176, v8
v_cvt_pk_bf16_f32 v205, v177, v8
v_cvt_pk_bf16_f32 v206, v178, v8
v_cvt_pk_bf16_f32 v207, v179, v8
v_cvt_pk_bf16_f32 v208, v180, v8
v_cvt_pk_bf16_f32 v209, v181, v8
v_cvt_pk_bf16_f32 v210, v182, v8
v_cvt_pk_bf16_f32 v211, v183, v8
v_lshlrev_b32 v212, 16, v204
v_lshlrev_b32 v213, 16, v205
v_lshlrev_b32 v214, 16, v206
v_lshlrev_b32 v215, 16, v207
v_lshlrev_b32 v216, 16, v208
v_lshlrev_b32 v217, 16, v209
v_lshlrev_b32 v218, 16, v210
v_lshlrev_b32 v219, 16, v211
v_add_f32 v12, v212, v213
v_add_f32 v13, v214, v215
v_add_f32 v12, v12, v216
v_add_f32 v13, v13, v217
v_add_f32 v12, v12, v218
v_add_f32 v13, v13, v219
v_add_f32 v12, v12, v13
v_mul_f32 v13, s42, v3
v_exp_f32 v3, v13
v_exp_f32 v13, -v13
v_add_f32 v3, 1.0, v3
v_add_f32 v13, 1.0, v13
v_mul_f32 v12, v12, v3
v_rcp_f32 v12, v12
v_rcp_f32 v13, v13
v_subrev_u32 v15, 1824, v14
ds_read2_b32 v[120:121], v15 offset0:72 offset1:73
ds_read2_b32 v[122:123], v15 offset0:74 offset1:75
ds_read2_b32 v[124:125], v15 offset0:76 offset1:77
ds_read2_b32 v[126:127], v15 offset0:78 offset1:79
ds_read_b32 v128, v15 offset:320
s_waitcnt lgkmcnt(10)
v_dot2_f32_bf16 v184, v100, v204, 0
v_dot2_f32_bf16 v185, v100, v212, 0
v_dot2_f32_bf16 v186, v101, v204, 0
v_dot2_f32_bf16 v187, v101, v212, 0
v_dot2_f32_bf16 v188, v102, v204, 0
v_dot2_f32_bf16 v189, v102, v212, 0
v_dot2_f32_bf16 v190, v103, v204, 0
v_dot2_f32_bf16 v191, v103, v212, 0
v_dot2_f32_bf16 v192, v104, v204, 0
v_dot2_f32_bf16 v193, v104, v212, 0
v_dot2_f32_bf16 v194, v105, v204, 0
v_dot2_f32_bf16 v195, v105, v212, 0
v_dot2_f32_bf16 v196, v106, v204, 0
v_dot2_f32_bf16 v197, v106, v212, 0
v_dot2_f32_bf16 v198, v107, v204, 0
v_dot2_f32_bf16 v199, v107, v212, 0
v_dot2_f32_bf16 v200, v108, v204, 0
v_dot2_f32_bf16 v201, v108, v212, 0
v_subrev_u32 v15, 2736, v14
ds_read2_b32 v[130:131], v15 offset0:72 offset1:73
ds_read2_b32 v[132:133], v15 offset0:74 offset1:75
ds_read2_b32 v[134:135], v15 offset0:76 offset1:77
ds_read2_b32 v[136:137], v15 offset0:78 offset1:79
ds_read_b32 v138, v15 offset:320
s_waitcnt lgkmcnt(10)
v_dot2_f32_bf16 v184, v110, v205, v184
v_dot2_f32_bf16 v185, v110, v213, v185
v_dot2_f32_bf16 v186, v111, v205, v186
v_dot2_f32_bf16 v187, v111, v213, v187
v_dot2_f32_bf16 v188, v112, v205, v188
v_dot2_f32_bf16 v189, v112, v213, v189
v_dot2_f32_bf16 v190, v113, v205, v190
v_dot2_f32_bf16 v191, v113, v213, v191
v_dot2_f32_bf16 v192, v114, v205, v192
v_dot2_f32_bf16 v193, v114, v213, v193
v_dot2_f32_bf16 v194, v115, v205, v194
v_dot2_f32_bf16 v195, v115, v213, v195
v_dot2_f32_bf16 v196, v116, v205, v196
v_dot2_f32_bf16 v197, v116, v213, v197
v_dot2_f32_bf16 v198, v117, v205, v198
v_dot2_f32_bf16 v199, v117, v213, v199
v_dot2_f32_bf16 v200, v118, v205, v200
v_dot2_f32_bf16 v201, v118, v213, v201
v_subrev_u32 v15, 3648, v14
ds_read2_b32 v[100:101], v15 offset0:72 offset1:73
ds_read2_b32 v[102:103], v15 offset0:74 offset1:75
ds_read2_b32 v[104:105], v15 offset0:76 offset1:77
ds_read2_b32 v[106:107], v15 offset0:78 offset1:79
ds_read_b32 v108, v15 offset:320
s_waitcnt lgkmcnt(10)
v_dot2_f32_bf16 v184, v120, v206, v184
v_dot2_f32_bf16 v185, v120, v214, v185
v_dot2_f32_bf16 v186, v121, v206, v186
v_dot2_f32_bf16 v187, v121, v214, v187
v_dot2_f32_bf16 v188, v122, v206, v188
v_dot2_f32_bf16 v189, v122, v214, v189
v_dot2_f32_bf16 v190, v123, v206, v190
v_dot2_f32_bf16 v191, v123, v214, v191
v_dot2_f32_bf16 v192, v124, v206, v192
v_dot2_f32_bf16 v193, v124, v214, v193
v_dot2_f32_bf16 v194, v125, v206, v194
v_dot2_f32_bf16 v195, v125, v214, v195
v_dot2_f32_bf16 v196, v126, v206, v196
v_dot2_f32_bf16 v197, v126, v214, v197
v_dot2_f32_bf16 v198, v127, v206, v198
v_dot2_f32_bf16 v199, v127, v214, v199
v_dot2_f32_bf16 v200, v128, v206, v200
v_dot2_f32_bf16 v201, v128, v214, v201
v_subrev_u32 v15, 4560, v14
ds_read2_b32 v[110:111], v15 offset0:72 offset1:73
ds_read2_b32 v[112:113], v15 offset0:74 offset1:75
ds_read2_b32 v[114:115], v15 offset0:76 offset1:77
ds_read2_b32 v[116:117], v15 offset0:78 offset1:79
ds_read_b32 v118, v15 offset:320
s_waitcnt lgkmcnt(10)
v_dot2_f32_bf16 v184, v130, v207, v184
v_dot2_f32_bf16 v185, v130, v215, v185
v_dot2_f32_bf16 v186, v131, v207, v186
v_dot2_f32_bf16 v187, v131, v215, v187
v_dot2_f32_bf16 v188, v132, v207, v188
v_dot2_f32_bf16 v189, v132, v215, v189
v_dot2_f32_bf16 v190, v133, v207, v190
v_dot2_f32_bf16 v191, v133, v215, v191
v_dot2_f32_bf16 v192, v134, v207, v192
v_dot2_f32_bf16 v193, v134, v215, v193
v_dot2_f32_bf16 v194, v135, v207, v194
v_dot2_f32_bf16 v195, v135, v215, v195
v_dot2_f32_bf16 v196, v136, v207, v196
v_dot2_f32_bf16 v197, v136, v215, v197
v_dot2_f32_bf16 v198, v137, v207, v198
v_dot2_f32_bf16 v199, v137, v215, v199
v_dot2_f32_bf16 v200, v138, v207, v200
v_dot2_f32_bf16 v201, v138, v215, v201
v_subrev_u32 v15, 5472, v14
ds_read2_b32 v[120:121], v15 offset0:72 offset1:73
ds_read2_b32 v[122:123], v15 offset0:74 offset1:75
ds_read2_b32 v[124:125], v15 offset0:76 offset1:77
ds_read2_b32 v[126:127], v15 offset0:78 offset1:79
ds_read_b32 v128, v15 offset:320
s_waitcnt lgkmcnt(10)
v_dot2_f32_bf16 v184, v100, v208, v184
v_dot2_f32_bf16 v185, v100, v216, v185
v_dot2_f32_bf16 v186, v101, v208, v186
v_dot2_f32_bf16 v187, v101, v216, v187
v_dot2_f32_bf16 v188, v102, v208, v188
v_dot2_f32_bf16 v189, v102, v216, v189
v_dot2_f32_bf16 v190, v103, v208, v190
v_dot2_f32_bf16 v191, v103, v216, v191
v_dot2_f32_bf16 v192, v104, v208, v192
v_dot2_f32_bf16 v193, v104, v216, v193
v_dot2_f32_bf16 v194, v105, v208, v194
v_dot2_f32_bf16 v195, v105, v216, v195
v_dot2_f32_bf16 v196, v106, v208, v196
v_dot2_f32_bf16 v197, v106, v216, v197
v_dot2_f32_bf16 v198, v107, v208, v198
v_dot2_f32_bf16 v199, v107, v216, v199
v_dot2_f32_bf16 v200, v108, v208, v200
v_dot2_f32_bf16 v201, v108, v216, v201
v_subrev_u32 v15, 6384, v14
ds_read2_b32 v[130:131], v15 offset0:72 offset1:73
ds_read2_b32 v[132:133], v15 offset0:74 offset1:75
ds_read2_b32 v[134:135], v15 offset0:76 offset1:77
ds_read2_b32 v[136:137], v15 offset0:78 offset1:79
ds_read_b32 v138, v15 offset:320
s_waitcnt lgkmcnt(10)
v_dot2_f32_bf16 v184, v110, v209, v184
v_dot2_f32_bf16 v185, v110, v217, v185
v_dot2_f32_bf16 v186, v111, v209, v186
v_dot2_f32_bf16 v187, v111, v217, v187
v_dot2_f32_bf16 v188, v112, v209, v188
v_dot2_f32_bf16 v189, v112, v217, v189
v_dot2_f32_bf16 v190, v113, v209, v190
v_dot2_f32_bf16 v191, v113, v217, v191
v_dot2_f32_bf16 v192, v114, v209, v192
v_dot2_f32_bf16 v193, v114, v217, v193
v_dot2_f32_bf16 v194, v115, v209, v194
v_dot2_f32_bf16 v195, v115, v217, v195
v_dot2_f32_bf16 v196, v116, v209, v196
v_dot2_f32_bf16 v197, v116, v217, v197
v_dot2_f32_bf16 v198, v117, v209, v198
v_dot2_f32_bf16 v199, v117, v217, v199
v_dot2_f32_bf16 v200, v118, v209, v200
v_dot2_f32_bf16 v201, v118, v217, v201
s_waitcnt lgkmcnt(5)
v_dot2_f32_bf16 v184, v120, v210, v184
v_dot2_f32_bf16 v185, v120, v218, v185
v_dot2_f32_bf16 v186, v121, v210, v186
v_dot2_f32_bf16 v187, v121, v218, v187
v_dot2_f32_bf16 v188, v122, v210, v188
v_dot2_f32_bf16 v189, v122, v218, v189
v_dot2_f32_bf16 v190, v123, v210, v190
v_dot2_f32_bf16 v191, v123, v218, v191
v_dot2_f32_bf16 v192, v124, v210, v192
v_dot2_f32_bf16 v193, v124, v218, v193
v_dot2_f32_bf16 v194, v125, v210, v194
v_dot2_f32_bf16 v195, v125, v218, v195
v_dot2_f32_bf16 v196, v126, v210, v196
v_dot2_f32_bf16 v197, v126, v218, v197
v_dot2_f32_bf16 v198, v127, v210, v198
v_dot2_f32_bf16 v199, v127, v218, v199
v_dot2_f32_bf16 v200, v128, v210, v200
v_dot2_f32_bf16 v201, v128, v218, v201
s_waitcnt lgkmcnt(0)
v_dot2_f32_bf16 v184, v130, v211, v184
v_dot2_f32_bf16 v185, v130, v219, v185
v_dot2_f32_bf16 v186, v131, v211, v186
v_dot2_f32_bf16 v187, v131, v219, v187
v_dot2_f32_bf16 v188, v132, v211, v188
v_dot2_f32_bf16 v189, v132, v219, v189
v_dot2_f32_bf16 v190, v133, v211, v190
v_dot2_f32_bf16 v191, v133, v219, v191
v_dot2_f32_bf16 v192, v134, v211, v192
v_dot2_f32_bf16 v193, v134, v219, v193
v_dot2_f32_bf16 v194, v135, v211, v194
v_dot2_f32_bf16 v195, v135, v219, v195
v_dot2_f32_bf16 v196, v136, v211, v196
v_dot2_f32_bf16 v197, v136, v219, v197
v_dot2_f32_bf16 v198, v137, v211, v198
v_dot2_f32_bf16 v199, v137, v219, v199
v_dot2_f32_bf16 v200, v138, v211, v200
v_dot2_f32_bf16 v201, v138, v219, v201
s_or_b32 s37, s32, s34
s_cmp_lg_u32 s37, 0
s_cbranch_scc1 L_la_noomg
v_lshlrev_b32 v15, 2, v2
v_min_u32 v15, 8192, v15
s_mov_b32 s37, 87031808
buffer_store_dword v13, v15, s[4:7], s37 offen sc0 sc1
L_la_noomg:
v_mul_f32 v184, v184, v12
v_mul_f32 v185, v185, v12
v_mul_f32 v186, v186, v12
v_mul_f32 v187, v187, v12
v_mul_f32 v188, v188, v12
v_mul_f32 v189, v189, v12
v_mul_f32 v190, v190, v12
v_mul_f32 v191, v191, v12
v_mul_f32 v192, v192, v12
v_mul_f32 v193, v193, v12
v_mul_f32 v194, v194, v12
v_mul_f32 v195, v195, v12
v_mul_f32 v196, v196, v12
v_mul_f32 v197, v197, v12
v_mul_f32 v198, v198, v12
v_mul_f32 v199, v199, v12
v_mul_f32 v200, v200, v12
v_mul_f32 v201, v201, v12
v_cvt_pk_bf16_f32 v184, v184, v185
v_cvt_pk_bf16_f32 v185, v186, v187
v_cvt_pk_bf16_f32 v186, v188, v189
v_cvt_pk_bf16_f32 v187, v190, v191
v_cvt_pk_bf16_f32 v188, v192, v193
v_cvt_pk_bf16_f32 v189, v194, v195
v_cvt_pk_bf16_f32 v190, v196, v197
v_cvt_pk_bf16_f32 v191, v198, v199
v_cvt_pk_bf16_f32 v192, v200, v201
ds_write2_b32 v14, v184, v185 offset0:0 offset1:1
ds_write2_b32 v14, v186, v187 offset0:2 offset1:3
ds_write2_b32 v14, v188, v189 offset0:4 offset1:5
ds_write2_b32 v14, v190, v191 offset0:6 offset1:7
ds_write_b32 v14, v192 offset:32
s_add_u32 s35, s35, 64
s_cmp_lt_u32 s35, 192
s_cbranch_scc1 L_la_loop
s_waitcnt lgkmcnt(0)
s_barrier
v_mul_u32_u24 v14, 456, v10
v_lshl_add_u32 v14, v11, 4, v14
s_add_u32 s37, s34, 1
s_mul_i32 s37, s37, 7296
s_add_u32 s37, s37, 73728
v_add_u32 v14, s37, v14
s_mul_i32 s40, s33, 11
s_add_u32 s40, s40, s34
s_mov_b32 s35, s34
s_mul_i32 s41, s32, 2304
s_add_u32 s41, s41, 83886080
L_oa_loop:
s_cmp_ge_u32 s40, 128
s_cbranch_scc1 L_oa_done
ds_read2_b64 v[16:19], v14 offset0:0 offset1:1
ds_read2_b64 v[20:23], v14 offset0:8 offset1:9
ds_read2_b64 v[24:27], v14 offset0:16 offset1:17
s_mul_i32 s37, s40, 18432
s_add_u32 s37, s37, s41
s_waitcnt lgkmcnt(2)
buffer_store_dwordx4 v[16:19], v1, s[4:7], s37 offen offset:0 sc0 sc1
s_waitcnt lgkmcnt(1)
buffer_store_dwordx4 v[20:23], v1, s[4:7], s37 offen offset:1024 sc0 sc1
s_waitcnt lgkmcnt(0)
s_mov_b64 exec, 0xffff
buffer_store_dwordx4 v[24:27], v1, s[4:7], s37 offen offset:2048 sc0 sc1
s_mov_b64 exec, -1
v_add_u32 v14, 29184, v14
s_add_u32 s40, s40, 4
s_add_u32 s35, s35, 4
s_cmp_lt_u32 s35, 11
s_cbranch_scc1 L_oa_loop
L_oa_done:
s_waitcnt vmcnt(0)
s_barrier
s_cmp_lg_u32 s34, 0
s_cbranch_scc1 L_a_sig
v_mov_b32 v12, 1
s_mov_b64 exec, 1
buffer_atomic_add v12, v8, s[24:27], 0 offen offset:4 sc1
s_mov_b64 exec, -1
L_a_sig:
v_add_u32 v12, 0, v9
v_mul_u32_u24 v13, 171, v12
v_lshrrev_b32 v13, 10, v13
v_mul_u32_u24 v13, 1056, v13
v_lshl_add_u32 v2, v12, 4, v13
v_add_u32 v12, 64, v9
v_mul_u32_u24 v13, 171, v12
v_lshrrev_b32 v13, 10, v13
v_mul_u32_u24 v13, 1056, v13
v_lshl_add_u32 v3, v12, 4, v13
v_add_u32 v12, 128, v9
v_mul_u32_u24 v13, 171, v12
v_lshrrev_b32 v13, 10, v13
v_mul_u32_u24 v13, 1056, v13
v_lshl_add_u32 v4, v12, 4, v13
v_lshrrev_b32 v12, 2, v10
v_lshl_add_u32 v12, v11, 2, v12
v_mul_u32_u24 v5, 96, v12
v_and_b32 v12, 3, v10
v_lshl_add_u32 v5, v12, 3, v5
v_lshrrev_b32 v12, 2, v10
v_lshl_add_u32 v12, v11, 3, v12
v_mul_u32_u24 v6, 96, v12
v_and_b32 v12, 3, v10
v_lshl_add_u32 v6, v12, 3, v6
s_lshl_b32 s50, s34, 15
v_add_u32 v5, s50, v5
v_add_u32 v6, s50, v6
v_add_u32 v7, s50, v1
s_mul_i32 s37, s49, 96
s_mul_i32 s51, s34, 1179648
s_add_u32 s51, s51, s37
s_mul_i32 s52, s34, 184320
s_add_u32 s52, s52, s37
v_mul_u32_u24 v15, 1152, v10
v_lshl_add_u32 v15, v11, 3, v15
s_lshl_b32 s38, s34, 5
s_add_u32 s37, s37, s38
s_mul_i32 s55, s48, 18432
s_add_u32 s54, s55, 83886080
s_add_u32 s55, s55, s37
s_lshl_b32 s53, s48, 17
s_add_u32 s53, s53, s50
s_add_u32 s53, s53, 67108864
s_lshl_b32 s56, s48, 6
s_add_u32 s56, s56, 87031808
s_lshl_b32 s57, s48, 8
s_add_u32 s57, s57, 331776
v_lshlrev_b32 v9, 2, v9
v_lshlrev_b32 v10, 2, v10
v_add_u32 v14, 131072, v1
s_add_u32 s37, s52, 0
s_add_u32 m0, s50, 0
s_nop 0
buffer_load_dwordx4 v2, s[16:19], s37 offen lds
s_add_u32 m0, s50, 1024
s_nop 0
buffer_load_dwordx4 v3, s[16:19], s37 offen lds
s_add_u32 m0, s50, 2048
s_nop 0
buffer_load_dwordx4 v4, s[16:19], s37 offen lds
s_add_u32 s37, s52, 36864
s_add_u32 m0, s50, 3072
s_nop 0
buffer_load_dwordx4 v2, s[16:19], s37 offen lds
s_add_u32 m0, s50, 4096
s_nop 0
buffer_load_dwordx4 v3, s[16:19], s37 offen lds
s_add_u32 m0, s50, 5120
s_nop 0
buffer_load_dwordx4 v4, s[16:19], s37 offen lds
s_add_u32 s37, s52, 73728
s_add_u32 m0, s50, 6144
s_nop 0
buffer_load_dwordx4 v2, s[16:19], s37 offen lds
s_add_u32 m0, s50, 7168
s_nop 0
buffer_load_dwordx4 v3, s[16:19], s37 offen lds
s_add_u32 m0, s50, 8192
s_nop 0
buffer_load_dwordx4 v4, s[16:19], s37 offen lds
s_add_u32 s37, s52, 110592
s_add_u32 m0, s50, 9216
s_nop 0
buffer_load_dwordx4 v2, s[16:19], s37 offen lds
s_add_u32 m0, s50, 10240
s_nop 0
buffer_load_dwordx4 v3, s[16:19], s37 offen lds
s_add_u32 m0, s50, 11264
s_nop 0
buffer_load_dwordx4 v4, s[16:19], s37 offen lds
s_add_u32 s37, s52, 147456
s_add_u32 m0, s50, 12288
s_nop 0
buffer_load_dwordx4 v2, s[16:19], s37 offen lds
s_add_u32 m0, s50, 13312
s_nop 0
buffer_load_dwordx4 v3, s[16:19], s37 offen lds
s_add_u32 m0, s50, 14336
s_nop 0
buffer_load_dwordx4 v4, s[16:19], s37 offen lds
s_add_u32 s37, s51, 0
s_add_u32 m0, s50, 15360
s_nop 0
buffer_load_dwordx4 v2, s[20:23], s37 offen lds
s_add_u32 m0, s50, 16384
s_nop 0
buffer_load_dwordx4 v3, s[20:23], s37 offen lds
s_add_u32 m0, s50, 17408
s_nop 0
buffer_load_dwordx4 v4, s[20:23], s37 offen lds
s_add_u32 s37, s51, 36864
s_add_u32 m0, s50, 18432
s_nop 0
buffer_load_dwordx4 v2, s[20:23], s37 offen lds
s_add_u32 m0, s50, 19456
s_nop 0
buffer_load_dwordx4 v3, s[20:23], s37 offen lds
s_add_u32 m0, s50, 20480
s_nop 0
buffer_load_dwordx4 v4, s[20:23], s37 offen lds
s_add_u32 s37, s51, 73728
s_add_u32 m0, s50, 21504
s_nop 0
buffer_load_dwordx4 v2, s[20:23], s37 offen lds
s_add_u32 m0, s50, 22528
s_nop 0
buffer_load_dwordx4 v3, s[20:23], s37 offen lds
s_add_u32 m0, s50, 23552
s_nop 0
buffer_load_dwordx4 v4, s[20:23], s37 offen lds
s_add_u32 s37, s51, 110592
s_add_u32 m0, s50, 24576
s_nop 0
buffer_load_dwordx4 v2, s[20:23], s37 offen lds
s_add_u32 m0, s50, 25600
s_nop 0
buffer_load_dwordx4 v3, s[20:23], s37 offen lds
s_add_u32 m0, s50, 26624
s_nop 0
buffer_load_dwordx4 v4, s[20:23], s37 offen lds
s_waitcnt vmcnt(24)
ds_read_b64_tr_b16 v[68:69], v6 offset:0
ds_read_b64_tr_b16 v[70:71], v6 offset:384
ds_read_b64_tr_b16 v[72:73], v6 offset:32
ds_read_b64_tr_b16 v[74:75], v6 offset:416
ds_read_b64_tr_b16 v[76:77], v6 offset:64
ds_read_b64_tr_b16 v[78:79], v6 offset:448
s_waitcnt lgkmcnt(0)
s_add_u32 s37, s51, 147456
s_add_u32 m0, s50, 27648
s_nop 0
buffer_load_dwordx4 v2, s[20:23], s37 offen lds
s_add_u32 m0, s50, 28672
s_nop 0
buffer_load_dwordx4 v3, s[20:23], s37 offen lds
s_add_u32 m0, s50, 29696
s_nop 0
buffer_load_dwordx4 v4, s[20:23], s37 offen lds
s_waitcnt vmcnt(24)
ds_read_b64_tr_b16 v[80:81], v6 offset:3072
ds_read_b64_tr_b16 v[82:83], v6 offset:3456
ds_read_b64_tr_b16 v[84:85], v6 offset:3104
ds_read_b64_tr_b16 v[86:87], v6 offset:3488
ds_read_b64_tr_b16 v[88:89], v6 offset:3136
ds_read_b64_tr_b16 v[90:91], v6 offset:3520
s_waitcnt lgkmcnt(0)
s_add_u32 s37, s51, 184320
s_add_u32 m0, s50, 0
s_nop 0
buffer_load_dwordx4 v2, s[20:23], s37 offen lds
s_add_u32 m0, s50, 1024
s_nop 0
buffer_load_dwordx4 v3, s[20:23], s37 offen lds
s_add_u32 m0, s50, 2048
s_nop 0
buffer_load_dwordx4 v4, s[20:23], s37 offen lds
s_waitcnt vmcnt(24)
ds_read_b64_tr_b16 v[92:93], v6 offset:6144
ds_read_b64_tr_b16 v[94:95], v6 offset:6528
ds_read_b64_tr_b16 v[96:97], v6 offset:6176
ds_read_b64_tr_b16 v[98:99], v6 offset:6560
ds_read_b64_tr_b16 v[100:101], v6 offset:6208
ds_read_b64_tr_b16 v[102:103], v6 offset:6592
s_waitcnt lgkmcnt(0)
s_add_u32 s37, s51, 221184
s_add_u32 m0, s50, 3072
s_nop 0
buffer_load_dwordx4 v2, s[20:23], s37 offen lds
s_add_u32 m0, s50, 4096
s_nop 0
buffer_load_dwordx4 v3, s[20:23], s37 offen lds
s_add_u32 m0, s50, 5120
s_nop 0
buffer_load_dwordx4 v4, s[20:23], s37 offen lds
s_waitcnt vmcnt(24)
ds_read_b64_tr_b16 v[104:105], v6 offset:9216
ds_read_b64_tr_b16 v[106:107], v6 offset:9600
ds_read_b64_tr_b16 v[108:109], v6 offset:9248
ds_read_b64_tr_b16 v[110:111], v6 offset:9632
ds_read_b64_tr_b16 v[112:113], v6 offset:9280
ds_read_b64_tr_b16 v[114:115], v6 offset:9664
s_waitcnt lgkmcnt(0)
s_add_u32 s37, s51, 258048
s_add_u32 m0, s50, 6144
s_nop 0
buffer_load_dwordx4 v2, s[20:23], s37 offen lds
s_add_u32 m0, s50, 7168
s_nop 0
buffer_load_dwordx4 v3, s[20:23], s37 offen lds
s_add_u32 m0, s50, 8192
s_nop 0
buffer_load_dwordx4 v4, s[20:23], s37 offen lds
s_waitcnt vmcnt(24)
ds_read_b64_tr_b16 v[116:117], v6 offset:12288
ds_read_b64_tr_b16 v[118:119], v6 offset:12672
ds_read_b64_tr_b16 v[120:121], v6 offset:12320
ds_read_b64_tr_b16 v[122:123], v6 offset:12704
ds_read_b64_tr_b16 v[124:125], v6 offset:12352
ds_read_b64_tr_b16 v[126:127], v6 offset:12736
s_waitcnt lgkmcnt(0)
s_add_u32 s37, s51, 294912
s_add_u32 m0, s50, 9216
s_nop 0
buffer_load_dwordx4 v2, s[20:23], s37 offen lds
s_add_u32 m0, s50, 10240
s_nop 0
buffer_load_dwordx4 v3, s[20:23], s37 offen lds
s_add_u32 m0, s50, 11264
s_nop 0
buffer_load_dwordx4 v4, s[20:23], s37 offen lds
s_waitcnt vmcnt(24)
ds_read_b64_tr_b16 v[128:129], v5 offset:15360
ds_read_b64_tr_b16 v[130:131], v5 offset:16896
ds_read_b64_tr_b16 v[132:133], v5 offset:15392
ds_read_b64_tr_b16 v[134:135], v5 offset:16928
ds_read_b64_tr_b16 v[136:137], v5 offset:15424
ds_read_b64_tr_b16 v[138:139], v5 offset:16960
s_waitcnt lgkmcnt(0)
s_add_u32 s37, s51, 331776
s_add_u32 m0, s50, 12288
s_nop 0
buffer_load_dwordx4 v2, s[20:23], s37 offen lds
s_add_u32 m0, s50, 13312
s_nop 0
buffer_load_dwordx4 v3, s[20:23], s37 offen lds
s_add_u32 m0, s50, 14336
s_nop 0
buffer_load_dwordx4 v4, s[20:23], s37 offen lds
s_waitcnt vmcnt(24)
ds_read_b64_tr_b16 v[140:141], v5 offset:18432
ds_read_b64_tr_b16 v[142:143], v5 offset:19968
ds_read_b64_tr_b16 v[144:145], v5 offset:18464
ds_read_b64_tr_b16 v[146:147], v5 offset:20000
ds_read_b64_tr_b16 v[148:149], v5 offset:18496
ds_read_b64_tr_b16 v[150:151], v5 offset:20032
s_waitcnt lgkmcnt(0)
s_add_u32 s37, s51, 368640
s_add_u32 m0, s50, 15360
s_nop 0
buffer_load_dwordx4 v2, s[20:23], s37 offen lds
s_add_u32 m0, s50, 16384
s_nop 0
buffer_load_dwordx4 v3, s[20:23], s37 offen lds
s_add_u32 m0, s50, 17408
s_nop 0
buffer_load_dwordx4 v4, s[20:23], s37 offen lds
s_waitcnt vmcnt(24)
ds_read_b64_tr_b16 v[152:153], v5 offset:21504
ds_read_b64_tr_b16 v[154:155], v5 offset:23040
ds_read_b64_tr_b16 v[156:157], v5 offset:21536
ds_read_b64_tr_b16 v[158:159], v5 offset:23072
ds_read_b64_tr_b16 v[160:161], v5 offset:21568
ds_read_b64_tr_b16 v[162:163], v5 offset:23104
s_waitcnt lgkmcnt(0)
s_add_u32 s37, s51, 405504
s_add_u32 m0, s50, 18432
s_nop 0
buffer_load_dwordx4 v2, s[20:23], s37 offen lds
s_add_u32 m0, s50, 19456
s_nop 0
buffer_load_dwordx4 v3, s[20:23], s37 offen lds
s_add_u32 m0, s50, 20480
s_nop 0
buffer_load_dwordx4 v4, s[20:23], s37 offen lds
s_waitcnt vmcnt(24)
ds_read_b64_tr_b16 v[164:165], v5 offset:24576
ds_read_b64_tr_b16 v[166:167], v5 offset:26112
ds_read_b64_tr_b16 v[168:169], v5 offset:24608
ds_read_b64_tr_b16 v[170:171], v5 offset:26144
ds_read_b64_tr_b16 v[172:173], v5 offset:24640
ds_read_b64_tr_b16 v[174:175], v5 offset:26176
s_waitcnt lgkmcnt(0)
s_add_u32 s37, s51, 442368
s_add_u32 m0, s50, 21504
s_nop 0
buffer_load_dwordx4 v2, s[20:23], s37 offen lds
s_add_u32 m0, s50, 22528
s_nop 0
buffer_load_dwordx4 v3, s[20:23], s37 offen lds
s_add_u32 m0, s50, 23552
s_nop 0
buffer_load_dwordx4 v4, s[20:23], s37 offen lds
s_waitcnt vmcnt(24)
ds_read_b64_tr_b16 v[176:177], v5 offset:27648
ds_read_b64_tr_b16 v[178:179], v5 offset:29184
ds_read_b64_tr_b16 v[180:181], v5 offset:27680
ds_read_b64_tr_b16 v[182:183], v5 offset:29216
ds_read_b64_tr_b16 v[184:185], v5 offset:27712
ds_read_b64_tr_b16 v[186:187], v5 offset:29248
s_waitcnt lgkmcnt(0)
s_add_u32 s37, s51, 479232
s_add_u32 m0, s50, 24576
s_nop 0
buffer_load_dwordx4 v2, s[20:23], s37 offen lds
s_add_u32 m0, s50, 25600
s_nop 0
buffer_load_dwordx4 v3, s[20:23], s37 offen lds
s_add_u32 m0, s50, 26624
s_nop 0
buffer_load_dwordx4 v4, s[20:23], s37 offen lds
s_waitcnt vmcnt(24)
ds_read_b64_tr_b16 v[188:189], v5 offset:0
ds_read_b64_tr_b16 v[190:191], v5 offset:1536
ds_read_b64_tr_b16 v[192:193], v5 offset:32
ds_read_b64_tr_b16 v[194:195], v5 offset:1568
ds_read_b64_tr_b16 v[196:197], v5 offset:64
ds_read_b64_tr_b16 v[198:199], v5 offset:1600
s_waitcnt lgkmcnt(0)
s_add_u32 s37, s51, 516096
s_add_u32 m0, s50, 27648
s_nop 0
buffer_load_dwordx4 v2, s[20:23], s37 offen lds
s_add_u32 m0, s50, 28672
s_nop 0
buffer_load_dwordx4 v3, s[20:23], s37 offen lds
s_add_u32 m0, s50, 29696
s_nop 0
buffer_load_dwordx4 v4, s[20:23], s37 offen lds
s_waitcnt vmcnt(24)
ds_read_b64_tr_b16 v[200:201], v5 offset:3072
ds_read_b64_tr_b16 v[202:203], v5 offset:4608
ds_read_b64_tr_b16 v[204:205], v5 offset:3104
ds_read_b64_tr_b16 v[206:207], v5 offset:4640
ds_read_b64_tr_b16 v[208:209], v5 offset:3136
ds_read_b64_tr_b16 v[210:211], v5 offset:4672
s_waitcnt lgkmcnt(0)
s_add_u32 s37, s51, 552960
s_add_u32 m0, s50, 0
s_nop 0
buffer_load_dwordx4 v2, s[20:23], s37 offen lds
s_add_u32 m0, s50, 1024
s_nop 0
buffer_load_dwordx4 v3, s[20:23], s37 offen lds
s_add_u32 m0, s50, 2048
s_nop 0
buffer_load_dwordx4 v4, s[20:23], s37 offen lds
s_waitcnt vmcnt(24)
ds_read_b64_tr_b16 v[212:213], v5 offset:6144
ds_read_b64_tr_b16 v[214:215], v5 offset:7680
ds_read_b64_tr_b16 v[216:217], v5 offset:6176
ds_read_b64_tr_b16 v[218:219], v5 offset:7712
ds_read_b64_tr_b16 v[220:221], v5 offset:6208
ds_read_b64_tr_b16 v[222:223], v5 offset:7744
s_waitcnt lgkmcnt(0)
s_add_u32 s37, s51, 589824
s_add_u32 m0, s50, 3072
s_nop 0
buffer_load_dwordx4 v2, s[20:23], s37 offen lds
s_add_u32 m0, s50, 4096
s_nop 0
buffer_load_dwordx4 v3, s[20:23], s37 offen lds
s_add_u32 m0, s50, 5120
s_nop 0
buffer_load_dwordx4 v4, s[20:23], s37 offen lds
s_waitcnt vmcnt(24)
ds_read_b64_tr_b16 v[224:225], v5 offset:9216
ds_read_b64_tr_b16 v[226:227], v5 offset:10752
ds_read_b64_tr_b16 v[228:229], v5 offset:9248
ds_read_b64_tr_b16 v[230:231], v5 offset:10784
ds_read_b64_tr_b16 v[232:233], v5 offset:9280
ds_read_b64_tr_b16 v[234:235], v5 offset:10816
s_waitcnt lgkmcnt(0)
s_add_u32 s37, s51, 626688
s_add_u32 m0, s50, 6144
s_nop 0
buffer_load_dwordx4 v2, s[20:23], s37 offen lds
s_add_u32 m0, s50, 7168
s_nop 0
buffer_load_dwordx4 v3, s[20:23], s37 offen lds
s_add_u32 m0, s50, 8192
s_nop 0
buffer_load_dwordx4 v4, s[20:23], s37 offen lds
s_waitcnt vmcnt(24)
ds_read_b64_tr_b16 v[236:237], v5 offset:12288
ds_read_b64_tr_b16 v[238:239], v5 offset:13824
ds_read_b64_tr_b16 v[240:241], v5 offset:12320
ds_read_b64_tr_b16 v[242:243], v5 offset:13856
ds_read_b64_tr_b16 v[244:245], v5 offset:12352
ds_read_b64_tr_b16 v[246:247], v5 offset:13888
s_waitcnt lgkmcnt(0)
s_add_u32 s37, s51, 663552
s_add_u32 m0, s50, 9216
s_nop 0
buffer_load_dwordx4 v2, s[20:23], s37 offen lds
s_add_u32 m0, s50, 10240
s_nop 0
buffer_load_dwordx4 v3, s[20:23], s37 offen lds
s_add_u32 m0, s50, 11264
s_nop 0
buffer_load_dwordx4 v4, s[20:23], s37 offen lds
s_waitcnt vmcnt(24)
ds_read_b64_tr_b16 v[248:249], v5 offset:15360
ds_read_b64_tr_b16 v[250:251], v5 offset:16896
ds_read_b64_tr_b16 v[252:253], v5 offset:15392
ds_read_b64_tr_b16 v[254:255], v5 offset:16928
ds_read_b64_tr_b16 a[0:1], v5 offset:15424
ds_read_b64_tr_b16 a[2:3], v5 offset:16960
s_waitcnt lgkmcnt(0)
s_add_u32 s37, s51, 700416
s_add_u32 m0, s50, 12288
s_nop 0
buffer_load_dwordx4 v2, s[20:23], s37 offen lds
s_add_u32 m0, s50, 13312
s_nop 0
buffer_load_dwordx4 v3, s[20:23], s37 offen lds
s_add_u32 m0, s50, 14336
s_nop 0
buffer_load_dwordx4 v4, s[20:23], s37 offen lds
s_waitcnt vmcnt(24)
ds_read_b64_tr_b16 a[4:5], v5 offset:18432
ds_read_b64_tr_b16 a[6:7], v5 offset:19968
ds_read_b64_tr_b16 a[8:9], v5 offset:18464
ds_read_b64_tr_b16 a[10:11], v5 offset:20000
ds_read_b64_tr_b16 a[12:13], v5 offset:18496
ds_read_b64_tr_b16 a[14:15], v5 offset:20032
s_waitcnt lgkmcnt(0)
s_add_u32 s37, s51, 737280
s_add_u32 m0, s50, 15360
s_nop 0
buffer_load_dwordx4 v2, s[20:23], s37 offen lds
s_add_u32 m0, s50, 16384
s_nop 0
buffer_load_dwordx4 v3, s[20:23], s37 offen lds
s_add_u32 m0, s50, 17408
s_nop 0
buffer_load_dwordx4 v4, s[20:23], s37 offen lds
s_waitcnt vmcnt(24)
ds_read_b64_tr_b16 a[16:17], v5 offset:21504
ds_read_b64_tr_b16 a[18:19], v5 offset:23040
ds_read_b64_tr_b16 a[20:21], v5 offset:21536
ds_read_b64_tr_b16 a[22:23], v5 offset:23072
ds_read_b64_tr_b16 a[24:25], v5 offset:21568
ds_read_b64_tr_b16 a[26:27], v5 offset:23104
s_waitcnt lgkmcnt(0)
s_add_u32 s37, s51, 774144
s_add_u32 m0, s50, 18432
s_nop 0
buffer_load_dwordx4 v2, s[20:23], s37 offen lds
s_add_u32 m0, s50, 19456
s_nop 0
buffer_load_dwordx4 v3, s[20:23], s37 offen lds
s_add_u32 m0, s50, 20480
s_nop 0
buffer_load_dwordx4 v4, s[20:23], s37 offen lds
s_waitcnt vmcnt(24)
ds_read_b64_tr_b16 a[28:29], v5 offset:24576
ds_read_b64_tr_b16 a[30:31], v5 offset:26112
ds_read_b64_tr_b16 a[32:33], v5 offset:24608
ds_read_b64_tr_b16 a[34:35], v5 offset:26144
ds_read_b64_tr_b16 a[36:37], v5 offset:24640
ds_read_b64_tr_b16 a[38:39], v5 offset:26176
s_waitcnt lgkmcnt(0)
s_add_u32 s37, s51, 811008
s_add_u32 m0, s50, 21504
s_nop 0
buffer_load_dwordx4 v2, s[20:23], s37 offen lds
s_add_u32 m0, s50, 22528
s_nop 0
buffer_load_dwordx4 v3, s[20:23], s37 offen lds
s_add_u32 m0, s50, 23552
s_nop 0
buffer_load_dwordx4 v4, s[20:23], s37 offen lds
s_waitcnt vmcnt(24)
ds_read_b64_tr_b16 a[40:41], v5 offset:27648
ds_read_b64_tr_b16 a[42:43], v5 offset:29184
ds_read_b64_tr_b16 a[44:45], v5 offset:27680
ds_read_b64_tr_b16 a[46:47], v5 offset:29216
ds_read_b64_tr_b16 a[48:49], v5 offset:27712
ds_read_b64_tr_b16 a[50:51], v5 offset:29248
s_waitcnt lgkmcnt(0)
s_add_u32 s37, s51, 847872
s_add_u32 m0, s50, 24576
s_nop 0
buffer_load_dwordx4 v2, s[20:23], s37 offen lds
s_add_u32 m0, s50, 25600
s_nop 0
buffer_load_dwordx4 v3, s[20:23], s37 offen lds
s_add_u32 m0, s50, 26624
s_nop 0
buffer_load_dwordx4 v4, s[20:23], s37 offen lds
s_waitcnt vmcnt(24)
ds_read_b64_tr_b16 a[52:53], v5 offset:0
ds_read_b64_tr_b16 a[54:55], v5 offset:1536
ds_read_b64_tr_b16 a[56:57], v5 offset:32
ds_read_b64_tr_b16 a[58:59], v5 offset:1568
ds_read_b64_tr_b16 a[60:61], v5 offset:64
ds_read_b64_tr_b16 a[62:63], v5 offset:1600
s_waitcnt lgkmcnt(0)
s_add_u32 s37, s51, 884736
s_add_u32 m0, s50, 27648
s_nop 0
buffer_load_dwordx4 v2, s[20:23], s37 offen lds
s_add_u32 m0, s50, 28672
s_nop 0
buffer_load_dwordx4 v3, s[20:23], s37 offen lds
s_add_u32 m0, s50, 29696
s_nop 0
buffer_load_dwordx4 v4, s[20:23], s37 offen lds
s_waitcnt vmcnt(24)
ds_read_b64_tr_b16 a[64:65], v5 offset:3072
ds_read_b64_tr_b16 a[66:67], v5 offset:4608
ds_read_b64_tr_b16 a[68:69], v5 offset:3104
ds_read_b64_tr_b16 a[70:71], v5 offset:4640
ds_read_b64_tr_b16 a[72:73], v5 offset:3136
ds_read_b64_tr_b16 a[74:75], v5 offset:4672
s_waitcnt lgkmcnt(0)
s_add_u32 s37, s51, 921600
s_add_u32 m0, s50, 0
s_nop 0
buffer_load_dwordx4 v2, s[20:23], s37 offen lds
s_add_u32 m0, s50, 1024
s_nop 0
buffer_load_dwordx4 v3, s[20:23], s37 offen lds
s_add_u32 m0, s50, 2048
s_nop 0
buffer_load_dwordx4 v4, s[20:23], s37 offen lds
s_waitcnt vmcnt(24)
ds_read_b64_tr_b16 a[76:77], v5 offset:6144
ds_read_b64_tr_b16 a[78:79], v5 offset:7680
ds_read_b64_tr_b16 a[80:81], v5 offset:6176
ds_read_b64_tr_b16 a[82:83], v5 offset:7712
ds_read_b64_tr_b16 a[84:85], v5 offset:6208
ds_read_b64_tr_b16 a[86:87], v5 offset:7744
s_waitcnt lgkmcnt(0)
s_add_u32 s37, s51, 958464
s_add_u32 m0, s50, 3072
s_nop 0
buffer_load_dwordx4 v2, s[20:23], s37 offen lds
s_add_u32 m0, s50, 4096
s_nop 0
buffer_load_dwordx4 v3, s[20:23], s37 offen lds
s_add_u32 m0, s50, 5120
s_nop 0
buffer_load_dwordx4 v4, s[20:23], s37 offen lds
s_waitcnt vmcnt(24)
ds_read_b64_tr_b16 a[88:89], v5 offset:9216
ds_read_b64_tr_b16 a[90:91], v5 offset:10752
ds_read_b64_tr_b16 a[92:93], v5 offset:9248
ds_read_b64_tr_b16 a[94:95], v5 offset:10784
ds_read_b64_tr_b16 a[96:97], v5 offset:9280
ds_read_b64_tr_b16 a[98:99], v5 offset:10816
s_waitcnt lgkmcnt(0)
s_add_u32 s37, s51, 995328
s_add_u32 m0, s50, 6144
s_nop 0
buffer_load_dwordx4 v2, s[20:23], s37 offen lds
s_add_u32 m0, s50, 7168
s_nop 0
buffer_load_dwordx4 v3, s[20:23], s37 offen lds
s_add_u32 m0, s50, 8192
s_nop 0
buffer_load_dwordx4 v4, s[20:23], s37 offen lds
s_waitcnt vmcnt(24)
ds_read_b64_tr_b16 a[100:101], v5 offset:12288
ds_read_b64_tr_b16 a[102:103], v5 offset:13824
ds_read_b64_tr_b16 a[104:105], v5 offset:12320
ds_read_b64_tr_b16 a[106:107], v5 offset:13856
ds_read_b64_tr_b16 a[108:109], v5 offset:12352
ds_read_b64_tr_b16 a[110:111], v5 offset:13888
s_waitcnt lgkmcnt(0)
s_add_u32 s37, s51, 1032192
s_add_u32 m0, s50, 9216
s_nop 0
buffer_load_dwordx4 v2, s[20:23], s37 offen lds
s_add_u32 m0, s50, 10240
s_nop 0
buffer_load_dwordx4 v3, s[20:23], s37 offen lds
s_add_u32 m0, s50, 11264
s_nop 0
buffer_load_dwordx4 v4, s[20:23], s37 offen lds
s_waitcnt vmcnt(24)
ds_read_b64_tr_b16 a[112:113], v5 offset:15360
ds_read_b64_tr_b16 a[114:115], v5 offset:16896
ds_read_b64_tr_b16 a[116:117], v5 offset:15392
ds_read_b64_tr_b16 a[118:119], v5 offset:16928
ds_read_b64_tr_b16 a[120:121], v5 offset:15424
ds_read_b64_tr_b16 a[122:123], v5 offset:16960
s_waitcnt lgkmcnt(0)
s_add_u32 s37, s51, 1069056
s_add_u32 m0, s50, 12288
s_nop 0
buffer_load_dwordx4 v2, s[20:23], s37 offen lds
s_add_u32 m0, s50, 13312
s_nop 0
buffer_load_dwordx4 v3, s[20:23], s37 offen lds
s_add_u32 m0, s50, 14336
s_nop 0
buffer_load_dwordx4 v4, s[20:23], s37 offen lds
s_waitcnt vmcnt(24)
ds_read_b64_tr_b16 a[124:125], v5 offset:18432
ds_read_b64_tr_b16 a[126:127], v5 offset:19968
ds_read_b64_tr_b16 a[128:129], v5 offset:18464
ds_read_b64_tr_b16 a[130:131], v5 offset:20000
ds_read_b64_tr_b16 a[132:133], v5 offset:18496
ds_read_b64_tr_b16 a[134:135], v5 offset:20032
s_waitcnt lgkmcnt(0)
s_add_u32 s37, s51, 1105920
s_add_u32 m0, s50, 15360
s_nop 0
buffer_load_dwordx4 v2, s[20:23], s37 offen lds
s_add_u32 m0, s50, 16384
s_nop 0
buffer_load_dwordx4 v3, s[20:23], s37 offen lds
s_add_u32 m0, s50, 17408
s_nop 0
buffer_load_dwordx4 v4, s[20:23], s37 offen lds
s_waitcnt vmcnt(24)
ds_read_b64_tr_b16 a[136:137], v5 offset:21504
ds_read_b64_tr_b16 a[138:139], v5 offset:23040
ds_read_b64_tr_b16 a[140:141], v5 offset:21536
ds_read_b64_tr_b16 a[142:143], v5 offset:23072
ds_read_b64_tr_b16 a[144:145], v5 offset:21568
ds_read_b64_tr_b16 a[146:147], v5 offset:23104
s_waitcnt lgkmcnt(0)
s_add_u32 s37, s51, 1142784
s_add_u32 m0, s50, 18432
s_nop 0
buffer_load_dwordx4 v2, s[20:23], s37 offen lds
s_add_u32 m0, s50, 19456
s_nop 0
buffer_load_dwordx4 v3, s[20:23], s37 offen lds
s_add_u32 m0, s50, 20480
s_nop 0
buffer_load_dwordx4 v4, s[20:23], s37 offen lds
s_waitcnt vmcnt(24)
ds_read_b64_tr_b16 a[148:149], v5 offset:24576
ds_read_b64_tr_b16 a[150:151], v5 offset:26112
ds_read_b64_tr_b16 a[152:153], v5 offset:24608
ds_read_b64_tr_b16 a[154:155], v5 offset:26144
ds_read_b64_tr_b16 a[156:157], v5 offset:24640
ds_read_b64_tr_b16 a[158:159], v5 offset:26176
s_waitcnt lgkmcnt(0)
s_waitcnt vmcnt(21)
ds_read_b64_tr_b16 a[160:161], v5 offset:27648
ds_read_b64_tr_b16 a[162:163], v5 offset:29184
ds_read_b64_tr_b16 a[164:165], v5 offset:27680
ds_read_b64_tr_b16 a[166:167], v5 offset:29216
ds_read_b64_tr_b16 a[168:169], v5 offset:27712
ds_read_b64_tr_b16 a[170:171], v5 offset:29248
s_waitcnt lgkmcnt(0)
s_waitcnt vmcnt(18)
ds_read_b64_tr_b16 a[172:173], v5 offset:0
ds_read_b64_tr_b16 a[174:175], v5 offset:1536
ds_read_b64_tr_b16 a[176:177], v5 offset:32
ds_read_b64_tr_b16 a[178:179], v5 offset:1568
ds_read_b64_tr_b16 a[180:181], v5 offset:64
ds_read_b64_tr_b16 a[182:183], v5 offset:1600
s_waitcnt lgkmcnt(0)
s_waitcnt vmcnt(15)
ds_read_b64_tr_b16 a[184:185], v5 offset:3072
ds_read_b64_tr_b16 a[186:187], v5 offset:4608
ds_read_b64_tr_b16 a[188:189], v5 offset:3104
ds_read_b64_tr_b16 a[190:191], v5 offset:4640
ds_read_b64_tr_b16 a[192:193], v5 offset:3136
ds_read_b64_tr_b16 a[194:195], v5 offset:4672
s_waitcnt lgkmcnt(0)
s_waitcnt vmcnt(12)
ds_read_b64_tr_b16 a[196:197], v5 offset:6144
ds_read_b64_tr_b16 a[198:199], v5 offset:7680
ds_read_b64_tr_b16 a[200:201], v5 offset:6176
ds_read_b64_tr_b16 a[202:203], v5 offset:7712
ds_read_b64_tr_b16 a[204:205], v5 offset:6208
ds_read_b64_tr_b16 a[206:207], v5 offset:7744
s_waitcnt lgkmcnt(0)
s_waitcnt vmcnt(9)
ds_read_b64_tr_b16 a[208:209], v5 offset:9216
ds_read_b64_tr_b16 a[210:211], v5 offset:10752
ds_read_b64_tr_b16 a[212:213], v5 offset:9248
ds_read_b64_tr_b16 a[214:215], v5 offset:10784
ds_read_b64_tr_b16 a[216:217], v5 offset:9280
ds_read_b64_tr_b16 a[218:219], v5 offset:10816
s_waitcnt lgkmcnt(0)
s_waitcnt vmcnt(6)
ds_read_b64_tr_b16 a[220:221], v5 offset:12288
ds_read_b64_tr_b16 a[222:223], v5 offset:13824
ds_read_b64_tr_b16 a[224:225], v5 offset:12320
ds_read_b64_tr_b16 a[226:227], v5 offset:13856
ds_read_b64_tr_b16 a[228:229], v5 offset:12352
ds_read_b64_tr_b16 a[230:231], v5 offset:13888
s_waitcnt lgkmcnt(0)
s_waitcnt vmcnt(3)
ds_read_b64_tr_b16 a[232:233], v5 offset:15360
ds_read_b64_tr_b16 a[234:235], v5 offset:16896
ds_read_b64_tr_b16 a[236:237], v5 offset:15392
ds_read_b64_tr_b16 a[238:239], v5 offset:16928
ds_read_b64_tr_b16 a[240:241], v5 offset:15424
ds_read_b64_tr_b16 a[242:243], v5 offset:16960
s_waitcnt lgkmcnt(0)
s_waitcnt vmcnt(0)
ds_read_b64_tr_b16 a[244:245], v5 offset:18432
ds_read_b64_tr_b16 a[246:247], v5 offset:19968
ds_read_b64_tr_b16 a[248:249], v5 offset:18464
ds_read_b64_tr_b16 a[250:251], v5 offset:20000
ds_read_b64_tr_b16 a[252:253], v5 offset:18496
ds_read_b64_tr_b16 a[254:255], v5 offset:20032
s_waitcnt lgkmcnt(0)
s_branch L_w_init_in
L_w_init:
s_sleep 4
L_w_init_in:
buffer_load_dword v12, v8, s[24:27], 0 offen offset:0 sc0 sc1
s_sub_u32 s36, s36, 1
s_cbranch_scc1 L_exit_w
s_waitcnt vmcnt(0)
v_readfirstlane_b32 s37, v12
s_nop 0
s_and_b32 s37, s37, 0xff
s_cmp_eq_u32 s37, 32
s_cbranch_scc0 L_w_init
s_branch L_w_adone_in
L_w_adone:
s_sleep 4
L_w_adone_in:
buffer_load_dword v12, v8, s[24:27], 0 offen offset:4 sc0 sc1
s_sub_u32 s36, s36, 1
s_cbranch_scc1 L_exit_w
s_waitcnt vmcnt(0)
v_readfirstlane_b32 s37, v12
s_nop 0
s_cmp_eq_u32 s37, 96
s_cbranch_scc0 L_w_adone
s_mov_b32 s35, 0
s_mul_i32 s52, s34, 5
s_mul_i32 s58, s34, 3072
v_add_u32 v2, s58, v14
s_lshl_b32 s37, s34, 10
v_add_u32 v14, s37, v14
L_w_loop:
s_add_u32 s37, s52, 0
s_min_u32 s37, s37, 17
s_lshl_b32 s37, s37, 10
s_add_u32 s37, s37, s54
buffer_load_dwordx4 v[40:43], v1, s[4:7], s37 offen sc1
s_add_u32 s37, s52, 1
s_min_u32 s37, s37, 17
s_lshl_b32 s37, s37, 10
s_add_u32 s37, s37, s54
buffer_load_dwordx4 v[44:47], v1, s[4:7], s37 offen sc1
s_add_u32 s37, s52, 2
s_min_u32 s37, s37, 17
s_lshl_b32 s37, s37, 10
s_add_u32 s37, s37, s54
buffer_load_dwordx4 v[48:51], v1, s[4:7], s37 offen sc1
s_add_u32 s37, s52, 3
s_min_u32 s37, s37, 17
s_lshl_b32 s37, s37, 10
s_add_u32 s37, s37, s54
buffer_load_dwordx4 v[52:55], v1, s[4:7], s37 offen sc1
s_add_u32 s37, s52, 4
s_min_u32 s37, s37, 17
s_lshl_b32 s37, s37, 10
s_add_u32 s37, s37, s54
buffer_load_dwordx4 v[56:59], v1, s[4:7], s37 offen sc1
buffer_load_dword v13, v10, s[4:7], s56 offen sc1
s_waitcnt vmcnt(5)
v_mfma_f32_16x16x32_bf16 v[28:31], v[68:71], v[40:43], 0
v_mfma_f32_16x16x32_bf16 v[32:35], v[72:75], v[40:43], 0
v_mfma_f32_16x16x32_bf16 v[36:39], v[76:79], v[40:43], 0
s_waitcnt vmcnt(4)
v_mfma_f32_16x16x32_bf16 v[28:31], v[80:83], v[44:47], v[28:31]
v_mfma_f32_16x16x32_bf16 v[32:35], v[84:87], v[44:47], v[32:35]
v_mfma_f32_16x16x32_bf16 v[36:39], v[88:91], v[44:47], v[36:39]
s_waitcnt vmcnt(3)
v_mfma_f32_16x16x32_bf16 v[28:31], v[92:95], v[48:51], v[28:31]
v_mfma_f32_16x16x32_bf16 v[32:35], v[96:99], v[48:51], v[32:35]
v_mfma_f32_16x16x32_bf16 v[36:39], v[100:103], v[48:51], v[36:39]
s_waitcnt vmcnt(2)
v_mfma_f32_16x16x32_bf16 v[28:31], v[104:107], v[52:55], v[28:31]
v_mfma_f32_16x16x32_bf16 v[32:35], v[108:111], v[52:55], v[32:35]
v_mfma_f32_16x16x32_bf16 v[36:39], v[112:115], v[52:55], v[36:39]
s_waitcnt vmcnt(1)
v_mfma_f32_16x16x32_bf16 v[28:31], v[116:119], v[56:59], v[28:31]
v_mfma_f32_16x16x32_bf16 v[32:35], v[120:123], v[56:59], v[32:35]
v_mfma_f32_16x16x32_bf16 v[36:39], v[124:127], v[56:59], v[36:39]
s_branch L_w_poll_in
L_w_poll:
s_sleep 2
L_w_poll_in:
buffer_load_dword v12, v9, s[4:7], s57 offen offset:0 sc0 sc1
s_sub_u32 s36, s36, 1
s_cbranch_scc1 L_exit_w
s_waitcnt vmcnt(0)
v_cmp_ge_u32 vcc, s35, v12
s_nop 1
s_cmp_eq_u64 vcc, 0
s_cbranch_scc0 L_w_poll
s_add_u32 s37, s53, 0
s_add_u32 m0, s50, 0
s_nop 0
buffer_load_dwordx4 v1, s[4:7], s37 offen offset:0 sc1 lds
buffer_load_dwordx4 v1, s[4:7], s37 offen offset:1024 sc1 lds
buffer_load_dwordx4 v1, s[4:7], s37 offen offset:2048 sc1 lds
buffer_load_dwordx4 v1, s[4:7], s37 offen offset:3072 sc1 lds
s_add_u32 s37, s53, 4096
s_add_u32 m0, s50, 4096
s_nop 0
buffer_load_dwordx4 v1, s[4:7], s37 offen offset:0 sc1 lds
buffer_load_dwordx4 v1, s[4:7], s37 offen offset:1024 sc1 lds
buffer_load_dwordx4 v1, s[4:7], s37 offen offset:2048 sc1 lds
buffer_load_dwordx4 v1, s[4:7], s37 offen offset:3072 sc1 lds
s_add_u32 s37, s53, 8192
s_add_u32 m0, s50, 8192
s_nop 0
buffer_load_dwordx4 v1, s[4:7], s37 offen offset:0 sc1 lds
buffer_load_dwordx4 v1, s[4:7], s37 offen offset:1024 sc1 lds
buffer_load_dwordx4 v1, s[4:7], s37 offen offset:2048 sc1 lds
buffer_load_dwordx4 v1, s[4:7], s37 offen offset:3072 sc1 lds
s_add_u32 s37, s53, 12288
s_add_u32 m0, s50, 12288
s_nop 0
buffer_load_dwordx4 v1, s[4:7], s37 offen offset:0 sc1 lds
buffer_load_dwordx4 v1, s[4:7], s37 offen offset:1024 sc1 lds
buffer_load_dwordx4 v1, s[4:7], s37 offen offset:2048 sc1 lds
buffer_load_dwordx4 v1, s[4:7], s37 offen offset:3072 sc1 lds
s_add_u32 s37, s53, 16384
s_add_u32 m0, s50, 16384
s_nop 0
buffer_load_dwordx4 v1, s[4:7], s37 offen offset:0 sc1 lds
buffer_load_dwordx4 v1, s[4:7], s37 offen offset:1024 sc1 lds
buffer_load_dwordx4 v1, s[4:7], s37 offen offset:2048 sc1 lds
buffer_load_dwordx4 v1, s[4:7], s37 offen offset:3072 sc1 lds
s_add_u32 s37, s53, 20480
s_add_u32 m0, s50, 20480
s_nop 0
buffer_load_dwordx4 v1, s[4:7], s37 offen offset:0 sc1 lds
buffer_load_dwordx4 v1, s[4:7], s37 offen offset:1024 sc1 lds
buffer_load_dwordx4 v1, s[4:7], s37 offen offset:2048 sc1 lds
buffer_load_dwordx4 v1, s[4:7], s37 offen offset:3072 sc1 lds
s_add_u32 s37, s53, 24576
s_add_u32 m0, s50, 24576
s_nop 0
buffer_load_dwordx4 v1, s[4:7], s37 offen offset:0 sc1 lds
buffer_load_dwordx4 v1, s[4:7], s37 offen offset:1024 sc1 lds
buffer_load_dwordx4 v1, s[4:7], s37 offen offset:2048 sc1 lds
buffer_load_dwordx4 v1, s[4:7], s37 offen offset:3072 sc1 lds
s_add_u32 s37, s53, 28672
s_add_u32 m0, s50, 28672
s_nop 0
buffer_load_dwordx4 v1, s[4:7], s37 offen offset:0 sc1 lds
buffer_load_dwordx4 v1, s[4:7], s37 offen offset:1024 sc1 lds
buffer_load_dwordx4 v1, s[4:7], s37 offen offset:2048 sc1 lds
buffer_load_dwordx4 v1, s[4:7], s37 offen offset:3072 sc1 lds
s_waitcnt vmcnt(31)
ds_read_b128 v[40:43], v7 offset:0
s_waitcnt vmcnt(30)
ds_read_b128 v[44:47], v7 offset:1024
s_waitcnt vmcnt(29)
ds_read_b128 v[48:51], v7 offset:2048
s_waitcnt lgkmcnt(2)
v_mfma_f32_16x16x32_bf16 v[16:19], v[128:131], v[40:43], 0
v_mfma_f32_16x16x32_bf16 v[20:23], v[132:135], v[40:43], 0
v_mfma_f32_16x16x32_bf16 v[24:27], v[136:139], v[40:43], 0
s_waitcnt vmcnt(28)
ds_read_b128 v[52:55], v7 offset:3072
s_waitcnt lgkmcnt(2)
v_mfma_f32_16x16x32_bf16 v[16:19], v[140:143], v[44:47], v[16:19]
v_mfma_f32_16x16x32_bf16 v[20:23], v[144:147], v[44:47], v[20:23]
v_mfma_f32_16x16x32_bf16 v[24:27], v[148:151], v[44:47], v[24:27]
s_waitcnt vmcnt(27)
ds_read_b128 v[40:43], v7 offset:4096
s_waitcnt lgkmcnt(2)
v_mfma_f32_16x16x32_bf16 v[16:19], v[152:155], v[48:51], v[16:19]
v_mfma_f32_16x16x32_bf16 v[20:23], v[156:159], v[48:51], v[20:23]
v_mfma_f32_16x16x32_bf16 v[24:27], v[160:163], v[48:51], v[24:27]
s_waitcnt vmcnt(26)
ds_read_b128 v[44:47], v7 offset:5120
s_waitcnt lgkmcnt(2)
v_mfma_f32_16x16x32_bf16 v[16:19], v[164:167], v[52:55], v[16:19]
v_mfma_f32_16x16x32_bf16 v[20:23], v[168:171], v[52:55], v[20:23]
v_mfma_f32_16x16x32_bf16 v[24:27], v[172:175], v[52:55], v[24:27]
s_waitcnt vmcnt(25)
ds_read_b128 v[48:51], v7 offset:6144
s_waitcnt lgkmcnt(2)
v_mfma_f32_16x16x32_bf16 v[16:19], v[176:179], v[40:43], v[16:19]
v_mfma_f32_16x16x32_bf16 v[20:23], v[180:183], v[40:43], v[20:23]
v_mfma_f32_16x16x32_bf16 v[24:27], v[184:187], v[40:43], v[24:27]
s_waitcnt vmcnt(24)
ds_read_b128 v[52:55], v7 offset:7168
s_waitcnt lgkmcnt(2)
v_mfma_f32_16x16x32_bf16 v[16:19], v[188:191], v[44:47], v[16:19]
v_mfma_f32_16x16x32_bf16 v[20:23], v[192:195], v[44:47], v[20:23]
v_mfma_f32_16x16x32_bf16 v[24:27], v[196:199], v[44:47], v[24:27]
s_waitcnt vmcnt(23)
ds_read_b128 v[40:43], v7 offset:8192
s_waitcnt lgkmcnt(2)
v_mfma_f32_16x16x32_bf16 v[16:19], v[200:203], v[48:51], v[16:19]
v_mfma_f32_16x16x32_bf16 v[20:23], v[204:207], v[48:51], v[20:23]
v_mfma_f32_16x16x32_bf16 v[24:27], v[208:211], v[48:51], v[24:27]
s_waitcnt vmcnt(22)
ds_read_b128 v[44:47], v7 offset:9216
s_waitcnt lgkmcnt(2)
v_mfma_f32_16x16x32_bf16 v[16:19], v[212:215], v[52:55], v[16:19]
v_mfma_f32_16x16x32_bf16 v[20:23], v[216:219], v[52:55], v[20:23]
v_mfma_f32_16x16x32_bf16 v[24:27], v[220:223], v[52:55], v[24:27]
s_waitcnt vmcnt(21)
ds_read_b128 v[48:51], v7 offset:10240
s_waitcnt lgkmcnt(2)
v_mfma_f32_16x16x32_bf16 v[16:19], v[224:227], v[40:43], v[16:19]
v_mfma_f32_16x16x32_bf16 v[20:23], v[228:231], v[40:43], v[20:23]
v_mfma_f32_16x16x32_bf16 v[24:27], v[232:235], v[40:43], v[24:27]
s_waitcnt vmcnt(20)
ds_read_b128 v[52:55], v7 offset:11264
s_waitcnt lgkmcnt(2)
v_mfma_f32_16x16x32_bf16 v[16:19], v[236:239], v[44:47], v[16:19]
v_mfma_f32_16x16x32_bf16 v[20:23], v[240:243], v[44:47], v[20:23]
v_mfma_f32_16x16x32_bf16 v[24:27], v[244:247], v[44:47], v[24:27]
s_waitcnt vmcnt(19)
ds_read_b128 v[40:43], v7 offset:12288
s_waitcnt lgkmcnt(2)
v_mfma_f32_16x16x32_bf16 v[16:19], v[248:251], v[48:51], v[16:19]
v_mfma_f32_16x16x32_bf16 v[20:23], v[252:255], v[48:51], v[20:23]
v_mfma_f32_16x16x32_bf16 v[24:27], a[0:3], v[48:51], v[24:27]
s_waitcnt vmcnt(18)
ds_read_b128 v[44:47], v7 offset:13312
s_waitcnt lgkmcnt(2)
v_mfma_f32_16x16x32_bf16 v[16:19], a[4:7], v[52:55], v[16:19]
v_mfma_f32_16x16x32_bf16 v[20:23], a[8:11], v[52:55], v[20:23]
v_mfma_f32_16x16x32_bf16 v[24:27], a[12:15], v[52:55], v[24:27]
s_waitcnt vmcnt(17)
ds_read_b128 v[48:51], v7 offset:14336
s_waitcnt lgkmcnt(2)
v_mfma_f32_16x16x32_bf16 v[16:19], a[16:19], v[40:43], v[16:19]
v_mfma_f32_16x16x32_bf16 v[20:23], a[20:23], v[40:43], v[20:23]
v_mfma_f32_16x16x32_bf16 v[24:27], a[24:27], v[40:43], v[24:27]
s_waitcnt vmcnt(16)
ds_read_b128 v[52:55], v7 offset:15360
s_waitcnt lgkmcnt(2)
v_mfma_f32_16x16x32_bf16 v[16:19], a[28:31], v[44:47], v[16:19]
v_mfma_f32_16x16x32_bf16 v[20:23], a[32:35], v[44:47], v[20:23]
v_mfma_f32_16x16x32_bf16 v[24:27], a[36:39], v[44:47], v[24:27]
s_waitcnt vmcnt(15)
ds_read_b128 v[40:43], v7 offset:16384
s_waitcnt lgkmcnt(2)
v_mfma_f32_16x16x32_bf16 v[16:19], a[40:43], v[48:51], v[16:19]
v_mfma_f32_16x16x32_bf16 v[20:23], a[44:47], v[48:51], v[20:23]
v_mfma_f32_16x16x32_bf16 v[24:27], a[48:51], v[48:51], v[24:27]
s_waitcnt vmcnt(14)
ds_read_b128 v[44:47], v7 offset:17408
s_waitcnt lgkmcnt(2)
v_mfma_f32_16x16x32_bf16 v[16:19], a[52:55], v[52:55], v[16:19]
v_mfma_f32_16x16x32_bf16 v[20:23], a[56:59], v[52:55], v[20:23]
v_mfma_f32_16x16x32_bf16 v[24:27], a[60:63], v[52:55], v[24:27]
s_waitcnt vmcnt(13)
ds_read_b128 v[48:51], v7 offset:18432
s_waitcnt lgkmcnt(2)
v_mfma_f32_16x16x32_bf16 v[16:19], a[64:67], v[40:43], v[16:19]
v_mfma_f32_16x16x32_bf16 v[20:23], a[68:71], v[40:43], v[20:23]
v_mfma_f32_16x16x32_bf16 v[24:27], a[72:75], v[40:43], v[24:27]
s_waitcnt vmcnt(12)
ds_read_b128 v[52:55], v7 offset:19456
s_waitcnt lgkmcnt(2)
v_mfma_f32_16x16x32_bf16 v[16:19], a[76:79], v[44:47], v[16:19]
v_mfma_f32_16x16x32_bf16 v[20:23], a[80:83], v[44:47], v[20:23]
v_mfma_f32_16x16x32_bf16 v[24:27], a[84:87], v[44:47], v[24:27]
s_waitcnt vmcnt(11)
ds_read_b128 v[40:43], v7 offset:20480
s_waitcnt lgkmcnt(2)
v_mfma_f32_16x16x32_bf16 v[16:19], a[88:91], v[48:51], v[16:19]
v_mfma_f32_16x16x32_bf16 v[20:23], a[92:95], v[48:51], v[20:23]
v_mfma_f32_16x16x32_bf16 v[24:27], a[96:99], v[48:51], v[24:27]
s_waitcnt vmcnt(10)
ds_read_b128 v[44:47], v7 offset:21504
s_waitcnt lgkmcnt(2)
v_mfma_f32_16x16x32_bf16 v[16:19], a[100:103], v[52:55], v[16:19]
v_mfma_f32_16x16x32_bf16 v[20:23], a[104:107], v[52:55], v[20:23]
v_mfma_f32_16x16x32_bf16 v[24:27], a[108:111], v[52:55], v[24:27]
s_waitcnt vmcnt(9)
ds_read_b128 v[48:51], v7 offset:22528
s_waitcnt lgkmcnt(2)
v_mfma_f32_16x16x32_bf16 v[16:19], a[112:115], v[40:43], v[16:19]
v_mfma_f32_16x16x32_bf16 v[20:23], a[116:119], v[40:43], v[20:23]
v_mfma_f32_16x16x32_bf16 v[24:27], a[120:123], v[40:43], v[24:27]
s_waitcnt vmcnt(8)
ds_read_b128 v[52:55], v7 offset:23552
s_waitcnt lgkmcnt(2)
v_mfma_f32_16x16x32_bf16 v[16:19], a[124:127], v[44:47], v[16:19]
v_mfma_f32_16x16x32_bf16 v[20:23], a[128:131], v[44:47], v[20:23]
v_mfma_f32_16x16x32_bf16 v[24:27], a[132:135], v[44:47], v[24:27]
s_waitcnt vmcnt(7)
ds_read_b128 v[40:43], v7 offset:24576
s_waitcnt lgkmcnt(2)
v_mfma_f32_16x16x32_bf16 v[16:19], a[136:139], v[48:51], v[16:19]
v_mfma_f32_16x16x32_bf16 v[20:23], a[140:143], v[48:51], v[20:23]
v_mfma_f32_16x16x32_bf16 v[24:27], a[144:147], v[48:51], v[24:27]
s_waitcnt vmcnt(6)
ds_read_b128 v[44:47], v7 offset:25600
s_waitcnt lgkmcnt(2)
v_mfma_f32_16x16x32_bf16 v[16:19], a[148:151], v[52:55], v[16:19]
v_mfma_f32_16x16x32_bf16 v[20:23], a[152:155], v[52:55], v[20:23]
v_mfma_f32_16x16x32_bf16 v[24:27], a[156:159], v[52:55], v[24:27]
s_waitcnt vmcnt(5)
ds_read_b128 v[48:51], v7 offset:26624
s_waitcnt lgkmcnt(2)
v_mfma_f32_16x16x32_bf16 v[16:19], a[160:163], v[40:43], v[16:19]
v_mfma_f32_16x16x32_bf16 v[20:23], a[164:167], v[40:43], v[20:23]
v_mfma_f32_16x16x32_bf16 v[24:27], a[168:171], v[40:43], v[24:27]
s_waitcnt vmcnt(4)
ds_read_b128 v[52:55], v7 offset:27648
s_waitcnt lgkmcnt(2)
v_mfma_f32_16x16x32_bf16 v[16:19], a[172:175], v[44:47], v[16:19]
v_mfma_f32_16x16x32_bf16 v[20:23], a[176:179], v[44:47], v[20:23]
v_mfma_f32_16x16x32_bf16 v[24:27], a[180:183], v[44:47], v[24:27]
s_waitcnt vmcnt(3)
ds_read_b128 v[40:43], v7 offset:28672
s_waitcnt lgkmcnt(2)
v_mfma_f32_16x16x32_bf16 v[16:19], a[184:187], v[48:51], v[16:19]
v_mfma_f32_16x16x32_bf16 v[20:23], a[188:191], v[48:51], v[20:23]
v_mfma_f32_16x16x32_bf16 v[24:27], a[192:195], v[48:51], v[24:27]
s_waitcnt vmcnt(2)
ds_read_b128 v[44:47], v7 offset:29696
s_waitcnt lgkmcnt(2)
v_mfma_f32_16x16x32_bf16 v[16:19], a[196:199], v[52:55], v[16:19]
v_mfma_f32_16x16x32_bf16 v[20:23], a[200:203], v[52:55], v[20:23]
v_mfma_f32_16x16x32_bf16 v[24:27], a[204:207], v[52:55], v[24:27]
s_waitcnt vmcnt(1)
ds_read_b128 v[48:51], v7 offset:30720
s_waitcnt lgkmcnt(2)
v_mfma_f32_16x16x32_bf16 v[16:19], a[208:211], v[40:43], v[16:19]
v_mfma_f32_16x16x32_bf16 v[20:23], a[212:215], v[40:43], v[20:23]
v_mfma_f32_16x16x32_bf16 v[24:27], a[216:219], v[40:43], v[24:27]
s_waitcnt vmcnt(0)
ds_read_b128 v[52:55], v7 offset:31744
s_waitcnt lgkmcnt(2)
v_mfma_f32_16x16x32_bf16 v[16:19], a[220:223], v[44:47], v[16:19]
v_mfma_f32_16x16x32_bf16 v[20:23], a[224:227], v[44:47], v[20:23]
v_mfma_f32_16x16x32_bf16 v[24:27], a[228:231], v[44:47], v[24:27]
s_waitcnt lgkmcnt(1)
v_mfma_f32_16x16x32_bf16 v[16:19], a[232:235], v[48:51], v[16:19]
v_mfma_f32_16x16x32_bf16 v[20:23], a[236:239], v[48:51], v[20:23]
v_mfma_f32_16x16x32_bf16 v[24:27], a[240:243], v[48:51], v[24:27]
s_waitcnt lgkmcnt(0)
v_mfma_f32_16x16x32_bf16 v[16:19], a[244:247], v[52:55], v[16:19]
v_mfma_f32_16x16x32_bf16 v[20:23], a[248:251], v[52:55], v[20:23]
v_mfma_f32_16x16x32_bf16 v[24:27], a[252:255], v[52:55], v[24:27]
v_fma_f32 v16, v16, v13, v28
v_fma_f32 v17, v17, v13, v29
v_fma_f32 v18, v18, v13, v30
v_fma_f32 v19, v19, v13, v31
ds_write_b128 v2, v[16:19] offset:0
v_fma_f32 v20, v20, v13, v32
v_fma_f32 v21, v21, v13, v33
v_fma_f32 v22, v22, v13, v34
v_fma_f32 v23, v23, v13, v35
ds_write_b128 v2, v[20:23] offset:1024
v_fma_f32 v24, v24, v13, v36
v_fma_f32 v25, v25, v13, v37
v_fma_f32 v26, v26, v13, v38
v_fma_f32 v27, v27, v13, v39
ds_write_b128 v2, v[24:27] offset:2048
s_waitcnt lgkmcnt(0)
s_barrier
s_cmp_eq_u32 s34, 3
s_cbranch_scc1 L_w_next
ds_read_b128 v[40:43], v14 offset:0
ds_read_b128 v[44:47], v14 offset:3072
ds_read_b128 v[48:51], v14 offset:6144
ds_read_b128 v[52:55], v14 offset:9216
s_waitcnt lgkmcnt(0)
v_pk_add_f32 v[40:41], v[40:41], v[44:45]
v_pk_add_f32 v[42:43], v[42:43], v[46:47]
v_pk_add_f32 v[48:49], v[48:49], v[52:53]
v_pk_add_f32 v[50:51], v[50:51], v[54:55]
v_pk_add_f32 v[40:41], v[40:41], v[48:49]
v_pk_add_f32 v[42:43], v[42:43], v[50:51]
v_cvt_pk_bf16_f32 v60, v40, v41
v_cvt_pk_bf16_f32 v61, v42, v43
buffer_store_dwordx2 v[60:61], v15, s[28:31], s55 offen
L_w_next:
v_xor_b32 v2, 16384, v2
v_xor_b32 v14, 16384, v14
s_add_u32 s55, s55, 147456
s_add_u32 s54, s54, 147456
s_add_u32 s53, s53, 1048576
s_add_u32 s56, s56, 512
s_add_u32 s35, s35, 1
s_cmp_lt_u32 s35, 16
s_cbranch_scc1 L_w_loop
s_waitcnt vmcnt(0)
s_endpgm
L_role_chain:
s_load_dwordx2 s[24:25], s[0:1], 32
s_load_dwordx2 s[8:9], s[0:1], 40
s_load_dwordx2 s[12:13], s[0:1], 48
s_load_dwordx2 s[16:17], s[0:1], 56
s_load_dwordx2 s[20:21], s[0:1], 64
s_load_dwordx2 s[28:29], s[0:1], 96
s_load_dwordx2 s[4:5], s[0:1], 104
s_mov_b32 s26, 9216
s_mov_b32 s27, 0x20000
s_mov_b32 s10, 4718592
s_mov_b32 s11, 0x20000
s_mov_b32 s14, 4718592
s_mov_b32 s15, 0x20000
s_mov_b32 s18, 4718592
s_mov_b32 s19, 0x20000
s_mov_b32 s22, 4718592
s_mov_b32 s23, 0x20000
s_mov_b32 s30, 256
s_mov_b32 s31, 0x20000
s_mov_b32 s6, 268435456
s_mov_b32 s7, 0x20000
v_lshrrev_b32 v1, 6, v0
s_nop 0
v_readfirstlane_b32 s33, v1
s_nop 0
s_cmp_eq_u32 s33, 0
s_cbranch_scc1 L_pro_w0
s_cmp_eq_u32 s33, 2
s_cbranch_scc1 L_pro_w2r
s_cmp_eq_u32 s33, 3
s_cbranch_scc1 L_pro_w3r
s_cmp_lt_u32 s32, 8
s_cbranch_scc1 L_pro_w1r
s_branch L_pro_w1
L_exit:
s_endpgm
L_pro_w0:
v_and_b32 v20, 63, v0
v_and_b32 v21, 15, v0
v_bfe_u32 v22, v0, 4, 2
v_lshlrev_b32 v1, 4, v20
v_add_u32 v2, 16384, v1
v_lshrrev_b32 v24, 1, v22
v_and_b32 v23, 1, v22
v_lshl_add_u32 v23, v24, 3, v23
v_lshlrev_b32 v23, 13, v23
v_lshlrev_b32 v26, 1, v22
v_xor_b32 v26, v26, v21
v_lshl_add_u32 v26, v26, 4, v23
v_xor_b32 v27, 128, v26
v_and_b32 v23, 1, v22
v_lshl_add_u32 v23, v24, 4, v23
v_mul_u32_u24 v23, 1152, v23
v_lshlrev_b32 v28, 2, v22
v_xor_b32 v28, v28, v21
v_lshl_add_u32 v28, v28, 4, v23
s_lshl_b32 s54, s32, 8
s_mul_i32 s55, s32, 147456
v_lshrrev_b32 v23, 2, v21
v_and_b32 v24, 1, v21
v_lshl_add_u32 v23, v23, 1, v24
v_mul_u32_u24 v23, 1152, v23
v_lshl_add_u32 v23, v22, 5, v23
v_bfe_u32 v24, v21, 1, 1
v_lshl_add_u32 v23, v24, 4, v23
s_lshl_b32 s56, s32, 7
s_waitcnt lgkmcnt(0)
buffer_load_dwordx4 v[12:15], v23, s[24:27], s56 offen
s_add_u32 s56, s54, 524288
s_mov_b32 m0, 36864
s_nop 0
buffer_load_dwordx4 v26, s[8:11], s56 offen lds
s_add_u32 s56, s54, 540672
s_mov_b32 m0, 37888
s_nop 0
buffer_load_dwordx4 v26, s[8:11], s56 offen lds
s_add_u32 s56, s54, 557056
s_mov_b32 m0, 38912
s_nop 0
buffer_load_dwordx4 v27, s[8:11], s56 offen lds
s_add_u32 s56, s54, 573440
s_mov_b32 m0, 39936
s_nop 0
buffer_load_dwordx4 v27, s[8:11], s56 offen lds
s_add_u32 s56, s54, 1048576
s_mov_b32 m0, 40960
s_nop 0
buffer_load_dwordx4 v26, s[8:11], s56 offen lds
s_add_u32 s56, s54, 1064960
s_mov_b32 m0, 41984
s_nop 0
buffer_load_dwordx4 v26, s[8:11], s56 offen lds
s_add_u32 s56, s54, 1081344
s_mov_b32 m0, 43008
s_nop 0
buffer_load_dwordx4 v27, s[8:11], s56 offen lds
s_add_u32 s56, s54, 1097728
s_mov_b32 m0, 44032
s_nop 0
buffer_load_dwordx4 v27, s[8:11], s56 offen lds
v_and_b32 v23, 1, v22
v_lshrrev_b32 v24, 2, v21
v_lshl_add_u32 v23, v23, 2, v24
v_lshlrev_b32 v23, 1, v23
v_bfe_u32 v44, v21, 1, 1
v_add_u32 v44, 0, v44
v_xor_b32 v44, v44, v23
v_lshlrev_b32 v44, 4, v44
v_lshl_add_u32 v44, v24, 8, v44
v_and_b32 v23, 1, v22
v_lshl_add_u32 v44, v23, 11, v44
v_and_b32 v23, 1, v21
v_lshl_add_u32 v44, v23, 3, v44
v_lshrrev_b32 v23, 1, v22
v_mul_u32_u24 v23, 40960, v23
v_add_u32 v23, 16384, v23
v_add_u32 v44, v44, v23
v_and_b32 v23, 1, v22
v_lshrrev_b32 v24, 2, v21
v_lshl_add_u32 v23, v23, 2, v24
v_lshlrev_b32 v23, 1, v23
v_bfe_u32 v45, v21, 1, 1
v_add_u32 v45, 2, v45
v_xor_b32 v45, v45, v23
v_lshlrev_b32 v45, 4, v45
v_lshl_add_u32 v45, v24, 8, v45
v_and_b32 v23, 1, v22
v_lshl_add_u32 v45, v23, 11, v45
v_and_b32 v23, 1, v21
v_lshl_add_u32 v45, v23, 3, v45
v_lshrrev_b32 v23, 1, v22
v_mul_u32_u24 v23, 40960, v23
v_add_u32 v23, 16384, v23
v_add_u32 v45, v45, v23
v_and_b32 v23, 1, v22
v_lshrrev_b32 v24, 2, v21
v_lshl_add_u32 v23, v23, 2, v24
v_lshlrev_b32 v23, 1, v23
v_bfe_u32 v46, v21, 1, 1
v_add_u32 v46, 0, v46
v_xor_b32 v46, v46, v23
v_lshlrev_b32 v46, 4, v46
v_lshl_add_u32 v46, v24, 8, v46
v_and_b32 v23, 1, v22
v_lshl_add_u32 v46, v23, 11, v46
v_and_b32 v23, 1, v21
v_lshl_add_u32 v46, v23, 3, v46
v_lshrrev_b32 v23, 1, v22
v_mul_u32_u24 v23, 32768, v23
v_add_u32 v23, 98304, v23
v_add_u32 v46, v46, v23
v_and_b32 v23, 1, v22
v_lshrrev_b32 v24, 2, v21
v_lshl_add_u32 v23, v23, 2, v24
v_lshlrev_b32 v23, 1, v23
v_bfe_u32 v47, v21, 1, 1
v_add_u32 v47, 2, v47
v_xor_b32 v47, v47, v23
v_lshlrev_b32 v47, 4, v47
v_lshl_add_u32 v47, v24, 8, v47
v_and_b32 v23, 1, v22
v_lshl_add_u32 v47, v23, 11, v47
v_and_b32 v23, 1, v21
v_lshl_add_u32 v47, v23, 3, v47
v_lshrrev_b32 v23, 1, v22
v_mul_u32_u24 v23, 32768, v23
v_add_u32 v23, 98304, v23
v_add_u32 v47, v47, v23
v_and_b32 v23, 1, v22
v_bfe_u32 v24, v21, 2, 1
v_lshl_add_u32 v23, v23, 1, v24
v_xor_b32 v24, 0, v23
v_lshlrev_b32 v24, 6, v24
v_lshl_add_u32 v48, v23, 8, v24
v_and_b32 v23, 3, v21
v_lshl_add_u32 v48, v23, 4, v48
v_and_b32 v23, 8, v21
v_add_u32 v48, v48, v23
v_lshrrev_b32 v23, 1, v22
v_mul_u32_u24 v23, 40960, v23
v_add_u32 v23, 16384, v23
v_add_u32 v48, v48, v23
v_and_b32 v23, 1, v22
v_bfe_u32 v24, v21, 2, 1
v_lshl_add_u32 v23, v23, 1, v24
v_xor_b32 v24, 0, v23
v_lshlrev_b32 v24, 6, v24
v_lshl_add_u32 v49, v23, 8, v24
v_and_b32 v23, 3, v21
v_lshl_add_u32 v49, v23, 4, v49
v_and_b32 v23, 8, v21
v_add_u32 v49, v49, v23
v_lshrrev_b32 v23, 1, v22
v_mul_u32_u24 v23, 32768, v23
v_add_u32 v23, 98304, v23
v_add_u32 v49, v49, v23
v_bfe_u32 v23, v21, 1, 1
v_and_b32 v24, 1, v21
v_lshl_add_u32 v23, v24, 16, v23
v_mul_u32_u24 v23, 0xaaaa, v23
v_add_u32 v0, 0x44444444, v23
v_lshlrev_b32 v3, 3, v20
v_lshrrev_b32 v25, 5, v20
v_lshlrev_b32 v25, 6, v25
v_xor_b32 v3, v3, v25
v_lshrrev_b32 v25, 2, v20
v_and_b32 v4, 3, v21
v_lshl_add_u32 v4, v4, 4, v25
v_lshlrev_b32 v4, 3, v4
v_bfe_u32 v25, v21, 1, 1
v_lshlrev_b32 v23, 6, v25
v_xor_b32 v4, v4, v23
v_and_b32 v23, 2, v22
v_xor_b32 v5, v21, v23
v_lshlrev_b32 v5, 4, v5
v_lshl_add_u32 v5, v25, 10, v5
v_and_b32 v23, 1, v22
v_lshl_add_u32 v5, v23, 3, v5
v_lshlrev_b32 v9, 8, v22
v_lshl_add_u32 v9, v25, 6, v9
v_bfe_u32 v23, v21, 3, 1
v_lshl_add_u32 v9, v23, 7, v9
v_bfe_u32 v23, v21, 2, 1
v_lshl_add_u32 v9, v23, 5, v9
v_and_b32 v23, 1, v21
v_lshl_add_u32 v9, v23, 4, v9
v_lshrrev_b32 v23, 1, v22
v_and_b32 v24, 1, v22
v_and_b32 v25, 7, v21
v_lshrrev_b32 v7, 3, v21
v_lshl_add_u32 v8, v7, 1, v23
v_lshlrev_b32 v8, 12, v8
v_lshl_add_u32 v8, v24, 7, v8
v_and_b32 v25, 4, v21
v_lshl_add_u32 v8, v25, 3, v8
v_and_b32 v25, 1, v21
v_lshl_add_u32 v8, v25, 4, v8
v_bfe_u32 v25, v21, 1, 1
v_lshl_add_u32 v8, v25, 3, v8
s_lshr_b32 s56, s32, 1
s_lshl_b32 s56, s56, 8
s_and_b32 s57, s32, 1
s_lshl_b32 s57, s57, 6
s_add_u32 s56, s56, s57
s_add_u32 s56, s56, 0
v_add_u32 v8, s56, v8
v_and_b32 v7, 12, v21
v_bfe_u32 v25, v21, 1, 1
v_add_u32 v7, v7, v25
v_lshlrev_b32 v7, 4, v7
v_lshl_add_u32 v7, v22, 8, v7
s_mov_b32 s42, 0
s_mov_b32 s43, 65536
s_mov_b32 s44, 131072
s_mov_b32 s45, 196608
s_mov_b32 s46, 262144
s_mov_b32 s47, 294912
s_mov_b32 s48, 299008
s_mov_b32 s49, 303104
s_mov_b32 s50, 0x3e0293ee
s_mov_b32 s51, 0x3e0293ee
s_mov_b32 s52, 0x3f803f80
s_mov_b32 s53, 0x3f803f80
v_and_b32 v11, 3, v21
v_cmp_eq_u32 vcc, 0, v11
s_nop 1
v_cndmask_b32 v11, 0, 1, vcc
s_mov_b32 s34, 0
s_mov_b32 s35, -1
s_mov_b32 s36, 0
s_mov_b32 s41, 300000
s_lshl_b32 s37, s32, 14
s_add_u32 s39, s37, 17301504
s_add_u32 s37, s37, 16777216
s_mov_b32 s40, 8749056
v_mov_b64 v[36:37], 0
v_mov_b64 v[38:39], 0
s_lshl_b32 s56, s32, 1
s_add_u32 s56, s56, 0
s_cmp_eq_u32 s56, 0
s_cselect_b32 s56, 64, s56
s_mul_i32 s56, s56, 10240
s_add_u32 s56, s56, 8388608
s_add_u32 s57, s56, 4096
v_mov_b32 v40, 0
v_mov_b32 v41, 0
v_mov_b32 v42, 0
v_mov_b32 v43, 0
buffer_store_dwordx4 v[40:43], v1, s[4:7], s56 offen offset:0 sc0 sc1
buffer_store_dwordx4 v[40:43], v1, s[4:7], s56 offen offset:1024 sc0 sc1
buffer_store_dwordx4 v[40:43], v1, s[4:7], s56 offen offset:2048 sc0 sc1
buffer_store_dwordx4 v[40:43], v1, s[4:7], s56 offen offset:3072 sc0 sc1
v_lshlrev_b32 v23, 2, v20
s_lshl_b32 s56, s32, 8
s_add_u32 s56, s56, 327680
buffer_store_dword v36, v23, s[4:7], s56 offen sc0 sc1
s_lshl_b32 s56, s32, 10
s_cmp_ge_u32 s32, 9
s_cselect_b32 s56, 268435456, s56
s_add_u32 s57, s56, 8388608
s_add_u32 s56, s56, 294912
s_waitcnt vmcnt(13)
v_or_b32 v12, 1, v12
buffer_store_dwordx4 v[12:15], v1, s[4:7], s56 offen sc0 sc1
buffer_store_dwordx4 v[12:15], v1, s[4:7], s57 offen sc0 sc1
s_getreg_b32 s56, hwreg(HW_REG_XCC_ID)
s_and_b32 s56, s56, 15
s_mul_i32 s57, s56, s56
s_lshl_b32 s57, s57, 18
s_lshl_b32 s56, s56, 8
s_add_u32 s57, s57, s56
s_add_u32 s58, s57, 1
s_lshl_b32 s101, s32, 7
s_add_u32 s101, s101, 327680
v_mov_b32 v24, 0
s_add_u32 s56, s54, 2621440
s_mov_b32 m0, 45056
s_nop 0
buffer_load_dwordx4 v26, s[8:11], s56 offen lds
s_add_u32 s56, s54, 2637824
s_mov_b32 m0, 46080
s_nop 0
buffer_load_dwordx4 v26, s[8:11], s56 offen lds
s_add_u32 s56, s54, 2654208
s_mov_b32 m0, 47104
s_nop 0
buffer_load_dwordx4 v27, s[8:11], s56 offen lds
s_add_u32 s56, s54, 2670592
s_mov_b32 m0, 48128
s_nop 0
buffer_load_dwordx4 v27, s[8:11], s56 offen lds
s_add_u32 s56, s54, 3145728
s_mov_b32 m0, 16384
s_nop 0
buffer_load_dwordx4 v26, s[8:11], s56 offen lds
s_add_u32 s56, s54, 3162112
s_mov_b32 m0, 17408
s_nop 0
buffer_load_dwordx4 v26, s[8:11], s56 offen lds
s_add_u32 s56, s54, 3178496
s_mov_b32 m0, 18432
s_nop 0
buffer_load_dwordx4 v27, s[8:11], s56 offen lds
s_add_u32 s56, s54, 3194880
s_mov_b32 m0, 19456
s_nop 0
buffer_load_dwordx4 v27, s[8:11], s56 offen lds
s_add_u32 s56, s54, 3670016
s_mov_b32 m0, 20480
s_nop 0
buffer_load_dwordx4 v26, s[8:11], s56 offen lds
s_add_u32 s56, s54, 3686400
s_mov_b32 m0, 21504
s_nop 0
buffer_load_dwordx4 v26, s[8:11], s56 offen lds
s_add_u32 s56, s54, 3702784
s_mov_b32 m0, 22528
s_nop 0
buffer_load_dwordx4 v27, s[8:11], s56 offen lds
s_add_u32 s56, s54, 3719168
s_mov_b32 m0, 23552
s_nop 0
buffer_load_dwordx4 v27, s[8:11], s56 offen lds
s_add_u32 s56, s54, 4194304
s_mov_b32 m0, 24576
s_nop 0
buffer_load_dwordx4 v26, s[8:11], s56 offen lds
s_add_u32 s56, s54, 4210688
s_mov_b32 m0, 25600
s_nop 0
buffer_load_dwordx4 v26, s[8:11], s56 offen lds
s_add_u32 s56, s54, 4227072
s_mov_b32 m0, 26624
s_nop 0
buffer_load_dwordx4 v27, s[8:11], s56 offen lds
s_add_u32 s56, s54, 4243456
s_mov_b32 m0, 27648
s_nop 0
buffer_load_dwordx4 v27, s[8:11], s56 offen lds
s_add_u32 s56, s54, 0
s_mov_b32 m0, 28672
s_nop 0
buffer_load_dwordx4 v26, s[12:15], s56 offen lds
s_add_u32 s56, s54, 16384
s_mov_b32 m0, 29696
s_nop 0
buffer_load_dwordx4 v26, s[12:15], s56 offen lds
s_add_u32 s56, s54, 32768
s_mov_b32 m0, 30720
s_nop 0
buffer_load_dwordx4 v27, s[12:15], s56 offen lds
s_add_u32 s56, s54, 49152
s_mov_b32 m0, 31744
s_nop 0
buffer_load_dwordx4 v27, s[12:15], s56 offen lds
s_add_u32 s56, s54, 524288
s_mov_b32 m0, 32768
s_nop 0
buffer_load_dwordx4 v26, s[12:15], s56 offen lds
s_add_u32 s56, s54, 540672
s_mov_b32 m0, 33792
s_nop 0
buffer_load_dwordx4 v26, s[12:15], s56 offen lds
s_add_u32 s56, s54, 557056
s_mov_b32 m0, 34816
s_nop 0
buffer_load_dwordx4 v27, s[12:15], s56 offen lds
s_add_u32 s56, s54, 573440
s_mov_b32 m0, 35840
s_nop 0
buffer_load_dwordx4 v27, s[12:15], s56 offen lds
v_and_b32 v23, 3, v20
v_lshrrev_b32 v24, 2, v20
v_mul_u32_u24 v29, 1152, v24
v_lshl_add_u32 v29, v23, 4, v29
v_lshrrev_b32 v24, 2, v21
v_and_b32 v25, 1, v22
v_lshlrev_b32 v31, 10, v25
v_lshrrev_b32 v25, 1, v22
v_lshl_add_u32 v31, v25, 8, v31
v_and_b32 v25, 1, v24
v_lshl_add_u32 v31, v25, 6, v31
v_lshrrev_b32 v25, 1, v24
v_lshl_add_u32 v31, v25, 3, v31
v_lshl_add_u32 v31, v23, 4, v31
v_add_u32 v31, 16384, v31
s_add_u32 s56, s55, 1024
s_mov_b32 m0, 49152
s_nop 0
buffer_load_dwordx4 v29, s[20:23], s56 offen lds
s_add_u32 s56, s55, 19456
s_mov_b32 m0, 50176
s_nop 0
buffer_load_dwordx4 v29, s[20:23], s56 offen lds
s_add_u32 s56, s55, 37888
s_mov_b32 m0, 53248
s_nop 0
buffer_load_dwordx4 v29, s[20:23], s56 offen lds
s_add_u32 s56, s55, 56320
s_mov_b32 m0, 54272
s_nop 0
buffer_load_dwordx4 v29, s[20:23], s56 offen lds
s_add_u32 s56, s55, 74752
s_mov_b32 m0, 51200
s_nop 0
buffer_load_dwordx4 v29, s[20:23], s56 offen lds
s_add_u32 s56, s55, 93184
s_mov_b32 m0, 52224
s_nop 0
buffer_load_dwordx4 v29, s[20:23], s56 offen lds
s_add_u32 s56, s55, 111616
s_mov_b32 m0, 55296
s_nop 0
buffer_load_dwordx4 v29, s[20:23], s56 offen lds
s_add_u32 s56, s55, 130048
s_mov_b32 m0, 56320
s_nop 0
buffer_load_dwordx4 v29, s[20:23], s56 offen lds
v_mov_b32 v24, 0
s_waitcnt vmcnt(43)
s_barrier
ds_read_b64_tr_b16 v[80:81], v44 offset:20480
ds_read_b64_tr_b16 v[82:83], v44 offset:21504
ds_read_b64_tr_b16 v[84:85], v46 offset:20480
ds_read_b64_tr_b16 v[86:87], v46 offset:21504
ds_read_b64_tr_b16 v[88:89], v45 offset:20480
ds_read_b64_tr_b16 v[90:91], v45 offset:21504
ds_read_b64_tr_b16 v[92:93], v47 offset:20480
ds_read_b64_tr_b16 v[94:95], v47 offset:21504
s_waitcnt lgkmcnt(0)
s_waitcnt vmcnt(39)
s_barrier
s_add_u32 s56, s54, 1048576
s_mov_b32 m0, 36864
s_nop 0
buffer_load_dwordx4 v26, s[12:15], s56 offen lds
s_add_u32 s56, s54, 1064960
s_mov_b32 m0, 37888
s_nop 0
buffer_load_dwordx4 v26, s[12:15], s56 offen lds
s_add_u32 s56, s54, 1081344
s_mov_b32 m0, 38912
s_nop 0
buffer_load_dwordx4 v27, s[12:15], s56 offen lds
s_add_u32 s56, s54, 1097728
s_mov_b32 m0, 39936
s_nop 0
buffer_load_dwordx4 v27, s[12:15], s56 offen lds
ds_read_b64_tr_b16 v[96:97], v44 offset:24576
ds_read_b64_tr_b16 v[98:99], v44 offset:25600
ds_read_b64_tr_b16 v[100:101], v46 offset:24576
ds_read_b64_tr_b16 v[102:103], v46 offset:25600
ds_read_b64_tr_b16 v[104:105], v45 offset:24576
ds_read_b64_tr_b16 v[106:107], v45 offset:25600
ds_read_b64_tr_b16 v[108:109], v47 offset:24576
ds_read_b64_tr_b16 v[110:111], v47 offset:25600
s_waitcnt lgkmcnt(0)
s_waitcnt vmcnt(32)
s_barrier
s_add_u32 s56, s54, 1572864
s_mov_b32 m0, 40960
s_nop 0
buffer_load_dwordx4 v26, s[12:15], s56 offen lds
s_add_u32 s56, s54, 1589248
s_mov_b32 m0, 41984
s_nop 0
buffer_load_dwordx4 v26, s[12:15], s56 offen lds
s_add_u32 s56, s54, 1605632
s_mov_b32 m0, 43008
s_nop 0
buffer_load_dwordx4 v27, s[12:15], s56 offen lds
s_add_u32 s56, s54, 1622016
s_mov_b32 m0, 44032
s_nop 0
buffer_load_dwordx4 v27, s[12:15], s56 offen lds
ds_read_b64_tr_b16 v[112:113], v44 offset:28672
ds_read_b64_tr_b16 v[114:115], v44 offset:29696
ds_read_b64_tr_b16 v[116:117], v46 offset:28672
ds_read_b64_tr_b16 v[118:119], v46 offset:29696
ds_read_b64_tr_b16 v[120:121], v45 offset:28672
ds_read_b64_tr_b16 v[122:123], v45 offset:29696
ds_read_b64_tr_b16 v[124:125], v47 offset:28672
ds_read_b64_tr_b16 v[126:127], v47 offset:29696
v_mov_b32 v23, s58
s_mov_b64 exec, 1
buffer_atomic_add v23, v24, s[28:31], 0 offen sc1
s_mov_b64 exec, -1
s_waitcnt lgkmcnt(0)
s_waitcnt vmcnt(33)
s_barrier
s_add_u32 s56, s54, 2097152
s_mov_b32 m0, 45056
s_nop 0
buffer_load_dwordx4 v26, s[12:15], s56 offen lds
s_add_u32 s56, s54, 2113536
s_mov_b32 m0, 46080
s_nop 0
buffer_load_dwordx4 v26, s[12:15], s56 offen lds
s_add_u32 s56, s54, 2129920
s_mov_b32 m0, 47104
s_nop 0
buffer_load_dwordx4 v27, s[12:15], s56 offen lds
s_add_u32 s56, s54, 2146304
s_mov_b32 m0, 48128
s_nop 0
buffer_load_dwordx4 v27, s[12:15], s56 offen lds
ds_read_b64_tr_b16 v[128:129], v44 offset:0
ds_read_b64_tr_b16 v[130:131], v44 offset:1024
ds_read_b64_tr_b16 v[132:133], v46 offset:0
ds_read_b64_tr_b16 v[134:135], v46 offset:1024
ds_read_b64_tr_b16 v[136:137], v45 offset:0
ds_read_b64_tr_b16 v[138:139], v45 offset:1024
ds_read_b64_tr_b16 v[140:141], v47 offset:0
ds_read_b64_tr_b16 v[142:143], v47 offset:1024
s_waitcnt lgkmcnt(0)
s_waitcnt vmcnt(33)
s_barrier
s_add_u32 s56, s54, 3145728
s_mov_b32 m0, 16384
s_nop 0
buffer_load_dwordx4 v26, s[12:15], s56 offen lds
s_add_u32 s56, s54, 3162112
s_mov_b32 m0, 17408
s_nop 0
buffer_load_dwordx4 v26, s[12:15], s56 offen lds
s_add_u32 s56, s54, 3178496
s_mov_b32 m0, 18432
s_nop 0
buffer_load_dwordx4 v27, s[12:15], s56 offen lds
s_add_u32 s56, s54, 3194880
s_mov_b32 m0, 19456
s_nop 0
buffer_load_dwordx4 v27, s[12:15], s56 offen lds
ds_read_b64_tr_b16 v[144:145], v44 offset:4096
ds_read_b64_tr_b16 v[146:147], v44 offset:5120
ds_read_b64_tr_b16 v[148:149], v46 offset:4096
ds_read_b64_tr_b16 v[150:151], v46 offset:5120
ds_read_b64_tr_b16 v[152:153], v45 offset:4096
ds_read_b64_tr_b16 v[154:155], v45 offset:5120
ds_read_b64_tr_b16 v[156:157], v47 offset:4096
ds_read_b64_tr_b16 v[158:159], v47 offset:5120
s_waitcnt lgkmcnt(0)
s_waitcnt vmcnt(33)
s_barrier
s_add_u32 s56, s54, 3670016
s_mov_b32 m0, 20480
s_nop 0
buffer_load_dwordx4 v26, s[12:15], s56 offen lds
s_add_u32 s56, s54, 3686400
s_mov_b32 m0, 21504
s_nop 0
buffer_load_dwordx4 v26, s[12:15], s56 offen lds
s_add_u32 s56, s54, 3702784
s_mov_b32 m0, 22528
s_nop 0
buffer_load_dwordx4 v27, s[12:15], s56 offen lds
s_add_u32 s56, s54, 3719168
s_mov_b32 m0, 23552
s_nop 0
buffer_load_dwordx4 v27, s[12:15], s56 offen lds
ds_read_b64_tr_b16 v[160:161], v44 offset:8192
ds_read_b64_tr_b16 v[162:163], v44 offset:9216
ds_read_b64_tr_b16 v[164:165], v46 offset:8192
ds_read_b64_tr_b16 v[166:167], v46 offset:9216
ds_read_b64_tr_b16 v[168:169], v45 offset:8192
ds_read_b64_tr_b16 v[170:171], v45 offset:9216
ds_read_b64_tr_b16 v[172:173], v47 offset:8192
ds_read_b64_tr_b16 v[174:175], v47 offset:9216
s_waitcnt lgkmcnt(0)
s_waitcnt vmcnt(33)
s_barrier
s_add_u32 s56, s54, 4194304
s_mov_b32 m0, 24576
s_nop 0
buffer_load_dwordx4 v26, s[12:15], s56 offen lds
s_add_u32 s56, s54, 4210688
s_mov_b32 m0, 25600
s_nop 0
buffer_load_dwordx4 v26, s[12:15], s56 offen lds
s_add_u32 s56, s54, 4227072
s_mov_b32 m0, 26624
s_nop 0
buffer_load_dwordx4 v27, s[12:15], s56 offen lds
s_add_u32 s56, s54, 4243456
s_mov_b32 m0, 27648
s_nop 0
buffer_load_dwordx4 v27, s[12:15], s56 offen lds
ds_read_b64_tr_b16 v[176:177], v44 offset:12288
ds_read_b64_tr_b16 v[178:179], v44 offset:13312
ds_read_b64_tr_b16 v[180:181], v46 offset:12288
ds_read_b64_tr_b16 v[182:183], v46 offset:13312
ds_read_b64_tr_b16 v[184:185], v45 offset:12288
ds_read_b64_tr_b16 v[186:187], v45 offset:13312
ds_read_b64_tr_b16 v[188:189], v47 offset:12288
ds_read_b64_tr_b16 v[190:191], v47 offset:13312
s_waitcnt lgkmcnt(0)
s_waitcnt vmcnt(33)
s_barrier
s_add_u32 s56, s54, 0
s_mov_b32 m0, 28672
s_nop 0
buffer_load_dwordx4 v26, s[16:19], s56 offen lds
s_add_u32 s56, s54, 16384
s_mov_b32 m0, 29696
s_nop 0
buffer_load_dwordx4 v26, s[16:19], s56 offen lds
s_add_u32 s56, s54, 32768
s_mov_b32 m0, 30720
s_nop 0
buffer_load_dwordx4 v27, s[16:19], s56 offen lds
s_add_u32 s56, s54, 49152
s_mov_b32 m0, 31744
s_nop 0
buffer_load_dwordx4 v27, s[16:19], s56 offen lds
ds_read_b64_tr_b16 v[192:193], v44 offset:16384
ds_read_b64_tr_b16 v[194:195], v44 offset:17408
ds_read_b64_tr_b16 v[196:197], v46 offset:16384
ds_read_b64_tr_b16 v[198:199], v46 offset:17408
ds_read_b64_tr_b16 v[200:201], v45 offset:16384
ds_read_b64_tr_b16 v[202:203], v45 offset:17408
ds_read_b64_tr_b16 v[204:205], v47 offset:16384
ds_read_b64_tr_b16 v[206:207], v47 offset:17408
s_waitcnt lgkmcnt(0)
s_waitcnt vmcnt(25)
s_barrier
s_add_u32 s56, s54, 524288
s_mov_b32 m0, 32768
s_nop 0
buffer_load_dwordx4 v26, s[16:19], s56 offen lds
s_add_u32 s56, s54, 540672
s_mov_b32 m0, 33792
s_nop 0
buffer_load_dwordx4 v26, s[16:19], s56 offen lds
s_add_u32 s56, s54, 557056
s_mov_b32 m0, 34816
s_nop 0
buffer_load_dwordx4 v27, s[16:19], s56 offen lds
s_add_u32 s56, s54, 573440
s_mov_b32 m0, 35840
s_nop 0
buffer_load_dwordx4 v27, s[16:19], s56 offen lds
ds_read_b64_tr_b16 v[208:209], v44 offset:20480
ds_read_b64_tr_b16 v[210:211], v44 offset:21504
ds_read_b64_tr_b16 v[212:213], v46 offset:20480
ds_read_b64_tr_b16 v[214:215], v46 offset:21504
ds_read_b64_tr_b16 v[216:217], v45 offset:20480
ds_read_b64_tr_b16 v[218:219], v45 offset:21504
ds_read_b64_tr_b16 v[220:221], v47 offset:20480
ds_read_b64_tr_b16 v[222:223], v47 offset:21504
s_waitcnt lgkmcnt(0)
s_waitcnt vmcnt(25)
s_barrier
s_add_u32 s56, s54, 1048576
s_mov_b32 m0, 36864
s_nop 0
buffer_load_dwordx4 v26, s[16:19], s56 offen lds
s_add_u32 s56, s54, 1064960
s_mov_b32 m0, 37888
s_nop 0
buffer_load_dwordx4 v26, s[16:19], s56 offen lds
s_add_u32 s56, s54, 1081344
s_mov_b32 m0, 38912
s_nop 0
buffer_load_dwordx4 v27, s[16:19], s56 offen lds
s_add_u32 s56, s54, 1097728
s_mov_b32 m0, 39936
s_nop 0
buffer_load_dwordx4 v27, s[16:19], s56 offen lds
ds_read_b64_tr_b16 v[224:225], v44 offset:24576
ds_read_b64_tr_b16 v[226:227], v44 offset:25600
ds_read_b64_tr_b16 v[228:229], v46 offset:24576
ds_read_b64_tr_b16 v[230:231], v46 offset:25600
ds_read_b64_tr_b16 v[232:233], v45 offset:24576
ds_read_b64_tr_b16 v[234:235], v45 offset:25600
ds_read_b64_tr_b16 v[236:237], v47 offset:24576
ds_read_b64_tr_b16 v[238:239], v47 offset:25600
ds_read_b64_tr_b16 v[60:61], v31 offset:32768
ds_read_b64_tr_b16 v[62:63], v31 offset:32896
ds_read_b64_tr_b16 v[64:65], v31 offset:33280
ds_read_b64_tr_b16 v[66:67], v31 offset:33408
ds_read_b64_tr_b16 v[68:69], v31 offset:34816
ds_read_b64_tr_b16 v[70:71], v31 offset:34944
ds_read_b64_tr_b16 v[72:73], v31 offset:35328
ds_read_b64_tr_b16 v[74:75], v31 offset:35456
s_waitcnt lgkmcnt(0)
ds_write_b128 v2, v[60:63] offset:32768
ds_write_b128 v2, v[64:67] offset:33792
ds_write_b128 v2, v[68:71] offset:34816
ds_write_b128 v2, v[72:75] offset:35840
s_waitcnt lgkmcnt(0)
s_waitcnt vmcnt(24)
s_barrier
s_add_u32 s56, s54, 1572864
s_mov_b32 m0, 40960
s_nop 0
buffer_load_dwordx4 v26, s[16:19], s56 offen lds
s_add_u32 s56, s54, 1589248
s_mov_b32 m0, 41984
s_nop 0
buffer_load_dwordx4 v26, s[16:19], s56 offen lds
s_add_u32 s56, s54, 1605632
s_mov_b32 m0, 43008
s_nop 0
buffer_load_dwordx4 v27, s[16:19], s56 offen lds
s_add_u32 s56, s54, 1622016
s_mov_b32 m0, 44032
s_nop 0
buffer_load_dwordx4 v27, s[16:19], s56 offen lds
ds_read_b64_tr_b16 v[240:241], v44 offset:28672
ds_read_b64_tr_b16 v[242:243], v44 offset:29696
ds_read_b64_tr_b16 v[244:245], v46 offset:28672
ds_read_b64_tr_b16 v[246:247], v46 offset:29696
ds_read_b64_tr_b16 v[248:249], v45 offset:28672
ds_read_b64_tr_b16 v[250:251], v45 offset:29696
ds_read_b64_tr_b16 v[252:253], v47 offset:28672
ds_read_b64_tr_b16 v[254:255], v47 offset:29696
ds_read_b64_tr_b16 v[60:61], v31 offset:36864
ds_read_b64_tr_b16 v[62:63], v31 offset:36992
ds_read_b64_tr_b16 v[64:65], v31 offset:37376
ds_read_b64_tr_b16 v[66:67], v31 offset:37504
ds_read_b64_tr_b16 v[68:69], v31 offset:38912
ds_read_b64_tr_b16 v[70:71], v31 offset:39040
ds_read_b64_tr_b16 v[72:73], v31 offset:39424
ds_read_b64_tr_b16 v[74:75], v31 offset:39552
s_waitcnt lgkmcnt(0)
ds_write_b128 v2, v[60:63] offset:36864
ds_write_b128 v2, v[64:67] offset:37888
ds_write_b128 v2, v[68:71] offset:38912
ds_write_b128 v2, v[72:75] offset:39936
s_waitcnt lgkmcnt(0)
s_waitcnt vmcnt(24)
s_barrier
s_add_u32 s56, s54, 2097152
s_mov_b32 m0, 45056
s_nop 0
buffer_load_dwordx4 v26, s[16:19], s56 offen lds
s_add_u32 s56, s54, 2113536
s_mov_b32 m0, 46080
s_nop 0
buffer_load_dwordx4 v26, s[16:19], s56 offen lds
s_add_u32 s56, s54, 2129920
s_mov_b32 m0, 47104
s_nop 0
buffer_load_dwordx4 v27, s[16:19], s56 offen lds
s_add_u32 s56, s54, 2146304
s_mov_b32 m0, 48128
s_nop 0
buffer_load_dwordx4 v27, s[16:19], s56 offen lds
ds_read_b64_tr_b16 a[0:1], v44 offset:0
ds_read_b64_tr_b16 a[2:3], v44 offset:1024
ds_read_b64_tr_b16 a[4:5], v46 offset:0
ds_read_b64_tr_b16 a[6:7], v46 offset:1024
ds_read_b64_tr_b16 a[8:9], v45 offset:0
ds_read_b64_tr_b16 a[10:11], v45 offset:1024
ds_read_b64_tr_b16 a[12:13], v47 offset:0
ds_read_b64_tr_b16 a[14:15], v47 offset:1024
s_waitcnt lgkmcnt(0)
s_waitcnt vmcnt(24)
s_barrier
s_add_u32 s56, s54, 2621440
s_mov_b32 m0, 16384
s_nop 0
buffer_load_dwordx4 v26, s[16:19], s56 offen lds
s_add_u32 s56, s54, 2637824
s_mov_b32 m0, 17408
s_nop 0
buffer_load_dwordx4 v26, s[16:19], s56 offen lds
s_add_u32 s56, s54, 2654208
s_mov_b32 m0, 18432
s_nop 0
buffer_load_dwordx4 v27, s[16:19], s56 offen lds
s_add_u32 s56, s54, 2670592
s_mov_b32 m0, 19456
s_nop 0
buffer_load_dwordx4 v27, s[16:19], s56 offen lds
ds_read_b64_tr_b16 a[16:17], v44 offset:4096
ds_read_b64_tr_b16 a[18:19], v44 offset:5120
ds_read_b64_tr_b16 a[20:21], v46 offset:4096
ds_read_b64_tr_b16 a[22:23], v46 offset:5120
ds_read_b64_tr_b16 a[24:25], v45 offset:4096
ds_read_b64_tr_b16 a[26:27], v45 offset:5120
ds_read_b64_tr_b16 a[28:29], v47 offset:4096
ds_read_b64_tr_b16 a[30:31], v47 offset:5120
s_waitcnt lgkmcnt(0)
s_waitcnt vmcnt(24)
s_barrier
s_add_u32 s56, s54, 3145728
s_mov_b32 m0, 20480
s_nop 0
buffer_load_dwordx4 v26, s[16:19], s56 offen lds
s_add_u32 s56, s54, 3162112
s_mov_b32 m0, 21504
s_nop 0
buffer_load_dwordx4 v26, s[16:19], s56 offen lds
s_add_u32 s56, s54, 3178496
s_mov_b32 m0, 22528
s_nop 0
buffer_load_dwordx4 v27, s[16:19], s56 offen lds
s_add_u32 s56, s54, 3194880
s_mov_b32 m0, 23552
s_nop 0
buffer_load_dwordx4 v27, s[16:19], s56 offen lds
ds_read_b64_tr_b16 a[32:33], v44 offset:8192
ds_read_b64_tr_b16 a[34:35], v44 offset:9216
ds_read_b64_tr_b16 a[36:37], v46 offset:8192
ds_read_b64_tr_b16 a[38:39], v46 offset:9216
ds_read_b64_tr_b16 a[40:41], v45 offset:8192
ds_read_b64_tr_b16 a[42:43], v45 offset:9216
ds_read_b64_tr_b16 a[44:45], v47 offset:8192
ds_read_b64_tr_b16 a[46:47], v47 offset:9216
s_waitcnt lgkmcnt(0)
s_waitcnt vmcnt(24)
s_barrier
s_add_u32 s56, s54, 3670016
s_mov_b32 m0, 24576
s_nop 0
buffer_load_dwordx4 v26, s[16:19], s56 offen lds
s_add_u32 s56, s54, 3686400
s_mov_b32 m0, 25600
s_nop 0
buffer_load_dwordx4 v26, s[16:19], s56 offen lds
s_add_u32 s56, s54, 3702784
s_mov_b32 m0, 26624
s_nop 0
buffer_load_dwordx4 v27, s[16:19], s56 offen lds
s_add_u32 s56, s54, 3719168
s_mov_b32 m0, 27648
s_nop 0
buffer_load_dwordx4 v27, s[16:19], s56 offen lds
ds_read_b64_tr_b16 a[48:49], v44 offset:12288
ds_read_b64_tr_b16 a[50:51], v44 offset:13312
ds_read_b64_tr_b16 a[52:53], v46 offset:12288
ds_read_b64_tr_b16 a[54:55], v46 offset:13312
ds_read_b64_tr_b16 a[56:57], v45 offset:12288
ds_read_b64_tr_b16 a[58:59], v45 offset:13312
ds_read_b64_tr_b16 a[60:61], v47 offset:12288
ds_read_b64_tr_b16 a[62:63], v47 offset:13312
s_waitcnt lgkmcnt(0)
s_waitcnt vmcnt(24)
s_barrier
s_add_u32 s56, s55, 36864
s_mov_b32 m0, 28672
s_nop 0
buffer_load_dwordx4 v28, s[20:23], s56 offen lds
s_add_u32 s56, s55, 39168
s_mov_b32 m0, 29696
s_nop 0
buffer_load_dwordx4 v28, s[20:23], s56 offen lds
s_add_u32 s56, s55, 46080
s_mov_b32 m0, 30720
s_nop 0
buffer_load_dwordx4 v28, s[20:23], s56 offen lds
s_add_u32 s56, s55, 48384
s_mov_b32 m0, 31744
s_nop 0
buffer_load_dwordx4 v28, s[20:23], s56 offen lds
ds_read_b64_tr_b16 a[64:65], v44 offset:16384
ds_read_b64_tr_b16 a[66:67], v44 offset:17408
ds_read_b64_tr_b16 a[68:69], v46 offset:16384
ds_read_b64_tr_b16 a[70:71], v46 offset:17408
ds_read_b64_tr_b16 a[72:73], v45 offset:16384
ds_read_b64_tr_b16 a[74:75], v45 offset:17408
ds_read_b64_tr_b16 a[76:77], v47 offset:16384
ds_read_b64_tr_b16 a[78:79], v47 offset:17408
s_waitcnt lgkmcnt(0)
s_waitcnt vmcnt(24)
s_barrier
s_add_u32 s56, s55, 37120
s_mov_b32 m0, 32768
s_nop 0
buffer_load_dwordx4 v28, s[20:23], s56 offen lds
s_add_u32 s56, s55, 39424
s_mov_b32 m0, 33792
s_nop 0
buffer_load_dwordx4 v28, s[20:23], s56 offen lds
s_add_u32 s56, s55, 46336
s_mov_b32 m0, 34816
s_nop 0
buffer_load_dwordx4 v28, s[20:23], s56 offen lds
s_add_u32 s56, s55, 48640
s_mov_b32 m0, 35840
s_nop 0
buffer_load_dwordx4 v28, s[20:23], s56 offen lds
ds_read_b64_tr_b16 a[80:81], v44 offset:20480
ds_read_b64_tr_b16 a[82:83], v44 offset:21504
ds_read_b64_tr_b16 a[84:85], v46 offset:20480
ds_read_b64_tr_b16 a[86:87], v46 offset:21504
ds_read_b64_tr_b16 a[88:89], v45 offset:20480
ds_read_b64_tr_b16 a[90:91], v45 offset:21504
ds_read_b64_tr_b16 a[92:93], v47 offset:20480
ds_read_b64_tr_b16 a[94:95], v47 offset:21504
s_waitcnt lgkmcnt(0)
s_waitcnt vmcnt(24)
s_barrier
s_add_u32 s56, s55, 37376
s_mov_b32 m0, 36864
s_nop 0
buffer_load_dwordx4 v28, s[20:23], s56 offen lds
s_add_u32 s56, s55, 39680
s_mov_b32 m0, 37888
s_nop 0
buffer_load_dwordx4 v28, s[20:23], s56 offen lds
s_add_u32 s56, s55, 46592
s_mov_b32 m0, 38912
s_nop 0
buffer_load_dwordx4 v28, s[20:23], s56 offen lds
s_add_u32 s56, s55, 48896
s_mov_b32 m0, 39936
s_nop 0
buffer_load_dwordx4 v28, s[20:23], s56 offen lds
ds_read_b64_tr_b16 a[96:97], v44 offset:24576
ds_read_b64_tr_b16 a[98:99], v44 offset:25600
ds_read_b64_tr_b16 a[100:101], v46 offset:24576
ds_read_b64_tr_b16 a[102:103], v46 offset:25600
ds_read_b64_tr_b16 a[104:105], v45 offset:24576
ds_read_b64_tr_b16 a[106:107], v45 offset:25600
ds_read_b64_tr_b16 a[108:109], v47 offset:24576
ds_read_b64_tr_b16 a[110:111], v47 offset:25600
s_waitcnt lgkmcnt(0)
s_waitcnt vmcnt(24)
s_barrier
s_add_u32 s56, s55, 37632
s_mov_b32 m0, 40960
s_nop 0
buffer_load_dwordx4 v28, s[20:23], s56 offen lds
s_add_u32 s56, s55, 39936
s_mov_b32 m0, 41984
s_nop 0
buffer_load_dwordx4 v28, s[20:23], s56 offen lds
s_add_u32 s56, s55, 46848
s_mov_b32 m0, 43008
s_nop 0
buffer_load_dwordx4 v28, s[20:23], s56 offen lds
s_add_u32 s56, s55, 49152
s_mov_b32 m0, 44032
s_nop 0
buffer_load_dwordx4 v28, s[20:23], s56 offen lds
ds_read_b64_tr_b16 a[112:113], v44 offset:28672
ds_read_b64_tr_b16 a[114:115], v44 offset:29696
ds_read_b64_tr_b16 a[116:117], v46 offset:28672
ds_read_b64_tr_b16 a[118:119], v46 offset:29696
ds_read_b64_tr_b16 a[120:121], v45 offset:28672
ds_read_b64_tr_b16 a[122:123], v45 offset:29696
ds_read_b64_tr_b16 a[124:125], v47 offset:28672
ds_read_b64_tr_b16 a[126:127], v47 offset:29696
s_waitcnt lgkmcnt(0)
s_waitcnt vmcnt(24)
s_barrier
s_add_u32 s56, s55, 768
s_mov_b32 m0, 45056
s_nop 0
buffer_load_dwordx4 v28, s[20:23], s56 offen lds
s_add_u32 s56, s55, 3072
s_mov_b32 m0, 46080
s_nop 0
buffer_load_dwordx4 v28, s[20:23], s56 offen lds
s_add_u32 s56, s55, 9984
s_mov_b32 m0, 47104
s_nop 0
buffer_load_dwordx4 v28, s[20:23], s56 offen lds
s_add_u32 s56, s55, 12288
s_mov_b32 m0, 48128
s_nop 0
buffer_load_dwordx4 v28, s[20:23], s56 offen lds
ds_read_b64_tr_b16 a[128:129], v44 offset:0
ds_read_b64_tr_b16 a[130:131], v44 offset:1024
ds_read_b64_tr_b16 a[132:133], v46 offset:0
ds_read_b64_tr_b16 a[134:135], v46 offset:1024
ds_read_b64_tr_b16 a[136:137], v45 offset:0
ds_read_b64_tr_b16 a[138:139], v45 offset:1024
ds_read_b64_tr_b16 a[140:141], v47 offset:0
ds_read_b64_tr_b16 a[142:143], v47 offset:1024
buffer_load_dword v32, v24, s[28:31], 0 offen sc0 sc1
s_waitcnt lgkmcnt(0)
s_waitcnt vmcnt(25)
s_barrier
s_add_u32 s56, s54, 0
s_mov_b32 m0, 16384
s_nop 0
buffer_load_dwordx4 v26, s[8:11], s56 offen lds
s_add_u32 s56, s54, 16384
s_mov_b32 m0, 17408
s_nop 0
buffer_load_dwordx4 v26, s[8:11], s56 offen lds
s_add_u32 s56, s54, 32768
s_mov_b32 m0, 18432
s_nop 0
buffer_load_dwordx4 v27, s[8:11], s56 offen lds
s_add_u32 s56, s54, 49152
s_mov_b32 m0, 19456
s_nop 0
buffer_load_dwordx4 v27, s[8:11], s56 offen lds
ds_read_b64_tr_b16 a[144:145], v44 offset:4096
ds_read_b64_tr_b16 a[146:147], v44 offset:5120
ds_read_b64_tr_b16 a[148:149], v46 offset:4096
ds_read_b64_tr_b16 a[150:151], v46 offset:5120
ds_read_b64_tr_b16 a[152:153], v45 offset:4096
ds_read_b64_tr_b16 a[154:155], v45 offset:5120
ds_read_b64_tr_b16 a[156:157], v47 offset:4096
ds_read_b64_tr_b16 a[158:159], v47 offset:5120
s_waitcnt lgkmcnt(0)
s_waitcnt vmcnt(25)
s_barrier
s_add_u32 s56, s54, 1572864
s_mov_b32 m0, 20480
s_nop 0
buffer_load_dwordx4 v26, s[8:11], s56 offen lds
s_add_u32 s56, s54, 1589248
s_mov_b32 m0, 21504
s_nop 0
buffer_load_dwordx4 v26, s[8:11], s56 offen lds
s_add_u32 s56, s54, 1605632
s_mov_b32 m0, 22528
s_nop 0
buffer_load_dwordx4 v27, s[8:11], s56 offen lds
s_add_u32 s56, s54, 1622016
s_mov_b32 m0, 23552
s_nop 0
buffer_load_dwordx4 v27, s[8:11], s56 offen lds
ds_read_b64_tr_b16 a[160:161], v44 offset:8192
ds_read_b64_tr_b16 a[162:163], v44 offset:9216
ds_read_b64_tr_b16 a[164:165], v46 offset:8192
ds_read_b64_tr_b16 a[166:167], v46 offset:9216
ds_read_b64_tr_b16 a[168:169], v45 offset:8192
ds_read_b64_tr_b16 a[170:171], v45 offset:9216
ds_read_b64_tr_b16 a[172:173], v47 offset:8192
ds_read_b64_tr_b16 a[174:175], v47 offset:9216
s_waitcnt lgkmcnt(0)
s_waitcnt vmcnt(25)
s_barrier
s_add_u32 s56, s54, 2097152
s_mov_b32 m0, 24576
s_nop 0
buffer_load_dwordx4 v26, s[8:11], s56 offen lds
s_add_u32 s56, s54, 2113536
s_mov_b32 m0, 25600
s_nop 0
buffer_load_dwordx4 v26, s[8:11], s56 offen lds
s_add_u32 s56, s54, 2129920
s_mov_b32 m0, 26624
s_nop 0
buffer_load_dwordx4 v27, s[8:11], s56 offen lds
s_add_u32 s56, s54, 2146304
s_mov_b32 m0, 27648
s_nop 0
buffer_load_dwordx4 v27, s[8:11], s56 offen lds
ds_read_b64_tr_b16 a[176:177], v48 offset:12288
ds_read_b64_tr_b16 a[178:179], v48 offset:13312
ds_read_b64_tr_b16 a[180:181], v48 offset:14336
ds_read_b64_tr_b16 a[182:183], v48 offset:15360
ds_read_b64_tr_b16 a[184:185], v49 offset:12288
ds_read_b64_tr_b16 a[186:187], v49 offset:13312
ds_read_b64_tr_b16 a[188:189], v49 offset:14336
ds_read_b64_tr_b16 a[190:191], v49 offset:15360
s_waitcnt lgkmcnt(0)
s_waitcnt vmcnt(25)
s_barrier
s_add_u32 s56, s54, 2621440
s_mov_b32 m0, 28672
s_nop 0
buffer_load_dwordx4 v26, s[12:15], s56 offen lds
s_add_u32 s56, s54, 2637824
s_mov_b32 m0, 29696
s_nop 0
buffer_load_dwordx4 v26, s[12:15], s56 offen lds
s_add_u32 s56, s54, 2654208
s_mov_b32 m0, 30720
s_nop 0
buffer_load_dwordx4 v27, s[12:15], s56 offen lds
s_add_u32 s56, s54, 2670592
s_mov_b32 m0, 31744
s_nop 0
buffer_load_dwordx4 v27, s[12:15], s56 offen lds
ds_read_b64_tr_b16 a[192:193], v48 offset:16384
ds_read_b64_tr_b16 a[194:195], v48 offset:17408
ds_read_b64_tr_b16 a[196:197], v48 offset:18432
ds_read_b64_tr_b16 a[198:199], v48 offset:19456
ds_read_b64_tr_b16 a[200:201], v49 offset:16384
ds_read_b64_tr_b16 a[202:203], v49 offset:17408
ds_read_b64_tr_b16 a[204:205], v49 offset:18432
ds_read_b64_tr_b16 a[206:207], v49 offset:19456
s_waitcnt lgkmcnt(0)
s_waitcnt vmcnt(25)
s_barrier
s_add_u32 s56, s54, 4194304
s_mov_b32 m0, 32768
s_nop 0
buffer_load_dwordx4 v26, s[16:19], s56 offen lds
s_add_u32 s56, s54, 4210688
s_mov_b32 m0, 33792
s_nop 0
buffer_load_dwordx4 v26, s[16:19], s56 offen lds
s_add_u32 s56, s54, 4227072
s_mov_b32 m0, 34816
s_nop 0
buffer_load_dwordx4 v27, s[16:19], s56 offen lds
s_add_u32 s56, s54, 4243456
s_mov_b32 m0, 35840
s_nop 0
buffer_load_dwordx4 v27, s[16:19], s56 offen lds
ds_read_b64_tr_b16 a[208:209], v48 offset:20480
ds_read_b64_tr_b16 a[210:211], v48 offset:21504
ds_read_b64_tr_b16 a[212:213], v48 offset:22528
ds_read_b64_tr_b16 a[214:215], v48 offset:23552
ds_read_b64_tr_b16 a[216:217], v49 offset:20480
ds_read_b64_tr_b16 a[218:219], v49 offset:21504
ds_read_b64_tr_b16 a[220:221], v49 offset:22528
ds_read_b64_tr_b16 a[222:223], v49 offset:23552
s_waitcnt lgkmcnt(0)
s_waitcnt vmcnt(25)
s_barrier
s_add_u32 s56, s55, 0
s_mov_b32 m0, 36864
s_nop 0
buffer_load_dwordx4 v28, s[20:23], s56 offen lds
s_add_u32 s56, s55, 2304
s_mov_b32 m0, 37888
s_nop 0
buffer_load_dwordx4 v28, s[20:23], s56 offen lds
s_add_u32 s56, s55, 9216
s_mov_b32 m0, 38912
s_nop 0
buffer_load_dwordx4 v28, s[20:23], s56 offen lds
s_add_u32 s56, s55, 11520
s_mov_b32 m0, 39936
s_nop 0
buffer_load_dwordx4 v28, s[20:23], s56 offen lds
ds_read_b64_tr_b16 a[232:233], v48 offset:24576
ds_read_b64_tr_b16 a[234:235], v48 offset:25600
ds_read_b64_tr_b16 a[236:237], v48 offset:26624
ds_read_b64_tr_b16 a[238:239], v48 offset:27648
ds_read_b64_tr_b16 a[248:249], v49 offset:24576
ds_read_b64_tr_b16 a[250:251], v49 offset:25600
ds_read_b64_tr_b16 a[252:253], v49 offset:26624
ds_read_b64_tr_b16 a[254:255], v49 offset:27648
s_waitcnt lgkmcnt(0)
s_waitcnt vmcnt(25)
s_barrier
s_add_u32 s56, s55, 256
s_mov_b32 m0, 40960
s_nop 0
buffer_load_dwordx4 v28, s[20:23], s56 offen lds
s_add_u32 s56, s55, 2560
s_mov_b32 m0, 41984
s_nop 0
buffer_load_dwordx4 v28, s[20:23], s56 offen lds
s_add_u32 s56, s55, 9472
s_mov_b32 m0, 43008
s_nop 0
buffer_load_dwordx4 v28, s[20:23], s56 offen lds
s_add_u32 s56, s55, 11776
s_mov_b32 m0, 44032
s_nop 0
buffer_load_dwordx4 v28, s[20:23], s56 offen lds
ds_read_b64_tr_b16 a[224:225], v48 offset:28672
ds_read_b64_tr_b16 a[226:227], v48 offset:29696
ds_read_b64_tr_b16 a[228:229], v48 offset:30720
ds_read_b64_tr_b16 a[230:231], v48 offset:31744
ds_read_b64_tr_b16 a[240:241], v49 offset:28672
ds_read_b64_tr_b16 a[242:243], v49 offset:29696
ds_read_b64_tr_b16 a[244:245], v49 offset:30720
ds_read_b64_tr_b16 a[246:247], v49 offset:31744
s_waitcnt lgkmcnt(0)
s_waitcnt vmcnt(24)
s_barrier
s_add_u32 s56, s55, 512
s_mov_b32 m0, 45056
s_nop 0
buffer_load_dwordx4 v28, s[20:23], s56 offen lds
s_add_u32 s56, s55, 2816
s_mov_b32 m0, 46080
s_nop 0
buffer_load_dwordx4 v28, s[20:23], s56 offen lds
s_add_u32 s56, s55, 9728
s_mov_b32 m0, 47104
s_nop 0
buffer_load_dwordx4 v28, s[20:23], s56 offen lds
s_add_u32 s56, s55, 12032
s_mov_b32 m0, 48128
s_nop 0
buffer_load_dwordx4 v28, s[20:23], s56 offen lds
ds_read_b64_tr_b16 v[60:61], v44 offset:0
ds_read_b64_tr_b16 v[62:63], v44 offset:1024
ds_read_b64_tr_b16 v[64:65], v46 offset:0
ds_read_b64_tr_b16 v[66:67], v46 offset:1024
ds_read_b64_tr_b16 v[68:69], v45 offset:0
ds_read_b64_tr_b16 v[70:71], v45 offset:1024
ds_read_b64_tr_b16 v[72:73], v47 offset:0
ds_read_b64_tr_b16 v[74:75], v47 offset:1024
s_waitcnt lgkmcnt(0)
s_waitcnt vmcnt(24)
s_barrier
ds_write_b128 v2, v[60:63] offset:0
ds_write_b128 v2, v[64:67] offset:1024
ds_write_b128 v2, v[68:71] offset:2048
ds_write_b128 v2, v[72:75] offset:3072
ds_read_b64_tr_b16 v[60:61], v44 offset:4096
ds_read_b64_tr_b16 v[62:63], v44 offset:5120
ds_read_b64_tr_b16 v[64:65], v46 offset:4096
ds_read_b64_tr_b16 v[66:67], v46 offset:5120
ds_read_b64_tr_b16 v[68:69], v45 offset:4096
ds_read_b64_tr_b16 v[70:71], v45 offset:5120
ds_read_b64_tr_b16 v[72:73], v47 offset:4096
ds_read_b64_tr_b16 v[74:75], v47 offset:5120
L_rdv_w0:
v_readfirstlane_b32 s38, v32
s_nop 0
s_and_b32 s57, s38, 0xff
s_cmp_lg_u32 s57, 32
s_cbranch_scc1 L_rdv2_w0
L_kvw_w0p:
s_load_dwordx16 s[64:79], s[4:5], s101 glc
s_sub_u32 s41, s41, 1
s_cbranch_scc1 L_exit
s_waitcnt lgkmcnt(0)
s_min_u32 s64, s64, s65
s_min_u32 s64, s64, s66
s_min_u32 s64, s64, s67
s_min_u32 s64, s64, s68
s_min_u32 s64, s64, s69
s_min_u32 s64, s64, s70
s_min_u32 s64, s64, s71
s_min_u32 s64, s64, s72
s_min_u32 s64, s64, s73
s_min_u32 s64, s64, s74
s_min_u32 s64, s64, s75
s_min_u32 s64, s64, s76
s_min_u32 s64, s64, s77
s_min_u32 s64, s64, s78
s_min_u32 s64, s64, s79
s_lshl_b32 s100, s64, 2
s_sub_u32 s100, s100, 1
s_cmp_ge_i32 s34, s100
s_cbranch_scc1 L_kvw_w0p
s_waitcnt lgkmcnt(0)
s_waitcnt vmcnt(20)
s_barrier
ds_write_b128 v2, v[60:63] offset:4096
ds_write_b128 v2, v[64:67] offset:5120
ds_write_b128 v2, v[68:71] offset:6144
ds_write_b128 v2, v[72:75] offset:7168
ds_read_b64_tr_b16 v[60:61], v44 offset:8192
ds_read_b64_tr_b16 v[62:63], v44 offset:9216
ds_read_b64_tr_b16 v[64:65], v46 offset:8192
ds_read_b64_tr_b16 v[66:67], v46 offset:9216
ds_read_b64_tr_b16 v[68:69], v45 offset:8192
ds_read_b64_tr_b16 v[70:71], v45 offset:9216
ds_read_b64_tr_b16 v[72:73], v47 offset:8192
ds_read_b64_tr_b16 v[74:75], v47 offset:9216
buffer_load_dwordx4 v[12:15], v9, s[4:7], s37 offen offset:0
buffer_load_dwordx4 v[16:19], v9, s[4:7], s37 offen offset:1024
buffer_load_dwordx4 v[52:55], v1, s[4:7], s37 offen offset:2048
buffer_load_dwordx4 v[56:59], v1, s[4:7], s37 offen offset:3072
s_mov_b32 m0, 1024
s_nop 0
buffer_load_dwordx4 v1, s[4:7], s47 offen offset:0 sc0 sc1 lds
s_waitcnt lgkmcnt(0)
s_waitcnt vmcnt(21)
s_barrier
ds_write_b128 v2, v[60:63] offset:8192
ds_write_b128 v2, v[64:67] offset:9216
ds_write_b128 v2, v[68:71] offset:10240
ds_write_b128 v2, v[72:75] offset:11264
ds_read_b64_tr_b16 v[60:61], v44 offset:12288
ds_read_b64_tr_b16 v[62:63], v44 offset:13312
ds_read_b64_tr_b16 v[64:65], v46 offset:12288
ds_read_b64_tr_b16 v[66:67], v46 offset:13312
ds_read_b64_tr_b16 v[68:69], v45 offset:12288
ds_read_b64_tr_b16 v[70:71], v45 offset:13312
ds_read_b64_tr_b16 v[72:73], v47 offset:12288
ds_read_b64_tr_b16 v[74:75], v47 offset:13312
s_waitcnt lgkmcnt(0)
s_waitcnt vmcnt(17)
s_barrier
ds_write_b128 v2, v[60:63] offset:12288
ds_write_b128 v2, v[64:67] offset:13312
ds_write_b128 v2, v[68:71] offset:14336
ds_write_b128 v2, v[72:75] offset:15360
ds_read_b64_tr_b16 v[60:61], v44 offset:16384
ds_read_b64_tr_b16 v[62:63], v44 offset:17408
ds_read_b64_tr_b16 v[64:65], v46 offset:16384
ds_read_b64_tr_b16 v[66:67], v46 offset:17408
ds_read_b64_tr_b16 v[68:69], v45 offset:16384
ds_read_b64_tr_b16 v[70:71], v45 offset:17408
ds_read_b64_tr_b16 v[72:73], v47 offset:16384
ds_read_b64_tr_b16 v[74:75], v47 offset:17408
s_waitcnt lgkmcnt(0)
s_waitcnt vmcnt(13)
s_barrier
ds_write_b128 v2, v[60:63] offset:16384
ds_write_b128 v2, v[64:67] offset:17408
ds_write_b128 v2, v[68:71] offset:18432
ds_write_b128 v2, v[72:75] offset:19456
ds_read_b64_tr_b16 v[60:61], v48 offset:20480
ds_read_b64_tr_b16 v[62:63], v48 offset:21504
ds_read_b64_tr_b16 v[64:65], v48 offset:22528
ds_read_b64_tr_b16 v[66:67], v48 offset:23552
ds_read_b64_tr_b16 v[68:69], v49 offset:20480
ds_read_b64_tr_b16 v[70:71], v49 offset:21504
ds_read_b64_tr_b16 v[72:73], v49 offset:22528
ds_read_b64_tr_b16 v[74:75], v49 offset:23552
s_waitcnt lgkmcnt(0)
s_waitcnt vmcnt(9)
s_barrier
ds_write_b128 v2, v[60:63] offset:20480
ds_write_b128 v2, v[64:67] offset:21504
ds_write_b128 v2, v[68:71] offset:22528
ds_write_b128 v2, v[72:75] offset:23552
ds_read_b64_tr_b16 v[60:61], v48 offset:24576
ds_read_b64_tr_b16 v[62:63], v48 offset:25600
ds_read_b64_tr_b16 v[64:65], v48 offset:26624
ds_read_b64_tr_b16 v[66:67], v48 offset:27648
ds_read_b64_tr_b16 v[68:69], v49 offset:24576
ds_read_b64_tr_b16 v[70:71], v49 offset:25600
ds_read_b64_tr_b16 v[72:73], v49 offset:26624
ds_read_b64_tr_b16 v[74:75], v49 offset:27648
s_waitcnt lgkmcnt(0)
s_waitcnt vmcnt(5)
s_barrier
ds_write_b128 v2, v[60:63] offset:24576
ds_write_b128 v2, v[64:67] offset:25600
ds_write_b128 v2, v[68:71] offset:26624
ds_write_b128 v2, v[72:75] offset:27648
ds_read_b64_tr_b16 v[60:61], v48 offset:28672
ds_read_b64_tr_b16 v[62:63], v48 offset:29696
ds_read_b64_tr_b16 v[64:65], v48 offset:30720
ds_read_b64_tr_b16 v[66:67], v48 offset:31744
ds_read_b64_tr_b16 v[68:69], v49 offset:28672
ds_read_b64_tr_b16 v[70:71], v49 offset:29696
ds_read_b64_tr_b16 v[72:73], v49 offset:30720
ds_read_b64_tr_b16 v[74:75], v49 offset:31744
s_waitcnt lgkmcnt(0)
s_barrier
ds_write_b128 v2, v[60:63] offset:28672
ds_write_b128 v2, v[64:67] offset:29696
ds_write_b128 v2, v[68:71] offset:30720
ds_write_b128 v2, v[72:75] offset:31744
s_lshl_b32 s57, s58, 5
s_mov_b32 s0, 0x3f003f00
s_mov_b32 s1, 0x3f003f00
s_mov_b32 s58, 304128
s_cmp_eq_u32 s38, s57
s_cbranch_scc0 L_slow_w0
v_mov_b64 v[20:21], 0
v_mov_b64 v[22:23], 0
v_mov_b64 v[24:25], 0
v_mov_b64 v[26:27], 0
v_mov_b64 v[28:29], 0
v_mov_b64 v[30:31], 0
v_mov_b64 v[32:33], 0
v_mov_b64 v[34:35], 0
v_mov_b64 v[36:37], 0
v_mov_b64 v[38:39], 0
v_mov_b64 v[40:41], 0
v_mov_b64 v[42:43], 0
ds_read_b128 v[44:47], v2 offset:0
ds_read_b128 v[48:51], v2 offset:1024
v_bfe_u32 v77, v1, 6, 1
v_lshl_add_u32 v77, v77, 3, v1
v_lshlrev_b32 v77, 1, v77
v_lshlrev_b32 v78, 2, v1
s_waitcnt vmcnt(0) lgkmcnt(0)
s_branch L_top_w0f
.p2align 6
L_ex_w0f:
s_add_u32 s34, s34, 1
s_add_u32 s37, s37, 524288
s_add_u32 s39, s39, 524288
s_mul_i32 s40, s34, 10240
s_add_u32 s40, s40, 8093696
s_not_b32 s35, s35
s_not_b32 s36, s36
v_mov_b64 v[20:21], 0
v_mov_b64 v[22:23], 0
v_mov_b64 v[24:25], 0
v_mov_b64 v[26:27], 0
v_mov_b64 v[28:29], 0
v_mov_b64 v[30:31], 0
v_mov_b64 v[32:33], 0
v_mov_b64 v[34:35], 0
v_mov_b64 v[36:37], 0
v_mov_b64 v[38:39], 0
v_mov_b64 v[40:41], 0
v_mov_b64 v[42:43], 0
s_cmp_eq_u32 s34, 63
s_cbranch_scc1 L_done_w0f
ds_read_b128 v[44:47], v2 offset:0
ds_read_b128 v[48:51], v2 offset:1024
v_bfe_u32 v77, v1, 6, 1
v_lshl_add_u32 v77, v77, 3, v1
v_lshlrev_b32 v77, 1, v77
v_lshlrev_b32 v78, 2, v1
s_barrier
s_cmp_ge_u32 s34, s100
s_cbranch_scc1 L_ev_w0f
L_evb_w0f:
L_top_w0f:
s_barrier
ds_read_b128 v[60:63], v1 offset:1024
ds_read_b128 v[64:67], v1 offset:2048
s_mov_b32 m0, 5120
s_nop 0
buffer_load_dwordx4 v1, s[4:7], s48 offen offset:0 sc1 lds
s_barrier
ds_read_b128 v[68:71], v1 offset:3072
ds_read_b128 v[72:75], v1 offset:4096
L_s0_w0f:
s_waitcnt lgkmcnt(3)
v_smfmac_f32_16x16x64_bf16 v[28:31], v[60:63], v[176:183], v0
v_smfmac_f32_16x16x64_bf16 v[32:35], v[60:63], v[184:191], v0
v_smfmac_f32_16x16x64_bf16 v[36:39], v[60:63], a[48:55], v0
v_smfmac_f32_16x16x64_bf16 v[40:43], v[60:63], a[56:63], v0
s_waitcnt lgkmcnt(2)
v_smfmac_f32_16x16x64_bf16 v[20:23], v[64:67], v[80:87], v0
v_smfmac_f32_16x16x64_bf16 v[20:23], v[60:63], v[44:51], v0
ds_read_b128 v[44:47], v2 offset:2048
buffer_load_dwordx4 v[12:15], v9, s[4:7], s37 offen offset:0
buffer_load_dwordx4 v[16:19], v9, s[4:7], s37 offen offset:1024
buffer_load_dwordx4 v[52:55], v1, s[4:7], s37 offen offset:2048
buffer_load_dwordx4 v[56:59], v1, s[4:7], s37 offen offset:3072
v_smfmac_f32_16x16x64_bf16 v[24:27], v[64:67], v[88:95], v0
ds_read_b128 v[48:51], v2 offset:3072
v_smfmac_f32_16x16x64_bf16 v[28:31], v[64:67], v[192:199], v0
s_waitcnt lgkmcnt(2)
v_bitop3_b32 v6, v60, v64, s35 bitop3:0x7e
v_smfmac_f32_16x16x64_bf16 v[32:35], v[64:67], v[200:207], v0
v_bitop3_b32 v76, v68, v72, s35 bitop3:0x7e
v_smfmac_f32_16x16x64_bf16 v[36:39], v[64:67], a[64:71], v0
v_bitop3_b32 v6, v6, v76, 1 bitop3:0xa8
s_waitcnt lgkmcnt(0)
v_smfmac_f32_16x16x64_bf16 v[24:27], v[60:63], v[44:51], v0
ds_read_b128 v[44:47], v2 offset:4096
v_cmp_ne_u32 vcc, 0, v6
v_smfmac_f32_16x16x64_bf16 v[40:43], v[64:67], a[72:79], v0
ds_read_b128 v[48:51], v2 offset:5120
v_smfmac_f32_16x16x64_bf16 v[20:23], v[68:71], v[96:103], v0
s_cbranch_vccnz L_ra0_w0f
v_smfmac_f32_16x16x64_bf16 v[24:27], v[68:71], v[104:111], v0
s_waitcnt vmcnt(4)
s_barrier
ds_read_b32 v6, v77 offset:8192
v_smfmac_f32_16x16x64_bf16 v[28:31], v[68:71], v[208:215], v0
ds_read_b128 v[60:63], v1 offset:6144
s_waitcnt lgkmcnt(2)
v_smfmac_f32_16x16x64_bf16 v[20:23], v[72:75], v[44:51], v0
ds_read_b128 v[64:67], v1 offset:7168
v_smfmac_f32_16x16x64_bf16 v[32:35], v[68:71], v[216:223], v0
ds_read_b128 v[76:79], v1 offset:5120
v_smfmac_f32_16x16x64_bf16 v[36:39], v[68:71], a[80:87], v0
ds_read_b128 v[44:47], v2 offset:6144
v_smfmac_f32_16x16x64_bf16 v[40:43], v[68:71], a[88:95], v0
ds_read_b128 v[48:51], v2 offset:7168
s_waitcnt lgkmcnt(4)
v_bitop3_b32 v6, v6, v60, s35 bitop3:0x7e
v_smfmac_f32_16x16x64_bf16 v[28:31], v[72:75], v[224:231], v0
ds_read_b128 v[68:71], v1 offset:8192
s_waitcnt lgkmcnt(4)
v_bitop3_b32 v6, v6, v64, s35 bitop3:0xf6
v_smfmac_f32_16x16x64_bf16 v[32:35], v[72:75], v[232:239], v0
s_waitcnt lgkmcnt(3)
v_bitop3_b32 v6, v6, v76, s35 bitop3:0xf6
v_and_b32 v6, 1, v6
v_smfmac_f32_16x16x64_bf16 v[36:39], v[72:75], a[96:103], v0
v_cmp_ne_u32 vcc, 0, v6
s_waitcnt lgkmcnt(1)
v_smfmac_f32_16x16x64_bf16 v[24:27], v[72:75], v[44:51], v0
ds_read_b128 v[44:47], v2 offset:8192
v_lshlrev_b32 v6, 2, v1
v_smfmac_f32_16x16x64_bf16 v[40:43], v[72:75], a[104:111], v0
ds_read_b128 v[72:75], v1 offset:9216
s_cbranch_vccnz L_ra1_w0f
L_a1_w0f:
s_mov_b32 m0, 0
s_nop 0
buffer_load_dword v6, s[4:7], s39 offen lds
v_smfmac_f32_16x16x64_bf16 v[20:23], v[60:63], v[112:119], v0
ds_read_b128 v[48:51], v2 offset:9216
v_smfmac_f32_16x16x64_bf16 v[20:23], v[64:67], v[128:135], v0
s_waitcnt lgkmcnt(3)
v_smfmac_f32_16x16x64_bf16 v[20:23], v[68:71], v[144:151], v0
s_waitcnt lgkmcnt(1)
v_smfmac_f32_16x16x64_bf16 v[20:23], v[72:75], v[160:167], v0
s_waitcnt lgkmcnt(0)
v_smfmac_f32_16x16x64_bf16 v[20:23], v[76:79], v[44:51], v0
ds_read_b128 v[44:47], v2 offset:10240
v_smfmac_f32_16x16x64_bf16 v[24:27], v[60:63], v[120:127], v0
ds_read_b128 v[48:51], v2 offset:11264
v_smfmac_f32_16x16x64_bf16 v[24:27], v[64:67], v[136:143], v0
v_add_f32 v20, v20, v22
v_smfmac_f32_16x16x64_bf16 v[24:27], v[68:71], v[152:159], v0
v_add_f32 v21, v21, v23
v_smfmac_f32_16x16x64_bf16 v[24:27], v[72:75], v[168:175], v0
v_cvt_pk_bf16_f32 v22, v20, v21
s_waitcnt lgkmcnt(0)
v_smfmac_f32_16x16x64_bf16 v[24:27], v[76:79], v[44:51], v0
ds_read_b128 v[44:47], v2 offset:12288
v_smfmac_f32_16x16x64_bf16 v[28:31], v[76:79], v[240:247], v0
ds_read_b128 v[48:51], v2 offset:13312
v_smfmac_f32_16x16x64_bf16 v[28:31], v[64:67], a[0:7], v0
v_add_f32 v24, v24, v26
v_add_f32 v25, v25, v27
v_cvt_pk_bf16_f32 v23, v24, v25
v_smfmac_f32_16x16x64_bf16 v[28:31], v[68:71], a[16:23], v0
ds_write_b64 v3, v[22:23] offset:10240
v_smfmac_f32_16x16x64_bf16 v[28:31], v[72:75], a[32:39], v0
s_waitcnt lgkmcnt(1)
v_smfmac_f32_16x16x64_bf16 v[28:31], v[60:63], v[44:51], v0
ds_read_b128 v[44:47], v2 offset:14336
v_smfmac_f32_16x16x64_bf16 v[32:35], v[76:79], v[248:255], v0
ds_read_b128 v[48:51], v2 offset:15360
s_waitcnt lgkmcnt(2)
s_barrier
v_smfmac_f32_16x16x64_bf16 v[32:35], v[64:67], a[8:15], v0
ds_read_b64_tr_b16 v[20:21], v4 offset:10240
ds_read_b64_tr_b16 v[22:23], v4 offset:10752
v_add_f32 v28, v28, v30
v_smfmac_f32_16x16x64_bf16 v[32:35], v[68:71], a[24:31], v0
ds_read_b64_tr_b16 v[24:25], v4 offset:11264
v_add_f32 v29, v29, v31
v_smfmac_f32_16x16x64_bf16 v[32:35], v[72:75], a[40:47], v0
ds_read_b64_tr_b16 v[26:27], v4 offset:11776
v_cvt_pk_bf16_f32 v30, v28, v29
s_waitcnt lgkmcnt(4)
v_smfmac_f32_16x16x64_bf16 v[32:35], v[60:63], v[44:51], v0
ds_read_b128 v[44:47], v2 offset:18432
s_waitcnt vmcnt(3)
s_waitcnt lgkmcnt(3)
v_mfma_f32_16x16x32_bf16 v[12:15], v[12:15], v[20:23], 0
ds_read_b128 v[48:51], v2 offset:19456
s_waitcnt lgkmcnt(2)
v_mfma_f32_16x16x32_bf16 v[12:15], v[16:19], v[24:27], v[12:15]
v_add_f32 v32, v32, v34
v_add_f32 v33, v33, v35
v_cvt_pk_bf16_f32 v31, v32, v33
ds_write_b64 v3, v[30:31] offset:12288
v_smfmac_f32_16x16x64_bf16 v[36:39], v[76:79], a[112:119], v0
s_nop 2
v_add_f32_dpp v12, v14, v12 quad_perm:[2,3,0,1] row_mask:0xf bank_mask:0xf
v_add_f32_dpp v13, v15, v13 quad_perm:[2,3,0,1] row_mask:0xf bank_mask:0xf
ds_write_b64 v5, v[12:13] offset:14336
v_smfmac_f32_16x16x64_bf16 v[40:43], v[76:79], a[120:127], v0
s_waitcnt lgkmcnt(1)
s_barrier
ds_read_b64_tr_b16 v[28:29], v4 offset:12288
v_smfmac_f32_16x16x64_bf16 v[36:39], v[60:63], a[128:135], v0
ds_read_b64_tr_b16 v[30:31], v4 offset:12800
ds_read_b64_tr_b16 v[32:33], v4 offset:13312
v_smfmac_f32_16x16x64_bf16 v[40:43], v[60:63], a[136:143], v0
ds_read_b64_tr_b16 v[34:35], v4 offset:13824
v_mov_b64 v[76:77], s[52:53]
s_waitcnt lgkmcnt(4)
s_barrier
ds_read_b128 v[12:15], v1 offset:14336
v_smfmac_f32_16x16x64_bf16 v[40:43], v[72:75], v[44:51], v0
ds_read_b128 v[44:47], v2 offset:16384
v_mov_b64 v[78:79], s[52:53]
s_waitcnt lgkmcnt(4)
v_mfma_f32_16x16x32_bf16 v[28:31], v[28:31], v[20:23], 0
ds_read_b128 v[48:51], v2 offset:17408
s_waitcnt lgkmcnt(3)
v_mfma_f32_16x16x32_bf16 v[28:31], v[32:35], v[24:27], v[28:31]
v_smfmac_f32_16x16x64_bf16 v[40:43], v[64:67], a[152:159], v0
s_waitcnt lgkmcnt(2)
v_max3_f32 v17, v12, v13, v14
v_smfmac_f32_16x16x64_bf16 v[36:39], v[64:67], a[144:151], v0
ds_read_b128 v[60:63], v2 offset:24576
v_add_f32_dpp v28, v30, v28 quad_perm:[2,3,0,1] row_mask:0xf bank_mask:0xf
v_add_f32_dpp v29, v31, v29 quad_perm:[2,3,0,1] row_mask:0xf bank_mask:0xf
v_max_f32 v17, v17, v15
v_max_f32 v16, v28, v29
v_mul_f32 v16, s50, v16
v_max_f32_dpp v17, v17, v17 quad_perm:[2,3,0,1] row_mask:0xf bank_mask:0xf
v_smfmac_f32_16x16x64_bf16 v[40:43], v[68:71], a[168:175], v0
ds_read_b128 v[64:67], v2 offset:25600
v_max_f32_dpp v18, v16, v17 quad_perm:[0,1,0,1] row_mask:0xf bank_mask:0xf
v_max_f32_dpp v19, v16, v17 quad_perm:[0,1,0,1] row_mask:0xf bank_mask:0xf
v_smfmac_f32_16x16x64_bf16 v[36:39], v[68:71], a[160:167], v0
ds_read_b128 v[68:71], v2 offset:22528
v_permlane16_swap_b32 v18, v19
v_max_f32 v20, v18, v19
v_max_f32 v21, v18, v19
s_waitcnt lgkmcnt(3)
v_smfmac_f32_16x16x64_bf16 v[36:39], v[72:75], v[44:51], v0
ds_read_b128 v[72:75], v2 offset:23552
v_permlane32_swap_b32 v20, v21
v_max_f32 v20, v20, v21
v_sub_f32 v12, v12, v20
v_sub_f32 v13, v13, v20
v_pk_add_f32 v[14:15], v[14:15], v[20:21] op_sel_hi:[1,0] neg_lo:[0,1] neg_hi:[0,1]
v_exp_f32 v12, v12
v_exp_f32 v13, v13
v_exp_f32 v14, v14
v_exp_f32 v15, v15
v_cvt_pk_bf16_f32 v16, v12, v13
v_cvt_pk_bf16_f32 v17, v14, v15
v_pk_fma_f32 v[28:29], v[28:29], s[50:51], v[20:21] op_sel_hi:[1,1,0] neg_lo:[0,0,1] neg_hi:[0,0,1]
v_mov_b32_dpp v18, v16 quad_perm:[2,3,0,1] row_mask:0xf bank_mask:0xf
v_mov_b32_dpp v19, v17 quad_perm:[2,3,0,1] row_mask:0xf bank_mask:0xf
v_exp_f32 v28, v28
s_waitcnt vmcnt(1)
v_mfma_f32_16x16x32_bf16 v[32:35], v[76:79], v[16:19], 0
v_exp_f32 v29, v29
v_mfma_f32_16x16x32_bf16 v[20:23], v[52:55], v[16:19], 0
v_cvt_pk_bf16_f32 v12, v28, v29
v_cvt_pk_bf16_f32 v13, v28, v29
v_mov_b64 v[14:15], s[0:1]
v_mfma_f32_16x16x32_bf16 v[24:27], v[56:59], v[16:19], 0
v_cvt_pk_bf16_f32 v36, v36, v37
v_cvt_pk_bf16_f32 v37, v38, v39
v_mfma_f32_16x16x16_bf16 v[32:35], v[14:15], v[12:13], v[32:35]
v_cvt_pk_bf16_f32 v38, v40, v41
v_cvt_pk_bf16_f32 v39, v42, v43
v_mfma_f32_16x16x16_bf16 v[20:23], v[36:37], v[12:13], v[20:23]
ds_read_b128 v[44:47], v2 offset:20480
v_mfma_f32_16x16x16_bf16 v[24:27], v[38:39], v[12:13], v[24:27]
ds_read_b128 v[48:51], v2 offset:21504
v_rcp_f32 v32, v32
v_mov_b64 v[28:29], 0
v_mov_b64 v[30:31], 0
v_pk_mul_f32 v[20:21], v[20:21], v[32:33] op_sel_hi:[1,0]
v_pk_mul_f32 v[22:23], v[22:23], v[32:33] op_sel_hi:[1,0]
v_cvt_pk_bf16_f32 v20, v20, v21
v_cvt_pk_bf16_f32 v21, v22, v23
ds_write_b64 v1, v[20:21] offset:5120
v_pk_mul_f32 v[24:25], v[24:25], v[32:33] op_sel_hi:[1,0]
v_pk_mul_f32 v[26:27], v[26:27], v[32:33] op_sel_hi:[1,0]
v_cvt_pk_bf16_f32 v24, v24, v25
v_cvt_pk_bf16_f32 v25, v26, v27
ds_write_b64 v1, v[24:25] offset:5128
v_mov_b64 v[76:77], 0
ds_read_b128 v[12:15], v7 offset:5120
v_mov_b64 v[78:79], 0
v_mov_b64 v[40:41], 0
v_mov_b64 v[42:43], 0
v_mov_b64 v[36:37], 0
v_mov_b64 v[38:39], 0
v_mov_b64 v[32:33], 0
v_mov_b64 v[34:35], 0
s_waitcnt lgkmcnt(1)
s_barrier
ds_read_b128 v[16:19], v7 offset:6144
ds_read_b128 v[52:55], v7 offset:7168
ds_read_b128 v[56:59], v7 offset:8192
s_waitcnt lgkmcnt(3)
v_smfmac_f32_16x16x64_bf16 v[28:31], v[12:15], v[44:51], v0 abid:1
v_smfmac_f32_16x16x64_bf16 v[76:79], v[12:15], v[60:67], v0 abid:1
ds_read_b128 v[44:47], v2 offset:26624
s_waitcnt lgkmcnt(3)
v_smfmac_f32_16x16x64_bf16 v[28:31], v[16:19], a[176:183], v0 abid:1
ds_read_b128 v[48:51], v2 offset:27648
s_waitcnt lgkmcnt(3)
v_smfmac_f32_16x16x64_bf16 v[28:31], v[52:55], v[68:75], v0 abid:1
ds_read_b128 v[60:63], v2 offset:28672
s_waitcnt lgkmcnt(3)
v_smfmac_f32_16x16x64_bf16 v[28:31], v[56:59], a[184:191], v0 abid:1
ds_read_b128 v[64:67], v2 offset:29696
v_smfmac_f32_16x16x64_bf16 v[76:79], v[16:19], a[192:199], v0 abid:1
ds_read_b128 v[68:71], v2 offset:30720
s_waitcnt lgkmcnt(3)
v_smfmac_f32_16x16x64_bf16 v[76:79], v[52:55], v[44:51], v0 abid:1
ds_read_b128 v[72:75], v2 offset:31744
v_cvt_pk_bf16_f32 v28, v28, v29
v_cvt_pk_bf16_f32 v29, v30, v31
v_bfi_b32 v28, 1, s35, v28
buffer_store_dwordx2 v[28:29], v8, s[4:7], s42 offen
v_smfmac_f32_16x16x64_bf16 v[76:79], v[56:59], a[200:207], v0 abid:1
ds_read_b128 v[44:47], v2 offset:32768
s_waitcnt lgkmcnt(3)
v_smfmac_f32_16x16x64_bf16 v[40:43], v[12:15], v[60:67], v0 abid:1
ds_read_b128 v[48:51], v2 offset:33792
v_smfmac_f32_16x16x64_bf16 v[40:43], v[16:19], a[208:215], v0 abid:1
ds_read_b128 v[60:63], v2 offset:36864
v_cvt_pk_bf16_f32 v76, v76, v77
v_cvt_pk_bf16_f32 v77, v78, v79
v_bfi_b32 v76, 1, s35, v76
buffer_store_dwordx2 v[76:77], v8, s[4:7], s43 offen
s_waitcnt lgkmcnt(3)
v_smfmac_f32_16x16x64_bf16 v[40:43], v[52:55], v[68:75], v0 abid:1
ds_read_b128 v[64:67], v2 offset:37888
v_smfmac_f32_16x16x64_bf16 v[40:43], v[56:59], a[216:223], v0 abid:1
ds_read_b128 v[68:71], v2 offset:34816
v_smfmac_f32_16x16x64_bf16 v[36:39], v[12:15], a[224:231], v0 abid:1
ds_read_b128 v[72:75], v2 offset:35840
v_smfmac_f32_16x16x64_bf16 v[36:39], v[16:19], a[232:239], v0 abid:1
v_cvt_pk_bf16_f32 v40, v40, v41
v_cvt_pk_bf16_f32 v41, v42, v43
v_bfi_b32 v40, 1, s35, v40
buffer_store_dwordx2 v[40:41], v8, s[4:7], s44 offen
v_smfmac_f32_16x16x64_bf16 v[36:39], v[52:55], a[240:247], v0 abid:1
v_smfmac_f32_16x16x64_bf16 v[36:39], v[56:59], a[248:255], v0 abid:1
s_waitcnt lgkmcnt(4)
v_smfmac_f32_16x16x64_bf16 v[32:35], v[12:15], v[44:51], v0 abid:1
ds_read_b128 v[44:47], v2 offset:38912
s_waitcnt lgkmcnt(3)
v_smfmac_f32_16x16x64_bf16 v[32:35], v[16:19], v[60:67], v0 abid:1
ds_read_b128 v[48:51], v2 offset:39936
v_cvt_pk_bf16_f32 v36, v36, v37
v_cvt_pk_bf16_f32 v37, v38, v39
v_bfi_b32 v36, 1, s35, v36
buffer_store_dwordx2 v[36:37], v8, s[4:7], s45 offen
s_waitcnt lgkmcnt(2)
v_smfmac_f32_16x16x64_bf16 v[32:35], v[52:55], v[68:75], v0 abid:1
s_waitcnt lgkmcnt(0)
v_smfmac_f32_16x16x64_bf16 v[32:35], v[56:59], v[44:51], v0 abid:1
s_nop 7
v_cvt_pk_bf16_f32 v32, v32, v33
v_cvt_pk_bf16_f32 v33, v34, v35
v_bfi_b32 v32, 1, s35, v32
buffer_store_dwordx2 v[32:33], v8, s[4:7], s46 offen
s_branch L_ex_w0f
L_done_w0f:
s_waitcnt vmcnt(0) lgkmcnt(0)
s_endpgm
L_rdv2_w0:
buffer_load_dword v32, v24, s[28:31], 0 offen sc0 sc1
s_sub_u32 s41, s41, 1
s_cbranch_scc1 L_exit
s_waitcnt vmcnt(0)
s_branch L_rdv_w0
L_ra0_w0f:
s_mov_b32 m0, 1024
s_nop 0
buffer_load_dwordx4 v1, s[4:7], s47 offen offset:0 sc1 lds
buffer_load_dwordx4 v1, s[4:7], s47 offen offset:1024 sc1 lds
buffer_load_dwordx4 v1, s[4:7], s47 offen offset:2048 sc1 lds
buffer_load_dwordx4 v1, s[4:7], s47 offen offset:3072 sc1 lds
s_sub_u32 s41, s41, 1
s_cbranch_scc1 L_exit
ds_read_b128 v[44:47], v2 offset:0
ds_read_b128 v[48:51], v2 offset:1024
v_mov_b64 v[20:21], 0
v_mov_b64 v[22:23], 0
v_mov_b64 v[24:25], 0
v_mov_b64 v[26:27], 0
v_mov_b64 v[28:29], 0
v_mov_b64 v[30:31], 0
v_mov_b64 v[32:33], 0
v_mov_b64 v[34:35], 0
v_mov_b64 v[36:37], 0
v_mov_b64 v[38:39], 0
v_mov_b64 v[40:41], 0
v_mov_b64 v[42:43], 0
s_waitcnt vmcnt(0)
ds_read_b128 v[60:63], v1 offset:1024
ds_read_b128 v[64:67], v1 offset:2048
ds_read_b128 v[68:71], v1 offset:3072
ds_read_b128 v[72:75], v1 offset:4096
s_branch L_s0_w0f
L_ra1_w0f:
s_waitcnt lgkmcnt(0)
s_barrier
s_mov_b32 m0, 5120
s_nop 0
buffer_load_dwordx4 v1, s[4:7], s48 offen offset:0 sc1 lds
s_mov_b32 m0, 9216
s_nop 0
buffer_load_dwordx4 v1, s[4:7], s49 offen offset:0 sc1 lds
s_sub_u32 s41, s41, 1
s_cbranch_scc1 L_exit
s_waitcnt vmcnt(0)
s_barrier
ds_read_b128 v[76:79], v1 offset:5120
ds_read_b128 v[60:63], v1 offset:6144
ds_read_b128 v[64:67], v1 offset:7168
ds_read_b128 v[68:71], v1 offset:8192
ds_read_b128 v[72:75], v1 offset:9216
s_waitcnt lgkmcnt(0)
v_bitop3_b32 v6, v76, v60, s35 bitop3:0x7e
v_bitop3_b32 v6, v6, v64, s35 bitop3:0xf6
v_bitop3_b32 v6, v6, v68, s35 bitop3:0xf6
v_bitop3_b32 v6, v6, v72, s35 bitop3:0xf6
v_and_b32 v6, 1, v6
v_cmp_ne_u32 vcc, 0, v6
v_lshlrev_b32 v6, 2, v1
s_cbranch_vccnz L_ra1_w0f
s_branch L_a1_w0f
L_ev_w0f:

L_kvw_w0f:
s_load_dwordx16 s[64:79], s[4:5], s101 glc
s_sub_u32 s41, s41, 1
s_cbranch_scc1 L_exit
s_waitcnt lgkmcnt(0)
s_min_u32 s64, s64, s65
s_min_u32 s64, s64, s66
s_min_u32 s64, s64, s67
s_min_u32 s64, s64, s68
s_min_u32 s64, s64, s69
s_min_u32 s64, s64, s70
s_min_u32 s64, s64, s71
s_min_u32 s64, s64, s72
s_min_u32 s64, s64, s73
s_min_u32 s64, s64, s74
s_min_u32 s64, s64, s75
s_min_u32 s64, s64, s76
s_min_u32 s64, s64, s77
s_min_u32 s64, s64, s78
s_min_u32 s64, s64, s79
s_lshl_b32 s100, s64, 2
s_sub_u32 s100, s100, 1
s_cmp_ge_i32 s34, s100
s_cbranch_scc1 L_kvw_w0f
s_branch L_evb_w0f
L_slow_w0:
v_mov_b64 v[20:21], 0
v_mov_b64 v[22:23], 0
v_mov_b64 v[24:25], 0
v_mov_b64 v[26:27], 0
v_mov_b64 v[28:29], 0
v_mov_b64 v[30:31], 0
v_mov_b64 v[32:33], 0
v_mov_b64 v[34:35], 0
v_mov_b64 v[36:37], 0
v_mov_b64 v[38:39], 0
v_mov_b64 v[40:41], 0
v_mov_b64 v[42:43], 0
ds_read_b128 v[44:47], v2 offset:0
ds_read_b128 v[48:51], v2 offset:1024
v_bfe_u32 v77, v1, 6, 1
v_lshl_add_u32 v77, v77, 3, v1
v_lshlrev_b32 v77, 1, v77
v_lshlrev_b32 v78, 2, v1
s_waitcnt vmcnt(0) lgkmcnt(0)
s_branch L_top_w0s
.p2align 6
L_ex_w0s:
s_add_u32 s34, s34, 1
s_add_u32 s37, s37, 524288
s_add_u32 s39, s39, 524288
s_mul_i32 s40, s34, 10240
s_add_u32 s40, s40, 8093696
s_not_b32 s35, s35
s_not_b32 s36, s36
v_mov_b64 v[20:21], 0
v_mov_b64 v[22:23], 0
v_mov_b64 v[24:25], 0
v_mov_b64 v[26:27], 0
v_mov_b64 v[28:29], 0
v_mov_b64 v[30:31], 0
v_mov_b64 v[32:33], 0
v_mov_b64 v[34:35], 0
v_mov_b64 v[36:37], 0
v_mov_b64 v[38:39], 0
v_mov_b64 v[40:41], 0
v_mov_b64 v[42:43], 0
s_cmp_eq_u32 s34, 63
s_cbranch_scc1 L_done_w0s
ds_read_b128 v[44:47], v2 offset:0
ds_read_b128 v[48:51], v2 offset:1024
v_bfe_u32 v77, v1, 6, 1
v_lshl_add_u32 v77, v77, 3, v1
v_lshlrev_b32 v77, 1, v77
v_lshlrev_b32 v78, 2, v1
s_barrier
s_cmp_ge_u32 s34, s100
s_cbranch_scc1 L_ev_w0s
L_evb_w0s:
L_top_w0s:
s_barrier
ds_read_b128 v[60:63], v1 offset:1024
ds_read_b128 v[64:67], v1 offset:2048
s_mov_b32 m0, 5120
s_nop 0
buffer_load_dwordx4 v1, s[4:7], s48 offen offset:0 sc0 sc1 lds
s_barrier
ds_read_b128 v[68:71], v1 offset:3072
ds_read_b128 v[72:75], v1 offset:4096
L_s0_w0s:
s_waitcnt lgkmcnt(3)
v_smfmac_f32_16x16x64_bf16 v[28:31], v[60:63], v[176:183], v0
v_smfmac_f32_16x16x64_bf16 v[32:35], v[60:63], v[184:191], v0
v_smfmac_f32_16x16x64_bf16 v[36:39], v[60:63], a[48:55], v0
v_smfmac_f32_16x16x64_bf16 v[40:43], v[60:63], a[56:63], v0
s_waitcnt lgkmcnt(2)
v_smfmac_f32_16x16x64_bf16 v[20:23], v[64:67], v[80:87], v0
v_smfmac_f32_16x16x64_bf16 v[20:23], v[60:63], v[44:51], v0
ds_read_b128 v[44:47], v2 offset:2048
buffer_load_dwordx4 v[12:15], v9, s[4:7], s37 offen offset:0
buffer_load_dwordx4 v[16:19], v9, s[4:7], s37 offen offset:1024
buffer_load_dwordx4 v[52:55], v1, s[4:7], s37 offen offset:2048
buffer_load_dwordx4 v[56:59], v1, s[4:7], s37 offen offset:3072
v_smfmac_f32_16x16x64_bf16 v[24:27], v[64:67], v[88:95], v0
ds_read_b128 v[48:51], v2 offset:3072
v_smfmac_f32_16x16x64_bf16 v[28:31], v[64:67], v[192:199], v0
s_waitcnt lgkmcnt(2)
v_bitop3_b32 v6, v60, v64, s35 bitop3:0x7e
v_smfmac_f32_16x16x64_bf16 v[32:35], v[64:67], v[200:207], v0
v_bitop3_b32 v76, v68, v72, s35 bitop3:0x7e
v_smfmac_f32_16x16x64_bf16 v[36:39], v[64:67], a[64:71], v0
v_bitop3_b32 v6, v6, v76, 1 bitop3:0xa8
s_waitcnt lgkmcnt(0)
v_smfmac_f32_16x16x64_bf16 v[24:27], v[60:63], v[44:51], v0
ds_read_b128 v[44:47], v2 offset:4096
v_cmp_ne_u32 vcc, 0, v6
v_smfmac_f32_16x16x64_bf16 v[40:43], v[64:67], a[72:79], v0
ds_read_b128 v[48:51], v2 offset:5120
v_smfmac_f32_16x16x64_bf16 v[20:23], v[68:71], v[96:103], v0
s_cbranch_vccnz L_ra0_w0s
v_smfmac_f32_16x16x64_bf16 v[24:27], v[68:71], v[104:111], v0
s_waitcnt vmcnt(4)
s_barrier
ds_read_b32 v6, v77 offset:8192
v_smfmac_f32_16x16x64_bf16 v[28:31], v[68:71], v[208:215], v0
ds_read_b128 v[60:63], v1 offset:6144
s_waitcnt lgkmcnt(2)
v_smfmac_f32_16x16x64_bf16 v[20:23], v[72:75], v[44:51], v0
ds_read_b128 v[64:67], v1 offset:7168
v_smfmac_f32_16x16x64_bf16 v[32:35], v[68:71], v[216:223], v0
ds_read_b128 v[76:79], v1 offset:5120
v_smfmac_f32_16x16x64_bf16 v[36:39], v[68:71], a[80:87], v0
ds_read_b128 v[44:47], v2 offset:6144
v_smfmac_f32_16x16x64_bf16 v[40:43], v[68:71], a[88:95], v0
ds_read_b128 v[48:51], v2 offset:7168
s_waitcnt lgkmcnt(4)
v_bitop3_b32 v6, v6, v60, s35 bitop3:0x7e
v_smfmac_f32_16x16x64_bf16 v[28:31], v[72:75], v[224:231], v0
ds_read_b128 v[68:71], v1 offset:8192
s_waitcnt lgkmcnt(4)
v_bitop3_b32 v6, v6, v64, s35 bitop3:0xf6
v_smfmac_f32_16x16x64_bf16 v[32:35], v[72:75], v[232:239], v0
s_waitcnt lgkmcnt(3)
v_bitop3_b32 v6, v6, v76, s35 bitop3:0xf6
v_and_b32 v6, 1, v6
v_smfmac_f32_16x16x64_bf16 v[36:39], v[72:75], a[96:103], v0
v_cmp_ne_u32 vcc, 0, v6
s_waitcnt lgkmcnt(1)
v_smfmac_f32_16x16x64_bf16 v[24:27], v[72:75], v[44:51], v0
ds_read_b128 v[44:47], v2 offset:8192
v_lshlrev_b32 v6, 2, v1
v_smfmac_f32_16x16x64_bf16 v[40:43], v[72:75], a[104:111], v0
ds_read_b128 v[72:75], v1 offset:9216
s_cbranch_vccnz L_ra1_w0s
L_a1_w0s:
s_mov_b32 m0, 0
s_nop 0
buffer_load_dword v6, s[4:7], s39 offen lds
v_smfmac_f32_16x16x64_bf16 v[20:23], v[60:63], v[112:119], v0
ds_read_b128 v[48:51], v2 offset:9216
v_smfmac_f32_16x16x64_bf16 v[20:23], v[64:67], v[128:135], v0
s_waitcnt lgkmcnt(3)
v_smfmac_f32_16x16x64_bf16 v[20:23], v[68:71], v[144:151], v0
s_waitcnt lgkmcnt(1)
v_smfmac_f32_16x16x64_bf16 v[20:23], v[72:75], v[160:167], v0
s_waitcnt lgkmcnt(0)
v_smfmac_f32_16x16x64_bf16 v[20:23], v[76:79], v[44:51], v0
ds_read_b128 v[44:47], v2 offset:10240
v_smfmac_f32_16x16x64_bf16 v[24:27], v[60:63], v[120:127], v0
ds_read_b128 v[48:51], v2 offset:11264
v_smfmac_f32_16x16x64_bf16 v[24:27], v[64:67], v[136:143], v0
v_add_f32 v20, v20, v22
v_smfmac_f32_16x16x64_bf16 v[24:27], v[68:71], v[152:159], v0
v_add_f32 v21, v21, v23
v_smfmac_f32_16x16x64_bf16 v[24:27], v[72:75], v[168:175], v0
v_cvt_pk_bf16_f32 v22, v20, v21
s_waitcnt lgkmcnt(0)
v_smfmac_f32_16x16x64_bf16 v[24:27], v[76:79], v[44:51], v0
ds_read_b128 v[44:47], v2 offset:12288
v_smfmac_f32_16x16x64_bf16 v[28:31], v[76:79], v[240:247], v0
ds_read_b128 v[48:51], v2 offset:13312
v_smfmac_f32_16x16x64_bf16 v[28:31], v[64:67], a[0:7], v0
v_add_f32 v24, v24, v26
v_add_f32 v25, v25, v27
v_cvt_pk_bf16_f32 v23, v24, v25
v_smfmac_f32_16x16x64_bf16 v[28:31], v[68:71], a[16:23], v0
ds_write_b64 v3, v[22:23] offset:10240
v_smfmac_f32_16x16x64_bf16 v[28:31], v[72:75], a[32:39], v0
s_waitcnt lgkmcnt(1)
v_smfmac_f32_16x16x64_bf16 v[28:31], v[60:63], v[44:51], v0
ds_read_b128 v[44:47], v2 offset:14336
v_smfmac_f32_16x16x64_bf16 v[32:35], v[76:79], v[248:255], v0
ds_read_b128 v[48:51], v2 offset:15360
s_waitcnt lgkmcnt(2)
s_barrier
v_smfmac_f32_16x16x64_bf16 v[32:35], v[64:67], a[8:15], v0
ds_read_b64_tr_b16 v[20:21], v4 offset:10240
ds_read_b64_tr_b16 v[22:23], v4 offset:10752
v_add_f32 v28, v28, v30
v_smfmac_f32_16x16x64_bf16 v[32:35], v[68:71], a[24:31], v0
ds_read_b64_tr_b16 v[24:25], v4 offset:11264
v_add_f32 v29, v29, v31
v_smfmac_f32_16x16x64_bf16 v[32:35], v[72:75], a[40:47], v0
ds_read_b64_tr_b16 v[26:27], v4 offset:11776
v_cvt_pk_bf16_f32 v30, v28, v29
s_waitcnt lgkmcnt(4)
v_smfmac_f32_16x16x64_bf16 v[32:35], v[60:63], v[44:51], v0
ds_read_b128 v[44:47], v2 offset:18432
s_waitcnt vmcnt(3)
s_waitcnt lgkmcnt(3)
v_mfma_f32_16x16x32_bf16 v[12:15], v[12:15], v[20:23], 0
ds_read_b128 v[48:51], v2 offset:19456
s_waitcnt lgkmcnt(2)
v_mfma_f32_16x16x32_bf16 v[12:15], v[16:19], v[24:27], v[12:15]
v_add_f32 v32, v32, v34
v_add_f32 v33, v33, v35
v_cvt_pk_bf16_f32 v31, v32, v33
ds_write_b64 v3, v[30:31] offset:12288
v_smfmac_f32_16x16x64_bf16 v[36:39], v[76:79], a[112:119], v0
s_nop 2
v_add_f32_dpp v12, v14, v12 quad_perm:[2,3,0,1] row_mask:0xf bank_mask:0xf
v_add_f32_dpp v13, v15, v13 quad_perm:[2,3,0,1] row_mask:0xf bank_mask:0xf
ds_write_b64 v5, v[12:13] offset:14336
v_smfmac_f32_16x16x64_bf16 v[40:43], v[76:79], a[120:127], v0
s_waitcnt lgkmcnt(1)
s_barrier
ds_read_b64_tr_b16 v[28:29], v4 offset:12288
v_smfmac_f32_16x16x64_bf16 v[36:39], v[60:63], a[128:135], v0
ds_read_b64_tr_b16 v[30:31], v4 offset:12800
ds_read_b64_tr_b16 v[32:33], v4 offset:13312
v_smfmac_f32_16x16x64_bf16 v[40:43], v[60:63], a[136:143], v0
ds_read_b64_tr_b16 v[34:35], v4 offset:13824
v_mov_b64 v[76:77], s[52:53]
s_waitcnt lgkmcnt(4)
s_barrier
ds_read_b128 v[12:15], v1 offset:14336
v_smfmac_f32_16x16x64_bf16 v[40:43], v[72:75], v[44:51], v0
ds_read_b128 v[44:47], v2 offset:16384
v_mov_b64 v[78:79], s[52:53]
s_waitcnt lgkmcnt(4)
v_mfma_f32_16x16x32_bf16 v[28:31], v[28:31], v[20:23], 0
ds_read_b128 v[48:51], v2 offset:17408
s_waitcnt lgkmcnt(3)
v_mfma_f32_16x16x32_bf16 v[28:31], v[32:35], v[24:27], v[28:31]
v_smfmac_f32_16x16x64_bf16 v[40:43], v[64:67], a[152:159], v0
s_waitcnt lgkmcnt(2)
v_max3_f32 v17, v12, v13, v14
v_smfmac_f32_16x16x64_bf16 v[36:39], v[64:67], a[144:151], v0
ds_read_b128 v[60:63], v2 offset:24576
v_add_f32_dpp v28, v30, v28 quad_perm:[2,3,0,1] row_mask:0xf bank_mask:0xf
v_add_f32_dpp v29, v31, v29 quad_perm:[2,3,0,1] row_mask:0xf bank_mask:0xf
v_max_f32 v17, v17, v15
v_max_f32 v16, v28, v29
v_mul_f32 v16, s50, v16
v_max_f32_dpp v17, v17, v17 quad_perm:[2,3,0,1] row_mask:0xf bank_mask:0xf
v_smfmac_f32_16x16x64_bf16 v[40:43], v[68:71], a[168:175], v0
ds_read_b128 v[64:67], v2 offset:25600
v_max_f32_dpp v18, v16, v17 quad_perm:[0,1,0,1] row_mask:0xf bank_mask:0xf
v_max_f32_dpp v19, v16, v17 quad_perm:[0,1,0,1] row_mask:0xf bank_mask:0xf
v_smfmac_f32_16x16x64_bf16 v[36:39], v[68:71], a[160:167], v0
ds_read_b128 v[68:71], v2 offset:22528
v_permlane16_swap_b32 v18, v19
v_max_f32 v20, v18, v19
v_max_f32 v21, v18, v19
s_waitcnt lgkmcnt(3)
v_smfmac_f32_16x16x64_bf16 v[36:39], v[72:75], v[44:51], v0
ds_read_b128 v[72:75], v2 offset:23552
v_permlane32_swap_b32 v20, v21
v_max_f32 v20, v20, v21
v_sub_f32 v12, v12, v20
v_sub_f32 v13, v13, v20
v_pk_add_f32 v[14:15], v[14:15], v[20:21] op_sel_hi:[1,0] neg_lo:[0,1] neg_hi:[0,1]
v_exp_f32 v12, v12
v_exp_f32 v13, v13
v_exp_f32 v14, v14
v_exp_f32 v15, v15
v_cvt_pk_bf16_f32 v16, v12, v13
v_cvt_pk_bf16_f32 v17, v14, v15
v_pk_fma_f32 v[28:29], v[28:29], s[50:51], v[20:21] op_sel_hi:[1,1,0] neg_lo:[0,0,1] neg_hi:[0,0,1]
v_mov_b32_dpp v18, v16 quad_perm:[2,3,0,1] row_mask:0xf bank_mask:0xf
v_mov_b32_dpp v19, v17 quad_perm:[2,3,0,1] row_mask:0xf bank_mask:0xf
v_exp_f32 v28, v28
s_waitcnt vmcnt(1)
v_mfma_f32_16x16x32_bf16 v[32:35], v[76:79], v[16:19], 0
v_exp_f32 v29, v29
v_mfma_f32_16x16x32_bf16 v[20:23], v[52:55], v[16:19], 0
v_cvt_pk_bf16_f32 v12, v28, v29
v_cvt_pk_bf16_f32 v13, v28, v29
v_mov_b64 v[14:15], s[0:1]
v_mfma_f32_16x16x32_bf16 v[24:27], v[56:59], v[16:19], 0
v_cvt_pk_bf16_f32 v36, v36, v37
v_cvt_pk_bf16_f32 v37, v38, v39
v_mfma_f32_16x16x16_bf16 v[32:35], v[14:15], v[12:13], v[32:35]
v_cvt_pk_bf16_f32 v38, v40, v41
v_cvt_pk_bf16_f32 v39, v42, v43
v_mfma_f32_16x16x16_bf16 v[20:23], v[36:37], v[12:13], v[20:23]
ds_read_b128 v[44:47], v2 offset:20480
v_mfma_f32_16x16x16_bf16 v[24:27], v[38:39], v[12:13], v[24:27]
ds_read_b128 v[48:51], v2 offset:21504
v_rcp_f32 v32, v32
v_mov_b64 v[28:29], 0
v_mov_b64 v[30:31], 0
v_pk_mul_f32 v[20:21], v[20:21], v[32:33] op_sel_hi:[1,0]
v_pk_mul_f32 v[22:23], v[22:23], v[32:33] op_sel_hi:[1,0]
v_cvt_pk_bf16_f32 v20, v20, v21
v_cvt_pk_bf16_f32 v21, v22, v23
ds_write_b64 v1, v[20:21] offset:5120
v_pk_mul_f32 v[24:25], v[24:25], v[32:33] op_sel_hi:[1,0]
v_pk_mul_f32 v[26:27], v[26:27], v[32:33] op_sel_hi:[1,0]
v_cvt_pk_bf16_f32 v24, v24, v25
v_cvt_pk_bf16_f32 v25, v26, v27
ds_write_b64 v1, v[24:25] offset:5128
v_mov_b64 v[76:77], 0
ds_read_b128 v[12:15], v7 offset:5120
v_mov_b64 v[78:79], 0
v_mov_b64 v[40:41], 0
v_mov_b64 v[42:43], 0
v_mov_b64 v[36:37], 0
v_mov_b64 v[38:39], 0
v_mov_b64 v[32:33], 0
v_mov_b64 v[34:35], 0
s_waitcnt lgkmcnt(1)
s_barrier
ds_read_b128 v[16:19], v7 offset:6144
ds_read_b128 v[52:55], v7 offset:7168
ds_read_b128 v[56:59], v7 offset:8192
s_waitcnt lgkmcnt(3)
v_smfmac_f32_16x16x64_bf16 v[28:31], v[12:15], v[44:51], v0 abid:1
v_smfmac_f32_16x16x64_bf16 v[76:79], v[12:15], v[60:67], v0 abid:1
ds_read_b128 v[44:47], v2 offset:26624
s_waitcnt lgkmcnt(3)
v_smfmac_f32_16x16x64_bf16 v[28:31], v[16:19], a[176:183], v0 abid:1
ds_read_b128 v[48:51], v2 offset:27648
s_waitcnt lgkmcnt(3)
v_smfmac_f32_16x16x64_bf16 v[28:31], v[52:55], v[68:75], v0 abid:1
ds_read_b128 v[60:63], v2 offset:28672
s_waitcnt lgkmcnt(3)
v_smfmac_f32_16x16x64_bf16 v[28:31], v[56:59], a[184:191], v0 abid:1
ds_read_b128 v[64:67], v2 offset:29696
v_smfmac_f32_16x16x64_bf16 v[76:79], v[16:19], a[192:199], v0 abid:1
ds_read_b128 v[68:71], v2 offset:30720
s_waitcnt lgkmcnt(3)
v_smfmac_f32_16x16x64_bf16 v[76:79], v[52:55], v[44:51], v0 abid:1
ds_read_b128 v[72:75], v2 offset:31744
v_cvt_pk_bf16_f32 v28, v28, v29
v_cvt_pk_bf16_f32 v29, v30, v31
v_bfi_b32 v28, 1, s35, v28
buffer_store_dwordx2 v[28:29], v8, s[4:7], s42 offen sc0 sc1
v_smfmac_f32_16x16x64_bf16 v[76:79], v[56:59], a[200:207], v0 abid:1
ds_read_b128 v[44:47], v2 offset:32768
s_waitcnt lgkmcnt(3)
v_smfmac_f32_16x16x64_bf16 v[40:43], v[12:15], v[60:67], v0 abid:1
ds_read_b128 v[48:51], v2 offset:33792
v_smfmac_f32_16x16x64_bf16 v[40:43], v[16:19], a[208:215], v0 abid:1
ds_read_b128 v[60:63], v2 offset:36864
v_cvt_pk_bf16_f32 v76, v76, v77
v_cvt_pk_bf16_f32 v77, v78, v79
v_bfi_b32 v76, 1, s35, v76
buffer_store_dwordx2 v[76:77], v8, s[4:7], s43 offen sc0 sc1
s_waitcnt lgkmcnt(3)
v_smfmac_f32_16x16x64_bf16 v[40:43], v[52:55], v[68:75], v0 abid:1
ds_read_b128 v[64:67], v2 offset:37888
v_smfmac_f32_16x16x64_bf16 v[40:43], v[56:59], a[216:223], v0 abid:1
ds_read_b128 v[68:71], v2 offset:34816
v_smfmac_f32_16x16x64_bf16 v[36:39], v[12:15], a[224:231], v0 abid:1
ds_read_b128 v[72:75], v2 offset:35840
v_smfmac_f32_16x16x64_bf16 v[36:39], v[16:19], a[232:239], v0 abid:1
v_cvt_pk_bf16_f32 v40, v40, v41
v_cvt_pk_bf16_f32 v41, v42, v43
v_bfi_b32 v40, 1, s35, v40
buffer_store_dwordx2 v[40:41], v8, s[4:7], s44 offen sc0 sc1
v_smfmac_f32_16x16x64_bf16 v[36:39], v[52:55], a[240:247], v0 abid:1
v_smfmac_f32_16x16x64_bf16 v[36:39], v[56:59], a[248:255], v0 abid:1
s_waitcnt lgkmcnt(4)
v_smfmac_f32_16x16x64_bf16 v[32:35], v[12:15], v[44:51], v0 abid:1
ds_read_b128 v[44:47], v2 offset:38912
s_waitcnt lgkmcnt(3)
v_smfmac_f32_16x16x64_bf16 v[32:35], v[16:19], v[60:67], v0 abid:1
ds_read_b128 v[48:51], v2 offset:39936
v_cvt_pk_bf16_f32 v36, v36, v37
v_cvt_pk_bf16_f32 v37, v38, v39
v_bfi_b32 v36, 1, s35, v36
buffer_store_dwordx2 v[36:37], v8, s[4:7], s45 offen sc0 sc1
s_waitcnt lgkmcnt(2)
v_smfmac_f32_16x16x64_bf16 v[32:35], v[52:55], v[68:75], v0 abid:1
s_waitcnt lgkmcnt(0)
v_smfmac_f32_16x16x64_bf16 v[32:35], v[56:59], v[44:51], v0 abid:1
s_nop 7
v_cvt_pk_bf16_f32 v32, v32, v33
v_cvt_pk_bf16_f32 v33, v34, v35
v_bfi_b32 v32, 1, s35, v32
buffer_store_dwordx2 v[32:33], v8, s[4:7], s46 offen sc0 sc1
s_branch L_ex_w0s
L_done_w0s:
s_waitcnt vmcnt(0) lgkmcnt(0)
s_endpgm
L_ra0_w0s:
s_mov_b32 m0, 1024
s_nop 0
buffer_load_dwordx4 v1, s[4:7], s47 offen offset:0 sc0 sc1 lds
buffer_load_dwordx4 v1, s[4:7], s47 offen offset:1024 sc0 sc1 lds
buffer_load_dwordx4 v1, s[4:7], s47 offen offset:2048 sc0 sc1 lds
buffer_load_dwordx4 v1, s[4:7], s47 offen offset:3072 sc0 sc1 lds
s_sub_u32 s41, s41, 1
s_cbranch_scc1 L_exit
ds_read_b128 v[44:47], v2 offset:0
ds_read_b128 v[48:51], v2 offset:1024
v_mov_b64 v[20:21], 0
v_mov_b64 v[22:23], 0
v_mov_b64 v[24:25], 0
v_mov_b64 v[26:27], 0
v_mov_b64 v[28:29], 0
v_mov_b64 v[30:31], 0
v_mov_b64 v[32:33], 0
v_mov_b64 v[34:35], 0
v_mov_b64 v[36:37], 0
v_mov_b64 v[38:39], 0
v_mov_b64 v[40:41], 0
v_mov_b64 v[42:43], 0
s_waitcnt vmcnt(0)
ds_read_b128 v[60:63], v1 offset:1024
ds_read_b128 v[64:67], v1 offset:2048
ds_read_b128 v[68:71], v1 offset:3072
ds_read_b128 v[72:75], v1 offset:4096
s_branch L_s0_w0s
L_ra1_w0s:
s_waitcnt lgkmcnt(0)
s_barrier
s_mov_b32 m0, 5120
s_nop 0
buffer_load_dwordx4 v1, s[4:7], s48 offen offset:0 sc0 sc1 lds
s_mov_b32 m0, 9216
s_nop 0
buffer_load_dwordx4 v1, s[4:7], s49 offen offset:0 sc0 sc1 lds
s_sub_u32 s41, s41, 1
s_cbranch_scc1 L_exit
s_waitcnt vmcnt(0)
s_barrier
ds_read_b128 v[76:79], v1 offset:5120
ds_read_b128 v[60:63], v1 offset:6144
ds_read_b128 v[64:67], v1 offset:7168
ds_read_b128 v[68:71], v1 offset:8192
ds_read_b128 v[72:75], v1 offset:9216
s_waitcnt lgkmcnt(0)
v_bitop3_b32 v6, v76, v60, s35 bitop3:0x7e
v_bitop3_b32 v6, v6, v64, s35 bitop3:0xf6
v_bitop3_b32 v6, v6, v68, s35 bitop3:0xf6
v_bitop3_b32 v6, v6, v72, s35 bitop3:0xf6
v_and_b32 v6, 1, v6
v_cmp_ne_u32 vcc, 0, v6
v_lshlrev_b32 v6, 2, v1
s_cbranch_vccnz L_ra1_w0s
s_branch L_a1_w0s
L_ev_w0s:

L_kvw_w0s:
s_load_dwordx16 s[64:79], s[4:5], s101 glc
s_sub_u32 s41, s41, 1
s_cbranch_scc1 L_exit
s_waitcnt lgkmcnt(0)
s_min_u32 s64, s64, s65
s_min_u32 s64, s64, s66
s_min_u32 s64, s64, s67
s_min_u32 s64, s64, s68
s_min_u32 s64, s64, s69
s_min_u32 s64, s64, s70
s_min_u32 s64, s64, s71
s_min_u32 s64, s64, s72
s_min_u32 s64, s64, s73
s_min_u32 s64, s64, s74
s_min_u32 s64, s64, s75
s_min_u32 s64, s64, s76
s_min_u32 s64, s64, s77
s_min_u32 s64, s64, s78
s_min_u32 s64, s64, s79
s_lshl_b32 s100, s64, 2
s_sub_u32 s100, s100, 1
s_cmp_ge_i32 s34, s100
s_cbranch_scc1 L_kvw_w0s
s_branch L_evb_w0s
L_pro_w1:
v_and_b32 v20, 63, v0
v_and_b32 v21, 15, v0
v_bfe_u32 v22, v0, 4, 2
v_lshlrev_b32 v1, 4, v20
v_add_u32 v2, 57344, v1
v_lshrrev_b32 v24, 1, v22
v_and_b32 v23, 1, v22
v_lshl_add_u32 v23, v24, 3, v23
v_lshlrev_b32 v23, 13, v23
v_lshlrev_b32 v26, 1, v22
v_xor_b32 v26, v26, v21
v_lshl_add_u32 v26, v26, 4, v23
v_xor_b32 v27, 128, v26
v_and_b32 v23, 1, v22
v_lshl_add_u32 v23, v24, 4, v23
v_mul_u32_u24 v23, 1152, v23
v_lshlrev_b32 v28, 2, v22
v_xor_b32 v28, v28, v21
v_lshl_add_u32 v28, v28, 4, v23
s_lshl_b32 s54, s32, 8
s_mul_i32 s55, s32, 147456
s_waitcnt lgkmcnt(0)
s_add_u32 s56, s54, 655360
s_mov_b32 m0, 77824
s_nop 0
buffer_load_dwordx4 v26, s[8:11], s56 offen lds
s_add_u32 s56, s54, 671744
s_mov_b32 m0, 78848
s_nop 0
buffer_load_dwordx4 v26, s[8:11], s56 offen lds
s_add_u32 s56, s54, 688128
s_mov_b32 m0, 79872
s_nop 0
buffer_load_dwordx4 v27, s[8:11], s56 offen lds
s_add_u32 s56, s54, 704512
s_mov_b32 m0, 80896
s_nop 0
buffer_load_dwordx4 v27, s[8:11], s56 offen lds
s_add_u32 s56, s54, 1179648
s_mov_b32 m0, 81920
s_nop 0
buffer_load_dwordx4 v26, s[8:11], s56 offen lds
s_add_u32 s56, s54, 1196032
s_mov_b32 m0, 82944
s_nop 0
buffer_load_dwordx4 v26, s[8:11], s56 offen lds
s_add_u32 s56, s54, 1212416
s_mov_b32 m0, 83968
s_nop 0
buffer_load_dwordx4 v27, s[8:11], s56 offen lds
s_add_u32 s56, s54, 1228800
s_mov_b32 m0, 84992
s_nop 0
buffer_load_dwordx4 v27, s[8:11], s56 offen lds
v_and_b32 v23, 1, v22
v_lshrrev_b32 v24, 2, v21
v_lshl_add_u32 v23, v23, 2, v24
v_lshlrev_b32 v23, 1, v23
v_bfe_u32 v44, v21, 1, 1
v_add_u32 v44, 4, v44
v_xor_b32 v44, v44, v23
v_lshlrev_b32 v44, 4, v44
v_lshl_add_u32 v44, v24, 8, v44
v_and_b32 v23, 1, v22
v_lshl_add_u32 v44, v23, 11, v44
v_and_b32 v23, 1, v21
v_lshl_add_u32 v44, v23, 3, v44
v_lshrrev_b32 v23, 1, v22
v_mul_u32_u24 v23, 40960, v23
v_add_u32 v23, 16384, v23
v_add_u32 v44, v44, v23
v_and_b32 v23, 1, v22
v_lshrrev_b32 v24, 2, v21
v_lshl_add_u32 v23, v23, 2, v24
v_lshlrev_b32 v23, 1, v23
v_bfe_u32 v45, v21, 1, 1
v_add_u32 v45, 6, v45
v_xor_b32 v45, v45, v23
v_lshlrev_b32 v45, 4, v45
v_lshl_add_u32 v45, v24, 8, v45
v_and_b32 v23, 1, v22
v_lshl_add_u32 v45, v23, 11, v45
v_and_b32 v23, 1, v21
v_lshl_add_u32 v45, v23, 3, v45
v_lshrrev_b32 v23, 1, v22
v_mul_u32_u24 v23, 40960, v23
v_add_u32 v23, 16384, v23
v_add_u32 v45, v45, v23
v_and_b32 v23, 1, v22
v_lshrrev_b32 v24, 2, v21
v_lshl_add_u32 v23, v23, 2, v24
v_lshlrev_b32 v23, 1, v23
v_bfe_u32 v46, v21, 1, 1
v_add_u32 v46, 4, v46
v_xor_b32 v46, v46, v23
v_lshlrev_b32 v46, 4, v46
v_lshl_add_u32 v46, v24, 8, v46
v_and_b32 v23, 1, v22
v_lshl_add_u32 v46, v23, 11, v46
v_and_b32 v23, 1, v21
v_lshl_add_u32 v46, v23, 3, v46
v_lshrrev_b32 v23, 1, v22
v_mul_u32_u24 v23, 32768, v23
v_add_u32 v23, 98304, v23
v_add_u32 v46, v46, v23
v_and_b32 v23, 1, v22
v_lshrrev_b32 v24, 2, v21
v_lshl_add_u32 v23, v23, 2, v24
v_lshlrev_b32 v23, 1, v23
v_bfe_u32 v47, v21, 1, 1
v_add_u32 v47, 6, v47
v_xor_b32 v47, v47, v23
v_lshlrev_b32 v47, 4, v47
v_lshl_add_u32 v47, v24, 8, v47
v_and_b32 v23, 1, v22
v_lshl_add_u32 v47, v23, 11, v47
v_and_b32 v23, 1, v21
v_lshl_add_u32 v47, v23, 3, v47
v_lshrrev_b32 v23, 1, v22
v_mul_u32_u24 v23, 32768, v23
v_add_u32 v23, 98304, v23
v_add_u32 v47, v47, v23
v_and_b32 v23, 1, v22
v_bfe_u32 v24, v21, 2, 1
v_lshl_add_u32 v23, v23, 1, v24
v_xor_b32 v24, 1, v23
v_lshlrev_b32 v24, 6, v24
v_lshl_add_u32 v48, v23, 8, v24
v_and_b32 v23, 3, v21
v_lshl_add_u32 v48, v23, 4, v48
v_and_b32 v23, 8, v21
v_add_u32 v48, v48, v23
v_lshrrev_b32 v23, 1, v22
v_mul_u32_u24 v23, 40960, v23
v_add_u32 v23, 16384, v23
v_add_u32 v48, v48, v23
v_and_b32 v23, 1, v22
v_bfe_u32 v24, v21, 2, 1
v_lshl_add_u32 v23, v23, 1, v24
v_xor_b32 v24, 1, v23
v_lshlrev_b32 v24, 6, v24
v_lshl_add_u32 v49, v23, 8, v24
v_and_b32 v23, 3, v21
v_lshl_add_u32 v49, v23, 4, v49
v_and_b32 v23, 8, v21
v_add_u32 v49, v49, v23
v_lshrrev_b32 v23, 1, v22
v_mul_u32_u24 v23, 32768, v23
v_add_u32 v23, 98304, v23
v_add_u32 v49, v49, v23
v_bfe_u32 v23, v21, 1, 1
v_and_b32 v24, 1, v21
v_lshl_add_u32 v23, v24, 16, v23
v_mul_u32_u24 v23, 0xaaaa, v23
v_add_u32 v0, 0x44444444, v23
v_lshlrev_b32 v3, 3, v20
v_lshrrev_b32 v25, 5, v20
v_lshlrev_b32 v25, 6, v25
v_xor_b32 v3, v3, v25
v_lshrrev_b32 v25, 2, v20
v_and_b32 v4, 3, v21
v_lshl_add_u32 v4, v4, 4, v25
v_lshlrev_b32 v4, 3, v4
v_bfe_u32 v25, v21, 1, 1
v_lshlrev_b32 v23, 6, v25
v_xor_b32 v4, v4, v23
v_and_b32 v23, 2, v22
v_xor_b32 v5, v21, v23
v_lshlrev_b32 v5, 4, v5
v_lshl_add_u32 v5, v25, 10, v5
v_and_b32 v23, 1, v22
v_lshl_add_u32 v5, v23, 3, v5
v_lshlrev_b32 v9, 8, v22
v_lshl_add_u32 v9, v25, 6, v9
v_bfe_u32 v23, v21, 3, 1
v_lshl_add_u32 v9, v23, 7, v9
v_bfe_u32 v23, v21, 2, 1
v_lshl_add_u32 v9, v23, 5, v9
v_and_b32 v23, 1, v21
v_lshl_add_u32 v9, v23, 4, v9
v_lshrrev_b32 v23, 1, v22
v_and_b32 v24, 1, v22
v_and_b32 v25, 7, v21
v_lshrrev_b32 v7, 3, v21
v_lshl_add_u32 v8, v7, 1, v23
v_lshlrev_b32 v8, 12, v8
v_lshl_add_u32 v8, v24, 7, v8
v_and_b32 v25, 4, v21
v_lshl_add_u32 v8, v25, 3, v8
v_and_b32 v25, 1, v21
v_lshl_add_u32 v8, v25, 4, v8
v_bfe_u32 v25, v21, 1, 1
v_lshl_add_u32 v8, v25, 3, v8
s_lshr_b32 s56, s32, 1
s_lshl_b32 s56, s56, 8
s_and_b32 s57, s32, 1
s_lshl_b32 s57, s57, 6
s_add_u32 s56, s56, s57
s_add_u32 s56, s56, 16384
v_add_u32 v8, s56, v8
v_and_b32 v7, 12, v21
v_bfe_u32 v25, v21, 1, 1
v_add_u32 v7, v7, v25
v_lshlrev_b32 v7, 4, v7
v_lshl_add_u32 v7, v22, 8, v7
s_mov_b32 s42, 0
s_mov_b32 s43, 65536
s_mov_b32 s44, 131072
s_mov_b32 s45, 196608
s_mov_b32 s46, 262144
s_mov_b32 s47, 294912
s_mov_b32 s48, 299008
s_mov_b32 s49, 303104
s_mov_b32 s50, 0x3e0293ee
s_mov_b32 s51, 0x3e0293ee
s_mov_b32 s52, 0x3f803f80
s_mov_b32 s53, 0x3f803f80
v_and_b32 v11, 3, v21
v_cmp_eq_u32 vcc, 0, v11
s_nop 1
v_cndmask_b32 v11, 0, 1, vcc
s_mov_b32 s34, 0
s_mov_b32 s35, -1
s_mov_b32 s36, 0
s_mov_b32 s41, 300000
s_lshl_b32 s37, s32, 14
s_add_u32 s39, s37, 17305600
s_add_u32 s37, s37, 16781312
s_mov_b32 s40, 8749056
v_mov_b64 v[36:37], 0
v_mov_b64 v[38:39], 0
s_lshl_b32 s56, s32, 1
s_add_u32 s56, s56, 0
s_cmp_eq_u32 s56, 0
s_cselect_b32 s56, 64, s56
s_mul_i32 s56, s56, 10240
s_add_u32 s56, s56, 8392704
s_add_u32 s57, s56, 4096
v_mov_b32 v40, 0
v_mov_b32 v41, 0
v_mov_b32 v42, 0
v_mov_b32 v43, 0
buffer_store_dwordx4 v[40:43], v1, s[4:7], s56 offen offset:0 sc0 sc1
buffer_store_dwordx4 v[40:43], v1, s[4:7], s56 offen offset:1024 sc0 sc1
buffer_store_dwordx4 v[40:43], v1, s[4:7], s56 offen offset:2048 sc0 sc1
buffer_store_dwordx4 v[40:43], v1, s[4:7], s56 offen offset:3072 sc0 sc1
buffer_store_dwordx4 v[40:43], v1, s[4:7], s57 offen offset:0 sc0 sc1
s_getreg_b32 s56, hwreg(HW_REG_XCC_ID)
s_and_b32 s56, s56, 15
s_mul_i32 s57, s56, s56
s_lshl_b32 s57, s57, 18
s_lshl_b32 s56, s56, 8
s_add_u32 s57, s57, s56
s_add_u32 s58, s57, 1
s_lshl_b32 s101, s32, 7
s_add_u32 s101, s101, 327680
v_mov_b32 v24, 0
s_add_u32 s56, s54, 2752512
s_mov_b32 m0, 86016
s_nop 0
buffer_load_dwordx4 v26, s[8:11], s56 offen lds
s_add_u32 s56, s54, 2768896
s_mov_b32 m0, 87040
s_nop 0
buffer_load_dwordx4 v26, s[8:11], s56 offen lds
s_add_u32 s56, s54, 2785280
s_mov_b32 m0, 88064
s_nop 0
buffer_load_dwordx4 v27, s[8:11], s56 offen lds
s_add_u32 s56, s54, 2801664
s_mov_b32 m0, 89088
s_nop 0
buffer_load_dwordx4 v27, s[8:11], s56 offen lds
s_add_u32 s56, s54, 3276800
s_mov_b32 m0, 57344
s_nop 0
buffer_load_dwordx4 v26, s[8:11], s56 offen lds
s_add_u32 s56, s54, 3293184
s_mov_b32 m0, 58368
s_nop 0
buffer_load_dwordx4 v26, s[8:11], s56 offen lds
s_add_u32 s56, s54, 3309568
s_mov_b32 m0, 59392
s_nop 0
buffer_load_dwordx4 v27, s[8:11], s56 offen lds
s_add_u32 s56, s54, 3325952
s_mov_b32 m0, 60416
s_nop 0
buffer_load_dwordx4 v27, s[8:11], s56 offen lds
s_add_u32 s56, s54, 3801088
s_mov_b32 m0, 61440
s_nop 0
buffer_load_dwordx4 v26, s[8:11], s56 offen lds
s_add_u32 s56, s54, 3817472
s_mov_b32 m0, 62464
s_nop 0
buffer_load_dwordx4 v26, s[8:11], s56 offen lds
s_add_u32 s56, s54, 3833856
s_mov_b32 m0, 63488
s_nop 0
buffer_load_dwordx4 v27, s[8:11], s56 offen lds
s_add_u32 s56, s54, 3850240
s_mov_b32 m0, 64512
s_nop 0
buffer_load_dwordx4 v27, s[8:11], s56 offen lds
s_add_u32 s56, s54, 4325376
s_mov_b32 m0, 65536
s_nop 0
buffer_load_dwordx4 v26, s[8:11], s56 offen lds
s_add_u32 s56, s54, 4341760
s_mov_b32 m0, 66560
s_nop 0
buffer_load_dwordx4 v26, s[8:11], s56 offen lds
s_add_u32 s56, s54, 4358144
s_mov_b32 m0, 67584
s_nop 0
buffer_load_dwordx4 v27, s[8:11], s56 offen lds
s_add_u32 s56, s54, 4374528
s_mov_b32 m0, 68608
s_nop 0
buffer_load_dwordx4 v27, s[8:11], s56 offen lds
s_add_u32 s56, s54, 131072
s_mov_b32 m0, 69632
s_nop 0
buffer_load_dwordx4 v26, s[12:15], s56 offen lds
s_add_u32 s56, s54, 147456
s_mov_b32 m0, 70656
s_nop 0
buffer_load_dwordx4 v26, s[12:15], s56 offen lds
s_add_u32 s56, s54, 163840
s_mov_b32 m0, 71680
s_nop 0
buffer_load_dwordx4 v27, s[12:15], s56 offen lds
s_add_u32 s56, s54, 180224
s_mov_b32 m0, 72704
s_nop 0
buffer_load_dwordx4 v27, s[12:15], s56 offen lds
s_add_u32 s56, s54, 655360
s_mov_b32 m0, 73728
s_nop 0
buffer_load_dwordx4 v26, s[12:15], s56 offen lds
s_add_u32 s56, s54, 671744
s_mov_b32 m0, 74752
s_nop 0
buffer_load_dwordx4 v26, s[12:15], s56 offen lds
s_add_u32 s56, s54, 688128
s_mov_b32 m0, 75776
s_nop 0
buffer_load_dwordx4 v27, s[12:15], s56 offen lds
s_add_u32 s56, s54, 704512
s_mov_b32 m0, 76800
s_nop 0
buffer_load_dwordx4 v27, s[12:15], s56 offen lds
v_and_b32 v23, 3, v20
v_lshrrev_b32 v24, 2, v20
v_mul_u32_u24 v29, 1152, v24
v_lshl_add_u32 v29, v23, 4, v29
v_lshrrev_b32 v24, 2, v21
v_and_b32 v25, 1, v22
v_lshlrev_b32 v31, 10, v25
v_lshrrev_b32 v25, 1, v22
v_lshl_add_u32 v31, v25, 8, v31
v_and_b32 v25, 1, v24
v_lshl_add_u32 v31, v25, 6, v31
v_lshrrev_b32 v25, 1, v24
v_lshl_add_u32 v31, v25, 3, v31
v_lshl_add_u32 v31, v23, 4, v31
v_add_u32 v31, 57344, v31
s_add_u32 s56, s55, 1088
s_mov_b32 m0, 90112
s_nop 0
buffer_load_dwordx4 v29, s[20:23], s56 offen lds
s_add_u32 s56, s55, 19520
s_mov_b32 m0, 91136
s_nop 0
buffer_load_dwordx4 v29, s[20:23], s56 offen lds
s_add_u32 s56, s55, 37952
s_mov_b32 m0, 94208
s_nop 0
buffer_load_dwordx4 v29, s[20:23], s56 offen lds
s_add_u32 s56, s55, 56384
s_mov_b32 m0, 95232
s_nop 0
buffer_load_dwordx4 v29, s[20:23], s56 offen lds
s_add_u32 s56, s55, 74816
s_mov_b32 m0, 92160
s_nop 0
buffer_load_dwordx4 v29, s[20:23], s56 offen lds
s_add_u32 s56, s55, 93248
s_mov_b32 m0, 93184
s_nop 0
buffer_load_dwordx4 v29, s[20:23], s56 offen lds
s_add_u32 s56, s55, 111680
s_mov_b32 m0, 96256
s_nop 0
buffer_load_dwordx4 v29, s[20:23], s56 offen lds
s_add_u32 s56, s55, 130112
s_mov_b32 m0, 97280
s_nop 0
buffer_load_dwordx4 v29, s[20:23], s56 offen lds
v_mov_b32 v24, 0
s_waitcnt vmcnt(41)
s_barrier
ds_read_b64_tr_b16 v[80:81], v44 offset:20480
ds_read_b64_tr_b16 v[82:83], v44 offset:21504
ds_read_b64_tr_b16 v[84:85], v46 offset:20480
ds_read_b64_tr_b16 v[86:87], v46 offset:21504
ds_read_b64_tr_b16 v[88:89], v45 offset:20480
ds_read_b64_tr_b16 v[90:91], v45 offset:21504
ds_read_b64_tr_b16 v[92:93], v47 offset:20480
ds_read_b64_tr_b16 v[94:95], v47 offset:21504
s_waitcnt lgkmcnt(0)
s_waitcnt vmcnt(37)
s_barrier
s_add_u32 s56, s54, 1179648
s_mov_b32 m0, 77824
s_nop 0
buffer_load_dwordx4 v26, s[12:15], s56 offen lds
s_add_u32 s56, s54, 1196032
s_mov_b32 m0, 78848
s_nop 0
buffer_load_dwordx4 v26, s[12:15], s56 offen lds
s_add_u32 s56, s54, 1212416
s_mov_b32 m0, 79872
s_nop 0
buffer_load_dwordx4 v27, s[12:15], s56 offen lds
s_add_u32 s56, s54, 1228800
s_mov_b32 m0, 80896
s_nop 0
buffer_load_dwordx4 v27, s[12:15], s56 offen lds
ds_read_b64_tr_b16 v[96:97], v44 offset:24576
ds_read_b64_tr_b16 v[98:99], v44 offset:25600
ds_read_b64_tr_b16 v[100:101], v46 offset:24576
ds_read_b64_tr_b16 v[102:103], v46 offset:25600
ds_read_b64_tr_b16 v[104:105], v45 offset:24576
ds_read_b64_tr_b16 v[106:107], v45 offset:25600
ds_read_b64_tr_b16 v[108:109], v47 offset:24576
ds_read_b64_tr_b16 v[110:111], v47 offset:25600
s_waitcnt lgkmcnt(0)
s_waitcnt vmcnt(32)
s_barrier
s_add_u32 s56, s54, 1703936
s_mov_b32 m0, 81920
s_nop 0
buffer_load_dwordx4 v26, s[12:15], s56 offen lds
s_add_u32 s56, s54, 1720320
s_mov_b32 m0, 82944
s_nop 0
buffer_load_dwordx4 v26, s[12:15], s56 offen lds
s_add_u32 s56, s54, 1736704
s_mov_b32 m0, 83968
s_nop 0
buffer_load_dwordx4 v27, s[12:15], s56 offen lds
s_add_u32 s56, s54, 1753088
s_mov_b32 m0, 84992
s_nop 0
buffer_load_dwordx4 v27, s[12:15], s56 offen lds
ds_read_b64_tr_b16 v[112:113], v44 offset:28672
ds_read_b64_tr_b16 v[114:115], v44 offset:29696
ds_read_b64_tr_b16 v[116:117], v46 offset:28672
ds_read_b64_tr_b16 v[118:119], v46 offset:29696
ds_read_b64_tr_b16 v[120:121], v45 offset:28672
ds_read_b64_tr_b16 v[122:123], v45 offset:29696
ds_read_b64_tr_b16 v[124:125], v47 offset:28672
ds_read_b64_tr_b16 v[126:127], v47 offset:29696
s_waitcnt lgkmcnt(0)
s_waitcnt vmcnt(32)
s_barrier
s_add_u32 s56, s54, 2228224
s_mov_b32 m0, 86016
s_nop 0
buffer_load_dwordx4 v26, s[12:15], s56 offen lds
s_add_u32 s56, s54, 2244608
s_mov_b32 m0, 87040
s_nop 0
buffer_load_dwordx4 v26, s[12:15], s56 offen lds
s_add_u32 s56, s54, 2260992
s_mov_b32 m0, 88064
s_nop 0
buffer_load_dwordx4 v27, s[12:15], s56 offen lds
s_add_u32 s56, s54, 2277376
s_mov_b32 m0, 89088
s_nop 0
buffer_load_dwordx4 v27, s[12:15], s56 offen lds
ds_read_b64_tr_b16 v[128:129], v44 offset:0
ds_read_b64_tr_b16 v[130:131], v44 offset:1024
ds_read_b64_tr_b16 v[132:133], v46 offset:0
ds_read_b64_tr_b16 v[134:135], v46 offset:1024
ds_read_b64_tr_b16 v[136:137], v45 offset:0
ds_read_b64_tr_b16 v[138:139], v45 offset:1024
ds_read_b64_tr_b16 v[140:141], v47 offset:0
ds_read_b64_tr_b16 v[142:143], v47 offset:1024
s_waitcnt lgkmcnt(0)
s_waitcnt vmcnt(32)
s_barrier
s_add_u32 s56, s54, 3276800
s_mov_b32 m0, 57344
s_nop 0
buffer_load_dwordx4 v26, s[12:15], s56 offen lds
s_add_u32 s56, s54, 3293184
s_mov_b32 m0, 58368
s_nop 0
buffer_load_dwordx4 v26, s[12:15], s56 offen lds
s_add_u32 s56, s54, 3309568
s_mov_b32 m0, 59392
s_nop 0
buffer_load_dwordx4 v27, s[12:15], s56 offen lds
s_add_u32 s56, s54, 3325952
s_mov_b32 m0, 60416
s_nop 0
buffer_load_dwordx4 v27, s[12:15], s56 offen lds
ds_read_b64_tr_b16 v[144:145], v44 offset:4096
ds_read_b64_tr_b16 v[146:147], v44 offset:5120
ds_read_b64_tr_b16 v[148:149], v46 offset:4096
ds_read_b64_tr_b16 v[150:151], v46 offset:5120
ds_read_b64_tr_b16 v[152:153], v45 offset:4096
ds_read_b64_tr_b16 v[154:155], v45 offset:5120
ds_read_b64_tr_b16 v[156:157], v47 offset:4096
ds_read_b64_tr_b16 v[158:159], v47 offset:5120
s_waitcnt lgkmcnt(0)
s_waitcnt vmcnt(32)
s_barrier
s_add_u32 s56, s54, 3801088
s_mov_b32 m0, 61440
s_nop 0
buffer_load_dwordx4 v26, s[12:15], s56 offen lds
s_add_u32 s56, s54, 3817472
s_mov_b32 m0, 62464
s_nop 0
buffer_load_dwordx4 v26, s[12:15], s56 offen lds
s_add_u32 s56, s54, 3833856
s_mov_b32 m0, 63488
s_nop 0
buffer_load_dwordx4 v27, s[12:15], s56 offen lds
s_add_u32 s56, s54, 3850240
s_mov_b32 m0, 64512
s_nop 0
buffer_load_dwordx4 v27, s[12:15], s56 offen lds
ds_read_b64_tr_b16 v[160:161], v44 offset:8192
ds_read_b64_tr_b16 v[162:163], v44 offset:9216
ds_read_b64_tr_b16 v[164:165], v46 offset:8192
ds_read_b64_tr_b16 v[166:167], v46 offset:9216
ds_read_b64_tr_b16 v[168:169], v45 offset:8192
ds_read_b64_tr_b16 v[170:171], v45 offset:9216
ds_read_b64_tr_b16 v[172:173], v47 offset:8192
ds_read_b64_tr_b16 v[174:175], v47 offset:9216
s_waitcnt lgkmcnt(0)
s_waitcnt vmcnt(32)
s_barrier
s_add_u32 s56, s54, 4325376
s_mov_b32 m0, 65536
s_nop 0
buffer_load_dwordx4 v26, s[12:15], s56 offen lds
s_add_u32 s56, s54, 4341760
s_mov_b32 m0, 66560
s_nop 0
buffer_load_dwordx4 v26, s[12:15], s56 offen lds
s_add_u32 s56, s54, 4358144
s_mov_b32 m0, 67584
s_nop 0
buffer_load_dwordx4 v27, s[12:15], s56 offen lds
s_add_u32 s56, s54, 4374528
s_mov_b32 m0, 68608
s_nop 0
buffer_load_dwordx4 v27, s[12:15], s56 offen lds
ds_read_b64_tr_b16 v[176:177], v44 offset:12288
ds_read_b64_tr_b16 v[178:179], v44 offset:13312
ds_read_b64_tr_b16 v[180:181], v46 offset:12288
ds_read_b64_tr_b16 v[182:183], v46 offset:13312
ds_read_b64_tr_b16 v[184:185], v45 offset:12288
ds_read_b64_tr_b16 v[186:187], v45 offset:13312
ds_read_b64_tr_b16 v[188:189], v47 offset:12288
ds_read_b64_tr_b16 v[190:191], v47 offset:13312
s_waitcnt lgkmcnt(0)
s_waitcnt vmcnt(32)
s_barrier
s_add_u32 s56, s54, 131072
s_mov_b32 m0, 69632
s_nop 0
buffer_load_dwordx4 v26, s[16:19], s56 offen lds
s_add_u32 s56, s54, 147456
s_mov_b32 m0, 70656
s_nop 0
buffer_load_dwordx4 v26, s[16:19], s56 offen lds
s_add_u32 s56, s54, 163840
s_mov_b32 m0, 71680
s_nop 0
buffer_load_dwordx4 v27, s[16:19], s56 offen lds
s_add_u32 s56, s54, 180224
s_mov_b32 m0, 72704
s_nop 0
buffer_load_dwordx4 v27, s[16:19], s56 offen lds
ds_read_b64_tr_b16 v[192:193], v44 offset:16384
ds_read_b64_tr_b16 v[194:195], v44 offset:17408
ds_read_b64_tr_b16 v[196:197], v46 offset:16384
ds_read_b64_tr_b16 v[198:199], v46 offset:17408
ds_read_b64_tr_b16 v[200:201], v45 offset:16384
ds_read_b64_tr_b16 v[202:203], v45 offset:17408
ds_read_b64_tr_b16 v[204:205], v47 offset:16384
ds_read_b64_tr_b16 v[206:207], v47 offset:17408
s_waitcnt lgkmcnt(0)
s_waitcnt vmcnt(24)
s_barrier
s_add_u32 s56, s54, 655360
s_mov_b32 m0, 73728
s_nop 0
buffer_load_dwordx4 v26, s[16:19], s56 offen lds
s_add_u32 s56, s54, 671744
s_mov_b32 m0, 74752
s_nop 0
buffer_load_dwordx4 v26, s[16:19], s56 offen lds
s_add_u32 s56, s54, 688128
s_mov_b32 m0, 75776
s_nop 0
buffer_load_dwordx4 v27, s[16:19], s56 offen lds
s_add_u32 s56, s54, 704512
s_mov_b32 m0, 76800
s_nop 0
buffer_load_dwordx4 v27, s[16:19], s56 offen lds
ds_read_b64_tr_b16 v[208:209], v44 offset:20480
ds_read_b64_tr_b16 v[210:211], v44 offset:21504
ds_read_b64_tr_b16 v[212:213], v46 offset:20480
ds_read_b64_tr_b16 v[214:215], v46 offset:21504
ds_read_b64_tr_b16 v[216:217], v45 offset:20480
ds_read_b64_tr_b16 v[218:219], v45 offset:21504
ds_read_b64_tr_b16 v[220:221], v47 offset:20480
ds_read_b64_tr_b16 v[222:223], v47 offset:21504
s_waitcnt lgkmcnt(0)
s_waitcnt vmcnt(24)
s_barrier
s_add_u32 s56, s54, 1179648
s_mov_b32 m0, 77824
s_nop 0
buffer_load_dwordx4 v26, s[16:19], s56 offen lds
s_add_u32 s56, s54, 1196032
s_mov_b32 m0, 78848
s_nop 0
buffer_load_dwordx4 v26, s[16:19], s56 offen lds
s_add_u32 s56, s54, 1212416
s_mov_b32 m0, 79872
s_nop 0
buffer_load_dwordx4 v27, s[16:19], s56 offen lds
s_add_u32 s56, s54, 1228800
s_mov_b32 m0, 80896
s_nop 0
buffer_load_dwordx4 v27, s[16:19], s56 offen lds
ds_read_b64_tr_b16 v[224:225], v44 offset:24576
ds_read_b64_tr_b16 v[226:227], v44 offset:25600
ds_read_b64_tr_b16 v[228:229], v46 offset:24576
ds_read_b64_tr_b16 v[230:231], v46 offset:25600
ds_read_b64_tr_b16 v[232:233], v45 offset:24576
ds_read_b64_tr_b16 v[234:235], v45 offset:25600
ds_read_b64_tr_b16 v[236:237], v47 offset:24576
ds_read_b64_tr_b16 v[238:239], v47 offset:25600
ds_read_b64_tr_b16 v[60:61], v31 offset:32768
ds_read_b64_tr_b16 v[62:63], v31 offset:32896
ds_read_b64_tr_b16 v[64:65], v31 offset:33280
ds_read_b64_tr_b16 v[66:67], v31 offset:33408
ds_read_b64_tr_b16 v[68:69], v31 offset:34816
ds_read_b64_tr_b16 v[70:71], v31 offset:34944
ds_read_b64_tr_b16 v[72:73], v31 offset:35328
ds_read_b64_tr_b16 v[74:75], v31 offset:35456
s_waitcnt lgkmcnt(0)
ds_write_b128 v2, v[60:63] offset:32768
ds_write_b128 v2, v[64:67] offset:33792
ds_write_b128 v2, v[68:71] offset:34816
ds_write_b128 v2, v[72:75] offset:35840
s_waitcnt lgkmcnt(0)
s_waitcnt vmcnt(24)
s_barrier
s_add_u32 s56, s54, 1703936
s_mov_b32 m0, 81920
s_nop 0
buffer_load_dwordx4 v26, s[16:19], s56 offen lds
s_add_u32 s56, s54, 1720320
s_mov_b32 m0, 82944
s_nop 0
buffer_load_dwordx4 v26, s[16:19], s56 offen lds
s_add_u32 s56, s54, 1736704
s_mov_b32 m0, 83968
s_nop 0
buffer_load_dwordx4 v27, s[16:19], s56 offen lds
s_add_u32 s56, s54, 1753088
s_mov_b32 m0, 84992
s_nop 0
buffer_load_dwordx4 v27, s[16:19], s56 offen lds
ds_read_b64_tr_b16 v[240:241], v44 offset:28672
ds_read_b64_tr_b16 v[242:243], v44 offset:29696
ds_read_b64_tr_b16 v[244:245], v46 offset:28672
ds_read_b64_tr_b16 v[246:247], v46 offset:29696
ds_read_b64_tr_b16 v[248:249], v45 offset:28672
ds_read_b64_tr_b16 v[250:251], v45 offset:29696
ds_read_b64_tr_b16 v[252:253], v47 offset:28672
ds_read_b64_tr_b16 v[254:255], v47 offset:29696
ds_read_b64_tr_b16 v[60:61], v31 offset:36864
ds_read_b64_tr_b16 v[62:63], v31 offset:36992
ds_read_b64_tr_b16 v[64:65], v31 offset:37376
ds_read_b64_tr_b16 v[66:67], v31 offset:37504
ds_read_b64_tr_b16 v[68:69], v31 offset:38912
ds_read_b64_tr_b16 v[70:71], v31 offset:39040
ds_read_b64_tr_b16 v[72:73], v31 offset:39424
ds_read_b64_tr_b16 v[74:75], v31 offset:39552
s_waitcnt lgkmcnt(0)
ds_write_b128 v2, v[60:63] offset:36864
ds_write_b128 v2, v[64:67] offset:37888
ds_write_b128 v2, v[68:71] offset:38912
ds_write_b128 v2, v[72:75] offset:39936
s_waitcnt lgkmcnt(0)
s_waitcnt vmcnt(24)
s_barrier
s_add_u32 s56, s54, 2228224
s_mov_b32 m0, 86016
s_nop 0
buffer_load_dwordx4 v26, s[16:19], s56 offen lds
s_add_u32 s56, s54, 2244608
s_mov_b32 m0, 87040
s_nop 0
buffer_load_dwordx4 v26, s[16:19], s56 offen lds
s_add_u32 s56, s54, 2260992
s_mov_b32 m0, 88064
s_nop 0
buffer_load_dwordx4 v27, s[16:19], s56 offen lds
s_add_u32 s56, s54, 2277376
s_mov_b32 m0, 89088
s_nop 0
buffer_load_dwordx4 v27, s[16:19], s56 offen lds
ds_read_b64_tr_b16 a[0:1], v44 offset:0
ds_read_b64_tr_b16 a[2:3], v44 offset:1024
ds_read_b64_tr_b16 a[4:5], v46 offset:0
ds_read_b64_tr_b16 a[6:7], v46 offset:1024
ds_read_b64_tr_b16 a[8:9], v45 offset:0
ds_read_b64_tr_b16 a[10:11], v45 offset:1024
ds_read_b64_tr_b16 a[12:13], v47 offset:0
ds_read_b64_tr_b16 a[14:15], v47 offset:1024
s_waitcnt lgkmcnt(0)
s_waitcnt vmcnt(24)
s_barrier
s_add_u32 s56, s54, 2752512
s_mov_b32 m0, 57344
s_nop 0
buffer_load_dwordx4 v26, s[16:19], s56 offen lds
s_add_u32 s56, s54, 2768896
s_mov_b32 m0, 58368
s_nop 0
buffer_load_dwordx4 v26, s[16:19], s56 offen lds
s_add_u32 s56, s54, 2785280
s_mov_b32 m0, 59392
s_nop 0
buffer_load_dwordx4 v27, s[16:19], s56 offen lds
s_add_u32 s56, s54, 2801664
s_mov_b32 m0, 60416
s_nop 0
buffer_load_dwordx4 v27, s[16:19], s56 offen lds
ds_read_b64_tr_b16 a[16:17], v44 offset:4096
ds_read_b64_tr_b16 a[18:19], v44 offset:5120
ds_read_b64_tr_b16 a[20:21], v46 offset:4096
ds_read_b64_tr_b16 a[22:23], v46 offset:5120
ds_read_b64_tr_b16 a[24:25], v45 offset:4096
ds_read_b64_tr_b16 a[26:27], v45 offset:5120
ds_read_b64_tr_b16 a[28:29], v47 offset:4096
ds_read_b64_tr_b16 a[30:31], v47 offset:5120
s_waitcnt lgkmcnt(0)
s_waitcnt vmcnt(24)
s_barrier
s_add_u32 s56, s54, 3276800
s_mov_b32 m0, 61440
s_nop 0
buffer_load_dwordx4 v26, s[16:19], s56 offen lds
s_add_u32 s56, s54, 3293184
s_mov_b32 m0, 62464
s_nop 0
buffer_load_dwordx4 v26, s[16:19], s56 offen lds
s_add_u32 s56, s54, 3309568
s_mov_b32 m0, 63488
s_nop 0
buffer_load_dwordx4 v27, s[16:19], s56 offen lds
s_add_u32 s56, s54, 3325952
s_mov_b32 m0, 64512
s_nop 0
buffer_load_dwordx4 v27, s[16:19], s56 offen lds
ds_read_b64_tr_b16 a[32:33], v44 offset:8192
ds_read_b64_tr_b16 a[34:35], v44 offset:9216
ds_read_b64_tr_b16 a[36:37], v46 offset:8192
ds_read_b64_tr_b16 a[38:39], v46 offset:9216
ds_read_b64_tr_b16 a[40:41], v45 offset:8192
ds_read_b64_tr_b16 a[42:43], v45 offset:9216
ds_read_b64_tr_b16 a[44:45], v47 offset:8192
ds_read_b64_tr_b16 a[46:47], v47 offset:9216
s_waitcnt lgkmcnt(0)
s_waitcnt vmcnt(24)
s_barrier
s_add_u32 s56, s54, 3801088
s_mov_b32 m0, 65536
s_nop 0
buffer_load_dwordx4 v26, s[16:19], s56 offen lds
s_add_u32 s56, s54, 3817472
s_mov_b32 m0, 66560
s_nop 0
buffer_load_dwordx4 v26, s[16:19], s56 offen lds
s_add_u32 s56, s54, 3833856
s_mov_b32 m0, 67584
s_nop 0
buffer_load_dwordx4 v27, s[16:19], s56 offen lds
s_add_u32 s56, s54, 3850240
s_mov_b32 m0, 68608
s_nop 0
buffer_load_dwordx4 v27, s[16:19], s56 offen lds
ds_read_b64_tr_b16 a[48:49], v44 offset:12288
ds_read_b64_tr_b16 a[50:51], v44 offset:13312
ds_read_b64_tr_b16 a[52:53], v46 offset:12288
ds_read_b64_tr_b16 a[54:55], v46 offset:13312
ds_read_b64_tr_b16 a[56:57], v45 offset:12288
ds_read_b64_tr_b16 a[58:59], v45 offset:13312
ds_read_b64_tr_b16 a[60:61], v47 offset:12288
ds_read_b64_tr_b16 a[62:63], v47 offset:13312
s_waitcnt lgkmcnt(0)
s_waitcnt vmcnt(24)
s_barrier
s_add_u32 s56, s55, 41472
s_mov_b32 m0, 69632
s_nop 0
buffer_load_dwordx4 v28, s[20:23], s56 offen lds
s_add_u32 s56, s55, 43776
s_mov_b32 m0, 70656
s_nop 0
buffer_load_dwordx4 v28, s[20:23], s56 offen lds
s_add_u32 s56, s55, 50688
s_mov_b32 m0, 71680
s_nop 0
buffer_load_dwordx4 v28, s[20:23], s56 offen lds
s_add_u32 s56, s55, 52992
s_mov_b32 m0, 72704
s_nop 0
buffer_load_dwordx4 v28, s[20:23], s56 offen lds
ds_read_b64_tr_b16 a[64:65], v44 offset:16384
ds_read_b64_tr_b16 a[66:67], v44 offset:17408
ds_read_b64_tr_b16 a[68:69], v46 offset:16384
ds_read_b64_tr_b16 a[70:71], v46 offset:17408
ds_read_b64_tr_b16 a[72:73], v45 offset:16384
ds_read_b64_tr_b16 a[74:75], v45 offset:17408
ds_read_b64_tr_b16 a[76:77], v47 offset:16384
ds_read_b64_tr_b16 a[78:79], v47 offset:17408
s_waitcnt lgkmcnt(0)
s_waitcnt vmcnt(24)
s_barrier
s_add_u32 s56, s55, 41728
s_mov_b32 m0, 73728
s_nop 0
buffer_load_dwordx4 v28, s[20:23], s56 offen lds
s_add_u32 s56, s55, 44032
s_mov_b32 m0, 74752
s_nop 0
buffer_load_dwordx4 v28, s[20:23], s56 offen lds
s_add_u32 s56, s55, 50944
s_mov_b32 m0, 75776
s_nop 0
buffer_load_dwordx4 v28, s[20:23], s56 offen lds
s_add_u32 s56, s55, 53248
s_mov_b32 m0, 76800
s_nop 0
buffer_load_dwordx4 v28, s[20:23], s56 offen lds
ds_read_b64_tr_b16 a[80:81], v44 offset:20480
ds_read_b64_tr_b16 a[82:83], v44 offset:21504
ds_read_b64_tr_b16 a[84:85], v46 offset:20480
ds_read_b64_tr_b16 a[86:87], v46 offset:21504
ds_read_b64_tr_b16 a[88:89], v45 offset:20480
ds_read_b64_tr_b16 a[90:91], v45 offset:21504
ds_read_b64_tr_b16 a[92:93], v47 offset:20480
ds_read_b64_tr_b16 a[94:95], v47 offset:21504
s_waitcnt lgkmcnt(0)
s_waitcnt vmcnt(24)
s_barrier
s_add_u32 s56, s55, 41984
s_mov_b32 m0, 77824
s_nop 0
buffer_load_dwordx4 v28, s[20:23], s56 offen lds
s_add_u32 s56, s55, 44288
s_mov_b32 m0, 78848
s_nop 0
buffer_load_dwordx4 v28, s[20:23], s56 offen lds
s_add_u32 s56, s55, 51200
s_mov_b32 m0, 79872
s_nop 0
buffer_load_dwordx4 v28, s[20:23], s56 offen lds
s_add_u32 s56, s55, 53504
s_mov_b32 m0, 80896
s_nop 0
buffer_load_dwordx4 v28, s[20:23], s56 offen lds
ds_read_b64_tr_b16 a[96:97], v44 offset:24576
ds_read_b64_tr_b16 a[98:99], v44 offset:25600
ds_read_b64_tr_b16 a[100:101], v46 offset:24576
ds_read_b64_tr_b16 a[102:103], v46 offset:25600
ds_read_b64_tr_b16 a[104:105], v45 offset:24576
ds_read_b64_tr_b16 a[106:107], v45 offset:25600
ds_read_b64_tr_b16 a[108:109], v47 offset:24576
ds_read_b64_tr_b16 a[110:111], v47 offset:25600
s_waitcnt lgkmcnt(0)
s_waitcnt vmcnt(24)
s_barrier
s_add_u32 s56, s55, 42240
s_mov_b32 m0, 81920
s_nop 0
buffer_load_dwordx4 v28, s[20:23], s56 offen lds
s_add_u32 s56, s55, 44544
s_mov_b32 m0, 82944
s_nop 0
buffer_load_dwordx4 v28, s[20:23], s56 offen lds
s_add_u32 s56, s55, 51456
s_mov_b32 m0, 83968
s_nop 0
buffer_load_dwordx4 v28, s[20:23], s56 offen lds
s_add_u32 s56, s55, 53760
s_mov_b32 m0, 84992
s_nop 0
buffer_load_dwordx4 v28, s[20:23], s56 offen lds
ds_read_b64_tr_b16 a[112:113], v44 offset:28672
ds_read_b64_tr_b16 a[114:115], v44 offset:29696
ds_read_b64_tr_b16 a[116:117], v46 offset:28672
ds_read_b64_tr_b16 a[118:119], v46 offset:29696
ds_read_b64_tr_b16 a[120:121], v45 offset:28672
ds_read_b64_tr_b16 a[122:123], v45 offset:29696
ds_read_b64_tr_b16 a[124:125], v47 offset:28672
ds_read_b64_tr_b16 a[126:127], v47 offset:29696
s_waitcnt lgkmcnt(0)
s_waitcnt vmcnt(24)
s_barrier
s_add_u32 s56, s55, 5376
s_mov_b32 m0, 86016
s_nop 0
buffer_load_dwordx4 v28, s[20:23], s56 offen lds
s_add_u32 s56, s55, 7680
s_mov_b32 m0, 87040
s_nop 0
buffer_load_dwordx4 v28, s[20:23], s56 offen lds
s_add_u32 s56, s55, 14592
s_mov_b32 m0, 88064
s_nop 0
buffer_load_dwordx4 v28, s[20:23], s56 offen lds
s_add_u32 s56, s55, 16896
s_mov_b32 m0, 89088
s_nop 0
buffer_load_dwordx4 v28, s[20:23], s56 offen lds
ds_read_b64_tr_b16 a[128:129], v44 offset:0
ds_read_b64_tr_b16 a[130:131], v44 offset:1024
ds_read_b64_tr_b16 a[132:133], v46 offset:0
ds_read_b64_tr_b16 a[134:135], v46 offset:1024
ds_read_b64_tr_b16 a[136:137], v45 offset:0
ds_read_b64_tr_b16 a[138:139], v45 offset:1024
ds_read_b64_tr_b16 a[140:141], v47 offset:0
ds_read_b64_tr_b16 a[142:143], v47 offset:1024
buffer_load_dword v32, v24, s[28:31], 0 offen sc0 sc1
s_waitcnt lgkmcnt(0)
s_waitcnt vmcnt(25)
s_barrier
s_add_u32 s56, s54, 131072
s_mov_b32 m0, 57344
s_nop 0
buffer_load_dwordx4 v26, s[8:11], s56 offen lds
s_add_u32 s56, s54, 147456
s_mov_b32 m0, 58368
s_nop 0
buffer_load_dwordx4 v26, s[8:11], s56 offen lds
s_add_u32 s56, s54, 163840
s_mov_b32 m0, 59392
s_nop 0
buffer_load_dwordx4 v27, s[8:11], s56 offen lds
s_add_u32 s56, s54, 180224
s_mov_b32 m0, 60416
s_nop 0
buffer_load_dwordx4 v27, s[8:11], s56 offen lds
ds_read_b64_tr_b16 a[144:145], v44 offset:4096
ds_read_b64_tr_b16 a[146:147], v44 offset:5120
ds_read_b64_tr_b16 a[148:149], v46 offset:4096
ds_read_b64_tr_b16 a[150:151], v46 offset:5120
ds_read_b64_tr_b16 a[152:153], v45 offset:4096
ds_read_b64_tr_b16 a[154:155], v45 offset:5120
ds_read_b64_tr_b16 a[156:157], v47 offset:4096
ds_read_b64_tr_b16 a[158:159], v47 offset:5120
s_waitcnt lgkmcnt(0)
s_waitcnt vmcnt(25)
s_barrier
s_add_u32 s56, s54, 1703936
s_mov_b32 m0, 61440
s_nop 0
buffer_load_dwordx4 v26, s[8:11], s56 offen lds
s_add_u32 s56, s54, 1720320
s_mov_b32 m0, 62464
s_nop 0
buffer_load_dwordx4 v26, s[8:11], s56 offen lds
s_add_u32 s56, s54, 1736704
s_mov_b32 m0, 63488
s_nop 0
buffer_load_dwordx4 v27, s[8:11], s56 offen lds
s_add_u32 s56, s54, 1753088
s_mov_b32 m0, 64512
s_nop 0
buffer_load_dwordx4 v27, s[8:11], s56 offen lds
ds_read_b64_tr_b16 a[160:161], v44 offset:8192
ds_read_b64_tr_b16 a[162:163], v44 offset:9216
ds_read_b64_tr_b16 a[164:165], v46 offset:8192
ds_read_b64_tr_b16 a[166:167], v46 offset:9216
ds_read_b64_tr_b16 a[168:169], v45 offset:8192
ds_read_b64_tr_b16 a[170:171], v45 offset:9216
ds_read_b64_tr_b16 a[172:173], v47 offset:8192
ds_read_b64_tr_b16 a[174:175], v47 offset:9216
s_waitcnt lgkmcnt(0)
s_waitcnt vmcnt(25)
s_barrier
s_add_u32 s56, s54, 2228224
s_mov_b32 m0, 65536
s_nop 0
buffer_load_dwordx4 v26, s[8:11], s56 offen lds
s_add_u32 s56, s54, 2244608
s_mov_b32 m0, 66560
s_nop 0
buffer_load_dwordx4 v26, s[8:11], s56 offen lds
s_add_u32 s56, s54, 2260992
s_mov_b32 m0, 67584
s_nop 0
buffer_load_dwordx4 v27, s[8:11], s56 offen lds
s_add_u32 s56, s54, 2277376
s_mov_b32 m0, 68608
s_nop 0
buffer_load_dwordx4 v27, s[8:11], s56 offen lds
ds_read_b64_tr_b16 a[176:177], v48 offset:12288
ds_read_b64_tr_b16 a[178:179], v48 offset:13312
ds_read_b64_tr_b16 a[180:181], v48 offset:14336
ds_read_b64_tr_b16 a[182:183], v48 offset:15360
ds_read_b64_tr_b16 a[192:193], v49 offset:12288
ds_read_b64_tr_b16 a[194:195], v49 offset:13312
ds_read_b64_tr_b16 a[196:197], v49 offset:14336
ds_read_b64_tr_b16 a[198:199], v49 offset:15360
s_waitcnt lgkmcnt(0)
s_waitcnt vmcnt(25)
s_barrier
s_add_u32 s56, s54, 2752512
s_mov_b32 m0, 69632
s_nop 0
buffer_load_dwordx4 v26, s[12:15], s56 offen lds
s_add_u32 s56, s54, 2768896
s_mov_b32 m0, 70656
s_nop 0
buffer_load_dwordx4 v26, s[12:15], s56 offen lds
s_add_u32 s56, s54, 2785280
s_mov_b32 m0, 71680
s_nop 0
buffer_load_dwordx4 v27, s[12:15], s56 offen lds
s_add_u32 s56, s54, 2801664
s_mov_b32 m0, 72704
s_nop 0
buffer_load_dwordx4 v27, s[12:15], s56 offen lds
ds_read_b64_tr_b16 a[184:185], v48 offset:16384
ds_read_b64_tr_b16 a[186:187], v48 offset:17408
ds_read_b64_tr_b16 a[188:189], v48 offset:18432
ds_read_b64_tr_b16 a[190:191], v48 offset:19456
ds_read_b64_tr_b16 a[200:201], v49 offset:16384
ds_read_b64_tr_b16 a[202:203], v49 offset:17408
ds_read_b64_tr_b16 a[204:205], v49 offset:18432
ds_read_b64_tr_b16 a[206:207], v49 offset:19456
s_waitcnt lgkmcnt(0)
s_waitcnt vmcnt(25)
s_barrier
s_add_u32 s56, s54, 4325376
s_mov_b32 m0, 73728
s_nop 0
buffer_load_dwordx4 v26, s[16:19], s56 offen lds
s_add_u32 s56, s54, 4341760
s_mov_b32 m0, 74752
s_nop 0
buffer_load_dwordx4 v26, s[16:19], s56 offen lds
s_add_u32 s56, s54, 4358144
s_mov_b32 m0, 75776
s_nop 0
buffer_load_dwordx4 v27, s[16:19], s56 offen lds
s_add_u32 s56, s54, 4374528
s_mov_b32 m0, 76800
s_nop 0
buffer_load_dwordx4 v27, s[16:19], s56 offen lds
ds_read_b64_tr_b16 a[208:209], v48 offset:20480
ds_read_b64_tr_b16 a[210:211], v48 offset:21504
ds_read_b64_tr_b16 a[212:213], v48 offset:22528
ds_read_b64_tr_b16 a[214:215], v48 offset:23552
ds_read_b64_tr_b16 a[216:217], v49 offset:20480
ds_read_b64_tr_b16 a[218:219], v49 offset:21504
ds_read_b64_tr_b16 a[220:221], v49 offset:22528
ds_read_b64_tr_b16 a[222:223], v49 offset:23552
s_waitcnt lgkmcnt(0)
s_waitcnt vmcnt(25)
s_barrier
s_add_u32 s56, s55, 4608
s_mov_b32 m0, 77824
s_nop 0
buffer_load_dwordx4 v28, s[20:23], s56 offen lds
s_add_u32 s56, s55, 6912
s_mov_b32 m0, 78848
s_nop 0
buffer_load_dwordx4 v28, s[20:23], s56 offen lds
s_add_u32 s56, s55, 13824
s_mov_b32 m0, 79872
s_nop 0
buffer_load_dwordx4 v28, s[20:23], s56 offen lds
s_add_u32 s56, s55, 16128
s_mov_b32 m0, 80896
s_nop 0
buffer_load_dwordx4 v28, s[20:23], s56 offen lds
ds_read_b64_tr_b16 a[224:225], v48 offset:24576
ds_read_b64_tr_b16 a[226:227], v48 offset:25600
ds_read_b64_tr_b16 a[228:229], v48 offset:26624
ds_read_b64_tr_b16 a[230:231], v48 offset:27648
ds_read_b64_tr_b16 a[240:241], v49 offset:24576
ds_read_b64_tr_b16 a[242:243], v49 offset:25600
ds_read_b64_tr_b16 a[244:245], v49 offset:26624
ds_read_b64_tr_b16 a[246:247], v49 offset:27648
s_waitcnt lgkmcnt(0)
s_waitcnt vmcnt(25)
s_barrier
s_add_u32 s56, s55, 4864
s_mov_b32 m0, 81920
s_nop 0
buffer_load_dwordx4 v28, s[20:23], s56 offen lds
s_add_u32 s56, s55, 7168
s_mov_b32 m0, 82944
s_nop 0
buffer_load_dwordx4 v28, s[20:23], s56 offen lds
s_add_u32 s56, s55, 14080
s_mov_b32 m0, 83968
s_nop 0
buffer_load_dwordx4 v28, s[20:23], s56 offen lds
s_add_u32 s56, s55, 16384
s_mov_b32 m0, 84992
s_nop 0
buffer_load_dwordx4 v28, s[20:23], s56 offen lds
ds_read_b64_tr_b16 a[248:249], v48 offset:28672
ds_read_b64_tr_b16 a[250:251], v48 offset:29696
ds_read_b64_tr_b16 a[252:253], v48 offset:30720
ds_read_b64_tr_b16 a[254:255], v48 offset:31744
ds_read_b64_tr_b16 a[232:233], v49 offset:28672
ds_read_b64_tr_b16 a[234:235], v49 offset:29696
ds_read_b64_tr_b16 a[236:237], v49 offset:30720
ds_read_b64_tr_b16 a[238:239], v49 offset:31744
s_waitcnt lgkmcnt(0)
s_waitcnt vmcnt(24)
s_barrier
s_add_u32 s56, s55, 5120
s_mov_b32 m0, 86016
s_nop 0
buffer_load_dwordx4 v28, s[20:23], s56 offen lds
s_add_u32 s56, s55, 7424
s_mov_b32 m0, 87040
s_nop 0
buffer_load_dwordx4 v28, s[20:23], s56 offen lds
s_add_u32 s56, s55, 14336
s_mov_b32 m0, 88064
s_nop 0
buffer_load_dwordx4 v28, s[20:23], s56 offen lds
s_add_u32 s56, s55, 16640
s_mov_b32 m0, 89088
s_nop 0
buffer_load_dwordx4 v28, s[20:23], s56 offen lds
ds_read_b64_tr_b16 v[60:61], v44 offset:0
ds_read_b64_tr_b16 v[62:63], v44 offset:1024
ds_read_b64_tr_b16 v[64:65], v46 offset:0
ds_read_b64_tr_b16 v[66:67], v46 offset:1024
ds_read_b64_tr_b16 v[68:69], v45 offset:0
ds_read_b64_tr_b16 v[70:71], v45 offset:1024
ds_read_b64_tr_b16 v[72:73], v47 offset:0
ds_read_b64_tr_b16 v[74:75], v47 offset:1024
s_waitcnt lgkmcnt(0)
s_waitcnt vmcnt(24)
s_barrier
ds_write_b128 v2, v[60:63] offset:0
ds_write_b128 v2, v[64:67] offset:1024
ds_write_b128 v2, v[68:71] offset:2048
ds_write_b128 v2, v[72:75] offset:3072
ds_read_b64_tr_b16 v[60:61], v44 offset:4096
ds_read_b64_tr_b16 v[62:63], v44 offset:5120
ds_read_b64_tr_b16 v[64:65], v46 offset:4096
ds_read_b64_tr_b16 v[66:67], v46 offset:5120
ds_read_b64_tr_b16 v[68:69], v45 offset:4096
ds_read_b64_tr_b16 v[70:71], v45 offset:5120
ds_read_b64_tr_b16 v[72:73], v47 offset:4096
ds_read_b64_tr_b16 v[74:75], v47 offset:5120
L_rdv_w1:
v_readfirstlane_b32 s38, v32
s_nop 0
s_and_b32 s57, s38, 0xff
s_cmp_lg_u32 s57, 32
s_cbranch_scc1 L_rdv2_w1
s_waitcnt lgkmcnt(0)
s_waitcnt vmcnt(20)
s_barrier
ds_write_b128 v2, v[60:63] offset:4096
ds_write_b128 v2, v[64:67] offset:5120
ds_write_b128 v2, v[68:71] offset:6144
ds_write_b128 v2, v[72:75] offset:7168
ds_read_b64_tr_b16 v[60:61], v44 offset:8192
ds_read_b64_tr_b16 v[62:63], v44 offset:9216
ds_read_b64_tr_b16 v[64:65], v46 offset:8192
ds_read_b64_tr_b16 v[66:67], v46 offset:9216
ds_read_b64_tr_b16 v[68:69], v45 offset:8192
ds_read_b64_tr_b16 v[70:71], v45 offset:9216
ds_read_b64_tr_b16 v[72:73], v47 offset:8192
ds_read_b64_tr_b16 v[74:75], v47 offset:9216
buffer_load_dwordx4 v[12:15], v9, s[4:7], s37 offen offset:0
buffer_load_dwordx4 v[16:19], v9, s[4:7], s37 offen offset:1024
buffer_load_dwordx4 v[52:55], v1, s[4:7], s37 offen offset:2048
buffer_load_dwordx4 v[56:59], v1, s[4:7], s37 offen offset:3072
s_mov_b32 m0, 1024
s_nop 0
buffer_load_dwordx4 v1, s[4:7], s47 offen offset:1024 sc0 sc1 lds
s_waitcnt lgkmcnt(0)
s_waitcnt vmcnt(21)
s_barrier
ds_write_b128 v2, v[60:63] offset:8192
ds_write_b128 v2, v[64:67] offset:9216
ds_write_b128 v2, v[68:71] offset:10240
ds_write_b128 v2, v[72:75] offset:11264
ds_read_b64_tr_b16 v[60:61], v44 offset:12288
ds_read_b64_tr_b16 v[62:63], v44 offset:13312
ds_read_b64_tr_b16 v[64:65], v46 offset:12288
ds_read_b64_tr_b16 v[66:67], v46 offset:13312
ds_read_b64_tr_b16 v[68:69], v45 offset:12288
ds_read_b64_tr_b16 v[70:71], v45 offset:13312
ds_read_b64_tr_b16 v[72:73], v47 offset:12288
ds_read_b64_tr_b16 v[74:75], v47 offset:13312
s_waitcnt lgkmcnt(0)
s_waitcnt vmcnt(17)
s_barrier
ds_write_b128 v2, v[60:63] offset:12288
ds_write_b128 v2, v[64:67] offset:13312
ds_write_b128 v2, v[68:71] offset:14336
ds_write_b128 v2, v[72:75] offset:15360
ds_read_b64_tr_b16 v[60:61], v44 offset:16384
ds_read_b64_tr_b16 v[62:63], v44 offset:17408
ds_read_b64_tr_b16 v[64:65], v46 offset:16384
ds_read_b64_tr_b16 v[66:67], v46 offset:17408
ds_read_b64_tr_b16 v[68:69], v45 offset:16384
ds_read_b64_tr_b16 v[70:71], v45 offset:17408
ds_read_b64_tr_b16 v[72:73], v47 offset:16384
ds_read_b64_tr_b16 v[74:75], v47 offset:17408
s_waitcnt lgkmcnt(0)
s_waitcnt vmcnt(13)
s_barrier
ds_write_b128 v2, v[60:63] offset:16384
ds_write_b128 v2, v[64:67] offset:17408
ds_write_b128 v2, v[68:71] offset:18432
ds_write_b128 v2, v[72:75] offset:19456
ds_read_b64_tr_b16 v[60:61], v48 offset:20480
ds_read_b64_tr_b16 v[62:63], v48 offset:21504
ds_read_b64_tr_b16 v[64:65], v48 offset:22528
ds_read_b64_tr_b16 v[66:67], v48 offset:23552
ds_read_b64_tr_b16 v[68:69], v49 offset:20480
ds_read_b64_tr_b16 v[70:71], v49 offset:21504
ds_read_b64_tr_b16 v[72:73], v49 offset:22528
ds_read_b64_tr_b16 v[74:75], v49 offset:23552
s_waitcnt lgkmcnt(0)
s_waitcnt vmcnt(9)
s_barrier
ds_write_b128 v2, v[60:63] offset:20480
ds_write_b128 v2, v[64:67] offset:21504
ds_write_b128 v2, v[68:71] offset:22528
ds_write_b128 v2, v[72:75] offset:23552
ds_read_b64_tr_b16 v[60:61], v48 offset:24576
ds_read_b64_tr_b16 v[62:63], v48 offset:25600
ds_read_b64_tr_b16 v[64:65], v48 offset:26624
ds_read_b64_tr_b16 v[66:67], v48 offset:27648
ds_read_b64_tr_b16 v[68:69], v49 offset:24576
ds_read_b64_tr_b16 v[70:71], v49 offset:25600
ds_read_b64_tr_b16 v[72:73], v49 offset:26624
ds_read_b64_tr_b16 v[74:75], v49 offset:27648
s_waitcnt lgkmcnt(0)
s_waitcnt vmcnt(5)
s_barrier
ds_write_b128 v2, v[60:63] offset:24576
ds_write_b128 v2, v[64:67] offset:25600
ds_write_b128 v2, v[68:71] offset:26624
ds_write_b128 v2, v[72:75] offset:27648
ds_read_b64_tr_b16 v[60:61], v48 offset:28672
ds_read_b64_tr_b16 v[62:63], v48 offset:29696
ds_read_b64_tr_b16 v[64:65], v48 offset:30720
ds_read_b64_tr_b16 v[66:67], v48 offset:31744
ds_read_b64_tr_b16 v[68:69], v49 offset:28672
ds_read_b64_tr_b16 v[70:71], v49 offset:29696
ds_read_b64_tr_b16 v[72:73], v49 offset:30720
ds_read_b64_tr_b16 v[74:75], v49 offset:31744
s_waitcnt lgkmcnt(0)
s_barrier
ds_write_b128 v2, v[60:63] offset:28672
ds_write_b128 v2, v[64:67] offset:29696
ds_write_b128 v2, v[68:71] offset:30720
ds_write_b128 v2, v[72:75] offset:31744
s_lshl_b32 s57, s58, 5
s_mov_b32 s0, 0x3f003f00
s_mov_b32 s1, 0x3f003f00
s_mov_b32 s58, 304128
s_cmp_eq_u32 s38, s57
s_cbranch_scc0 L_slow_w1
v_mov_b64 v[20:21], 0
v_mov_b64 v[22:23], 0
v_mov_b64 v[24:25], 0
v_mov_b64 v[26:27], 0
v_mov_b64 v[28:29], 0
v_mov_b64 v[30:31], 0
v_mov_b64 v[32:33], 0
v_mov_b64 v[34:35], 0
v_mov_b64 v[36:37], 0
v_mov_b64 v[38:39], 0
v_mov_b64 v[40:41], 0
v_mov_b64 v[42:43], 0
ds_read_b128 v[44:47], v2 offset:0
ds_read_b128 v[48:51], v2 offset:1024
v_bfe_u32 v77, v1, 6, 1
v_lshl_add_u32 v77, v77, 3, v1
v_lshlrev_b32 v77, 1, v77
v_lshlrev_b32 v78, 2, v1
s_waitcnt vmcnt(0) lgkmcnt(0)
s_branch L_top_w1f
.p2align 6
L_ex_w1f:
s_add_u32 s34, s34, 1
s_add_u32 s37, s37, 524288
s_add_u32 s39, s39, 524288
s_mul_i32 s40, s34, 10240
s_add_u32 s40, s40, 8093696
s_not_b32 s35, s35
s_not_b32 s36, s36
v_mov_b64 v[20:21], 0
v_mov_b64 v[22:23], 0
v_mov_b64 v[24:25], 0
v_mov_b64 v[26:27], 0
v_mov_b64 v[28:29], 0
v_mov_b64 v[30:31], 0
v_mov_b64 v[32:33], 0
v_mov_b64 v[34:35], 0
v_mov_b64 v[36:37], 0
v_mov_b64 v[38:39], 0
v_mov_b64 v[40:41], 0
v_mov_b64 v[42:43], 0
s_cmp_eq_u32 s34, 63
s_cbranch_scc1 L_done_w1f
ds_read_b128 v[44:47], v2 offset:0
ds_read_b128 v[48:51], v2 offset:1024
v_bfe_u32 v77, v1, 6, 1
v_lshl_add_u32 v77, v77, 3, v1
v_lshlrev_b32 v77, 1, v77
v_lshlrev_b32 v78, 2, v1
s_barrier
L_top_w1f:
s_barrier
ds_read_b128 v[60:63], v1 offset:1024
ds_read_b128 v[64:67], v1 offset:2048
s_mov_b32 m0, 5120
s_nop 0
buffer_load_dwordx4 v1, s[4:7], s48 offen offset:1024 sc1 lds
s_barrier
ds_read_b128 v[68:71], v1 offset:3072
ds_read_b128 v[72:75], v1 offset:4096
L_s0_w1f:
s_waitcnt lgkmcnt(3)
v_smfmac_f32_16x16x64_bf16 v[28:31], v[60:63], v[176:183], v0
v_smfmac_f32_16x16x64_bf16 v[32:35], v[60:63], v[184:191], v0
s_mov_b32 m0, 9216
s_nop 0
buffer_load_dwordx4 v1, s[4:7], s49 offen offset:0 sc1 lds
v_smfmac_f32_16x16x64_bf16 v[36:39], v[60:63], a[48:55], v0
v_smfmac_f32_16x16x64_bf16 v[40:43], v[60:63], a[56:63], v0
s_waitcnt lgkmcnt(2)
v_smfmac_f32_16x16x64_bf16 v[20:23], v[64:67], v[80:87], v0
v_smfmac_f32_16x16x64_bf16 v[20:23], v[60:63], v[44:51], v0
ds_read_b128 v[44:47], v2 offset:2048
v_smfmac_f32_16x16x64_bf16 v[24:27], v[64:67], v[88:95], v0
ds_read_b128 v[48:51], v2 offset:3072
v_smfmac_f32_16x16x64_bf16 v[28:31], v[64:67], v[192:199], v0
s_waitcnt lgkmcnt(2)
v_bitop3_b32 v6, v60, v64, s35 bitop3:0x7e
buffer_load_dwordx4 v[12:15], v9, s[4:7], s37 offen offset:0
buffer_load_dwordx4 v[16:19], v9, s[4:7], s37 offen offset:1024
buffer_load_dwordx4 v[52:55], v1, s[4:7], s37 offen offset:2048
buffer_load_dwordx4 v[56:59], v1, s[4:7], s37 offen offset:3072
v_smfmac_f32_16x16x64_bf16 v[32:35], v[64:67], v[200:207], v0
v_bitop3_b32 v76, v68, v72, s35 bitop3:0x7e
v_smfmac_f32_16x16x64_bf16 v[36:39], v[64:67], a[64:71], v0
v_bitop3_b32 v6, v6, v76, 1 bitop3:0xa8
s_waitcnt lgkmcnt(0)
v_smfmac_f32_16x16x64_bf16 v[24:27], v[60:63], v[44:51], v0
ds_read_b128 v[44:47], v2 offset:4096
v_cmp_ne_u32 vcc, 0, v6
v_smfmac_f32_16x16x64_bf16 v[40:43], v[64:67], a[72:79], v0
ds_read_b128 v[48:51], v2 offset:5120
v_smfmac_f32_16x16x64_bf16 v[20:23], v[68:71], v[96:103], v0
s_cbranch_vccnz L_ra0_w1f
v_smfmac_f32_16x16x64_bf16 v[24:27], v[68:71], v[104:111], v0
s_waitcnt vmcnt(4)
s_barrier
ds_read_b32 v6, v77 offset:8192
v_smfmac_f32_16x16x64_bf16 v[28:31], v[68:71], v[208:215], v0
ds_read_b128 v[60:63], v1 offset:6144
s_waitcnt lgkmcnt(2)
v_smfmac_f32_16x16x64_bf16 v[20:23], v[72:75], v[44:51], v0
ds_read_b128 v[64:67], v1 offset:7168
v_smfmac_f32_16x16x64_bf16 v[32:35], v[68:71], v[216:223], v0
ds_read_b128 v[76:79], v1 offset:5120
v_smfmac_f32_16x16x64_bf16 v[36:39], v[68:71], a[80:87], v0
ds_read_b128 v[44:47], v2 offset:6144
v_smfmac_f32_16x16x64_bf16 v[40:43], v[68:71], a[88:95], v0
ds_read_b128 v[48:51], v2 offset:7168
s_waitcnt lgkmcnt(4)
v_bitop3_b32 v6, v6, v60, s35 bitop3:0x7e
v_smfmac_f32_16x16x64_bf16 v[28:31], v[72:75], v[224:231], v0
ds_read_b128 v[68:71], v1 offset:8192
s_waitcnt lgkmcnt(4)
v_bitop3_b32 v6, v6, v64, s35 bitop3:0xf6
v_smfmac_f32_16x16x64_bf16 v[32:35], v[72:75], v[232:239], v0
s_waitcnt lgkmcnt(3)
v_bitop3_b32 v6, v6, v76, s35 bitop3:0xf6
v_and_b32 v6, 1, v6
v_smfmac_f32_16x16x64_bf16 v[36:39], v[72:75], a[96:103], v0
v_cmp_ne_u32 vcc, 0, v6
s_waitcnt lgkmcnt(1)
v_smfmac_f32_16x16x64_bf16 v[24:27], v[72:75], v[44:51], v0
ds_read_b128 v[44:47], v2 offset:8192
v_lshlrev_b32 v6, 2, v1
v_smfmac_f32_16x16x64_bf16 v[40:43], v[72:75], a[104:111], v0
ds_read_b128 v[72:75], v1 offset:9216
s_cbranch_vccnz L_ra1_w1f
L_a1_w1f:
s_mov_b32 m0, 0
s_nop 0
buffer_load_dword v6, s[4:7], s39 offen lds
v_smfmac_f32_16x16x64_bf16 v[20:23], v[60:63], v[112:119], v0
ds_read_b128 v[48:51], v2 offset:9216
v_smfmac_f32_16x16x64_bf16 v[20:23], v[64:67], v[128:135], v0
s_waitcnt lgkmcnt(3)
v_smfmac_f32_16x16x64_bf16 v[20:23], v[68:71], v[144:151], v0
s_waitcnt lgkmcnt(1)
v_smfmac_f32_16x16x64_bf16 v[20:23], v[72:75], v[160:167], v0
s_waitcnt lgkmcnt(0)
v_smfmac_f32_16x16x64_bf16 v[20:23], v[76:79], v[44:51], v0
ds_read_b128 v[44:47], v2 offset:10240
v_smfmac_f32_16x16x64_bf16 v[24:27], v[60:63], v[120:127], v0
ds_read_b128 v[48:51], v2 offset:11264
v_smfmac_f32_16x16x64_bf16 v[24:27], v[64:67], v[136:143], v0
v_add_f32 v20, v20, v22
v_smfmac_f32_16x16x64_bf16 v[24:27], v[68:71], v[152:159], v0
v_add_f32 v21, v21, v23
v_smfmac_f32_16x16x64_bf16 v[24:27], v[72:75], v[168:175], v0
v_cvt_pk_bf16_f32 v22, v20, v21
s_waitcnt lgkmcnt(0)
v_smfmac_f32_16x16x64_bf16 v[24:27], v[76:79], v[44:51], v0
ds_read_b128 v[44:47], v2 offset:12288
v_smfmac_f32_16x16x64_bf16 v[28:31], v[76:79], v[240:247], v0
ds_read_b128 v[48:51], v2 offset:13312
v_smfmac_f32_16x16x64_bf16 v[28:31], v[64:67], a[0:7], v0
v_add_f32 v24, v24, v26
v_add_f32 v25, v25, v27
v_cvt_pk_bf16_f32 v23, v24, v25
v_smfmac_f32_16x16x64_bf16 v[28:31], v[68:71], a[16:23], v0
ds_write_b64 v3, v[22:23] offset:10752
v_smfmac_f32_16x16x64_bf16 v[28:31], v[72:75], a[32:39], v0
s_waitcnt lgkmcnt(1)
v_smfmac_f32_16x16x64_bf16 v[28:31], v[60:63], v[44:51], v0
ds_read_b128 v[44:47], v2 offset:14336
v_smfmac_f32_16x16x64_bf16 v[32:35], v[76:79], v[248:255], v0
ds_read_b128 v[48:51], v2 offset:15360
s_waitcnt lgkmcnt(2)
s_barrier
v_smfmac_f32_16x16x64_bf16 v[32:35], v[64:67], a[8:15], v0
ds_read_b64_tr_b16 v[20:21], v4 offset:10240
ds_read_b64_tr_b16 v[22:23], v4 offset:10752
v_add_f32 v28, v28, v30
v_smfmac_f32_16x16x64_bf16 v[32:35], v[68:71], a[24:31], v0
ds_read_b64_tr_b16 v[24:25], v4 offset:11264
v_add_f32 v29, v29, v31
v_smfmac_f32_16x16x64_bf16 v[32:35], v[72:75], a[40:47], v0
ds_read_b64_tr_b16 v[26:27], v4 offset:11776
v_cvt_pk_bf16_f32 v30, v28, v29
s_waitcnt lgkmcnt(4)
v_smfmac_f32_16x16x64_bf16 v[32:35], v[60:63], v[44:51], v0
ds_read_b128 v[44:47], v2 offset:18432
s_waitcnt vmcnt(3)
s_waitcnt lgkmcnt(3)
v_mfma_f32_16x16x32_bf16 v[12:15], v[12:15], v[20:23], 0
ds_read_b128 v[48:51], v2 offset:19456
s_waitcnt lgkmcnt(2)
v_mfma_f32_16x16x32_bf16 v[12:15], v[16:19], v[24:27], v[12:15]
v_add_f32 v32, v32, v34
v_add_f32 v33, v33, v35
v_cvt_pk_bf16_f32 v31, v32, v33
ds_write_b64 v3, v[30:31] offset:12800
v_smfmac_f32_16x16x64_bf16 v[36:39], v[76:79], a[112:119], v0
s_nop 2
v_add_f32_dpp v12, v14, v12 quad_perm:[2,3,0,1] row_mask:0xf bank_mask:0xf
v_add_f32_dpp v13, v15, v13 quad_perm:[2,3,0,1] row_mask:0xf bank_mask:0xf
ds_write_b64 v5, v[12:13] offset:14592
v_smfmac_f32_16x16x64_bf16 v[40:43], v[76:79], a[120:127], v0
s_waitcnt lgkmcnt(1)
s_barrier
ds_read_b64_tr_b16 v[28:29], v4 offset:12288
v_smfmac_f32_16x16x64_bf16 v[36:39], v[60:63], a[128:135], v0
ds_read_b64_tr_b16 v[30:31], v4 offset:12800
ds_read_b64_tr_b16 v[32:33], v4 offset:13312
v_smfmac_f32_16x16x64_bf16 v[40:43], v[60:63], a[136:143], v0
ds_read_b64_tr_b16 v[34:35], v4 offset:13824
v_mov_b64 v[76:77], s[52:53]
s_waitcnt lgkmcnt(4)
s_barrier
ds_read_b128 v[12:15], v1 offset:14336
v_smfmac_f32_16x16x64_bf16 v[40:43], v[72:75], v[44:51], v0
ds_read_b128 v[44:47], v2 offset:16384
v_mov_b64 v[78:79], s[52:53]
s_waitcnt lgkmcnt(4)
v_mfma_f32_16x16x32_bf16 v[28:31], v[28:31], v[20:23], 0
ds_read_b128 v[48:51], v2 offset:17408
s_waitcnt lgkmcnt(3)
v_mfma_f32_16x16x32_bf16 v[28:31], v[32:35], v[24:27], v[28:31]
v_smfmac_f32_16x16x64_bf16 v[40:43], v[64:67], a[152:159], v0
s_waitcnt lgkmcnt(2)
v_max3_f32 v17, v12, v13, v14
v_smfmac_f32_16x16x64_bf16 v[36:39], v[64:67], a[144:151], v0
ds_read_b128 v[60:63], v2 offset:20480
v_add_f32_dpp v28, v30, v28 quad_perm:[2,3,0,1] row_mask:0xf bank_mask:0xf
v_add_f32_dpp v29, v31, v29 quad_perm:[2,3,0,1] row_mask:0xf bank_mask:0xf
v_max_f32 v17, v17, v15
v_max_f32 v16, v28, v29
v_mul_f32 v16, s50, v16
v_max_f32_dpp v17, v17, v17 quad_perm:[2,3,0,1] row_mask:0xf bank_mask:0xf
v_smfmac_f32_16x16x64_bf16 v[40:43], v[68:71], a[168:175], v0
ds_read_b128 v[64:67], v2 offset:21504
v_max_f32_dpp v18, v16, v17 quad_perm:[0,1,0,1] row_mask:0xf bank_mask:0xf
v_max_f32_dpp v19, v16, v17 quad_perm:[0,1,0,1] row_mask:0xf bank_mask:0xf
v_smfmac_f32_16x16x64_bf16 v[36:39], v[68:71], a[160:167], v0
ds_read_b128 v[68:71], v2 offset:26624
v_permlane16_swap_b32 v18, v19
v_max_f32 v20, v18, v19
v_max_f32 v21, v18, v19
s_waitcnt lgkmcnt(3)
v_smfmac_f32_16x16x64_bf16 v[36:39], v[72:75], v[44:51], v0
ds_read_b128 v[72:75], v2 offset:27648
v_permlane32_swap_b32 v20, v21
v_max_f32 v20, v20, v21
v_sub_f32 v12, v12, v20
v_sub_f32 v13, v13, v20
v_pk_add_f32 v[14:15], v[14:15], v[20:21] op_sel_hi:[1,0] neg_lo:[0,1] neg_hi:[0,1]
v_exp_f32 v12, v12
v_exp_f32 v13, v13
v_exp_f32 v14, v14
v_exp_f32 v15, v15
v_cvt_pk_bf16_f32 v16, v12, v13
v_cvt_pk_bf16_f32 v17, v14, v15
v_pk_fma_f32 v[28:29], v[28:29], s[50:51], v[20:21] op_sel_hi:[1,1,0] neg_lo:[0,0,1] neg_hi:[0,0,1]
v_mov_b32_dpp v18, v16 quad_perm:[2,3,0,1] row_mask:0xf bank_mask:0xf
v_mov_b32_dpp v19, v17 quad_perm:[2,3,0,1] row_mask:0xf bank_mask:0xf
v_exp_f32 v28, v28
s_waitcnt vmcnt(1)
v_mfma_f32_16x16x32_bf16 v[32:35], v[76:79], v[16:19], 0
v_exp_f32 v29, v29
v_mfma_f32_16x16x32_bf16 v[20:23], v[52:55], v[16:19], 0
v_cvt_pk_bf16_f32 v12, v28, v29
v_cvt_pk_bf16_f32 v13, v28, v29
v_mov_b64 v[14:15], s[0:1]
v_mfma_f32_16x16x32_bf16 v[24:27], v[56:59], v[16:19], 0
v_cvt_pk_bf16_f32 v36, v36, v37
v_cvt_pk_bf16_f32 v37, v38, v39
v_mfma_f32_16x16x16_bf16 v[32:35], v[14:15], v[12:13], v[32:35]
v_cvt_pk_bf16_f32 v38, v40, v41
v_cvt_pk_bf16_f32 v39, v42, v43
v_mfma_f32_16x16x16_bf16 v[20:23], v[36:37], v[12:13], v[20:23]
ds_read_b128 v[44:47], v2 offset:22528
v_mfma_f32_16x16x16_bf16 v[24:27], v[38:39], v[12:13], v[24:27]
ds_read_b128 v[48:51], v2 offset:23552
v_rcp_f32 v32, v32
v_mov_b64 v[28:29], 0
v_mov_b64 v[30:31], 0
v_pk_mul_f32 v[20:21], v[20:21], v[32:33] op_sel_hi:[1,0]
v_pk_mul_f32 v[22:23], v[22:23], v[32:33] op_sel_hi:[1,0]
v_cvt_pk_bf16_f32 v20, v20, v21
v_cvt_pk_bf16_f32 v21, v22, v23
ds_write_b64 v1, v[20:21] offset:6144
v_pk_mul_f32 v[24:25], v[24:25], v[32:33] op_sel_hi:[1,0]
v_pk_mul_f32 v[26:27], v[26:27], v[32:33] op_sel_hi:[1,0]
v_cvt_pk_bf16_f32 v24, v24, v25
v_cvt_pk_bf16_f32 v25, v26, v27
ds_write_b64 v1, v[24:25] offset:6152
v_mov_b64 v[76:77], 0
ds_read_b128 v[12:15], v7 offset:6144
v_mov_b64 v[78:79], 0
v_mov_b64 v[40:41], 0
v_mov_b64 v[42:43], 0
v_mov_b64 v[36:37], 0
v_mov_b64 v[38:39], 0
v_mov_b64 v[32:33], 0
v_mov_b64 v[34:35], 0
s_waitcnt lgkmcnt(1)
s_barrier
ds_read_b128 v[16:19], v7 offset:7168
ds_read_b128 v[52:55], v7 offset:8192
ds_read_b128 v[56:59], v7 offset:5120
s_waitcnt lgkmcnt(3)
v_smfmac_f32_16x16x64_bf16 v[28:31], v[12:15], a[176:183], v0 abid:1
v_smfmac_f32_16x16x64_bf16 v[76:79], v[12:15], a[184:191], v0 abid:1
s_waitcnt lgkmcnt(2)
v_smfmac_f32_16x16x64_bf16 v[28:31], v[16:19], v[44:51], v0 abid:1
ds_read_b128 v[44:47], v2 offset:24576
s_waitcnt lgkmcnt(2)
v_smfmac_f32_16x16x64_bf16 v[28:31], v[52:55], a[192:199], v0 abid:1
ds_read_b128 v[48:51], v2 offset:25600
s_waitcnt lgkmcnt(2)
v_smfmac_f32_16x16x64_bf16 v[28:31], v[56:59], v[60:67], v0 abid:1
ds_read_b128 v[60:63], v2 offset:30720
v_smfmac_f32_16x16x64_bf16 v[76:79], v[16:19], v[68:75], v0 abid:1
ds_read_b128 v[64:67], v2 offset:31744
v_smfmac_f32_16x16x64_bf16 v[76:79], v[52:55], a[200:207], v0 abid:1
ds_read_b128 v[68:71], v2 offset:28672
v_cvt_pk_bf16_f32 v28, v28, v29
v_cvt_pk_bf16_f32 v29, v30, v31
v_bfi_b32 v28, 1, s35, v28
buffer_store_dwordx2 v[28:29], v8, s[4:7], s42 offen
s_waitcnt lgkmcnt(3)
v_smfmac_f32_16x16x64_bf16 v[76:79], v[56:59], v[44:51], v0 abid:1
ds_read_b128 v[72:75], v2 offset:29696
v_smfmac_f32_16x16x64_bf16 v[40:43], v[12:15], a[208:215], v0 abid:1
ds_read_b128 v[44:47], v2 offset:36864
s_waitcnt lgkmcnt(3)
v_smfmac_f32_16x16x64_bf16 v[40:43], v[16:19], v[60:67], v0 abid:1
ds_read_b128 v[48:51], v2 offset:37888
v_cvt_pk_bf16_f32 v76, v76, v77
v_cvt_pk_bf16_f32 v77, v78, v79
v_bfi_b32 v76, 1, s35, v76
buffer_store_dwordx2 v[76:77], v8, s[4:7], s43 offen
v_smfmac_f32_16x16x64_bf16 v[40:43], v[52:55], a[216:223], v0 abid:1
ds_read_b128 v[60:63], v2 offset:34816
s_waitcnt lgkmcnt(3)
v_smfmac_f32_16x16x64_bf16 v[40:43], v[56:59], v[68:75], v0 abid:1
ds_read_b128 v[64:67], v2 offset:35840
v_smfmac_f32_16x16x64_bf16 v[36:39], v[12:15], a[224:231], v0 abid:1
ds_read_b128 v[68:71], v2 offset:38912
v_smfmac_f32_16x16x64_bf16 v[36:39], v[16:19], a[232:239], v0 abid:1
ds_read_b128 v[72:75], v2 offset:39936
v_cvt_pk_bf16_f32 v40, v40, v41
v_cvt_pk_bf16_f32 v41, v42, v43
v_bfi_b32 v40, 1, s35, v40
buffer_store_dwordx2 v[40:41], v8, s[4:7], s44 offen
v_smfmac_f32_16x16x64_bf16 v[36:39], v[52:55], a[240:247], v0 abid:1
v_smfmac_f32_16x16x64_bf16 v[36:39], v[56:59], a[248:255], v0 abid:1
s_waitcnt lgkmcnt(4)
v_smfmac_f32_16x16x64_bf16 v[32:35], v[12:15], v[44:51], v0 abid:1
ds_read_b128 v[44:47], v2 offset:32768
s_waitcnt lgkmcnt(3)
v_smfmac_f32_16x16x64_bf16 v[32:35], v[16:19], v[60:67], v0 abid:1
ds_read_b128 v[48:51], v2 offset:33792
v_cvt_pk_bf16_f32 v36, v36, v37
v_cvt_pk_bf16_f32 v37, v38, v39
v_bfi_b32 v36, 1, s35, v36
buffer_store_dwordx2 v[36:37], v8, s[4:7], s45 offen
s_waitcnt lgkmcnt(2)
v_smfmac_f32_16x16x64_bf16 v[32:35], v[52:55], v[68:75], v0 abid:1
s_waitcnt lgkmcnt(0)
v_smfmac_f32_16x16x64_bf16 v[32:35], v[56:59], v[44:51], v0 abid:1
s_nop 7
v_cvt_pk_bf16_f32 v32, v32, v33
v_cvt_pk_bf16_f32 v33, v34, v35
v_bfi_b32 v32, 1, s35, v32
buffer_store_dwordx2 v[32:33], v8, s[4:7], s46 offen
s_branch L_ex_w1f
L_done_w1f:
s_waitcnt vmcnt(0) lgkmcnt(0)
s_endpgm
L_rdv2_w1:
buffer_load_dword v32, v24, s[28:31], 0 offen sc0 sc1
s_sub_u32 s41, s41, 1
s_cbranch_scc1 L_exit
s_waitcnt vmcnt(0)
s_branch L_rdv_w1
L_ra0_w1f:
s_mov_b32 m0, 1024
s_nop 0
buffer_load_dwordx4 v1, s[4:7], s47 offen offset:0 sc1 lds
buffer_load_dwordx4 v1, s[4:7], s47 offen offset:1024 sc1 lds
buffer_load_dwordx4 v1, s[4:7], s47 offen offset:2048 sc1 lds
buffer_load_dwordx4 v1, s[4:7], s47 offen offset:3072 sc1 lds
s_sub_u32 s41, s41, 1
s_cbranch_scc1 L_exit
ds_read_b128 v[44:47], v2 offset:0
ds_read_b128 v[48:51], v2 offset:1024
v_mov_b64 v[20:21], 0
v_mov_b64 v[22:23], 0
v_mov_b64 v[24:25], 0
v_mov_b64 v[26:27], 0
v_mov_b64 v[28:29], 0
v_mov_b64 v[30:31], 0
v_mov_b64 v[32:33], 0
v_mov_b64 v[34:35], 0
v_mov_b64 v[36:37], 0
v_mov_b64 v[38:39], 0
v_mov_b64 v[40:41], 0
v_mov_b64 v[42:43], 0
s_waitcnt vmcnt(0)
ds_read_b128 v[60:63], v1 offset:1024
ds_read_b128 v[64:67], v1 offset:2048
ds_read_b128 v[68:71], v1 offset:3072
ds_read_b128 v[72:75], v1 offset:4096
s_branch L_s0_w1f
L_ra1_w1f:
s_waitcnt lgkmcnt(0)
s_barrier
s_mov_b32 m0, 5120
s_nop 0
buffer_load_dwordx4 v1, s[4:7], s48 offen offset:1024 sc1 lds
s_sub_u32 s41, s41, 1
s_cbranch_scc1 L_exit
s_waitcnt vmcnt(0)
s_barrier
ds_read_b128 v[76:79], v1 offset:5120
ds_read_b128 v[60:63], v1 offset:6144
ds_read_b128 v[64:67], v1 offset:7168
ds_read_b128 v[68:71], v1 offset:8192
ds_read_b128 v[72:75], v1 offset:9216
s_waitcnt lgkmcnt(0)
v_bitop3_b32 v6, v76, v60, s35 bitop3:0x7e
v_bitop3_b32 v6, v6, v64, s35 bitop3:0xf6
v_bitop3_b32 v6, v6, v68, s35 bitop3:0xf6
v_bitop3_b32 v6, v6, v72, s35 bitop3:0xf6
v_and_b32 v6, 1, v6
v_cmp_ne_u32 vcc, 0, v6
v_lshlrev_b32 v6, 2, v1
s_cbranch_vccnz L_ra1_w1f
s_branch L_a1_w1f
L_slow_w1:
v_mov_b64 v[20:21], 0
v_mov_b64 v[22:23], 0
v_mov_b64 v[24:25], 0
v_mov_b64 v[26:27], 0
v_mov_b64 v[28:29], 0
v_mov_b64 v[30:31], 0
v_mov_b64 v[32:33], 0
v_mov_b64 v[34:35], 0
v_mov_b64 v[36:37], 0
v_mov_b64 v[38:39], 0
v_mov_b64 v[40:41], 0
v_mov_b64 v[42:43], 0
ds_read_b128 v[44:47], v2 offset:0
ds_read_b128 v[48:51], v2 offset:1024
v_bfe_u32 v77, v1, 6, 1
v_lshl_add_u32 v77, v77, 3, v1
v_lshlrev_b32 v77, 1, v77
v_lshlrev_b32 v78, 2, v1
s_waitcnt vmcnt(0) lgkmcnt(0)
s_branch L_top_w1s
.p2align 6
L_ex_w1s:
s_add_u32 s34, s34, 1
s_add_u32 s37, s37, 524288
s_add_u32 s39, s39, 524288
s_mul_i32 s40, s34, 10240
s_add_u32 s40, s40, 8093696
s_not_b32 s35, s35
s_not_b32 s36, s36
v_mov_b64 v[20:21], 0
v_mov_b64 v[22:23], 0
v_mov_b64 v[24:25], 0
v_mov_b64 v[26:27], 0
v_mov_b64 v[28:29], 0
v_mov_b64 v[30:31], 0
v_mov_b64 v[32:33], 0
v_mov_b64 v[34:35], 0
v_mov_b64 v[36:37], 0
v_mov_b64 v[38:39], 0
v_mov_b64 v[40:41], 0
v_mov_b64 v[42:43], 0
s_cmp_eq_u32 s34, 63
s_cbranch_scc1 L_done_w1s
ds_read_b128 v[44:47], v2 offset:0
ds_read_b128 v[48:51], v2 offset:1024
v_bfe_u32 v77, v1, 6, 1
v_lshl_add_u32 v77, v77, 3, v1
v_lshlrev_b32 v77, 1, v77
v_lshlrev_b32 v78, 2, v1
s_barrier
L_top_w1s:
s_barrier
ds_read_b128 v[60:63], v1 offset:1024
ds_read_b128 v[64:67], v1 offset:2048
s_mov_b32 m0, 5120
s_nop 0
buffer_load_dwordx4 v1, s[4:7], s48 offen offset:1024 sc0 sc1 lds
s_barrier
ds_read_b128 v[68:71], v1 offset:3072
ds_read_b128 v[72:75], v1 offset:4096
L_s0_w1s:
s_waitcnt lgkmcnt(3)
v_smfmac_f32_16x16x64_bf16 v[28:31], v[60:63], v[176:183], v0
v_smfmac_f32_16x16x64_bf16 v[32:35], v[60:63], v[184:191], v0
s_mov_b32 m0, 9216
s_nop 0
buffer_load_dwordx4 v1, s[4:7], s49 offen offset:0 sc0 sc1 lds
v_smfmac_f32_16x16x64_bf16 v[36:39], v[60:63], a[48:55], v0
v_smfmac_f32_16x16x64_bf16 v[40:43], v[60:63], a[56:63], v0
s_waitcnt lgkmcnt(2)
v_smfmac_f32_16x16x64_bf16 v[20:23], v[64:67], v[80:87], v0
v_smfmac_f32_16x16x64_bf16 v[20:23], v[60:63], v[44:51], v0
ds_read_b128 v[44:47], v2 offset:2048
v_smfmac_f32_16x16x64_bf16 v[24:27], v[64:67], v[88:95], v0
ds_read_b128 v[48:51], v2 offset:3072
v_smfmac_f32_16x16x64_bf16 v[28:31], v[64:67], v[192:199], v0
s_waitcnt lgkmcnt(2)
v_bitop3_b32 v6, v60, v64, s35 bitop3:0x7e
buffer_load_dwordx4 v[12:15], v9, s[4:7], s37 offen offset:0
buffer_load_dwordx4 v[16:19], v9, s[4:7], s37 offen offset:1024
buffer_load_dwordx4 v[52:55], v1, s[4:7], s37 offen offset:2048
buffer_load_dwordx4 v[56:59], v1, s[4:7], s37 offen offset:3072
v_smfmac_f32_16x16x64_bf16 v[32:35], v[64:67], v[200:207], v0
v_bitop3_b32 v76, v68, v72, s35 bitop3:0x7e
v_smfmac_f32_16x16x64_bf16 v[36:39], v[64:67], a[64:71], v0
v_bitop3_b32 v6, v6, v76, 1 bitop3:0xa8
s_waitcnt lgkmcnt(0)
v_smfmac_f32_16x16x64_bf16 v[24:27], v[60:63], v[44:51], v0
ds_read_b128 v[44:47], v2 offset:4096
v_cmp_ne_u32 vcc, 0, v6
v_smfmac_f32_16x16x64_bf16 v[40:43], v[64:67], a[72:79], v0
ds_read_b128 v[48:51], v2 offset:5120
v_smfmac_f32_16x16x64_bf16 v[20:23], v[68:71], v[96:103], v0
s_cbranch_vccnz L_ra0_w1s
v_smfmac_f32_16x16x64_bf16 v[24:27], v[68:71], v[104:111], v0
s_waitcnt vmcnt(4)
s_barrier
ds_read_b32 v6, v77 offset:8192
v_smfmac_f32_16x16x64_bf16 v[28:31], v[68:71], v[208:215], v0
ds_read_b128 v[60:63], v1 offset:6144
s_waitcnt lgkmcnt(2)
v_smfmac_f32_16x16x64_bf16 v[20:23], v[72:75], v[44:51], v0
ds_read_b128 v[64:67], v1 offset:7168
v_smfmac_f32_16x16x64_bf16 v[32:35], v[68:71], v[216:223], v0
ds_read_b128 v[76:79], v1 offset:5120
v_smfmac_f32_16x16x64_bf16 v[36:39], v[68:71], a[80:87], v0
ds_read_b128 v[44:47], v2 offset:6144
v_smfmac_f32_16x16x64_bf16 v[40:43], v[68:71], a[88:95], v0
ds_read_b128 v[48:51], v2 offset:7168
s_waitcnt lgkmcnt(4)
v_bitop3_b32 v6, v6, v60, s35 bitop3:0x7e
v_smfmac_f32_16x16x64_bf16 v[28:31], v[72:75], v[224:231], v0
ds_read_b128 v[68:71], v1 offset:8192
s_waitcnt lgkmcnt(4)
v_bitop3_b32 v6, v6, v64, s35 bitop3:0xf6
v_smfmac_f32_16x16x64_bf16 v[32:35], v[72:75], v[232:239], v0
s_waitcnt lgkmcnt(3)
v_bitop3_b32 v6, v6, v76, s35 bitop3:0xf6
v_and_b32 v6, 1, v6
v_smfmac_f32_16x16x64_bf16 v[36:39], v[72:75], a[96:103], v0
v_cmp_ne_u32 vcc, 0, v6
s_waitcnt lgkmcnt(1)
v_smfmac_f32_16x16x64_bf16 v[24:27], v[72:75], v[44:51], v0
ds_read_b128 v[44:47], v2 offset:8192
v_lshlrev_b32 v6, 2, v1
v_smfmac_f32_16x16x64_bf16 v[40:43], v[72:75], a[104:111], v0
ds_read_b128 v[72:75], v1 offset:9216
s_cbranch_vccnz L_ra1_w1s
L_a1_w1s:
s_mov_b32 m0, 0
s_nop 0
buffer_load_dword v6, s[4:7], s39 offen lds
v_smfmac_f32_16x16x64_bf16 v[20:23], v[60:63], v[112:119], v0
ds_read_b128 v[48:51], v2 offset:9216
v_smfmac_f32_16x16x64_bf16 v[20:23], v[64:67], v[128:135], v0
s_waitcnt lgkmcnt(3)
v_smfmac_f32_16x16x64_bf16 v[20:23], v[68:71], v[144:151], v0
s_waitcnt lgkmcnt(1)
v_smfmac_f32_16x16x64_bf16 v[20:23], v[72:75], v[160:167], v0
s_waitcnt lgkmcnt(0)
v_smfmac_f32_16x16x64_bf16 v[20:23], v[76:79], v[44:51], v0
ds_read_b128 v[44:47], v2 offset:10240
v_smfmac_f32_16x16x64_bf16 v[24:27], v[60:63], v[120:127], v0
ds_read_b128 v[48:51], v2 offset:11264
v_smfmac_f32_16x16x64_bf16 v[24:27], v[64:67], v[136:143], v0
v_add_f32 v20, v20, v22
v_smfmac_f32_16x16x64_bf16 v[24:27], v[68:71], v[152:159], v0
v_add_f32 v21, v21, v23
v_smfmac_f32_16x16x64_bf16 v[24:27], v[72:75], v[168:175], v0
v_cvt_pk_bf16_f32 v22, v20, v21
s_waitcnt lgkmcnt(0)
v_smfmac_f32_16x16x64_bf16 v[24:27], v[76:79], v[44:51], v0
ds_read_b128 v[44:47], v2 offset:12288
v_smfmac_f32_16x16x64_bf16 v[28:31], v[76:79], v[240:247], v0
ds_read_b128 v[48:51], v2 offset:13312
v_smfmac_f32_16x16x64_bf16 v[28:31], v[64:67], a[0:7], v0
v_add_f32 v24, v24, v26
v_add_f32 v25, v25, v27
v_cvt_pk_bf16_f32 v23, v24, v25
v_smfmac_f32_16x16x64_bf16 v[28:31], v[68:71], a[16:23], v0
ds_write_b64 v3, v[22:23] offset:10752
v_smfmac_f32_16x16x64_bf16 v[28:31], v[72:75], a[32:39], v0
s_waitcnt lgkmcnt(1)
v_smfmac_f32_16x16x64_bf16 v[28:31], v[60:63], v[44:51], v0
ds_read_b128 v[44:47], v2 offset:14336
v_smfmac_f32_16x16x64_bf16 v[32:35], v[76:79], v[248:255], v0
ds_read_b128 v[48:51], v2 offset:15360
s_waitcnt lgkmcnt(2)
s_barrier
v_smfmac_f32_16x16x64_bf16 v[32:35], v[64:67], a[8:15], v0
ds_read_b64_tr_b16 v[20:21], v4 offset:10240
ds_read_b64_tr_b16 v[22:23], v4 offset:10752
v_add_f32 v28, v28, v30
v_smfmac_f32_16x16x64_bf16 v[32:35], v[68:71], a[24:31], v0
ds_read_b64_tr_b16 v[24:25], v4 offset:11264
v_add_f32 v29, v29, v31
v_smfmac_f32_16x16x64_bf16 v[32:35], v[72:75], a[40:47], v0
ds_read_b64_tr_b16 v[26:27], v4 offset:11776
v_cvt_pk_bf16_f32 v30, v28, v29
s_waitcnt lgkmcnt(4)
v_smfmac_f32_16x16x64_bf16 v[32:35], v[60:63], v[44:51], v0
ds_read_b128 v[44:47], v2 offset:18432
s_waitcnt vmcnt(3)
s_waitcnt lgkmcnt(3)
v_mfma_f32_16x16x32_bf16 v[12:15], v[12:15], v[20:23], 0
ds_read_b128 v[48:51], v2 offset:19456
s_waitcnt lgkmcnt(2)
v_mfma_f32_16x16x32_bf16 v[12:15], v[16:19], v[24:27], v[12:15]
v_add_f32 v32, v32, v34
v_add_f32 v33, v33, v35
v_cvt_pk_bf16_f32 v31, v32, v33
ds_write_b64 v3, v[30:31] offset:12800
v_smfmac_f32_16x16x64_bf16 v[36:39], v[76:79], a[112:119], v0
s_nop 2
v_add_f32_dpp v12, v14, v12 quad_perm:[2,3,0,1] row_mask:0xf bank_mask:0xf
v_add_f32_dpp v13, v15, v13 quad_perm:[2,3,0,1] row_mask:0xf bank_mask:0xf
ds_write_b64 v5, v[12:13] offset:14592
v_smfmac_f32_16x16x64_bf16 v[40:43], v[76:79], a[120:127], v0
s_waitcnt lgkmcnt(1)
s_barrier
ds_read_b64_tr_b16 v[28:29], v4 offset:12288
v_smfmac_f32_16x16x64_bf16 v[36:39], v[60:63], a[128:135], v0
ds_read_b64_tr_b16 v[30:31], v4 offset:12800
ds_read_b64_tr_b16 v[32:33], v4 offset:13312
v_smfmac_f32_16x16x64_bf16 v[40:43], v[60:63], a[136:143], v0
ds_read_b64_tr_b16 v[34:35], v4 offset:13824
v_mov_b64 v[76:77], s[52:53]
s_waitcnt lgkmcnt(4)
s_barrier
ds_read_b128 v[12:15], v1 offset:14336
v_smfmac_f32_16x16x64_bf16 v[40:43], v[72:75], v[44:51], v0
ds_read_b128 v[44:47], v2 offset:16384
v_mov_b64 v[78:79], s[52:53]
s_waitcnt lgkmcnt(4)
v_mfma_f32_16x16x32_bf16 v[28:31], v[28:31], v[20:23], 0
ds_read_b128 v[48:51], v2 offset:17408
s_waitcnt lgkmcnt(3)
v_mfma_f32_16x16x32_bf16 v[28:31], v[32:35], v[24:27], v[28:31]
v_smfmac_f32_16x16x64_bf16 v[40:43], v[64:67], a[152:159], v0
s_waitcnt lgkmcnt(2)
v_max3_f32 v17, v12, v13, v14
v_smfmac_f32_16x16x64_bf16 v[36:39], v[64:67], a[144:151], v0
ds_read_b128 v[60:63], v2 offset:20480
v_add_f32_dpp v28, v30, v28 quad_perm:[2,3,0,1] row_mask:0xf bank_mask:0xf
v_add_f32_dpp v29, v31, v29 quad_perm:[2,3,0,1] row_mask:0xf bank_mask:0xf
v_max_f32 v17, v17, v15
v_max_f32 v16, v28, v29
v_mul_f32 v16, s50, v16
v_max_f32_dpp v17, v17, v17 quad_perm:[2,3,0,1] row_mask:0xf bank_mask:0xf
v_smfmac_f32_16x16x64_bf16 v[40:43], v[68:71], a[168:175], v0
ds_read_b128 v[64:67], v2 offset:21504
v_max_f32_dpp v18, v16, v17 quad_perm:[0,1,0,1] row_mask:0xf bank_mask:0xf
v_max_f32_dpp v19, v16, v17 quad_perm:[0,1,0,1] row_mask:0xf bank_mask:0xf
v_smfmac_f32_16x16x64_bf16 v[36:39], v[68:71], a[160:167], v0
ds_read_b128 v[68:71], v2 offset:26624
v_permlane16_swap_b32 v18, v19
v_max_f32 v20, v18, v19
v_max_f32 v21, v18, v19
s_waitcnt lgkmcnt(3)
v_smfmac_f32_16x16x64_bf16 v[36:39], v[72:75], v[44:51], v0
ds_read_b128 v[72:75], v2 offset:27648
v_permlane32_swap_b32 v20, v21
v_max_f32 v20, v20, v21
v_sub_f32 v12, v12, v20
v_sub_f32 v13, v13, v20
v_pk_add_f32 v[14:15], v[14:15], v[20:21] op_sel_hi:[1,0] neg_lo:[0,1] neg_hi:[0,1]
v_exp_f32 v12, v12
v_exp_f32 v13, v13
v_exp_f32 v14, v14
v_exp_f32 v15, v15
v_cvt_pk_bf16_f32 v16, v12, v13
v_cvt_pk_bf16_f32 v17, v14, v15
v_pk_fma_f32 v[28:29], v[28:29], s[50:51], v[20:21] op_sel_hi:[1,1,0] neg_lo:[0,0,1] neg_hi:[0,0,1]
v_mov_b32_dpp v18, v16 quad_perm:[2,3,0,1] row_mask:0xf bank_mask:0xf
v_mov_b32_dpp v19, v17 quad_perm:[2,3,0,1] row_mask:0xf bank_mask:0xf
v_exp_f32 v28, v28
s_waitcnt vmcnt(1)
v_mfma_f32_16x16x32_bf16 v[32:35], v[76:79], v[16:19], 0
v_exp_f32 v29, v29
v_mfma_f32_16x16x32_bf16 v[20:23], v[52:55], v[16:19], 0
v_cvt_pk_bf16_f32 v12, v28, v29
v_cvt_pk_bf16_f32 v13, v28, v29
v_mov_b64 v[14:15], s[0:1]
v_mfma_f32_16x16x32_bf16 v[24:27], v[56:59], v[16:19], 0
v_cvt_pk_bf16_f32 v36, v36, v37
v_cvt_pk_bf16_f32 v37, v38, v39
v_mfma_f32_16x16x16_bf16 v[32:35], v[14:15], v[12:13], v[32:35]
v_cvt_pk_bf16_f32 v38, v40, v41
v_cvt_pk_bf16_f32 v39, v42, v43
v_mfma_f32_16x16x16_bf16 v[20:23], v[36:37], v[12:13], v[20:23]
ds_read_b128 v[44:47], v2 offset:22528
v_mfma_f32_16x16x16_bf16 v[24:27], v[38:39], v[12:13], v[24:27]
ds_read_b128 v[48:51], v2 offset:23552
v_rcp_f32 v32, v32
v_mov_b64 v[28:29], 0
v_mov_b64 v[30:31], 0
v_pk_mul_f32 v[20:21], v[20:21], v[32:33] op_sel_hi:[1,0]
v_pk_mul_f32 v[22:23], v[22:23], v[32:33] op_sel_hi:[1,0]
v_cvt_pk_bf16_f32 v20, v20, v21
v_cvt_pk_bf16_f32 v21, v22, v23
ds_write_b64 v1, v[20:21] offset:6144
v_pk_mul_f32 v[24:25], v[24:25], v[32:33] op_sel_hi:[1,0]
v_pk_mul_f32 v[26:27], v[26:27], v[32:33] op_sel_hi:[1,0]
v_cvt_pk_bf16_f32 v24, v24, v25
v_cvt_pk_bf16_f32 v25, v26, v27
ds_write_b64 v1, v[24:25] offset:6152
v_mov_b64 v[76:77], 0
ds_read_b128 v[12:15], v7 offset:6144
v_mov_b64 v[78:79], 0
v_mov_b64 v[40:41], 0
v_mov_b64 v[42:43], 0
v_mov_b64 v[36:37], 0
v_mov_b64 v[38:39], 0
v_mov_b64 v[32:33], 0
v_mov_b64 v[34:35], 0
s_waitcnt lgkmcnt(1)
s_barrier
ds_read_b128 v[16:19], v7 offset:7168
ds_read_b128 v[52:55], v7 offset:8192
ds_read_b128 v[56:59], v7 offset:5120
s_waitcnt lgkmcnt(3)
v_smfmac_f32_16x16x64_bf16 v[28:31], v[12:15], a[176:183], v0 abid:1
v_smfmac_f32_16x16x64_bf16 v[76:79], v[12:15], a[184:191], v0 abid:1
s_waitcnt lgkmcnt(2)
v_smfmac_f32_16x16x64_bf16 v[28:31], v[16:19], v[44:51], v0 abid:1
ds_read_b128 v[44:47], v2 offset:24576
s_waitcnt lgkmcnt(2)
v_smfmac_f32_16x16x64_bf16 v[28:31], v[52:55], a[192:199], v0 abid:1
ds_read_b128 v[48:51], v2 offset:25600
s_waitcnt lgkmcnt(2)
v_smfmac_f32_16x16x64_bf16 v[28:31], v[56:59], v[60:67], v0 abid:1
ds_read_b128 v[60:63], v2 offset:30720
v_smfmac_f32_16x16x64_bf16 v[76:79], v[16:19], v[68:75], v0 abid:1
ds_read_b128 v[64:67], v2 offset:31744
v_smfmac_f32_16x16x64_bf16 v[76:79], v[52:55], a[200:207], v0 abid:1
ds_read_b128 v[68:71], v2 offset:28672
v_cvt_pk_bf16_f32 v28, v28, v29
v_cvt_pk_bf16_f32 v29, v30, v31
v_bfi_b32 v28, 1, s35, v28
buffer_store_dwordx2 v[28:29], v8, s[4:7], s42 offen sc0 sc1
s_waitcnt lgkmcnt(3)
v_smfmac_f32_16x16x64_bf16 v[76:79], v[56:59], v[44:51], v0 abid:1
ds_read_b128 v[72:75], v2 offset:29696
v_smfmac_f32_16x16x64_bf16 v[40:43], v[12:15], a[208:215], v0 abid:1
ds_read_b128 v[44:47], v2 offset:36864
s_waitcnt lgkmcnt(3)
v_smfmac_f32_16x16x64_bf16 v[40:43], v[16:19], v[60:67], v0 abid:1
ds_read_b128 v[48:51], v2 offset:37888
v_cvt_pk_bf16_f32 v76, v76, v77
v_cvt_pk_bf16_f32 v77, v78, v79
v_bfi_b32 v76, 1, s35, v76
buffer_store_dwordx2 v[76:77], v8, s[4:7], s43 offen sc0 sc1
v_smfmac_f32_16x16x64_bf16 v[40:43], v[52:55], a[216:223], v0 abid:1
ds_read_b128 v[60:63], v2 offset:34816
s_waitcnt lgkmcnt(3)
v_smfmac_f32_16x16x64_bf16 v[40:43], v[56:59], v[68:75], v0 abid:1
ds_read_b128 v[64:67], v2 offset:35840
v_smfmac_f32_16x16x64_bf16 v[36:39], v[12:15], a[224:231], v0 abid:1
ds_read_b128 v[68:71], v2 offset:38912
v_smfmac_f32_16x16x64_bf16 v[36:39], v[16:19], a[232:239], v0 abid:1
ds_read_b128 v[72:75], v2 offset:39936
v_cvt_pk_bf16_f32 v40, v40, v41
v_cvt_pk_bf16_f32 v41, v42, v43
v_bfi_b32 v40, 1, s35, v40
buffer_store_dwordx2 v[40:41], v8, s[4:7], s44 offen sc0 sc1
v_smfmac_f32_16x16x64_bf16 v[36:39], v[52:55], a[240:247], v0 abid:1
v_smfmac_f32_16x16x64_bf16 v[36:39], v[56:59], a[248:255], v0 abid:1
s_waitcnt lgkmcnt(4)
v_smfmac_f32_16x16x64_bf16 v[32:35], v[12:15], v[44:51], v0 abid:1
ds_read_b128 v[44:47], v2 offset:32768
s_waitcnt lgkmcnt(3)
v_smfmac_f32_16x16x64_bf16 v[32:35], v[16:19], v[60:67], v0 abid:1
ds_read_b128 v[48:51], v2 offset:33792
v_cvt_pk_bf16_f32 v36, v36, v37
v_cvt_pk_bf16_f32 v37, v38, v39
v_bfi_b32 v36, 1, s35, v36
buffer_store_dwordx2 v[36:37], v8, s[4:7], s45 offen sc0 sc1
s_waitcnt lgkmcnt(2)
v_smfmac_f32_16x16x64_bf16 v[32:35], v[52:55], v[68:75], v0 abid:1
s_waitcnt lgkmcnt(0)
v_smfmac_f32_16x16x64_bf16 v[32:35], v[56:59], v[44:51], v0 abid:1
s_nop 7
v_cvt_pk_bf16_f32 v32, v32, v33
v_cvt_pk_bf16_f32 v33, v34, v35
v_bfi_b32 v32, 1, s35, v32
buffer_store_dwordx2 v[32:33], v8, s[4:7], s46 offen sc0 sc1
s_branch L_ex_w1s
L_done_w1s:
s_waitcnt vmcnt(0) lgkmcnt(0)
s_endpgm
L_ra0_w1s:
s_mov_b32 m0, 1024
s_nop 0
buffer_load_dwordx4 v1, s[4:7], s47 offen offset:0 sc0 sc1 lds
buffer_load_dwordx4 v1, s[4:7], s47 offen offset:1024 sc0 sc1 lds
buffer_load_dwordx4 v1, s[4:7], s47 offen offset:2048 sc0 sc1 lds
buffer_load_dwordx4 v1, s[4:7], s47 offen offset:3072 sc0 sc1 lds
s_sub_u32 s41, s41, 1
s_cbranch_scc1 L_exit
ds_read_b128 v[44:47], v2 offset:0
ds_read_b128 v[48:51], v2 offset:1024
v_mov_b64 v[20:21], 0
v_mov_b64 v[22:23], 0
v_mov_b64 v[24:25], 0
v_mov_b64 v[26:27], 0
v_mov_b64 v[28:29], 0
v_mov_b64 v[30:31], 0
v_mov_b64 v[32:33], 0
v_mov_b64 v[34:35], 0
v_mov_b64 v[36:37], 0
v_mov_b64 v[38:39], 0
v_mov_b64 v[40:41], 0
v_mov_b64 v[42:43], 0
s_waitcnt vmcnt(0)
ds_read_b128 v[60:63], v1 offset:1024
ds_read_b128 v[64:67], v1 offset:2048
ds_read_b128 v[68:71], v1 offset:3072
ds_read_b128 v[72:75], v1 offset:4096
s_branch L_s0_w1s
L_ra1_w1s:
s_waitcnt lgkmcnt(0)
s_barrier
s_mov_b32 m0, 5120
s_nop 0
buffer_load_dwordx4 v1, s[4:7], s48 offen offset:1024 sc0 sc1 lds
s_sub_u32 s41, s41, 1
s_cbranch_scc1 L_exit
s_waitcnt vmcnt(0)
s_barrier
ds_read_b128 v[76:79], v1 offset:5120
ds_read_b128 v[60:63], v1 offset:6144
ds_read_b128 v[64:67], v1 offset:7168
ds_read_b128 v[68:71], v1 offset:8192
ds_read_b128 v[72:75], v1 offset:9216
s_waitcnt lgkmcnt(0)
v_bitop3_b32 v6, v76, v60, s35 bitop3:0x7e
v_bitop3_b32 v6, v6, v64, s35 bitop3:0xf6
v_bitop3_b32 v6, v6, v68, s35 bitop3:0xf6
v_bitop3_b32 v6, v6, v72, s35 bitop3:0xf6
v_and_b32 v6, 1, v6
v_cmp_ne_u32 vcc, 0, v6
v_lshlrev_b32 v6, 2, v1
s_cbranch_vccnz L_ra1_w1s
s_branch L_a1_w1s
L_pro_w1r:
v_and_b32 v20, 63, v0
v_and_b32 v21, 15, v0
v_bfe_u32 v22, v0, 4, 2
v_lshlrev_b32 v1, 4, v20
v_add_u32 v2, 57344, v1
v_lshrrev_b32 v24, 1, v22
v_and_b32 v23, 1, v22
v_lshl_add_u32 v23, v24, 3, v23
v_lshlrev_b32 v23, 13, v23
v_lshlrev_b32 v26, 1, v22
v_xor_b32 v26, v26, v21
v_lshl_add_u32 v26, v26, 4, v23
v_xor_b32 v27, 128, v26
v_and_b32 v23, 1, v22
v_lshl_add_u32 v23, v24, 4, v23
v_mul_u32_u24 v23, 1152, v23
v_lshlrev_b32 v28, 2, v22
v_xor_b32 v28, v28, v21
v_lshl_add_u32 v28, v28, 4, v23
s_lshl_b32 s54, s32, 8
s_mul_i32 s55, s32, 147456
s_waitcnt lgkmcnt(0)
s_add_u32 s56, s54, 655360
s_mov_b32 m0, 77824
s_nop 0
buffer_load_dwordx4 v26, s[8:11], s56 offen lds
s_add_u32 s56, s54, 671744
s_mov_b32 m0, 78848
s_nop 0
buffer_load_dwordx4 v26, s[8:11], s56 offen lds
s_add_u32 s56, s54, 688128
s_mov_b32 m0, 79872
s_nop 0
buffer_load_dwordx4 v27, s[8:11], s56 offen lds
s_add_u32 s56, s54, 704512
s_mov_b32 m0, 80896
s_nop 0
buffer_load_dwordx4 v27, s[8:11], s56 offen lds
s_add_u32 s56, s54, 1179648
s_mov_b32 m0, 81920
s_nop 0
buffer_load_dwordx4 v26, s[8:11], s56 offen lds
s_add_u32 s56, s54, 1196032
s_mov_b32 m0, 82944
s_nop 0
buffer_load_dwordx4 v26, s[8:11], s56 offen lds
s_add_u32 s56, s54, 1212416
s_mov_b32 m0, 83968
s_nop 0
buffer_load_dwordx4 v27, s[8:11], s56 offen lds
s_add_u32 s56, s54, 1228800
s_mov_b32 m0, 84992
s_nop 0
buffer_load_dwordx4 v27, s[8:11], s56 offen lds
v_and_b32 v23, 1, v22
v_lshrrev_b32 v24, 2, v21
v_lshl_add_u32 v23, v23, 2, v24
v_lshlrev_b32 v23, 1, v23
v_bfe_u32 v44, v21, 1, 1
v_add_u32 v44, 4, v44
v_xor_b32 v44, v44, v23
v_lshlrev_b32 v44, 4, v44
v_lshl_add_u32 v44, v24, 8, v44
v_and_b32 v23, 1, v22
v_lshl_add_u32 v44, v23, 11, v44
v_and_b32 v23, 1, v21
v_lshl_add_u32 v44, v23, 3, v44
v_lshrrev_b32 v23, 1, v22
v_mul_u32_u24 v23, 40960, v23
v_add_u32 v23, 16384, v23
v_add_u32 v44, v44, v23
v_and_b32 v23, 1, v22
v_lshrrev_b32 v24, 2, v21
v_lshl_add_u32 v23, v23, 2, v24
v_lshlrev_b32 v23, 1, v23
v_bfe_u32 v45, v21, 1, 1
v_add_u32 v45, 6, v45
v_xor_b32 v45, v45, v23
v_lshlrev_b32 v45, 4, v45
v_lshl_add_u32 v45, v24, 8, v45
v_and_b32 v23, 1, v22
v_lshl_add_u32 v45, v23, 11, v45
v_and_b32 v23, 1, v21
v_lshl_add_u32 v45, v23, 3, v45
v_lshrrev_b32 v23, 1, v22
v_mul_u32_u24 v23, 40960, v23
v_add_u32 v23, 16384, v23
v_add_u32 v45, v45, v23
v_and_b32 v23, 1, v22
v_lshrrev_b32 v24, 2, v21
v_lshl_add_u32 v23, v23, 2, v24
v_lshlrev_b32 v23, 1, v23
v_bfe_u32 v46, v21, 1, 1
v_add_u32 v46, 4, v46
v_xor_b32 v46, v46, v23
v_lshlrev_b32 v46, 4, v46
v_lshl_add_u32 v46, v24, 8, v46
v_and_b32 v23, 1, v22
v_lshl_add_u32 v46, v23, 11, v46
v_and_b32 v23, 1, v21
v_lshl_add_u32 v46, v23, 3, v46
v_lshrrev_b32 v23, 1, v22
v_mul_u32_u24 v23, 32768, v23
v_add_u32 v23, 98304, v23
v_add_u32 v46, v46, v23
v_and_b32 v23, 1, v22
v_lshrrev_b32 v24, 2, v21
v_lshl_add_u32 v23, v23, 2, v24
v_lshlrev_b32 v23, 1, v23
v_bfe_u32 v47, v21, 1, 1
v_add_u32 v47, 6, v47
v_xor_b32 v47, v47, v23
v_lshlrev_b32 v47, 4, v47
v_lshl_add_u32 v47, v24, 8, v47
v_and_b32 v23, 1, v22
v_lshl_add_u32 v47, v23, 11, v47
v_and_b32 v23, 1, v21
v_lshl_add_u32 v47, v23, 3, v47
v_lshrrev_b32 v23, 1, v22
v_mul_u32_u24 v23, 32768, v23
v_add_u32 v23, 98304, v23
v_add_u32 v47, v47, v23
v_and_b32 v23, 1, v22
v_bfe_u32 v24, v21, 2, 1
v_lshl_add_u32 v23, v23, 1, v24
v_xor_b32 v24, 1, v23
v_lshlrev_b32 v24, 6, v24
v_lshl_add_u32 v48, v23, 8, v24
v_and_b32 v23, 3, v21
v_lshl_add_u32 v48, v23, 4, v48
v_and_b32 v23, 8, v21
v_add_u32 v48, v48, v23
v_lshrrev_b32 v23, 1, v22
v_mul_u32_u24 v23, 40960, v23
v_add_u32 v23, 16384, v23
v_add_u32 v48, v48, v23
v_and_b32 v23, 1, v22
v_bfe_u32 v24, v21, 2, 1
v_lshl_add_u32 v23, v23, 1, v24
v_xor_b32 v24, 1, v23
v_lshlrev_b32 v24, 6, v24
v_lshl_add_u32 v49, v23, 8, v24
v_and_b32 v23, 3, v21
v_lshl_add_u32 v49, v23, 4, v49
v_and_b32 v23, 8, v21
v_add_u32 v49, v49, v23
v_lshrrev_b32 v23, 1, v22
v_mul_u32_u24 v23, 32768, v23
v_add_u32 v23, 98304, v23
v_add_u32 v49, v49, v23
v_bfe_u32 v23, v21, 1, 1
v_and_b32 v24, 1, v21
v_lshl_add_u32 v23, v24, 16, v23
v_mul_u32_u24 v23, 0xaaaa, v23
v_add_u32 v0, 0x44444444, v23
v_lshlrev_b32 v3, 3, v20
v_lshrrev_b32 v25, 5, v20
v_lshlrev_b32 v25, 6, v25
v_xor_b32 v3, v3, v25
v_lshrrev_b32 v25, 2, v20
v_and_b32 v4, 3, v21
v_lshl_add_u32 v4, v4, 4, v25
v_lshlrev_b32 v4, 3, v4
v_bfe_u32 v25, v21, 1, 1
v_lshlrev_b32 v23, 6, v25
v_xor_b32 v4, v4, v23
v_and_b32 v23, 2, v22
v_xor_b32 v5, v21, v23
v_lshlrev_b32 v5, 4, v5
v_lshl_add_u32 v5, v25, 10, v5
v_and_b32 v23, 1, v22
v_lshl_add_u32 v5, v23, 3, v5
v_lshlrev_b32 v9, 8, v22
v_lshl_add_u32 v9, v25, 6, v9
v_bfe_u32 v23, v21, 3, 1
v_lshl_add_u32 v9, v23, 7, v9
v_bfe_u32 v23, v21, 2, 1
v_lshl_add_u32 v9, v23, 5, v9
v_and_b32 v23, 1, v21
v_lshl_add_u32 v9, v23, 4, v9
v_lshrrev_b32 v23, 1, v22
v_and_b32 v24, 1, v22
v_and_b32 v25, 7, v21
v_lshrrev_b32 v7, 3, v21
v_lshl_add_u32 v8, v7, 1, v23
v_lshlrev_b32 v8, 12, v8
v_lshl_add_u32 v8, v24, 7, v8
v_and_b32 v25, 4, v21
v_lshl_add_u32 v8, v25, 3, v8
v_and_b32 v25, 1, v21
v_lshl_add_u32 v8, v25, 4, v8
v_bfe_u32 v25, v21, 1, 1
v_lshl_add_u32 v8, v25, 3, v8
s_lshr_b32 s56, s32, 1
s_lshl_b32 s56, s56, 8
s_and_b32 s57, s32, 1
s_lshl_b32 s57, s57, 6
s_add_u32 s56, s56, s57
s_add_u32 s56, s56, 16384
v_add_u32 v8, s56, v8
v_and_b32 v7, 12, v21
v_bfe_u32 v25, v21, 1, 1
v_add_u32 v7, v7, v25
v_lshlrev_b32 v7, 4, v7
v_lshl_add_u32 v7, v22, 8, v7
s_mov_b32 s42, 0
s_mov_b32 s43, 65536
s_mov_b32 s44, 131072
s_mov_b32 s45, 196608
s_mov_b32 s46, 262144
s_mov_b32 s47, 294912
s_mov_b32 s48, 299008
s_mov_b32 s49, 303104
s_mov_b32 s50, 0x3e0293ee
s_mov_b32 s51, 0x3e0293ee
s_mov_b32 s52, 0x3f803f80
s_mov_b32 s53, 0x3f803f80
v_and_b32 v11, 3, v21
v_cmp_eq_u32 vcc, 0, v11
s_nop 1
v_cndmask_b32 v11, 0, 1, vcc
s_mov_b32 s34, 0
s_mov_b32 s35, -1
s_mov_b32 s36, 0
s_mov_b32 s41, 300000
s_lshl_b32 s37, s32, 14
s_add_u32 s39, s37, 17305600
s_add_u32 s37, s37, 16781312
s_mov_b32 s40, 8749056
v_mov_b64 v[36:37], 0
v_mov_b64 v[38:39], 0
s_lshl_b32 s56, s32, 1
s_add_u32 s56, s56, 0
s_cmp_eq_u32 s56, 0
s_cselect_b32 s56, 64, s56
s_mul_i32 s56, s56, 10240
s_add_u32 s56, s56, 8392704
s_add_u32 s57, s56, 4096
v_mov_b32 v40, 0
v_mov_b32 v41, 0
v_mov_b32 v42, 0
v_mov_b32 v43, 0
buffer_store_dwordx4 v[40:43], v1, s[4:7], s56 offen offset:0 sc0 sc1
buffer_store_dwordx4 v[40:43], v1, s[4:7], s56 offen offset:1024 sc0 sc1
buffer_store_dwordx4 v[40:43], v1, s[4:7], s56 offen offset:2048 sc0 sc1
buffer_store_dwordx4 v[40:43], v1, s[4:7], s56 offen offset:3072 sc0 sc1
buffer_store_dwordx4 v[40:43], v1, s[4:7], s57 offen offset:0 sc0 sc1
s_add_u32 s56, s32, 64
s_lshl_b32 s3, s56, 12
v_and_b32 v23, 1, v21
v_bfe_u32 v24, v21, 2, 1
v_bfe_u32 v25, v21, 1, 1
s_lshl_b32 s57, s56, 7
s_add_u32 s57, s57, 294912
v_and_b32 v10, 7, v21
v_lshlrev_b32 v10, 2, v10
v_lshl_add_u32 v10, v22, 5, v10
v_add_u32 v10, s57, v10
s_lshl_b32 s33, s56, 2
s_add_u32 s33, s33, 304128
v_mov_b32 v30, -1
s_mov_b64 exec, 1
buffer_store_dword v30, v1, s[4:7], s33 offen sc0 sc1
s_mov_b64 exec, -1
v_lshl_add_u32 v23, v23, 1, v24
v_lshlrev_b32 v25, 4, v25
v_mov_b32 v24, 0x3f80
v_lshlrev_b32 v24, v25, v24
v_cmp_eq_u32 vcc, 0, v23
s_nop 1
v_cndmask_b32 v76, 0, v24, vcc
v_cmp_eq_u32 vcc, 1, v23
s_nop 1
v_cndmask_b32 v77, 0, v24, vcc
v_cmp_eq_u32 vcc, 2, v23
s_nop 1
v_cndmask_b32 v78, 0, v24, vcc
v_cmp_eq_u32 vcc, 3, v23
s_nop 1
v_cndmask_b32 v79, 0, v24, vcc
buffer_store_dwordx4 v[36:39], v9, s[4:7], s3 offen offset:0 sc0 sc1
buffer_store_dwordx4 v[36:39], v9, s[4:7], s3 offen offset:1024 sc0 sc1
buffer_store_dwordx4 v[36:39], v9, s[4:7], s3 offen offset:2048 sc0 sc1
buffer_store_dwordx4 v[36:39], v9, s[4:7], s3 offen offset:3072 sc0 sc1
s_getreg_b32 s56, hwreg(HW_REG_XCC_ID)
s_and_b32 s56, s56, 15
s_mul_i32 s57, s56, s56
s_lshl_b32 s57, s57, 18
s_lshl_b32 s56, s56, 8
s_add_u32 s57, s57, s56
s_add_u32 s58, s57, 1
s_lshl_b32 s101, s32, 7
s_add_u32 s101, s101, 327680
v_mov_b32 v24, 0
s_add_u32 s56, s54, 2752512
s_mov_b32 m0, 86016
s_nop 0
buffer_load_dwordx4 v26, s[8:11], s56 offen lds
s_add_u32 s56, s54, 2768896
s_mov_b32 m0, 87040
s_nop 0
buffer_load_dwordx4 v26, s[8:11], s56 offen lds
s_add_u32 s56, s54, 2785280
s_mov_b32 m0, 88064
s_nop 0
buffer_load_dwordx4 v27, s[8:11], s56 offen lds
s_add_u32 s56, s54, 2801664
s_mov_b32 m0, 89088
s_nop 0
buffer_load_dwordx4 v27, s[8:11], s56 offen lds
s_add_u32 s56, s54, 3276800
s_mov_b32 m0, 57344
s_nop 0
buffer_load_dwordx4 v26, s[8:11], s56 offen lds
s_add_u32 s56, s54, 3293184
s_mov_b32 m0, 58368
s_nop 0
buffer_load_dwordx4 v26, s[8:11], s56 offen lds
s_add_u32 s56, s54, 3309568
s_mov_b32 m0, 59392
s_nop 0
buffer_load_dwordx4 v27, s[8:11], s56 offen lds
s_add_u32 s56, s54, 3325952
s_mov_b32 m0, 60416
s_nop 0
buffer_load_dwordx4 v27, s[8:11], s56 offen lds
s_add_u32 s56, s54, 3801088
s_mov_b32 m0, 61440
s_nop 0
buffer_load_dwordx4 v26, s[8:11], s56 offen lds
s_add_u32 s56, s54, 3817472
s_mov_b32 m0, 62464
s_nop 0
buffer_load_dwordx4 v26, s[8:11], s56 offen lds
s_add_u32 s56, s54, 3833856
s_mov_b32 m0, 63488
s_nop 0
buffer_load_dwordx4 v27, s[8:11], s56 offen lds
s_add_u32 s56, s54, 3850240
s_mov_b32 m0, 64512
s_nop 0
buffer_load_dwordx4 v27, s[8:11], s56 offen lds
s_add_u32 s56, s54, 4325376
s_mov_b32 m0, 65536
s_nop 0
buffer_load_dwordx4 v26, s[8:11], s56 offen lds
s_add_u32 s56, s54, 4341760
s_mov_b32 m0, 66560
s_nop 0
buffer_load_dwordx4 v26, s[8:11], s56 offen lds
s_add_u32 s56, s54, 4358144
s_mov_b32 m0, 67584
s_nop 0
buffer_load_dwordx4 v27, s[8:11], s56 offen lds
s_add_u32 s56, s54, 4374528
s_mov_b32 m0, 68608
s_nop 0
buffer_load_dwordx4 v27, s[8:11], s56 offen lds
s_add_u32 s56, s54, 131072
s_mov_b32 m0, 69632
s_nop 0
buffer_load_dwordx4 v26, s[12:15], s56 offen lds
s_add_u32 s56, s54, 147456
s_mov_b32 m0, 70656
s_nop 0
buffer_load_dwordx4 v26, s[12:15], s56 offen lds
s_add_u32 s56, s54, 163840
s_mov_b32 m0, 71680
s_nop 0
buffer_load_dwordx4 v27, s[12:15], s56 offen lds
s_add_u32 s56, s54, 180224
s_mov_b32 m0, 72704
s_nop 0
buffer_load_dwordx4 v27, s[12:15], s56 offen lds
s_add_u32 s56, s54, 655360
s_mov_b32 m0, 73728
s_nop 0
buffer_load_dwordx4 v26, s[12:15], s56 offen lds
s_add_u32 s56, s54, 671744
s_mov_b32 m0, 74752
s_nop 0
buffer_load_dwordx4 v26, s[12:15], s56 offen lds
s_add_u32 s56, s54, 688128
s_mov_b32 m0, 75776
s_nop 0
buffer_load_dwordx4 v27, s[12:15], s56 offen lds
s_add_u32 s56, s54, 704512
s_mov_b32 m0, 76800
s_nop 0
buffer_load_dwordx4 v27, s[12:15], s56 offen lds
v_and_b32 v23, 3, v20
v_lshrrev_b32 v24, 2, v20
v_mul_u32_u24 v29, 1152, v24
v_lshl_add_u32 v29, v23, 4, v29
v_lshrrev_b32 v24, 2, v21
v_and_b32 v25, 1, v22
v_lshlrev_b32 v31, 10, v25
v_lshrrev_b32 v25, 1, v22
v_lshl_add_u32 v31, v25, 8, v31
v_and_b32 v25, 1, v24
v_lshl_add_u32 v31, v25, 6, v31
v_lshrrev_b32 v25, 1, v24
v_lshl_add_u32 v31, v25, 3, v31
v_lshl_add_u32 v31, v23, 4, v31
v_add_u32 v31, 57344, v31
s_add_u32 s56, s55, 1088
s_mov_b32 m0, 90112
s_nop 0
buffer_load_dwordx4 v29, s[20:23], s56 offen lds
s_add_u32 s56, s55, 19520
s_mov_b32 m0, 91136
s_nop 0
buffer_load_dwordx4 v29, s[20:23], s56 offen lds
s_add_u32 s56, s55, 37952
s_mov_b32 m0, 94208
s_nop 0
buffer_load_dwordx4 v29, s[20:23], s56 offen lds
s_add_u32 s56, s55, 56384
s_mov_b32 m0, 95232
s_nop 0
buffer_load_dwordx4 v29, s[20:23], s56 offen lds
s_add_u32 s56, s55, 74816
s_mov_b32 m0, 92160
s_nop 0
buffer_load_dwordx4 v29, s[20:23], s56 offen lds
s_add_u32 s56, s55, 93248
s_mov_b32 m0, 93184
s_nop 0
buffer_load_dwordx4 v29, s[20:23], s56 offen lds
s_add_u32 s56, s55, 111680
s_mov_b32 m0, 96256
s_nop 0
buffer_load_dwordx4 v29, s[20:23], s56 offen lds
s_add_u32 s56, s55, 130112
s_mov_b32 m0, 97280
s_nop 0
buffer_load_dwordx4 v29, s[20:23], s56 offen lds
v_mov_b32 v24, 0
s_waitcnt vmcnt(46)
s_barrier
ds_read_b64_tr_b16 v[80:81], v44 offset:20480
ds_read_b64_tr_b16 v[82:83], v44 offset:21504
ds_read_b64_tr_b16 v[84:85], v46 offset:20480
ds_read_b64_tr_b16 v[86:87], v46 offset:21504
ds_read_b64_tr_b16 v[88:89], v45 offset:20480
ds_read_b64_tr_b16 v[90:91], v45 offset:21504
ds_read_b64_tr_b16 v[92:93], v47 offset:20480
ds_read_b64_tr_b16 v[94:95], v47 offset:21504
s_waitcnt lgkmcnt(0)
s_waitcnt vmcnt(42)
s_barrier
s_add_u32 s56, s54, 1179648
s_mov_b32 m0, 77824
s_nop 0
buffer_load_dwordx4 v26, s[12:15], s56 offen lds
s_add_u32 s56, s54, 1196032
s_mov_b32 m0, 78848
s_nop 0
buffer_load_dwordx4 v26, s[12:15], s56 offen lds
s_add_u32 s56, s54, 1212416
s_mov_b32 m0, 79872
s_nop 0
buffer_load_dwordx4 v27, s[12:15], s56 offen lds
s_add_u32 s56, s54, 1228800
s_mov_b32 m0, 80896
s_nop 0
buffer_load_dwordx4 v27, s[12:15], s56 offen lds
ds_read_b64_tr_b16 v[96:97], v44 offset:24576
ds_read_b64_tr_b16 v[98:99], v44 offset:25600
ds_read_b64_tr_b16 v[100:101], v46 offset:24576
ds_read_b64_tr_b16 v[102:103], v46 offset:25600
ds_read_b64_tr_b16 v[104:105], v45 offset:24576
ds_read_b64_tr_b16 v[106:107], v45 offset:25600
ds_read_b64_tr_b16 v[108:109], v47 offset:24576
ds_read_b64_tr_b16 v[110:111], v47 offset:25600
s_waitcnt lgkmcnt(0)
s_waitcnt vmcnt(32)
s_barrier
s_add_u32 s56, s54, 1703936
s_mov_b32 m0, 81920
s_nop 0
buffer_load_dwordx4 v26, s[12:15], s56 offen lds
s_add_u32 s56, s54, 1720320
s_mov_b32 m0, 82944
s_nop 0
buffer_load_dwordx4 v26, s[12:15], s56 offen lds
s_add_u32 s56, s54, 1736704
s_mov_b32 m0, 83968
s_nop 0
buffer_load_dwordx4 v27, s[12:15], s56 offen lds
s_add_u32 s56, s54, 1753088
s_mov_b32 m0, 84992
s_nop 0
buffer_load_dwordx4 v27, s[12:15], s56 offen lds
ds_read_b64_tr_b16 v[112:113], v44 offset:28672
ds_read_b64_tr_b16 v[114:115], v44 offset:29696
ds_read_b64_tr_b16 v[116:117], v46 offset:28672
ds_read_b64_tr_b16 v[118:119], v46 offset:29696
ds_read_b64_tr_b16 v[120:121], v45 offset:28672
ds_read_b64_tr_b16 v[122:123], v45 offset:29696
ds_read_b64_tr_b16 v[124:125], v47 offset:28672
ds_read_b64_tr_b16 v[126:127], v47 offset:29696
s_waitcnt lgkmcnt(0)
s_waitcnt vmcnt(32)
s_barrier
s_add_u32 s56, s54, 2228224
s_mov_b32 m0, 86016
s_nop 0
buffer_load_dwordx4 v26, s[12:15], s56 offen lds
s_add_u32 s56, s54, 2244608
s_mov_b32 m0, 87040
s_nop 0
buffer_load_dwordx4 v26, s[12:15], s56 offen lds
s_add_u32 s56, s54, 2260992
s_mov_b32 m0, 88064
s_nop 0
buffer_load_dwordx4 v27, s[12:15], s56 offen lds
s_add_u32 s56, s54, 2277376
s_mov_b32 m0, 89088
s_nop 0
buffer_load_dwordx4 v27, s[12:15], s56 offen lds
ds_read_b64_tr_b16 v[128:129], v44 offset:0
ds_read_b64_tr_b16 v[130:131], v44 offset:1024
ds_read_b64_tr_b16 v[132:133], v46 offset:0
ds_read_b64_tr_b16 v[134:135], v46 offset:1024
ds_read_b64_tr_b16 v[136:137], v45 offset:0
ds_read_b64_tr_b16 v[138:139], v45 offset:1024
ds_read_b64_tr_b16 v[140:141], v47 offset:0
ds_read_b64_tr_b16 v[142:143], v47 offset:1024
s_waitcnt lgkmcnt(0)
s_waitcnt vmcnt(32)
s_barrier
s_add_u32 s56, s54, 3276800
s_mov_b32 m0, 57344
s_nop 0
buffer_load_dwordx4 v26, s[12:15], s56 offen lds
s_add_u32 s56, s54, 3293184
s_mov_b32 m0, 58368
s_nop 0
buffer_load_dwordx4 v26, s[12:15], s56 offen lds
s_add_u32 s56, s54, 3309568
s_mov_b32 m0, 59392
s_nop 0
buffer_load_dwordx4 v27, s[12:15], s56 offen lds
s_add_u32 s56, s54, 3325952
s_mov_b32 m0, 60416
s_nop 0
buffer_load_dwordx4 v27, s[12:15], s56 offen lds
ds_read_b64_tr_b16 v[144:145], v44 offset:4096
ds_read_b64_tr_b16 v[146:147], v44 offset:5120
ds_read_b64_tr_b16 v[148:149], v46 offset:4096
ds_read_b64_tr_b16 v[150:151], v46 offset:5120
ds_read_b64_tr_b16 v[152:153], v45 offset:4096
ds_read_b64_tr_b16 v[154:155], v45 offset:5120
ds_read_b64_tr_b16 v[156:157], v47 offset:4096
ds_read_b64_tr_b16 v[158:159], v47 offset:5120
s_waitcnt lgkmcnt(0)
s_waitcnt vmcnt(32)
s_barrier
s_add_u32 s56, s54, 3801088
s_mov_b32 m0, 61440
s_nop 0
buffer_load_dwordx4 v26, s[12:15], s56 offen lds
s_add_u32 s56, s54, 3817472
s_mov_b32 m0, 62464
s_nop 0
buffer_load_dwordx4 v26, s[12:15], s56 offen lds
s_add_u32 s56, s54, 3833856
s_mov_b32 m0, 63488
s_nop 0
buffer_load_dwordx4 v27, s[12:15], s56 offen lds
s_add_u32 s56, s54, 3850240
s_mov_b32 m0, 64512
s_nop 0
buffer_load_dwordx4 v27, s[12:15], s56 offen lds
ds_read_b64_tr_b16 v[160:161], v44 offset:8192
ds_read_b64_tr_b16 v[162:163], v44 offset:9216
ds_read_b64_tr_b16 v[164:165], v46 offset:8192
ds_read_b64_tr_b16 v[166:167], v46 offset:9216
ds_read_b64_tr_b16 v[168:169], v45 offset:8192
ds_read_b64_tr_b16 v[170:171], v45 offset:9216
ds_read_b64_tr_b16 v[172:173], v47 offset:8192
ds_read_b64_tr_b16 v[174:175], v47 offset:9216
s_waitcnt lgkmcnt(0)
s_waitcnt vmcnt(32)
s_barrier
s_add_u32 s56, s54, 4325376
s_mov_b32 m0, 65536
s_nop 0
buffer_load_dwordx4 v26, s[12:15], s56 offen lds
s_add_u32 s56, s54, 4341760
s_mov_b32 m0, 66560
s_nop 0
buffer_load_dwordx4 v26, s[12:15], s56 offen lds
s_add_u32 s56, s54, 4358144
s_mov_b32 m0, 67584
s_nop 0
buffer_load_dwordx4 v27, s[12:15], s56 offen lds
s_add_u32 s56, s54, 4374528
s_mov_b32 m0, 68608
s_nop 0
buffer_load_dwordx4 v27, s[12:15], s56 offen lds
ds_read_b64_tr_b16 v[176:177], v44 offset:12288
ds_read_b64_tr_b16 v[178:179], v44 offset:13312
ds_read_b64_tr_b16 v[180:181], v46 offset:12288
ds_read_b64_tr_b16 v[182:183], v46 offset:13312
ds_read_b64_tr_b16 v[184:185], v45 offset:12288
ds_read_b64_tr_b16 v[186:187], v45 offset:13312
ds_read_b64_tr_b16 v[188:189], v47 offset:12288
ds_read_b64_tr_b16 v[190:191], v47 offset:13312
s_waitcnt lgkmcnt(0)
s_waitcnt vmcnt(32)
s_barrier
s_add_u32 s56, s54, 131072
s_mov_b32 m0, 69632
s_nop 0
buffer_load_dwordx4 v26, s[16:19], s56 offen lds
s_add_u32 s56, s54, 147456
s_mov_b32 m0, 70656
s_nop 0
buffer_load_dwordx4 v26, s[16:19], s56 offen lds
s_add_u32 s56, s54, 163840
s_mov_b32 m0, 71680
s_nop 0
buffer_load_dwordx4 v27, s[16:19], s56 offen lds
s_add_u32 s56, s54, 180224
s_mov_b32 m0, 72704
s_nop 0
buffer_load_dwordx4 v27, s[16:19], s56 offen lds
ds_read_b64_tr_b16 v[192:193], v44 offset:16384
ds_read_b64_tr_b16 v[194:195], v44 offset:17408
ds_read_b64_tr_b16 v[196:197], v46 offset:16384
ds_read_b64_tr_b16 v[198:199], v46 offset:17408
ds_read_b64_tr_b16 v[200:201], v45 offset:16384
ds_read_b64_tr_b16 v[202:203], v45 offset:17408
ds_read_b64_tr_b16 v[204:205], v47 offset:16384
ds_read_b64_tr_b16 v[206:207], v47 offset:17408
s_waitcnt lgkmcnt(0)
s_waitcnt vmcnt(24)
s_barrier
s_add_u32 s56, s54, 655360
s_mov_b32 m0, 73728
s_nop 0
buffer_load_dwordx4 v26, s[16:19], s56 offen lds
s_add_u32 s56, s54, 671744
s_mov_b32 m0, 74752
s_nop 0
buffer_load_dwordx4 v26, s[16:19], s56 offen lds
s_add_u32 s56, s54, 688128
s_mov_b32 m0, 75776
s_nop 0
buffer_load_dwordx4 v27, s[16:19], s56 offen lds
s_add_u32 s56, s54, 704512
s_mov_b32 m0, 76800
s_nop 0
buffer_load_dwordx4 v27, s[16:19], s56 offen lds
ds_read_b64_tr_b16 v[208:209], v44 offset:20480
ds_read_b64_tr_b16 v[210:211], v44 offset:21504
ds_read_b64_tr_b16 v[212:213], v46 offset:20480
ds_read_b64_tr_b16 v[214:215], v46 offset:21504
ds_read_b64_tr_b16 v[216:217], v45 offset:20480
ds_read_b64_tr_b16 v[218:219], v45 offset:21504
ds_read_b64_tr_b16 v[220:221], v47 offset:20480
ds_read_b64_tr_b16 v[222:223], v47 offset:21504
s_waitcnt lgkmcnt(0)
s_waitcnt vmcnt(24)
s_barrier
s_add_u32 s56, s54, 1179648
s_mov_b32 m0, 77824
s_nop 0
buffer_load_dwordx4 v26, s[16:19], s56 offen lds
s_add_u32 s56, s54, 1196032
s_mov_b32 m0, 78848
s_nop 0
buffer_load_dwordx4 v26, s[16:19], s56 offen lds
s_add_u32 s56, s54, 1212416
s_mov_b32 m0, 79872
s_nop 0
buffer_load_dwordx4 v27, s[16:19], s56 offen lds
s_add_u32 s56, s54, 1228800
s_mov_b32 m0, 80896
s_nop 0
buffer_load_dwordx4 v27, s[16:19], s56 offen lds
ds_read_b64_tr_b16 v[224:225], v44 offset:24576
ds_read_b64_tr_b16 v[226:227], v44 offset:25600
ds_read_b64_tr_b16 v[228:229], v46 offset:24576
ds_read_b64_tr_b16 v[230:231], v46 offset:25600
ds_read_b64_tr_b16 v[232:233], v45 offset:24576
ds_read_b64_tr_b16 v[234:235], v45 offset:25600
ds_read_b64_tr_b16 v[236:237], v47 offset:24576
ds_read_b64_tr_b16 v[238:239], v47 offset:25600
ds_read_b64_tr_b16 v[60:61], v31 offset:32768
ds_read_b64_tr_b16 v[62:63], v31 offset:32896
ds_read_b64_tr_b16 v[64:65], v31 offset:33280
ds_read_b64_tr_b16 v[66:67], v31 offset:33408
ds_read_b64_tr_b16 v[68:69], v31 offset:34816
ds_read_b64_tr_b16 v[70:71], v31 offset:34944
ds_read_b64_tr_b16 v[72:73], v31 offset:35328
ds_read_b64_tr_b16 v[74:75], v31 offset:35456
s_waitcnt lgkmcnt(0)
ds_write_b128 v2, v[60:63] offset:32768
ds_write_b128 v2, v[64:67] offset:33792
ds_write_b128 v2, v[68:71] offset:34816
ds_write_b128 v2, v[72:75] offset:35840
s_waitcnt lgkmcnt(0)
s_waitcnt vmcnt(24)
s_barrier
s_add_u32 s56, s54, 1703936
s_mov_b32 m0, 81920
s_nop 0
buffer_load_dwordx4 v26, s[16:19], s56 offen lds
s_add_u32 s56, s54, 1720320
s_mov_b32 m0, 82944
s_nop 0
buffer_load_dwordx4 v26, s[16:19], s56 offen lds
s_add_u32 s56, s54, 1736704
s_mov_b32 m0, 83968
s_nop 0
buffer_load_dwordx4 v27, s[16:19], s56 offen lds
s_add_u32 s56, s54, 1753088
s_mov_b32 m0, 84992
s_nop 0
buffer_load_dwordx4 v27, s[16:19], s56 offen lds
ds_read_b64_tr_b16 v[240:241], v44 offset:28672
ds_read_b64_tr_b16 v[242:243], v44 offset:29696
ds_read_b64_tr_b16 v[244:245], v46 offset:28672
ds_read_b64_tr_b16 v[246:247], v46 offset:29696
ds_read_b64_tr_b16 v[248:249], v45 offset:28672
ds_read_b64_tr_b16 v[250:251], v45 offset:29696
ds_read_b64_tr_b16 v[252:253], v47 offset:28672
ds_read_b64_tr_b16 v[254:255], v47 offset:29696
ds_read_b64_tr_b16 v[60:61], v31 offset:36864
ds_read_b64_tr_b16 v[62:63], v31 offset:36992
ds_read_b64_tr_b16 v[64:65], v31 offset:37376
ds_read_b64_tr_b16 v[66:67], v31 offset:37504
ds_read_b64_tr_b16 v[68:69], v31 offset:38912
ds_read_b64_tr_b16 v[70:71], v31 offset:39040
ds_read_b64_tr_b16 v[72:73], v31 offset:39424
ds_read_b64_tr_b16 v[74:75], v31 offset:39552
s_waitcnt lgkmcnt(0)
ds_write_b128 v2, v[60:63] offset:36864
ds_write_b128 v2, v[64:67] offset:37888
ds_write_b128 v2, v[68:71] offset:38912
ds_write_b128 v2, v[72:75] offset:39936
s_waitcnt lgkmcnt(0)
s_waitcnt vmcnt(24)
s_barrier
s_add_u32 s56, s54, 2228224
s_mov_b32 m0, 86016
s_nop 0
buffer_load_dwordx4 v26, s[16:19], s56 offen lds
s_add_u32 s56, s54, 2244608
s_mov_b32 m0, 87040
s_nop 0
buffer_load_dwordx4 v26, s[16:19], s56 offen lds
s_add_u32 s56, s54, 2260992
s_mov_b32 m0, 88064
s_nop 0
buffer_load_dwordx4 v27, s[16:19], s56 offen lds
s_add_u32 s56, s54, 2277376
s_mov_b32 m0, 89088
s_nop 0
buffer_load_dwordx4 v27, s[16:19], s56 offen lds
ds_read_b64_tr_b16 a[0:1], v44 offset:0
ds_read_b64_tr_b16 a[2:3], v44 offset:1024
ds_read_b64_tr_b16 a[4:5], v46 offset:0
ds_read_b64_tr_b16 a[6:7], v46 offset:1024
ds_read_b64_tr_b16 a[8:9], v45 offset:0
ds_read_b64_tr_b16 a[10:11], v45 offset:1024
ds_read_b64_tr_b16 a[12:13], v47 offset:0
ds_read_b64_tr_b16 a[14:15], v47 offset:1024
s_waitcnt lgkmcnt(0)
s_waitcnt vmcnt(24)
s_barrier
s_add_u32 s56, s54, 2752512
s_mov_b32 m0, 57344
s_nop 0
buffer_load_dwordx4 v26, s[16:19], s56 offen lds
s_add_u32 s56, s54, 2768896
s_mov_b32 m0, 58368
s_nop 0
buffer_load_dwordx4 v26, s[16:19], s56 offen lds
s_add_u32 s56, s54, 2785280
s_mov_b32 m0, 59392
s_nop 0
buffer_load_dwordx4 v27, s[16:19], s56 offen lds
s_add_u32 s56, s54, 2801664
s_mov_b32 m0, 60416
s_nop 0
buffer_load_dwordx4 v27, s[16:19], s56 offen lds
ds_read_b64_tr_b16 a[16:17], v44 offset:4096
ds_read_b64_tr_b16 a[18:19], v44 offset:5120
ds_read_b64_tr_b16 a[20:21], v46 offset:4096
ds_read_b64_tr_b16 a[22:23], v46 offset:5120
ds_read_b64_tr_b16 a[24:25], v45 offset:4096
ds_read_b64_tr_b16 a[26:27], v45 offset:5120
ds_read_b64_tr_b16 a[28:29], v47 offset:4096
ds_read_b64_tr_b16 a[30:31], v47 offset:5120
s_waitcnt lgkmcnt(0)
s_waitcnt vmcnt(24)
s_barrier
s_add_u32 s56, s54, 3276800
s_mov_b32 m0, 61440
s_nop 0
buffer_load_dwordx4 v26, s[16:19], s56 offen lds
s_add_u32 s56, s54, 3293184
s_mov_b32 m0, 62464
s_nop 0
buffer_load_dwordx4 v26, s[16:19], s56 offen lds
s_add_u32 s56, s54, 3309568
s_mov_b32 m0, 63488
s_nop 0
buffer_load_dwordx4 v27, s[16:19], s56 offen lds
s_add_u32 s56, s54, 3325952
s_mov_b32 m0, 64512
s_nop 0
buffer_load_dwordx4 v27, s[16:19], s56 offen lds
ds_read_b64_tr_b16 a[32:33], v44 offset:8192
ds_read_b64_tr_b16 a[34:35], v44 offset:9216
ds_read_b64_tr_b16 a[36:37], v46 offset:8192
ds_read_b64_tr_b16 a[38:39], v46 offset:9216
ds_read_b64_tr_b16 a[40:41], v45 offset:8192
ds_read_b64_tr_b16 a[42:43], v45 offset:9216
ds_read_b64_tr_b16 a[44:45], v47 offset:8192
ds_read_b64_tr_b16 a[46:47], v47 offset:9216
s_waitcnt lgkmcnt(0)
s_waitcnt vmcnt(24)
s_barrier
s_add_u32 s56, s54, 3801088
s_mov_b32 m0, 65536
s_nop 0
buffer_load_dwordx4 v26, s[16:19], s56 offen lds
s_add_u32 s56, s54, 3817472
s_mov_b32 m0, 66560
s_nop 0
buffer_load_dwordx4 v26, s[16:19], s56 offen lds
s_add_u32 s56, s54, 3833856
s_mov_b32 m0, 67584
s_nop 0
buffer_load_dwordx4 v27, s[16:19], s56 offen lds
s_add_u32 s56, s54, 3850240
s_mov_b32 m0, 68608
s_nop 0
buffer_load_dwordx4 v27, s[16:19], s56 offen lds
ds_read_b64_tr_b16 a[48:49], v44 offset:12288
ds_read_b64_tr_b16 a[50:51], v44 offset:13312
ds_read_b64_tr_b16 a[52:53], v46 offset:12288
ds_read_b64_tr_b16 a[54:55], v46 offset:13312
ds_read_b64_tr_b16 a[56:57], v45 offset:12288
ds_read_b64_tr_b16 a[58:59], v45 offset:13312
ds_read_b64_tr_b16 a[60:61], v47 offset:12288
ds_read_b64_tr_b16 a[62:63], v47 offset:13312
s_waitcnt lgkmcnt(0)
s_waitcnt vmcnt(24)
s_barrier
s_add_u32 s56, s55, 41472
s_mov_b32 m0, 69632
s_nop 0
buffer_load_dwordx4 v28, s[20:23], s56 offen lds
s_add_u32 s56, s55, 43776
s_mov_b32 m0, 70656
s_nop 0
buffer_load_dwordx4 v28, s[20:23], s56 offen lds
s_add_u32 s56, s55, 50688
s_mov_b32 m0, 71680
s_nop 0
buffer_load_dwordx4 v28, s[20:23], s56 offen lds
s_add_u32 s56, s55, 52992
s_mov_b32 m0, 72704
s_nop 0
buffer_load_dwordx4 v28, s[20:23], s56 offen lds
ds_read_b64_tr_b16 a[64:65], v44 offset:16384
ds_read_b64_tr_b16 a[66:67], v44 offset:17408
ds_read_b64_tr_b16 a[68:69], v46 offset:16384
ds_read_b64_tr_b16 a[70:71], v46 offset:17408
ds_read_b64_tr_b16 a[72:73], v45 offset:16384
ds_read_b64_tr_b16 a[74:75], v45 offset:17408
ds_read_b64_tr_b16 a[76:77], v47 offset:16384
ds_read_b64_tr_b16 a[78:79], v47 offset:17408
s_waitcnt lgkmcnt(0)
s_waitcnt vmcnt(24)
s_barrier
s_add_u32 s56, s55, 41728
s_mov_b32 m0, 73728
s_nop 0
buffer_load_dwordx4 v28, s[20:23], s56 offen lds
s_add_u32 s56, s55, 44032
s_mov_b32 m0, 74752
s_nop 0
buffer_load_dwordx4 v28, s[20:23], s56 offen lds
s_add_u32 s56, s55, 50944
s_mov_b32 m0, 75776
s_nop 0
buffer_load_dwordx4 v28, s[20:23], s56 offen lds
s_add_u32 s56, s55, 53248
s_mov_b32 m0, 76800
s_nop 0
buffer_load_dwordx4 v28, s[20:23], s56 offen lds
ds_read_b64_tr_b16 a[80:81], v44 offset:20480
ds_read_b64_tr_b16 a[82:83], v44 offset:21504
ds_read_b64_tr_b16 a[84:85], v46 offset:20480
ds_read_b64_tr_b16 a[86:87], v46 offset:21504
ds_read_b64_tr_b16 a[88:89], v45 offset:20480
ds_read_b64_tr_b16 a[90:91], v45 offset:21504
ds_read_b64_tr_b16 a[92:93], v47 offset:20480
ds_read_b64_tr_b16 a[94:95], v47 offset:21504
s_waitcnt lgkmcnt(0)
s_waitcnt vmcnt(24)
s_barrier
s_add_u32 s56, s55, 41984
s_mov_b32 m0, 77824
s_nop 0
buffer_load_dwordx4 v28, s[20:23], s56 offen lds
s_add_u32 s56, s55, 44288
s_mov_b32 m0, 78848
s_nop 0
buffer_load_dwordx4 v28, s[20:23], s56 offen lds
s_add_u32 s56, s55, 51200
s_mov_b32 m0, 79872
s_nop 0
buffer_load_dwordx4 v28, s[20:23], s56 offen lds
s_add_u32 s56, s55, 53504
s_mov_b32 m0, 80896
s_nop 0
buffer_load_dwordx4 v28, s[20:23], s56 offen lds
ds_read_b64_tr_b16 a[96:97], v44 offset:24576
ds_read_b64_tr_b16 a[98:99], v44 offset:25600
ds_read_b64_tr_b16 a[100:101], v46 offset:24576
ds_read_b64_tr_b16 a[102:103], v46 offset:25600
ds_read_b64_tr_b16 a[104:105], v45 offset:24576
ds_read_b64_tr_b16 a[106:107], v45 offset:25600
ds_read_b64_tr_b16 a[108:109], v47 offset:24576
ds_read_b64_tr_b16 a[110:111], v47 offset:25600
s_waitcnt lgkmcnt(0)
s_waitcnt vmcnt(24)
s_barrier
s_add_u32 s56, s55, 42240
s_mov_b32 m0, 81920
s_nop 0
buffer_load_dwordx4 v28, s[20:23], s56 offen lds
s_add_u32 s56, s55, 44544
s_mov_b32 m0, 82944
s_nop 0
buffer_load_dwordx4 v28, s[20:23], s56 offen lds
s_add_u32 s56, s55, 51456
s_mov_b32 m0, 83968
s_nop 0
buffer_load_dwordx4 v28, s[20:23], s56 offen lds
s_add_u32 s56, s55, 53760
s_mov_b32 m0, 84992
s_nop 0
buffer_load_dwordx4 v28, s[20:23], s56 offen lds
ds_read_b64_tr_b16 a[112:113], v44 offset:28672
ds_read_b64_tr_b16 a[114:115], v44 offset:29696
ds_read_b64_tr_b16 a[116:117], v46 offset:28672
ds_read_b64_tr_b16 a[118:119], v46 offset:29696
ds_read_b64_tr_b16 a[120:121], v45 offset:28672
ds_read_b64_tr_b16 a[122:123], v45 offset:29696
ds_read_b64_tr_b16 a[124:125], v47 offset:28672
ds_read_b64_tr_b16 a[126:127], v47 offset:29696
s_waitcnt lgkmcnt(0)
s_waitcnt vmcnt(24)
s_barrier
s_add_u32 s56, s55, 5376
s_mov_b32 m0, 86016
s_nop 0
buffer_load_dwordx4 v28, s[20:23], s56 offen lds
s_add_u32 s56, s55, 7680
s_mov_b32 m0, 87040
s_nop 0
buffer_load_dwordx4 v28, s[20:23], s56 offen lds
s_add_u32 s56, s55, 14592
s_mov_b32 m0, 88064
s_nop 0
buffer_load_dwordx4 v28, s[20:23], s56 offen lds
s_add_u32 s56, s55, 16896
s_mov_b32 m0, 89088
s_nop 0
buffer_load_dwordx4 v28, s[20:23], s56 offen lds
ds_read_b64_tr_b16 a[128:129], v44 offset:0
ds_read_b64_tr_b16 a[130:131], v44 offset:1024
ds_read_b64_tr_b16 a[132:133], v46 offset:0
ds_read_b64_tr_b16 a[134:135], v46 offset:1024
ds_read_b64_tr_b16 a[136:137], v45 offset:0
ds_read_b64_tr_b16 a[138:139], v45 offset:1024
ds_read_b64_tr_b16 a[140:141], v47 offset:0
ds_read_b64_tr_b16 a[142:143], v47 offset:1024
buffer_load_dword v32, v24, s[28:31], 0 offen sc0 sc1
s_waitcnt lgkmcnt(0)
s_waitcnt vmcnt(25)
s_barrier
s_add_u32 s56, s54, 131072
s_mov_b32 m0, 57344
s_nop 0
buffer_load_dwordx4 v26, s[8:11], s56 offen lds
s_add_u32 s56, s54, 147456
s_mov_b32 m0, 58368
s_nop 0
buffer_load_dwordx4 v26, s[8:11], s56 offen lds
s_add_u32 s56, s54, 163840
s_mov_b32 m0, 59392
s_nop 0
buffer_load_dwordx4 v27, s[8:11], s56 offen lds
s_add_u32 s56, s54, 180224
s_mov_b32 m0, 60416
s_nop 0
buffer_load_dwordx4 v27, s[8:11], s56 offen lds
ds_read_b64_tr_b16 a[144:145], v44 offset:4096
ds_read_b64_tr_b16 a[146:147], v44 offset:5120
ds_read_b64_tr_b16 a[148:149], v46 offset:4096
ds_read_b64_tr_b16 a[150:151], v46 offset:5120
ds_read_b64_tr_b16 a[152:153], v45 offset:4096
ds_read_b64_tr_b16 a[154:155], v45 offset:5120
ds_read_b64_tr_b16 a[156:157], v47 offset:4096
ds_read_b64_tr_b16 a[158:159], v47 offset:5120
s_waitcnt lgkmcnt(0)
s_waitcnt vmcnt(25)
s_barrier
s_add_u32 s56, s54, 1703936
s_mov_b32 m0, 61440
s_nop 0
buffer_load_dwordx4 v26, s[8:11], s56 offen lds
s_add_u32 s56, s54, 1720320
s_mov_b32 m0, 62464
s_nop 0
buffer_load_dwordx4 v26, s[8:11], s56 offen lds
s_add_u32 s56, s54, 1736704
s_mov_b32 m0, 63488
s_nop 0
buffer_load_dwordx4 v27, s[8:11], s56 offen lds
s_add_u32 s56, s54, 1753088
s_mov_b32 m0, 64512
s_nop 0
buffer_load_dwordx4 v27, s[8:11], s56 offen lds
ds_read_b64_tr_b16 a[160:161], v44 offset:8192
ds_read_b64_tr_b16 a[162:163], v44 offset:9216
ds_read_b64_tr_b16 a[164:165], v46 offset:8192
ds_read_b64_tr_b16 a[166:167], v46 offset:9216
ds_read_b64_tr_b16 a[168:169], v45 offset:8192
ds_read_b64_tr_b16 a[170:171], v45 offset:9216
ds_read_b64_tr_b16 a[172:173], v47 offset:8192
ds_read_b64_tr_b16 a[174:175], v47 offset:9216
s_waitcnt lgkmcnt(0)
s_waitcnt vmcnt(25)
s_barrier
s_add_u32 s56, s54, 2228224
s_mov_b32 m0, 65536
s_nop 0
buffer_load_dwordx4 v26, s[8:11], s56 offen lds
s_add_u32 s56, s54, 2244608
s_mov_b32 m0, 66560
s_nop 0
buffer_load_dwordx4 v26, s[8:11], s56 offen lds
s_add_u32 s56, s54, 2260992
s_mov_b32 m0, 67584
s_nop 0
buffer_load_dwordx4 v27, s[8:11], s56 offen lds
s_add_u32 s56, s54, 2277376
s_mov_b32 m0, 68608
s_nop 0
buffer_load_dwordx4 v27, s[8:11], s56 offen lds
ds_read_b64_tr_b16 a[176:177], v48 offset:12288
ds_read_b64_tr_b16 a[178:179], v48 offset:13312
ds_read_b64_tr_b16 a[180:181], v48 offset:14336
ds_read_b64_tr_b16 a[182:183], v48 offset:15360
ds_read_b64_tr_b16 a[192:193], v49 offset:12288
ds_read_b64_tr_b16 a[194:195], v49 offset:13312
ds_read_b64_tr_b16 a[196:197], v49 offset:14336
ds_read_b64_tr_b16 a[198:199], v49 offset:15360
s_waitcnt lgkmcnt(0)
s_waitcnt vmcnt(25)
s_barrier
s_add_u32 s56, s54, 2752512
s_mov_b32 m0, 69632
s_nop 0
buffer_load_dwordx4 v26, s[12:15], s56 offen lds
s_add_u32 s56, s54, 2768896
s_mov_b32 m0, 70656
s_nop 0
buffer_load_dwordx4 v26, s[12:15], s56 offen lds
s_add_u32 s56, s54, 2785280
s_mov_b32 m0, 71680
s_nop 0
buffer_load_dwordx4 v27, s[12:15], s56 offen lds
s_add_u32 s56, s54, 2801664
s_mov_b32 m0, 72704
s_nop 0
buffer_load_dwordx4 v27, s[12:15], s56 offen lds
ds_read_b64_tr_b16 a[184:185], v48 offset:16384
ds_read_b64_tr_b16 a[186:187], v48 offset:17408
ds_read_b64_tr_b16 a[188:189], v48 offset:18432
ds_read_b64_tr_b16 a[190:191], v48 offset:19456
ds_read_b64_tr_b16 a[200:201], v49 offset:16384
ds_read_b64_tr_b16 a[202:203], v49 offset:17408
ds_read_b64_tr_b16 a[204:205], v49 offset:18432
ds_read_b64_tr_b16 a[206:207], v49 offset:19456
s_waitcnt lgkmcnt(0)
s_waitcnt vmcnt(25)
s_barrier
s_add_u32 s56, s54, 4325376
s_mov_b32 m0, 73728
s_nop 0
buffer_load_dwordx4 v26, s[16:19], s56 offen lds
s_add_u32 s56, s54, 4341760
s_mov_b32 m0, 74752
s_nop 0
buffer_load_dwordx4 v26, s[16:19], s56 offen lds
s_add_u32 s56, s54, 4358144
s_mov_b32 m0, 75776
s_nop 0
buffer_load_dwordx4 v27, s[16:19], s56 offen lds
s_add_u32 s56, s54, 4374528
s_mov_b32 m0, 76800
s_nop 0
buffer_load_dwordx4 v27, s[16:19], s56 offen lds
ds_read_b64_tr_b16 a[208:209], v48 offset:20480
ds_read_b64_tr_b16 a[210:211], v48 offset:21504
ds_read_b64_tr_b16 a[212:213], v48 offset:22528
ds_read_b64_tr_b16 a[214:215], v48 offset:23552
ds_read_b64_tr_b16 a[216:217], v49 offset:20480
ds_read_b64_tr_b16 a[218:219], v49 offset:21504
ds_read_b64_tr_b16 a[220:221], v49 offset:22528
ds_read_b64_tr_b16 a[222:223], v49 offset:23552
s_waitcnt lgkmcnt(0)
s_waitcnt vmcnt(25)
s_barrier
s_add_u32 s56, s55, 4608
s_mov_b32 m0, 77824
s_nop 0
buffer_load_dwordx4 v28, s[20:23], s56 offen lds
s_add_u32 s56, s55, 6912
s_mov_b32 m0, 78848
s_nop 0
buffer_load_dwordx4 v28, s[20:23], s56 offen lds
s_add_u32 s56, s55, 13824
s_mov_b32 m0, 79872
s_nop 0
buffer_load_dwordx4 v28, s[20:23], s56 offen lds
s_add_u32 s56, s55, 16128
s_mov_b32 m0, 80896
s_nop 0
buffer_load_dwordx4 v28, s[20:23], s56 offen lds
ds_read_b64_tr_b16 a[224:225], v48 offset:24576
ds_read_b64_tr_b16 a[226:227], v48 offset:25600
ds_read_b64_tr_b16 a[228:229], v48 offset:26624
ds_read_b64_tr_b16 a[230:231], v48 offset:27648
ds_read_b64_tr_b16 a[240:241], v49 offset:24576
ds_read_b64_tr_b16 a[242:243], v49 offset:25600
ds_read_b64_tr_b16 a[244:245], v49 offset:26624
ds_read_b64_tr_b16 a[246:247], v49 offset:27648
s_waitcnt lgkmcnt(0)
s_waitcnt vmcnt(25)
s_barrier
s_add_u32 s56, s55, 4864
s_mov_b32 m0, 81920
s_nop 0
buffer_load_dwordx4 v28, s[20:23], s56 offen lds
s_add_u32 s56, s55, 7168
s_mov_b32 m0, 82944
s_nop 0
buffer_load_dwordx4 v28, s[20:23], s56 offen lds
s_add_u32 s56, s55, 14080
s_mov_b32 m0, 83968
s_nop 0
buffer_load_dwordx4 v28, s[20:23], s56 offen lds
s_add_u32 s56, s55, 16384
s_mov_b32 m0, 84992
s_nop 0
buffer_load_dwordx4 v28, s[20:23], s56 offen lds
ds_read_b64_tr_b16 a[248:249], v48 offset:28672
ds_read_b64_tr_b16 a[250:251], v48 offset:29696
ds_read_b64_tr_b16 a[252:253], v48 offset:30720
ds_read_b64_tr_b16 a[254:255], v48 offset:31744
ds_read_b64_tr_b16 a[232:233], v49 offset:28672
ds_read_b64_tr_b16 a[234:235], v49 offset:29696
ds_read_b64_tr_b16 a[236:237], v49 offset:30720
ds_read_b64_tr_b16 a[238:239], v49 offset:31744
s_waitcnt lgkmcnt(0)
s_waitcnt vmcnt(24)
s_barrier
s_add_u32 s56, s55, 5120
s_mov_b32 m0, 86016
s_nop 0
buffer_load_dwordx4 v28, s[20:23], s56 offen lds
s_add_u32 s56, s55, 7424
s_mov_b32 m0, 87040
s_nop 0
buffer_load_dwordx4 v28, s[20:23], s56 offen lds
s_add_u32 s56, s55, 14336
s_mov_b32 m0, 88064
s_nop 0
buffer_load_dwordx4 v28, s[20:23], s56 offen lds
s_add_u32 s56, s55, 16640
s_mov_b32 m0, 89088
s_nop 0
buffer_load_dwordx4 v28, s[20:23], s56 offen lds
ds_read_b64_tr_b16 v[60:61], v44 offset:0
ds_read_b64_tr_b16 v[62:63], v44 offset:1024
ds_read_b64_tr_b16 v[64:65], v46 offset:0
ds_read_b64_tr_b16 v[66:67], v46 offset:1024
ds_read_b64_tr_b16 v[68:69], v45 offset:0
ds_read_b64_tr_b16 v[70:71], v45 offset:1024
ds_read_b64_tr_b16 v[72:73], v47 offset:0
ds_read_b64_tr_b16 v[74:75], v47 offset:1024
s_waitcnt lgkmcnt(0)
s_waitcnt vmcnt(24)
s_barrier
ds_write_b128 v2, v[60:63] offset:0
ds_write_b128 v2, v[64:67] offset:1024
ds_write_b128 v2, v[68:71] offset:2048
ds_write_b128 v2, v[72:75] offset:3072
ds_read_b64_tr_b16 v[60:61], v44 offset:4096
ds_read_b64_tr_b16 v[62:63], v44 offset:5120
ds_read_b64_tr_b16 v[64:65], v46 offset:4096
ds_read_b64_tr_b16 v[66:67], v46 offset:5120
ds_read_b64_tr_b16 v[68:69], v45 offset:4096
ds_read_b64_tr_b16 v[70:71], v45 offset:5120
ds_read_b64_tr_b16 v[72:73], v47 offset:4096
ds_read_b64_tr_b16 v[74:75], v47 offset:5120
L_rdv_w1r:
v_readfirstlane_b32 s38, v32
s_nop 0
s_and_b32 s57, s38, 0xff
s_cmp_lg_u32 s57, 32
s_cbranch_scc1 L_rdv2_w1r
s_waitcnt lgkmcnt(0)
s_waitcnt vmcnt(20)
s_barrier
ds_write_b128 v2, v[60:63] offset:4096
ds_write_b128 v2, v[64:67] offset:5120
ds_write_b128 v2, v[68:71] offset:6144
ds_write_b128 v2, v[72:75] offset:7168
ds_read_b64_tr_b16 v[60:61], v44 offset:8192
ds_read_b64_tr_b16 v[62:63], v44 offset:9216
ds_read_b64_tr_b16 v[64:65], v46 offset:8192
ds_read_b64_tr_b16 v[66:67], v46 offset:9216
ds_read_b64_tr_b16 v[68:69], v45 offset:8192
ds_read_b64_tr_b16 v[70:71], v45 offset:9216
ds_read_b64_tr_b16 v[72:73], v47 offset:8192
ds_read_b64_tr_b16 v[74:75], v47 offset:9216
buffer_load_dwordx4 v[12:15], v9, s[4:7], s37 offen offset:0
buffer_load_dwordx4 v[16:19], v9, s[4:7], s37 offen offset:1024
buffer_load_dwordx4 v[52:55], v1, s[4:7], s37 offen offset:2048
buffer_load_dwordx4 v[56:59], v1, s[4:7], s37 offen offset:3072
s_mov_b32 m0, 1024
s_nop 0
buffer_load_dwordx4 v1, s[4:7], s47 offen offset:1024 sc0 sc1 lds
s_waitcnt lgkmcnt(0)
s_waitcnt vmcnt(21)
s_barrier
ds_write_b128 v2, v[60:63] offset:8192
ds_write_b128 v2, v[64:67] offset:9216
ds_write_b128 v2, v[68:71] offset:10240
ds_write_b128 v2, v[72:75] offset:11264
ds_read_b64_tr_b16 v[60:61], v44 offset:12288
ds_read_b64_tr_b16 v[62:63], v44 offset:13312
ds_read_b64_tr_b16 v[64:65], v46 offset:12288
ds_read_b64_tr_b16 v[66:67], v46 offset:13312
ds_read_b64_tr_b16 v[68:69], v45 offset:12288
ds_read_b64_tr_b16 v[70:71], v45 offset:13312
ds_read_b64_tr_b16 v[72:73], v47 offset:12288
ds_read_b64_tr_b16 v[74:75], v47 offset:13312
s_waitcnt lgkmcnt(0)
s_waitcnt vmcnt(17)
s_barrier
ds_write_b128 v2, v[60:63] offset:12288
ds_write_b128 v2, v[64:67] offset:13312
ds_write_b128 v2, v[68:71] offset:14336
ds_write_b128 v2, v[72:75] offset:15360
ds_read_b64_tr_b16 v[60:61], v44 offset:16384
ds_read_b64_tr_b16 v[62:63], v44 offset:17408
ds_read_b64_tr_b16 v[64:65], v46 offset:16384
ds_read_b64_tr_b16 v[66:67], v46 offset:17408
ds_read_b64_tr_b16 v[68:69], v45 offset:16384
ds_read_b64_tr_b16 v[70:71], v45 offset:17408
ds_read_b64_tr_b16 v[72:73], v47 offset:16384
ds_read_b64_tr_b16 v[74:75], v47 offset:17408
s_waitcnt lgkmcnt(0)
s_waitcnt vmcnt(13)
s_barrier
ds_write_b128 v2, v[60:63] offset:16384
ds_write_b128 v2, v[64:67] offset:17408
ds_write_b128 v2, v[68:71] offset:18432
ds_write_b128 v2, v[72:75] offset:19456
ds_read_b64_tr_b16 v[60:61], v48 offset:20480
ds_read_b64_tr_b16 v[62:63], v48 offset:21504
ds_read_b64_tr_b16 v[64:65], v48 offset:22528
ds_read_b64_tr_b16 v[66:67], v48 offset:23552
ds_read_b64_tr_b16 v[68:69], v49 offset:20480
ds_read_b64_tr_b16 v[70:71], v49 offset:21504
ds_read_b64_tr_b16 v[72:73], v49 offset:22528
ds_read_b64_tr_b16 v[74:75], v49 offset:23552
s_waitcnt lgkmcnt(0)
s_waitcnt vmcnt(9)
s_barrier
ds_write_b128 v2, v[60:63] offset:20480
ds_write_b128 v2, v[64:67] offset:21504
ds_write_b128 v2, v[68:71] offset:22528
ds_write_b128 v2, v[72:75] offset:23552
ds_read_b64_tr_b16 v[60:61], v48 offset:24576
ds_read_b64_tr_b16 v[62:63], v48 offset:25600
ds_read_b64_tr_b16 v[64:65], v48 offset:26624
ds_read_b64_tr_b16 v[66:67], v48 offset:27648
ds_read_b64_tr_b16 v[68:69], v49 offset:24576
ds_read_b64_tr_b16 v[70:71], v49 offset:25600
ds_read_b64_tr_b16 v[72:73], v49 offset:26624
ds_read_b64_tr_b16 v[74:75], v49 offset:27648
s_waitcnt lgkmcnt(0)
s_waitcnt vmcnt(5)
s_barrier
ds_write_b128 v2, v[60:63] offset:24576
ds_write_b128 v2, v[64:67] offset:25600
ds_write_b128 v2, v[68:71] offset:26624
ds_write_b128 v2, v[72:75] offset:27648
ds_read_b64_tr_b16 v[60:61], v48 offset:28672
ds_read_b64_tr_b16 v[62:63], v48 offset:29696
ds_read_b64_tr_b16 v[64:65], v48 offset:30720
ds_read_b64_tr_b16 v[66:67], v48 offset:31744
ds_read_b64_tr_b16 v[68:69], v49 offset:28672
ds_read_b64_tr_b16 v[70:71], v49 offset:29696
ds_read_b64_tr_b16 v[72:73], v49 offset:30720
ds_read_b64_tr_b16 v[74:75], v49 offset:31744
s_waitcnt lgkmcnt(0)
s_barrier
ds_write_b128 v2, v[60:63] offset:28672
ds_write_b128 v2, v[64:67] offset:29696
ds_write_b128 v2, v[68:71] offset:30720
ds_write_b128 v2, v[72:75] offset:31744
s_lshl_b32 s57, s58, 5
s_mov_b32 s0, 0x3f003f00
s_mov_b32 s1, 0x3f003f00
s_mov_b32 s58, 304128
s_cmp_eq_u32 s38, s57
s_cbranch_scc0 L_slow_w1r
v_mov_b64 v[20:21], 0
v_mov_b64 v[22:23], 0
v_mov_b64 v[24:25], 0
v_mov_b64 v[26:27], 0
v_mov_b64 v[28:29], 0
v_mov_b64 v[30:31], 0
v_mov_b64 v[32:33], 0
v_mov_b64 v[34:35], 0
v_mov_b64 v[36:37], 0
v_mov_b64 v[38:39], 0
v_mov_b64 v[40:41], 0
v_mov_b64 v[42:43], 0
ds_read_b128 v[44:47], v2 offset:0
ds_read_b128 v[48:51], v2 offset:1024
v_bfe_u32 v77, v1, 6, 1
v_lshl_add_u32 v77, v77, 3, v1
v_lshlrev_b32 v77, 1, v77
v_lshlrev_b32 v78, 2, v1
s_waitcnt vmcnt(0) lgkmcnt(0)
s_branch L_top_w1rf
.p2align 6
L_ex_w1rf:
v_and_b32 v6, 0x70, v1
ds_read_b128 v[76:79], v6 offset:256
v_bfe_u32 v11, v1, 4, 2
v_lshrrev_b32_e64 v11, v11, 1
s_add_u32 s34, s34, 1
s_add_u32 s37, s37, 524288
s_add_u32 s39, s39, 524288
s_mul_i32 s40, s34, 10240
s_add_u32 s40, s40, 8093696
s_not_b32 s35, s35
s_not_b32 s36, s36
ds_read_b128 v[44:47], v2 offset:0
ds_read_b128 v[48:51], v2 offset:1024
s_barrier
s_waitcnt vmcnt(0)
v_mov_b64 v[20:21], 0
v_mov_b64 v[22:23], 0
v_mov_b64 v[24:25], 0
v_mov_b64 v[26:27], 0
v_mov_b64 v[28:29], 0
v_mov_b64 v[30:31], 0
v_mov_b64 v[32:33], 0
v_mov_b64 v[34:35], 0
v_mov_b64 v[36:37], 0
v_mov_b64 v[38:39], 0
v_mov_b64 v[40:41], 0
v_mov_b64 v[42:43], 0
buffer_load_dwordx4 v[60:63], v9, s[4:7], s3 offen offset:0 sc1
buffer_load_dwordx4 v[64:67], v9, s[4:7], s3 offen offset:1024 sc1
buffer_load_dwordx4 v[68:71], v9, s[4:7], s3 offen offset:2048 sc1
buffer_load_dwordx4 v[72:75], v9, s[4:7], s3 offen offset:3072 sc1
s_waitcnt lgkmcnt(2)
s_waitcnt vmcnt(3)
L_r_w1rf:
v_mfma_f32_16x16x32_bf16 v[52:55], v[60:63], v[76:79], 0
s_waitcnt vmcnt(2)
v_mfma_f32_16x16x32_bf16 v[52:55], v[64:67], v[76:79], v[52:55]
v_bitop3_b32 v56, v60, v64, s36 bitop3:0x7e
s_waitcnt vmcnt(1)
v_mfma_f32_16x16x32_bf16 v[52:55], v[68:71], v[76:79], v[52:55]
s_waitcnt vmcnt(0)
v_mfma_f32_16x16x32_bf16 v[52:55], v[72:75], v[76:79], v[52:55]
v_bitop3_b32 v57, v68, v72, s36 bitop3:0x7e
v_bitop3_b32 v56, v56, v57, 1 bitop3:0xa8
v_cmp_ne_u32 vcc, 0, v56
s_cmp_eq_u32 s34, 63
s_nop 3
v_pk_add_f32 v[52:53], v[52:53], v[54:55]
v_cvt_pk_bf16_f32 v56, v52, v53
v_bfi_b32 v56, v11, s35, v56
s_cbranch_vccnz L_rr_w1rf
buffer_store_dword v56, v10, s[4:7], 0 offen
v_mov_b32 v11, v56
s_cbranch_scc1 L_done_w1rf
v_bfe_u32 v77, v1, 6, 1
v_lshl_add_u32 v77, v77, 3, v1
v_lshlrev_b32 v77, 1, v77
v_lshlrev_b32 v78, 2, v1
L_top_w1rf:
s_barrier
ds_read_b128 v[60:63], v1 offset:1024
ds_read_b128 v[64:67], v1 offset:2048
s_mov_b32 m0, 5120
s_nop 0
buffer_load_dwordx4 v1, s[4:7], s48 offen offset:1024 sc1 lds
s_barrier
ds_read_b128 v[68:71], v1 offset:3072
ds_read_b128 v[72:75], v1 offset:4096
L_s0_w1rf:
s_waitcnt lgkmcnt(3)
v_smfmac_f32_16x16x64_bf16 v[28:31], v[60:63], v[176:183], v0
v_smfmac_f32_16x16x64_bf16 v[32:35], v[60:63], v[184:191], v0
s_mov_b32 m0, 9216
s_nop 0
buffer_load_dwordx4 v1, s[4:7], s49 offen offset:0 sc1 lds
v_smfmac_f32_16x16x64_bf16 v[36:39], v[60:63], a[48:55], v0
v_smfmac_f32_16x16x64_bf16 v[40:43], v[60:63], a[56:63], v0
s_waitcnt lgkmcnt(2)
v_smfmac_f32_16x16x64_bf16 v[20:23], v[64:67], v[80:87], v0
v_smfmac_f32_16x16x64_bf16 v[20:23], v[60:63], v[44:51], v0
ds_read_b128 v[44:47], v2 offset:2048
v_smfmac_f32_16x16x64_bf16 v[24:27], v[64:67], v[88:95], v0
ds_read_b128 v[48:51], v2 offset:3072
v_smfmac_f32_16x16x64_bf16 v[28:31], v[64:67], v[192:199], v0
s_waitcnt lgkmcnt(2)
v_bitop3_b32 v6, v60, v64, s35 bitop3:0x7e
buffer_load_dwordx4 v[12:15], v9, s[4:7], s37 offen offset:0
buffer_load_dwordx4 v[16:19], v9, s[4:7], s37 offen offset:1024
buffer_load_dwordx4 v[52:55], v1, s[4:7], s37 offen offset:2048
buffer_load_dwordx4 v[56:59], v1, s[4:7], s37 offen offset:3072
v_smfmac_f32_16x16x64_bf16 v[32:35], v[64:67], v[200:207], v0
v_bitop3_b32 v76, v68, v72, s35 bitop3:0x7e
v_smfmac_f32_16x16x64_bf16 v[36:39], v[64:67], a[64:71], v0
v_bitop3_b32 v6, v6, v76, 1 bitop3:0xa8
s_waitcnt lgkmcnt(0)
v_smfmac_f32_16x16x64_bf16 v[24:27], v[60:63], v[44:51], v0
ds_read_b128 v[44:47], v2 offset:4096
v_cmp_ne_u32 vcc, 0, v6
v_smfmac_f32_16x16x64_bf16 v[40:43], v[64:67], a[72:79], v0
ds_read_b128 v[48:51], v2 offset:5120
v_smfmac_f32_16x16x64_bf16 v[20:23], v[68:71], v[96:103], v0
s_cbranch_vccnz L_ra0_w1rf
v_smfmac_f32_16x16x64_bf16 v[24:27], v[68:71], v[104:111], v0
s_waitcnt vmcnt(4)
s_barrier
ds_read_b32 v6, v77 offset:8192
v_smfmac_f32_16x16x64_bf16 v[28:31], v[68:71], v[208:215], v0
ds_read_b128 v[60:63], v1 offset:6144
s_waitcnt lgkmcnt(2)
v_smfmac_f32_16x16x64_bf16 v[20:23], v[72:75], v[44:51], v0
ds_read_b128 v[64:67], v1 offset:7168
v_smfmac_f32_16x16x64_bf16 v[32:35], v[68:71], v[216:223], v0
ds_read_b128 v[76:79], v1 offset:5120
v_smfmac_f32_16x16x64_bf16 v[36:39], v[68:71], a[80:87], v0
ds_read_b128 v[44:47], v2 offset:6144
v_smfmac_f32_16x16x64_bf16 v[40:43], v[68:71], a[88:95], v0
ds_read_b128 v[48:51], v2 offset:7168
s_waitcnt lgkmcnt(4)
v_bitop3_b32 v6, v6, v60, s35 bitop3:0x7e
v_smfmac_f32_16x16x64_bf16 v[28:31], v[72:75], v[224:231], v0
ds_read_b128 v[68:71], v1 offset:8192
s_waitcnt lgkmcnt(4)
v_bitop3_b32 v6, v6, v64, s35 bitop3:0xf6
v_smfmac_f32_16x16x64_bf16 v[32:35], v[72:75], v[232:239], v0
s_waitcnt lgkmcnt(3)
v_bitop3_b32 v6, v6, v76, s35 bitop3:0xf6
v_and_b32 v6, 1, v6
v_smfmac_f32_16x16x64_bf16 v[36:39], v[72:75], a[96:103], v0
v_cmp_ne_u32 vcc, 0, v6
s_waitcnt lgkmcnt(1)
v_smfmac_f32_16x16x64_bf16 v[24:27], v[72:75], v[44:51], v0
ds_read_b128 v[44:47], v2 offset:8192
v_lshlrev_b32 v6, 2, v1
v_smfmac_f32_16x16x64_bf16 v[40:43], v[72:75], a[104:111], v0
ds_read_b128 v[72:75], v1 offset:9216
s_cbranch_vccnz L_ra1_w1rf
L_a1_w1rf:
buffer_store_dword v11, v10, s[4:7], s40 offen sc0 sc1
s_mov_b32 m0, 0
s_nop 0
buffer_load_dword v6, s[4:7], s39 offen lds
v_smfmac_f32_16x16x64_bf16 v[20:23], v[60:63], v[112:119], v0
ds_read_b128 v[48:51], v2 offset:9216
v_smfmac_f32_16x16x64_bf16 v[20:23], v[64:67], v[128:135], v0
s_waitcnt lgkmcnt(3)
v_smfmac_f32_16x16x64_bf16 v[20:23], v[68:71], v[144:151], v0
s_waitcnt lgkmcnt(1)
v_smfmac_f32_16x16x64_bf16 v[20:23], v[72:75], v[160:167], v0
s_waitcnt lgkmcnt(0)
v_smfmac_f32_16x16x64_bf16 v[20:23], v[76:79], v[44:51], v0
ds_read_b128 v[44:47], v2 offset:10240
v_smfmac_f32_16x16x64_bf16 v[24:27], v[60:63], v[120:127], v0
ds_read_b128 v[48:51], v2 offset:11264
v_smfmac_f32_16x16x64_bf16 v[24:27], v[64:67], v[136:143], v0
v_add_f32 v20, v20, v22
v_smfmac_f32_16x16x64_bf16 v[24:27], v[68:71], v[152:159], v0
v_add_f32 v21, v21, v23
v_smfmac_f32_16x16x64_bf16 v[24:27], v[72:75], v[168:175], v0
v_cvt_pk_bf16_f32 v22, v20, v21
s_waitcnt lgkmcnt(0)
v_smfmac_f32_16x16x64_bf16 v[24:27], v[76:79], v[44:51], v0
ds_read_b128 v[44:47], v2 offset:12288
v_smfmac_f32_16x16x64_bf16 v[28:31], v[76:79], v[240:247], v0
ds_read_b128 v[48:51], v2 offset:13312
v_smfmac_f32_16x16x64_bf16 v[28:31], v[64:67], a[0:7], v0
v_add_f32 v24, v24, v26
v_add_f32 v25, v25, v27
v_cvt_pk_bf16_f32 v23, v24, v25
v_smfmac_f32_16x16x64_bf16 v[28:31], v[68:71], a[16:23], v0
ds_write_b64 v3, v[22:23] offset:10752
v_smfmac_f32_16x16x64_bf16 v[28:31], v[72:75], a[32:39], v0
s_waitcnt lgkmcnt(1)
v_smfmac_f32_16x16x64_bf16 v[28:31], v[60:63], v[44:51], v0
ds_read_b128 v[44:47], v2 offset:14336
v_smfmac_f32_16x16x64_bf16 v[32:35], v[76:79], v[248:255], v0
ds_read_b128 v[48:51], v2 offset:15360
s_waitcnt lgkmcnt(2)
s_barrier
v_smfmac_f32_16x16x64_bf16 v[32:35], v[64:67], a[8:15], v0
ds_read_b64_tr_b16 v[20:21], v4 offset:10240
ds_read_b64_tr_b16 v[22:23], v4 offset:10752
v_add_f32 v28, v28, v30
v_smfmac_f32_16x16x64_bf16 v[32:35], v[68:71], a[24:31], v0
ds_read_b64_tr_b16 v[24:25], v4 offset:11264
v_add_f32 v29, v29, v31
v_smfmac_f32_16x16x64_bf16 v[32:35], v[72:75], a[40:47], v0
ds_read_b64_tr_b16 v[26:27], v4 offset:11776
v_cvt_pk_bf16_f32 v30, v28, v29
s_waitcnt lgkmcnt(4)
v_smfmac_f32_16x16x64_bf16 v[32:35], v[60:63], v[44:51], v0
ds_read_b128 v[44:47], v2 offset:18432
s_waitcnt vmcnt(4)
s_waitcnt lgkmcnt(3)
v_mfma_f32_16x16x32_bf16 v[12:15], v[12:15], v[20:23], 0
ds_read_b128 v[48:51], v2 offset:19456
s_waitcnt lgkmcnt(2)
v_mfma_f32_16x16x32_bf16 v[12:15], v[16:19], v[24:27], v[12:15]
v_add_f32 v32, v32, v34
v_add_f32 v33, v33, v35
v_cvt_pk_bf16_f32 v31, v32, v33
ds_write_b64 v3, v[30:31] offset:12800
v_smfmac_f32_16x16x64_bf16 v[36:39], v[76:79], a[112:119], v0
s_nop 2
v_add_f32_dpp v12, v14, v12 quad_perm:[2,3,0,1] row_mask:0xf bank_mask:0xf
v_add_f32_dpp v13, v15, v13 quad_perm:[2,3,0,1] row_mask:0xf bank_mask:0xf
ds_write_b64 v5, v[12:13] offset:14592
v_smfmac_f32_16x16x64_bf16 v[40:43], v[76:79], a[120:127], v0
s_waitcnt lgkmcnt(1)
s_barrier
ds_read_b64_tr_b16 v[28:29], v4 offset:12288
v_smfmac_f32_16x16x64_bf16 v[36:39], v[60:63], a[128:135], v0
ds_read_b64_tr_b16 v[30:31], v4 offset:12800
ds_read_b64_tr_b16 v[32:33], v4 offset:13312
v_smfmac_f32_16x16x64_bf16 v[40:43], v[60:63], a[136:143], v0
ds_read_b64_tr_b16 v[34:35], v4 offset:13824
v_mov_b64 v[76:77], s[52:53]
s_waitcnt lgkmcnt(4)
s_barrier
ds_read_b128 v[12:15], v1 offset:14336
v_smfmac_f32_16x16x64_bf16 v[40:43], v[72:75], v[44:51], v0
ds_read_b128 v[44:47], v2 offset:16384
v_mov_b64 v[78:79], s[52:53]
s_waitcnt lgkmcnt(4)
v_mfma_f32_16x16x32_bf16 v[28:31], v[28:31], v[20:23], 0
ds_read_b128 v[48:51], v2 offset:17408
s_waitcnt lgkmcnt(3)
v_mfma_f32_16x16x32_bf16 v[28:31], v[32:35], v[24:27], v[28:31]
v_smfmac_f32_16x16x64_bf16 v[40:43], v[64:67], a[152:159], v0
s_waitcnt lgkmcnt(2)
v_max3_f32 v17, v12, v13, v14
v_smfmac_f32_16x16x64_bf16 v[36:39], v[64:67], a[144:151], v0
ds_read_b128 v[60:63], v2 offset:20480
v_add_f32_dpp v28, v30, v28 quad_perm:[2,3,0,1] row_mask:0xf bank_mask:0xf
v_add_f32_dpp v29, v31, v29 quad_perm:[2,3,0,1] row_mask:0xf bank_mask:0xf
v_max_f32 v17, v17, v15
v_max_f32 v16, v28, v29
v_mul_f32 v16, s50, v16
v_max_f32_dpp v17, v17, v17 quad_perm:[2,3,0,1] row_mask:0xf bank_mask:0xf
v_smfmac_f32_16x16x64_bf16 v[40:43], v[68:71], a[168:175], v0
ds_read_b128 v[64:67], v2 offset:21504
v_max_f32_dpp v18, v16, v17 quad_perm:[0,1,0,1] row_mask:0xf bank_mask:0xf
v_max_f32_dpp v19, v16, v17 quad_perm:[0,1,0,1] row_mask:0xf bank_mask:0xf
v_smfmac_f32_16x16x64_bf16 v[36:39], v[68:71], a[160:167], v0
ds_read_b128 v[68:71], v2 offset:26624
v_permlane16_swap_b32 v18, v19
v_max_f32 v20, v18, v19
v_max_f32 v21, v18, v19
s_waitcnt lgkmcnt(3)
v_smfmac_f32_16x16x64_bf16 v[36:39], v[72:75], v[44:51], v0
ds_read_b128 v[72:75], v2 offset:27648
v_permlane32_swap_b32 v20, v21
v_max_f32 v20, v20, v21
v_sub_f32 v12, v12, v20
v_sub_f32 v13, v13, v20
v_pk_add_f32 v[14:15], v[14:15], v[20:21] op_sel_hi:[1,0] neg_lo:[0,1] neg_hi:[0,1]
v_exp_f32 v12, v12
v_exp_f32 v13, v13
v_exp_f32 v14, v14
v_exp_f32 v15, v15
v_cvt_pk_bf16_f32 v16, v12, v13
v_cvt_pk_bf16_f32 v17, v14, v15
v_pk_fma_f32 v[28:29], v[28:29], s[50:51], v[20:21] op_sel_hi:[1,1,0] neg_lo:[0,0,1] neg_hi:[0,0,1]
v_mov_b32_dpp v18, v16 quad_perm:[2,3,0,1] row_mask:0xf bank_mask:0xf
v_mov_b32_dpp v19, v17 quad_perm:[2,3,0,1] row_mask:0xf bank_mask:0xf
v_exp_f32 v28, v28
s_waitcnt vmcnt(2)
v_mfma_f32_16x16x32_bf16 v[32:35], v[76:79], v[16:19], 0
v_exp_f32 v29, v29
v_mfma_f32_16x16x32_bf16 v[20:23], v[52:55], v[16:19], 0
v_cvt_pk_bf16_f32 v12, v28, v29
v_cvt_pk_bf16_f32 v13, v28, v29
v_mov_b64 v[14:15], s[0:1]
v_mfma_f32_16x16x32_bf16 v[24:27], v[56:59], v[16:19], 0
v_cvt_pk_bf16_f32 v36, v36, v37
v_cvt_pk_bf16_f32 v37, v38, v39
v_mfma_f32_16x16x16_bf16 v[32:35], v[14:15], v[12:13], v[32:35]
v_cvt_pk_bf16_f32 v38, v40, v41
v_cvt_pk_bf16_f32 v39, v42, v43
v_mfma_f32_16x16x16_bf16 v[20:23], v[36:37], v[12:13], v[20:23]
ds_read_b128 v[44:47], v2 offset:22528
v_mfma_f32_16x16x16_bf16 v[24:27], v[38:39], v[12:13], v[24:27]
ds_read_b128 v[48:51], v2 offset:23552
v_rcp_f32 v32, v32
v_mov_b64 v[28:29], 0
v_mov_b64 v[30:31], 0
v_pk_mul_f32 v[20:21], v[20:21], v[32:33] op_sel_hi:[1,0]
v_pk_mul_f32 v[22:23], v[22:23], v[32:33] op_sel_hi:[1,0]
v_cvt_pk_bf16_f32 v20, v20, v21
v_cvt_pk_bf16_f32 v21, v22, v23
ds_write_b64 v1, v[20:21] offset:6144
v_pk_mul_f32 v[24:25], v[24:25], v[32:33] op_sel_hi:[1,0]
v_pk_mul_f32 v[26:27], v[26:27], v[32:33] op_sel_hi:[1,0]
v_cvt_pk_bf16_f32 v24, v24, v25
v_cvt_pk_bf16_f32 v25, v26, v27
ds_write_b64 v1, v[24:25] offset:6152
v_mov_b64 v[76:77], 0
ds_read_b128 v[12:15], v7 offset:6144
v_mov_b64 v[78:79], 0
v_mov_b64 v[40:41], 0
v_mov_b64 v[42:43], 0
v_mov_b64 v[36:37], 0
v_mov_b64 v[38:39], 0
v_mov_b64 v[32:33], 0
v_mov_b64 v[34:35], 0
s_waitcnt lgkmcnt(1)
s_barrier
ds_read_b128 v[16:19], v7 offset:7168
ds_read_b128 v[52:55], v7 offset:8192
ds_read_b128 v[56:59], v7 offset:5120
s_waitcnt lgkmcnt(3)
v_smfmac_f32_16x16x64_bf16 v[28:31], v[12:15], a[176:183], v0 abid:1
v_smfmac_f32_16x16x64_bf16 v[76:79], v[12:15], a[184:191], v0 abid:1
s_waitcnt lgkmcnt(2)
v_smfmac_f32_16x16x64_bf16 v[28:31], v[16:19], v[44:51], v0 abid:1
ds_read_b128 v[44:47], v2 offset:24576
s_waitcnt lgkmcnt(2)
v_smfmac_f32_16x16x64_bf16 v[28:31], v[52:55], a[192:199], v0 abid:1
ds_read_b128 v[48:51], v2 offset:25600
s_waitcnt lgkmcnt(2)
v_smfmac_f32_16x16x64_bf16 v[28:31], v[56:59], v[60:67], v0 abid:1
ds_read_b128 v[60:63], v2 offset:30720
v_smfmac_f32_16x16x64_bf16 v[76:79], v[16:19], v[68:75], v0 abid:1
ds_read_b128 v[64:67], v2 offset:31744
v_smfmac_f32_16x16x64_bf16 v[76:79], v[52:55], a[200:207], v0 abid:1
ds_read_b128 v[68:71], v2 offset:28672
v_cvt_pk_bf16_f32 v28, v28, v29
v_cvt_pk_bf16_f32 v29, v30, v31
v_bfi_b32 v28, 1, s35, v28
buffer_store_dwordx2 v[28:29], v8, s[4:7], s42 offen
s_waitcnt lgkmcnt(3)
v_smfmac_f32_16x16x64_bf16 v[76:79], v[56:59], v[44:51], v0 abid:1
ds_read_b128 v[72:75], v2 offset:29696
v_smfmac_f32_16x16x64_bf16 v[40:43], v[12:15], a[208:215], v0 abid:1
ds_read_b128 v[44:47], v2 offset:36864
s_waitcnt lgkmcnt(3)
v_smfmac_f32_16x16x64_bf16 v[40:43], v[16:19], v[60:67], v0 abid:1
ds_read_b128 v[48:51], v2 offset:37888
v_cvt_pk_bf16_f32 v76, v76, v77
v_cvt_pk_bf16_f32 v77, v78, v79
v_bfi_b32 v76, 1, s35, v76
buffer_store_dwordx2 v[76:77], v8, s[4:7], s43 offen
v_smfmac_f32_16x16x64_bf16 v[40:43], v[52:55], a[216:223], v0 abid:1
ds_read_b128 v[60:63], v2 offset:34816
s_waitcnt lgkmcnt(3)
v_smfmac_f32_16x16x64_bf16 v[40:43], v[56:59], v[68:75], v0 abid:1
ds_read_b128 v[64:67], v2 offset:35840
v_smfmac_f32_16x16x64_bf16 v[36:39], v[12:15], a[224:231], v0 abid:1
ds_read_b128 v[68:71], v2 offset:38912
v_smfmac_f32_16x16x64_bf16 v[36:39], v[16:19], a[232:239], v0 abid:1
ds_read_b128 v[72:75], v2 offset:39936
v_cvt_pk_bf16_f32 v40, v40, v41
v_cvt_pk_bf16_f32 v41, v42, v43
v_bfi_b32 v40, 1, s35, v40
buffer_store_dwordx2 v[40:41], v8, s[4:7], s44 offen
v_smfmac_f32_16x16x64_bf16 v[36:39], v[52:55], a[240:247], v0 abid:1
v_smfmac_f32_16x16x64_bf16 v[36:39], v[56:59], a[248:255], v0 abid:1
s_waitcnt lgkmcnt(4)
v_smfmac_f32_16x16x64_bf16 v[32:35], v[12:15], v[44:51], v0 abid:1
ds_read_b128 v[44:47], v2 offset:32768
s_waitcnt lgkmcnt(3)
v_smfmac_f32_16x16x64_bf16 v[32:35], v[16:19], v[60:67], v0 abid:1
ds_read_b128 v[48:51], v2 offset:33792
v_cvt_pk_bf16_f32 v36, v36, v37
v_cvt_pk_bf16_f32 v37, v38, v39
v_bfi_b32 v36, 1, s35, v36
buffer_store_dwordx2 v[36:37], v8, s[4:7], s45 offen
s_waitcnt lgkmcnt(2)
v_smfmac_f32_16x16x64_bf16 v[32:35], v[52:55], v[68:75], v0 abid:1
s_waitcnt lgkmcnt(0)
v_smfmac_f32_16x16x64_bf16 v[32:35], v[56:59], v[44:51], v0 abid:1
s_nop 7
v_cvt_pk_bf16_f32 v32, v32, v33
v_cvt_pk_bf16_f32 v33, v34, v35
v_bfi_b32 v32, 1, s35, v32
buffer_store_dwordx2 v[32:33], v8, s[4:7], s46 offen
s_branch L_ex_w1rf
L_done_w1rf:
buffer_store_dword v11, v10, s[4:7], s40 offen sc0 sc1
s_waitcnt vmcnt(0) lgkmcnt(0)
s_endpgm
L_rdv2_w1r:
buffer_load_dword v32, v24, s[28:31], 0 offen sc0 sc1
s_sub_u32 s41, s41, 1
s_cbranch_scc1 L_exit
s_waitcnt vmcnt(0)
s_branch L_rdv_w1r
L_ra0_w1rf:
s_mov_b32 m0, 1024
s_nop 0
buffer_load_dwordx4 v1, s[4:7], s47 offen offset:0 sc1 lds
buffer_load_dwordx4 v1, s[4:7], s47 offen offset:1024 sc1 lds
buffer_load_dwordx4 v1, s[4:7], s47 offen offset:2048 sc1 lds
buffer_load_dwordx4 v1, s[4:7], s47 offen offset:3072 sc1 lds
s_sub_u32 s41, s41, 1
s_cbranch_scc1 L_exit
ds_read_b128 v[44:47], v2 offset:0
ds_read_b128 v[48:51], v2 offset:1024
v_mov_b64 v[20:21], 0
v_mov_b64 v[22:23], 0
v_mov_b64 v[24:25], 0
v_mov_b64 v[26:27], 0
v_mov_b64 v[28:29], 0
v_mov_b64 v[30:31], 0
v_mov_b64 v[32:33], 0
v_mov_b64 v[34:35], 0
v_mov_b64 v[36:37], 0
v_mov_b64 v[38:39], 0
v_mov_b64 v[40:41], 0
v_mov_b64 v[42:43], 0
s_waitcnt vmcnt(0)
ds_read_b128 v[60:63], v1 offset:1024
ds_read_b128 v[64:67], v1 offset:2048
ds_read_b128 v[68:71], v1 offset:3072
ds_read_b128 v[72:75], v1 offset:4096
s_branch L_s0_w1rf
L_ra1_w1rf:
s_waitcnt lgkmcnt(0)
s_barrier
s_mov_b32 m0, 5120
s_nop 0
buffer_load_dwordx4 v1, s[4:7], s48 offen offset:1024 sc1 lds
s_sub_u32 s41, s41, 1
s_cbranch_scc1 L_exit
s_waitcnt vmcnt(0)
s_barrier
ds_read_b128 v[76:79], v1 offset:5120
ds_read_b128 v[60:63], v1 offset:6144
ds_read_b128 v[64:67], v1 offset:7168
ds_read_b128 v[68:71], v1 offset:8192
ds_read_b128 v[72:75], v1 offset:9216
s_waitcnt lgkmcnt(0)
v_bitop3_b32 v6, v76, v60, s35 bitop3:0x7e
v_bitop3_b32 v6, v6, v64, s35 bitop3:0xf6
v_bitop3_b32 v6, v6, v68, s35 bitop3:0xf6
v_bitop3_b32 v6, v6, v72, s35 bitop3:0xf6
v_and_b32 v6, 1, v6
v_cmp_ne_u32 vcc, 0, v6
v_lshlrev_b32 v6, 2, v1
s_cbranch_vccnz L_ra1_w1rf
s_branch L_a1_w1rf
L_rr_w1rf:
buffer_load_dwordx4 v[60:63], v9, s[4:7], s3 offen offset:0 sc1
buffer_load_dwordx4 v[64:67], v9, s[4:7], s3 offen offset:1024 sc1
buffer_load_dwordx4 v[68:71], v9, s[4:7], s3 offen offset:2048 sc1
buffer_load_dwordx4 v[72:75], v9, s[4:7], s3 offen offset:3072 sc1
s_sub_u32 s41, s41, 1
s_cbranch_scc1 L_exit
s_waitcnt vmcnt(0)
s_branch L_r_w1rf
L_slow_w1r:
v_mov_b64 v[20:21], 0
v_mov_b64 v[22:23], 0
v_mov_b64 v[24:25], 0
v_mov_b64 v[26:27], 0
v_mov_b64 v[28:29], 0
v_mov_b64 v[30:31], 0
v_mov_b64 v[32:33], 0
v_mov_b64 v[34:35], 0
v_mov_b64 v[36:37], 0
v_mov_b64 v[38:39], 0
v_mov_b64 v[40:41], 0
v_mov_b64 v[42:43], 0
ds_read_b128 v[44:47], v2 offset:0
ds_read_b128 v[48:51], v2 offset:1024
v_bfe_u32 v77, v1, 6, 1
v_lshl_add_u32 v77, v77, 3, v1
v_lshlrev_b32 v77, 1, v77
v_lshlrev_b32 v78, 2, v1
s_waitcnt vmcnt(0) lgkmcnt(0)
s_branch L_top_w1rs
.p2align 6
L_ex_w1rs:
v_and_b32 v6, 0x70, v1
ds_read_b128 v[76:79], v6 offset:256
v_bfe_u32 v11, v1, 4, 2
v_lshrrev_b32_e64 v11, v11, 1
s_add_u32 s34, s34, 1
s_add_u32 s37, s37, 524288
s_add_u32 s39, s39, 524288
s_mul_i32 s40, s34, 10240
s_add_u32 s40, s40, 8093696
s_not_b32 s35, s35
s_not_b32 s36, s36
ds_read_b128 v[44:47], v2 offset:0
ds_read_b128 v[48:51], v2 offset:1024
s_barrier
s_waitcnt vmcnt(0)
v_mov_b64 v[20:21], 0
v_mov_b64 v[22:23], 0
v_mov_b64 v[24:25], 0
v_mov_b64 v[26:27], 0
v_mov_b64 v[28:29], 0
v_mov_b64 v[30:31], 0
v_mov_b64 v[32:33], 0
v_mov_b64 v[34:35], 0
v_mov_b64 v[36:37], 0
v_mov_b64 v[38:39], 0
v_mov_b64 v[40:41], 0
v_mov_b64 v[42:43], 0
buffer_load_dwordx4 v[60:63], v9, s[4:7], s3 offen offset:0 sc0 sc1
buffer_load_dwordx4 v[64:67], v9, s[4:7], s3 offen offset:1024 sc0 sc1
buffer_load_dwordx4 v[68:71], v9, s[4:7], s3 offen offset:2048 sc0 sc1
buffer_load_dwordx4 v[72:75], v9, s[4:7], s3 offen offset:3072 sc0 sc1
s_waitcnt lgkmcnt(2)
s_waitcnt vmcnt(3)
L_r_w1rs:
v_mfma_f32_16x16x32_bf16 v[52:55], v[60:63], v[76:79], 0
s_waitcnt vmcnt(2)
v_mfma_f32_16x16x32_bf16 v[52:55], v[64:67], v[76:79], v[52:55]
v_bitop3_b32 v56, v60, v64, s36 bitop3:0x7e
s_waitcnt vmcnt(1)
v_mfma_f32_16x16x32_bf16 v[52:55], v[68:71], v[76:79], v[52:55]
s_waitcnt vmcnt(0)
v_mfma_f32_16x16x32_bf16 v[52:55], v[72:75], v[76:79], v[52:55]
v_bitop3_b32 v57, v68, v72, s36 bitop3:0x7e
v_bitop3_b32 v56, v56, v57, 1 bitop3:0xa8
v_cmp_ne_u32 vcc, 0, v56
s_cmp_eq_u32 s34, 63
s_nop 3
v_pk_add_f32 v[52:53], v[52:53], v[54:55]
v_cvt_pk_bf16_f32 v56, v52, v53
v_bfi_b32 v56, v11, s35, v56
s_cbranch_vccnz L_rr_w1rs
buffer_store_dword v56, v10, s[4:7], 0 offen sc0 sc1
v_mov_b32 v11, v56
s_cbranch_scc1 L_done_w1rs
v_bfe_u32 v77, v1, 6, 1
v_lshl_add_u32 v77, v77, 3, v1
v_lshlrev_b32 v77, 1, v77
v_lshlrev_b32 v78, 2, v1
L_top_w1rs:
s_barrier
ds_read_b128 v[60:63], v1 offset:1024
ds_read_b128 v[64:67], v1 offset:2048
s_mov_b32 m0, 5120
s_nop 0
buffer_load_dwordx4 v1, s[4:7], s48 offen offset:1024 sc0 sc1 lds
s_barrier
ds_read_b128 v[68:71], v1 offset:3072
ds_read_b128 v[72:75], v1 offset:4096
L_s0_w1rs:
s_waitcnt lgkmcnt(3)
v_smfmac_f32_16x16x64_bf16 v[28:31], v[60:63], v[176:183], v0
v_smfmac_f32_16x16x64_bf16 v[32:35], v[60:63], v[184:191], v0
s_mov_b32 m0, 9216
s_nop 0
buffer_load_dwordx4 v1, s[4:7], s49 offen offset:0 sc0 sc1 lds
v_smfmac_f32_16x16x64_bf16 v[36:39], v[60:63], a[48:55], v0
v_smfmac_f32_16x16x64_bf16 v[40:43], v[60:63], a[56:63], v0
s_waitcnt lgkmcnt(2)
v_smfmac_f32_16x16x64_bf16 v[20:23], v[64:67], v[80:87], v0
v_smfmac_f32_16x16x64_bf16 v[20:23], v[60:63], v[44:51], v0
ds_read_b128 v[44:47], v2 offset:2048
v_smfmac_f32_16x16x64_bf16 v[24:27], v[64:67], v[88:95], v0
ds_read_b128 v[48:51], v2 offset:3072
v_smfmac_f32_16x16x64_bf16 v[28:31], v[64:67], v[192:199], v0
s_waitcnt lgkmcnt(2)
v_bitop3_b32 v6, v60, v64, s35 bitop3:0x7e
buffer_load_dwordx4 v[12:15], v9, s[4:7], s37 offen offset:0
buffer_load_dwordx4 v[16:19], v9, s[4:7], s37 offen offset:1024
buffer_load_dwordx4 v[52:55], v1, s[4:7], s37 offen offset:2048
buffer_load_dwordx4 v[56:59], v1, s[4:7], s37 offen offset:3072
v_smfmac_f32_16x16x64_bf16 v[32:35], v[64:67], v[200:207], v0
v_bitop3_b32 v76, v68, v72, s35 bitop3:0x7e
v_smfmac_f32_16x16x64_bf16 v[36:39], v[64:67], a[64:71], v0
v_bitop3_b32 v6, v6, v76, 1 bitop3:0xa8
s_waitcnt lgkmcnt(0)
v_smfmac_f32_16x16x64_bf16 v[24:27], v[60:63], v[44:51], v0
ds_read_b128 v[44:47], v2 offset:4096
v_cmp_ne_u32 vcc, 0, v6
v_smfmac_f32_16x16x64_bf16 v[40:43], v[64:67], a[72:79], v0
ds_read_b128 v[48:51], v2 offset:5120
v_smfmac_f32_16x16x64_bf16 v[20:23], v[68:71], v[96:103], v0
s_cbranch_vccnz L_ra0_w1rs
v_smfmac_f32_16x16x64_bf16 v[24:27], v[68:71], v[104:111], v0
s_waitcnt vmcnt(4)
s_barrier
ds_read_b32 v6, v77 offset:8192
v_smfmac_f32_16x16x64_bf16 v[28:31], v[68:71], v[208:215], v0
ds_read_b128 v[60:63], v1 offset:6144
s_waitcnt lgkmcnt(2)
v_smfmac_f32_16x16x64_bf16 v[20:23], v[72:75], v[44:51], v0
ds_read_b128 v[64:67], v1 offset:7168
v_smfmac_f32_16x16x64_bf16 v[32:35], v[68:71], v[216:223], v0
ds_read_b128 v[76:79], v1 offset:5120
v_smfmac_f32_16x16x64_bf16 v[36:39], v[68:71], a[80:87], v0
ds_read_b128 v[44:47], v2 offset:6144
v_smfmac_f32_16x16x64_bf16 v[40:43], v[68:71], a[88:95], v0
ds_read_b128 v[48:51], v2 offset:7168
s_waitcnt lgkmcnt(4)
v_bitop3_b32 v6, v6, v60, s35 bitop3:0x7e
v_smfmac_f32_16x16x64_bf16 v[28:31], v[72:75], v[224:231], v0
ds_read_b128 v[68:71], v1 offset:8192
s_waitcnt lgkmcnt(4)
v_bitop3_b32 v6, v6, v64, s35 bitop3:0xf6
v_smfmac_f32_16x16x64_bf16 v[32:35], v[72:75], v[232:239], v0
s_waitcnt lgkmcnt(3)
v_bitop3_b32 v6, v6, v76, s35 bitop3:0xf6
v_and_b32 v6, 1, v6
v_smfmac_f32_16x16x64_bf16 v[36:39], v[72:75], a[96:103], v0
v_cmp_ne_u32 vcc, 0, v6
s_waitcnt lgkmcnt(1)
v_smfmac_f32_16x16x64_bf16 v[24:27], v[72:75], v[44:51], v0
ds_read_b128 v[44:47], v2 offset:8192
v_lshlrev_b32 v6, 2, v1
v_smfmac_f32_16x16x64_bf16 v[40:43], v[72:75], a[104:111], v0
ds_read_b128 v[72:75], v1 offset:9216
s_cbranch_vccnz L_ra1_w1rs
L_a1_w1rs:
buffer_store_dword v11, v10, s[4:7], s40 offen sc0 sc1
s_mov_b32 m0, 0
s_nop 0
buffer_load_dword v6, s[4:7], s39 offen lds
v_smfmac_f32_16x16x64_bf16 v[20:23], v[60:63], v[112:119], v0
ds_read_b128 v[48:51], v2 offset:9216
v_smfmac_f32_16x16x64_bf16 v[20:23], v[64:67], v[128:135], v0
s_waitcnt lgkmcnt(3)
v_smfmac_f32_16x16x64_bf16 v[20:23], v[68:71], v[144:151], v0
s_waitcnt lgkmcnt(1)
v_smfmac_f32_16x16x64_bf16 v[20:23], v[72:75], v[160:167], v0
s_waitcnt lgkmcnt(0)
v_smfmac_f32_16x16x64_bf16 v[20:23], v[76:79], v[44:51], v0
ds_read_b128 v[44:47], v2 offset:10240
v_smfmac_f32_16x16x64_bf16 v[24:27], v[60:63], v[120:127], v0
ds_read_b128 v[48:51], v2 offset:11264
v_smfmac_f32_16x16x64_bf16 v[24:27], v[64:67], v[136:143], v0
v_add_f32 v20, v20, v22
v_smfmac_f32_16x16x64_bf16 v[24:27], v[68:71], v[152:159], v0
v_add_f32 v21, v21, v23
v_smfmac_f32_16x16x64_bf16 v[24:27], v[72:75], v[168:175], v0
v_cvt_pk_bf16_f32 v22, v20, v21
s_waitcnt lgkmcnt(0)
v_smfmac_f32_16x16x64_bf16 v[24:27], v[76:79], v[44:51], v0
ds_read_b128 v[44:47], v2 offset:12288
v_smfmac_f32_16x16x64_bf16 v[28:31], v[76:79], v[240:247], v0
ds_read_b128 v[48:51], v2 offset:13312
v_smfmac_f32_16x16x64_bf16 v[28:31], v[64:67], a[0:7], v0
v_add_f32 v24, v24, v26
v_add_f32 v25, v25, v27
v_cvt_pk_bf16_f32 v23, v24, v25
v_smfmac_f32_16x16x64_bf16 v[28:31], v[68:71], a[16:23], v0
ds_write_b64 v3, v[22:23] offset:10752
v_smfmac_f32_16x16x64_bf16 v[28:31], v[72:75], a[32:39], v0
s_waitcnt lgkmcnt(1)
v_smfmac_f32_16x16x64_bf16 v[28:31], v[60:63], v[44:51], v0
ds_read_b128 v[44:47], v2 offset:14336
v_smfmac_f32_16x16x64_bf16 v[32:35], v[76:79], v[248:255], v0
ds_read_b128 v[48:51], v2 offset:15360
s_waitcnt lgkmcnt(2)
s_barrier
v_smfmac_f32_16x16x64_bf16 v[32:35], v[64:67], a[8:15], v0
ds_read_b64_tr_b16 v[20:21], v4 offset:10240
ds_read_b64_tr_b16 v[22:23], v4 offset:10752
v_add_f32 v28, v28, v30
v_smfmac_f32_16x16x64_bf16 v[32:35], v[68:71], a[24:31], v0
ds_read_b64_tr_b16 v[24:25], v4 offset:11264
v_add_f32 v29, v29, v31
v_smfmac_f32_16x16x64_bf16 v[32:35], v[72:75], a[40:47], v0
ds_read_b64_tr_b16 v[26:27], v4 offset:11776
v_cvt_pk_bf16_f32 v30, v28, v29
s_waitcnt lgkmcnt(4)
v_smfmac_f32_16x16x64_bf16 v[32:35], v[60:63], v[44:51], v0
ds_read_b128 v[44:47], v2 offset:18432
s_waitcnt vmcnt(4)
s_waitcnt lgkmcnt(3)
v_mfma_f32_16x16x32_bf16 v[12:15], v[12:15], v[20:23], 0
ds_read_b128 v[48:51], v2 offset:19456
s_waitcnt lgkmcnt(2)
v_mfma_f32_16x16x32_bf16 v[12:15], v[16:19], v[24:27], v[12:15]
v_add_f32 v32, v32, v34
v_add_f32 v33, v33, v35
v_cvt_pk_bf16_f32 v31, v32, v33
ds_write_b64 v3, v[30:31] offset:12800
v_smfmac_f32_16x16x64_bf16 v[36:39], v[76:79], a[112:119], v0
s_nop 2
v_add_f32_dpp v12, v14, v12 quad_perm:[2,3,0,1] row_mask:0xf bank_mask:0xf
v_add_f32_dpp v13, v15, v13 quad_perm:[2,3,0,1] row_mask:0xf bank_mask:0xf
ds_write_b64 v5, v[12:13] offset:14592
v_smfmac_f32_16x16x64_bf16 v[40:43], v[76:79], a[120:127], v0
s_waitcnt lgkmcnt(1)
s_barrier
ds_read_b64_tr_b16 v[28:29], v4 offset:12288
v_smfmac_f32_16x16x64_bf16 v[36:39], v[60:63], a[128:135], v0
ds_read_b64_tr_b16 v[30:31], v4 offset:12800
ds_read_b64_tr_b16 v[32:33], v4 offset:13312
v_smfmac_f32_16x16x64_bf16 v[40:43], v[60:63], a[136:143], v0
ds_read_b64_tr_b16 v[34:35], v4 offset:13824
v_mov_b64 v[76:77], s[52:53]
s_waitcnt lgkmcnt(4)
s_barrier
ds_read_b128 v[12:15], v1 offset:14336
v_smfmac_f32_16x16x64_bf16 v[40:43], v[72:75], v[44:51], v0
ds_read_b128 v[44:47], v2 offset:16384
v_mov_b64 v[78:79], s[52:53]
s_waitcnt lgkmcnt(4)
v_mfma_f32_16x16x32_bf16 v[28:31], v[28:31], v[20:23], 0
ds_read_b128 v[48:51], v2 offset:17408
s_waitcnt lgkmcnt(3)
v_mfma_f32_16x16x32_bf16 v[28:31], v[32:35], v[24:27], v[28:31]
v_smfmac_f32_16x16x64_bf16 v[40:43], v[64:67], a[152:159], v0
s_waitcnt lgkmcnt(2)
v_max3_f32 v17, v12, v13, v14
v_smfmac_f32_16x16x64_bf16 v[36:39], v[64:67], a[144:151], v0
ds_read_b128 v[60:63], v2 offset:20480
v_add_f32_dpp v28, v30, v28 quad_perm:[2,3,0,1] row_mask:0xf bank_mask:0xf
v_add_f32_dpp v29, v31, v29 quad_perm:[2,3,0,1] row_mask:0xf bank_mask:0xf
v_max_f32 v17, v17, v15
v_max_f32 v16, v28, v29
v_mul_f32 v16, s50, v16
v_max_f32_dpp v17, v17, v17 quad_perm:[2,3,0,1] row_mask:0xf bank_mask:0xf
v_smfmac_f32_16x16x64_bf16 v[40:43], v[68:71], a[168:175], v0
ds_read_b128 v[64:67], v2 offset:21504
v_max_f32_dpp v18, v16, v17 quad_perm:[0,1,0,1] row_mask:0xf bank_mask:0xf
v_max_f32_dpp v19, v16, v17 quad_perm:[0,1,0,1] row_mask:0xf bank_mask:0xf
v_smfmac_f32_16x16x64_bf16 v[36:39], v[68:71], a[160:167], v0
ds_read_b128 v[68:71], v2 offset:26624
v_permlane16_swap_b32 v18, v19
v_max_f32 v20, v18, v19
v_max_f32 v21, v18, v19
s_waitcnt lgkmcnt(3)
v_smfmac_f32_16x16x64_bf16 v[36:39], v[72:75], v[44:51], v0
ds_read_b128 v[72:75], v2 offset:27648
v_permlane32_swap_b32 v20, v21
v_max_f32 v20, v20, v21
v_sub_f32 v12, v12, v20
v_sub_f32 v13, v13, v20
v_pk_add_f32 v[14:15], v[14:15], v[20:21] op_sel_hi:[1,0] neg_lo:[0,1] neg_hi:[0,1]
v_exp_f32 v12, v12
v_exp_f32 v13, v13
v_exp_f32 v14, v14
v_exp_f32 v15, v15
v_cvt_pk_bf16_f32 v16, v12, v13
v_cvt_pk_bf16_f32 v17, v14, v15
v_pk_fma_f32 v[28:29], v[28:29], s[50:51], v[20:21] op_sel_hi:[1,1,0] neg_lo:[0,0,1] neg_hi:[0,0,1]
v_mov_b32_dpp v18, v16 quad_perm:[2,3,0,1] row_mask:0xf bank_mask:0xf
v_mov_b32_dpp v19, v17 quad_perm:[2,3,0,1] row_mask:0xf bank_mask:0xf
v_exp_f32 v28, v28
s_waitcnt vmcnt(2)
v_mfma_f32_16x16x32_bf16 v[32:35], v[76:79], v[16:19], 0
v_exp_f32 v29, v29
v_mfma_f32_16x16x32_bf16 v[20:23], v[52:55], v[16:19], 0
v_cvt_pk_bf16_f32 v12, v28, v29
v_cvt_pk_bf16_f32 v13, v28, v29
v_mov_b64 v[14:15], s[0:1]
v_mfma_f32_16x16x32_bf16 v[24:27], v[56:59], v[16:19], 0
v_cvt_pk_bf16_f32 v36, v36, v37
v_cvt_pk_bf16_f32 v37, v38, v39
v_mfma_f32_16x16x16_bf16 v[32:35], v[14:15], v[12:13], v[32:35]
v_cvt_pk_bf16_f32 v38, v40, v41
v_cvt_pk_bf16_f32 v39, v42, v43
v_mfma_f32_16x16x16_bf16 v[20:23], v[36:37], v[12:13], v[20:23]
ds_read_b128 v[44:47], v2 offset:22528
v_mfma_f32_16x16x16_bf16 v[24:27], v[38:39], v[12:13], v[24:27]
ds_read_b128 v[48:51], v2 offset:23552
v_rcp_f32 v32, v32
v_mov_b64 v[28:29], 0
v_mov_b64 v[30:31], 0
v_pk_mul_f32 v[20:21], v[20:21], v[32:33] op_sel_hi:[1,0]
v_pk_mul_f32 v[22:23], v[22:23], v[32:33] op_sel_hi:[1,0]
v_cvt_pk_bf16_f32 v20, v20, v21
v_cvt_pk_bf16_f32 v21, v22, v23
ds_write_b64 v1, v[20:21] offset:6144
v_pk_mul_f32 v[24:25], v[24:25], v[32:33] op_sel_hi:[1,0]
v_pk_mul_f32 v[26:27], v[26:27], v[32:33] op_sel_hi:[1,0]
v_cvt_pk_bf16_f32 v24, v24, v25
v_cvt_pk_bf16_f32 v25, v26, v27
ds_write_b64 v1, v[24:25] offset:6152
v_mov_b64 v[76:77], 0
ds_read_b128 v[12:15], v7 offset:6144
v_mov_b64 v[78:79], 0
v_mov_b64 v[40:41], 0
v_mov_b64 v[42:43], 0
v_mov_b64 v[36:37], 0
v_mov_b64 v[38:39], 0
v_mov_b64 v[32:33], 0
v_mov_b64 v[34:35], 0
s_waitcnt lgkmcnt(1)
s_barrier
ds_read_b128 v[16:19], v7 offset:7168
ds_read_b128 v[52:55], v7 offset:8192
ds_read_b128 v[56:59], v7 offset:5120
s_waitcnt lgkmcnt(3)
v_smfmac_f32_16x16x64_bf16 v[28:31], v[12:15], a[176:183], v0 abid:1
v_smfmac_f32_16x16x64_bf16 v[76:79], v[12:15], a[184:191], v0 abid:1
s_waitcnt lgkmcnt(2)
v_smfmac_f32_16x16x64_bf16 v[28:31], v[16:19], v[44:51], v0 abid:1
ds_read_b128 v[44:47], v2 offset:24576
s_waitcnt lgkmcnt(2)
v_smfmac_f32_16x16x64_bf16 v[28:31], v[52:55], a[192:199], v0 abid:1
ds_read_b128 v[48:51], v2 offset:25600
s_waitcnt lgkmcnt(2)
v_smfmac_f32_16x16x64_bf16 v[28:31], v[56:59], v[60:67], v0 abid:1
ds_read_b128 v[60:63], v2 offset:30720
v_smfmac_f32_16x16x64_bf16 v[76:79], v[16:19], v[68:75], v0 abid:1
ds_read_b128 v[64:67], v2 offset:31744
v_smfmac_f32_16x16x64_bf16 v[76:79], v[52:55], a[200:207], v0 abid:1
ds_read_b128 v[68:71], v2 offset:28672
v_cvt_pk_bf16_f32 v28, v28, v29
v_cvt_pk_bf16_f32 v29, v30, v31
v_bfi_b32 v28, 1, s35, v28
buffer_store_dwordx2 v[28:29], v8, s[4:7], s42 offen sc0 sc1
s_waitcnt lgkmcnt(3)
v_smfmac_f32_16x16x64_bf16 v[76:79], v[56:59], v[44:51], v0 abid:1
ds_read_b128 v[72:75], v2 offset:29696
v_smfmac_f32_16x16x64_bf16 v[40:43], v[12:15], a[208:215], v0 abid:1
ds_read_b128 v[44:47], v2 offset:36864
s_waitcnt lgkmcnt(3)
v_smfmac_f32_16x16x64_bf16 v[40:43], v[16:19], v[60:67], v0 abid:1
ds_read_b128 v[48:51], v2 offset:37888
v_cvt_pk_bf16_f32 v76, v76, v77
v_cvt_pk_bf16_f32 v77, v78, v79
v_bfi_b32 v76, 1, s35, v76
buffer_store_dwordx2 v[76:77], v8, s[4:7], s43 offen sc0 sc1
v_smfmac_f32_16x16x64_bf16 v[40:43], v[52:55], a[216:223], v0 abid:1
ds_read_b128 v[60:63], v2 offset:34816
s_waitcnt lgkmcnt(3)
v_smfmac_f32_16x16x64_bf16 v[40:43], v[56:59], v[68:75], v0 abid:1
ds_read_b128 v[64:67], v2 offset:35840
v_smfmac_f32_16x16x64_bf16 v[36:39], v[12:15], a[224:231], v0 abid:1
ds_read_b128 v[68:71], v2 offset:38912
v_smfmac_f32_16x16x64_bf16 v[36:39], v[16:19], a[232:239], v0 abid:1
ds_read_b128 v[72:75], v2 offset:39936
v_cvt_pk_bf16_f32 v40, v40, v41
v_cvt_pk_bf16_f32 v41, v42, v43
v_bfi_b32 v40, 1, s35, v40
buffer_store_dwordx2 v[40:41], v8, s[4:7], s44 offen sc0 sc1
v_smfmac_f32_16x16x64_bf16 v[36:39], v[52:55], a[240:247], v0 abid:1
v_smfmac_f32_16x16x64_bf16 v[36:39], v[56:59], a[248:255], v0 abid:1
s_waitcnt lgkmcnt(4)
v_smfmac_f32_16x16x64_bf16 v[32:35], v[12:15], v[44:51], v0 abid:1
ds_read_b128 v[44:47], v2 offset:32768
s_waitcnt lgkmcnt(3)
v_smfmac_f32_16x16x64_bf16 v[32:35], v[16:19], v[60:67], v0 abid:1
ds_read_b128 v[48:51], v2 offset:33792
v_cvt_pk_bf16_f32 v36, v36, v37
v_cvt_pk_bf16_f32 v37, v38, v39
v_bfi_b32 v36, 1, s35, v36
buffer_store_dwordx2 v[36:37], v8, s[4:7], s45 offen sc0 sc1
s_waitcnt lgkmcnt(2)
v_smfmac_f32_16x16x64_bf16 v[32:35], v[52:55], v[68:75], v0 abid:1
s_waitcnt lgkmcnt(0)
v_smfmac_f32_16x16x64_bf16 v[32:35], v[56:59], v[44:51], v0 abid:1
s_nop 7
v_cvt_pk_bf16_f32 v32, v32, v33
v_cvt_pk_bf16_f32 v33, v34, v35
v_bfi_b32 v32, 1, s35, v32
buffer_store_dwordx2 v[32:33], v8, s[4:7], s46 offen sc0 sc1
s_branch L_ex_w1rs
L_done_w1rs:
buffer_store_dword v11, v10, s[4:7], s40 offen sc0 sc1
s_waitcnt vmcnt(0) lgkmcnt(0)
s_endpgm
L_ra0_w1rs:
s_mov_b32 m0, 1024
s_nop 0
buffer_load_dwordx4 v1, s[4:7], s47 offen offset:0 sc0 sc1 lds
buffer_load_dwordx4 v1, s[4:7], s47 offen offset:1024 sc0 sc1 lds
buffer_load_dwordx4 v1, s[4:7], s47 offen offset:2048 sc0 sc1 lds
buffer_load_dwordx4 v1, s[4:7], s47 offen offset:3072 sc0 sc1 lds
s_sub_u32 s41, s41, 1
s_cbranch_scc1 L_exit
ds_read_b128 v[44:47], v2 offset:0
ds_read_b128 v[48:51], v2 offset:1024
v_mov_b64 v[20:21], 0
v_mov_b64 v[22:23], 0
v_mov_b64 v[24:25], 0
v_mov_b64 v[26:27], 0
v_mov_b64 v[28:29], 0
v_mov_b64 v[30:31], 0
v_mov_b64 v[32:33], 0
v_mov_b64 v[34:35], 0
v_mov_b64 v[36:37], 0
v_mov_b64 v[38:39], 0
v_mov_b64 v[40:41], 0
v_mov_b64 v[42:43], 0
s_waitcnt vmcnt(0)
ds_read_b128 v[60:63], v1 offset:1024
ds_read_b128 v[64:67], v1 offset:2048
ds_read_b128 v[68:71], v1 offset:3072
ds_read_b128 v[72:75], v1 offset:4096
s_branch L_s0_w1rs
L_ra1_w1rs:
s_waitcnt lgkmcnt(0)
s_barrier
s_mov_b32 m0, 5120
s_nop 0
buffer_load_dwordx4 v1, s[4:7], s48 offen offset:1024 sc0 sc1 lds
s_sub_u32 s41, s41, 1
s_cbranch_scc1 L_exit
s_waitcnt vmcnt(0)
s_barrier
ds_read_b128 v[76:79], v1 offset:5120
ds_read_b128 v[60:63], v1 offset:6144
ds_read_b128 v[64:67], v1 offset:7168
ds_read_b128 v[68:71], v1 offset:8192
ds_read_b128 v[72:75], v1 offset:9216
s_waitcnt lgkmcnt(0)
v_bitop3_b32 v6, v76, v60, s35 bitop3:0x7e
v_bitop3_b32 v6, v6, v64, s35 bitop3:0xf6
v_bitop3_b32 v6, v6, v68, s35 bitop3:0xf6
v_bitop3_b32 v6, v6, v72, s35 bitop3:0xf6
v_and_b32 v6, 1, v6
v_cmp_ne_u32 vcc, 0, v6
v_lshlrev_b32 v6, 2, v1
s_cbranch_vccnz L_ra1_w1rs
s_branch L_a1_w1rs
L_rr_w1rs:
buffer_load_dwordx4 v[60:63], v9, s[4:7], s3 offen offset:0 sc0 sc1
buffer_load_dwordx4 v[64:67], v9, s[4:7], s3 offen offset:1024 sc0 sc1
buffer_load_dwordx4 v[68:71], v9, s[4:7], s3 offen offset:2048 sc0 sc1
buffer_load_dwordx4 v[72:75], v9, s[4:7], s3 offen offset:3072 sc0 sc1
s_sub_u32 s41, s41, 1
s_cbranch_scc1 L_exit
s_waitcnt vmcnt(0)
s_branch L_r_w1rs
L_pro_w2r:
v_and_b32 v20, 63, v0
v_and_b32 v21, 15, v0
v_bfe_u32 v22, v0, 4, 2
v_lshlrev_b32 v1, 4, v20
v_add_u32 v2, 98304, v1
v_lshrrev_b32 v24, 1, v22
v_and_b32 v23, 1, v22
v_lshl_add_u32 v23, v24, 3, v23
v_lshlrev_b32 v23, 13, v23
v_lshlrev_b32 v26, 1, v22
v_xor_b32 v26, v26, v21
v_lshl_add_u32 v26, v26, 4, v23
v_xor_b32 v27, 128, v26
v_and_b32 v23, 1, v22
v_lshl_add_u32 v23, v24, 4, v23
v_mul_u32_u24 v23, 1152, v23
v_lshlrev_b32 v28, 2, v22
v_xor_b32 v28, v28, v21
v_lshl_add_u32 v28, v28, 4, v23
s_lshl_b32 s54, s32, 8
s_mul_i32 s55, s32, 147456
s_waitcnt lgkmcnt(0)
s_add_u32 s56, s54, 786432
s_mov_b32 m0, 118784
s_nop 0
buffer_load_dwordx4 v26, s[8:11], s56 offen lds
s_add_u32 s56, s54, 802816
s_mov_b32 m0, 119808
s_nop 0
buffer_load_dwordx4 v26, s[8:11], s56 offen lds
s_add_u32 s56, s54, 819200
s_mov_b32 m0, 120832
s_nop 0
buffer_load_dwordx4 v27, s[8:11], s56 offen lds
s_add_u32 s56, s54, 835584
s_mov_b32 m0, 121856
s_nop 0
buffer_load_dwordx4 v27, s[8:11], s56 offen lds
s_add_u32 s56, s54, 1310720
s_mov_b32 m0, 122880
s_nop 0
buffer_load_dwordx4 v26, s[8:11], s56 offen lds
s_add_u32 s56, s54, 1327104
s_mov_b32 m0, 123904
s_nop 0
buffer_load_dwordx4 v26, s[8:11], s56 offen lds
s_add_u32 s56, s54, 1343488
s_mov_b32 m0, 124928
s_nop 0
buffer_load_dwordx4 v27, s[8:11], s56 offen lds
s_add_u32 s56, s54, 1359872
s_mov_b32 m0, 125952
s_nop 0
buffer_load_dwordx4 v27, s[8:11], s56 offen lds
v_and_b32 v23, 1, v22
v_lshrrev_b32 v24, 2, v21
v_lshl_add_u32 v23, v23, 2, v24
v_lshlrev_b32 v23, 1, v23
v_bfe_u32 v44, v21, 1, 1
v_add_u32 v44, 8, v44
v_xor_b32 v44, v44, v23
v_lshlrev_b32 v44, 4, v44
v_lshl_add_u32 v44, v24, 8, v44
v_and_b32 v23, 1, v22
v_lshl_add_u32 v44, v23, 11, v44
v_and_b32 v23, 1, v21
v_lshl_add_u32 v44, v23, 3, v44
v_lshrrev_b32 v23, 1, v22
v_mul_u32_u24 v23, 40960, v23
v_add_u32 v23, 16384, v23
v_add_u32 v44, v44, v23
v_and_b32 v23, 1, v22
v_lshrrev_b32 v24, 2, v21
v_lshl_add_u32 v23, v23, 2, v24
v_lshlrev_b32 v23, 1, v23
v_bfe_u32 v45, v21, 1, 1
v_add_u32 v45, 10, v45
v_xor_b32 v45, v45, v23
v_lshlrev_b32 v45, 4, v45
v_lshl_add_u32 v45, v24, 8, v45
v_and_b32 v23, 1, v22
v_lshl_add_u32 v45, v23, 11, v45
v_and_b32 v23, 1, v21
v_lshl_add_u32 v45, v23, 3, v45
v_lshrrev_b32 v23, 1, v22
v_mul_u32_u24 v23, 40960, v23
v_add_u32 v23, 16384, v23
v_add_u32 v45, v45, v23
v_and_b32 v23, 1, v22
v_lshrrev_b32 v24, 2, v21
v_lshl_add_u32 v23, v23, 2, v24
v_lshlrev_b32 v23, 1, v23
v_bfe_u32 v46, v21, 1, 1
v_add_u32 v46, 8, v46
v_xor_b32 v46, v46, v23
v_lshlrev_b32 v46, 4, v46
v_lshl_add_u32 v46, v24, 8, v46
v_and_b32 v23, 1, v22
v_lshl_add_u32 v46, v23, 11, v46
v_and_b32 v23, 1, v21
v_lshl_add_u32 v46, v23, 3, v46
v_lshrrev_b32 v23, 1, v22
v_mul_u32_u24 v23, 32768, v23
v_add_u32 v23, 98304, v23
v_add_u32 v46, v46, v23
v_and_b32 v23, 1, v22
v_lshrrev_b32 v24, 2, v21
v_lshl_add_u32 v23, v23, 2, v24
v_lshlrev_b32 v23, 1, v23
v_bfe_u32 v47, v21, 1, 1
v_add_u32 v47, 10, v47
v_xor_b32 v47, v47, v23
v_lshlrev_b32 v47, 4, v47
v_lshl_add_u32 v47, v24, 8, v47
v_and_b32 v23, 1, v22
v_lshl_add_u32 v47, v23, 11, v47
v_and_b32 v23, 1, v21
v_lshl_add_u32 v47, v23, 3, v47
v_lshrrev_b32 v23, 1, v22
v_mul_u32_u24 v23, 32768, v23
v_add_u32 v23, 98304, v23
v_add_u32 v47, v47, v23
v_and_b32 v23, 1, v22
v_bfe_u32 v24, v21, 2, 1
v_lshl_add_u32 v23, v23, 1, v24
v_xor_b32 v24, 2, v23
v_lshlrev_b32 v24, 6, v24
v_lshl_add_u32 v48, v23, 8, v24
v_and_b32 v23, 3, v21
v_lshl_add_u32 v48, v23, 4, v48
v_and_b32 v23, 8, v21
v_add_u32 v48, v48, v23
v_lshrrev_b32 v23, 1, v22
v_mul_u32_u24 v23, 40960, v23
v_add_u32 v23, 16384, v23
v_add_u32 v48, v48, v23
v_and_b32 v23, 1, v22
v_bfe_u32 v24, v21, 2, 1
v_lshl_add_u32 v23, v23, 1, v24
v_xor_b32 v24, 2, v23
v_lshlrev_b32 v24, 6, v24
v_lshl_add_u32 v49, v23, 8, v24
v_and_b32 v23, 3, v21
v_lshl_add_u32 v49, v23, 4, v49
v_and_b32 v23, 8, v21
v_add_u32 v49, v49, v23
v_lshrrev_b32 v23, 1, v22
v_mul_u32_u24 v23, 32768, v23
v_add_u32 v23, 98304, v23
v_add_u32 v49, v49, v23
v_bfe_u32 v23, v21, 1, 1
v_and_b32 v24, 1, v21
v_lshl_add_u32 v23, v24, 16, v23
v_mul_u32_u24 v23, 0xaaaa, v23
v_add_u32 v0, 0x44444444, v23
v_lshlrev_b32 v3, 3, v20
v_lshrrev_b32 v25, 5, v20
v_lshlrev_b32 v25, 6, v25
v_xor_b32 v3, v3, v25
v_lshrrev_b32 v25, 2, v20
v_and_b32 v4, 3, v21
v_lshl_add_u32 v4, v4, 4, v25
v_lshlrev_b32 v4, 3, v4
v_bfe_u32 v25, v21, 1, 1
v_lshlrev_b32 v23, 6, v25
v_xor_b32 v4, v4, v23
v_and_b32 v23, 2, v22
v_xor_b32 v5, v21, v23
v_lshlrev_b32 v5, 4, v5
v_lshl_add_u32 v5, v25, 10, v5
v_and_b32 v23, 1, v22
v_lshl_add_u32 v5, v23, 3, v5
v_lshlrev_b32 v9, 8, v22
v_lshl_add_u32 v9, v25, 6, v9
v_bfe_u32 v23, v21, 3, 1
v_lshl_add_u32 v9, v23, 7, v9
v_bfe_u32 v23, v21, 2, 1
v_lshl_add_u32 v9, v23, 5, v9
v_and_b32 v23, 1, v21
v_lshl_add_u32 v9, v23, 4, v9
v_lshrrev_b32 v23, 1, v22
v_and_b32 v24, 1, v22
v_and_b32 v25, 7, v21
v_lshrrev_b32 v7, 3, v21
v_lshl_add_u32 v8, v7, 1, v23
v_lshlrev_b32 v8, 12, v8
v_lshl_add_u32 v8, v24, 7, v8
v_and_b32 v25, 4, v21
v_lshl_add_u32 v8, v25, 3, v8
v_and_b32 v25, 1, v21
v_lshl_add_u32 v8, v25, 4, v8
v_bfe_u32 v25, v21, 1, 1
v_lshl_add_u32 v8, v25, 3, v8
s_lshr_b32 s56, s32, 1
s_lshl_b32 s56, s56, 8
s_and_b32 s57, s32, 1
s_lshl_b32 s57, s57, 6
s_add_u32 s56, s56, s57
s_add_u32 s56, s56, 32768
v_add_u32 v8, s56, v8
v_and_b32 v7, 12, v21
v_bfe_u32 v25, v21, 1, 1
v_add_u32 v7, v7, v25
v_lshlrev_b32 v7, 4, v7
v_lshl_add_u32 v7, v22, 8, v7
s_mov_b32 s42, 0
s_mov_b32 s43, 65536
s_mov_b32 s44, 131072
s_mov_b32 s45, 196608
s_mov_b32 s46, 262144
s_mov_b32 s47, 294912
s_mov_b32 s48, 299008
s_mov_b32 s49, 303104
s_mov_b32 s50, 0x3e0293ee
s_mov_b32 s51, 0x3e0293ee
s_mov_b32 s52, 0x3f803f80
s_mov_b32 s53, 0x3f803f80
v_and_b32 v11, 3, v21
v_cmp_eq_u32 vcc, 0, v11
s_nop 1
v_cndmask_b32 v11, 0, 1, vcc
s_mov_b32 s34, 0
s_mov_b32 s35, -1
s_mov_b32 s36, 0
s_mov_b32 s41, 300000
s_lshl_b32 s37, s32, 14
s_add_u32 s39, s37, 17309696
s_add_u32 s37, s37, 16785408
s_mov_b32 s40, 8749056
v_mov_b64 v[36:37], 0
v_mov_b64 v[38:39], 0
s_lshl_b32 s56, s32, 1
s_add_u32 s56, s56, 1
s_cmp_eq_u32 s56, 0
s_cselect_b32 s56, 64, s56
s_mul_i32 s56, s56, 10240
s_add_u32 s56, s56, 8388608
s_add_u32 s57, s56, 4096
v_mov_b32 v40, 1
v_mov_b32 v41, 1
v_mov_b32 v42, 1
v_mov_b32 v43, 1
buffer_store_dwordx4 v[40:43], v1, s[4:7], s56 offen offset:0 sc0 sc1
buffer_store_dwordx4 v[40:43], v1, s[4:7], s56 offen offset:1024 sc0 sc1
buffer_store_dwordx4 v[40:43], v1, s[4:7], s56 offen offset:2048 sc0 sc1
buffer_store_dwordx4 v[40:43], v1, s[4:7], s56 offen offset:3072 sc0 sc1
s_add_u32 s56, s32, 0
s_lshl_b32 s3, s56, 12
v_and_b32 v23, 1, v21
v_bfe_u32 v24, v21, 2, 1
v_bfe_u32 v25, v21, 1, 1
s_lshl_b32 s57, s56, 7
s_add_u32 s57, s57, 294912
v_and_b32 v10, 7, v21
v_lshlrev_b32 v10, 2, v10
v_lshl_add_u32 v10, v22, 5, v10
v_add_u32 v10, s57, v10
s_lshl_b32 s33, s56, 2
s_add_u32 s33, s33, 304128
v_mov_b32 v30, -1
s_mov_b64 exec, 1
buffer_store_dword v30, v1, s[4:7], s33 offen sc0 sc1
s_mov_b64 exec, -1
v_lshl_add_u32 v23, v23, 1, v24
v_lshlrev_b32 v25, 4, v25
v_mov_b32 v24, 0x3f80
v_lshlrev_b32 v24, v25, v24
v_cmp_eq_u32 vcc, 0, v23
s_nop 1
v_cndmask_b32 v76, 0, v24, vcc
v_cmp_eq_u32 vcc, 1, v23
s_nop 1
v_cndmask_b32 v77, 0, v24, vcc
v_cmp_eq_u32 vcc, 2, v23
s_nop 1
v_cndmask_b32 v78, 0, v24, vcc
v_cmp_eq_u32 vcc, 3, v23
s_nop 1
v_cndmask_b32 v79, 0, v24, vcc
v_and_b32 v23, 0x70, v1
ds_write_b128 v23, v[76:79] offset:256
buffer_store_dwordx4 v[36:39], v9, s[4:7], s3 offen offset:0 sc0 sc1
buffer_store_dwordx4 v[36:39], v9, s[4:7], s3 offen offset:1024 sc0 sc1
buffer_store_dwordx4 v[36:39], v9, s[4:7], s3 offen offset:2048 sc0 sc1
buffer_store_dwordx4 v[36:39], v9, s[4:7], s3 offen offset:3072 sc0 sc1
s_getreg_b32 s56, hwreg(HW_REG_XCC_ID)
s_and_b32 s56, s56, 15
s_mul_i32 s57, s56, s56
s_lshl_b32 s57, s57, 18
s_lshl_b32 s56, s56, 8
s_add_u32 s57, s57, s56
s_add_u32 s58, s57, 1
s_lshl_b32 s101, s32, 7
s_add_u32 s101, s101, 327680
v_mov_b32 v24, 0
s_add_u32 s56, s54, 2883584
s_mov_b32 m0, 126976
s_nop 0
buffer_load_dwordx4 v26, s[8:11], s56 offen lds
s_add_u32 s56, s54, 2899968
s_mov_b32 m0, 128000
s_nop 0
buffer_load_dwordx4 v26, s[8:11], s56 offen lds
s_add_u32 s56, s54, 2916352
s_mov_b32 m0, 129024
s_nop 0
buffer_load_dwordx4 v27, s[8:11], s56 offen lds
s_add_u32 s56, s54, 2932736
s_mov_b32 m0, 130048
s_nop 0
buffer_load_dwordx4 v27, s[8:11], s56 offen lds
s_add_u32 s56, s54, 3407872
s_mov_b32 m0, 98304
s_nop 0
buffer_load_dwordx4 v26, s[8:11], s56 offen lds
s_add_u32 s56, s54, 3424256
s_mov_b32 m0, 99328
s_nop 0
buffer_load_dwordx4 v26, s[8:11], s56 offen lds
s_add_u32 s56, s54, 3440640
s_mov_b32 m0, 100352
s_nop 0
buffer_load_dwordx4 v27, s[8:11], s56 offen lds
s_add_u32 s56, s54, 3457024
s_mov_b32 m0, 101376
s_nop 0
buffer_load_dwordx4 v27, s[8:11], s56 offen lds
s_add_u32 s56, s54, 3932160
s_mov_b32 m0, 102400
s_nop 0
buffer_load_dwordx4 v26, s[8:11], s56 offen lds
s_add_u32 s56, s54, 3948544
s_mov_b32 m0, 103424
s_nop 0
buffer_load_dwordx4 v26, s[8:11], s56 offen lds
s_add_u32 s56, s54, 3964928
s_mov_b32 m0, 104448
s_nop 0
buffer_load_dwordx4 v27, s[8:11], s56 offen lds
s_add_u32 s56, s54, 3981312
s_mov_b32 m0, 105472
s_nop 0
buffer_load_dwordx4 v27, s[8:11], s56 offen lds
s_add_u32 s56, s54, 4456448
s_mov_b32 m0, 106496
s_nop 0
buffer_load_dwordx4 v26, s[8:11], s56 offen lds
s_add_u32 s56, s54, 4472832
s_mov_b32 m0, 107520
s_nop 0
buffer_load_dwordx4 v26, s[8:11], s56 offen lds
s_add_u32 s56, s54, 4489216
s_mov_b32 m0, 108544
s_nop 0
buffer_load_dwordx4 v27, s[8:11], s56 offen lds
s_add_u32 s56, s54, 4505600
s_mov_b32 m0, 109568
s_nop 0
buffer_load_dwordx4 v27, s[8:11], s56 offen lds
s_add_u32 s56, s54, 262144
s_mov_b32 m0, 110592
s_nop 0
buffer_load_dwordx4 v26, s[12:15], s56 offen lds
s_add_u32 s56, s54, 278528
s_mov_b32 m0, 111616
s_nop 0
buffer_load_dwordx4 v26, s[12:15], s56 offen lds
s_add_u32 s56, s54, 294912
s_mov_b32 m0, 112640
s_nop 0
buffer_load_dwordx4 v27, s[12:15], s56 offen lds
s_add_u32 s56, s54, 311296
s_mov_b32 m0, 113664
s_nop 0
buffer_load_dwordx4 v27, s[12:15], s56 offen lds
s_add_u32 s56, s54, 786432
s_mov_b32 m0, 114688
s_nop 0
buffer_load_dwordx4 v26, s[12:15], s56 offen lds
s_add_u32 s56, s54, 802816
s_mov_b32 m0, 115712
s_nop 0
buffer_load_dwordx4 v26, s[12:15], s56 offen lds
s_add_u32 s56, s54, 819200
s_mov_b32 m0, 116736
s_nop 0
buffer_load_dwordx4 v27, s[12:15], s56 offen lds
s_add_u32 s56, s54, 835584
s_mov_b32 m0, 117760
s_nop 0
buffer_load_dwordx4 v27, s[12:15], s56 offen lds
v_mov_b32 v24, 0
s_waitcnt vmcnt(37)
s_barrier
ds_read_b64_tr_b16 v[80:81], v44 offset:20480
ds_read_b64_tr_b16 v[82:83], v44 offset:21504
ds_read_b64_tr_b16 v[84:85], v46 offset:20480
ds_read_b64_tr_b16 v[86:87], v46 offset:21504
ds_read_b64_tr_b16 v[88:89], v45 offset:20480
ds_read_b64_tr_b16 v[90:91], v45 offset:21504
ds_read_b64_tr_b16 v[92:93], v47 offset:20480
ds_read_b64_tr_b16 v[94:95], v47 offset:21504
s_waitcnt lgkmcnt(0)
s_waitcnt vmcnt(33)
s_barrier
s_add_u32 s56, s54, 1310720
s_mov_b32 m0, 118784
s_nop 0
buffer_load_dwordx4 v26, s[12:15], s56 offen lds
s_add_u32 s56, s54, 1327104
s_mov_b32 m0, 119808
s_nop 0
buffer_load_dwordx4 v26, s[12:15], s56 offen lds
s_add_u32 s56, s54, 1343488
s_mov_b32 m0, 120832
s_nop 0
buffer_load_dwordx4 v27, s[12:15], s56 offen lds
s_add_u32 s56, s54, 1359872
s_mov_b32 m0, 121856
s_nop 0
buffer_load_dwordx4 v27, s[12:15], s56 offen lds
ds_read_b64_tr_b16 v[96:97], v44 offset:24576
ds_read_b64_tr_b16 v[98:99], v44 offset:25600
ds_read_b64_tr_b16 v[100:101], v46 offset:24576
ds_read_b64_tr_b16 v[102:103], v46 offset:25600
ds_read_b64_tr_b16 v[104:105], v45 offset:24576
ds_read_b64_tr_b16 v[106:107], v45 offset:25600
ds_read_b64_tr_b16 v[108:109], v47 offset:24576
ds_read_b64_tr_b16 v[110:111], v47 offset:25600
s_waitcnt lgkmcnt(0)
s_waitcnt vmcnt(24)
s_barrier
s_add_u32 s56, s54, 1835008
s_mov_b32 m0, 122880
s_nop 0
buffer_load_dwordx4 v26, s[12:15], s56 offen lds
s_add_u32 s56, s54, 1851392
s_mov_b32 m0, 123904
s_nop 0
buffer_load_dwordx4 v26, s[12:15], s56 offen lds
s_add_u32 s56, s54, 1867776
s_mov_b32 m0, 124928
s_nop 0
buffer_load_dwordx4 v27, s[12:15], s56 offen lds
s_add_u32 s56, s54, 1884160
s_mov_b32 m0, 125952
s_nop 0
buffer_load_dwordx4 v27, s[12:15], s56 offen lds
ds_read_b64_tr_b16 v[112:113], v44 offset:28672
ds_read_b64_tr_b16 v[114:115], v44 offset:29696
ds_read_b64_tr_b16 v[116:117], v46 offset:28672
ds_read_b64_tr_b16 v[118:119], v46 offset:29696
ds_read_b64_tr_b16 v[120:121], v45 offset:28672
ds_read_b64_tr_b16 v[122:123], v45 offset:29696
ds_read_b64_tr_b16 v[124:125], v47 offset:28672
ds_read_b64_tr_b16 v[126:127], v47 offset:29696
s_waitcnt lgkmcnt(0)
s_waitcnt vmcnt(24)
s_barrier
s_add_u32 s56, s54, 2359296
s_mov_b32 m0, 126976
s_nop 0
buffer_load_dwordx4 v26, s[12:15], s56 offen lds
s_add_u32 s56, s54, 2375680
s_mov_b32 m0, 128000
s_nop 0
buffer_load_dwordx4 v26, s[12:15], s56 offen lds
s_add_u32 s56, s54, 2392064
s_mov_b32 m0, 129024
s_nop 0
buffer_load_dwordx4 v27, s[12:15], s56 offen lds
s_add_u32 s56, s54, 2408448
s_mov_b32 m0, 130048
s_nop 0
buffer_load_dwordx4 v27, s[12:15], s56 offen lds
ds_read_b64_tr_b16 v[128:129], v44 offset:0
ds_read_b64_tr_b16 v[130:131], v44 offset:1024
ds_read_b64_tr_b16 v[132:133], v46 offset:0
ds_read_b64_tr_b16 v[134:135], v46 offset:1024
ds_read_b64_tr_b16 v[136:137], v45 offset:0
ds_read_b64_tr_b16 v[138:139], v45 offset:1024
ds_read_b64_tr_b16 v[140:141], v47 offset:0
ds_read_b64_tr_b16 v[142:143], v47 offset:1024
s_waitcnt lgkmcnt(0)
s_waitcnt vmcnt(24)
s_barrier
s_add_u32 s56, s54, 3407872
s_mov_b32 m0, 98304
s_nop 0
buffer_load_dwordx4 v26, s[12:15], s56 offen lds
s_add_u32 s56, s54, 3424256
s_mov_b32 m0, 99328
s_nop 0
buffer_load_dwordx4 v26, s[12:15], s56 offen lds
s_add_u32 s56, s54, 3440640
s_mov_b32 m0, 100352
s_nop 0
buffer_load_dwordx4 v27, s[12:15], s56 offen lds
s_add_u32 s56, s54, 3457024
s_mov_b32 m0, 101376
s_nop 0
buffer_load_dwordx4 v27, s[12:15], s56 offen lds
ds_read_b64_tr_b16 v[144:145], v44 offset:4096
ds_read_b64_tr_b16 v[146:147], v44 offset:5120
ds_read_b64_tr_b16 v[148:149], v46 offset:4096
ds_read_b64_tr_b16 v[150:151], v46 offset:5120
ds_read_b64_tr_b16 v[152:153], v45 offset:4096
ds_read_b64_tr_b16 v[154:155], v45 offset:5120
ds_read_b64_tr_b16 v[156:157], v47 offset:4096
ds_read_b64_tr_b16 v[158:159], v47 offset:5120
s_waitcnt lgkmcnt(0)
s_waitcnt vmcnt(24)
s_barrier
s_add_u32 s56, s54, 3932160
s_mov_b32 m0, 102400
s_nop 0
buffer_load_dwordx4 v26, s[12:15], s56 offen lds
s_add_u32 s56, s54, 3948544
s_mov_b32 m0, 103424
s_nop 0
buffer_load_dwordx4 v26, s[12:15], s56 offen lds
s_add_u32 s56, s54, 3964928
s_mov_b32 m0, 104448
s_nop 0
buffer_load_dwordx4 v27, s[12:15], s56 offen lds
s_add_u32 s56, s54, 3981312
s_mov_b32 m0, 105472
s_nop 0
buffer_load_dwordx4 v27, s[12:15], s56 offen lds
ds_read_b64_tr_b16 v[160:161], v44 offset:8192
ds_read_b64_tr_b16 v[162:163], v44 offset:9216
ds_read_b64_tr_b16 v[164:165], v46 offset:8192
ds_read_b64_tr_b16 v[166:167], v46 offset:9216
ds_read_b64_tr_b16 v[168:169], v45 offset:8192
ds_read_b64_tr_b16 v[170:171], v45 offset:9216
ds_read_b64_tr_b16 v[172:173], v47 offset:8192
ds_read_b64_tr_b16 v[174:175], v47 offset:9216
s_waitcnt lgkmcnt(0)
s_waitcnt vmcnt(24)
s_barrier
s_add_u32 s56, s54, 4456448
s_mov_b32 m0, 106496
s_nop 0
buffer_load_dwordx4 v26, s[12:15], s56 offen lds
s_add_u32 s56, s54, 4472832
s_mov_b32 m0, 107520
s_nop 0
buffer_load_dwordx4 v26, s[12:15], s56 offen lds
s_add_u32 s56, s54, 4489216
s_mov_b32 m0, 108544
s_nop 0
buffer_load_dwordx4 v27, s[12:15], s56 offen lds
s_add_u32 s56, s54, 4505600
s_mov_b32 m0, 109568
s_nop 0
buffer_load_dwordx4 v27, s[12:15], s56 offen lds
ds_read_b64_tr_b16 v[176:177], v44 offset:12288
ds_read_b64_tr_b16 v[178:179], v44 offset:13312
ds_read_b64_tr_b16 v[180:181], v46 offset:12288
ds_read_b64_tr_b16 v[182:183], v46 offset:13312
ds_read_b64_tr_b16 v[184:185], v45 offset:12288
ds_read_b64_tr_b16 v[186:187], v45 offset:13312
ds_read_b64_tr_b16 v[188:189], v47 offset:12288
ds_read_b64_tr_b16 v[190:191], v47 offset:13312
s_waitcnt lgkmcnt(0)
s_waitcnt vmcnt(24)
s_barrier
s_add_u32 s56, s54, 262144
s_mov_b32 m0, 110592
s_nop 0
buffer_load_dwordx4 v26, s[16:19], s56 offen lds
s_add_u32 s56, s54, 278528
s_mov_b32 m0, 111616
s_nop 0
buffer_load_dwordx4 v26, s[16:19], s56 offen lds
s_add_u32 s56, s54, 294912
s_mov_b32 m0, 112640
s_nop 0
buffer_load_dwordx4 v27, s[16:19], s56 offen lds
s_add_u32 s56, s54, 311296
s_mov_b32 m0, 113664
s_nop 0
buffer_load_dwordx4 v27, s[16:19], s56 offen lds
ds_read_b64_tr_b16 v[192:193], v44 offset:16384
ds_read_b64_tr_b16 v[194:195], v44 offset:17408
ds_read_b64_tr_b16 v[196:197], v46 offset:16384
ds_read_b64_tr_b16 v[198:199], v46 offset:17408
ds_read_b64_tr_b16 v[200:201], v45 offset:16384
ds_read_b64_tr_b16 v[202:203], v45 offset:17408
ds_read_b64_tr_b16 v[204:205], v47 offset:16384
ds_read_b64_tr_b16 v[206:207], v47 offset:17408
s_waitcnt lgkmcnt(0)
s_waitcnt vmcnt(24)
s_barrier
s_add_u32 s56, s54, 786432
s_mov_b32 m0, 114688
s_nop 0
buffer_load_dwordx4 v26, s[16:19], s56 offen lds
s_add_u32 s56, s54, 802816
s_mov_b32 m0, 115712
s_nop 0
buffer_load_dwordx4 v26, s[16:19], s56 offen lds
s_add_u32 s56, s54, 819200
s_mov_b32 m0, 116736
s_nop 0
buffer_load_dwordx4 v27, s[16:19], s56 offen lds
s_add_u32 s56, s54, 835584
s_mov_b32 m0, 117760
s_nop 0
buffer_load_dwordx4 v27, s[16:19], s56 offen lds
ds_read_b64_tr_b16 v[208:209], v44 offset:20480
ds_read_b64_tr_b16 v[210:211], v44 offset:21504
ds_read_b64_tr_b16 v[212:213], v46 offset:20480
ds_read_b64_tr_b16 v[214:215], v46 offset:21504
ds_read_b64_tr_b16 v[216:217], v45 offset:20480
ds_read_b64_tr_b16 v[218:219], v45 offset:21504
ds_read_b64_tr_b16 v[220:221], v47 offset:20480
ds_read_b64_tr_b16 v[222:223], v47 offset:21504
s_waitcnt lgkmcnt(0)
s_waitcnt vmcnt(24)
s_barrier
s_add_u32 s56, s54, 1310720
s_mov_b32 m0, 118784
s_nop 0
buffer_load_dwordx4 v26, s[16:19], s56 offen lds
s_add_u32 s56, s54, 1327104
s_mov_b32 m0, 119808
s_nop 0
buffer_load_dwordx4 v26, s[16:19], s56 offen lds
s_add_u32 s56, s54, 1343488
s_mov_b32 m0, 120832
s_nop 0
buffer_load_dwordx4 v27, s[16:19], s56 offen lds
s_add_u32 s56, s54, 1359872
s_mov_b32 m0, 121856
s_nop 0
buffer_load_dwordx4 v27, s[16:19], s56 offen lds
ds_read_b64_tr_b16 v[224:225], v44 offset:24576
ds_read_b64_tr_b16 v[226:227], v44 offset:25600
ds_read_b64_tr_b16 v[228:229], v46 offset:24576
ds_read_b64_tr_b16 v[230:231], v46 offset:25600
ds_read_b64_tr_b16 v[232:233], v45 offset:24576
ds_read_b64_tr_b16 v[234:235], v45 offset:25600
ds_read_b64_tr_b16 v[236:237], v47 offset:24576
ds_read_b64_tr_b16 v[238:239], v47 offset:25600
s_waitcnt lgkmcnt(0)
s_waitcnt vmcnt(24)
s_barrier
s_add_u32 s56, s54, 1835008
s_mov_b32 m0, 122880
s_nop 0
buffer_load_dwordx4 v26, s[16:19], s56 offen lds
s_add_u32 s56, s54, 1851392
s_mov_b32 m0, 123904
s_nop 0
buffer_load_dwordx4 v26, s[16:19], s56 offen lds
s_add_u32 s56, s54, 1867776
s_mov_b32 m0, 124928
s_nop 0
buffer_load_dwordx4 v27, s[16:19], s56 offen lds
s_add_u32 s56, s54, 1884160
s_mov_b32 m0, 125952
s_nop 0
buffer_load_dwordx4 v27, s[16:19], s56 offen lds
ds_read_b64_tr_b16 v[240:241], v44 offset:28672
ds_read_b64_tr_b16 v[242:243], v44 offset:29696
ds_read_b64_tr_b16 v[244:245], v46 offset:28672
ds_read_b64_tr_b16 v[246:247], v46 offset:29696
ds_read_b64_tr_b16 v[248:249], v45 offset:28672
ds_read_b64_tr_b16 v[250:251], v45 offset:29696
ds_read_b64_tr_b16 v[252:253], v47 offset:28672
ds_read_b64_tr_b16 v[254:255], v47 offset:29696
s_waitcnt lgkmcnt(0)
s_waitcnt vmcnt(24)
s_barrier
s_add_u32 s56, s54, 2359296
s_mov_b32 m0, 126976
s_nop 0
buffer_load_dwordx4 v26, s[16:19], s56 offen lds
s_add_u32 s56, s54, 2375680
s_mov_b32 m0, 128000
s_nop 0
buffer_load_dwordx4 v26, s[16:19], s56 offen lds
s_add_u32 s56, s54, 2392064
s_mov_b32 m0, 129024
s_nop 0
buffer_load_dwordx4 v27, s[16:19], s56 offen lds
s_add_u32 s56, s54, 2408448
s_mov_b32 m0, 130048
s_nop 0
buffer_load_dwordx4 v27, s[16:19], s56 offen lds
ds_read_b64_tr_b16 a[0:1], v44 offset:0
ds_read_b64_tr_b16 a[2:3], v44 offset:1024
ds_read_b64_tr_b16 a[4:5], v46 offset:0
ds_read_b64_tr_b16 a[6:7], v46 offset:1024
ds_read_b64_tr_b16 a[8:9], v45 offset:0
ds_read_b64_tr_b16 a[10:11], v45 offset:1024
ds_read_b64_tr_b16 a[12:13], v47 offset:0
ds_read_b64_tr_b16 a[14:15], v47 offset:1024
s_waitcnt lgkmcnt(0)
s_waitcnt vmcnt(24)
s_barrier
s_add_u32 s56, s54, 2883584
s_mov_b32 m0, 98304
s_nop 0
buffer_load_dwordx4 v26, s[16:19], s56 offen lds
s_add_u32 s56, s54, 2899968
s_mov_b32 m0, 99328
s_nop 0
buffer_load_dwordx4 v26, s[16:19], s56 offen lds
s_add_u32 s56, s54, 2916352
s_mov_b32 m0, 100352
s_nop 0
buffer_load_dwordx4 v27, s[16:19], s56 offen lds
s_add_u32 s56, s54, 2932736
s_mov_b32 m0, 101376
s_nop 0
buffer_load_dwordx4 v27, s[16:19], s56 offen lds
ds_read_b64_tr_b16 a[16:17], v44 offset:4096
ds_read_b64_tr_b16 a[18:19], v44 offset:5120
ds_read_b64_tr_b16 a[20:21], v46 offset:4096
ds_read_b64_tr_b16 a[22:23], v46 offset:5120
ds_read_b64_tr_b16 a[24:25], v45 offset:4096
ds_read_b64_tr_b16 a[26:27], v45 offset:5120
ds_read_b64_tr_b16 a[28:29], v47 offset:4096
ds_read_b64_tr_b16 a[30:31], v47 offset:5120
s_waitcnt lgkmcnt(0)
s_waitcnt vmcnt(24)
s_barrier
s_add_u32 s56, s54, 3407872
s_mov_b32 m0, 102400
s_nop 0
buffer_load_dwordx4 v26, s[16:19], s56 offen lds
s_add_u32 s56, s54, 3424256
s_mov_b32 m0, 103424
s_nop 0
buffer_load_dwordx4 v26, s[16:19], s56 offen lds
s_add_u32 s56, s54, 3440640
s_mov_b32 m0, 104448
s_nop 0
buffer_load_dwordx4 v27, s[16:19], s56 offen lds
s_add_u32 s56, s54, 3457024
s_mov_b32 m0, 105472
s_nop 0
buffer_load_dwordx4 v27, s[16:19], s56 offen lds
ds_read_b64_tr_b16 a[32:33], v44 offset:8192
ds_read_b64_tr_b16 a[34:35], v44 offset:9216
ds_read_b64_tr_b16 a[36:37], v46 offset:8192
ds_read_b64_tr_b16 a[38:39], v46 offset:9216
ds_read_b64_tr_b16 a[40:41], v45 offset:8192
ds_read_b64_tr_b16 a[42:43], v45 offset:9216
ds_read_b64_tr_b16 a[44:45], v47 offset:8192
ds_read_b64_tr_b16 a[46:47], v47 offset:9216
s_waitcnt lgkmcnt(0)
s_waitcnt vmcnt(24)
s_barrier
s_add_u32 s56, s54, 3932160
s_mov_b32 m0, 106496
s_nop 0
buffer_load_dwordx4 v26, s[16:19], s56 offen lds
s_add_u32 s56, s54, 3948544
s_mov_b32 m0, 107520
s_nop 0
buffer_load_dwordx4 v26, s[16:19], s56 offen lds
s_add_u32 s56, s54, 3964928
s_mov_b32 m0, 108544
s_nop 0
buffer_load_dwordx4 v27, s[16:19], s56 offen lds
s_add_u32 s56, s54, 3981312
s_mov_b32 m0, 109568
s_nop 0
buffer_load_dwordx4 v27, s[16:19], s56 offen lds
ds_read_b64_tr_b16 a[48:49], v44 offset:12288
ds_read_b64_tr_b16 a[50:51], v44 offset:13312
ds_read_b64_tr_b16 a[52:53], v46 offset:12288
ds_read_b64_tr_b16 a[54:55], v46 offset:13312
ds_read_b64_tr_b16 a[56:57], v45 offset:12288
ds_read_b64_tr_b16 a[58:59], v45 offset:13312
ds_read_b64_tr_b16 a[60:61], v47 offset:12288
ds_read_b64_tr_b16 a[62:63], v47 offset:13312
s_waitcnt lgkmcnt(0)
s_waitcnt vmcnt(24)
s_barrier
s_add_u32 s56, s55, 110592
s_mov_b32 m0, 110592
s_nop 0
buffer_load_dwordx4 v28, s[20:23], s56 offen lds
s_add_u32 s56, s55, 112896
s_mov_b32 m0, 111616
s_nop 0
buffer_load_dwordx4 v28, s[20:23], s56 offen lds
s_add_u32 s56, s55, 119808
s_mov_b32 m0, 112640
s_nop 0
buffer_load_dwordx4 v28, s[20:23], s56 offen lds
s_add_u32 s56, s55, 122112
s_mov_b32 m0, 113664
s_nop 0
buffer_load_dwordx4 v28, s[20:23], s56 offen lds
ds_read_b64_tr_b16 a[64:65], v44 offset:16384
ds_read_b64_tr_b16 a[66:67], v44 offset:17408
ds_read_b64_tr_b16 a[68:69], v46 offset:16384
ds_read_b64_tr_b16 a[70:71], v46 offset:17408
ds_read_b64_tr_b16 a[72:73], v45 offset:16384
ds_read_b64_tr_b16 a[74:75], v45 offset:17408
ds_read_b64_tr_b16 a[76:77], v47 offset:16384
ds_read_b64_tr_b16 a[78:79], v47 offset:17408
s_waitcnt lgkmcnt(0)
s_waitcnt vmcnt(24)
s_barrier
s_add_u32 s56, s55, 110848
s_mov_b32 m0, 114688
s_nop 0
buffer_load_dwordx4 v28, s[20:23], s56 offen lds
s_add_u32 s56, s55, 113152
s_mov_b32 m0, 115712
s_nop 0
buffer_load_dwordx4 v28, s[20:23], s56 offen lds
s_add_u32 s56, s55, 120064
s_mov_b32 m0, 116736
s_nop 0
buffer_load_dwordx4 v28, s[20:23], s56 offen lds
s_add_u32 s56, s55, 122368
s_mov_b32 m0, 117760
s_nop 0
buffer_load_dwordx4 v28, s[20:23], s56 offen lds
ds_read_b64_tr_b16 a[80:81], v44 offset:20480
ds_read_b64_tr_b16 a[82:83], v44 offset:21504
ds_read_b64_tr_b16 a[84:85], v46 offset:20480
ds_read_b64_tr_b16 a[86:87], v46 offset:21504
ds_read_b64_tr_b16 a[88:89], v45 offset:20480
ds_read_b64_tr_b16 a[90:91], v45 offset:21504
ds_read_b64_tr_b16 a[92:93], v47 offset:20480
ds_read_b64_tr_b16 a[94:95], v47 offset:21504
s_waitcnt lgkmcnt(0)
s_waitcnt vmcnt(24)
s_barrier
s_add_u32 s56, s55, 111104
s_mov_b32 m0, 118784
s_nop 0
buffer_load_dwordx4 v28, s[20:23], s56 offen lds
s_add_u32 s56, s55, 113408
s_mov_b32 m0, 119808
s_nop 0
buffer_load_dwordx4 v28, s[20:23], s56 offen lds
s_add_u32 s56, s55, 120320
s_mov_b32 m0, 120832
s_nop 0
buffer_load_dwordx4 v28, s[20:23], s56 offen lds
s_add_u32 s56, s55, 122624
s_mov_b32 m0, 121856
s_nop 0
buffer_load_dwordx4 v28, s[20:23], s56 offen lds
ds_read_b64_tr_b16 a[96:97], v44 offset:24576
ds_read_b64_tr_b16 a[98:99], v44 offset:25600
ds_read_b64_tr_b16 a[100:101], v46 offset:24576
ds_read_b64_tr_b16 a[102:103], v46 offset:25600
ds_read_b64_tr_b16 a[104:105], v45 offset:24576
ds_read_b64_tr_b16 a[106:107], v45 offset:25600
ds_read_b64_tr_b16 a[108:109], v47 offset:24576
ds_read_b64_tr_b16 a[110:111], v47 offset:25600
s_waitcnt lgkmcnt(0)
s_waitcnt vmcnt(24)
s_barrier
s_add_u32 s56, s55, 111360
s_mov_b32 m0, 122880
s_nop 0
buffer_load_dwordx4 v28, s[20:23], s56 offen lds
s_add_u32 s56, s55, 113664
s_mov_b32 m0, 123904
s_nop 0
buffer_load_dwordx4 v28, s[20:23], s56 offen lds
s_add_u32 s56, s55, 120576
s_mov_b32 m0, 124928
s_nop 0
buffer_load_dwordx4 v28, s[20:23], s56 offen lds
s_add_u32 s56, s55, 122880
s_mov_b32 m0, 125952
s_nop 0
buffer_load_dwordx4 v28, s[20:23], s56 offen lds
ds_read_b64_tr_b16 a[112:113], v44 offset:28672
ds_read_b64_tr_b16 a[114:115], v44 offset:29696
ds_read_b64_tr_b16 a[116:117], v46 offset:28672
ds_read_b64_tr_b16 a[118:119], v46 offset:29696
ds_read_b64_tr_b16 a[120:121], v45 offset:28672
ds_read_b64_tr_b16 a[122:123], v45 offset:29696
ds_read_b64_tr_b16 a[124:125], v47 offset:28672
ds_read_b64_tr_b16 a[126:127], v47 offset:29696
s_waitcnt lgkmcnt(0)
s_waitcnt vmcnt(24)
s_barrier
s_add_u32 s56, s55, 74496
s_mov_b32 m0, 126976
s_nop 0
buffer_load_dwordx4 v28, s[20:23], s56 offen lds
s_add_u32 s56, s55, 76800
s_mov_b32 m0, 128000
s_nop 0
buffer_load_dwordx4 v28, s[20:23], s56 offen lds
s_add_u32 s56, s55, 83712
s_mov_b32 m0, 129024
s_nop 0
buffer_load_dwordx4 v28, s[20:23], s56 offen lds
s_add_u32 s56, s55, 86016
s_mov_b32 m0, 130048
s_nop 0
buffer_load_dwordx4 v28, s[20:23], s56 offen lds
ds_read_b64_tr_b16 a[128:129], v44 offset:0
ds_read_b64_tr_b16 a[130:131], v44 offset:1024
ds_read_b64_tr_b16 a[132:133], v46 offset:0
ds_read_b64_tr_b16 a[134:135], v46 offset:1024
ds_read_b64_tr_b16 a[136:137], v45 offset:0
ds_read_b64_tr_b16 a[138:139], v45 offset:1024
ds_read_b64_tr_b16 a[140:141], v47 offset:0
ds_read_b64_tr_b16 a[142:143], v47 offset:1024
buffer_load_dword v32, v24, s[28:31], 0 offen sc0 sc1
s_waitcnt lgkmcnt(0)
s_waitcnt vmcnt(25)
s_barrier
s_add_u32 s56, s54, 262144
s_mov_b32 m0, 98304
s_nop 0
buffer_load_dwordx4 v26, s[8:11], s56 offen lds
s_add_u32 s56, s54, 278528
s_mov_b32 m0, 99328
s_nop 0
buffer_load_dwordx4 v26, s[8:11], s56 offen lds
s_add_u32 s56, s54, 294912
s_mov_b32 m0, 100352
s_nop 0
buffer_load_dwordx4 v27, s[8:11], s56 offen lds
s_add_u32 s56, s54, 311296
s_mov_b32 m0, 101376
s_nop 0
buffer_load_dwordx4 v27, s[8:11], s56 offen lds
ds_read_b64_tr_b16 a[144:145], v44 offset:4096
ds_read_b64_tr_b16 a[146:147], v44 offset:5120
ds_read_b64_tr_b16 a[148:149], v46 offset:4096
ds_read_b64_tr_b16 a[150:151], v46 offset:5120
ds_read_b64_tr_b16 a[152:153], v45 offset:4096
ds_read_b64_tr_b16 a[154:155], v45 offset:5120
ds_read_b64_tr_b16 a[156:157], v47 offset:4096
ds_read_b64_tr_b16 a[158:159], v47 offset:5120
s_waitcnt lgkmcnt(0)
s_waitcnt vmcnt(25)
s_barrier
s_add_u32 s56, s54, 1835008
s_mov_b32 m0, 102400
s_nop 0
buffer_load_dwordx4 v26, s[8:11], s56 offen lds
s_add_u32 s56, s54, 1851392
s_mov_b32 m0, 103424
s_nop 0
buffer_load_dwordx4 v26, s[8:11], s56 offen lds
s_add_u32 s56, s54, 1867776
s_mov_b32 m0, 104448
s_nop 0
buffer_load_dwordx4 v27, s[8:11], s56 offen lds
s_add_u32 s56, s54, 1884160
s_mov_b32 m0, 105472
s_nop 0
buffer_load_dwordx4 v27, s[8:11], s56 offen lds
ds_read_b64_tr_b16 a[160:161], v44 offset:8192
ds_read_b64_tr_b16 a[162:163], v44 offset:9216
ds_read_b64_tr_b16 a[164:165], v46 offset:8192
ds_read_b64_tr_b16 a[166:167], v46 offset:9216
ds_read_b64_tr_b16 a[168:169], v45 offset:8192
ds_read_b64_tr_b16 a[170:171], v45 offset:9216
ds_read_b64_tr_b16 a[172:173], v47 offset:8192
ds_read_b64_tr_b16 a[174:175], v47 offset:9216
s_waitcnt lgkmcnt(0)
s_waitcnt vmcnt(25)
s_barrier
s_add_u32 s56, s54, 2359296
s_mov_b32 m0, 106496
s_nop 0
buffer_load_dwordx4 v26, s[8:11], s56 offen lds
s_add_u32 s56, s54, 2375680
s_mov_b32 m0, 107520
s_nop 0
buffer_load_dwordx4 v26, s[8:11], s56 offen lds
s_add_u32 s56, s54, 2392064
s_mov_b32 m0, 108544
s_nop 0
buffer_load_dwordx4 v27, s[8:11], s56 offen lds
s_add_u32 s56, s54, 2408448
s_mov_b32 m0, 109568
s_nop 0
buffer_load_dwordx4 v27, s[8:11], s56 offen lds
ds_read_b64_tr_b16 a[184:185], v48 offset:12288
ds_read_b64_tr_b16 a[186:187], v48 offset:13312
ds_read_b64_tr_b16 a[188:189], v48 offset:14336
ds_read_b64_tr_b16 a[190:191], v48 offset:15360
ds_read_b64_tr_b16 a[176:177], v49 offset:12288
ds_read_b64_tr_b16 a[178:179], v49 offset:13312
ds_read_b64_tr_b16 a[180:181], v49 offset:14336
ds_read_b64_tr_b16 a[182:183], v49 offset:15360
s_waitcnt lgkmcnt(0)
s_waitcnt vmcnt(25)
s_barrier
s_add_u32 s56, s54, 2883584
s_mov_b32 m0, 110592
s_nop 0
buffer_load_dwordx4 v26, s[12:15], s56 offen lds
s_add_u32 s56, s54, 2899968
s_mov_b32 m0, 111616
s_nop 0
buffer_load_dwordx4 v26, s[12:15], s56 offen lds
s_add_u32 s56, s54, 2916352
s_mov_b32 m0, 112640
s_nop 0
buffer_load_dwordx4 v27, s[12:15], s56 offen lds
s_add_u32 s56, s54, 2932736
s_mov_b32 m0, 113664
s_nop 0
buffer_load_dwordx4 v27, s[12:15], s56 offen lds
ds_read_b64_tr_b16 a[200:201], v48 offset:16384
ds_read_b64_tr_b16 a[202:203], v48 offset:17408
ds_read_b64_tr_b16 a[204:205], v48 offset:18432
ds_read_b64_tr_b16 a[206:207], v48 offset:19456
ds_read_b64_tr_b16 a[192:193], v49 offset:16384
ds_read_b64_tr_b16 a[194:195], v49 offset:17408
ds_read_b64_tr_b16 a[196:197], v49 offset:18432
ds_read_b64_tr_b16 a[198:199], v49 offset:19456
s_waitcnt lgkmcnt(0)
s_waitcnt vmcnt(25)
s_barrier
s_add_u32 s56, s54, 4456448
s_mov_b32 m0, 114688
s_nop 0
buffer_load_dwordx4 v26, s[16:19], s56 offen lds
s_add_u32 s56, s54, 4472832
s_mov_b32 m0, 115712
s_nop 0
buffer_load_dwordx4 v26, s[16:19], s56 offen lds
s_add_u32 s56, s54, 4489216
s_mov_b32 m0, 116736
s_nop 0
buffer_load_dwordx4 v27, s[16:19], s56 offen lds
s_add_u32 s56, s54, 4505600
s_mov_b32 m0, 117760
s_nop 0
buffer_load_dwordx4 v27, s[16:19], s56 offen lds
ds_read_b64_tr_b16 a[216:217], v48 offset:20480
ds_read_b64_tr_b16 a[218:219], v48 offset:21504
ds_read_b64_tr_b16 a[220:221], v48 offset:22528
ds_read_b64_tr_b16 a[222:223], v48 offset:23552
ds_read_b64_tr_b16 a[208:209], v49 offset:20480
ds_read_b64_tr_b16 a[210:211], v49 offset:21504
ds_read_b64_tr_b16 a[212:213], v49 offset:22528
ds_read_b64_tr_b16 a[214:215], v49 offset:23552
s_waitcnt lgkmcnt(0)
s_waitcnt vmcnt(25)
s_barrier
s_add_u32 s56, s55, 73728
s_mov_b32 m0, 118784
s_nop 0
buffer_load_dwordx4 v28, s[20:23], s56 offen lds
s_add_u32 s56, s55, 76032
s_mov_b32 m0, 119808
s_nop 0
buffer_load_dwordx4 v28, s[20:23], s56 offen lds
s_add_u32 s56, s55, 82944
s_mov_b32 m0, 120832
s_nop 0
buffer_load_dwordx4 v28, s[20:23], s56 offen lds
s_add_u32 s56, s55, 85248
s_mov_b32 m0, 121856
s_nop 0
buffer_load_dwordx4 v28, s[20:23], s56 offen lds
ds_read_b64_tr_b16 a[248:249], v48 offset:24576
ds_read_b64_tr_b16 a[250:251], v48 offset:25600
ds_read_b64_tr_b16 a[252:253], v48 offset:26624
ds_read_b64_tr_b16 a[254:255], v48 offset:27648
ds_read_b64_tr_b16 a[232:233], v49 offset:24576
ds_read_b64_tr_b16 a[234:235], v49 offset:25600
ds_read_b64_tr_b16 a[236:237], v49 offset:26624
ds_read_b64_tr_b16 a[238:239], v49 offset:27648
s_waitcnt lgkmcnt(0)
s_waitcnt vmcnt(25)
s_barrier
s_add_u32 s56, s55, 73984
s_mov_b32 m0, 122880
s_nop 0
buffer_load_dwordx4 v28, s[20:23], s56 offen lds
s_add_u32 s56, s55, 76288
s_mov_b32 m0, 123904
s_nop 0
buffer_load_dwordx4 v28, s[20:23], s56 offen lds
s_add_u32 s56, s55, 83200
s_mov_b32 m0, 124928
s_nop 0
buffer_load_dwordx4 v28, s[20:23], s56 offen lds
s_add_u32 s56, s55, 85504
s_mov_b32 m0, 125952
s_nop 0
buffer_load_dwordx4 v28, s[20:23], s56 offen lds
ds_read_b64_tr_b16 a[240:241], v48 offset:28672
ds_read_b64_tr_b16 a[242:243], v48 offset:29696
ds_read_b64_tr_b16 a[244:245], v48 offset:30720
ds_read_b64_tr_b16 a[246:247], v48 offset:31744
ds_read_b64_tr_b16 a[224:225], v49 offset:28672
ds_read_b64_tr_b16 a[226:227], v49 offset:29696
ds_read_b64_tr_b16 a[228:229], v49 offset:30720
ds_read_b64_tr_b16 a[230:231], v49 offset:31744
s_waitcnt lgkmcnt(0)
s_waitcnt vmcnt(24)
s_barrier
s_add_u32 s56, s55, 74240
s_mov_b32 m0, 126976
s_nop 0
buffer_load_dwordx4 v28, s[20:23], s56 offen lds
s_add_u32 s56, s55, 76544
s_mov_b32 m0, 128000
s_nop 0
buffer_load_dwordx4 v28, s[20:23], s56 offen lds
s_add_u32 s56, s55, 83456
s_mov_b32 m0, 129024
s_nop 0
buffer_load_dwordx4 v28, s[20:23], s56 offen lds
s_add_u32 s56, s55, 85760
s_mov_b32 m0, 130048
s_nop 0
buffer_load_dwordx4 v28, s[20:23], s56 offen lds
ds_read_b64_tr_b16 v[60:61], v44 offset:0
ds_read_b64_tr_b16 v[62:63], v44 offset:1024
ds_read_b64_tr_b16 v[64:65], v46 offset:0
ds_read_b64_tr_b16 v[66:67], v46 offset:1024
ds_read_b64_tr_b16 v[68:69], v45 offset:0
ds_read_b64_tr_b16 v[70:71], v45 offset:1024
ds_read_b64_tr_b16 v[72:73], v47 offset:0
ds_read_b64_tr_b16 v[74:75], v47 offset:1024
s_waitcnt lgkmcnt(0)
s_waitcnt vmcnt(24)
s_barrier
ds_write_b128 v2, v[60:63] offset:0
ds_write_b128 v2, v[64:67] offset:1024
ds_write_b128 v2, v[68:71] offset:2048
ds_write_b128 v2, v[72:75] offset:3072
ds_read_b64_tr_b16 v[60:61], v44 offset:4096
ds_read_b64_tr_b16 v[62:63], v44 offset:5120
ds_read_b64_tr_b16 v[64:65], v46 offset:4096
ds_read_b64_tr_b16 v[66:67], v46 offset:5120
ds_read_b64_tr_b16 v[68:69], v45 offset:4096
ds_read_b64_tr_b16 v[70:71], v45 offset:5120
ds_read_b64_tr_b16 v[72:73], v47 offset:4096
ds_read_b64_tr_b16 v[74:75], v47 offset:5120
L_rdv_w2r:
v_readfirstlane_b32 s38, v32
s_nop 0
s_and_b32 s57, s38, 0xff
s_cmp_lg_u32 s57, 32
s_cbranch_scc1 L_rdv2_w2r
s_waitcnt lgkmcnt(0)
s_waitcnt vmcnt(20)
s_barrier
ds_write_b128 v2, v[60:63] offset:4096
ds_write_b128 v2, v[64:67] offset:5120
ds_write_b128 v2, v[68:71] offset:6144
ds_write_b128 v2, v[72:75] offset:7168
ds_read_b64_tr_b16 v[60:61], v44 offset:8192
ds_read_b64_tr_b16 v[62:63], v44 offset:9216
ds_read_b64_tr_b16 v[64:65], v46 offset:8192
ds_read_b64_tr_b16 v[66:67], v46 offset:9216
ds_read_b64_tr_b16 v[68:69], v45 offset:8192
ds_read_b64_tr_b16 v[70:71], v45 offset:9216
ds_read_b64_tr_b16 v[72:73], v47 offset:8192
ds_read_b64_tr_b16 v[74:75], v47 offset:9216
buffer_load_dwordx4 v[12:15], v9, s[4:7], s37 offen offset:0
buffer_load_dwordx4 v[16:19], v9, s[4:7], s37 offen offset:1024
buffer_load_dwordx4 v[52:55], v1, s[4:7], s37 offen offset:2048
buffer_load_dwordx4 v[56:59], v1, s[4:7], s37 offen offset:3072
s_mov_b32 m0, 1024
s_nop 0
buffer_load_dwordx4 v1, s[4:7], s47 offen offset:2048 sc0 sc1 lds
s_waitcnt lgkmcnt(0)
s_waitcnt vmcnt(21)
s_barrier
ds_write_b128 v2, v[60:63] offset:8192
ds_write_b128 v2, v[64:67] offset:9216
ds_write_b128 v2, v[68:71] offset:10240
ds_write_b128 v2, v[72:75] offset:11264
ds_read_b64_tr_b16 v[60:61], v44 offset:12288
ds_read_b64_tr_b16 v[62:63], v44 offset:13312
ds_read_b64_tr_b16 v[64:65], v46 offset:12288
ds_read_b64_tr_b16 v[66:67], v46 offset:13312
ds_read_b64_tr_b16 v[68:69], v45 offset:12288
ds_read_b64_tr_b16 v[70:71], v45 offset:13312
ds_read_b64_tr_b16 v[72:73], v47 offset:12288
ds_read_b64_tr_b16 v[74:75], v47 offset:13312
s_waitcnt lgkmcnt(0)
s_waitcnt vmcnt(17)
s_barrier
ds_write_b128 v2, v[60:63] offset:12288
ds_write_b128 v2, v[64:67] offset:13312
ds_write_b128 v2, v[68:71] offset:14336
ds_write_b128 v2, v[72:75] offset:15360
ds_read_b64_tr_b16 v[60:61], v44 offset:16384
ds_read_b64_tr_b16 v[62:63], v44 offset:17408
ds_read_b64_tr_b16 v[64:65], v46 offset:16384
ds_read_b64_tr_b16 v[66:67], v46 offset:17408
ds_read_b64_tr_b16 v[68:69], v45 offset:16384
ds_read_b64_tr_b16 v[70:71], v45 offset:17408
ds_read_b64_tr_b16 v[72:73], v47 offset:16384
ds_read_b64_tr_b16 v[74:75], v47 offset:17408
s_waitcnt lgkmcnt(0)
s_waitcnt vmcnt(13)
s_barrier
ds_write_b128 v2, v[60:63] offset:16384
ds_write_b128 v2, v[64:67] offset:17408
ds_write_b128 v2, v[68:71] offset:18432
ds_write_b128 v2, v[72:75] offset:19456
ds_read_b64_tr_b16 v[60:61], v48 offset:20480
ds_read_b64_tr_b16 v[62:63], v48 offset:21504
ds_read_b64_tr_b16 v[64:65], v48 offset:22528
ds_read_b64_tr_b16 v[66:67], v48 offset:23552
ds_read_b64_tr_b16 v[68:69], v49 offset:20480
ds_read_b64_tr_b16 v[70:71], v49 offset:21504
ds_read_b64_tr_b16 v[72:73], v49 offset:22528
ds_read_b64_tr_b16 v[74:75], v49 offset:23552
s_waitcnt lgkmcnt(0)
s_waitcnt vmcnt(9)
s_barrier
ds_write_b128 v2, v[60:63] offset:20480
ds_write_b128 v2, v[64:67] offset:21504
ds_write_b128 v2, v[68:71] offset:22528
ds_write_b128 v2, v[72:75] offset:23552
ds_read_b64_tr_b16 v[60:61], v48 offset:24576
ds_read_b64_tr_b16 v[62:63], v48 offset:25600
ds_read_b64_tr_b16 v[64:65], v48 offset:26624
ds_read_b64_tr_b16 v[66:67], v48 offset:27648
ds_read_b64_tr_b16 v[68:69], v49 offset:24576
ds_read_b64_tr_b16 v[70:71], v49 offset:25600
ds_read_b64_tr_b16 v[72:73], v49 offset:26624
ds_read_b64_tr_b16 v[74:75], v49 offset:27648
s_waitcnt lgkmcnt(0)
s_waitcnt vmcnt(5)
s_barrier
ds_write_b128 v2, v[60:63] offset:24576
ds_write_b128 v2, v[64:67] offset:25600
ds_write_b128 v2, v[68:71] offset:26624
ds_write_b128 v2, v[72:75] offset:27648
ds_read_b64_tr_b16 v[60:61], v48 offset:28672
ds_read_b64_tr_b16 v[62:63], v48 offset:29696
ds_read_b64_tr_b16 v[64:65], v48 offset:30720
ds_read_b64_tr_b16 v[66:67], v48 offset:31744
ds_read_b64_tr_b16 v[68:69], v49 offset:28672
ds_read_b64_tr_b16 v[70:71], v49 offset:29696
ds_read_b64_tr_b16 v[72:73], v49 offset:30720
ds_read_b64_tr_b16 v[74:75], v49 offset:31744
s_waitcnt lgkmcnt(0)
s_barrier
ds_write_b128 v2, v[60:63] offset:28672
ds_write_b128 v2, v[64:67] offset:29696
ds_write_b128 v2, v[68:71] offset:30720
ds_write_b128 v2, v[72:75] offset:31744
s_lshl_b32 s57, s58, 5
s_mov_b32 s0, 0x3f003f00
s_mov_b32 s1, 0x3f003f00
s_mov_b32 s58, 304128
s_cmp_eq_u32 s38, s57
s_cbranch_scc0 L_slow_w2r
v_mov_b64 v[20:21], 0
v_mov_b64 v[22:23], 0
v_mov_b64 v[24:25], 0
v_mov_b64 v[26:27], 0
v_mov_b64 v[28:29], 0
v_mov_b64 v[30:31], 0
v_mov_b64 v[32:33], 0
v_mov_b64 v[34:35], 0
v_mov_b64 v[36:37], 0
v_mov_b64 v[38:39], 0
v_mov_b64 v[40:41], 0
v_mov_b64 v[42:43], 0
ds_read_b128 v[44:47], v2 offset:0
ds_read_b128 v[48:51], v2 offset:1024
v_bfe_u32 v77, v1, 6, 1
v_lshl_add_u32 v77, v77, 3, v1
v_lshlrev_b32 v77, 1, v77
v_lshlrev_b32 v78, 2, v1
s_waitcnt vmcnt(0) lgkmcnt(0)
s_branch L_top_w2rf
.p2align 6
L_ex_w2rf:
v_and_b32 v6, 0x70, v1
ds_read_b128 v[76:79], v6 offset:256
v_bfe_u32 v11, v1, 4, 2
v_lshrrev_b32_e64 v11, v11, 1
s_add_u32 s34, s34, 1
s_add_u32 s37, s37, 524288
s_add_u32 s39, s39, 524288
s_mul_i32 s40, s34, 10240
s_add_u32 s40, s40, 8093696
s_not_b32 s35, s35
s_not_b32 s36, s36
ds_read_b128 v[44:47], v2 offset:0
ds_read_b128 v[48:51], v2 offset:1024
v_bfe_u32 v6, v1, 2, 7
v_mov_b32 v12, s36
v_mov_b32 v13, s35
s_mov_b32 m0, 1024
s_waitcnt vmcnt(2)
buffer_load_dwordx4 v[60:63], v9, s[4:7], s3 offen offset:0 sc1
buffer_load_dwordx4 v[64:67], v9, s[4:7], s3 offen offset:1024 sc1
buffer_load_dwordx4 v[68:71], v9, s[4:7], s3 offen offset:2048 sc1
buffer_load_dwordx4 v[72:75], v9, s[4:7], s3 offen offset:3072 sc1
s_barrier
s_waitcnt lgkmcnt(2)
s_waitcnt vmcnt(3)
L_r_w2rf:
v_mfma_f32_16x16x32_bf16 v[52:55], v[60:63], v[76:79], 0
s_waitcnt vmcnt(2)
v_mfma_f32_16x16x32_bf16 v[52:55], v[64:67], v[76:79], v[52:55]
v_bitop3_b32 v56, v60, v64, s36 bitop3:0x7e
s_waitcnt vmcnt(1)
v_mfma_f32_16x16x32_bf16 v[52:55], v[68:71], v[76:79], v[52:55]
s_waitcnt vmcnt(0)
v_mfma_f32_16x16x32_bf16 v[52:55], v[72:75], v[76:79], v[52:55]
v_bitop3_b32 v57, v68, v72, s36 bitop3:0x7e
v_bitop3_b32 v56, v56, v57, 1 bitop3:0xa8
v_cmp_ne_u32 vcc, 0, v56
s_cmp_eq_u32 s34, 63
s_nop 3
v_pk_add_f32 v[52:53], v[52:53], v[54:55]
v_cvt_pk_bf16_f32 v56, v52, v53
v_bfi_b32 v56, v11, s35, v56
s_cbranch_vccnz L_rr_w2rf
buffer_store_dword v56, v10, s[4:7], 0 offen
v_mov_b32 v11, v56
s_cbranch_scc1 L_done_w2rf
s_mov_b64 exec, 1
buffer_store_dword v13, v1, s[4:7], s33 offen
s_mov_b64 exec, -1
v_mov_b64 v[20:21], 0
v_mov_b64 v[22:23], 0
v_mov_b64 v[24:25], 0
v_mov_b64 v[26:27], 0
v_mov_b64 v[28:29], 0
v_mov_b64 v[30:31], 0
v_mov_b64 v[32:33], 0
v_mov_b64 v[34:35], 0
v_mov_b64 v[36:37], 0
v_mov_b64 v[38:39], 0
v_mov_b64 v[40:41], 0
v_mov_b64 v[42:43], 0
v_bfe_u32 v77, v1, 6, 1
v_lshl_add_u32 v77, v77, 3, v1
v_lshlrev_b32 v77, 1, v77
v_lshlrev_b32 v78, 2, v1
L_sp_w2rf:
buffer_load_dword v12, v6, s[4:7], s58 offen sc1
s_sub_u32 s41, s41, 1
s_cbranch_scc1 L_exit
buffer_load_dwordx4 v1, s[4:7], s47 offen offset:0 sc1 lds
buffer_load_dwordx4 v1, s[4:7], s47 offen offset:1024 sc1 lds
buffer_load_dwordx4 v1, s[4:7], s47 offen offset:2048 sc1 lds
buffer_load_dwordx4 v1, s[4:7], s47 offen offset:3072 sc1 lds
s_waitcnt vmcnt(9)
v_cmp_ne_u32 vcc, s35, v12
s_cbranch_vccnz L_sp_w2rf
L_top_w2rf:
s_waitcnt vmcnt(7)
s_barrier
ds_read_b128 v[60:63], v1 offset:1024
ds_read_b128 v[64:67], v1 offset:2048
s_mov_b32 m0, 5120
s_nop 0
buffer_load_dwordx4 v1, s[4:7], s48 offen offset:2048 sc1 lds
s_waitcnt vmcnt(6)
s_barrier
ds_read_b128 v[68:71], v1 offset:3072
ds_read_b128 v[72:75], v1 offset:4096
L_s0_w2rf:
s_waitcnt lgkmcnt(3)
v_smfmac_f32_16x16x64_bf16 v[28:31], v[60:63], v[176:183], v0
v_smfmac_f32_16x16x64_bf16 v[32:35], v[60:63], v[184:191], v0
v_smfmac_f32_16x16x64_bf16 v[36:39], v[60:63], a[48:55], v0
v_smfmac_f32_16x16x64_bf16 v[40:43], v[60:63], a[56:63], v0
s_waitcnt lgkmcnt(2)
v_smfmac_f32_16x16x64_bf16 v[20:23], v[64:67], v[80:87], v0
v_smfmac_f32_16x16x64_bf16 v[20:23], v[60:63], v[44:51], v0
ds_read_b128 v[44:47], v2 offset:2048
v_smfmac_f32_16x16x64_bf16 v[24:27], v[64:67], v[88:95], v0
ds_read_b128 v[48:51], v2 offset:3072
v_smfmac_f32_16x16x64_bf16 v[28:31], v[64:67], v[192:199], v0
s_waitcnt lgkmcnt(2)
v_bitop3_b32 v6, v60, v64, s35 bitop3:0x7e
v_smfmac_f32_16x16x64_bf16 v[32:35], v[64:67], v[200:207], v0
v_bitop3_b32 v76, v68, v72, s35 bitop3:0x7e
buffer_load_dwordx4 v[12:15], v9, s[4:7], s37 offen offset:0
buffer_load_dwordx4 v[16:19], v9, s[4:7], s37 offen offset:1024
buffer_load_dwordx4 v[52:55], v1, s[4:7], s37 offen offset:2048
buffer_load_dwordx4 v[56:59], v1, s[4:7], s37 offen offset:3072
v_smfmac_f32_16x16x64_bf16 v[36:39], v[64:67], a[64:71], v0
v_bitop3_b32 v6, v6, v76, 1 bitop3:0xa8
s_waitcnt lgkmcnt(0)
v_smfmac_f32_16x16x64_bf16 v[24:27], v[60:63], v[44:51], v0
ds_read_b128 v[44:47], v2 offset:4096
v_cmp_ne_u32 vcc, 0, v6
v_smfmac_f32_16x16x64_bf16 v[40:43], v[64:67], a[72:79], v0
ds_read_b128 v[48:51], v2 offset:5120
v_smfmac_f32_16x16x64_bf16 v[20:23], v[68:71], v[96:103], v0
s_cbranch_vccnz L_ra0_w2rf
v_smfmac_f32_16x16x64_bf16 v[24:27], v[68:71], v[104:111], v0
s_waitcnt vmcnt(4)
s_barrier
ds_read_b32 v6, v77 offset:8192
v_smfmac_f32_16x16x64_bf16 v[28:31], v[68:71], v[208:215], v0
ds_read_b128 v[60:63], v1 offset:6144
s_waitcnt lgkmcnt(2)
v_smfmac_f32_16x16x64_bf16 v[20:23], v[72:75], v[44:51], v0
ds_read_b128 v[64:67], v1 offset:7168
v_smfmac_f32_16x16x64_bf16 v[32:35], v[68:71], v[216:223], v0
ds_read_b128 v[76:79], v1 offset:5120
v_smfmac_f32_16x16x64_bf16 v[36:39], v[68:71], a[80:87], v0
ds_read_b128 v[44:47], v2 offset:6144
v_smfmac_f32_16x16x64_bf16 v[40:43], v[68:71], a[88:95], v0
ds_read_b128 v[48:51], v2 offset:7168
s_waitcnt lgkmcnt(4)
v_bitop3_b32 v6, v6, v60, s35 bitop3:0x7e
v_smfmac_f32_16x16x64_bf16 v[28:31], v[72:75], v[224:231], v0
ds_read_b128 v[68:71], v1 offset:8192
s_waitcnt lgkmcnt(4)
v_bitop3_b32 v6, v6, v64, s35 bitop3:0xf6
v_smfmac_f32_16x16x64_bf16 v[32:35], v[72:75], v[232:239], v0
s_waitcnt lgkmcnt(3)
v_bitop3_b32 v6, v6, v76, s35 bitop3:0xf6
v_and_b32 v6, 1, v6
v_smfmac_f32_16x16x64_bf16 v[36:39], v[72:75], a[96:103], v0
v_cmp_ne_u32 vcc, 0, v6
s_waitcnt lgkmcnt(1)
v_smfmac_f32_16x16x64_bf16 v[24:27], v[72:75], v[44:51], v0
ds_read_b128 v[44:47], v2 offset:8192
v_lshlrev_b32 v6, 2, v1
v_smfmac_f32_16x16x64_bf16 v[40:43], v[72:75], a[104:111], v0
ds_read_b128 v[72:75], v1 offset:9216
s_cbranch_vccnz L_ra1_w2rf
L_a1_w2rf:
buffer_store_dword v11, v10, s[4:7], s40 offen sc0 sc1
s_mov_b32 m0, 0
s_nop 0
buffer_load_dword v6, s[4:7], s39 offen lds
v_smfmac_f32_16x16x64_bf16 v[20:23], v[60:63], v[112:119], v0
ds_read_b128 v[48:51], v2 offset:9216
v_smfmac_f32_16x16x64_bf16 v[20:23], v[64:67], v[128:135], v0
s_waitcnt lgkmcnt(3)
v_smfmac_f32_16x16x64_bf16 v[20:23], v[68:71], v[144:151], v0
s_waitcnt lgkmcnt(1)
v_smfmac_f32_16x16x64_bf16 v[20:23], v[72:75], v[160:167], v0
s_waitcnt lgkmcnt(0)
v_smfmac_f32_16x16x64_bf16 v[20:23], v[76:79], v[44:51], v0
ds_read_b128 v[44:47], v2 offset:10240
v_smfmac_f32_16x16x64_bf16 v[24:27], v[60:63], v[120:127], v0
ds_read_b128 v[48:51], v2 offset:11264
v_smfmac_f32_16x16x64_bf16 v[24:27], v[64:67], v[136:143], v0
v_add_f32 v20, v20, v22
v_smfmac_f32_16x16x64_bf16 v[24:27], v[68:71], v[152:159], v0
v_add_f32 v21, v21, v23
v_smfmac_f32_16x16x64_bf16 v[24:27], v[72:75], v[168:175], v0
v_cvt_pk_bf16_f32 v22, v20, v21
s_waitcnt lgkmcnt(0)
v_smfmac_f32_16x16x64_bf16 v[24:27], v[76:79], v[44:51], v0
ds_read_b128 v[44:47], v2 offset:12288
v_smfmac_f32_16x16x64_bf16 v[28:31], v[76:79], v[240:247], v0
ds_read_b128 v[48:51], v2 offset:13312
v_smfmac_f32_16x16x64_bf16 v[28:31], v[64:67], a[0:7], v0
v_add_f32 v24, v24, v26
v_add_f32 v25, v25, v27
v_cvt_pk_bf16_f32 v23, v24, v25
v_smfmac_f32_16x16x64_bf16 v[28:31], v[68:71], a[16:23], v0
ds_write_b64 v3, v[22:23] offset:11264
v_smfmac_f32_16x16x64_bf16 v[28:31], v[72:75], a[32:39], v0
s_waitcnt lgkmcnt(1)
v_smfmac_f32_16x16x64_bf16 v[28:31], v[60:63], v[44:51], v0
ds_read_b128 v[44:47], v2 offset:14336
v_smfmac_f32_16x16x64_bf16 v[32:35], v[76:79], v[248:255], v0
ds_read_b128 v[48:51], v2 offset:15360
s_waitcnt lgkmcnt(2)
s_barrier
v_smfmac_f32_16x16x64_bf16 v[32:35], v[64:67], a[8:15], v0
ds_read_b64_tr_b16 v[20:21], v4 offset:10240
ds_read_b64_tr_b16 v[22:23], v4 offset:10752
v_add_f32 v28, v28, v30
v_smfmac_f32_16x16x64_bf16 v[32:35], v[68:71], a[24:31], v0
ds_read_b64_tr_b16 v[24:25], v4 offset:11264
v_add_f32 v29, v29, v31
v_smfmac_f32_16x16x64_bf16 v[32:35], v[72:75], a[40:47], v0
ds_read_b64_tr_b16 v[26:27], v4 offset:11776
v_cvt_pk_bf16_f32 v30, v28, v29
s_waitcnt lgkmcnt(4)
v_smfmac_f32_16x16x64_bf16 v[32:35], v[60:63], v[44:51], v0
ds_read_b128 v[44:47], v2 offset:18432
s_waitcnt vmcnt(4)
s_waitcnt lgkmcnt(3)
v_mfma_f32_16x16x32_bf16 v[12:15], v[12:15], v[20:23], 0
ds_read_b128 v[48:51], v2 offset:19456
s_waitcnt lgkmcnt(2)
v_mfma_f32_16x16x32_bf16 v[12:15], v[16:19], v[24:27], v[12:15]
v_add_f32 v32, v32, v34
v_add_f32 v33, v33, v35
v_cvt_pk_bf16_f32 v31, v32, v33
ds_write_b64 v3, v[30:31] offset:13312
v_smfmac_f32_16x16x64_bf16 v[36:39], v[76:79], a[112:119], v0
s_nop 2
v_add_f32_dpp v12, v14, v12 quad_perm:[2,3,0,1] row_mask:0xf bank_mask:0xf
v_add_f32_dpp v13, v15, v13 quad_perm:[2,3,0,1] row_mask:0xf bank_mask:0xf
ds_write_b64 v5, v[12:13] offset:14848
v_smfmac_f32_16x16x64_bf16 v[40:43], v[76:79], a[120:127], v0
s_waitcnt lgkmcnt(1)
s_barrier
ds_read_b64_tr_b16 v[28:29], v4 offset:12288
v_smfmac_f32_16x16x64_bf16 v[36:39], v[60:63], a[128:135], v0
ds_read_b64_tr_b16 v[30:31], v4 offset:12800
ds_read_b64_tr_b16 v[32:33], v4 offset:13312
v_smfmac_f32_16x16x64_bf16 v[40:43], v[60:63], a[136:143], v0
ds_read_b64_tr_b16 v[34:35], v4 offset:13824
v_mov_b64 v[76:77], s[52:53]
s_waitcnt lgkmcnt(4)
s_barrier
ds_read_b128 v[12:15], v1 offset:14336
v_smfmac_f32_16x16x64_bf16 v[40:43], v[72:75], v[44:51], v0
ds_read_b128 v[44:47], v2 offset:16384
v_mov_b64 v[78:79], s[52:53]
s_waitcnt lgkmcnt(4)
v_mfma_f32_16x16x32_bf16 v[28:31], v[28:31], v[20:23], 0
ds_read_b128 v[48:51], v2 offset:17408
s_waitcnt lgkmcnt(3)
v_mfma_f32_16x16x32_bf16 v[28:31], v[32:35], v[24:27], v[28:31]
v_smfmac_f32_16x16x64_bf16 v[40:43], v[64:67], a[152:159], v0
s_waitcnt lgkmcnt(2)
v_max3_f32 v17, v12, v13, v14
v_smfmac_f32_16x16x64_bf16 v[36:39], v[64:67], a[144:151], v0
ds_read_b128 v[60:63], v2 offset:26624
v_add_f32_dpp v28, v30, v28 quad_perm:[2,3,0,1] row_mask:0xf bank_mask:0xf
v_add_f32_dpp v29, v31, v29 quad_perm:[2,3,0,1] row_mask:0xf bank_mask:0xf
v_max_f32 v17, v17, v15
v_max_f32 v16, v28, v29
v_mul_f32 v16, s50, v16
v_max_f32_dpp v17, v17, v17 quad_perm:[2,3,0,1] row_mask:0xf bank_mask:0xf
v_smfmac_f32_16x16x64_bf16 v[40:43], v[68:71], a[168:175], v0
ds_read_b128 v[64:67], v2 offset:27648
v_max_f32_dpp v18, v16, v17 quad_perm:[0,1,0,1] row_mask:0xf bank_mask:0xf
v_max_f32_dpp v19, v16, v17 quad_perm:[0,1,0,1] row_mask:0xf bank_mask:0xf
v_smfmac_f32_16x16x64_bf16 v[36:39], v[68:71], a[160:167], v0
ds_read_b128 v[68:71], v2 offset:20480
v_permlane16_swap_b32 v18, v19
v_max_f32 v20, v18, v19
v_max_f32 v21, v18, v19
s_waitcnt lgkmcnt(3)
v_smfmac_f32_16x16x64_bf16 v[36:39], v[72:75], v[44:51], v0
ds_read_b128 v[72:75], v2 offset:21504
v_permlane32_swap_b32 v20, v21
v_max_f32 v20, v20, v21
v_sub_f32 v12, v12, v20
v_sub_f32 v13, v13, v20
v_pk_add_f32 v[14:15], v[14:15], v[20:21] op_sel_hi:[1,0] neg_lo:[0,1] neg_hi:[0,1]
v_exp_f32 v12, v12
v_exp_f32 v13, v13
v_exp_f32 v14, v14
v_exp_f32 v15, v15
v_cvt_pk_bf16_f32 v16, v12, v13
v_cvt_pk_bf16_f32 v17, v14, v15
v_pk_fma_f32 v[28:29], v[28:29], s[50:51], v[20:21] op_sel_hi:[1,1,0] neg_lo:[0,0,1] neg_hi:[0,0,1]
v_mov_b32_dpp v18, v16 quad_perm:[2,3,0,1] row_mask:0xf bank_mask:0xf
v_mov_b32_dpp v19, v17 quad_perm:[2,3,0,1] row_mask:0xf bank_mask:0xf
v_exp_f32 v28, v28
s_waitcnt vmcnt(2)
v_mfma_f32_16x16x32_bf16 v[32:35], v[76:79], v[16:19], 0
v_exp_f32 v29, v29
v_mfma_f32_16x16x32_bf16 v[20:23], v[52:55], v[16:19], 0
v_cvt_pk_bf16_f32 v12, v28, v29
v_cvt_pk_bf16_f32 v13, v28, v29
v_mov_b64 v[14:15], s[0:1]
v_mfma_f32_16x16x32_bf16 v[24:27], v[56:59], v[16:19], 0
v_cvt_pk_bf16_f32 v36, v36, v37
v_cvt_pk_bf16_f32 v37, v38, v39
v_mfma_f32_16x16x16_bf16 v[32:35], v[14:15], v[12:13], v[32:35]
v_cvt_pk_bf16_f32 v38, v40, v41
v_cvt_pk_bf16_f32 v39, v42, v43
v_mfma_f32_16x16x16_bf16 v[20:23], v[36:37], v[12:13], v[20:23]
ds_read_b128 v[44:47], v2 offset:22528
v_mfma_f32_16x16x16_bf16 v[24:27], v[38:39], v[12:13], v[24:27]
ds_read_b128 v[48:51], v2 offset:23552
v_rcp_f32 v32, v32
v_mov_b64 v[28:29], 0
v_mov_b64 v[30:31], 0
v_pk_mul_f32 v[20:21], v[20:21], v[32:33] op_sel_hi:[1,0]
v_pk_mul_f32 v[22:23], v[22:23], v[32:33] op_sel_hi:[1,0]
v_cvt_pk_bf16_f32 v20, v20, v21
v_cvt_pk_bf16_f32 v21, v22, v23
ds_write_b64 v1, v[20:21] offset:7168
v_pk_mul_f32 v[24:25], v[24:25], v[32:33] op_sel_hi:[1,0]
v_pk_mul_f32 v[26:27], v[26:27], v[32:33] op_sel_hi:[1,0]
v_cvt_pk_bf16_f32 v24, v24, v25
v_cvt_pk_bf16_f32 v25, v26, v27
ds_write_b64 v1, v[24:25] offset:7176
v_mov_b64 v[76:77], 0
ds_read_b128 v[12:15], v7 offset:7168
v_mov_b64 v[78:79], 0
v_mov_b64 v[40:41], 0
v_mov_b64 v[42:43], 0
v_mov_b64 v[36:37], 0
v_mov_b64 v[38:39], 0
v_mov_b64 v[32:33], 0
v_mov_b64 v[34:35], 0
s_waitcnt lgkmcnt(1)
s_barrier
ds_read_b128 v[16:19], v7 offset:8192
ds_read_b128 v[52:55], v7 offset:5120
ds_read_b128 v[56:59], v7 offset:6144
s_waitcnt lgkmcnt(3)
v_smfmac_f32_16x16x64_bf16 v[28:31], v[12:15], v[44:51], v0 abid:1
v_smfmac_f32_16x16x64_bf16 v[76:79], v[12:15], v[60:67], v0 abid:1
ds_read_b128 v[44:47], v2 offset:24576
s_waitcnt lgkmcnt(3)
v_smfmac_f32_16x16x64_bf16 v[28:31], v[16:19], a[176:183], v0 abid:1
ds_read_b128 v[48:51], v2 offset:25600
s_waitcnt lgkmcnt(3)
v_smfmac_f32_16x16x64_bf16 v[28:31], v[52:55], v[68:75], v0 abid:1
ds_read_b128 v[60:63], v2 offset:30720
s_waitcnt lgkmcnt(3)
v_smfmac_f32_16x16x64_bf16 v[28:31], v[56:59], a[184:191], v0 abid:1
ds_read_b128 v[64:67], v2 offset:31744
v_smfmac_f32_16x16x64_bf16 v[76:79], v[16:19], a[192:199], v0 abid:1
ds_read_b128 v[68:71], v2 offset:28672
s_waitcnt lgkmcnt(3)
v_smfmac_f32_16x16x64_bf16 v[76:79], v[52:55], v[44:51], v0 abid:1
ds_read_b128 v[72:75], v2 offset:29696
v_cvt_pk_bf16_f32 v28, v28, v29
v_cvt_pk_bf16_f32 v29, v30, v31
v_bfi_b32 v28, 1, s35, v28
buffer_store_dwordx2 v[28:29], v8, s[4:7], s42 offen
v_smfmac_f32_16x16x64_bf16 v[76:79], v[56:59], a[200:207], v0 abid:1
s_waitcnt lgkmcnt(2)
v_smfmac_f32_16x16x64_bf16 v[40:43], v[12:15], v[60:67], v0 abid:1
v_smfmac_f32_16x16x64_bf16 v[40:43], v[16:19], a[208:215], v0 abid:1
v_cvt_pk_bf16_f32 v76, v76, v77
v_cvt_pk_bf16_f32 v77, v78, v79
v_bfi_b32 v76, 1, s35, v76
buffer_store_dwordx2 v[76:77], v8, s[4:7], s43 offen
s_waitcnt lgkmcnt(0)
v_smfmac_f32_16x16x64_bf16 v[40:43], v[52:55], v[68:75], v0 abid:1
v_smfmac_f32_16x16x64_bf16 v[40:43], v[56:59], a[216:223], v0 abid:1
v_smfmac_f32_16x16x64_bf16 v[36:39], v[12:15], a[224:231], v0 abid:1
v_smfmac_f32_16x16x64_bf16 v[36:39], v[16:19], a[232:239], v0 abid:1
v_cvt_pk_bf16_f32 v40, v40, v41
v_cvt_pk_bf16_f32 v41, v42, v43
v_bfi_b32 v40, 1, s35, v40
buffer_store_dwordx2 v[40:41], v8, s[4:7], s44 offen
v_smfmac_f32_16x16x64_bf16 v[36:39], v[52:55], a[240:247], v0 abid:1
v_smfmac_f32_16x16x64_bf16 v[36:39], v[56:59], a[248:255], v0 abid:1
s_nop 7
v_cvt_pk_bf16_f32 v36, v36, v37
v_cvt_pk_bf16_f32 v37, v38, v39
v_bfi_b32 v36, 1, s35, v36
buffer_store_dwordx2 v[36:37], v8, s[4:7], s45 offen
s_branch L_ex_w2rf
L_done_w2rf:
buffer_store_dword v11, v10, s[4:7], s40 offen sc0 sc1
s_waitcnt vmcnt(0) lgkmcnt(0)
s_endpgm
L_rdv2_w2r:
buffer_load_dword v32, v24, s[28:31], 0 offen sc0 sc1
s_sub_u32 s41, s41, 1
s_cbranch_scc1 L_exit
s_waitcnt vmcnt(0)
s_branch L_rdv_w2r
L_ra0_w2rf:
s_mov_b32 m0, 1024
s_nop 0
buffer_load_dwordx4 v1, s[4:7], s47 offen offset:0 sc1 lds
buffer_load_dwordx4 v1, s[4:7], s47 offen offset:1024 sc1 lds
buffer_load_dwordx4 v1, s[4:7], s47 offen offset:2048 sc1 lds
buffer_load_dwordx4 v1, s[4:7], s47 offen offset:3072 sc1 lds
s_sub_u32 s41, s41, 1
s_cbranch_scc1 L_exit
ds_read_b128 v[44:47], v2 offset:0
ds_read_b128 v[48:51], v2 offset:1024
v_mov_b64 v[20:21], 0
v_mov_b64 v[22:23], 0
v_mov_b64 v[24:25], 0
v_mov_b64 v[26:27], 0
v_mov_b64 v[28:29], 0
v_mov_b64 v[30:31], 0
v_mov_b64 v[32:33], 0
v_mov_b64 v[34:35], 0
v_mov_b64 v[36:37], 0
v_mov_b64 v[38:39], 0
v_mov_b64 v[40:41], 0
v_mov_b64 v[42:43], 0
s_waitcnt vmcnt(0)
ds_read_b128 v[60:63], v1 offset:1024
ds_read_b128 v[64:67], v1 offset:2048
ds_read_b128 v[68:71], v1 offset:3072
ds_read_b128 v[72:75], v1 offset:4096
s_branch L_s0_w2rf
L_ra1_w2rf:
s_waitcnt lgkmcnt(0)
s_barrier
s_mov_b32 m0, 5120
s_nop 0
buffer_load_dwordx4 v1, s[4:7], s48 offen offset:2048 sc1 lds
s_sub_u32 s41, s41, 1
s_cbranch_scc1 L_exit
s_waitcnt vmcnt(0)
s_barrier
ds_read_b128 v[76:79], v1 offset:5120
ds_read_b128 v[60:63], v1 offset:6144
ds_read_b128 v[64:67], v1 offset:7168
ds_read_b128 v[68:71], v1 offset:8192
ds_read_b128 v[72:75], v1 offset:9216
s_waitcnt lgkmcnt(0)
v_bitop3_b32 v6, v76, v60, s35 bitop3:0x7e
v_bitop3_b32 v6, v6, v64, s35 bitop3:0xf6
v_bitop3_b32 v6, v6, v68, s35 bitop3:0xf6
v_bitop3_b32 v6, v6, v72, s35 bitop3:0xf6
v_and_b32 v6, 1, v6
v_cmp_ne_u32 vcc, 0, v6
v_lshlrev_b32 v6, 2, v1
s_cbranch_vccnz L_ra1_w2rf
s_branch L_a1_w2rf
L_rr_w2rf:
buffer_load_dwordx4 v[60:63], v9, s[4:7], s3 offen offset:0 sc1
buffer_load_dwordx4 v[64:67], v9, s[4:7], s3 offen offset:1024 sc1
buffer_load_dwordx4 v[68:71], v9, s[4:7], s3 offen offset:2048 sc1
buffer_load_dwordx4 v[72:75], v9, s[4:7], s3 offen offset:3072 sc1
s_sub_u32 s41, s41, 1
s_cbranch_scc1 L_exit
s_waitcnt vmcnt(0)
s_branch L_r_w2rf
L_slow_w2r:
v_mov_b64 v[20:21], 0
v_mov_b64 v[22:23], 0
v_mov_b64 v[24:25], 0
v_mov_b64 v[26:27], 0
v_mov_b64 v[28:29], 0
v_mov_b64 v[30:31], 0
v_mov_b64 v[32:33], 0
v_mov_b64 v[34:35], 0
v_mov_b64 v[36:37], 0
v_mov_b64 v[38:39], 0
v_mov_b64 v[40:41], 0
v_mov_b64 v[42:43], 0
ds_read_b128 v[44:47], v2 offset:0
ds_read_b128 v[48:51], v2 offset:1024
v_bfe_u32 v77, v1, 6, 1
v_lshl_add_u32 v77, v77, 3, v1
v_lshlrev_b32 v77, 1, v77
v_lshlrev_b32 v78, 2, v1
s_waitcnt vmcnt(0) lgkmcnt(0)
s_branch L_top_w2rs
.p2align 6
L_ex_w2rs:
v_and_b32 v6, 0x70, v1
ds_read_b128 v[76:79], v6 offset:256
v_bfe_u32 v11, v1, 4, 2
v_lshrrev_b32_e64 v11, v11, 1
s_add_u32 s34, s34, 1
s_add_u32 s37, s37, 524288
s_add_u32 s39, s39, 524288
s_mul_i32 s40, s34, 10240
s_add_u32 s40, s40, 8093696
s_not_b32 s35, s35
s_not_b32 s36, s36
ds_read_b128 v[44:47], v2 offset:0
ds_read_b128 v[48:51], v2 offset:1024
v_bfe_u32 v6, v1, 2, 7
v_mov_b32 v12, s36
v_mov_b32 v13, s35
s_mov_b32 m0, 1024
s_waitcnt vmcnt(2)
buffer_load_dwordx4 v[60:63], v9, s[4:7], s3 offen offset:0 sc0 sc1
buffer_load_dwordx4 v[64:67], v9, s[4:7], s3 offen offset:1024 sc0 sc1
buffer_load_dwordx4 v[68:71], v9, s[4:7], s3 offen offset:2048 sc0 sc1
buffer_load_dwordx4 v[72:75], v9, s[4:7], s3 offen offset:3072 sc0 sc1
s_barrier
s_waitcnt lgkmcnt(2)
s_waitcnt vmcnt(3)
L_r_w2rs:
v_mfma_f32_16x16x32_bf16 v[52:55], v[60:63], v[76:79], 0
s_waitcnt vmcnt(2)
v_mfma_f32_16x16x32_bf16 v[52:55], v[64:67], v[76:79], v[52:55]
v_bitop3_b32 v56, v60, v64, s36 bitop3:0x7e
s_waitcnt vmcnt(1)
v_mfma_f32_16x16x32_bf16 v[52:55], v[68:71], v[76:79], v[52:55]
s_waitcnt vmcnt(0)
v_mfma_f32_16x16x32_bf16 v[52:55], v[72:75], v[76:79], v[52:55]
v_bitop3_b32 v57, v68, v72, s36 bitop3:0x7e
v_bitop3_b32 v56, v56, v57, 1 bitop3:0xa8
v_cmp_ne_u32 vcc, 0, v56
s_cmp_eq_u32 s34, 63
s_nop 3
v_pk_add_f32 v[52:53], v[52:53], v[54:55]
v_cvt_pk_bf16_f32 v56, v52, v53
v_bfi_b32 v56, v11, s35, v56
s_cbranch_vccnz L_rr_w2rs
buffer_store_dword v56, v10, s[4:7], 0 offen sc0 sc1
v_mov_b32 v11, v56
s_cbranch_scc1 L_done_w2rs
s_mov_b64 exec, 1
buffer_store_dword v13, v1, s[4:7], s33 offen sc0 sc1
s_mov_b64 exec, -1
v_mov_b64 v[20:21], 0
v_mov_b64 v[22:23], 0
v_mov_b64 v[24:25], 0
v_mov_b64 v[26:27], 0
v_mov_b64 v[28:29], 0
v_mov_b64 v[30:31], 0
v_mov_b64 v[32:33], 0
v_mov_b64 v[34:35], 0
v_mov_b64 v[36:37], 0
v_mov_b64 v[38:39], 0
v_mov_b64 v[40:41], 0
v_mov_b64 v[42:43], 0
v_bfe_u32 v77, v1, 6, 1
v_lshl_add_u32 v77, v77, 3, v1
v_lshlrev_b32 v77, 1, v77
v_lshlrev_b32 v78, 2, v1
L_sp_w2rs:
buffer_load_dword v12, v6, s[4:7], s58 offen sc0 sc1
s_sub_u32 s41, s41, 1
s_cbranch_scc1 L_exit
buffer_load_dwordx4 v1, s[4:7], s47 offen offset:0 sc0 sc1 lds
buffer_load_dwordx4 v1, s[4:7], s47 offen offset:1024 sc0 sc1 lds
buffer_load_dwordx4 v1, s[4:7], s47 offen offset:2048 sc0 sc1 lds
buffer_load_dwordx4 v1, s[4:7], s47 offen offset:3072 sc0 sc1 lds
s_waitcnt vmcnt(4)
v_cmp_ne_u32 vcc, s35, v12
s_cbranch_vccnz L_sp_w2rs
L_top_w2rs:
s_waitcnt vmcnt(2)
s_barrier
ds_read_b128 v[60:63], v1 offset:1024
ds_read_b128 v[64:67], v1 offset:2048
s_mov_b32 m0, 5120
s_nop 0
buffer_load_dwordx4 v1, s[4:7], s48 offen offset:2048 sc0 sc1 lds
s_waitcnt vmcnt(1)
s_barrier
ds_read_b128 v[68:71], v1 offset:3072
ds_read_b128 v[72:75], v1 offset:4096
L_s0_w2rs:
s_waitcnt lgkmcnt(3)
v_smfmac_f32_16x16x64_bf16 v[28:31], v[60:63], v[176:183], v0
v_smfmac_f32_16x16x64_bf16 v[32:35], v[60:63], v[184:191], v0
v_smfmac_f32_16x16x64_bf16 v[36:39], v[60:63], a[48:55], v0
v_smfmac_f32_16x16x64_bf16 v[40:43], v[60:63], a[56:63], v0
s_waitcnt lgkmcnt(2)
v_smfmac_f32_16x16x64_bf16 v[20:23], v[64:67], v[80:87], v0
v_smfmac_f32_16x16x64_bf16 v[20:23], v[60:63], v[44:51], v0
ds_read_b128 v[44:47], v2 offset:2048
v_smfmac_f32_16x16x64_bf16 v[24:27], v[64:67], v[88:95], v0
ds_read_b128 v[48:51], v2 offset:3072
v_smfmac_f32_16x16x64_bf16 v[28:31], v[64:67], v[192:199], v0
s_waitcnt lgkmcnt(2)
v_bitop3_b32 v6, v60, v64, s35 bitop3:0x7e
v_smfmac_f32_16x16x64_bf16 v[32:35], v[64:67], v[200:207], v0
v_bitop3_b32 v76, v68, v72, s35 bitop3:0x7e
buffer_load_dwordx4 v[12:15], v9, s[4:7], s37 offen offset:0
buffer_load_dwordx4 v[16:19], v9, s[4:7], s37 offen offset:1024
buffer_load_dwordx4 v[52:55], v1, s[4:7], s37 offen offset:2048
buffer_load_dwordx4 v[56:59], v1, s[4:7], s37 offen offset:3072
v_smfmac_f32_16x16x64_bf16 v[36:39], v[64:67], a[64:71], v0
v_bitop3_b32 v6, v6, v76, 1 bitop3:0xa8
s_waitcnt lgkmcnt(0)
v_smfmac_f32_16x16x64_bf16 v[24:27], v[60:63], v[44:51], v0
ds_read_b128 v[44:47], v2 offset:4096
v_cmp_ne_u32 vcc, 0, v6
v_smfmac_f32_16x16x64_bf16 v[40:43], v[64:67], a[72:79], v0
ds_read_b128 v[48:51], v2 offset:5120
v_smfmac_f32_16x16x64_bf16 v[20:23], v[68:71], v[96:103], v0
s_cbranch_vccnz L_ra0_w2rs
v_smfmac_f32_16x16x64_bf16 v[24:27], v[68:71], v[104:111], v0
s_waitcnt vmcnt(4)
s_barrier
ds_read_b32 v6, v77 offset:8192
v_smfmac_f32_16x16x64_bf16 v[28:31], v[68:71], v[208:215], v0
ds_read_b128 v[60:63], v1 offset:6144
s_waitcnt lgkmcnt(2)
v_smfmac_f32_16x16x64_bf16 v[20:23], v[72:75], v[44:51], v0
ds_read_b128 v[64:67], v1 offset:7168
v_smfmac_f32_16x16x64_bf16 v[32:35], v[68:71], v[216:223], v0
ds_read_b128 v[76:79], v1 offset:5120
v_smfmac_f32_16x16x64_bf16 v[36:39], v[68:71], a[80:87], v0
ds_read_b128 v[44:47], v2 offset:6144
v_smfmac_f32_16x16x64_bf16 v[40:43], v[68:71], a[88:95], v0
ds_read_b128 v[48:51], v2 offset:7168
s_waitcnt lgkmcnt(4)
v_bitop3_b32 v6, v6, v60, s35 bitop3:0x7e
v_smfmac_f32_16x16x64_bf16 v[28:31], v[72:75], v[224:231], v0
ds_read_b128 v[68:71], v1 offset:8192
s_waitcnt lgkmcnt(4)
v_bitop3_b32 v6, v6, v64, s35 bitop3:0xf6
v_smfmac_f32_16x16x64_bf16 v[32:35], v[72:75], v[232:239], v0
s_waitcnt lgkmcnt(3)
v_bitop3_b32 v6, v6, v76, s35 bitop3:0xf6
v_and_b32 v6, 1, v6
v_smfmac_f32_16x16x64_bf16 v[36:39], v[72:75], a[96:103], v0
v_cmp_ne_u32 vcc, 0, v6
s_waitcnt lgkmcnt(1)
v_smfmac_f32_16x16x64_bf16 v[24:27], v[72:75], v[44:51], v0
ds_read_b128 v[44:47], v2 offset:8192
v_lshlrev_b32 v6, 2, v1
v_smfmac_f32_16x16x64_bf16 v[40:43], v[72:75], a[104:111], v0
ds_read_b128 v[72:75], v1 offset:9216
s_cbranch_vccnz L_ra1_w2rs
L_a1_w2rs:
buffer_store_dword v11, v10, s[4:7], s40 offen sc0 sc1
s_mov_b32 m0, 0
s_nop 0
buffer_load_dword v6, s[4:7], s39 offen lds
v_smfmac_f32_16x16x64_bf16 v[20:23], v[60:63], v[112:119], v0
ds_read_b128 v[48:51], v2 offset:9216
v_smfmac_f32_16x16x64_bf16 v[20:23], v[64:67], v[128:135], v0
s_waitcnt lgkmcnt(3)
v_smfmac_f32_16x16x64_bf16 v[20:23], v[68:71], v[144:151], v0
s_waitcnt lgkmcnt(1)
v_smfmac_f32_16x16x64_bf16 v[20:23], v[72:75], v[160:167], v0
s_waitcnt lgkmcnt(0)
v_smfmac_f32_16x16x64_bf16 v[20:23], v[76:79], v[44:51], v0
ds_read_b128 v[44:47], v2 offset:10240
v_smfmac_f32_16x16x64_bf16 v[24:27], v[60:63], v[120:127], v0
ds_read_b128 v[48:51], v2 offset:11264
v_smfmac_f32_16x16x64_bf16 v[24:27], v[64:67], v[136:143], v0
v_add_f32 v20, v20, v22
v_smfmac_f32_16x16x64_bf16 v[24:27], v[68:71], v[152:159], v0
v_add_f32 v21, v21, v23
v_smfmac_f32_16x16x64_bf16 v[24:27], v[72:75], v[168:175], v0
v_cvt_pk_bf16_f32 v22, v20, v21
s_waitcnt lgkmcnt(0)
v_smfmac_f32_16x16x64_bf16 v[24:27], v[76:79], v[44:51], v0
ds_read_b128 v[44:47], v2 offset:12288
v_smfmac_f32_16x16x64_bf16 v[28:31], v[76:79], v[240:247], v0
ds_read_b128 v[48:51], v2 offset:13312
v_smfmac_f32_16x16x64_bf16 v[28:31], v[64:67], a[0:7], v0
v_add_f32 v24, v24, v26
v_add_f32 v25, v25, v27
v_cvt_pk_bf16_f32 v23, v24, v25
v_smfmac_f32_16x16x64_bf16 v[28:31], v[68:71], a[16:23], v0
ds_write_b64 v3, v[22:23] offset:11264
v_smfmac_f32_16x16x64_bf16 v[28:31], v[72:75], a[32:39], v0
s_waitcnt lgkmcnt(1)
v_smfmac_f32_16x16x64_bf16 v[28:31], v[60:63], v[44:51], v0
ds_read_b128 v[44:47], v2 offset:14336
v_smfmac_f32_16x16x64_bf16 v[32:35], v[76:79], v[248:255], v0
ds_read_b128 v[48:51], v2 offset:15360
s_waitcnt lgkmcnt(2)
s_barrier
v_smfmac_f32_16x16x64_bf16 v[32:35], v[64:67], a[8:15], v0
ds_read_b64_tr_b16 v[20:21], v4 offset:10240
ds_read_b64_tr_b16 v[22:23], v4 offset:10752
v_add_f32 v28, v28, v30
v_smfmac_f32_16x16x64_bf16 v[32:35], v[68:71], a[24:31], v0
ds_read_b64_tr_b16 v[24:25], v4 offset:11264
v_add_f32 v29, v29, v31
v_smfmac_f32_16x16x64_bf16 v[32:35], v[72:75], a[40:47], v0
ds_read_b64_tr_b16 v[26:27], v4 offset:11776
v_cvt_pk_bf16_f32 v30, v28, v29
s_waitcnt lgkmcnt(4)
v_smfmac_f32_16x16x64_bf16 v[32:35], v[60:63], v[44:51], v0
ds_read_b128 v[44:47], v2 offset:18432
s_waitcnt vmcnt(4)
s_waitcnt lgkmcnt(3)
v_mfma_f32_16x16x32_bf16 v[12:15], v[12:15], v[20:23], 0
ds_read_b128 v[48:51], v2 offset:19456
s_waitcnt lgkmcnt(2)
v_mfma_f32_16x16x32_bf16 v[12:15], v[16:19], v[24:27], v[12:15]
v_add_f32 v32, v32, v34
v_add_f32 v33, v33, v35
v_cvt_pk_bf16_f32 v31, v32, v33
ds_write_b64 v3, v[30:31] offset:13312
v_smfmac_f32_16x16x64_bf16 v[36:39], v[76:79], a[112:119], v0
s_nop 2
v_add_f32_dpp v12, v14, v12 quad_perm:[2,3,0,1] row_mask:0xf bank_mask:0xf
v_add_f32_dpp v13, v15, v13 quad_perm:[2,3,0,1] row_mask:0xf bank_mask:0xf
ds_write_b64 v5, v[12:13] offset:14848
v_smfmac_f32_16x16x64_bf16 v[40:43], v[76:79], a[120:127], v0
s_waitcnt lgkmcnt(1)
s_barrier
ds_read_b64_tr_b16 v[28:29], v4 offset:12288
v_smfmac_f32_16x16x64_bf16 v[36:39], v[60:63], a[128:135], v0
ds_read_b64_tr_b16 v[30:31], v4 offset:12800
ds_read_b64_tr_b16 v[32:33], v4 offset:13312
v_smfmac_f32_16x16x64_bf16 v[40:43], v[60:63], a[136:143], v0
ds_read_b64_tr_b16 v[34:35], v4 offset:13824
v_mov_b64 v[76:77], s[52:53]
s_waitcnt lgkmcnt(4)
s_barrier
ds_read_b128 v[12:15], v1 offset:14336
v_smfmac_f32_16x16x64_bf16 v[40:43], v[72:75], v[44:51], v0
ds_read_b128 v[44:47], v2 offset:16384
v_mov_b64 v[78:79], s[52:53]
s_waitcnt lgkmcnt(4)
v_mfma_f32_16x16x32_bf16 v[28:31], v[28:31], v[20:23], 0
ds_read_b128 v[48:51], v2 offset:17408
s_waitcnt lgkmcnt(3)
v_mfma_f32_16x16x32_bf16 v[28:31], v[32:35], v[24:27], v[28:31]
v_smfmac_f32_16x16x64_bf16 v[40:43], v[64:67], a[152:159], v0
s_waitcnt lgkmcnt(2)
v_max3_f32 v17, v12, v13, v14
v_smfmac_f32_16x16x64_bf16 v[36:39], v[64:67], a[144:151], v0
ds_read_b128 v[60:63], v2 offset:26624
v_add_f32_dpp v28, v30, v28 quad_perm:[2,3,0,1] row_mask:0xf bank_mask:0xf
v_add_f32_dpp v29, v31, v29 quad_perm:[2,3,0,1] row_mask:0xf bank_mask:0xf
v_max_f32 v17, v17, v15
v_max_f32 v16, v28, v29
v_mul_f32 v16, s50, v16
v_max_f32_dpp v17, v17, v17 quad_perm:[2,3,0,1] row_mask:0xf bank_mask:0xf
v_smfmac_f32_16x16x64_bf16 v[40:43], v[68:71], a[168:175], v0
ds_read_b128 v[64:67], v2 offset:27648
v_max_f32_dpp v18, v16, v17 quad_perm:[0,1,0,1] row_mask:0xf bank_mask:0xf
v_max_f32_dpp v19, v16, v17 quad_perm:[0,1,0,1] row_mask:0xf bank_mask:0xf
v_smfmac_f32_16x16x64_bf16 v[36:39], v[68:71], a[160:167], v0
ds_read_b128 v[68:71], v2 offset:20480
v_permlane16_swap_b32 v18, v19
v_max_f32 v20, v18, v19
v_max_f32 v21, v18, v19
s_waitcnt lgkmcnt(3)
v_smfmac_f32_16x16x64_bf16 v[36:39], v[72:75], v[44:51], v0
ds_read_b128 v[72:75], v2 offset:21504
v_permlane32_swap_b32 v20, v21
v_max_f32 v20, v20, v21
v_sub_f32 v12, v12, v20
v_sub_f32 v13, v13, v20
v_pk_add_f32 v[14:15], v[14:15], v[20:21] op_sel_hi:[1,0] neg_lo:[0,1] neg_hi:[0,1]
v_exp_f32 v12, v12
v_exp_f32 v13, v13
v_exp_f32 v14, v14
v_exp_f32 v15, v15
v_cvt_pk_bf16_f32 v16, v12, v13
v_cvt_pk_bf16_f32 v17, v14, v15
v_pk_fma_f32 v[28:29], v[28:29], s[50:51], v[20:21] op_sel_hi:[1,1,0] neg_lo:[0,0,1] neg_hi:[0,0,1]
v_mov_b32_dpp v18, v16 quad_perm:[2,3,0,1] row_mask:0xf bank_mask:0xf
v_mov_b32_dpp v19, v17 quad_perm:[2,3,0,1] row_mask:0xf bank_mask:0xf
v_exp_f32 v28, v28
s_waitcnt vmcnt(2)
v_mfma_f32_16x16x32_bf16 v[32:35], v[76:79], v[16:19], 0
v_exp_f32 v29, v29
v_mfma_f32_16x16x32_bf16 v[20:23], v[52:55], v[16:19], 0
v_cvt_pk_bf16_f32 v12, v28, v29
v_cvt_pk_bf16_f32 v13, v28, v29
v_mov_b64 v[14:15], s[0:1]
v_mfma_f32_16x16x32_bf16 v[24:27], v[56:59], v[16:19], 0
v_cvt_pk_bf16_f32 v36, v36, v37
v_cvt_pk_bf16_f32 v37, v38, v39
v_mfma_f32_16x16x16_bf16 v[32:35], v[14:15], v[12:13], v[32:35]
v_cvt_pk_bf16_f32 v38, v40, v41
v_cvt_pk_bf16_f32 v39, v42, v43
v_mfma_f32_16x16x16_bf16 v[20:23], v[36:37], v[12:13], v[20:23]
ds_read_b128 v[44:47], v2 offset:22528
v_mfma_f32_16x16x16_bf16 v[24:27], v[38:39], v[12:13], v[24:27]
ds_read_b128 v[48:51], v2 offset:23552
v_rcp_f32 v32, v32
v_mov_b64 v[28:29], 0
v_mov_b64 v[30:31], 0
v_pk_mul_f32 v[20:21], v[20:21], v[32:33] op_sel_hi:[1,0]
v_pk_mul_f32 v[22:23], v[22:23], v[32:33] op_sel_hi:[1,0]
v_cvt_pk_bf16_f32 v20, v20, v21
v_cvt_pk_bf16_f32 v21, v22, v23
ds_write_b64 v1, v[20:21] offset:7168
v_pk_mul_f32 v[24:25], v[24:25], v[32:33] op_sel_hi:[1,0]
v_pk_mul_f32 v[26:27], v[26:27], v[32:33] op_sel_hi:[1,0]
v_cvt_pk_bf16_f32 v24, v24, v25
v_cvt_pk_bf16_f32 v25, v26, v27
ds_write_b64 v1, v[24:25] offset:7176
v_mov_b64 v[76:77], 0
ds_read_b128 v[12:15], v7 offset:7168
v_mov_b64 v[78:79], 0
v_mov_b64 v[40:41], 0
v_mov_b64 v[42:43], 0
v_mov_b64 v[36:37], 0
v_mov_b64 v[38:39], 0
v_mov_b64 v[32:33], 0
v_mov_b64 v[34:35], 0
s_waitcnt lgkmcnt(1)
s_barrier
ds_read_b128 v[16:19], v7 offset:8192
ds_read_b128 v[52:55], v7 offset:5120
ds_read_b128 v[56:59], v7 offset:6144
s_waitcnt lgkmcnt(3)
v_smfmac_f32_16x16x64_bf16 v[28:31], v[12:15], v[44:51], v0 abid:1
v_smfmac_f32_16x16x64_bf16 v[76:79], v[12:15], v[60:67], v0 abid:1
ds_read_b128 v[44:47], v2 offset:24576
s_waitcnt lgkmcnt(3)
v_smfmac_f32_16x16x64_bf16 v[28:31], v[16:19], a[176:183], v0 abid:1
ds_read_b128 v[48:51], v2 offset:25600
s_waitcnt lgkmcnt(3)
v_smfmac_f32_16x16x64_bf16 v[28:31], v[52:55], v[68:75], v0 abid:1
ds_read_b128 v[60:63], v2 offset:30720
s_waitcnt lgkmcnt(3)
v_smfmac_f32_16x16x64_bf16 v[28:31], v[56:59], a[184:191], v0 abid:1
ds_read_b128 v[64:67], v2 offset:31744
v_smfmac_f32_16x16x64_bf16 v[76:79], v[16:19], a[192:199], v0 abid:1
ds_read_b128 v[68:71], v2 offset:28672
s_waitcnt lgkmcnt(3)
v_smfmac_f32_16x16x64_bf16 v[76:79], v[52:55], v[44:51], v0 abid:1
ds_read_b128 v[72:75], v2 offset:29696
v_cvt_pk_bf16_f32 v28, v28, v29
v_cvt_pk_bf16_f32 v29, v30, v31
v_bfi_b32 v28, 1, s35, v28
buffer_store_dwordx2 v[28:29], v8, s[4:7], s42 offen sc0 sc1
v_smfmac_f32_16x16x64_bf16 v[76:79], v[56:59], a[200:207], v0 abid:1
s_waitcnt lgkmcnt(2)
v_smfmac_f32_16x16x64_bf16 v[40:43], v[12:15], v[60:67], v0 abid:1
v_smfmac_f32_16x16x64_bf16 v[40:43], v[16:19], a[208:215], v0 abid:1
v_cvt_pk_bf16_f32 v76, v76, v77
v_cvt_pk_bf16_f32 v77, v78, v79
v_bfi_b32 v76, 1, s35, v76
buffer_store_dwordx2 v[76:77], v8, s[4:7], s43 offen sc0 sc1
s_waitcnt lgkmcnt(0)
v_smfmac_f32_16x16x64_bf16 v[40:43], v[52:55], v[68:75], v0 abid:1
v_smfmac_f32_16x16x64_bf16 v[40:43], v[56:59], a[216:223], v0 abid:1
v_smfmac_f32_16x16x64_bf16 v[36:39], v[12:15], a[224:231], v0 abid:1
v_smfmac_f32_16x16x64_bf16 v[36:39], v[16:19], a[232:239], v0 abid:1
v_cvt_pk_bf16_f32 v40, v40, v41
v_cvt_pk_bf16_f32 v41, v42, v43
v_bfi_b32 v40, 1, s35, v40
buffer_store_dwordx2 v[40:41], v8, s[4:7], s44 offen sc0 sc1
v_smfmac_f32_16x16x64_bf16 v[36:39], v[52:55], a[240:247], v0 abid:1
v_smfmac_f32_16x16x64_bf16 v[36:39], v[56:59], a[248:255], v0 abid:1
s_nop 7
v_cvt_pk_bf16_f32 v36, v36, v37
v_cvt_pk_bf16_f32 v37, v38, v39
v_bfi_b32 v36, 1, s35, v36
buffer_store_dwordx2 v[36:37], v8, s[4:7], s45 offen sc0 sc1
s_branch L_ex_w2rs
L_done_w2rs:
buffer_store_dword v11, v10, s[4:7], s40 offen sc0 sc1
s_waitcnt vmcnt(0) lgkmcnt(0)
s_endpgm
L_ra0_w2rs:
s_mov_b32 m0, 1024
s_nop 0
buffer_load_dwordx4 v1, s[4:7], s47 offen offset:0 sc0 sc1 lds
buffer_load_dwordx4 v1, s[4:7], s47 offen offset:1024 sc0 sc1 lds
buffer_load_dwordx4 v1, s[4:7], s47 offen offset:2048 sc0 sc1 lds
buffer_load_dwordx4 v1, s[4:7], s47 offen offset:3072 sc0 sc1 lds
s_sub_u32 s41, s41, 1
s_cbranch_scc1 L_exit
ds_read_b128 v[44:47], v2 offset:0
ds_read_b128 v[48:51], v2 offset:1024
v_mov_b64 v[20:21], 0
v_mov_b64 v[22:23], 0
v_mov_b64 v[24:25], 0
v_mov_b64 v[26:27], 0
v_mov_b64 v[28:29], 0
v_mov_b64 v[30:31], 0
v_mov_b64 v[32:33], 0
v_mov_b64 v[34:35], 0
v_mov_b64 v[36:37], 0
v_mov_b64 v[38:39], 0
v_mov_b64 v[40:41], 0
v_mov_b64 v[42:43], 0
s_waitcnt vmcnt(0)
ds_read_b128 v[60:63], v1 offset:1024
ds_read_b128 v[64:67], v1 offset:2048
ds_read_b128 v[68:71], v1 offset:3072
ds_read_b128 v[72:75], v1 offset:4096
s_branch L_s0_w2rs
L_ra1_w2rs:
s_waitcnt lgkmcnt(0)
s_barrier
s_mov_b32 m0, 5120
s_nop 0
buffer_load_dwordx4 v1, s[4:7], s48 offen offset:2048 sc0 sc1 lds
s_sub_u32 s41, s41, 1
s_cbranch_scc1 L_exit
s_waitcnt vmcnt(0)
s_barrier
ds_read_b128 v[76:79], v1 offset:5120
ds_read_b128 v[60:63], v1 offset:6144
ds_read_b128 v[64:67], v1 offset:7168
ds_read_b128 v[68:71], v1 offset:8192
ds_read_b128 v[72:75], v1 offset:9216
s_waitcnt lgkmcnt(0)
v_bitop3_b32 v6, v76, v60, s35 bitop3:0x7e
v_bitop3_b32 v6, v6, v64, s35 bitop3:0xf6
v_bitop3_b32 v6, v6, v68, s35 bitop3:0xf6
v_bitop3_b32 v6, v6, v72, s35 bitop3:0xf6
v_and_b32 v6, 1, v6
v_cmp_ne_u32 vcc, 0, v6
v_lshlrev_b32 v6, 2, v1
s_cbranch_vccnz L_ra1_w2rs
s_branch L_a1_w2rs
L_rr_w2rs:
buffer_load_dwordx4 v[60:63], v9, s[4:7], s3 offen offset:0 sc0 sc1
buffer_load_dwordx4 v[64:67], v9, s[4:7], s3 offen offset:1024 sc0 sc1
buffer_load_dwordx4 v[68:71], v9, s[4:7], s3 offen offset:2048 sc0 sc1
buffer_load_dwordx4 v[72:75], v9, s[4:7], s3 offen offset:3072 sc0 sc1
s_sub_u32 s41, s41, 1
s_cbranch_scc1 L_exit
s_waitcnt vmcnt(0)
s_branch L_r_w2rs
L_pro_w3r:
v_and_b32 v20, 63, v0
v_and_b32 v21, 15, v0
v_bfe_u32 v22, v0, 4, 2
v_lshlrev_b32 v1, 4, v20
v_add_u32 v2, 131072, v1
v_lshrrev_b32 v24, 1, v22
v_and_b32 v23, 1, v22
v_lshl_add_u32 v23, v24, 3, v23
v_lshlrev_b32 v23, 13, v23
v_lshlrev_b32 v26, 1, v22
v_xor_b32 v26, v26, v21
v_lshl_add_u32 v26, v26, 4, v23
v_xor_b32 v27, 128, v26
v_and_b32 v23, 1, v22
v_lshl_add_u32 v23, v24, 4, v23
v_mul_u32_u24 v23, 1152, v23
v_lshlrev_b32 v28, 2, v22
v_xor_b32 v28, v28, v21
v_lshl_add_u32 v28, v28, 4, v23
s_lshl_b32 s54, s32, 8
s_mul_i32 s55, s32, 147456
s_waitcnt lgkmcnt(0)
s_add_u32 s56, s54, 917504
s_mov_b32 m0, 151552
s_nop 0
buffer_load_dwordx4 v26, s[8:11], s56 offen lds
s_add_u32 s56, s54, 933888
s_mov_b32 m0, 152576
s_nop 0
buffer_load_dwordx4 v26, s[8:11], s56 offen lds
s_add_u32 s56, s54, 950272
s_mov_b32 m0, 153600
s_nop 0
buffer_load_dwordx4 v27, s[8:11], s56 offen lds
s_add_u32 s56, s54, 966656
s_mov_b32 m0, 154624
s_nop 0
buffer_load_dwordx4 v27, s[8:11], s56 offen lds
s_add_u32 s56, s54, 1441792
s_mov_b32 m0, 155648
s_nop 0
buffer_load_dwordx4 v26, s[8:11], s56 offen lds
s_add_u32 s56, s54, 1458176
s_mov_b32 m0, 156672
s_nop 0
buffer_load_dwordx4 v26, s[8:11], s56 offen lds
s_add_u32 s56, s54, 1474560
s_mov_b32 m0, 157696
s_nop 0
buffer_load_dwordx4 v27, s[8:11], s56 offen lds
s_add_u32 s56, s54, 1490944
s_mov_b32 m0, 158720
s_nop 0
buffer_load_dwordx4 v27, s[8:11], s56 offen lds
v_and_b32 v23, 1, v22
v_lshrrev_b32 v24, 2, v21
v_lshl_add_u32 v23, v23, 2, v24
v_lshlrev_b32 v23, 1, v23
v_bfe_u32 v44, v21, 1, 1
v_add_u32 v44, 12, v44
v_xor_b32 v44, v44, v23
v_lshlrev_b32 v44, 4, v44
v_lshl_add_u32 v44, v24, 8, v44
v_and_b32 v23, 1, v22
v_lshl_add_u32 v44, v23, 11, v44
v_and_b32 v23, 1, v21
v_lshl_add_u32 v44, v23, 3, v44
v_lshrrev_b32 v23, 1, v22
v_mul_u32_u24 v23, 40960, v23
v_add_u32 v23, 16384, v23
v_add_u32 v44, v44, v23
v_and_b32 v23, 1, v22
v_lshrrev_b32 v24, 2, v21
v_lshl_add_u32 v23, v23, 2, v24
v_lshlrev_b32 v23, 1, v23
v_bfe_u32 v45, v21, 1, 1
v_add_u32 v45, 14, v45
v_xor_b32 v45, v45, v23
v_lshlrev_b32 v45, 4, v45
v_lshl_add_u32 v45, v24, 8, v45
v_and_b32 v23, 1, v22
v_lshl_add_u32 v45, v23, 11, v45
v_and_b32 v23, 1, v21
v_lshl_add_u32 v45, v23, 3, v45
v_lshrrev_b32 v23, 1, v22
v_mul_u32_u24 v23, 40960, v23
v_add_u32 v23, 16384, v23
v_add_u32 v45, v45, v23
v_and_b32 v23, 1, v22
v_lshrrev_b32 v24, 2, v21
v_lshl_add_u32 v23, v23, 2, v24
v_lshlrev_b32 v23, 1, v23
v_bfe_u32 v46, v21, 1, 1
v_add_u32 v46, 12, v46
v_xor_b32 v46, v46, v23
v_lshlrev_b32 v46, 4, v46
v_lshl_add_u32 v46, v24, 8, v46
v_and_b32 v23, 1, v22
v_lshl_add_u32 v46, v23, 11, v46
v_and_b32 v23, 1, v21
v_lshl_add_u32 v46, v23, 3, v46
v_lshrrev_b32 v23, 1, v22
v_mul_u32_u24 v23, 32768, v23
v_add_u32 v23, 98304, v23
v_add_u32 v46, v46, v23
v_and_b32 v23, 1, v22
v_lshrrev_b32 v24, 2, v21
v_lshl_add_u32 v23, v23, 2, v24
v_lshlrev_b32 v23, 1, v23
v_bfe_u32 v47, v21, 1, 1
v_add_u32 v47, 14, v47
v_xor_b32 v47, v47, v23
v_lshlrev_b32 v47, 4, v47
v_lshl_add_u32 v47, v24, 8, v47
v_and_b32 v23, 1, v22
v_lshl_add_u32 v47, v23, 11, v47
v_and_b32 v23, 1, v21
v_lshl_add_u32 v47, v23, 3, v47
v_lshrrev_b32 v23, 1, v22
v_mul_u32_u24 v23, 32768, v23
v_add_u32 v23, 98304, v23
v_add_u32 v47, v47, v23
v_and_b32 v23, 1, v22
v_bfe_u32 v24, v21, 2, 1
v_lshl_add_u32 v23, v23, 1, v24
v_xor_b32 v24, 3, v23
v_lshlrev_b32 v24, 6, v24
v_lshl_add_u32 v48, v23, 8, v24
v_and_b32 v23, 3, v21
v_lshl_add_u32 v48, v23, 4, v48
v_and_b32 v23, 8, v21
v_add_u32 v48, v48, v23
v_lshrrev_b32 v23, 1, v22
v_mul_u32_u24 v23, 40960, v23
v_add_u32 v23, 16384, v23
v_add_u32 v48, v48, v23
v_and_b32 v23, 1, v22
v_bfe_u32 v24, v21, 2, 1
v_lshl_add_u32 v23, v23, 1, v24
v_xor_b32 v24, 3, v23
v_lshlrev_b32 v24, 6, v24
v_lshl_add_u32 v49, v23, 8, v24
v_and_b32 v23, 3, v21
v_lshl_add_u32 v49, v23, 4, v49
v_and_b32 v23, 8, v21
v_add_u32 v49, v49, v23
v_lshrrev_b32 v23, 1, v22
v_mul_u32_u24 v23, 32768, v23
v_add_u32 v23, 98304, v23
v_add_u32 v49, v49, v23
v_bfe_u32 v23, v21, 1, 1
v_and_b32 v24, 1, v21
v_lshl_add_u32 v23, v24, 16, v23
v_mul_u32_u24 v23, 0xaaaa, v23
v_add_u32 v0, 0x44444444, v23
v_lshlrev_b32 v3, 3, v20
v_lshrrev_b32 v25, 5, v20
v_lshlrev_b32 v25, 6, v25
v_xor_b32 v3, v3, v25
v_lshrrev_b32 v25, 2, v20
v_and_b32 v4, 3, v21
v_lshl_add_u32 v4, v4, 4, v25
v_lshlrev_b32 v4, 3, v4
v_bfe_u32 v25, v21, 1, 1
v_lshlrev_b32 v23, 6, v25
v_xor_b32 v4, v4, v23
v_and_b32 v23, 2, v22
v_xor_b32 v5, v21, v23
v_lshlrev_b32 v5, 4, v5
v_lshl_add_u32 v5, v25, 10, v5
v_and_b32 v23, 1, v22
v_lshl_add_u32 v5, v23, 3, v5
v_lshlrev_b32 v9, 8, v22
v_lshl_add_u32 v9, v25, 6, v9
v_bfe_u32 v23, v21, 3, 1
v_lshl_add_u32 v9, v23, 7, v9
v_bfe_u32 v23, v21, 2, 1
v_lshl_add_u32 v9, v23, 5, v9
v_and_b32 v23, 1, v21
v_lshl_add_u32 v9, v23, 4, v9
v_lshrrev_b32 v23, 1, v22
v_and_b32 v24, 1, v22
v_and_b32 v25, 7, v21
v_lshrrev_b32 v7, 3, v21
v_lshl_add_u32 v8, v7, 1, v23
v_lshlrev_b32 v8, 12, v8
v_lshl_add_u32 v8, v24, 7, v8
v_and_b32 v25, 4, v21
v_lshl_add_u32 v8, v25, 3, v8
v_and_b32 v25, 1, v21
v_lshl_add_u32 v8, v25, 4, v8
v_bfe_u32 v25, v21, 1, 1
v_lshl_add_u32 v8, v25, 3, v8
s_lshr_b32 s56, s32, 1
s_lshl_b32 s56, s56, 8
s_and_b32 s57, s32, 1
s_lshl_b32 s57, s57, 6
s_add_u32 s56, s56, s57
s_add_u32 s56, s56, 49152
v_add_u32 v8, s56, v8
v_and_b32 v7, 12, v21
v_bfe_u32 v25, v21, 1, 1
v_add_u32 v7, v7, v25
v_lshlrev_b32 v7, 4, v7
v_lshl_add_u32 v7, v22, 8, v7
s_mov_b32 s42, 0
s_mov_b32 s43, 65536
s_mov_b32 s44, 131072
s_mov_b32 s45, 196608
s_mov_b32 s46, 262144
s_mov_b32 s47, 294912
s_mov_b32 s48, 299008
s_mov_b32 s49, 303104
s_mov_b32 s50, 0x3e0293ee
s_mov_b32 s51, 0x3e0293ee
s_mov_b32 s52, 0x3f803f80
s_mov_b32 s53, 0x3f803f80
v_and_b32 v11, 3, v21
v_cmp_eq_u32 vcc, 0, v11
s_nop 1
v_cndmask_b32 v11, 0, 1, vcc
s_mov_b32 s34, 0
s_mov_b32 s35, -1
s_mov_b32 s36, 0
s_mov_b32 s41, 300000
s_lshl_b32 s37, s32, 14
s_add_u32 s39, s37, 17313792
s_add_u32 s37, s37, 16789504
s_mov_b32 s40, 8749056
v_mov_b64 v[36:37], 0
v_mov_b64 v[38:39], 0
s_lshl_b32 s56, s32, 1
s_add_u32 s56, s56, 1
s_cmp_eq_u32 s56, 0
s_cselect_b32 s56, 64, s56
s_mul_i32 s56, s56, 10240
s_add_u32 s56, s56, 8392704
s_add_u32 s57, s56, 4096
v_mov_b32 v40, 1
v_mov_b32 v41, 1
v_mov_b32 v42, 1
v_mov_b32 v43, 1
buffer_store_dwordx4 v[40:43], v1, s[4:7], s56 offen offset:0 sc0 sc1
buffer_store_dwordx4 v[40:43], v1, s[4:7], s56 offen offset:1024 sc0 sc1
buffer_store_dwordx4 v[40:43], v1, s[4:7], s56 offen offset:2048 sc0 sc1
buffer_store_dwordx4 v[40:43], v1, s[4:7], s56 offen offset:3072 sc0 sc1
buffer_store_dwordx4 v[40:43], v1, s[4:7], s57 offen offset:0 sc0 sc1
s_add_u32 s56, s32, 32
s_lshl_b32 s3, s56, 12
v_and_b32 v23, 1, v21
v_bfe_u32 v24, v21, 2, 1
v_bfe_u32 v25, v21, 1, 1
s_lshl_b32 s57, s56, 7
s_add_u32 s57, s57, 294912
v_and_b32 v10, 7, v21
v_lshlrev_b32 v10, 2, v10
v_lshl_add_u32 v10, v22, 5, v10
v_add_u32 v10, s57, v10
s_lshl_b32 s33, s56, 2
s_add_u32 s33, s33, 304128
v_mov_b32 v30, -1
s_mov_b64 exec, 1
buffer_store_dword v30, v1, s[4:7], s33 offen sc0 sc1
s_mov_b64 exec, -1
v_lshl_add_u32 v23, v23, 1, v24
v_lshlrev_b32 v25, 4, v25
v_mov_b32 v24, 0x3f80
v_lshlrev_b32 v24, v25, v24
v_cmp_eq_u32 vcc, 0, v23
s_nop 1
v_cndmask_b32 v76, 0, v24, vcc
v_cmp_eq_u32 vcc, 1, v23
s_nop 1
v_cndmask_b32 v77, 0, v24, vcc
v_cmp_eq_u32 vcc, 2, v23
s_nop 1
v_cndmask_b32 v78, 0, v24, vcc
v_cmp_eq_u32 vcc, 3, v23
s_nop 1
v_cndmask_b32 v79, 0, v24, vcc
buffer_store_dwordx4 v[36:39], v9, s[4:7], s3 offen offset:0 sc0 sc1
buffer_store_dwordx4 v[36:39], v9, s[4:7], s3 offen offset:1024 sc0 sc1
buffer_store_dwordx4 v[36:39], v9, s[4:7], s3 offen offset:2048 sc0 sc1
buffer_store_dwordx4 v[36:39], v9, s[4:7], s3 offen offset:3072 sc0 sc1
s_getreg_b32 s56, hwreg(HW_REG_XCC_ID)
s_and_b32 s56, s56, 15
s_mul_i32 s57, s56, s56
s_lshl_b32 s57, s57, 18
s_lshl_b32 s56, s56, 8
s_add_u32 s57, s57, s56
s_add_u32 s58, s57, 1
s_lshl_b32 s101, s32, 7
s_add_u32 s101, s101, 327680
v_mov_b32 v24, 0
s_add_u32 s56, s54, 3014656
s_mov_b32 m0, 159744
s_nop 0
buffer_load_dwordx4 v26, s[8:11], s56 offen lds
s_add_u32 s56, s54, 3031040
s_mov_b32 m0, 160768
s_nop 0
buffer_load_dwordx4 v26, s[8:11], s56 offen lds
s_add_u32 s56, s54, 3047424
s_mov_b32 m0, 161792
s_nop 0
buffer_load_dwordx4 v27, s[8:11], s56 offen lds
s_add_u32 s56, s54, 3063808
s_mov_b32 m0, 162816
s_nop 0
buffer_load_dwordx4 v27, s[8:11], s56 offen lds
s_add_u32 s56, s54, 3538944
s_mov_b32 m0, 131072
s_nop 0
buffer_load_dwordx4 v26, s[8:11], s56 offen lds
s_add_u32 s56, s54, 3555328
s_mov_b32 m0, 132096
s_nop 0
buffer_load_dwordx4 v26, s[8:11], s56 offen lds
s_add_u32 s56, s54, 3571712
s_mov_b32 m0, 133120
s_nop 0
buffer_load_dwordx4 v27, s[8:11], s56 offen lds
s_add_u32 s56, s54, 3588096
s_mov_b32 m0, 134144
s_nop 0
buffer_load_dwordx4 v27, s[8:11], s56 offen lds
s_add_u32 s56, s54, 4063232
s_mov_b32 m0, 135168
s_nop 0
buffer_load_dwordx4 v26, s[8:11], s56 offen lds
s_add_u32 s56, s54, 4079616
s_mov_b32 m0, 136192
s_nop 0
buffer_load_dwordx4 v26, s[8:11], s56 offen lds
s_add_u32 s56, s54, 4096000
s_mov_b32 m0, 137216
s_nop 0
buffer_load_dwordx4 v27, s[8:11], s56 offen lds
s_add_u32 s56, s54, 4112384
s_mov_b32 m0, 138240
s_nop 0
buffer_load_dwordx4 v27, s[8:11], s56 offen lds
s_add_u32 s56, s54, 4587520
s_mov_b32 m0, 139264
s_nop 0
buffer_load_dwordx4 v26, s[8:11], s56 offen lds
s_add_u32 s56, s54, 4603904
s_mov_b32 m0, 140288
s_nop 0
buffer_load_dwordx4 v26, s[8:11], s56 offen lds
s_add_u32 s56, s54, 4620288
s_mov_b32 m0, 141312
s_nop 0
buffer_load_dwordx4 v27, s[8:11], s56 offen lds
s_add_u32 s56, s54, 4636672
s_mov_b32 m0, 142336
s_nop 0
buffer_load_dwordx4 v27, s[8:11], s56 offen lds
s_add_u32 s56, s54, 393216
s_mov_b32 m0, 143360
s_nop 0
buffer_load_dwordx4 v26, s[12:15], s56 offen lds
s_add_u32 s56, s54, 409600
s_mov_b32 m0, 144384
s_nop 0
buffer_load_dwordx4 v26, s[12:15], s56 offen lds
s_add_u32 s56, s54, 425984
s_mov_b32 m0, 145408
s_nop 0
buffer_load_dwordx4 v27, s[12:15], s56 offen lds
s_add_u32 s56, s54, 442368
s_mov_b32 m0, 146432
s_nop 0
buffer_load_dwordx4 v27, s[12:15], s56 offen lds
s_add_u32 s56, s54, 917504
s_mov_b32 m0, 147456
s_nop 0
buffer_load_dwordx4 v26, s[12:15], s56 offen lds
s_add_u32 s56, s54, 933888
s_mov_b32 m0, 148480
s_nop 0
buffer_load_dwordx4 v26, s[12:15], s56 offen lds
s_add_u32 s56, s54, 950272
s_mov_b32 m0, 149504
s_nop 0
buffer_load_dwordx4 v27, s[12:15], s56 offen lds
s_add_u32 s56, s54, 966656
s_mov_b32 m0, 150528
s_nop 0
buffer_load_dwordx4 v27, s[12:15], s56 offen lds
v_mov_b32 v24, 0
s_waitcnt vmcnt(38)
s_barrier
ds_read_b64_tr_b16 v[80:81], v44 offset:20480
ds_read_b64_tr_b16 v[82:83], v44 offset:21504
ds_read_b64_tr_b16 v[84:85], v46 offset:20480
ds_read_b64_tr_b16 v[86:87], v46 offset:21504
ds_read_b64_tr_b16 v[88:89], v45 offset:20480
ds_read_b64_tr_b16 v[90:91], v45 offset:21504
ds_read_b64_tr_b16 v[92:93], v47 offset:20480
ds_read_b64_tr_b16 v[94:95], v47 offset:21504
s_waitcnt lgkmcnt(0)
s_waitcnt vmcnt(34)
s_barrier
s_add_u32 s56, s54, 1441792
s_mov_b32 m0, 151552
s_nop 0
buffer_load_dwordx4 v26, s[12:15], s56 offen lds
s_add_u32 s56, s54, 1458176
s_mov_b32 m0, 152576
s_nop 0
buffer_load_dwordx4 v26, s[12:15], s56 offen lds
s_add_u32 s56, s54, 1474560
s_mov_b32 m0, 153600
s_nop 0
buffer_load_dwordx4 v27, s[12:15], s56 offen lds
s_add_u32 s56, s54, 1490944
s_mov_b32 m0, 154624
s_nop 0
buffer_load_dwordx4 v27, s[12:15], s56 offen lds
ds_read_b64_tr_b16 v[96:97], v44 offset:24576
ds_read_b64_tr_b16 v[98:99], v44 offset:25600
ds_read_b64_tr_b16 v[100:101], v46 offset:24576
ds_read_b64_tr_b16 v[102:103], v46 offset:25600
ds_read_b64_tr_b16 v[104:105], v45 offset:24576
ds_read_b64_tr_b16 v[106:107], v45 offset:25600
ds_read_b64_tr_b16 v[108:109], v47 offset:24576
ds_read_b64_tr_b16 v[110:111], v47 offset:25600
s_waitcnt lgkmcnt(0)
s_waitcnt vmcnt(24)
s_barrier
s_add_u32 s56, s54, 1966080
s_mov_b32 m0, 155648
s_nop 0
buffer_load_dwordx4 v26, s[12:15], s56 offen lds
s_add_u32 s56, s54, 1982464
s_mov_b32 m0, 156672
s_nop 0
buffer_load_dwordx4 v26, s[12:15], s56 offen lds
s_add_u32 s56, s54, 1998848
s_mov_b32 m0, 157696
s_nop 0
buffer_load_dwordx4 v27, s[12:15], s56 offen lds
s_add_u32 s56, s54, 2015232
s_mov_b32 m0, 158720
s_nop 0
buffer_load_dwordx4 v27, s[12:15], s56 offen lds
ds_read_b64_tr_b16 v[112:113], v44 offset:28672
ds_read_b64_tr_b16 v[114:115], v44 offset:29696
ds_read_b64_tr_b16 v[116:117], v46 offset:28672
ds_read_b64_tr_b16 v[118:119], v46 offset:29696
ds_read_b64_tr_b16 v[120:121], v45 offset:28672
ds_read_b64_tr_b16 v[122:123], v45 offset:29696
ds_read_b64_tr_b16 v[124:125], v47 offset:28672
ds_read_b64_tr_b16 v[126:127], v47 offset:29696
s_waitcnt lgkmcnt(0)
s_waitcnt vmcnt(24)
s_barrier
s_add_u32 s56, s54, 2490368
s_mov_b32 m0, 159744
s_nop 0
buffer_load_dwordx4 v26, s[12:15], s56 offen lds
s_add_u32 s56, s54, 2506752
s_mov_b32 m0, 160768
s_nop 0
buffer_load_dwordx4 v26, s[12:15], s56 offen lds
s_add_u32 s56, s54, 2523136
s_mov_b32 m0, 161792
s_nop 0
buffer_load_dwordx4 v27, s[12:15], s56 offen lds
s_add_u32 s56, s54, 2539520
s_mov_b32 m0, 162816
s_nop 0
buffer_load_dwordx4 v27, s[12:15], s56 offen lds
ds_read_b64_tr_b16 v[128:129], v44 offset:0
ds_read_b64_tr_b16 v[130:131], v44 offset:1024
ds_read_b64_tr_b16 v[132:133], v46 offset:0
ds_read_b64_tr_b16 v[134:135], v46 offset:1024
ds_read_b64_tr_b16 v[136:137], v45 offset:0
ds_read_b64_tr_b16 v[138:139], v45 offset:1024
ds_read_b64_tr_b16 v[140:141], v47 offset:0
ds_read_b64_tr_b16 v[142:143], v47 offset:1024
s_waitcnt lgkmcnt(0)
s_waitcnt vmcnt(24)
s_barrier
s_add_u32 s56, s54, 3538944
s_mov_b32 m0, 131072
s_nop 0
buffer_load_dwordx4 v26, s[12:15], s56 offen lds
s_add_u32 s56, s54, 3555328
s_mov_b32 m0, 132096
s_nop 0
buffer_load_dwordx4 v26, s[12:15], s56 offen lds
s_add_u32 s56, s54, 3571712
s_mov_b32 m0, 133120
s_nop 0
buffer_load_dwordx4 v27, s[12:15], s56 offen lds
s_add_u32 s56, s54, 3588096
s_mov_b32 m0, 134144
s_nop 0
buffer_load_dwordx4 v27, s[12:15], s56 offen lds
ds_read_b64_tr_b16 v[144:145], v44 offset:4096
ds_read_b64_tr_b16 v[146:147], v44 offset:5120
ds_read_b64_tr_b16 v[148:149], v46 offset:4096
ds_read_b64_tr_b16 v[150:151], v46 offset:5120
ds_read_b64_tr_b16 v[152:153], v45 offset:4096
ds_read_b64_tr_b16 v[154:155], v45 offset:5120
ds_read_b64_tr_b16 v[156:157], v47 offset:4096
ds_read_b64_tr_b16 v[158:159], v47 offset:5120
s_waitcnt lgkmcnt(0)
s_waitcnt vmcnt(24)
s_barrier
s_add_u32 s56, s54, 4063232
s_mov_b32 m0, 135168
s_nop 0
buffer_load_dwordx4 v26, s[12:15], s56 offen lds
s_add_u32 s56, s54, 4079616
s_mov_b32 m0, 136192
s_nop 0
buffer_load_dwordx4 v26, s[12:15], s56 offen lds
s_add_u32 s56, s54, 4096000
s_mov_b32 m0, 137216
s_nop 0
buffer_load_dwordx4 v27, s[12:15], s56 offen lds
s_add_u32 s56, s54, 4112384
s_mov_b32 m0, 138240
s_nop 0
buffer_load_dwordx4 v27, s[12:15], s56 offen lds
ds_read_b64_tr_b16 v[160:161], v44 offset:8192
ds_read_b64_tr_b16 v[162:163], v44 offset:9216
ds_read_b64_tr_b16 v[164:165], v46 offset:8192
ds_read_b64_tr_b16 v[166:167], v46 offset:9216
ds_read_b64_tr_b16 v[168:169], v45 offset:8192
ds_read_b64_tr_b16 v[170:171], v45 offset:9216
ds_read_b64_tr_b16 v[172:173], v47 offset:8192
ds_read_b64_tr_b16 v[174:175], v47 offset:9216
s_waitcnt lgkmcnt(0)
s_waitcnt vmcnt(24)
s_barrier
s_add_u32 s56, s54, 4587520
s_mov_b32 m0, 139264
s_nop 0
buffer_load_dwordx4 v26, s[12:15], s56 offen lds
s_add_u32 s56, s54, 4603904
s_mov_b32 m0, 140288
s_nop 0
buffer_load_dwordx4 v26, s[12:15], s56 offen lds
s_add_u32 s56, s54, 4620288
s_mov_b32 m0, 141312
s_nop 0
buffer_load_dwordx4 v27, s[12:15], s56 offen lds
s_add_u32 s56, s54, 4636672
s_mov_b32 m0, 142336
s_nop 0
buffer_load_dwordx4 v27, s[12:15], s56 offen lds
ds_read_b64_tr_b16 v[176:177], v44 offset:12288
ds_read_b64_tr_b16 v[178:179], v44 offset:13312
ds_read_b64_tr_b16 v[180:181], v46 offset:12288
ds_read_b64_tr_b16 v[182:183], v46 offset:13312
ds_read_b64_tr_b16 v[184:185], v45 offset:12288
ds_read_b64_tr_b16 v[186:187], v45 offset:13312
ds_read_b64_tr_b16 v[188:189], v47 offset:12288
ds_read_b64_tr_b16 v[190:191], v47 offset:13312
s_waitcnt lgkmcnt(0)
s_waitcnt vmcnt(24)
s_barrier
s_add_u32 s56, s54, 393216
s_mov_b32 m0, 143360
s_nop 0
buffer_load_dwordx4 v26, s[16:19], s56 offen lds
s_add_u32 s56, s54, 409600
s_mov_b32 m0, 144384
s_nop 0
buffer_load_dwordx4 v26, s[16:19], s56 offen lds
s_add_u32 s56, s54, 425984
s_mov_b32 m0, 145408
s_nop 0
buffer_load_dwordx4 v27, s[16:19], s56 offen lds
s_add_u32 s56, s54, 442368
s_mov_b32 m0, 146432
s_nop 0
buffer_load_dwordx4 v27, s[16:19], s56 offen lds
ds_read_b64_tr_b16 v[192:193], v44 offset:16384
ds_read_b64_tr_b16 v[194:195], v44 offset:17408
ds_read_b64_tr_b16 v[196:197], v46 offset:16384
ds_read_b64_tr_b16 v[198:199], v46 offset:17408
ds_read_b64_tr_b16 v[200:201], v45 offset:16384
ds_read_b64_tr_b16 v[202:203], v45 offset:17408
ds_read_b64_tr_b16 v[204:205], v47 offset:16384
ds_read_b64_tr_b16 v[206:207], v47 offset:17408
s_waitcnt lgkmcnt(0)
s_waitcnt vmcnt(24)
s_barrier
s_add_u32 s56, s54, 917504
s_mov_b32 m0, 147456
s_nop 0
buffer_load_dwordx4 v26, s[16:19], s56 offen lds
s_add_u32 s56, s54, 933888
s_mov_b32 m0, 148480
s_nop 0
buffer_load_dwordx4 v26, s[16:19], s56 offen lds
s_add_u32 s56, s54, 950272
s_mov_b32 m0, 149504
s_nop 0
buffer_load_dwordx4 v27, s[16:19], s56 offen lds
s_add_u32 s56, s54, 966656
s_mov_b32 m0, 150528
s_nop 0
buffer_load_dwordx4 v27, s[16:19], s56 offen lds
ds_read_b64_tr_b16 v[208:209], v44 offset:20480
ds_read_b64_tr_b16 v[210:211], v44 offset:21504
ds_read_b64_tr_b16 v[212:213], v46 offset:20480
ds_read_b64_tr_b16 v[214:215], v46 offset:21504
ds_read_b64_tr_b16 v[216:217], v45 offset:20480
ds_read_b64_tr_b16 v[218:219], v45 offset:21504
ds_read_b64_tr_b16 v[220:221], v47 offset:20480
ds_read_b64_tr_b16 v[222:223], v47 offset:21504
s_waitcnt lgkmcnt(0)
s_waitcnt vmcnt(24)
s_barrier
s_add_u32 s56, s54, 1441792
s_mov_b32 m0, 151552
s_nop 0
buffer_load_dwordx4 v26, s[16:19], s56 offen lds
s_add_u32 s56, s54, 1458176
s_mov_b32 m0, 152576
s_nop 0
buffer_load_dwordx4 v26, s[16:19], s56 offen lds
s_add_u32 s56, s54, 1474560
s_mov_b32 m0, 153600
s_nop 0
buffer_load_dwordx4 v27, s[16:19], s56 offen lds
s_add_u32 s56, s54, 1490944
s_mov_b32 m0, 154624
s_nop 0
buffer_load_dwordx4 v27, s[16:19], s56 offen lds
ds_read_b64_tr_b16 v[224:225], v44 offset:24576
ds_read_b64_tr_b16 v[226:227], v44 offset:25600
ds_read_b64_tr_b16 v[228:229], v46 offset:24576
ds_read_b64_tr_b16 v[230:231], v46 offset:25600
ds_read_b64_tr_b16 v[232:233], v45 offset:24576
ds_read_b64_tr_b16 v[234:235], v45 offset:25600
ds_read_b64_tr_b16 v[236:237], v47 offset:24576
ds_read_b64_tr_b16 v[238:239], v47 offset:25600
s_waitcnt lgkmcnt(0)
s_waitcnt vmcnt(24)
s_barrier
s_add_u32 s56, s54, 1966080
s_mov_b32 m0, 155648
s_nop 0
buffer_load_dwordx4 v26, s[16:19], s56 offen lds
s_add_u32 s56, s54, 1982464
s_mov_b32 m0, 156672
s_nop 0
buffer_load_dwordx4 v26, s[16:19], s56 offen lds
s_add_u32 s56, s54, 1998848
s_mov_b32 m0, 157696
s_nop 0
buffer_load_dwordx4 v27, s[16:19], s56 offen lds
s_add_u32 s56, s54, 2015232
s_mov_b32 m0, 158720
s_nop 0
buffer_load_dwordx4 v27, s[16:19], s56 offen lds
ds_read_b64_tr_b16 v[240:241], v44 offset:28672
ds_read_b64_tr_b16 v[242:243], v44 offset:29696
ds_read_b64_tr_b16 v[244:245], v46 offset:28672
ds_read_b64_tr_b16 v[246:247], v46 offset:29696
ds_read_b64_tr_b16 v[248:249], v45 offset:28672
ds_read_b64_tr_b16 v[250:251], v45 offset:29696
ds_read_b64_tr_b16 v[252:253], v47 offset:28672
ds_read_b64_tr_b16 v[254:255], v47 offset:29696
s_waitcnt lgkmcnt(0)
s_waitcnt vmcnt(24)
s_barrier
s_add_u32 s56, s54, 2490368
s_mov_b32 m0, 159744
s_nop 0
buffer_load_dwordx4 v26, s[16:19], s56 offen lds
s_add_u32 s56, s54, 2506752
s_mov_b32 m0, 160768
s_nop 0
buffer_load_dwordx4 v26, s[16:19], s56 offen lds
s_add_u32 s56, s54, 2523136
s_mov_b32 m0, 161792
s_nop 0
buffer_load_dwordx4 v27, s[16:19], s56 offen lds
s_add_u32 s56, s54, 2539520
s_mov_b32 m0, 162816
s_nop 0
buffer_load_dwordx4 v27, s[16:19], s56 offen lds
ds_read_b64_tr_b16 a[0:1], v44 offset:0
ds_read_b64_tr_b16 a[2:3], v44 offset:1024
ds_read_b64_tr_b16 a[4:5], v46 offset:0
ds_read_b64_tr_b16 a[6:7], v46 offset:1024
ds_read_b64_tr_b16 a[8:9], v45 offset:0
ds_read_b64_tr_b16 a[10:11], v45 offset:1024
ds_read_b64_tr_b16 a[12:13], v47 offset:0
ds_read_b64_tr_b16 a[14:15], v47 offset:1024
s_waitcnt lgkmcnt(0)
s_waitcnt vmcnt(24)
s_barrier
s_add_u32 s56, s54, 3014656
s_mov_b32 m0, 131072
s_nop 0
buffer_load_dwordx4 v26, s[16:19], s56 offen lds
s_add_u32 s56, s54, 3031040
s_mov_b32 m0, 132096
s_nop 0
buffer_load_dwordx4 v26, s[16:19], s56 offen lds
s_add_u32 s56, s54, 3047424
s_mov_b32 m0, 133120
s_nop 0
buffer_load_dwordx4 v27, s[16:19], s56 offen lds
s_add_u32 s56, s54, 3063808
s_mov_b32 m0, 134144
s_nop 0
buffer_load_dwordx4 v27, s[16:19], s56 offen lds
ds_read_b64_tr_b16 a[16:17], v44 offset:4096
ds_read_b64_tr_b16 a[18:19], v44 offset:5120
ds_read_b64_tr_b16 a[20:21], v46 offset:4096
ds_read_b64_tr_b16 a[22:23], v46 offset:5120
ds_read_b64_tr_b16 a[24:25], v45 offset:4096
ds_read_b64_tr_b16 a[26:27], v45 offset:5120
ds_read_b64_tr_b16 a[28:29], v47 offset:4096
ds_read_b64_tr_b16 a[30:31], v47 offset:5120
s_waitcnt lgkmcnt(0)
s_waitcnt vmcnt(24)
s_barrier
s_add_u32 s56, s54, 3538944
s_mov_b32 m0, 135168
s_nop 0
buffer_load_dwordx4 v26, s[16:19], s56 offen lds
s_add_u32 s56, s54, 3555328
s_mov_b32 m0, 136192
s_nop 0
buffer_load_dwordx4 v26, s[16:19], s56 offen lds
s_add_u32 s56, s54, 3571712
s_mov_b32 m0, 137216
s_nop 0
buffer_load_dwordx4 v27, s[16:19], s56 offen lds
s_add_u32 s56, s54, 3588096
s_mov_b32 m0, 138240
s_nop 0
buffer_load_dwordx4 v27, s[16:19], s56 offen lds
ds_read_b64_tr_b16 a[32:33], v44 offset:8192
ds_read_b64_tr_b16 a[34:35], v44 offset:9216
ds_read_b64_tr_b16 a[36:37], v46 offset:8192
ds_read_b64_tr_b16 a[38:39], v46 offset:9216
ds_read_b64_tr_b16 a[40:41], v45 offset:8192
ds_read_b64_tr_b16 a[42:43], v45 offset:9216
ds_read_b64_tr_b16 a[44:45], v47 offset:8192
ds_read_b64_tr_b16 a[46:47], v47 offset:9216
s_waitcnt lgkmcnt(0)
s_waitcnt vmcnt(24)
s_barrier
s_add_u32 s56, s54, 4063232
s_mov_b32 m0, 139264
s_nop 0
buffer_load_dwordx4 v26, s[16:19], s56 offen lds
s_add_u32 s56, s54, 4079616
s_mov_b32 m0, 140288
s_nop 0
buffer_load_dwordx4 v26, s[16:19], s56 offen lds
s_add_u32 s56, s54, 4096000
s_mov_b32 m0, 141312
s_nop 0
buffer_load_dwordx4 v27, s[16:19], s56 offen lds
s_add_u32 s56, s54, 4112384
s_mov_b32 m0, 142336
s_nop 0
buffer_load_dwordx4 v27, s[16:19], s56 offen lds
ds_read_b64_tr_b16 a[48:49], v44 offset:12288
ds_read_b64_tr_b16 a[50:51], v44 offset:13312
ds_read_b64_tr_b16 a[52:53], v46 offset:12288
ds_read_b64_tr_b16 a[54:55], v46 offset:13312
ds_read_b64_tr_b16 a[56:57], v45 offset:12288
ds_read_b64_tr_b16 a[58:59], v45 offset:13312
ds_read_b64_tr_b16 a[60:61], v47 offset:12288
ds_read_b64_tr_b16 a[62:63], v47 offset:13312
s_waitcnt lgkmcnt(0)
s_waitcnt vmcnt(24)
s_barrier
s_add_u32 s56, s55, 115200
s_mov_b32 m0, 143360
s_nop 0
buffer_load_dwordx4 v28, s[20:23], s56 offen lds
s_add_u32 s56, s55, 117504
s_mov_b32 m0, 144384
s_nop 0
buffer_load_dwordx4 v28, s[20:23], s56 offen lds
s_add_u32 s56, s55, 124416
s_mov_b32 m0, 145408
s_nop 0
buffer_load_dwordx4 v28, s[20:23], s56 offen lds
s_add_u32 s56, s55, 126720
s_mov_b32 m0, 146432
s_nop 0
buffer_load_dwordx4 v28, s[20:23], s56 offen lds
ds_read_b64_tr_b16 a[64:65], v44 offset:16384
ds_read_b64_tr_b16 a[66:67], v44 offset:17408
ds_read_b64_tr_b16 a[68:69], v46 offset:16384
ds_read_b64_tr_b16 a[70:71], v46 offset:17408
ds_read_b64_tr_b16 a[72:73], v45 offset:16384
ds_read_b64_tr_b16 a[74:75], v45 offset:17408
ds_read_b64_tr_b16 a[76:77], v47 offset:16384
ds_read_b64_tr_b16 a[78:79], v47 offset:17408
s_waitcnt lgkmcnt(0)
s_waitcnt vmcnt(24)
s_barrier
s_add_u32 s56, s55, 115456
s_mov_b32 m0, 147456
s_nop 0
buffer_load_dwordx4 v28, s[20:23], s56 offen lds
s_add_u32 s56, s55, 117760
s_mov_b32 m0, 148480
s_nop 0
buffer_load_dwordx4 v28, s[20:23], s56 offen lds
s_add_u32 s56, s55, 124672
s_mov_b32 m0, 149504
s_nop 0
buffer_load_dwordx4 v28, s[20:23], s56 offen lds
s_add_u32 s56, s55, 126976
s_mov_b32 m0, 150528
s_nop 0
buffer_load_dwordx4 v28, s[20:23], s56 offen lds
ds_read_b64_tr_b16 a[80:81], v44 offset:20480
ds_read_b64_tr_b16 a[82:83], v44 offset:21504
ds_read_b64_tr_b16 a[84:85], v46 offset:20480
ds_read_b64_tr_b16 a[86:87], v46 offset:21504
ds_read_b64_tr_b16 a[88:89], v45 offset:20480
ds_read_b64_tr_b16 a[90:91], v45 offset:21504
ds_read_b64_tr_b16 a[92:93], v47 offset:20480
ds_read_b64_tr_b16 a[94:95], v47 offset:21504
s_waitcnt lgkmcnt(0)
s_waitcnt vmcnt(24)
s_barrier
s_add_u32 s56, s55, 115712
s_mov_b32 m0, 151552
s_nop 0
buffer_load_dwordx4 v28, s[20:23], s56 offen lds
s_add_u32 s56, s55, 118016
s_mov_b32 m0, 152576
s_nop 0
buffer_load_dwordx4 v28, s[20:23], s56 offen lds
s_add_u32 s56, s55, 124928
s_mov_b32 m0, 153600
s_nop 0
buffer_load_dwordx4 v28, s[20:23], s56 offen lds
s_add_u32 s56, s55, 127232
s_mov_b32 m0, 154624
s_nop 0
buffer_load_dwordx4 v28, s[20:23], s56 offen lds
ds_read_b64_tr_b16 a[96:97], v44 offset:24576
ds_read_b64_tr_b16 a[98:99], v44 offset:25600
ds_read_b64_tr_b16 a[100:101], v46 offset:24576
ds_read_b64_tr_b16 a[102:103], v46 offset:25600
ds_read_b64_tr_b16 a[104:105], v45 offset:24576
ds_read_b64_tr_b16 a[106:107], v45 offset:25600
ds_read_b64_tr_b16 a[108:109], v47 offset:24576
ds_read_b64_tr_b16 a[110:111], v47 offset:25600
s_waitcnt lgkmcnt(0)
s_waitcnt vmcnt(24)
s_barrier
s_add_u32 s56, s55, 115968
s_mov_b32 m0, 155648
s_nop 0
buffer_load_dwordx4 v28, s[20:23], s56 offen lds
s_add_u32 s56, s55, 118272
s_mov_b32 m0, 156672
s_nop 0
buffer_load_dwordx4 v28, s[20:23], s56 offen lds
s_add_u32 s56, s55, 125184
s_mov_b32 m0, 157696
s_nop 0
buffer_load_dwordx4 v28, s[20:23], s56 offen lds
s_add_u32 s56, s55, 127488
s_mov_b32 m0, 158720
s_nop 0
buffer_load_dwordx4 v28, s[20:23], s56 offen lds
ds_read_b64_tr_b16 a[112:113], v44 offset:28672
ds_read_b64_tr_b16 a[114:115], v44 offset:29696
ds_read_b64_tr_b16 a[116:117], v46 offset:28672
ds_read_b64_tr_b16 a[118:119], v46 offset:29696
ds_read_b64_tr_b16 a[120:121], v45 offset:28672
ds_read_b64_tr_b16 a[122:123], v45 offset:29696
ds_read_b64_tr_b16 a[124:125], v47 offset:28672
ds_read_b64_tr_b16 a[126:127], v47 offset:29696
s_waitcnt lgkmcnt(0)
s_waitcnt vmcnt(24)
s_barrier
s_add_u32 s56, s55, 79104
s_mov_b32 m0, 159744
s_nop 0
buffer_load_dwordx4 v28, s[20:23], s56 offen lds
s_add_u32 s56, s55, 81408
s_mov_b32 m0, 160768
s_nop 0
buffer_load_dwordx4 v28, s[20:23], s56 offen lds
s_add_u32 s56, s55, 88320
s_mov_b32 m0, 161792
s_nop 0
buffer_load_dwordx4 v28, s[20:23], s56 offen lds
s_add_u32 s56, s55, 90624
s_mov_b32 m0, 162816
s_nop 0
buffer_load_dwordx4 v28, s[20:23], s56 offen lds
ds_read_b64_tr_b16 a[128:129], v44 offset:0
ds_read_b64_tr_b16 a[130:131], v44 offset:1024
ds_read_b64_tr_b16 a[132:133], v46 offset:0
ds_read_b64_tr_b16 a[134:135], v46 offset:1024
ds_read_b64_tr_b16 a[136:137], v45 offset:0
ds_read_b64_tr_b16 a[138:139], v45 offset:1024
ds_read_b64_tr_b16 a[140:141], v47 offset:0
ds_read_b64_tr_b16 a[142:143], v47 offset:1024
buffer_load_dword v32, v24, s[28:31], 0 offen sc0 sc1
s_waitcnt lgkmcnt(0)
s_waitcnt vmcnt(25)
s_barrier
s_add_u32 s56, s54, 393216
s_mov_b32 m0, 131072
s_nop 0
buffer_load_dwordx4 v26, s[8:11], s56 offen lds
s_add_u32 s56, s54, 409600
s_mov_b32 m0, 132096
s_nop 0
buffer_load_dwordx4 v26, s[8:11], s56 offen lds
s_add_u32 s56, s54, 425984
s_mov_b32 m0, 133120
s_nop 0
buffer_load_dwordx4 v27, s[8:11], s56 offen lds
s_add_u32 s56, s54, 442368
s_mov_b32 m0, 134144
s_nop 0
buffer_load_dwordx4 v27, s[8:11], s56 offen lds
ds_read_b64_tr_b16 a[144:145], v44 offset:4096
ds_read_b64_tr_b16 a[146:147], v44 offset:5120
ds_read_b64_tr_b16 a[148:149], v46 offset:4096
ds_read_b64_tr_b16 a[150:151], v46 offset:5120
ds_read_b64_tr_b16 a[152:153], v45 offset:4096
ds_read_b64_tr_b16 a[154:155], v45 offset:5120
ds_read_b64_tr_b16 a[156:157], v47 offset:4096
ds_read_b64_tr_b16 a[158:159], v47 offset:5120
s_waitcnt lgkmcnt(0)
s_waitcnt vmcnt(25)
s_barrier
s_add_u32 s56, s54, 1966080
s_mov_b32 m0, 135168
s_nop 0
buffer_load_dwordx4 v26, s[8:11], s56 offen lds
s_add_u32 s56, s54, 1982464
s_mov_b32 m0, 136192
s_nop 0
buffer_load_dwordx4 v26, s[8:11], s56 offen lds
s_add_u32 s56, s54, 1998848
s_mov_b32 m0, 137216
s_nop 0
buffer_load_dwordx4 v27, s[8:11], s56 offen lds
s_add_u32 s56, s54, 2015232
s_mov_b32 m0, 138240
s_nop 0
buffer_load_dwordx4 v27, s[8:11], s56 offen lds
ds_read_b64_tr_b16 a[160:161], v44 offset:8192
ds_read_b64_tr_b16 a[162:163], v44 offset:9216
ds_read_b64_tr_b16 a[164:165], v46 offset:8192
ds_read_b64_tr_b16 a[166:167], v46 offset:9216
ds_read_b64_tr_b16 a[168:169], v45 offset:8192
ds_read_b64_tr_b16 a[170:171], v45 offset:9216
ds_read_b64_tr_b16 a[172:173], v47 offset:8192
ds_read_b64_tr_b16 a[174:175], v47 offset:9216
s_waitcnt lgkmcnt(0)
s_waitcnt vmcnt(25)
s_barrier
s_add_u32 s56, s54, 2490368
s_mov_b32 m0, 139264
s_nop 0
buffer_load_dwordx4 v26, s[8:11], s56 offen lds
s_add_u32 s56, s54, 2506752
s_mov_b32 m0, 140288
s_nop 0
buffer_load_dwordx4 v26, s[8:11], s56 offen lds
s_add_u32 s56, s54, 2523136
s_mov_b32 m0, 141312
s_nop 0
buffer_load_dwordx4 v27, s[8:11], s56 offen lds
s_add_u32 s56, s54, 2539520
s_mov_b32 m0, 142336
s_nop 0
buffer_load_dwordx4 v27, s[8:11], s56 offen lds
ds_read_b64_tr_b16 a[192:193], v48 offset:12288
ds_read_b64_tr_b16 a[194:195], v48 offset:13312
ds_read_b64_tr_b16 a[196:197], v48 offset:14336
ds_read_b64_tr_b16 a[198:199], v48 offset:15360
ds_read_b64_tr_b16 a[176:177], v49 offset:12288
ds_read_b64_tr_b16 a[178:179], v49 offset:13312
ds_read_b64_tr_b16 a[180:181], v49 offset:14336
ds_read_b64_tr_b16 a[182:183], v49 offset:15360
s_waitcnt lgkmcnt(0)
s_waitcnt vmcnt(25)
s_barrier
s_add_u32 s56, s54, 3014656
s_mov_b32 m0, 143360
s_nop 0
buffer_load_dwordx4 v26, s[12:15], s56 offen lds
s_add_u32 s56, s54, 3031040
s_mov_b32 m0, 144384
s_nop 0
buffer_load_dwordx4 v26, s[12:15], s56 offen lds
s_add_u32 s56, s54, 3047424
s_mov_b32 m0, 145408
s_nop 0
buffer_load_dwordx4 v27, s[12:15], s56 offen lds
s_add_u32 s56, s54, 3063808
s_mov_b32 m0, 146432
s_nop 0
buffer_load_dwordx4 v27, s[12:15], s56 offen lds
ds_read_b64_tr_b16 a[200:201], v48 offset:16384
ds_read_b64_tr_b16 a[202:203], v48 offset:17408
ds_read_b64_tr_b16 a[204:205], v48 offset:18432
ds_read_b64_tr_b16 a[206:207], v48 offset:19456
ds_read_b64_tr_b16 a[184:185], v49 offset:16384
ds_read_b64_tr_b16 a[186:187], v49 offset:17408
ds_read_b64_tr_b16 a[188:189], v49 offset:18432
ds_read_b64_tr_b16 a[190:191], v49 offset:19456
s_waitcnt lgkmcnt(0)
s_waitcnt vmcnt(25)
s_barrier
s_add_u32 s56, s54, 4587520
s_mov_b32 m0, 147456
s_nop 0
buffer_load_dwordx4 v26, s[16:19], s56 offen lds
s_add_u32 s56, s54, 4603904
s_mov_b32 m0, 148480
s_nop 0
buffer_load_dwordx4 v26, s[16:19], s56 offen lds
s_add_u32 s56, s54, 4620288
s_mov_b32 m0, 149504
s_nop 0
buffer_load_dwordx4 v27, s[16:19], s56 offen lds
s_add_u32 s56, s54, 4636672
s_mov_b32 m0, 150528
s_nop 0
buffer_load_dwordx4 v27, s[16:19], s56 offen lds
ds_read_b64_tr_b16 a[216:217], v48 offset:20480
ds_read_b64_tr_b16 a[218:219], v48 offset:21504
ds_read_b64_tr_b16 a[220:221], v48 offset:22528
ds_read_b64_tr_b16 a[222:223], v48 offset:23552
ds_read_b64_tr_b16 a[208:209], v49 offset:20480
ds_read_b64_tr_b16 a[210:211], v49 offset:21504
ds_read_b64_tr_b16 a[212:213], v49 offset:22528
ds_read_b64_tr_b16 a[214:215], v49 offset:23552
s_waitcnt lgkmcnt(0)
s_waitcnt vmcnt(25)
s_barrier
s_add_u32 s56, s55, 78336
s_mov_b32 m0, 151552
s_nop 0
buffer_load_dwordx4 v28, s[20:23], s56 offen lds
s_add_u32 s56, s55, 80640
s_mov_b32 m0, 152576
s_nop 0
buffer_load_dwordx4 v28, s[20:23], s56 offen lds
s_add_u32 s56, s55, 87552
s_mov_b32 m0, 153600
s_nop 0
buffer_load_dwordx4 v28, s[20:23], s56 offen lds
s_add_u32 s56, s55, 89856
s_mov_b32 m0, 154624
s_nop 0
buffer_load_dwordx4 v28, s[20:23], s56 offen lds
ds_read_b64_tr_b16 a[240:241], v48 offset:24576
ds_read_b64_tr_b16 a[242:243], v48 offset:25600
ds_read_b64_tr_b16 a[244:245], v48 offset:26624
ds_read_b64_tr_b16 a[246:247], v48 offset:27648
ds_read_b64_tr_b16 a[224:225], v49 offset:24576
ds_read_b64_tr_b16 a[226:227], v49 offset:25600
ds_read_b64_tr_b16 a[228:229], v49 offset:26624
ds_read_b64_tr_b16 a[230:231], v49 offset:27648
s_waitcnt lgkmcnt(0)
s_waitcnt vmcnt(25)
s_barrier
s_add_u32 s56, s55, 78592
s_mov_b32 m0, 155648
s_nop 0
buffer_load_dwordx4 v28, s[20:23], s56 offen lds
s_add_u32 s56, s55, 80896
s_mov_b32 m0, 156672
s_nop 0
buffer_load_dwordx4 v28, s[20:23], s56 offen lds
s_add_u32 s56, s55, 87808
s_mov_b32 m0, 157696
s_nop 0
buffer_load_dwordx4 v28, s[20:23], s56 offen lds
s_add_u32 s56, s55, 90112
s_mov_b32 m0, 158720
s_nop 0
buffer_load_dwordx4 v28, s[20:23], s56 offen lds
ds_read_b64_tr_b16 a[232:233], v48 offset:28672
ds_read_b64_tr_b16 a[234:235], v48 offset:29696
ds_read_b64_tr_b16 a[236:237], v48 offset:30720
ds_read_b64_tr_b16 a[238:239], v48 offset:31744
ds_read_b64_tr_b16 a[248:249], v49 offset:28672
ds_read_b64_tr_b16 a[250:251], v49 offset:29696
ds_read_b64_tr_b16 a[252:253], v49 offset:30720
ds_read_b64_tr_b16 a[254:255], v49 offset:31744
s_waitcnt lgkmcnt(0)
s_waitcnt vmcnt(24)
s_barrier
s_add_u32 s56, s55, 78848
s_mov_b32 m0, 159744
s_nop 0
buffer_load_dwordx4 v28, s[20:23], s56 offen lds
s_add_u32 s56, s55, 81152
s_mov_b32 m0, 160768
s_nop 0
buffer_load_dwordx4 v28, s[20:23], s56 offen lds
s_add_u32 s56, s55, 88064
s_mov_b32 m0, 161792
s_nop 0
buffer_load_dwordx4 v28, s[20:23], s56 offen lds
s_add_u32 s56, s55, 90368
s_mov_b32 m0, 162816
s_nop 0
buffer_load_dwordx4 v28, s[20:23], s56 offen lds
ds_read_b64_tr_b16 v[60:61], v44 offset:0
ds_read_b64_tr_b16 v[62:63], v44 offset:1024
ds_read_b64_tr_b16 v[64:65], v46 offset:0
ds_read_b64_tr_b16 v[66:67], v46 offset:1024
ds_read_b64_tr_b16 v[68:69], v45 offset:0
ds_read_b64_tr_b16 v[70:71], v45 offset:1024
ds_read_b64_tr_b16 v[72:73], v47 offset:0
ds_read_b64_tr_b16 v[74:75], v47 offset:1024
s_waitcnt lgkmcnt(0)
s_waitcnt vmcnt(24)
s_barrier
ds_write_b128 v2, v[60:63] offset:0
ds_write_b128 v2, v[64:67] offset:1024
ds_write_b128 v2, v[68:71] offset:2048
ds_write_b128 v2, v[72:75] offset:3072
ds_read_b64_tr_b16 v[60:61], v44 offset:4096
ds_read_b64_tr_b16 v[62:63], v44 offset:5120
ds_read_b64_tr_b16 v[64:65], v46 offset:4096
ds_read_b64_tr_b16 v[66:67], v46 offset:5120
ds_read_b64_tr_b16 v[68:69], v45 offset:4096
ds_read_b64_tr_b16 v[70:71], v45 offset:5120
ds_read_b64_tr_b16 v[72:73], v47 offset:4096
ds_read_b64_tr_b16 v[74:75], v47 offset:5120
L_rdv_w3r:
v_readfirstlane_b32 s38, v32
s_nop 0
s_and_b32 s57, s38, 0xff
s_cmp_lg_u32 s57, 32
s_cbranch_scc1 L_rdv2_w3r
s_waitcnt lgkmcnt(0)
s_waitcnt vmcnt(20)
s_barrier
ds_write_b128 v2, v[60:63] offset:4096
ds_write_b128 v2, v[64:67] offset:5120
ds_write_b128 v2, v[68:71] offset:6144
ds_write_b128 v2, v[72:75] offset:7168
ds_read_b64_tr_b16 v[60:61], v44 offset:8192
ds_read_b64_tr_b16 v[62:63], v44 offset:9216
ds_read_b64_tr_b16 v[64:65], v46 offset:8192
ds_read_b64_tr_b16 v[66:67], v46 offset:9216
ds_read_b64_tr_b16 v[68:69], v45 offset:8192
ds_read_b64_tr_b16 v[70:71], v45 offset:9216
ds_read_b64_tr_b16 v[72:73], v47 offset:8192
ds_read_b64_tr_b16 v[74:75], v47 offset:9216
buffer_load_dwordx4 v[12:15], v9, s[4:7], s37 offen offset:0
buffer_load_dwordx4 v[16:19], v9, s[4:7], s37 offen offset:1024
buffer_load_dwordx4 v[52:55], v1, s[4:7], s37 offen offset:2048
buffer_load_dwordx4 v[56:59], v1, s[4:7], s37 offen offset:3072
s_mov_b32 m0, 1024
s_nop 0
buffer_load_dwordx4 v1, s[4:7], s47 offen offset:3072 sc0 sc1 lds
s_waitcnt lgkmcnt(0)
s_waitcnt vmcnt(21)
s_barrier
ds_write_b128 v2, v[60:63] offset:8192
ds_write_b128 v2, v[64:67] offset:9216
ds_write_b128 v2, v[68:71] offset:10240
ds_write_b128 v2, v[72:75] offset:11264
ds_read_b64_tr_b16 v[60:61], v44 offset:12288
ds_read_b64_tr_b16 v[62:63], v44 offset:13312
ds_read_b64_tr_b16 v[64:65], v46 offset:12288
ds_read_b64_tr_b16 v[66:67], v46 offset:13312
ds_read_b64_tr_b16 v[68:69], v45 offset:12288
ds_read_b64_tr_b16 v[70:71], v45 offset:13312
ds_read_b64_tr_b16 v[72:73], v47 offset:12288
ds_read_b64_tr_b16 v[74:75], v47 offset:13312
s_waitcnt lgkmcnt(0)
s_waitcnt vmcnt(17)
s_barrier
ds_write_b128 v2, v[60:63] offset:12288
ds_write_b128 v2, v[64:67] offset:13312
ds_write_b128 v2, v[68:71] offset:14336
ds_write_b128 v2, v[72:75] offset:15360
ds_read_b64_tr_b16 v[60:61], v44 offset:16384
ds_read_b64_tr_b16 v[62:63], v44 offset:17408
ds_read_b64_tr_b16 v[64:65], v46 offset:16384
ds_read_b64_tr_b16 v[66:67], v46 offset:17408
ds_read_b64_tr_b16 v[68:69], v45 offset:16384
ds_read_b64_tr_b16 v[70:71], v45 offset:17408
ds_read_b64_tr_b16 v[72:73], v47 offset:16384
ds_read_b64_tr_b16 v[74:75], v47 offset:17408
s_waitcnt lgkmcnt(0)
s_waitcnt vmcnt(13)
s_barrier
ds_write_b128 v2, v[60:63] offset:16384
ds_write_b128 v2, v[64:67] offset:17408
ds_write_b128 v2, v[68:71] offset:18432
ds_write_b128 v2, v[72:75] offset:19456
ds_read_b64_tr_b16 v[60:61], v48 offset:20480
ds_read_b64_tr_b16 v[62:63], v48 offset:21504
ds_read_b64_tr_b16 v[64:65], v48 offset:22528
ds_read_b64_tr_b16 v[66:67], v48 offset:23552
ds_read_b64_tr_b16 v[68:69], v49 offset:20480
ds_read_b64_tr_b16 v[70:71], v49 offset:21504
ds_read_b64_tr_b16 v[72:73], v49 offset:22528
ds_read_b64_tr_b16 v[74:75], v49 offset:23552
s_waitcnt lgkmcnt(0)
s_waitcnt vmcnt(9)
s_barrier
ds_write_b128 v2, v[60:63] offset:20480
ds_write_b128 v2, v[64:67] offset:21504
ds_write_b128 v2, v[68:71] offset:22528
ds_write_b128 v2, v[72:75] offset:23552
ds_read_b64_tr_b16 v[60:61], v48 offset:24576
ds_read_b64_tr_b16 v[62:63], v48 offset:25600
ds_read_b64_tr_b16 v[64:65], v48 offset:26624
ds_read_b64_tr_b16 v[66:67], v48 offset:27648
ds_read_b64_tr_b16 v[68:69], v49 offset:24576
ds_read_b64_tr_b16 v[70:71], v49 offset:25600
ds_read_b64_tr_b16 v[72:73], v49 offset:26624
ds_read_b64_tr_b16 v[74:75], v49 offset:27648
s_waitcnt lgkmcnt(0)
s_waitcnt vmcnt(5)
s_barrier
ds_write_b128 v2, v[60:63] offset:24576
ds_write_b128 v2, v[64:67] offset:25600
ds_write_b128 v2, v[68:71] offset:26624
ds_write_b128 v2, v[72:75] offset:27648
ds_read_b64_tr_b16 v[60:61], v48 offset:28672
ds_read_b64_tr_b16 v[62:63], v48 offset:29696
ds_read_b64_tr_b16 v[64:65], v48 offset:30720
ds_read_b64_tr_b16 v[66:67], v48 offset:31744
ds_read_b64_tr_b16 v[68:69], v49 offset:28672
ds_read_b64_tr_b16 v[70:71], v49 offset:29696
ds_read_b64_tr_b16 v[72:73], v49 offset:30720
ds_read_b64_tr_b16 v[74:75], v49 offset:31744
s_waitcnt lgkmcnt(0)
s_barrier
ds_write_b128 v2, v[60:63] offset:28672
ds_write_b128 v2, v[64:67] offset:29696
ds_write_b128 v2, v[68:71] offset:30720
ds_write_b128 v2, v[72:75] offset:31744
s_lshl_b32 s57, s58, 5
s_mov_b32 s0, 0x3f003f00
s_mov_b32 s1, 0x3f003f00
s_mov_b32 s58, 304128
s_cmp_eq_u32 s38, s57
s_cbranch_scc0 L_slow_w3r
v_mov_b64 v[20:21], 0
v_mov_b64 v[22:23], 0
v_mov_b64 v[24:25], 0
v_mov_b64 v[26:27], 0
v_mov_b64 v[28:29], 0
v_mov_b64 v[30:31], 0
v_mov_b64 v[32:33], 0
v_mov_b64 v[34:35], 0
v_mov_b64 v[36:37], 0
v_mov_b64 v[38:39], 0
v_mov_b64 v[40:41], 0
v_mov_b64 v[42:43], 0
ds_read_b128 v[44:47], v2 offset:0
ds_read_b128 v[48:51], v2 offset:1024
v_bfe_u32 v77, v1, 6, 1
v_lshl_add_u32 v77, v77, 3, v1
v_lshlrev_b32 v77, 1, v77
v_lshlrev_b32 v78, 2, v1
s_waitcnt vmcnt(0) lgkmcnt(0)
s_branch L_top_w3rf
.p2align 6
L_ex_w3rf:
v_and_b32 v6, 0x70, v1
ds_read_b128 v[76:79], v6 offset:256
v_bfe_u32 v11, v1, 4, 2
v_lshrrev_b32_e64 v11, v11, 1
s_add_u32 s34, s34, 1
s_add_u32 s37, s37, 524288
s_add_u32 s39, s39, 524288
s_mul_i32 s40, s34, 10240
s_add_u32 s40, s40, 8093696
s_not_b32 s35, s35
s_not_b32 s36, s36
ds_read_b128 v[44:47], v2 offset:0
ds_read_b128 v[48:51], v2 offset:1024
s_barrier
s_waitcnt vmcnt(0)
v_mov_b64 v[20:21], 0
v_mov_b64 v[22:23], 0
v_mov_b64 v[24:25], 0
v_mov_b64 v[26:27], 0
v_mov_b64 v[28:29], 0
v_mov_b64 v[30:31], 0
v_mov_b64 v[32:33], 0
v_mov_b64 v[34:35], 0
v_mov_b64 v[36:37], 0
v_mov_b64 v[38:39], 0
v_mov_b64 v[40:41], 0
v_mov_b64 v[42:43], 0
buffer_load_dwordx4 v[60:63], v9, s[4:7], s3 offen offset:0 sc1
buffer_load_dwordx4 v[64:67], v9, s[4:7], s3 offen offset:1024 sc1
buffer_load_dwordx4 v[68:71], v9, s[4:7], s3 offen offset:2048 sc1
buffer_load_dwordx4 v[72:75], v9, s[4:7], s3 offen offset:3072 sc1
s_waitcnt lgkmcnt(2)
s_waitcnt vmcnt(3)
L_r_w3rf:
v_mfma_f32_16x16x32_bf16 v[52:55], v[60:63], v[76:79], 0
s_waitcnt vmcnt(2)
v_mfma_f32_16x16x32_bf16 v[52:55], v[64:67], v[76:79], v[52:55]
v_bitop3_b32 v56, v60, v64, s36 bitop3:0x7e
s_waitcnt vmcnt(1)
v_mfma_f32_16x16x32_bf16 v[52:55], v[68:71], v[76:79], v[52:55]
s_waitcnt vmcnt(0)
v_mfma_f32_16x16x32_bf16 v[52:55], v[72:75], v[76:79], v[52:55]
v_bitop3_b32 v57, v68, v72, s36 bitop3:0x7e
v_bitop3_b32 v56, v56, v57, 1 bitop3:0xa8
v_cmp_ne_u32 vcc, 0, v56
s_cmp_eq_u32 s34, 63
s_nop 3
v_pk_add_f32 v[52:53], v[52:53], v[54:55]
v_cvt_pk_bf16_f32 v56, v52, v53
v_bfi_b32 v56, v11, s35, v56
s_cbranch_vccnz L_rr_w3rf
buffer_store_dword v56, v10, s[4:7], 0 offen
v_mov_b32 v11, v56
s_cbranch_scc1 L_done_w3rf
v_bfe_u32 v77, v1, 6, 1
v_lshl_add_u32 v77, v77, 3, v1
v_lshlrev_b32 v77, 1, v77
v_lshlrev_b32 v78, 2, v1
L_top_w3rf:
s_barrier
ds_read_b128 v[60:63], v1 offset:1024
ds_read_b128 v[64:67], v1 offset:2048
s_mov_b32 m0, 5120
s_nop 0
buffer_load_dwordx4 v1, s[4:7], s48 offen offset:3072 sc1 lds
s_barrier
ds_read_b128 v[68:71], v1 offset:3072
ds_read_b128 v[72:75], v1 offset:4096
L_s0_w3rf:
s_waitcnt lgkmcnt(3)
v_smfmac_f32_16x16x64_bf16 v[28:31], v[60:63], v[176:183], v0
v_smfmac_f32_16x16x64_bf16 v[32:35], v[60:63], v[184:191], v0
v_smfmac_f32_16x16x64_bf16 v[36:39], v[60:63], a[48:55], v0
v_smfmac_f32_16x16x64_bf16 v[40:43], v[60:63], a[56:63], v0
s_waitcnt lgkmcnt(2)
v_smfmac_f32_16x16x64_bf16 v[20:23], v[64:67], v[80:87], v0
v_smfmac_f32_16x16x64_bf16 v[20:23], v[60:63], v[44:51], v0
ds_read_b128 v[44:47], v2 offset:2048
v_smfmac_f32_16x16x64_bf16 v[24:27], v[64:67], v[88:95], v0
ds_read_b128 v[48:51], v2 offset:3072
v_smfmac_f32_16x16x64_bf16 v[28:31], v[64:67], v[192:199], v0
s_waitcnt lgkmcnt(2)
v_bitop3_b32 v6, v60, v64, s35 bitop3:0x7e
v_smfmac_f32_16x16x64_bf16 v[32:35], v[64:67], v[200:207], v0
v_bitop3_b32 v76, v68, v72, s35 bitop3:0x7e
v_smfmac_f32_16x16x64_bf16 v[36:39], v[64:67], a[64:71], v0
v_bitop3_b32 v6, v6, v76, 1 bitop3:0xa8
s_waitcnt lgkmcnt(0)
v_smfmac_f32_16x16x64_bf16 v[24:27], v[60:63], v[44:51], v0
ds_read_b128 v[44:47], v2 offset:4096
v_cmp_ne_u32 vcc, 0, v6
buffer_load_dwordx4 v[12:15], v9, s[4:7], s37 offen offset:0
buffer_load_dwordx4 v[16:19], v9, s[4:7], s37 offen offset:1024
buffer_load_dwordx4 v[52:55], v1, s[4:7], s37 offen offset:2048
buffer_load_dwordx4 v[56:59], v1, s[4:7], s37 offen offset:3072
v_smfmac_f32_16x16x64_bf16 v[40:43], v[64:67], a[72:79], v0
ds_read_b128 v[48:51], v2 offset:5120
v_smfmac_f32_16x16x64_bf16 v[20:23], v[68:71], v[96:103], v0
s_cbranch_vccnz L_ra0_w3rf
v_smfmac_f32_16x16x64_bf16 v[24:27], v[68:71], v[104:111], v0
s_waitcnt vmcnt(4)
s_barrier
ds_read_b32 v6, v77 offset:8192
v_smfmac_f32_16x16x64_bf16 v[28:31], v[68:71], v[208:215], v0
ds_read_b128 v[60:63], v1 offset:6144
s_waitcnt lgkmcnt(2)
v_smfmac_f32_16x16x64_bf16 v[20:23], v[72:75], v[44:51], v0
ds_read_b128 v[64:67], v1 offset:7168
v_smfmac_f32_16x16x64_bf16 v[32:35], v[68:71], v[216:223], v0
ds_read_b128 v[76:79], v1 offset:5120
v_smfmac_f32_16x16x64_bf16 v[36:39], v[68:71], a[80:87], v0
ds_read_b128 v[44:47], v2 offset:6144
v_smfmac_f32_16x16x64_bf16 v[40:43], v[68:71], a[88:95], v0
ds_read_b128 v[48:51], v2 offset:7168
s_waitcnt lgkmcnt(4)
v_bitop3_b32 v6, v6, v60, s35 bitop3:0x7e
v_smfmac_f32_16x16x64_bf16 v[28:31], v[72:75], v[224:231], v0
ds_read_b128 v[68:71], v1 offset:8192
s_waitcnt lgkmcnt(4)
v_bitop3_b32 v6, v6, v64, s35 bitop3:0xf6
v_smfmac_f32_16x16x64_bf16 v[32:35], v[72:75], v[232:239], v0
s_waitcnt lgkmcnt(3)
v_bitop3_b32 v6, v6, v76, s35 bitop3:0xf6
v_and_b32 v6, 1, v6
v_smfmac_f32_16x16x64_bf16 v[36:39], v[72:75], a[96:103], v0
v_cmp_ne_u32 vcc, 0, v6
s_waitcnt lgkmcnt(1)
v_smfmac_f32_16x16x64_bf16 v[24:27], v[72:75], v[44:51], v0
ds_read_b128 v[44:47], v2 offset:8192
v_lshlrev_b32 v6, 2, v1
v_smfmac_f32_16x16x64_bf16 v[40:43], v[72:75], a[104:111], v0
ds_read_b128 v[72:75], v1 offset:9216
s_cbranch_vccnz L_ra1_w3rf
L_a1_w3rf:
buffer_store_dword v11, v10, s[4:7], s40 offen sc0 sc1
s_mov_b32 m0, 0
s_nop 0
buffer_load_dword v6, s[4:7], s39 offen lds
v_smfmac_f32_16x16x64_bf16 v[20:23], v[60:63], v[112:119], v0
ds_read_b128 v[48:51], v2 offset:9216
v_smfmac_f32_16x16x64_bf16 v[20:23], v[64:67], v[128:135], v0
s_waitcnt lgkmcnt(3)
v_smfmac_f32_16x16x64_bf16 v[20:23], v[68:71], v[144:151], v0
s_waitcnt lgkmcnt(1)
v_smfmac_f32_16x16x64_bf16 v[20:23], v[72:75], v[160:167], v0
s_waitcnt lgkmcnt(0)
v_smfmac_f32_16x16x64_bf16 v[20:23], v[76:79], v[44:51], v0
ds_read_b128 v[44:47], v2 offset:10240
v_smfmac_f32_16x16x64_bf16 v[24:27], v[60:63], v[120:127], v0
ds_read_b128 v[48:51], v2 offset:11264
v_smfmac_f32_16x16x64_bf16 v[24:27], v[64:67], v[136:143], v0
v_add_f32 v20, v20, v22
v_smfmac_f32_16x16x64_bf16 v[24:27], v[68:71], v[152:159], v0
v_add_f32 v21, v21, v23
v_smfmac_f32_16x16x64_bf16 v[24:27], v[72:75], v[168:175], v0
v_cvt_pk_bf16_f32 v22, v20, v21
s_waitcnt lgkmcnt(0)
v_smfmac_f32_16x16x64_bf16 v[24:27], v[76:79], v[44:51], v0
ds_read_b128 v[44:47], v2 offset:12288
v_smfmac_f32_16x16x64_bf16 v[28:31], v[76:79], v[240:247], v0
ds_read_b128 v[48:51], v2 offset:13312
v_smfmac_f32_16x16x64_bf16 v[28:31], v[64:67], a[0:7], v0
v_add_f32 v24, v24, v26
v_add_f32 v25, v25, v27
v_cvt_pk_bf16_f32 v23, v24, v25
v_smfmac_f32_16x16x64_bf16 v[28:31], v[68:71], a[16:23], v0
ds_write_b64 v3, v[22:23] offset:11776
v_smfmac_f32_16x16x64_bf16 v[28:31], v[72:75], a[32:39], v0
s_waitcnt lgkmcnt(1)
v_smfmac_f32_16x16x64_bf16 v[28:31], v[60:63], v[44:51], v0
ds_read_b128 v[44:47], v2 offset:14336
v_smfmac_f32_16x16x64_bf16 v[32:35], v[76:79], v[248:255], v0
ds_read_b128 v[48:51], v2 offset:15360
s_waitcnt lgkmcnt(2)
s_barrier
v_smfmac_f32_16x16x64_bf16 v[32:35], v[64:67], a[8:15], v0
ds_read_b64_tr_b16 v[20:21], v4 offset:10240
ds_read_b64_tr_b16 v[22:23], v4 offset:10752
v_add_f32 v28, v28, v30
v_smfmac_f32_16x16x64_bf16 v[32:35], v[68:71], a[24:31], v0
ds_read_b64_tr_b16 v[24:25], v4 offset:11264
v_add_f32 v29, v29, v31
v_smfmac_f32_16x16x64_bf16 v[32:35], v[72:75], a[40:47], v0
ds_read_b64_tr_b16 v[26:27], v4 offset:11776
v_cvt_pk_bf16_f32 v30, v28, v29
s_waitcnt lgkmcnt(4)
v_smfmac_f32_16x16x64_bf16 v[32:35], v[60:63], v[44:51], v0
ds_read_b128 v[44:47], v2 offset:18432
s_waitcnt vmcnt(4)
s_waitcnt lgkmcnt(3)
v_mfma_f32_16x16x32_bf16 v[12:15], v[12:15], v[20:23], 0
ds_read_b128 v[48:51], v2 offset:19456
s_waitcnt lgkmcnt(2)
v_mfma_f32_16x16x32_bf16 v[12:15], v[16:19], v[24:27], v[12:15]
v_add_f32 v32, v32, v34
v_add_f32 v33, v33, v35
v_cvt_pk_bf16_f32 v31, v32, v33
ds_write_b64 v3, v[30:31] offset:13824
v_smfmac_f32_16x16x64_bf16 v[36:39], v[76:79], a[112:119], v0
s_nop 2
v_add_f32_dpp v12, v14, v12 quad_perm:[2,3,0,1] row_mask:0xf bank_mask:0xf
v_add_f32_dpp v13, v15, v13 quad_perm:[2,3,0,1] row_mask:0xf bank_mask:0xf
ds_write_b64 v5, v[12:13] offset:15104
v_smfmac_f32_16x16x64_bf16 v[40:43], v[76:79], a[120:127], v0
s_waitcnt lgkmcnt(1)
s_barrier
ds_read_b64_tr_b16 v[28:29], v4 offset:12288
v_smfmac_f32_16x16x64_bf16 v[36:39], v[60:63], a[128:135], v0
ds_read_b64_tr_b16 v[30:31], v4 offset:12800
ds_read_b64_tr_b16 v[32:33], v4 offset:13312
v_smfmac_f32_16x16x64_bf16 v[40:43], v[60:63], a[136:143], v0
ds_read_b64_tr_b16 v[34:35], v4 offset:13824
v_mov_b64 v[76:77], s[52:53]
s_waitcnt lgkmcnt(4)
s_barrier
ds_read_b128 v[12:15], v1 offset:14336
v_smfmac_f32_16x16x64_bf16 v[40:43], v[72:75], v[44:51], v0
ds_read_b128 v[44:47], v2 offset:16384
v_mov_b64 v[78:79], s[52:53]
s_waitcnt lgkmcnt(4)
v_mfma_f32_16x16x32_bf16 v[28:31], v[28:31], v[20:23], 0
ds_read_b128 v[48:51], v2 offset:17408
s_waitcnt lgkmcnt(3)
v_mfma_f32_16x16x32_bf16 v[28:31], v[32:35], v[24:27], v[28:31]
v_smfmac_f32_16x16x64_bf16 v[40:43], v[64:67], a[152:159], v0
s_waitcnt lgkmcnt(2)
v_max3_f32 v17, v12, v13, v14
v_smfmac_f32_16x16x64_bf16 v[36:39], v[64:67], a[144:151], v0
ds_read_b128 v[60:63], v2 offset:22528
v_add_f32_dpp v28, v30, v28 quad_perm:[2,3,0,1] row_mask:0xf bank_mask:0xf
v_add_f32_dpp v29, v31, v29 quad_perm:[2,3,0,1] row_mask:0xf bank_mask:0xf
v_max_f32 v17, v17, v15
v_max_f32 v16, v28, v29
v_mul_f32 v16, s50, v16
v_max_f32_dpp v17, v17, v17 quad_perm:[2,3,0,1] row_mask:0xf bank_mask:0xf
v_smfmac_f32_16x16x64_bf16 v[40:43], v[68:71], a[168:175], v0
ds_read_b128 v[64:67], v2 offset:23552
v_max_f32_dpp v18, v16, v17 quad_perm:[0,1,0,1] row_mask:0xf bank_mask:0xf
v_max_f32_dpp v19, v16, v17 quad_perm:[0,1,0,1] row_mask:0xf bank_mask:0xf
v_smfmac_f32_16x16x64_bf16 v[36:39], v[68:71], a[160:167], v0
ds_read_b128 v[68:71], v2 offset:24576
v_permlane16_swap_b32 v18, v19
v_max_f32 v20, v18, v19
v_max_f32 v21, v18, v19
s_waitcnt lgkmcnt(3)
v_smfmac_f32_16x16x64_bf16 v[36:39], v[72:75], v[44:51], v0
ds_read_b128 v[72:75], v2 offset:25600
v_permlane32_swap_b32 v20, v21
v_max_f32 v20, v20, v21
v_sub_f32 v12, v12, v20
v_sub_f32 v13, v13, v20
v_pk_add_f32 v[14:15], v[14:15], v[20:21] op_sel_hi:[1,0] neg_lo:[0,1] neg_hi:[0,1]
v_exp_f32 v12, v12
v_exp_f32 v13, v13
v_exp_f32 v14, v14
v_exp_f32 v15, v15
v_cvt_pk_bf16_f32 v16, v12, v13
v_cvt_pk_bf16_f32 v17, v14, v15
v_pk_fma_f32 v[28:29], v[28:29], s[50:51], v[20:21] op_sel_hi:[1,1,0] neg_lo:[0,0,1] neg_hi:[0,0,1]
v_mov_b32_dpp v18, v16 quad_perm:[2,3,0,1] row_mask:0xf bank_mask:0xf
v_mov_b32_dpp v19, v17 quad_perm:[2,3,0,1] row_mask:0xf bank_mask:0xf
v_exp_f32 v28, v28
s_waitcnt vmcnt(2)
v_mfma_f32_16x16x32_bf16 v[32:35], v[76:79], v[16:19], 0
v_exp_f32 v29, v29
v_mfma_f32_16x16x32_bf16 v[20:23], v[52:55], v[16:19], 0
v_cvt_pk_bf16_f32 v12, v28, v29
v_cvt_pk_bf16_f32 v13, v28, v29
v_mov_b64 v[14:15], s[0:1]
v_mfma_f32_16x16x32_bf16 v[24:27], v[56:59], v[16:19], 0
v_cvt_pk_bf16_f32 v36, v36, v37
v_cvt_pk_bf16_f32 v37, v38, v39
v_mfma_f32_16x16x16_bf16 v[32:35], v[14:15], v[12:13], v[32:35]
v_cvt_pk_bf16_f32 v38, v40, v41
v_cvt_pk_bf16_f32 v39, v42, v43
v_mfma_f32_16x16x16_bf16 v[20:23], v[36:37], v[12:13], v[20:23]
ds_read_b128 v[44:47], v2 offset:20480
v_mfma_f32_16x16x16_bf16 v[24:27], v[38:39], v[12:13], v[24:27]
ds_read_b128 v[48:51], v2 offset:21504
v_rcp_f32 v32, v32
v_mov_b64 v[28:29], 0
v_mov_b64 v[30:31], 0
v_pk_mul_f32 v[20:21], v[20:21], v[32:33] op_sel_hi:[1,0]
v_pk_mul_f32 v[22:23], v[22:23], v[32:33] op_sel_hi:[1,0]
v_cvt_pk_bf16_f32 v20, v20, v21
v_cvt_pk_bf16_f32 v21, v22, v23
ds_write_b64 v1, v[20:21] offset:8192
v_pk_mul_f32 v[24:25], v[24:25], v[32:33] op_sel_hi:[1,0]
v_pk_mul_f32 v[26:27], v[26:27], v[32:33] op_sel_hi:[1,0]
v_cvt_pk_bf16_f32 v24, v24, v25
v_cvt_pk_bf16_f32 v25, v26, v27
ds_write_b64 v1, v[24:25] offset:8200
v_mov_b64 v[76:77], 0
ds_read_b128 v[12:15], v7 offset:8192
v_mov_b64 v[78:79], 0
v_mov_b64 v[40:41], 0
v_mov_b64 v[42:43], 0
v_mov_b64 v[36:37], 0
v_mov_b64 v[38:39], 0
v_mov_b64 v[32:33], 0
v_mov_b64 v[34:35], 0
s_waitcnt lgkmcnt(1)
s_barrier
ds_read_b128 v[16:19], v7 offset:5120
ds_read_b128 v[52:55], v7 offset:6144
ds_read_b128 v[56:59], v7 offset:7168
s_waitcnt lgkmcnt(3)
v_smfmac_f32_16x16x64_bf16 v[28:31], v[12:15], a[176:183], v0 abid:1
v_smfmac_f32_16x16x64_bf16 v[76:79], v[12:15], a[184:191], v0 abid:1
s_waitcnt lgkmcnt(2)
v_smfmac_f32_16x16x64_bf16 v[28:31], v[16:19], v[44:51], v0 abid:1
ds_read_b128 v[44:47], v2 offset:26624
s_waitcnt lgkmcnt(2)
v_smfmac_f32_16x16x64_bf16 v[28:31], v[52:55], a[192:199], v0 abid:1
ds_read_b128 v[48:51], v2 offset:27648
s_waitcnt lgkmcnt(2)
v_smfmac_f32_16x16x64_bf16 v[28:31], v[56:59], v[60:67], v0 abid:1
ds_read_b128 v[60:63], v2 offset:28672
v_smfmac_f32_16x16x64_bf16 v[76:79], v[16:19], v[68:75], v0 abid:1
ds_read_b128 v[64:67], v2 offset:29696
v_smfmac_f32_16x16x64_bf16 v[76:79], v[52:55], a[200:207], v0 abid:1
ds_read_b128 v[68:71], v2 offset:30720
v_cvt_pk_bf16_f32 v28, v28, v29
v_cvt_pk_bf16_f32 v29, v30, v31
v_bfi_b32 v28, 1, s35, v28
buffer_store_dwordx2 v[28:29], v8, s[4:7], s42 offen
s_waitcnt lgkmcnt(3)
v_smfmac_f32_16x16x64_bf16 v[76:79], v[56:59], v[44:51], v0 abid:1
ds_read_b128 v[72:75], v2 offset:31744
v_smfmac_f32_16x16x64_bf16 v[40:43], v[12:15], a[208:215], v0 abid:1
s_waitcnt lgkmcnt(2)
v_smfmac_f32_16x16x64_bf16 v[40:43], v[16:19], v[60:67], v0 abid:1
v_cvt_pk_bf16_f32 v76, v76, v77
v_cvt_pk_bf16_f32 v77, v78, v79
v_bfi_b32 v76, 1, s35, v76
buffer_store_dwordx2 v[76:77], v8, s[4:7], s43 offen
v_smfmac_f32_16x16x64_bf16 v[40:43], v[52:55], a[216:223], v0 abid:1
s_waitcnt lgkmcnt(0)
v_smfmac_f32_16x16x64_bf16 v[40:43], v[56:59], v[68:75], v0 abid:1
v_smfmac_f32_16x16x64_bf16 v[36:39], v[12:15], a[224:231], v0 abid:1
v_smfmac_f32_16x16x64_bf16 v[36:39], v[16:19], a[232:239], v0 abid:1
v_cvt_pk_bf16_f32 v40, v40, v41
v_cvt_pk_bf16_f32 v41, v42, v43
v_bfi_b32 v40, 1, s35, v40
buffer_store_dwordx2 v[40:41], v8, s[4:7], s44 offen
v_smfmac_f32_16x16x64_bf16 v[36:39], v[52:55], a[240:247], v0 abid:1
v_smfmac_f32_16x16x64_bf16 v[36:39], v[56:59], a[248:255], v0 abid:1
s_nop 7
v_cvt_pk_bf16_f32 v36, v36, v37
v_cvt_pk_bf16_f32 v37, v38, v39
v_bfi_b32 v36, 1, s35, v36
buffer_store_dwordx2 v[36:37], v8, s[4:7], s45 offen
s_branch L_ex_w3rf
L_done_w3rf:
buffer_store_dword v11, v10, s[4:7], s40 offen sc0 sc1
s_waitcnt vmcnt(0) lgkmcnt(0)
s_endpgm
L_rdv2_w3r:
buffer_load_dword v32, v24, s[28:31], 0 offen sc0 sc1
s_sub_u32 s41, s41, 1
s_cbranch_scc1 L_exit
s_waitcnt vmcnt(0)
s_branch L_rdv_w3r
L_ra0_w3rf:
s_mov_b32 m0, 1024
s_nop 0
buffer_load_dwordx4 v1, s[4:7], s47 offen offset:0 sc1 lds
buffer_load_dwordx4 v1, s[4:7], s47 offen offset:1024 sc1 lds
buffer_load_dwordx4 v1, s[4:7], s47 offen offset:2048 sc1 lds
buffer_load_dwordx4 v1, s[4:7], s47 offen offset:3072 sc1 lds
s_sub_u32 s41, s41, 1
s_cbranch_scc1 L_exit
ds_read_b128 v[44:47], v2 offset:0
ds_read_b128 v[48:51], v2 offset:1024
v_mov_b64 v[20:21], 0
v_mov_b64 v[22:23], 0
v_mov_b64 v[24:25], 0
v_mov_b64 v[26:27], 0
v_mov_b64 v[28:29], 0
v_mov_b64 v[30:31], 0
v_mov_b64 v[32:33], 0
v_mov_b64 v[34:35], 0
v_mov_b64 v[36:37], 0
v_mov_b64 v[38:39], 0
v_mov_b64 v[40:41], 0
v_mov_b64 v[42:43], 0
s_waitcnt vmcnt(0)
ds_read_b128 v[60:63], v1 offset:1024
ds_read_b128 v[64:67], v1 offset:2048
ds_read_b128 v[68:71], v1 offset:3072
ds_read_b128 v[72:75], v1 offset:4096
s_branch L_s0_w3rf
L_ra1_w3rf:
s_waitcnt lgkmcnt(0)
s_barrier
s_mov_b32 m0, 5120
s_nop 0
buffer_load_dwordx4 v1, s[4:7], s48 offen offset:3072 sc1 lds
s_sub_u32 s41, s41, 1
s_cbranch_scc1 L_exit
s_waitcnt vmcnt(0)
s_barrier
ds_read_b128 v[76:79], v1 offset:5120
ds_read_b128 v[60:63], v1 offset:6144
ds_read_b128 v[64:67], v1 offset:7168
ds_read_b128 v[68:71], v1 offset:8192
ds_read_b128 v[72:75], v1 offset:9216
s_waitcnt lgkmcnt(0)
v_bitop3_b32 v6, v76, v60, s35 bitop3:0x7e
v_bitop3_b32 v6, v6, v64, s35 bitop3:0xf6
v_bitop3_b32 v6, v6, v68, s35 bitop3:0xf6
v_bitop3_b32 v6, v6, v72, s35 bitop3:0xf6
v_and_b32 v6, 1, v6
v_cmp_ne_u32 vcc, 0, v6
v_lshlrev_b32 v6, 2, v1
s_cbranch_vccnz L_ra1_w3rf
s_branch L_a1_w3rf
L_rr_w3rf:
buffer_load_dwordx4 v[60:63], v9, s[4:7], s3 offen offset:0 sc1
buffer_load_dwordx4 v[64:67], v9, s[4:7], s3 offen offset:1024 sc1
buffer_load_dwordx4 v[68:71], v9, s[4:7], s3 offen offset:2048 sc1
buffer_load_dwordx4 v[72:75], v9, s[4:7], s3 offen offset:3072 sc1
s_sub_u32 s41, s41, 1
s_cbranch_scc1 L_exit
s_waitcnt vmcnt(0)
s_branch L_r_w3rf
L_slow_w3r:
v_mov_b64 v[20:21], 0
v_mov_b64 v[22:23], 0
v_mov_b64 v[24:25], 0
v_mov_b64 v[26:27], 0
v_mov_b64 v[28:29], 0
v_mov_b64 v[30:31], 0
v_mov_b64 v[32:33], 0
v_mov_b64 v[34:35], 0
v_mov_b64 v[36:37], 0
v_mov_b64 v[38:39], 0
v_mov_b64 v[40:41], 0
v_mov_b64 v[42:43], 0
ds_read_b128 v[44:47], v2 offset:0
ds_read_b128 v[48:51], v2 offset:1024
v_bfe_u32 v77, v1, 6, 1
v_lshl_add_u32 v77, v77, 3, v1
v_lshlrev_b32 v77, 1, v77
v_lshlrev_b32 v78, 2, v1
s_waitcnt vmcnt(0) lgkmcnt(0)
s_branch L_top_w3rs
.p2align 6
L_ex_w3rs:
v_and_b32 v6, 0x70, v1
ds_read_b128 v[76:79], v6 offset:256
v_bfe_u32 v11, v1, 4, 2
v_lshrrev_b32_e64 v11, v11, 1
s_add_u32 s34, s34, 1
s_add_u32 s37, s37, 524288
s_add_u32 s39, s39, 524288
s_mul_i32 s40, s34, 10240
s_add_u32 s40, s40, 8093696
s_not_b32 s35, s35
s_not_b32 s36, s36
ds_read_b128 v[44:47], v2 offset:0
ds_read_b128 v[48:51], v2 offset:1024
s_barrier
s_waitcnt vmcnt(0)
v_mov_b64 v[20:21], 0
v_mov_b64 v[22:23], 0
v_mov_b64 v[24:25], 0
v_mov_b64 v[26:27], 0
v_mov_b64 v[28:29], 0
v_mov_b64 v[30:31], 0
v_mov_b64 v[32:33], 0
v_mov_b64 v[34:35], 0
v_mov_b64 v[36:37], 0
v_mov_b64 v[38:39], 0
v_mov_b64 v[40:41], 0
v_mov_b64 v[42:43], 0
buffer_load_dwordx4 v[60:63], v9, s[4:7], s3 offen offset:0 sc0 sc1
buffer_load_dwordx4 v[64:67], v9, s[4:7], s3 offen offset:1024 sc0 sc1
buffer_load_dwordx4 v[68:71], v9, s[4:7], s3 offen offset:2048 sc0 sc1
buffer_load_dwordx4 v[72:75], v9, s[4:7], s3 offen offset:3072 sc0 sc1
s_waitcnt lgkmcnt(2)
s_waitcnt vmcnt(3)
L_r_w3rs:
v_mfma_f32_16x16x32_bf16 v[52:55], v[60:63], v[76:79], 0
s_waitcnt vmcnt(2)
v_mfma_f32_16x16x32_bf16 v[52:55], v[64:67], v[76:79], v[52:55]
v_bitop3_b32 v56, v60, v64, s36 bitop3:0x7e
s_waitcnt vmcnt(1)
v_mfma_f32_16x16x32_bf16 v[52:55], v[68:71], v[76:79], v[52:55]
s_waitcnt vmcnt(0)
v_mfma_f32_16x16x32_bf16 v[52:55], v[72:75], v[76:79], v[52:55]
v_bitop3_b32 v57, v68, v72, s36 bitop3:0x7e
v_bitop3_b32 v56, v56, v57, 1 bitop3:0xa8
v_cmp_ne_u32 vcc, 0, v56
s_cmp_eq_u32 s34, 63
s_nop 3
v_pk_add_f32 v[52:53], v[52:53], v[54:55]
v_cvt_pk_bf16_f32 v56, v52, v53
v_bfi_b32 v56, v11, s35, v56
s_cbranch_vccnz L_rr_w3rs
buffer_store_dword v56, v10, s[4:7], 0 offen sc0 sc1
v_mov_b32 v11, v56
s_cbranch_scc1 L_done_w3rs
v_bfe_u32 v77, v1, 6, 1
v_lshl_add_u32 v77, v77, 3, v1
v_lshlrev_b32 v77, 1, v77
v_lshlrev_b32 v78, 2, v1
L_top_w3rs:
s_barrier
ds_read_b128 v[60:63], v1 offset:1024
ds_read_b128 v[64:67], v1 offset:2048
s_mov_b32 m0, 5120
s_nop 0
buffer_load_dwordx4 v1, s[4:7], s48 offen offset:3072 sc0 sc1 lds
s_barrier
ds_read_b128 v[68:71], v1 offset:3072
ds_read_b128 v[72:75], v1 offset:4096
L_s0_w3rs:
s_waitcnt lgkmcnt(3)
v_smfmac_f32_16x16x64_bf16 v[28:31], v[60:63], v[176:183], v0
v_smfmac_f32_16x16x64_bf16 v[32:35], v[60:63], v[184:191], v0
v_smfmac_f32_16x16x64_bf16 v[36:39], v[60:63], a[48:55], v0
v_smfmac_f32_16x16x64_bf16 v[40:43], v[60:63], a[56:63], v0
s_waitcnt lgkmcnt(2)
v_smfmac_f32_16x16x64_bf16 v[20:23], v[64:67], v[80:87], v0
v_smfmac_f32_16x16x64_bf16 v[20:23], v[60:63], v[44:51], v0
ds_read_b128 v[44:47], v2 offset:2048
v_smfmac_f32_16x16x64_bf16 v[24:27], v[64:67], v[88:95], v0
ds_read_b128 v[48:51], v2 offset:3072
v_smfmac_f32_16x16x64_bf16 v[28:31], v[64:67], v[192:199], v0
s_waitcnt lgkmcnt(2)
v_bitop3_b32 v6, v60, v64, s35 bitop3:0x7e
v_smfmac_f32_16x16x64_bf16 v[32:35], v[64:67], v[200:207], v0
v_bitop3_b32 v76, v68, v72, s35 bitop3:0x7e
v_smfmac_f32_16x16x64_bf16 v[36:39], v[64:67], a[64:71], v0
v_bitop3_b32 v6, v6, v76, 1 bitop3:0xa8
s_waitcnt lgkmcnt(0)
v_smfmac_f32_16x16x64_bf16 v[24:27], v[60:63], v[44:51], v0
ds_read_b128 v[44:47], v2 offset:4096
v_cmp_ne_u32 vcc, 0, v6
buffer_load_dwordx4 v[12:15], v9, s[4:7], s37 offen offset:0
buffer_load_dwordx4 v[16:19], v9, s[4:7], s37 offen offset:1024
buffer_load_dwordx4 v[52:55], v1, s[4:7], s37 offen offset:2048
buffer_load_dwordx4 v[56:59], v1, s[4:7], s37 offen offset:3072
v_smfmac_f32_16x16x64_bf16 v[40:43], v[64:67], a[72:79], v0
ds_read_b128 v[48:51], v2 offset:5120
v_smfmac_f32_16x16x64_bf16 v[20:23], v[68:71], v[96:103], v0
s_cbranch_vccnz L_ra0_w3rs
v_smfmac_f32_16x16x64_bf16 v[24:27], v[68:71], v[104:111], v0
s_waitcnt vmcnt(4)
s_barrier
ds_read_b32 v6, v77 offset:8192
v_smfmac_f32_16x16x64_bf16 v[28:31], v[68:71], v[208:215], v0
ds_read_b128 v[60:63], v1 offset:6144
s_waitcnt lgkmcnt(2)
v_smfmac_f32_16x16x64_bf16 v[20:23], v[72:75], v[44:51], v0
ds_read_b128 v[64:67], v1 offset:7168
v_smfmac_f32_16x16x64_bf16 v[32:35], v[68:71], v[216:223], v0
ds_read_b128 v[76:79], v1 offset:5120
v_smfmac_f32_16x16x64_bf16 v[36:39], v[68:71], a[80:87], v0
ds_read_b128 v[44:47], v2 offset:6144
v_smfmac_f32_16x16x64_bf16 v[40:43], v[68:71], a[88:95], v0
ds_read_b128 v[48:51], v2 offset:7168
s_waitcnt lgkmcnt(4)
v_bitop3_b32 v6, v6, v60, s35 bitop3:0x7e
v_smfmac_f32_16x16x64_bf16 v[28:31], v[72:75], v[224:231], v0
ds_read_b128 v[68:71], v1 offset:8192
s_waitcnt lgkmcnt(4)
v_bitop3_b32 v6, v6, v64, s35 bitop3:0xf6
v_smfmac_f32_16x16x64_bf16 v[32:35], v[72:75], v[232:239], v0
s_waitcnt lgkmcnt(3)
v_bitop3_b32 v6, v6, v76, s35 bitop3:0xf6
v_and_b32 v6, 1, v6
v_smfmac_f32_16x16x64_bf16 v[36:39], v[72:75], a[96:103], v0
v_cmp_ne_u32 vcc, 0, v6
s_waitcnt lgkmcnt(1)
v_smfmac_f32_16x16x64_bf16 v[24:27], v[72:75], v[44:51], v0
ds_read_b128 v[44:47], v2 offset:8192
v_lshlrev_b32 v6, 2, v1
v_smfmac_f32_16x16x64_bf16 v[40:43], v[72:75], a[104:111], v0
ds_read_b128 v[72:75], v1 offset:9216
s_cbranch_vccnz L_ra1_w3rs
L_a1_w3rs:
buffer_store_dword v11, v10, s[4:7], s40 offen sc0 sc1
s_mov_b32 m0, 0
s_nop 0
buffer_load_dword v6, s[4:7], s39 offen lds
v_smfmac_f32_16x16x64_bf16 v[20:23], v[60:63], v[112:119], v0
ds_read_b128 v[48:51], v2 offset:9216
v_smfmac_f32_16x16x64_bf16 v[20:23], v[64:67], v[128:135], v0
s_waitcnt lgkmcnt(3)
v_smfmac_f32_16x16x64_bf16 v[20:23], v[68:71], v[144:151], v0
s_waitcnt lgkmcnt(1)
v_smfmac_f32_16x16x64_bf16 v[20:23], v[72:75], v[160:167], v0
s_waitcnt lgkmcnt(0)
v_smfmac_f32_16x16x64_bf16 v[20:23], v[76:79], v[44:51], v0
ds_read_b128 v[44:47], v2 offset:10240
v_smfmac_f32_16x16x64_bf16 v[24:27], v[60:63], v[120:127], v0
ds_read_b128 v[48:51], v2 offset:11264
v_smfmac_f32_16x16x64_bf16 v[24:27], v[64:67], v[136:143], v0
v_add_f32 v20, v20, v22
v_smfmac_f32_16x16x64_bf16 v[24:27], v[68:71], v[152:159], v0
v_add_f32 v21, v21, v23
v_smfmac_f32_16x16x64_bf16 v[24:27], v[72:75], v[168:175], v0
v_cvt_pk_bf16_f32 v22, v20, v21
s_waitcnt lgkmcnt(0)
v_smfmac_f32_16x16x64_bf16 v[24:27], v[76:79], v[44:51], v0
ds_read_b128 v[44:47], v2 offset:12288
v_smfmac_f32_16x16x64_bf16 v[28:31], v[76:79], v[240:247], v0
ds_read_b128 v[48:51], v2 offset:13312
v_smfmac_f32_16x16x64_bf16 v[28:31], v[64:67], a[0:7], v0
v_add_f32 v24, v24, v26
v_add_f32 v25, v25, v27
v_cvt_pk_bf16_f32 v23, v24, v25
v_smfmac_f32_16x16x64_bf16 v[28:31], v[68:71], a[16:23], v0
ds_write_b64 v3, v[22:23] offset:11776
v_smfmac_f32_16x16x64_bf16 v[28:31], v[72:75], a[32:39], v0
s_waitcnt lgkmcnt(1)
v_smfmac_f32_16x16x64_bf16 v[28:31], v[60:63], v[44:51], v0
ds_read_b128 v[44:47], v2 offset:14336
v_smfmac_f32_16x16x64_bf16 v[32:35], v[76:79], v[248:255], v0
ds_read_b128 v[48:51], v2 offset:15360
s_waitcnt lgkmcnt(2)
s_barrier
v_smfmac_f32_16x16x64_bf16 v[32:35], v[64:67], a[8:15], v0
ds_read_b64_tr_b16 v[20:21], v4 offset:10240
ds_read_b64_tr_b16 v[22:23], v4 offset:10752
v_add_f32 v28, v28, v30
v_smfmac_f32_16x16x64_bf16 v[32:35], v[68:71], a[24:31], v0
ds_read_b64_tr_b16 v[24:25], v4 offset:11264
v_add_f32 v29, v29, v31
v_smfmac_f32_16x16x64_bf16 v[32:35], v[72:75], a[40:47], v0
ds_read_b64_tr_b16 v[26:27], v4 offset:11776
v_cvt_pk_bf16_f32 v30, v28, v29
s_waitcnt lgkmcnt(4)
v_smfmac_f32_16x16x64_bf16 v[32:35], v[60:63], v[44:51], v0
ds_read_b128 v[44:47], v2 offset:18432
s_waitcnt vmcnt(4)
s_waitcnt lgkmcnt(3)
v_mfma_f32_16x16x32_bf16 v[12:15], v[12:15], v[20:23], 0
ds_read_b128 v[48:51], v2 offset:19456
s_waitcnt lgkmcnt(2)
v_mfma_f32_16x16x32_bf16 v[12:15], v[16:19], v[24:27], v[12:15]
v_add_f32 v32, v32, v34
v_add_f32 v33, v33, v35
v_cvt_pk_bf16_f32 v31, v32, v33
ds_write_b64 v3, v[30:31] offset:13824
v_smfmac_f32_16x16x64_bf16 v[36:39], v[76:79], a[112:119], v0
s_nop 2
v_add_f32_dpp v12, v14, v12 quad_perm:[2,3,0,1] row_mask:0xf bank_mask:0xf
v_add_f32_dpp v13, v15, v13 quad_perm:[2,3,0,1] row_mask:0xf bank_mask:0xf
ds_write_b64 v5, v[12:13] offset:15104
v_smfmac_f32_16x16x64_bf16 v[40:43], v[76:79], a[120:127], v0
s_waitcnt lgkmcnt(1)
s_barrier
ds_read_b64_tr_b16 v[28:29], v4 offset:12288
v_smfmac_f32_16x16x64_bf16 v[36:39], v[60:63], a[128:135], v0
ds_read_b64_tr_b16 v[30:31], v4 offset:12800
ds_read_b64_tr_b16 v[32:33], v4 offset:13312
v_smfmac_f32_16x16x64_bf16 v[40:43], v[60:63], a[136:143], v0
ds_read_b64_tr_b16 v[34:35], v4 offset:13824
v_mov_b64 v[76:77], s[52:53]
s_waitcnt lgkmcnt(4)
s_barrier
ds_read_b128 v[12:15], v1 offset:14336
v_smfmac_f32_16x16x64_bf16 v[40:43], v[72:75], v[44:51], v0
ds_read_b128 v[44:47], v2 offset:16384
v_mov_b64 v[78:79], s[52:53]
s_waitcnt lgkmcnt(4)
v_mfma_f32_16x16x32_bf16 v[28:31], v[28:31], v[20:23], 0
ds_read_b128 v[48:51], v2 offset:17408
s_waitcnt lgkmcnt(3)
v_mfma_f32_16x16x32_bf16 v[28:31], v[32:35], v[24:27], v[28:31]
v_smfmac_f32_16x16x64_bf16 v[40:43], v[64:67], a[152:159], v0
s_waitcnt lgkmcnt(2)
v_max3_f32 v17, v12, v13, v14
v_smfmac_f32_16x16x64_bf16 v[36:39], v[64:67], a[144:151], v0
ds_read_b128 v[60:63], v2 offset:22528
v_add_f32_dpp v28, v30, v28 quad_perm:[2,3,0,1] row_mask:0xf bank_mask:0xf
v_add_f32_dpp v29, v31, v29 quad_perm:[2,3,0,1] row_mask:0xf bank_mask:0xf
v_max_f32 v17, v17, v15
v_max_f32 v16, v28, v29
v_mul_f32 v16, s50, v16
v_max_f32_dpp v17, v17, v17 quad_perm:[2,3,0,1] row_mask:0xf bank_mask:0xf
v_smfmac_f32_16x16x64_bf16 v[40:43], v[68:71], a[168:175], v0
ds_read_b128 v[64:67], v2 offset:23552
v_max_f32_dpp v18, v16, v17 quad_perm:[0,1,0,1] row_mask:0xf bank_mask:0xf
v_max_f32_dpp v19, v16, v17 quad_perm:[0,1,0,1] row_mask:0xf bank_mask:0xf
v_smfmac_f32_16x16x64_bf16 v[36:39], v[68:71], a[160:167], v0
ds_read_b128 v[68:71], v2 offset:24576
v_permlane16_swap_b32 v18, v19
v_max_f32 v20, v18, v19
v_max_f32 v21, v18, v19
s_waitcnt lgkmcnt(3)
v_smfmac_f32_16x16x64_bf16 v[36:39], v[72:75], v[44:51], v0
ds_read_b128 v[72:75], v2 offset:25600
v_permlane32_swap_b32 v20, v21
v_max_f32 v20, v20, v21
v_sub_f32 v12, v12, v20
v_sub_f32 v13, v13, v20
v_pk_add_f32 v[14:15], v[14:15], v[20:21] op_sel_hi:[1,0] neg_lo:[0,1] neg_hi:[0,1]
v_exp_f32 v12, v12
v_exp_f32 v13, v13
v_exp_f32 v14, v14
v_exp_f32 v15, v15
v_cvt_pk_bf16_f32 v16, v12, v13
v_cvt_pk_bf16_f32 v17, v14, v15
v_pk_fma_f32 v[28:29], v[28:29], s[50:51], v[20:21] op_sel_hi:[1,1,0] neg_lo:[0,0,1] neg_hi:[0,0,1]
v_mov_b32_dpp v18, v16 quad_perm:[2,3,0,1] row_mask:0xf bank_mask:0xf
v_mov_b32_dpp v19, v17 quad_perm:[2,3,0,1] row_mask:0xf bank_mask:0xf
v_exp_f32 v28, v28
s_waitcnt vmcnt(2)
v_mfma_f32_16x16x32_bf16 v[32:35], v[76:79], v[16:19], 0
v_exp_f32 v29, v29
v_mfma_f32_16x16x32_bf16 v[20:23], v[52:55], v[16:19], 0
v_cvt_pk_bf16_f32 v12, v28, v29
v_cvt_pk_bf16_f32 v13, v28, v29
v_mov_b64 v[14:15], s[0:1]
v_mfma_f32_16x16x32_bf16 v[24:27], v[56:59], v[16:19], 0
v_cvt_pk_bf16_f32 v36, v36, v37
v_cvt_pk_bf16_f32 v37, v38, v39
v_mfma_f32_16x16x16_bf16 v[32:35], v[14:15], v[12:13], v[32:35]
v_cvt_pk_bf16_f32 v38, v40, v41
v_cvt_pk_bf16_f32 v39, v42, v43
v_mfma_f32_16x16x16_bf16 v[20:23], v[36:37], v[12:13], v[20:23]
ds_read_b128 v[44:47], v2 offset:20480
v_mfma_f32_16x16x16_bf16 v[24:27], v[38:39], v[12:13], v[24:27]
ds_read_b128 v[48:51], v2 offset:21504
v_rcp_f32 v32, v32
v_mov_b64 v[28:29], 0
v_mov_b64 v[30:31], 0
v_pk_mul_f32 v[20:21], v[20:21], v[32:33] op_sel_hi:[1,0]
v_pk_mul_f32 v[22:23], v[22:23], v[32:33] op_sel_hi:[1,0]
v_cvt_pk_bf16_f32 v20, v20, v21
v_cvt_pk_bf16_f32 v21, v22, v23
ds_write_b64 v1, v[20:21] offset:8192
v_pk_mul_f32 v[24:25], v[24:25], v[32:33] op_sel_hi:[1,0]
v_pk_mul_f32 v[26:27], v[26:27], v[32:33] op_sel_hi:[1,0]
v_cvt_pk_bf16_f32 v24, v24, v25
v_cvt_pk_bf16_f32 v25, v26, v27
ds_write_b64 v1, v[24:25] offset:8200
v_mov_b64 v[76:77], 0
ds_read_b128 v[12:15], v7 offset:8192
v_mov_b64 v[78:79], 0
v_mov_b64 v[40:41], 0
v_mov_b64 v[42:43], 0
v_mov_b64 v[36:37], 0
v_mov_b64 v[38:39], 0
v_mov_b64 v[32:33], 0
v_mov_b64 v[34:35], 0
s_waitcnt lgkmcnt(1)
s_barrier
ds_read_b128 v[16:19], v7 offset:5120
ds_read_b128 v[52:55], v7 offset:6144
ds_read_b128 v[56:59], v7 offset:7168
s_waitcnt lgkmcnt(3)
v_smfmac_f32_16x16x64_bf16 v[28:31], v[12:15], a[176:183], v0 abid:1
v_smfmac_f32_16x16x64_bf16 v[76:79], v[12:15], a[184:191], v0 abid:1
s_waitcnt lgkmcnt(2)
v_smfmac_f32_16x16x64_bf16 v[28:31], v[16:19], v[44:51], v0 abid:1
ds_read_b128 v[44:47], v2 offset:26624
s_waitcnt lgkmcnt(2)
v_smfmac_f32_16x16x64_bf16 v[28:31], v[52:55], a[192:199], v0 abid:1
ds_read_b128 v[48:51], v2 offset:27648
s_waitcnt lgkmcnt(2)
v_smfmac_f32_16x16x64_bf16 v[28:31], v[56:59], v[60:67], v0 abid:1
ds_read_b128 v[60:63], v2 offset:28672
v_smfmac_f32_16x16x64_bf16 v[76:79], v[16:19], v[68:75], v0 abid:1
ds_read_b128 v[64:67], v2 offset:29696
v_smfmac_f32_16x16x64_bf16 v[76:79], v[52:55], a[200:207], v0 abid:1
ds_read_b128 v[68:71], v2 offset:30720
v_cvt_pk_bf16_f32 v28, v28, v29
v_cvt_pk_bf16_f32 v29, v30, v31
v_bfi_b32 v28, 1, s35, v28
buffer_store_dwordx2 v[28:29], v8, s[4:7], s42 offen sc0 sc1
s_waitcnt lgkmcnt(3)
v_smfmac_f32_16x16x64_bf16 v[76:79], v[56:59], v[44:51], v0 abid:1
ds_read_b128 v[72:75], v2 offset:31744
v_smfmac_f32_16x16x64_bf16 v[40:43], v[12:15], a[208:215], v0 abid:1
s_waitcnt lgkmcnt(2)
v_smfmac_f32_16x16x64_bf16 v[40:43], v[16:19], v[60:67], v0 abid:1
v_cvt_pk_bf16_f32 v76, v76, v77
v_cvt_pk_bf16_f32 v77, v78, v79
v_bfi_b32 v76, 1, s35, v76
buffer_store_dwordx2 v[76:77], v8, s[4:7], s43 offen sc0 sc1
v_smfmac_f32_16x16x64_bf16 v[40:43], v[52:55], a[216:223], v0 abid:1
s_waitcnt lgkmcnt(0)
v_smfmac_f32_16x16x64_bf16 v[40:43], v[56:59], v[68:75], v0 abid:1
v_smfmac_f32_16x16x64_bf16 v[36:39], v[12:15], a[224:231], v0 abid:1
v_smfmac_f32_16x16x64_bf16 v[36:39], v[16:19], a[232:239], v0 abid:1
v_cvt_pk_bf16_f32 v40, v40, v41
v_cvt_pk_bf16_f32 v41, v42, v43
v_bfi_b32 v40, 1, s35, v40
buffer_store_dwordx2 v[40:41], v8, s[4:7], s44 offen sc0 sc1
v_smfmac_f32_16x16x64_bf16 v[36:39], v[52:55], a[240:247], v0 abid:1
v_smfmac_f32_16x16x64_bf16 v[36:39], v[56:59], a[248:255], v0 abid:1
s_nop 7
v_cvt_pk_bf16_f32 v36, v36, v37
v_cvt_pk_bf16_f32 v37, v38, v39
v_bfi_b32 v36, 1, s35, v36
buffer_store_dwordx2 v[36:37], v8, s[4:7], s45 offen sc0 sc1
s_branch L_ex_w3rs
L_done_w3rs:
buffer_store_dword v11, v10, s[4:7], s40 offen sc0 sc1
s_waitcnt vmcnt(0) lgkmcnt(0)
s_endpgm
L_ra0_w3rs:
s_mov_b32 m0, 1024
s_nop 0
buffer_load_dwordx4 v1, s[4:7], s47 offen offset:0 sc0 sc1 lds
buffer_load_dwordx4 v1, s[4:7], s47 offen offset:1024 sc0 sc1 lds
buffer_load_dwordx4 v1, s[4:7], s47 offen offset:2048 sc0 sc1 lds
buffer_load_dwordx4 v1, s[4:7], s47 offen offset:3072 sc0 sc1 lds
s_sub_u32 s41, s41, 1
s_cbranch_scc1 L_exit
ds_read_b128 v[44:47], v2 offset:0
ds_read_b128 v[48:51], v2 offset:1024
v_mov_b64 v[20:21], 0
v_mov_b64 v[22:23], 0
v_mov_b64 v[24:25], 0
v_mov_b64 v[26:27], 0
v_mov_b64 v[28:29], 0
v_mov_b64 v[30:31], 0
v_mov_b64 v[32:33], 0
v_mov_b64 v[34:35], 0
v_mov_b64 v[36:37], 0
v_mov_b64 v[38:39], 0
v_mov_b64 v[40:41], 0
v_mov_b64 v[42:43], 0
s_waitcnt vmcnt(0)
ds_read_b128 v[60:63], v1 offset:1024
ds_read_b128 v[64:67], v1 offset:2048
ds_read_b128 v[68:71], v1 offset:3072
ds_read_b128 v[72:75], v1 offset:4096
s_branch L_s0_w3rs
L_ra1_w3rs:
s_waitcnt lgkmcnt(0)
s_barrier
s_mov_b32 m0, 5120
s_nop 0
buffer_load_dwordx4 v1, s[4:7], s48 offen offset:3072 sc0 sc1 lds
s_sub_u32 s41, s41, 1
s_cbranch_scc1 L_exit
s_waitcnt vmcnt(0)
s_barrier
ds_read_b128 v[76:79], v1 offset:5120
ds_read_b128 v[60:63], v1 offset:6144
ds_read_b128 v[64:67], v1 offset:7168
ds_read_b128 v[68:71], v1 offset:8192
ds_read_b128 v[72:75], v1 offset:9216
s_waitcnt lgkmcnt(0)
v_bitop3_b32 v6, v76, v60, s35 bitop3:0x7e
v_bitop3_b32 v6, v6, v64, s35 bitop3:0xf6
v_bitop3_b32 v6, v6, v68, s35 bitop3:0xf6
v_bitop3_b32 v6, v6, v72, s35 bitop3:0xf6
v_and_b32 v6, 1, v6
v_cmp_ne_u32 vcc, 0, v6
v_lshlrev_b32 v6, 2, v1
s_cbranch_vccnz L_ra1_w3rs
s_branch L_a1_w3rs
L_rr_w3rs:
buffer_load_dwordx4 v[60:63], v9, s[4:7], s3 offen offset:0 sc0 sc1
buffer_load_dwordx4 v[64:67], v9, s[4:7], s3 offen offset:1024 sc0 sc1
buffer_load_dwordx4 v[68:71], v9, s[4:7], s3 offen offset:2048 sc0 sc1
buffer_load_dwordx4 v[72:75], v9, s[4:7], s3 offen offset:3072 sc0 sc1
s_sub_u32 s41, s41, 1
s_cbranch_scc1 L_exit
s_waitcnt vmcnt(0)
s_branch L_r_w3rs
s_endpgm

.section .rodata,"a"
.p2align 6
.amdhsa_kernel gated_mix__sliding_local_dilated__memory_aug_recurrent_mem_tr__prompt_kernel
  .amdhsa_next_free_vgpr 512
  .amdhsa_next_free_sgpr 102
  .amdhsa_accum_offset 256
  .amdhsa_group_segment_fixed_size 0
  .amdhsa_kernarg_size 112
  .amdhsa_user_sgpr_count 2
  .amdhsa_user_sgpr_kernarg_segment_ptr 1
  .amdhsa_system_sgpr_workgroup_id_x 1
  .amdhsa_float_denorm_mode_32 3
.end_amdhsa_kernel
```

```asm
; @launch grid=(256,1,1) block=(256,1,1) lds=163840
.amdgcn_target "amdgcn-amd-amdhsa--gfx950"
.text
.globl gated_mix__sliding_local_dilated__memory_aug_recurrent_mem_tr__prompt_kernel
.p2align 8
.type gated_mix__sliding_local_dilated__memory_aug_recurrent_mem_tr__prompt_kernel,@function
gated_mix__sliding_local_dilated__memory_aug_recurrent_mem_tr__prompt_kernel:

s_cmp_ge_u32 s2, 256
s_cbranch_scc1 L_exit_w
s_and_b32 s3, s2, 7
s_lshr_b32 s32, s2, 3
s_cmp_eq_u32 s3, 0
s_cbranch_scc1 L_role_chain
s_cmp_ge_u32 s3, 5
s_cbranch_scc1 L_pre_aw
s_lshr_b32 s33, s32, 3
s_and_b32 s32, s32, 7
s_sub_u32 s3, s3, 1
s_lshl_b32 s3, s3, 3
s_add_u32 s32, s32, s3
s_branch L_role_q
L_pre_aw:
s_sub_u32 s3, s3, 5
s_lshl_b32 s49, s3, 5
s_add_u32 s49, s49, s32
s_lshr_b32 s33, s49, 3
s_and_b32 s32, s32, 7
s_mul_i32 s48, s49, 43
s_lshr_b32 s48, s48, 9
s_mul_i32 s3, s48, 12
s_sub_u32 s49, s49, s3
s_branch L_role_aw
L_exit_w:
s_endpgm
L_role_q:
s_load_dwordx2 s[4:5], s[0:1], 104
s_mov_b32 s6, 268435456
s_mov_b32 s7, 0x20000
s_load_dwordx2 s[8:9], s[0:1], 0
s_mov_b32 s10, 2359296
s_mov_b32 s11, 0x20000
s_load_dwordx2 s[12:13], s[0:1], 40
s_mov_b32 s14, 4718592
s_mov_b32 s15, 0x20000
s_load_dwordx2 s[16:17], s[0:1], 48
s_mov_b32 s18, 4718592
s_mov_b32 s19, 0x20000
s_load_dwordx2 s[20:21], s[0:1], 56
s_mov_b32 s22, 4718592
s_mov_b32 s23, 0x20000
s_load_dwordx2 s[24:25], s[0:1], 96
s_mov_b32 s26, 256
s_mov_b32 s27, 0x20000
v_and_b32 v9, 63, v0
v_and_b32 v10, 15, v0
v_bfe_u32 v11, v0, 4, 2
v_lshrrev_b32 v1, 6, v0
s_nop 0
v_readfirstlane_b32 s34, v1
v_lshrrev_b32 v12, 2, v9
v_mul_u32_u24 v2, 1152, v12
v_lshrrev_b32 v12, 5, v9
v_lshlrev_b32 v12, 1, v12
v_and_b32 v13, 3, v9
v_xor_b32 v12, v12, v13
v_lshl_add_u32 v2, v12, 4, v2
v_lshrrev_b32 v12, 3, v10
v_lshlrev_b32 v12, 1, v12
v_xor_b32 v12, v12, v11
v_lshlrev_b32 v12, 4, v12
v_lshl_add_u32 v3, v10, 6, v12
v_lshlrev_b32 v12, 13, v11
v_lshlrev_b32 v5, 1, v11
v_xor_b32 v5, v5, v10
v_lshl_add_u32 v5, v5, 4, v12
v_xor_b32 v6, 128, v5
v_lshlrev_b32 v1, 4, v9
s_mul_i32 s38, s34, 20480
s_add_u32 s38, s38, 73728
s_lshl_b32 s39, s32, 8
s_lshl_b32 s40, s34, 17
s_add_u32 s39, s39, s40
s_lshl_b32 s43, s33, 1
s_and_b32 s41, s34, 1
s_add_u32 s43, s43, s41
s_mul_i32 s43, s43, 18432
s_lshr_b32 s41, s34, 1
s_lshl_b32 s41, s41, 6
s_add_u32 s43, s43, s41
s_lshl_b32 s44, s34, 10
s_mov_b32 s36, 400000
s_mov_b32 s46, 0x3e0293ee
s_mov_b32 s47, 0x3e0293ee
v_mov_b32 v8, 0
v_lshrrev_b32 v12, 2, v10
v_lshlrev_b32 v4, 12, v12
v_lshl_add_u32 v4, v11, 8, v4
v_and_b32 v12, 3, v10
v_lshl_add_u32 v4, v12, 4, v4
s_waitcnt lgkmcnt(0)
s_add_u32 s37, s39, 0
s_add_u32 m0, s38, 0
s_nop 0
buffer_load_dwordx4 v5, s[12:15], s37 offen lds
s_add_u32 s37, s39, 32768
s_add_u32 m0, s38, 1024
s_nop 0
buffer_load_dwordx4 v5, s[12:15], s37 offen lds
s_add_u32 s37, s39, 65536
s_add_u32 m0, s38, 2048
s_nop 0
buffer_load_dwordx4 v6, s[12:15], s37 offen lds
s_add_u32 s37, s39, 98304
s_add_u32 m0, s38, 3072
s_nop 0
buffer_load_dwordx4 v6, s[12:15], s37 offen lds
s_add_u32 s37, s39, 524288
s_add_u32 m0, s38, 4096
s_nop 0
buffer_load_dwordx4 v5, s[12:15], s37 offen lds
s_add_u32 s37, s39, 557056
s_add_u32 m0, s38, 5120
s_nop 0
buffer_load_dwordx4 v5, s[12:15], s37 offen lds
s_add_u32 s37, s39, 589824
s_add_u32 m0, s38, 6144
s_nop 0
buffer_load_dwordx4 v6, s[12:15], s37 offen lds
s_add_u32 s37, s39, 622592
s_add_u32 m0, s38, 7168
s_nop 0
buffer_load_dwordx4 v6, s[12:15], s37 offen lds
s_add_u32 s37, s39, 1048576
s_add_u32 m0, s38, 8192
s_nop 0
buffer_load_dwordx4 v5, s[12:15], s37 offen lds
s_add_u32 s37, s39, 1081344
s_add_u32 m0, s38, 9216
s_nop 0
buffer_load_dwordx4 v5, s[12:15], s37 offen lds
s_add_u32 s37, s39, 1114112
s_add_u32 m0, s38, 10240
s_nop 0
buffer_load_dwordx4 v6, s[12:15], s37 offen lds
s_add_u32 s37, s39, 1146880
s_add_u32 m0, s38, 11264
s_nop 0
buffer_load_dwordx4 v6, s[12:15], s37 offen lds
s_add_u32 s37, s39, 1572864
s_add_u32 m0, s38, 12288
s_nop 0
buffer_load_dwordx4 v5, s[12:15], s37 offen lds
s_add_u32 s37, s39, 1605632
s_add_u32 m0, s38, 13312
s_nop 0
buffer_load_dwordx4 v5, s[12:15], s37 offen lds
s_add_u32 s37, s39, 1638400
s_add_u32 m0, s38, 14336
s_nop 0
buffer_load_dwordx4 v6, s[12:15], s37 offen lds
s_add_u32 s37, s39, 1671168
s_add_u32 m0, s38, 15360
s_nop 0
buffer_load_dwordx4 v6, s[12:15], s37 offen lds
s_add_u32 s37, s39, 2097152
s_add_u32 m0, s38, 16384
s_nop 0
buffer_load_dwordx4 v5, s[12:15], s37 offen lds
s_add_u32 s37, s39, 2129920
s_add_u32 m0, s38, 17408
s_nop 0
buffer_load_dwordx4 v5, s[12:15], s37 offen lds
s_add_u32 s37, s39, 2162688
s_add_u32 m0, s38, 18432
s_nop 0
buffer_load_dwordx4 v6, s[12:15], s37 offen lds
s_add_u32 s37, s39, 2195456
s_add_u32 m0, s38, 19456
s_nop 0
buffer_load_dwordx4 v6, s[12:15], s37 offen lds
s_add_u32 s37, s43, 0
s_add_u32 m0, s44, 0
s_nop 0
buffer_load_dwordx4 v2, s[8:11], s37 offen lds
s_add_u32 s37, s43, 128
s_add_u32 m0, s44, 4096
s_nop 0
buffer_load_dwordx4 v2, s[8:11], s37 offen lds
s_add_u32 s37, s43, 256
s_add_u32 m0, s44, 8192
s_nop 0
buffer_load_dwordx4 v2, s[8:11], s37 offen lds
s_add_u32 s37, s43, 384
s_add_u32 m0, s44, 12288
s_nop 0
buffer_load_dwordx4 v2, s[8:11], s37 offen lds
s_add_u32 s37, s43, 512
s_add_u32 m0, s44, 16384
s_nop 0
buffer_load_dwordx4 v2, s[8:11], s37 offen lds
s_add_u32 s37, s43, 640
s_add_u32 m0, s44, 20480
s_nop 0
buffer_load_dwordx4 v2, s[8:11], s37 offen lds
s_add_u32 s37, s43, 768
s_add_u32 m0, s44, 24576
s_nop 0
buffer_load_dwordx4 v2, s[8:11], s37 offen lds
s_add_u32 s37, s43, 896
s_add_u32 m0, s44, 28672
s_nop 0
buffer_load_dwordx4 v2, s[8:11], s37 offen lds
s_add_u32 s37, s43, 1024
s_add_u32 m0, s44, 32768
s_nop 0
buffer_load_dwordx4 v2, s[8:11], s37 offen lds
s_lshr_b32 s40, s34, 1
s_lshl_b32 s40, s40, 3
s_and_b32 s41, s34, 1
s_lshl_b32 s41, s41, 1
s_add_u32 s40, s40, s41
s_add_u32 s40, s40, 0
s_lshl_b32 s41, s34, 2
s_add_u32 s41, s41, 0
v_and_b32 v12, 1, v11
v_lshrrev_b32 v13, 2, v10
v_lshl_add_u32 v12, v12, 2, v13
v_lshlrev_b32 v12, 1, v12
v_bfe_u32 v16, v10, 1, 1
v_add_u32 v16, s40, v16
v_xor_b32 v16, v16, v12
v_lshlrev_b32 v16, 4, v16
v_lshl_add_u32 v16, v13, 8, v16
v_and_b32 v12, 1, v11
v_lshl_add_u32 v16, v12, 11, v16
v_and_b32 v12, 1, v10
v_lshl_add_u32 v16, v12, 3, v16
v_lshrrev_b32 v12, 1, v11
v_mul_u32_u24 v12, 20480, v12
v_add_u32 v12, 73728, v12
v_add_u32 v16, v16, v12
v_and_b32 v12, 1, v11
v_lshrrev_b32 v13, 2, v10
v_lshl_add_u32 v12, v12, 2, v13
v_lshlrev_b32 v12, 1, v12
v_bfe_u32 v20, v10, 1, 1
v_add_u32 v20, s41, v20
v_xor_b32 v20, v20, v12
v_lshlrev_b32 v20, 4, v20
v_lshl_add_u32 v20, v13, 8, v20
v_and_b32 v12, 1, v11
v_lshl_add_u32 v20, v12, 11, v20
v_and_b32 v12, 1, v10
v_lshl_add_u32 v20, v12, 3, v20
v_lshrrev_b32 v12, 1, v11
v_mul_u32_u24 v12, 20480, v12
v_add_u32 v12, 73728, v12
v_add_u32 v20, v20, v12
v_and_b32 v12, 1, v11
v_lshrrev_b32 v13, 2, v10
v_lshl_add_u32 v12, v12, 2, v13
v_lshlrev_b32 v12, 1, v12
v_bfe_u32 v18, v10, 1, 1
v_add_u32 v18, s40, v18
v_xor_b32 v18, v18, v12
v_lshlrev_b32 v18, 4, v18
v_lshl_add_u32 v18, v13, 8, v18
v_and_b32 v12, 1, v11
v_lshl_add_u32 v18, v12, 11, v18
v_and_b32 v12, 1, v10
v_lshl_add_u32 v18, v12, 3, v18
v_lshrrev_b32 v12, 1, v11
v_mul_u32_u24 v12, 20480, v12
v_add_u32 v12, 114688, v12
v_add_u32 v18, v18, v12
v_and_b32 v12, 1, v11
v_lshrrev_b32 v13, 2, v10
v_lshl_add_u32 v12, v12, 2, v13
v_lshlrev_b32 v12, 1, v12
v_bfe_u32 v22, v10, 1, 1
v_add_u32 v22, s41, v22
v_xor_b32 v22, v22, v12
v_lshlrev_b32 v22, 4, v22
v_lshl_add_u32 v22, v13, 8, v22
v_and_b32 v12, 1, v11
v_lshl_add_u32 v22, v12, 11, v22
v_and_b32 v12, 1, v10
v_lshl_add_u32 v22, v12, 3, v22
v_lshrrev_b32 v12, 1, v11
v_mul_u32_u24 v12, 20480, v12
v_add_u32 v12, 114688, v12
v_add_u32 v22, v22, v12
s_lshr_b32 s40, s34, 1
s_lshl_b32 s40, s40, 3
s_and_b32 s41, s34, 1
s_lshl_b32 s41, s41, 1
s_add_u32 s40, s40, s41
s_add_u32 s40, s40, 4
s_lshl_b32 s41, s34, 2
s_add_u32 s41, s41, 2
v_and_b32 v12, 1, v11
v_lshrrev_b32 v13, 2, v10
v_lshl_add_u32 v12, v12, 2, v13
v_lshlrev_b32 v12, 1, v12
v_bfe_u32 v17, v10, 1, 1
v_add_u32 v17, s40, v17
v_xor_b32 v17, v17, v12
v_lshlrev_b32 v17, 4, v17
v_lshl_add_u32 v17, v13, 8, v17
v_and_b32 v12, 1, v11
v_lshl_add_u32 v17, v12, 11, v17
v_and_b32 v12, 1, v10
v_lshl_add_u32 v17, v12, 3, v17
v_lshrrev_b32 v12, 1, v11
v_mul_u32_u24 v12, 20480, v12
v_add_u32 v12, 73728, v12
v_add_u32 v17, v17, v12
v_and_b32 v12, 1, v11
v_lshrrev_b32 v13, 2, v10
v_lshl_add_u32 v12, v12, 2, v13
v_lshlrev_b32 v12, 1, v12
v_bfe_u32 v21, v10, 1, 1
v_add_u32 v21, s41, v21
v_xor_b32 v21, v21, v12
v_lshlrev_b32 v21, 4, v21
v_lshl_add_u32 v21, v13, 8, v21
v_and_b32 v12, 1, v11
v_lshl_add_u32 v21, v12, 11, v21
v_and_b32 v12, 1, v10
v_lshl_add_u32 v21, v12, 3, v21
v_lshrrev_b32 v12, 1, v11
v_mul_u32_u24 v12, 20480, v12
v_add_u32 v12, 73728, v12
v_add_u32 v21, v21, v12
v_and_b32 v12, 1, v11
v_lshrrev_b32 v13, 2, v10
v_lshl_add_u32 v12, v12, 2, v13
v_lshlrev_b32 v12, 1, v12
v_bfe_u32 v19, v10, 1, 1
v_add_u32 v19, s40, v19
v_xor_b32 v19, v19, v12
v_lshlrev_b32 v19, 4, v19
v_lshl_add_u32 v19, v13, 8, v19
v_and_b32 v12, 1, v11
v_lshl_add_u32 v19, v12, 11, v19
v_and_b32 v12, 1, v10
v_lshl_add_u32 v19, v12, 3, v19
v_lshrrev_b32 v12, 1, v11
v_mul_u32_u24 v12, 20480, v12
v_add_u32 v12, 114688, v12
v_add_u32 v19, v19, v12
v_and_b32 v12, 1, v11
v_lshrrev_b32 v13, 2, v10
v_lshl_add_u32 v12, v12, 2, v13
v_lshlrev_b32 v12, 1, v12
v_bfe_u32 v23, v10, 1, 1
v_add_u32 v23, s41, v23
v_xor_b32 v23, v23, v12
v_lshlrev_b32 v23, 4, v23
v_lshl_add_u32 v23, v13, 8, v23
v_and_b32 v12, 1, v11
v_lshl_add_u32 v23, v12, 11, v23
v_and_b32 v12, 1, v10
v_lshl_add_u32 v23, v12, 3, v23
v_lshrrev_b32 v12, 1, v11
v_mul_u32_u24 v12, 20480, v12
v_add_u32 v12, 114688, v12
v_add_u32 v23, v23, v12
s_waitcnt vmcnt(25)
s_barrier
ds_read_b64_tr_b16 v[80:81], v16 offset:0
ds_read_b64_tr_b16 v[82:83], v16 offset:1024
ds_read_b64_tr_b16 v[84:85], v18 offset:0
ds_read_b64_tr_b16 v[86:87], v18 offset:1024
ds_read_b64_tr_b16 v[152:153], v17 offset:0
ds_read_b64_tr_b16 v[154:155], v17 offset:1024
ds_read_b64_tr_b16 v[156:157], v19 offset:0
ds_read_b64_tr_b16 v[158:159], v19 offset:1024
s_waitcnt lgkmcnt(0)
s_waitcnt vmcnt(21)
s_barrier
s_add_u32 s37, s39, 2621440
s_add_u32 m0, s38, 0
s_nop 0
buffer_load_dwordx4 v5, s[12:15], s37 offen lds
s_add_u32 s37, s39, 2654208
s_add_u32 m0, s38, 1024
s_nop 0
buffer_load_dwordx4 v5, s[12:15], s37 offen lds
s_add_u32 s37, s39, 2686976
s_add_u32 m0, s38, 2048
s_nop 0
buffer_load_dwordx4 v6, s[12:15], s37 offen lds
s_add_u32 s37, s39, 2719744
s_add_u32 m0, s38, 3072
s_nop 0
buffer_load_dwordx4 v6, s[12:15], s37 offen lds
ds_read_b64_tr_b16 v[88:89], v16 offset:4096
ds_read_b64_tr_b16 v[90:91], v16 offset:5120
ds_read_b64_tr_b16 v[92:93], v18 offset:4096
ds_read_b64_tr_b16 v[94:95], v18 offset:5120
ds_read_b64_tr_b16 v[160:161], v17 offset:4096
ds_read_b64_tr_b16 v[162:163], v17 offset:5120
ds_read_b64_tr_b16 v[164:165], v19 offset:4096
ds_read_b64_tr_b16 v[166:167], v19 offset:5120
s_waitcnt lgkmcnt(0)
s_waitcnt vmcnt(21)
s_barrier
s_add_u32 s37, s39, 3145728
s_add_u32 m0, s38, 4096
s_nop 0
buffer_load_dwordx4 v5, s[12:15], s37 offen lds
s_add_u32 s37, s39, 3178496
s_add_u32 m0, s38, 5120
s_nop 0
buffer_load_dwordx4 v5, s[12:15], s37 offen lds
s_add_u32 s37, s39, 3211264
s_add_u32 m0, s38, 6144
s_nop 0
buffer_load_dwordx4 v6, s[12:15], s37 offen lds
s_add_u32 s37, s39, 3244032
s_add_u32 m0, s38, 7168
s_nop 0
buffer_load_dwordx4 v6, s[12:15], s37 offen lds
ds_read_b64_tr_b16 v[96:97], v16 offset:8192
ds_read_b64_tr_b16 v[98:99], v16 offset:9216
ds_read_b64_tr_b16 v[100:101], v18 offset:8192
ds_read_b64_tr_b16 v[102:103], v18 offset:9216
ds_read_b64_tr_b16 v[168:169], v17 offset:8192
ds_read_b64_tr_b16 v[170:171], v17 offset:9216
ds_read_b64_tr_b16 v[172:173], v19 offset:8192
ds_read_b64_tr_b16 v[174:175], v19 offset:9216
s_waitcnt lgkmcnt(0)
s_waitcnt vmcnt(21)
s_barrier
s_add_u32 s37, s39, 3670016
s_add_u32 m0, s38, 8192
s_nop 0
buffer_load_dwordx4 v5, s[12:15], s37 offen lds
s_add_u32 s37, s39, 3702784
s_add_u32 m0, s38, 9216
s_nop 0
buffer_load_dwordx4 v5, s[12:15], s37 offen lds
s_add_u32 s37, s39, 3735552
s_add_u32 m0, s38, 10240
s_nop 0
buffer_load_dwordx4 v6, s[12:15], s37 offen lds
s_add_u32 s37, s39, 3768320
s_add_u32 m0, s38, 11264
s_nop 0
buffer_load_dwordx4 v6, s[12:15], s37 offen lds
ds_read_b64_tr_b16 v[104:105], v16 offset:12288
ds_read_b64_tr_b16 v[106:107], v16 offset:13312
ds_read_b64_tr_b16 v[108:109], v18 offset:12288
ds_read_b64_tr_b16 v[110:111], v18 offset:13312
ds_read_b64_tr_b16 v[176:177], v17 offset:12288
ds_read_b64_tr_b16 v[178:179], v17 offset:13312
ds_read_b64_tr_b16 v[180:181], v19 offset:12288
ds_read_b64_tr_b16 v[182:183], v19 offset:13312
s_waitcnt lgkmcnt(0)
s_waitcnt vmcnt(21)
s_barrier
s_add_u32 s37, s39, 4194304
s_add_u32 m0, s38, 12288
s_nop 0
buffer_load_dwordx4 v5, s[12:15], s37 offen lds
s_add_u32 s37, s39, 4227072
s_add_u32 m0, s38, 13312
s_nop 0
buffer_load_dwordx4 v5, s[12:15], s37 offen lds
s_add_u32 s37, s39, 4259840
s_add_u32 m0, s38, 14336
s_nop 0
buffer_load_dwordx4 v6, s[12:15], s37 offen lds
s_add_u32 s37, s39, 4292608
s_add_u32 m0, s38, 15360
s_nop 0
buffer_load_dwordx4 v6, s[12:15], s37 offen lds
ds_read_b64_tr_b16 v[112:113], v16 offset:16384
ds_read_b64_tr_b16 v[114:115], v16 offset:17408
ds_read_b64_tr_b16 v[116:117], v18 offset:16384
ds_read_b64_tr_b16 v[118:119], v18 offset:17408
ds_read_b64_tr_b16 v[184:185], v17 offset:16384
ds_read_b64_tr_b16 v[186:187], v17 offset:17408
ds_read_b64_tr_b16 v[188:189], v19 offset:16384
ds_read_b64_tr_b16 v[190:191], v19 offset:17408
s_waitcnt lgkmcnt(0)
s_waitcnt vmcnt(12)
s_barrier
s_add_u32 s37, s39, 0
s_add_u32 m0, s38, 16384
s_nop 0
buffer_load_dwordx4 v5, s[16:19], s37 offen lds
s_add_u32 s37, s39, 32768
s_add_u32 m0, s38, 17408
s_nop 0
buffer_load_dwordx4 v5, s[16:19], s37 offen lds
s_add_u32 s37, s39, 65536
s_add_u32 m0, s38, 18432
s_nop 0
buffer_load_dwordx4 v6, s[16:19], s37 offen lds
s_add_u32 s37, s39, 98304
s_add_u32 m0, s38, 19456
s_nop 0
buffer_load_dwordx4 v6, s[16:19], s37 offen lds
ds_read_b64_tr_b16 v[120:121], v16 offset:0
ds_read_b64_tr_b16 v[122:123], v16 offset:1024
ds_read_b64_tr_b16 v[124:125], v18 offset:0
ds_read_b64_tr_b16 v[126:127], v18 offset:1024
ds_read_b64_tr_b16 v[192:193], v17 offset:0
ds_read_b64_tr_b16 v[194:195], v17 offset:1024
ds_read_b64_tr_b16 v[196:197], v19 offset:0
ds_read_b64_tr_b16 v[198:199], v19 offset:1024
s_waitcnt lgkmcnt(0)
s_waitcnt vmcnt(12)
s_barrier
s_add_u32 s37, s39, 524288
s_add_u32 m0, s38, 0
s_nop 0
buffer_load_dwordx4 v5, s[16:19], s37 offen lds
s_add_u32 s37, s39, 557056
s_add_u32 m0, s38, 1024
s_nop 0
buffer_load_dwordx4 v5, s[16:19], s37 offen lds
s_add_u32 s37, s39, 589824
s_add_u32 m0, s38, 2048
s_nop 0
buffer_load_dwordx4 v6, s[16:19], s37 offen lds
s_add_u32 s37, s39, 622592
s_add_u32 m0, s38, 3072
s_nop 0
buffer_load_dwordx4 v6, s[16:19], s37 offen lds
ds_read_b64_tr_b16 v[128:129], v16 offset:4096
ds_read_b64_tr_b16 v[130:131], v16 offset:5120
ds_read_b64_tr_b16 v[132:133], v18 offset:4096
ds_read_b64_tr_b16 v[134:135], v18 offset:5120
ds_read_b64_tr_b16 v[200:201], v17 offset:4096
ds_read_b64_tr_b16 v[202:203], v17 offset:5120
ds_read_b64_tr_b16 v[204:205], v19 offset:4096
ds_read_b64_tr_b16 v[206:207], v19 offset:5120
s_waitcnt lgkmcnt(0)
s_waitcnt vmcnt(12)
s_barrier
s_add_u32 s37, s39, 1048576
s_add_u32 m0, s38, 4096
s_nop 0
buffer_load_dwordx4 v5, s[16:19], s37 offen lds
s_add_u32 s37, s39, 1081344
s_add_u32 m0, s38, 5120
s_nop 0
buffer_load_dwordx4 v5, s[16:19], s37 offen lds
s_add_u32 s37, s39, 1114112
s_add_u32 m0, s38, 6144
s_nop 0
buffer_load_dwordx4 v6, s[16:19], s37 offen lds
s_add_u32 s37, s39, 1146880
s_add_u32 m0, s38, 7168
s_nop 0
buffer_load_dwordx4 v6, s[16:19], s37 offen lds
ds_read_b64_tr_b16 v[136:137], v16 offset:8192
ds_read_b64_tr_b16 v[138:139], v16 offset:9216
ds_read_b64_tr_b16 v[140:141], v18 offset:8192
ds_read_b64_tr_b16 v[142:143], v18 offset:9216
ds_read_b64_tr_b16 v[208:209], v17 offset:8192
ds_read_b64_tr_b16 v[210:211], v17 offset:9216
ds_read_b64_tr_b16 v[212:213], v19 offset:8192
ds_read_b64_tr_b16 v[214:215], v19 offset:9216
s_waitcnt lgkmcnt(0)
s_waitcnt vmcnt(12)
s_barrier
s_add_u32 s37, s39, 1572864
s_add_u32 m0, s38, 8192
s_nop 0
buffer_load_dwordx4 v5, s[16:19], s37 offen lds
s_add_u32 s37, s39, 1605632
s_add_u32 m0, s38, 9216
s_nop 0
buffer_load_dwordx4 v5, s[16:19], s37 offen lds
s_add_u32 s37, s39, 1638400
s_add_u32 m0, s38, 10240
s_nop 0
buffer_load_dwordx4 v6, s[16:19], s37 offen lds
s_add_u32 s37, s39, 1671168
s_add_u32 m0, s38, 11264
s_nop 0
buffer_load_dwordx4 v6, s[16:19], s37 offen lds
ds_read_b64_tr_b16 v[144:145], v16 offset:12288
ds_read_b64_tr_b16 v[146:147], v16 offset:13312
ds_read_b64_tr_b16 v[148:149], v18 offset:12288
ds_read_b64_tr_b16 v[150:151], v18 offset:13312
ds_read_b64_tr_b16 v[216:217], v17 offset:12288
ds_read_b64_tr_b16 v[218:219], v17 offset:13312
ds_read_b64_tr_b16 v[220:221], v19 offset:12288
ds_read_b64_tr_b16 v[222:223], v19 offset:13312
s_waitcnt lgkmcnt(0)
s_waitcnt vmcnt(12)
s_barrier
s_add_u32 s37, s39, 2097152
s_add_u32 m0, s38, 12288
s_nop 0
buffer_load_dwordx4 v5, s[16:19], s37 offen lds
s_add_u32 s37, s39, 2129920
s_add_u32 m0, s38, 13312
s_nop 0
buffer_load_dwordx4 v5, s[16:19], s37 offen lds
s_add_u32 s37, s39, 2162688
s_add_u32 m0, s38, 14336
s_nop 0
buffer_load_dwordx4 v6, s[16:19], s37 offen lds
s_add_u32 s37, s39, 2195456
s_add_u32 m0, s38, 15360
s_nop 0
buffer_load_dwordx4 v6, s[16:19], s37 offen lds
ds_read_b64_tr_b16 v[224:225], v16 offset:16384
ds_read_b64_tr_b16 v[226:227], v16 offset:17408
ds_read_b64_tr_b16 v[228:229], v18 offset:16384
ds_read_b64_tr_b16 v[230:231], v18 offset:17408
ds_read_b64_tr_b16 a[40:41], v17 offset:16384
ds_read_b64_tr_b16 a[42:43], v17 offset:17408
ds_read_b64_tr_b16 a[44:45], v19 offset:16384
ds_read_b64_tr_b16 a[46:47], v19 offset:17408
s_waitcnt lgkmcnt(0)
s_waitcnt vmcnt(12)
s_barrier
s_add_u32 s37, s39, 2621440
s_add_u32 m0, s38, 16384
s_nop 0
buffer_load_dwordx4 v5, s[16:19], s37 offen lds
s_add_u32 s37, s39, 2654208
s_add_u32 m0, s38, 17408
s_nop 0
buffer_load_dwordx4 v5, s[16:19], s37 offen lds
s_add_u32 s37, s39, 2686976
s_add_u32 m0, s38, 18432
s_nop 0
buffer_load_dwordx4 v6, s[16:19], s37 offen lds
s_add_u32 s37, s39, 2719744
s_add_u32 m0, s38, 19456
s_nop 0
buffer_load_dwordx4 v6, s[16:19], s37 offen lds
ds_read_b64_tr_b16 v[232:233], v16 offset:0
ds_read_b64_tr_b16 v[234:235], v16 offset:1024
ds_read_b64_tr_b16 v[236:237], v18 offset:0
ds_read_b64_tr_b16 v[238:239], v18 offset:1024
ds_read_b64_tr_b16 a[48:49], v17 offset:0
ds_read_b64_tr_b16 a[50:51], v17 offset:1024
ds_read_b64_tr_b16 a[52:53], v19 offset:0
ds_read_b64_tr_b16 a[54:55], v19 offset:1024
s_waitcnt lgkmcnt(0)
s_waitcnt vmcnt(12)
s_barrier
s_add_u32 s37, s39, 3145728
s_add_u32 m0, s38, 0
s_nop 0
buffer_load_dwordx4 v5, s[16:19], s37 offen lds
s_add_u32 s37, s39, 3178496
s_add_u32 m0, s38, 1024
s_nop 0
buffer_load_dwordx4 v5, s[16:19], s37 offen lds
s_add_u32 s37, s39, 3211264
s_add_u32 m0, s38, 2048
s_nop 0
buffer_load_dwordx4 v6, s[16:19], s37 offen lds
s_add_u32 s37, s39, 3244032
s_add_u32 m0, s38, 3072
s_nop 0
buffer_load_dwordx4 v6, s[16:19], s37 offen lds
ds_read_b64_tr_b16 v[240:241], v16 offset:4096
ds_read_b64_tr_b16 v[242:243], v16 offset:5120
ds_read_b64_tr_b16 v[244:245], v18 offset:4096
ds_read_b64_tr_b16 v[246:247], v18 offset:5120
ds_read_b64_tr_b16 a[56:57], v17 offset:4096
ds_read_b64_tr_b16 a[58:59], v17 offset:5120
ds_read_b64_tr_b16 a[60:61], v19 offset:4096
ds_read_b64_tr_b16 a[62:63], v19 offset:5120
s_waitcnt lgkmcnt(0)
s_waitcnt vmcnt(12)
s_barrier
s_add_u32 s37, s39, 3670016
s_add_u32 m0, s38, 4096
s_nop 0
buffer_load_dwordx4 v5, s[16:19], s37 offen lds
s_add_u32 s37, s39, 3702784
s_add_u32 m0, s38, 5120
s_nop 0
buffer_load_dwordx4 v5, s[16:19], s37 offen lds
s_add_u32 s37, s39, 3735552
s_add_u32 m0, s38, 6144
s_nop 0
buffer_load_dwordx4 v6, s[16:19], s37 offen lds
s_add_u32 s37, s39, 3768320
s_add_u32 m0, s38, 7168
s_nop 0
buffer_load_dwordx4 v6, s[16:19], s37 offen lds
ds_read_b64_tr_b16 v[248:249], v16 offset:8192
ds_read_b64_tr_b16 v[250:251], v16 offset:9216
ds_read_b64_tr_b16 v[252:253], v18 offset:8192
ds_read_b64_tr_b16 v[254:255], v18 offset:9216
ds_read_b64_tr_b16 a[64:65], v17 offset:8192
ds_read_b64_tr_b16 a[66:67], v17 offset:9216
ds_read_b64_tr_b16 a[68:69], v19 offset:8192
ds_read_b64_tr_b16 a[70:71], v19 offset:9216
s_waitcnt lgkmcnt(0)
s_waitcnt vmcnt(12)
s_barrier
s_add_u32 s37, s39, 4194304
s_add_u32 m0, s38, 8192
s_nop 0
buffer_load_dwordx4 v5, s[16:19], s37 offen lds
s_add_u32 s37, s39, 4227072
s_add_u32 m0, s38, 9216
s_nop 0
buffer_load_dwordx4 v5, s[16:19], s37 offen lds
s_add_u32 s37, s39, 4259840
s_add_u32 m0, s38, 10240
s_nop 0
buffer_load_dwordx4 v6, s[16:19], s37 offen lds
s_add_u32 s37, s39, 4292608
s_add_u32 m0, s38, 11264
s_nop 0
buffer_load_dwordx4 v6, s[16:19], s37 offen lds
ds_read_b64_tr_b16 a[0:1], v16 offset:12288
ds_read_b64_tr_b16 a[2:3], v16 offset:13312
ds_read_b64_tr_b16 a[4:5], v18 offset:12288
ds_read_b64_tr_b16 a[6:7], v18 offset:13312
ds_read_b64_tr_b16 a[72:73], v17 offset:12288
ds_read_b64_tr_b16 a[74:75], v17 offset:13312
ds_read_b64_tr_b16 a[76:77], v19 offset:12288
ds_read_b64_tr_b16 a[78:79], v19 offset:13312
s_waitcnt lgkmcnt(0)
s_waitcnt vmcnt(12)
s_barrier
s_add_u32 s37, s39, 0
s_add_u32 m0, s38, 12288
s_nop 0
buffer_load_dwordx4 v5, s[20:23], s37 offen lds
s_add_u32 s37, s39, 32768
s_add_u32 m0, s38, 13312
s_nop 0
buffer_load_dwordx4 v5, s[20:23], s37 offen lds
s_add_u32 s37, s39, 65536
s_add_u32 m0, s38, 14336
s_nop 0
buffer_load_dwordx4 v6, s[20:23], s37 offen lds
s_add_u32 s37, s39, 98304
s_add_u32 m0, s38, 15360
s_nop 0
buffer_load_dwordx4 v6, s[20:23], s37 offen lds
ds_read_b64_tr_b16 a[8:9], v16 offset:16384
ds_read_b64_tr_b16 a[10:11], v16 offset:17408
ds_read_b64_tr_b16 a[12:13], v18 offset:16384
ds_read_b64_tr_b16 a[14:15], v18 offset:17408
ds_read_b64_tr_b16 a[80:81], v17 offset:16384
ds_read_b64_tr_b16 a[82:83], v17 offset:17408
ds_read_b64_tr_b16 a[84:85], v19 offset:16384
ds_read_b64_tr_b16 a[86:87], v19 offset:17408
s_waitcnt lgkmcnt(0)
s_waitcnt vmcnt(12)
s_barrier
s_add_u32 s37, s39, 524288
s_add_u32 m0, s38, 16384
s_nop 0
buffer_load_dwordx4 v5, s[20:23], s37 offen lds
s_add_u32 s37, s39, 557056
s_add_u32 m0, s38, 17408
s_nop 0
buffer_load_dwordx4 v5, s[20:23], s37 offen lds
s_add_u32 s37, s39, 589824
s_add_u32 m0, s38, 18432
s_nop 0
buffer_load_dwordx4 v6, s[20:23], s37 offen lds
s_add_u32 s37, s39, 622592
s_add_u32 m0, s38, 19456
s_nop 0
buffer_load_dwordx4 v6, s[20:23], s37 offen lds
ds_read_b64_tr_b16 a[16:17], v16 offset:0
ds_read_b64_tr_b16 a[18:19], v16 offset:1024
ds_read_b64_tr_b16 a[20:21], v18 offset:0
ds_read_b64_tr_b16 a[22:23], v18 offset:1024
ds_read_b64_tr_b16 a[88:89], v17 offset:0
ds_read_b64_tr_b16 a[90:91], v17 offset:1024
ds_read_b64_tr_b16 a[92:93], v19 offset:0
ds_read_b64_tr_b16 a[94:95], v19 offset:1024
s_waitcnt lgkmcnt(0)
s_waitcnt vmcnt(12)
s_barrier
s_add_u32 s37, s39, 1048576
s_add_u32 m0, s38, 0
s_nop 0
buffer_load_dwordx4 v5, s[20:23], s37 offen lds
s_add_u32 s37, s39, 1081344
s_add_u32 m0, s38, 1024
s_nop 0
buffer_load_dwordx4 v5, s[20:23], s37 offen lds
s_add_u32 s37, s39, 1114112
s_add_u32 m0, s38, 2048
s_nop 0
buffer_load_dwordx4 v6, s[20:23], s37 offen lds
s_add_u32 s37, s39, 1146880
s_add_u32 m0, s38, 3072
s_nop 0
buffer_load_dwordx4 v6, s[20:23], s37 offen lds
ds_read_b64_tr_b16 a[24:25], v16 offset:4096
ds_read_b64_tr_b16 a[26:27], v16 offset:5120
ds_read_b64_tr_b16 a[28:29], v18 offset:4096
ds_read_b64_tr_b16 a[30:31], v18 offset:5120
ds_read_b64_tr_b16 a[96:97], v17 offset:4096
ds_read_b64_tr_b16 a[98:99], v17 offset:5120
ds_read_b64_tr_b16 a[100:101], v19 offset:4096
ds_read_b64_tr_b16 a[102:103], v19 offset:5120
s_waitcnt lgkmcnt(0)
s_waitcnt vmcnt(12)
s_barrier
s_add_u32 s37, s39, 1572864
s_add_u32 m0, s38, 4096
s_nop 0
buffer_load_dwordx4 v5, s[20:23], s37 offen lds
s_add_u32 s37, s39, 1605632
s_add_u32 m0, s38, 5120
s_nop 0
buffer_load_dwordx4 v5, s[20:23], s37 offen lds
s_add_u32 s37, s39, 1638400
s_add_u32 m0, s38, 6144
s_nop 0
buffer_load_dwordx4 v6, s[20:23], s37 offen lds
s_add_u32 s37, s39, 1671168
s_add_u32 m0, s38, 7168
s_nop 0
buffer_load_dwordx4 v6, s[20:23], s37 offen lds
ds_read_b64_tr_b16 a[32:33], v16 offset:8192
ds_read_b64_tr_b16 a[34:35], v16 offset:9216
ds_read_b64_tr_b16 a[36:37], v18 offset:8192
ds_read_b64_tr_b16 a[38:39], v18 offset:9216
ds_read_b64_tr_b16 a[104:105], v17 offset:8192
ds_read_b64_tr_b16 a[106:107], v17 offset:9216
ds_read_b64_tr_b16 a[108:109], v19 offset:8192
ds_read_b64_tr_b16 a[110:111], v19 offset:9216
s_waitcnt lgkmcnt(0)
s_waitcnt vmcnt(12)
s_barrier
s_add_u32 s37, s39, 2097152
s_add_u32 m0, s38, 8192
s_nop 0
buffer_load_dwordx4 v5, s[20:23], s37 offen lds
s_add_u32 s37, s39, 2129920
s_add_u32 m0, s38, 9216
s_nop 0
buffer_load_dwordx4 v5, s[20:23], s37 offen lds
s_add_u32 s37, s39, 2162688
s_add_u32 m0, s38, 10240
s_nop 0
buffer_load_dwordx4 v6, s[20:23], s37 offen lds
s_add_u32 s37, s39, 2195456
s_add_u32 m0, s38, 11264
s_nop 0
buffer_load_dwordx4 v6, s[20:23], s37 offen lds
ds_read_b64_tr_b16 a[112:113], v20 offset:12288
ds_read_b64_tr_b16 a[114:115], v20 offset:13312
ds_read_b64_tr_b16 a[116:117], v22 offset:12288
ds_read_b64_tr_b16 a[118:119], v22 offset:13312
ds_read_b64_tr_b16 a[184:185], v21 offset:12288
ds_read_b64_tr_b16 a[186:187], v21 offset:13312
ds_read_b64_tr_b16 a[188:189], v23 offset:12288
ds_read_b64_tr_b16 a[190:191], v23 offset:13312
s_waitcnt lgkmcnt(0)
s_waitcnt vmcnt(12)
s_barrier
s_add_u32 s37, s39, 2621440
s_add_u32 m0, s38, 12288
s_nop 0
buffer_load_dwordx4 v5, s[20:23], s37 offen lds
s_add_u32 s37, s39, 2654208
s_add_u32 m0, s38, 13312
s_nop 0
buffer_load_dwordx4 v5, s[20:23], s37 offen lds
s_add_u32 s37, s39, 2686976
s_add_u32 m0, s38, 14336
s_nop 0
buffer_load_dwordx4 v6, s[20:23], s37 offen lds
s_add_u32 s37, s39, 2719744
s_add_u32 m0, s38, 15360
s_nop 0
buffer_load_dwordx4 v6, s[20:23], s37 offen lds
ds_read_b64_tr_b16 a[120:121], v20 offset:16384
ds_read_b64_tr_b16 a[122:123], v20 offset:17408
ds_read_b64_tr_b16 a[124:125], v22 offset:16384
ds_read_b64_tr_b16 a[126:127], v22 offset:17408
ds_read_b64_tr_b16 a[192:193], v21 offset:16384
ds_read_b64_tr_b16 a[194:195], v21 offset:17408
ds_read_b64_tr_b16 a[196:197], v23 offset:16384
ds_read_b64_tr_b16 a[198:199], v23 offset:17408
s_waitcnt lgkmcnt(0)
s_waitcnt vmcnt(12)
s_barrier
s_add_u32 s37, s39, 3145728
s_add_u32 m0, s38, 16384
s_nop 0
buffer_load_dwordx4 v5, s[20:23], s37 offen lds
s_add_u32 s37, s39, 3178496
s_add_u32 m0, s38, 17408
s_nop 0
buffer_load_dwordx4 v5, s[20:23], s37 offen lds
s_add_u32 s37, s39, 3211264
s_add_u32 m0, s38, 18432
s_nop 0
buffer_load_dwordx4 v6, s[20:23], s37 offen lds
s_add_u32 s37, s39, 3244032
s_add_u32 m0, s38, 19456
s_nop 0
buffer_load_dwordx4 v6, s[20:23], s37 offen lds
ds_read_b64_tr_b16 a[128:129], v20 offset:0
ds_read_b64_tr_b16 a[130:131], v20 offset:1024
ds_read_b64_tr_b16 a[132:133], v22 offset:0
ds_read_b64_tr_b16 a[134:135], v22 offset:1024
ds_read_b64_tr_b16 a[200:201], v21 offset:0
ds_read_b64_tr_b16 a[202:203], v21 offset:1024
ds_read_b64_tr_b16 a[204:205], v23 offset:0
ds_read_b64_tr_b16 a[206:207], v23 offset:1024
s_waitcnt lgkmcnt(0)
s_waitcnt vmcnt(12)
s_barrier
s_add_u32 s37, s39, 3670016
s_add_u32 m0, s38, 0
s_nop 0
buffer_load_dwordx4 v5, s[20:23], s37 offen lds
s_add_u32 s37, s39, 3702784
s_add_u32 m0, s38, 1024
s_nop 0
buffer_load_dwordx4 v5, s[20:23], s37 offen lds
s_add_u32 s37, s39, 3735552
s_add_u32 m0, s38, 2048
s_nop 0
buffer_load_dwordx4 v6, s[20:23], s37 offen lds
s_add_u32 s37, s39, 3768320
s_add_u32 m0, s38, 3072
s_nop 0
buffer_load_dwordx4 v6, s[20:23], s37 offen lds
ds_read_b64_tr_b16 a[136:137], v20 offset:4096
ds_read_b64_tr_b16 a[138:139], v20 offset:5120
ds_read_b64_tr_b16 a[140:141], v22 offset:4096
ds_read_b64_tr_b16 a[142:143], v22 offset:5120
ds_read_b64_tr_b16 a[208:209], v21 offset:4096
ds_read_b64_tr_b16 a[210:211], v21 offset:5120
ds_read_b64_tr_b16 a[212:213], v23 offset:4096
ds_read_b64_tr_b16 a[214:215], v23 offset:5120
s_waitcnt lgkmcnt(0)
s_waitcnt vmcnt(12)
s_barrier
s_add_u32 s37, s39, 4194304
s_add_u32 m0, s38, 4096
s_nop 0
buffer_load_dwordx4 v5, s[20:23], s37 offen lds
s_add_u32 s37, s39, 4227072
s_add_u32 m0, s38, 5120
s_nop 0
buffer_load_dwordx4 v5, s[20:23], s37 offen lds
s_add_u32 s37, s39, 4259840
s_add_u32 m0, s38, 6144
s_nop 0
buffer_load_dwordx4 v6, s[20:23], s37 offen lds
s_add_u32 s37, s39, 4292608
s_add_u32 m0, s38, 7168
s_nop 0
buffer_load_dwordx4 v6, s[20:23], s37 offen lds
ds_read_b64_tr_b16 a[144:145], v20 offset:8192
ds_read_b64_tr_b16 a[146:147], v20 offset:9216
ds_read_b64_tr_b16 a[148:149], v22 offset:8192
ds_read_b64_tr_b16 a[150:151], v22 offset:9216
ds_read_b64_tr_b16 a[216:217], v21 offset:8192
ds_read_b64_tr_b16 a[218:219], v21 offset:9216
ds_read_b64_tr_b16 a[220:221], v23 offset:8192
ds_read_b64_tr_b16 a[222:223], v23 offset:9216
s_waitcnt lgkmcnt(0)
s_waitcnt vmcnt(12)
s_barrier
ds_read_b64_tr_b16 a[152:153], v20 offset:12288
ds_read_b64_tr_b16 a[154:155], v20 offset:13312
ds_read_b64_tr_b16 a[156:157], v22 offset:12288
ds_read_b64_tr_b16 a[158:159], v22 offset:13312
ds_read_b64_tr_b16 a[224:225], v21 offset:12288
ds_read_b64_tr_b16 a[226:227], v21 offset:13312
ds_read_b64_tr_b16 a[228:229], v23 offset:12288
ds_read_b64_tr_b16 a[230:231], v23 offset:13312
s_waitcnt lgkmcnt(0)
s_waitcnt vmcnt(8)
s_barrier
ds_read_b64_tr_b16 a[160:161], v20 offset:16384
ds_read_b64_tr_b16 a[162:163], v20 offset:17408
ds_read_b64_tr_b16 a[164:165], v22 offset:16384
ds_read_b64_tr_b16 a[166:167], v22 offset:17408
ds_read_b64_tr_b16 a[232:233], v21 offset:16384
ds_read_b64_tr_b16 a[234:235], v21 offset:17408
ds_read_b64_tr_b16 a[236:237], v23 offset:16384
ds_read_b64_tr_b16 a[238:239], v23 offset:17408
s_waitcnt lgkmcnt(0)
s_waitcnt vmcnt(4)
s_barrier
ds_read_b64_tr_b16 a[168:169], v20 offset:0
ds_read_b64_tr_b16 a[170:171], v20 offset:1024
ds_read_b64_tr_b16 a[172:173], v22 offset:0
ds_read_b64_tr_b16 a[174:175], v22 offset:1024
ds_read_b64_tr_b16 a[240:241], v21 offset:0
ds_read_b64_tr_b16 a[242:243], v21 offset:1024
ds_read_b64_tr_b16 a[244:245], v23 offset:0
ds_read_b64_tr_b16 a[246:247], v23 offset:1024
s_waitcnt lgkmcnt(0)
s_waitcnt vmcnt(0)
s_barrier
ds_read_b64_tr_b16 a[176:177], v20 offset:4096
ds_read_b64_tr_b16 a[178:179], v20 offset:5120
ds_read_b64_tr_b16 a[180:181], v22 offset:4096
ds_read_b64_tr_b16 a[182:183], v22 offset:5120
ds_read_b64_tr_b16 a[248:249], v21 offset:4096
ds_read_b64_tr_b16 a[250:251], v21 offset:5120
ds_read_b64_tr_b16 a[252:253], v23 offset:4096
ds_read_b64_tr_b16 a[254:255], v23 offset:5120
s_waitcnt lgkmcnt(0)
s_lshl_b32 s42, s33, 5
s_add_u32 s42, s42, s32
s_lshl_b32 s39, s42, 13
s_lshl_b32 s37, s34, 11
s_add_u32 s39, s39, s37
s_add_u32 s39, s39, 50331648
s_lshl_b32 s40, s42, 14
s_add_u32 s40, s40, 16777216
s_lshl_b32 s37, s34, 12
s_add_u32 s41, s40, s37
s_lshr_b32 s37, s34, 1
s_lshl_b32 s37, s37, 10
s_add_u32 s40, s40, s37
s_and_b32 s37, s34, 1
s_lshl_b32 s37, s37, 6
s_add_u32 s40, s40, s37
s_mov_b32 s35, 0
s_mov_b32 s48, 36864
s_lshl_b32 s49, s32, 5
s_lshl_b32 s37, s33, 2
s_add_u32 s49, s49, s37
s_add_u32 s49, s49, s34
s_lshl_b32 s49, s49, 2
s_add_u32 s49, s49, 327680
s_branch L_q_init_in
L_q_init:
s_sleep 4
L_q_init_in:
buffer_load_dword v12, v8, s[24:27], 0 offen offset:0 sc0 sc1
s_sub_u32 s36, s36, 1
s_cbranch_scc1 L_exit_w
s_waitcnt vmcnt(0)
v_readfirstlane_b32 s37, v12
s_nop 0
s_and_b32 s37, s37, 0xff
s_cmp_eq_u32 s37, 32
s_cbranch_scc0 L_q_init
.p2align 6
L_q_loop:
s_waitcnt vmcnt(7)
s_barrier
s_add_u32 s43, s43, 147456
s_add_u32 s44, s44, s48
ds_read_b128 v[64:67], v3 offset:0
ds_read_b128 v[68:71], v3 offset:1024
ds_read_b128 v[72:75], v3 offset:2048
ds_read_b128 v[76:79], v3 offset:3072
s_waitcnt lgkmcnt(2)
v_mfma_f32_16x16x32_bf16 v[16:19], v[80:83], v[64:67], 0
v_mfma_f32_16x16x32_bf16 v[20:23], v[80:83], v[68:71], 0
v_mfma_f32_16x16x32_bf16 v[24:27], v[152:155], v[64:67], 0
v_mfma_f32_16x16x32_bf16 v[28:31], v[152:155], v[68:71], 0
s_add_u32 s37, s43, 0
s_add_u32 m0, s44, 0
s_nop 0
buffer_load_dwordx4 v2, s[8:11], s37 offen lds
v_mfma_f32_16x16x32_bf16 v[32:35], v[224:227], v[64:67], 0
v_mfma_f32_16x16x32_bf16 v[36:39], v[224:227], v[68:71], 0
v_mfma_f32_16x16x32_bf16 v[40:43], a[40:43], v[64:67], 0
v_mfma_f32_16x16x32_bf16 v[44:47], a[40:43], v[68:71], 0
v_mfma_f32_16x16x32_bf16 v[48:51], v[64:67], a[112:115], 0
v_mfma_f32_16x16x32_bf16 v[52:55], v[68:71], a[112:115], 0
v_mfma_f32_16x16x32_bf16 v[56:59], v[64:67], a[184:187], 0
v_mfma_f32_16x16x32_bf16 v[60:63], v[68:71], a[184:187], 0
ds_read_b128 v[64:67], v3 offset:4096
ds_read_b128 v[68:71], v3 offset:5120
s_waitcnt lgkmcnt(2)
v_mfma_f32_16x16x32_bf16 v[16:19], v[84:87], v[72:75], v[16:19]
v_mfma_f32_16x16x32_bf16 v[20:23], v[84:87], v[76:79], v[20:23]
v_mfma_f32_16x16x32_bf16 v[24:27], v[156:159], v[72:75], v[24:27]
v_mfma_f32_16x16x32_bf16 v[28:31], v[156:159], v[76:79], v[28:31]
s_add_u32 s37, s43, 128
s_add_u32 m0, s44, 4096
s_nop 0
buffer_load_dwordx4 v2, s[8:11], s37 offen lds
v_mfma_f32_16x16x32_bf16 v[32:35], v[228:231], v[72:75], v[32:35]
v_mfma_f32_16x16x32_bf16 v[36:39], v[228:231], v[76:79], v[36:39]
v_mfma_f32_16x16x32_bf16 v[40:43], a[44:47], v[72:75], v[40:43]
v_mfma_f32_16x16x32_bf16 v[44:47], a[44:47], v[76:79], v[44:47]
v_mfma_f32_16x16x32_bf16 v[48:51], v[72:75], a[116:119], v[48:51]
v_mfma_f32_16x16x32_bf16 v[52:55], v[76:79], a[116:119], v[52:55]
v_mfma_f32_16x16x32_bf16 v[56:59], v[72:75], a[188:191], v[56:59]
v_mfma_f32_16x16x32_bf16 v[60:63], v[76:79], a[188:191], v[60:63]
ds_read_b128 v[72:75], v3 offset:6144
ds_read_b128 v[76:79], v3 offset:7168
s_waitcnt lgkmcnt(2)
v_mfma_f32_16x16x32_bf16 v[16:19], v[88:91], v[64:67], v[16:19]
v_mfma_f32_16x16x32_bf16 v[20:23], v[88:91], v[68:71], v[20:23]
v_mfma_f32_16x16x32_bf16 v[24:27], v[160:163], v[64:67], v[24:27]
v_mfma_f32_16x16x32_bf16 v[28:31], v[160:163], v[68:71], v[28:31]
s_add_u32 s37, s43, 256
s_add_u32 m0, s44, 8192
s_nop 0
buffer_load_dwordx4 v2, s[8:11], s37 offen lds
v_mfma_f32_16x16x32_bf16 v[32:35], v[232:235], v[64:67], v[32:35]
v_mfma_f32_16x16x32_bf16 v[36:39], v[232:235], v[68:71], v[36:39]
v_mfma_f32_16x16x32_bf16 v[40:43], a[48:51], v[64:67], v[40:43]
v_mfma_f32_16x16x32_bf16 v[44:47], a[48:51], v[68:71], v[44:47]
v_mfma_f32_16x16x32_bf16 v[48:51], v[64:67], a[120:123], v[48:51]
v_mfma_f32_16x16x32_bf16 v[52:55], v[68:71], a[120:123], v[52:55]
v_mfma_f32_16x16x32_bf16 v[56:59], v[64:67], a[192:195], v[56:59]
v_mfma_f32_16x16x32_bf16 v[60:63], v[68:71], a[192:195], v[60:63]
ds_read_b128 v[64:67], v3 offset:8192
ds_read_b128 v[68:71], v3 offset:9216
s_waitcnt lgkmcnt(2)
v_mfma_f32_16x16x32_bf16 v[16:19], v[92:95], v[72:75], v[16:19]
v_mfma_f32_16x16x32_bf16 v[20:23], v[92:95], v[76:79], v[20:23]
v_mfma_f32_16x16x32_bf16 v[24:27], v[164:167], v[72:75], v[24:27]
v_mfma_f32_16x16x32_bf16 v[28:31], v[164:167], v[76:79], v[28:31]
s_add_u32 s37, s43, 384
s_add_u32 m0, s44, 12288
s_nop 0
buffer_load_dwordx4 v2, s[8:11], s37 offen lds
v_mfma_f32_16x16x32_bf16 v[32:35], v[236:239], v[72:75], v[32:35]
v_mfma_f32_16x16x32_bf16 v[36:39], v[236:239], v[76:79], v[36:39]
v_mfma_f32_16x16x32_bf16 v[40:43], a[52:55], v[72:75], v[40:43]
v_mfma_f32_16x16x32_bf16 v[44:47], a[52:55], v[76:79], v[44:47]
v_mfma_f32_16x16x32_bf16 v[48:51], v[72:75], a[124:127], v[48:51]
v_mfma_f32_16x16x32_bf16 v[52:55], v[76:79], a[124:127], v[52:55]
v_mfma_f32_16x16x32_bf16 v[56:59], v[72:75], a[196:199], v[56:59]
v_mfma_f32_16x16x32_bf16 v[60:63], v[76:79], a[196:199], v[60:63]
ds_read_b128 v[72:75], v3 offset:10240
ds_read_b128 v[76:79], v3 offset:11264
s_waitcnt lgkmcnt(2)
v_mfma_f32_16x16x32_bf16 v[16:19], v[96:99], v[64:67], v[16:19]
v_mfma_f32_16x16x32_bf16 v[20:23], v[96:99], v[68:71], v[20:23]
v_mfma_f32_16x16x32_bf16 v[24:27], v[168:171], v[64:67], v[24:27]
v_mfma_f32_16x16x32_bf16 v[28:31], v[168:171], v[68:71], v[28:31]
s_add_u32 s37, s43, 512
s_add_u32 m0, s44, 16384
s_nop 0
buffer_load_dwordx4 v2, s[8:11], s37 offen lds
v_mfma_f32_16x16x32_bf16 v[32:35], v[240:243], v[64:67], v[32:35]
v_mfma_f32_16x16x32_bf16 v[36:39], v[240:243], v[68:71], v[36:39]
v_mfma_f32_16x16x32_bf16 v[40:43], a[56:59], v[64:67], v[40:43]
v_mfma_f32_16x16x32_bf16 v[44:47], a[56:59], v[68:71], v[44:47]
v_mfma_f32_16x16x32_bf16 v[48:51], v[64:67], a[128:131], v[48:51]
v_mfma_f32_16x16x32_bf16 v[52:55], v[68:71], a[128:131], v[52:55]
v_mfma_f32_16x16x32_bf16 v[56:59], v[64:67], a[200:203], v[56:59]
v_mfma_f32_16x16x32_bf16 v[60:63], v[68:71], a[200:203], v[60:63]
ds_read_b128 v[64:67], v3 offset:12288
ds_read_b128 v[68:71], v3 offset:13312
s_waitcnt lgkmcnt(2)
v_mfma_f32_16x16x32_bf16 v[16:19], v[100:103], v[72:75], v[16:19]
v_mfma_f32_16x16x32_bf16 v[20:23], v[100:103], v[76:79], v[20:23]
v_mfma_f32_16x16x32_bf16 v[24:27], v[172:175], v[72:75], v[24:27]
v_mfma_f32_16x16x32_bf16 v[28:31], v[172:175], v[76:79], v[28:31]
s_add_u32 s37, s43, 640
s_add_u32 m0, s44, 20480
s_nop 0
buffer_load_dwordx4 v2, s[8:11], s37 offen lds
v_mfma_f32_16x16x32_bf16 v[32:35], v[244:247], v[72:75], v[32:35]
v_mfma_f32_16x16x32_bf16 v[36:39], v[244:247], v[76:79], v[36:39]
v_mfma_f32_16x16x32_bf16 v[40:43], a[60:63], v[72:75], v[40:43]
v_mfma_f32_16x16x32_bf16 v[44:47], a[60:63], v[76:79], v[44:47]
v_mfma_f32_16x16x32_bf16 v[48:51], v[72:75], a[132:135], v[48:51]
v_mfma_f32_16x16x32_bf16 v[52:55], v[76:79], a[132:135], v[52:55]
v_mfma_f32_16x16x32_bf16 v[56:59], v[72:75], a[204:207], v[56:59]
v_mfma_f32_16x16x32_bf16 v[60:63], v[76:79], a[204:207], v[60:63]
ds_read_b128 v[72:75], v3 offset:14336
ds_read_b128 v[76:79], v3 offset:15360
s_waitcnt lgkmcnt(2)
v_mfma_f32_16x16x32_bf16 v[16:19], v[104:107], v[64:67], v[16:19]
v_mfma_f32_16x16x32_bf16 v[20:23], v[104:107], v[68:71], v[20:23]
v_mfma_f32_16x16x32_bf16 v[24:27], v[176:179], v[64:67], v[24:27]
v_mfma_f32_16x16x32_bf16 v[28:31], v[176:179], v[68:71], v[28:31]
s_add_u32 s37, s43, 768
s_add_u32 m0, s44, 24576
s_nop 0
buffer_load_dwordx4 v2, s[8:11], s37 offen lds
v_mfma_f32_16x16x32_bf16 v[32:35], v[248:251], v[64:67], v[32:35]
v_mfma_f32_16x16x32_bf16 v[36:39], v[248:251], v[68:71], v[36:39]
v_mfma_f32_16x16x32_bf16 v[40:43], a[64:67], v[64:67], v[40:43]
v_mfma_f32_16x16x32_bf16 v[44:47], a[64:67], v[68:71], v[44:47]
v_mfma_f32_16x16x32_bf16 v[48:51], v[64:67], a[136:139], v[48:51]
v_mfma_f32_16x16x32_bf16 v[52:55], v[68:71], a[136:139], v[52:55]
v_mfma_f32_16x16x32_bf16 v[56:59], v[64:67], a[208:211], v[56:59]
v_mfma_f32_16x16x32_bf16 v[60:63], v[68:71], a[208:211], v[60:63]
ds_read_b128 v[64:67], v3 offset:16384
ds_read_b128 v[68:71], v3 offset:17408
s_waitcnt lgkmcnt(2)
v_mfma_f32_16x16x32_bf16 v[16:19], v[108:111], v[72:75], v[16:19]
v_mfma_f32_16x16x32_bf16 v[20:23], v[108:111], v[76:79], v[20:23]
v_mfma_f32_16x16x32_bf16 v[24:27], v[180:183], v[72:75], v[24:27]
v_mfma_f32_16x16x32_bf16 v[28:31], v[180:183], v[76:79], v[28:31]
s_add_u32 s37, s43, 896
s_add_u32 m0, s44, 28672
s_nop 0
buffer_load_dwordx4 v2, s[8:11], s37 offen lds
v_mfma_f32_16x16x32_bf16 v[32:35], v[252:255], v[72:75], v[32:35]
v_mfma_f32_16x16x32_bf16 v[36:39], v[252:255], v[76:79], v[36:39]
v_mfma_f32_16x16x32_bf16 v[40:43], a[68:71], v[72:75], v[40:43]
v_mfma_f32_16x16x32_bf16 v[44:47], a[68:71], v[76:79], v[44:47]
v_mfma_f32_16x16x32_bf16 v[48:51], v[72:75], a[140:143], v[48:51]
v_mfma_f32_16x16x32_bf16 v[52:55], v[76:79], a[140:143], v[52:55]
v_mfma_f32_16x16x32_bf16 v[56:59], v[72:75], a[212:215], v[56:59]
v_mfma_f32_16x16x32_bf16 v[60:63], v[76:79], a[212:215], v[60:63]
ds_read_b128 v[72:75], v3 offset:18432
ds_read_b128 v[76:79], v3 offset:19456
s_waitcnt lgkmcnt(2)
v_mfma_f32_16x16x32_bf16 v[16:19], v[112:115], v[64:67], v[16:19]
v_mfma_f32_16x16x32_bf16 v[20:23], v[112:115], v[68:71], v[20:23]
v_mfma_f32_16x16x32_bf16 v[24:27], v[184:187], v[64:67], v[24:27]
v_mfma_f32_16x16x32_bf16 v[28:31], v[184:187], v[68:71], v[28:31]
s_add_u32 s37, s43, 1024
s_add_u32 m0, s44, 32768
s_nop 0
buffer_load_dwordx4 v2, s[8:11], s37 offen lds
v_mfma_f32_16x16x32_bf16 v[32:35], a[0:3], v[64:67], v[32:35]
v_mfma_f32_16x16x32_bf16 v[36:39], a[0:3], v[68:71], v[36:39]
v_mfma_f32_16x16x32_bf16 v[40:43], a[72:75], v[64:67], v[40:43]
v_mfma_f32_16x16x32_bf16 v[44:47], a[72:75], v[68:71], v[44:47]
v_mfma_f32_16x16x32_bf16 v[48:51], v[64:67], a[144:147], v[48:51]
v_mfma_f32_16x16x32_bf16 v[52:55], v[68:71], a[144:147], v[52:55]
v_mfma_f32_16x16x32_bf16 v[56:59], v[64:67], a[216:219], v[56:59]
v_mfma_f32_16x16x32_bf16 v[60:63], v[68:71], a[216:219], v[60:63]
ds_read_b128 v[64:67], v3 offset:20480
ds_read_b128 v[68:71], v3 offset:21504
s_waitcnt lgkmcnt(2)
v_mfma_f32_16x16x32_bf16 v[16:19], v[116:119], v[72:75], v[16:19]
v_mfma_f32_16x16x32_bf16 v[20:23], v[116:119], v[76:79], v[20:23]
v_mfma_f32_16x16x32_bf16 v[24:27], v[188:191], v[72:75], v[24:27]
v_mfma_f32_16x16x32_bf16 v[28:31], v[188:191], v[76:79], v[28:31]
v_mfma_f32_16x16x32_bf16 v[32:35], a[4:7], v[72:75], v[32:35]
v_mfma_f32_16x16x32_bf16 v[36:39], a[4:7], v[76:79], v[36:39]
v_mfma_f32_16x16x32_bf16 v[40:43], a[76:79], v[72:75], v[40:43]
v_mfma_f32_16x16x32_bf16 v[44:47], a[76:79], v[76:79], v[44:47]
v_mfma_f32_16x16x32_bf16 v[48:51], v[72:75], a[148:151], v[48:51]
v_mfma_f32_16x16x32_bf16 v[52:55], v[76:79], a[148:151], v[52:55]
v_mfma_f32_16x16x32_bf16 v[56:59], v[72:75], a[220:223], v[56:59]
v_mfma_f32_16x16x32_bf16 v[60:63], v[76:79], a[220:223], v[60:63]
ds_read_b128 v[72:75], v3 offset:22528
ds_read_b128 v[76:79], v3 offset:23552
s_waitcnt lgkmcnt(2)
v_mfma_f32_16x16x32_bf16 v[16:19], v[120:123], v[64:67], v[16:19]
v_mfma_f32_16x16x32_bf16 v[20:23], v[120:123], v[68:71], v[20:23]
v_mfma_f32_16x16x32_bf16 v[24:27], v[192:195], v[64:67], v[24:27]
v_mfma_f32_16x16x32_bf16 v[28:31], v[192:195], v[68:71], v[28:31]
s_waitcnt vmcnt(9)
v_mov_b32 v12, s35
s_mov_b64 exec, 1
buffer_store_dword v12, v8, s[4:7], s49 offen sc0 sc1
s_mov_b64 exec, -1
v_mfma_f32_16x16x32_bf16 v[32:35], a[8:11], v[64:67], v[32:35]
v_mfma_f32_16x16x32_bf16 v[36:39], a[8:11], v[68:71], v[36:39]
v_mfma_f32_16x16x32_bf16 v[40:43], a[80:83], v[64:67], v[40:43]
v_mfma_f32_16x16x32_bf16 v[44:47], a[80:83], v[68:71], v[44:47]
v_mfma_f32_16x16x32_bf16 v[48:51], v[64:67], a[152:155], v[48:51]
v_mfma_f32_16x16x32_bf16 v[52:55], v[68:71], a[152:155], v[52:55]
v_mfma_f32_16x16x32_bf16 v[56:59], v[64:67], a[224:227], v[56:59]
v_mfma_f32_16x16x32_bf16 v[60:63], v[68:71], a[224:227], v[60:63]
ds_read_b128 v[64:67], v3 offset:24576
ds_read_b128 v[68:71], v3 offset:25600
s_waitcnt lgkmcnt(2)
v_mfma_f32_16x16x32_bf16 v[16:19], v[124:127], v[72:75], v[16:19]
v_mfma_f32_16x16x32_bf16 v[20:23], v[124:127], v[76:79], v[20:23]
v_mfma_f32_16x16x32_bf16 v[24:27], v[196:199], v[72:75], v[24:27]
v_mfma_f32_16x16x32_bf16 v[28:31], v[196:199], v[76:79], v[28:31]
v_mfma_f32_16x16x32_bf16 v[32:35], a[12:15], v[72:75], v[32:35]
v_mfma_f32_16x16x32_bf16 v[36:39], a[12:15], v[76:79], v[36:39]
v_mfma_f32_16x16x32_bf16 v[40:43], a[84:87], v[72:75], v[40:43]
v_mfma_f32_16x16x32_bf16 v[44:47], a[84:87], v[76:79], v[44:47]
v_mfma_f32_16x16x32_bf16 v[48:51], v[72:75], a[156:159], v[48:51]
v_mfma_f32_16x16x32_bf16 v[52:55], v[76:79], a[156:159], v[52:55]
v_mfma_f32_16x16x32_bf16 v[56:59], v[72:75], a[228:231], v[56:59]
v_mfma_f32_16x16x32_bf16 v[60:63], v[76:79], a[228:231], v[60:63]
ds_read_b128 v[72:75], v3 offset:26624
ds_read_b128 v[76:79], v3 offset:27648
s_waitcnt lgkmcnt(2)
v_mfma_f32_16x16x32_bf16 v[16:19], v[128:131], v[64:67], v[16:19]
v_mfma_f32_16x16x32_bf16 v[20:23], v[128:131], v[68:71], v[20:23]
v_mfma_f32_16x16x32_bf16 v[24:27], v[200:203], v[64:67], v[24:27]
v_mfma_f32_16x16x32_bf16 v[28:31], v[200:203], v[68:71], v[28:31]
v_mfma_f32_16x16x32_bf16 v[32:35], a[16:19], v[64:67], v[32:35]
v_mfma_f32_16x16x32_bf16 v[36:39], a[16:19], v[68:71], v[36:39]
v_mfma_f32_16x16x32_bf16 v[40:43], a[88:91], v[64:67], v[40:43]
v_mfma_f32_16x16x32_bf16 v[44:47], a[88:91], v[68:71], v[44:47]
v_mfma_f32_16x16x32_bf16 v[48:51], v[64:67], a[160:163], v[48:51]
v_mfma_f32_16x16x32_bf16 v[52:55], v[68:71], a[160:163], v[52:55]
v_mfma_f32_16x16x32_bf16 v[56:59], v[64:67], a[232:235], v[56:59]
v_mfma_f32_16x16x32_bf16 v[60:63], v[68:71], a[232:235], v[60:63]
ds_read_b128 v[64:67], v3 offset:28672
ds_read_b128 v[68:71], v3 offset:29696
s_waitcnt lgkmcnt(2)
v_mfma_f32_16x16x32_bf16 v[16:19], v[132:135], v[72:75], v[16:19]
v_mfma_f32_16x16x32_bf16 v[20:23], v[132:135], v[76:79], v[20:23]
v_mfma_f32_16x16x32_bf16 v[24:27], v[204:207], v[72:75], v[24:27]
v_mfma_f32_16x16x32_bf16 v[28:31], v[204:207], v[76:79], v[28:31]
v_mfma_f32_16x16x32_bf16 v[32:35], a[20:23], v[72:75], v[32:35]
v_mfma_f32_16x16x32_bf16 v[36:39], a[20:23], v[76:79], v[36:39]
v_mfma_f32_16x16x32_bf16 v[40:43], a[92:95], v[72:75], v[40:43]
v_mfma_f32_16x16x32_bf16 v[44:47], a[92:95], v[76:79], v[44:47]
v_mfma_f32_16x16x32_bf16 v[48:51], v[72:75], a[164:167], v[48:51]
v_mfma_f32_16x16x32_bf16 v[52:55], v[76:79], a[164:167], v[52:55]
v_mfma_f32_16x16x32_bf16 v[56:59], v[72:75], a[236:239], v[56:59]
v_mfma_f32_16x16x32_bf16 v[60:63], v[76:79], a[236:239], v[60:63]
ds_read_b128 v[72:75], v3 offset:30720
ds_read_b128 v[76:79], v3 offset:31744
s_waitcnt lgkmcnt(2)
v_mfma_f32_16x16x32_bf16 v[16:19], v[136:139], v[64:67], v[16:19]
v_mfma_f32_16x16x32_bf16 v[20:23], v[136:139], v[68:71], v[20:23]
v_mfma_f32_16x16x32_bf16 v[24:27], v[208:211], v[64:67], v[24:27]
v_mfma_f32_16x16x32_bf16 v[28:31], v[208:211], v[68:71], v[28:31]
v_mfma_f32_16x16x32_bf16 v[32:35], a[24:27], v[64:67], v[32:35]
v_mfma_f32_16x16x32_bf16 v[36:39], a[24:27], v[68:71], v[36:39]
v_mfma_f32_16x16x32_bf16 v[40:43], a[96:99], v[64:67], v[40:43]
v_mfma_f32_16x16x32_bf16 v[44:47], a[96:99], v[68:71], v[44:47]
v_mfma_f32_16x16x32_bf16 v[48:51], v[64:67], a[168:171], v[48:51]
v_mfma_f32_16x16x32_bf16 v[52:55], v[68:71], a[168:171], v[52:55]
v_mfma_f32_16x16x32_bf16 v[56:59], v[64:67], a[240:243], v[56:59]
v_mfma_f32_16x16x32_bf16 v[60:63], v[68:71], a[240:243], v[60:63]
ds_read_b128 v[64:67], v3 offset:32768
ds_read_b128 v[68:71], v3 offset:33792
s_waitcnt lgkmcnt(2)
v_mfma_f32_16x16x32_bf16 v[16:19], v[140:143], v[72:75], v[16:19]
v_mfma_f32_16x16x32_bf16 v[20:23], v[140:143], v[76:79], v[20:23]
v_mfma_f32_16x16x32_bf16 v[24:27], v[212:215], v[72:75], v[24:27]
v_mfma_f32_16x16x32_bf16 v[28:31], v[212:215], v[76:79], v[28:31]
v_mfma_f32_16x16x32_bf16 v[32:35], a[28:31], v[72:75], v[32:35]
v_mfma_f32_16x16x32_bf16 v[36:39], a[28:31], v[76:79], v[36:39]
v_mfma_f32_16x16x32_bf16 v[40:43], a[100:103], v[72:75], v[40:43]
v_mfma_f32_16x16x32_bf16 v[44:47], a[100:103], v[76:79], v[44:47]
v_mfma_f32_16x16x32_bf16 v[48:51], v[72:75], a[172:175], v[48:51]
v_mfma_f32_16x16x32_bf16 v[52:55], v[76:79], a[172:175], v[52:55]
v_mfma_f32_16x16x32_bf16 v[56:59], v[72:75], a[244:247], v[56:59]
v_mfma_f32_16x16x32_bf16 v[60:63], v[76:79], a[244:247], v[60:63]
ds_read_b128 v[72:75], v3 offset:34816
ds_read_b128 v[76:79], v3 offset:35840
s_waitcnt lgkmcnt(2)
v_mfma_f32_16x16x32_bf16 v[16:19], v[144:147], v[64:67], v[16:19]
v_mfma_f32_16x16x32_bf16 v[20:23], v[144:147], v[68:71], v[20:23]
v_mfma_f32_16x16x32_bf16 v[24:27], v[216:219], v[64:67], v[24:27]
v_mfma_f32_16x16x32_bf16 v[28:31], v[216:219], v[68:71], v[28:31]
v_mfma_f32_16x16x32_bf16 v[32:35], a[32:35], v[64:67], v[32:35]
v_mfma_f32_16x16x32_bf16 v[36:39], a[32:35], v[68:71], v[36:39]
v_mfma_f32_16x16x32_bf16 v[40:43], a[104:107], v[64:67], v[40:43]
v_mfma_f32_16x16x32_bf16 v[44:47], a[104:107], v[68:71], v[44:47]
v_mfma_f32_16x16x32_bf16 v[48:51], v[64:67], a[176:179], v[48:51]
v_mfma_f32_16x16x32_bf16 v[52:55], v[68:71], a[176:179], v[52:55]
v_mfma_f32_16x16x32_bf16 v[56:59], v[64:67], a[248:251], v[56:59]
v_mfma_f32_16x16x32_bf16 v[60:63], v[68:71], a[248:251], v[60:63]
s_waitcnt lgkmcnt(0)
v_mfma_f32_16x16x32_bf16 v[16:19], v[148:151], v[72:75], v[16:19]
v_mfma_f32_16x16x32_bf16 v[20:23], v[148:151], v[76:79], v[20:23]
v_mfma_f32_16x16x32_bf16 v[24:27], v[220:223], v[72:75], v[24:27]
v_mfma_f32_16x16x32_bf16 v[28:31], v[220:223], v[76:79], v[28:31]
v_mfma_f32_16x16x32_bf16 v[32:35], a[36:39], v[72:75], v[32:35]
v_mfma_f32_16x16x32_bf16 v[36:39], a[36:39], v[76:79], v[36:39]
v_mfma_f32_16x16x32_bf16 v[40:43], a[108:111], v[72:75], v[40:43]
v_mfma_f32_16x16x32_bf16 v[44:47], a[108:111], v[76:79], v[44:47]
v_mfma_f32_16x16x32_bf16 v[48:51], v[72:75], a[180:183], v[48:51]
v_mfma_f32_16x16x32_bf16 v[52:55], v[76:79], a[180:183], v[52:55]
v_mfma_f32_16x16x32_bf16 v[56:59], v[72:75], a[252:255], v[56:59]
v_mfma_f32_16x16x32_bf16 v[60:63], v[76:79], a[252:255], v[60:63]
v_add_u32 v3, s48, v3
s_sub_u32 s48, 0, s48
v_cvt_pk_bf16_f32 v64, v16, v17
v_cvt_pk_bf16_f32 v65, v18, v19
v_cvt_pk_bf16_f32 v66, v24, v25
v_cvt_pk_bf16_f32 v67, v26, v27
buffer_store_dwordx4 v[64:67], v1, s[4:7], s39 offen offset:0
v_cvt_pk_bf16_f32 v68, v20, v21
v_cvt_pk_bf16_f32 v69, v22, v23
v_cvt_pk_bf16_f32 v70, v28, v29
v_cvt_pk_bf16_f32 v71, v30, v31
buffer_store_dwordx4 v[68:71], v1, s[4:7], s39 offen offset:1024
v_pk_mul_f32 v[32:33], v[32:33], s[46:47]
v_pk_mul_f32 v[34:35], v[34:35], s[46:47]
v_pk_mul_f32 v[36:37], v[36:37], s[46:47]
v_pk_mul_f32 v[38:39], v[38:39], s[46:47]
v_pk_mul_f32 v[40:41], v[40:41], s[46:47]
v_pk_mul_f32 v[42:43], v[42:43], s[46:47]
v_pk_mul_f32 v[44:45], v[44:45], s[46:47]
v_pk_mul_f32 v[46:47], v[46:47], s[46:47]
v_cvt_pk_bf16_f32 v72, v32, v33
v_cvt_pk_bf16_f32 v73, v34, v35
v_cvt_pk_bf16_f32 v74, v40, v41
v_cvt_pk_bf16_f32 v75, v42, v43
buffer_store_dwordx4 v[72:75], v4, s[4:7], s40 offen offset:0 sc0 sc1
v_cvt_pk_bf16_f32 v76, v36, v37
v_cvt_pk_bf16_f32 v77, v38, v39
v_cvt_pk_bf16_f32 v78, v44, v45
v_cvt_pk_bf16_f32 v79, v46, v47
buffer_store_dwordx4 v[76:79], v4, s[4:7], s40 offen offset:128 sc0 sc1
v_cvt_pk_bf16_f32 v16, v48, v49
v_cvt_pk_bf16_f32 v17, v50, v51
v_cvt_pk_bf16_f32 v18, v52, v53
v_cvt_pk_bf16_f32 v19, v54, v55
buffer_store_dwordx4 v[16:19], v1, s[4:7], s41 offen offset:2048 sc0 sc1
v_cvt_pk_bf16_f32 v20, v56, v57
v_cvt_pk_bf16_f32 v21, v58, v59
v_cvt_pk_bf16_f32 v22, v60, v61
v_cvt_pk_bf16_f32 v23, v62, v63
buffer_store_dwordx4 v[20:23], v1, s[4:7], s41 offen offset:3072 sc0 sc1
s_add_u32 s39, s39, 1048576
s_add_u32 s40, s40, 2097152
s_add_u32 s41, s41, 2097152
s_add_u32 s35, s35, 1
s_cmp_lg_u32 s35, 1
s_cbranch_scc1 L_q_n1
s_waitcnt vmcnt(0)
v_mov_b32 v12, s35
s_mov_b64 exec, 1
buffer_store_dword v12, v8, s[4:7], s49 offen sc0 sc1
s_mov_b64 exec, -1
s_waitcnt vmcnt(0)
L_q_n1:
s_cmp_lt_u32 s35, 16
s_cbranch_scc1 L_q_loop
s_waitcnt vmcnt(0)
v_mov_b32 v12, s35
s_mov_b64 exec, 1
buffer_store_dword v12, v8, s[4:7], s49 offen sc0 sc1
s_mov_b64 exec, -1
s_barrier
s_lshr_b32 s37, s34, 1
s_and_b32 s38, s34, 1
s_lshl_b32 s50, s42, 13
s_lshl_b32 s39, s37, 10
s_add_u32 s50, s50, s39
s_add_u32 s50, s50, 50331648
s_lshl_b32 s52, s42, 14
s_add_u32 s52, s52, 16777216
s_lshl_b32 s39, s38, 13
s_add_u32 s53, s52, s39
s_mul_i32 s55, s33, 10240
s_add_u32 s55, s55, 8388608
s_and_b32 s59, s33, 1
s_sub_u32 s59, s59, 1
s_lshl_b32 s39, s33, 1
s_add_u32 s39, s39, s37
s_lshl_b32 s56, s39, 6
s_lshl_b32 s40, s32, 1
s_add_u32 s40, s40, s38
s_add_u32 s56, s56, s40
s_lshl_b32 s58, s56, 2
s_add_u32 s58, s58, 331776
s_lshl_b32 s56, s56, 11
s_add_u32 s56, s56, 67108864
s_mov_b32 s35, 0
s_lshl_b32 s37, s37, 4
v_add_u32 v12, s37, v10
v_lshlrev_b32 v13, 2, v11
v_sub_u32 v12, v12, v13
v_mov_b32 v13, 0xf149f2ca
v_cmp_le_i32 vcc, 0, v12
s_nop 1
v_cndmask_b32 v80, v13, v8, vcc
v_cmp_le_i32 vcc, 1, v12
s_nop 1
v_cndmask_b32 v81, v13, v8, vcc
v_cmp_le_i32 vcc, 2, v12
s_nop 1
v_cndmask_b32 v82, v13, v8, vcc
v_cmp_le_i32 vcc, 3, v12
s_nop 1
v_cndmask_b32 v83, v13, v8, vcc
v_cmp_le_i32 vcc, 16, v12
s_nop 1
v_cndmask_b32 v84, v13, v8, vcc
v_cmp_le_i32 vcc, 17, v12
s_nop 1
v_cndmask_b32 v85, v13, v8, vcc
v_cmp_le_i32 vcc, 18, v12
s_nop 1
v_cndmask_b32 v86, v13, v8, vcc
v_cmp_le_i32 vcc, 19, v12
s_nop 1
v_cndmask_b32 v87, v13, v8, vcc
v_cmp_gt_u32 vcc, 2, v11
s_nop 1
v_cndmask_b32 v88, v13, v8, vcc
v_cndmask_b32 v89, v13, v8, vcc
v_cndmask_b32 v90, v13, v8, vcc
v_cndmask_b32 v91, v13, v8, vcc
v_mov_b32 v92, 0x3f803f80
v_mov_b32 v93, 0x3f803f80
v_mov_b32 v94, 0x3f803f80
v_mov_b32 v95, 0x3f803f80
v_lshrrev_b32 v12, 1, v11
v_lshlrev_b32 v14, 8, v12
v_and_b32 v12, 1, v11
v_lshl_add_u32 v14, v12, 5, v14
v_bfe_u32 v12, v10, 1, 2
v_lshl_add_u32 v14, v12, 6, v14
v_and_b32 v12, 1, v10
v_lshl_add_u32 v14, v12, 4, v14
s_lshl_b32 s37, s34, 8
v_lshl_add_u32 v15, v9, 2, s37
s_lshl_b32 s37, s34, 10
v_add_u32 v6, s37, v1
s_lshl_b32 s38, s38, 11
v_add_u32 v3, s38, v1
v_and_b32 v12, 3, v10
v_cmp_eq_u32 vcc, 0, v12
s_nop 1
v_cndmask_b32 v5, 0, 1, vcc
L_at_loop:
s_add_u32 s51, s50, 4096
s_add_u32 s54, s53, 4096
s_add_u32 s60, s55, 4096
s_add_u32 s57, s55, 8192
buffer_load_dwordx4 v[16:19], v1, s[4:7], s50 offen offset:0
buffer_load_dwordx4 v[32:35], v4, s[4:7], s52 offen offset:0 sc1
buffer_load_dwordx4 v[48:51], v4, s[4:7], s52 offen offset:128 sc1
buffer_load_dwordx4 v[20:23], v1, s[4:7], s50 offen offset:2048
buffer_load_dwordx4 v[36:39], v4, s[4:7], s52 offen offset:64 sc1
buffer_load_dwordx4 v[52:55], v4, s[4:7], s52 offen offset:192 sc1
buffer_load_dwordx4 v[24:27], v1, s[4:7], s51 offen offset:0
buffer_load_dwordx4 v[40:43], v4, s[4:7], s52 offen offset:1024 sc1
buffer_load_dwordx4 v[56:59], v4, s[4:7], s52 offen offset:1152 sc1
buffer_load_dwordx4 v[28:31], v1, s[4:7], s51 offen offset:2048
buffer_load_dwordx4 v[44:47], v4, s[4:7], s52 offen offset:1088 sc1
buffer_load_dwordx4 v[60:63], v4, s[4:7], s52 offen offset:1216 sc1
buffer_load_dwordx4 v[64:67], v1, s[4:7], s53 offen offset:2048 sc1
buffer_load_dwordx4 v[68:71], v1, s[4:7], s53 offen offset:3072 sc1
buffer_load_dwordx4 v[72:75], v1, s[4:7], s54 offen offset:2048 sc1
buffer_load_dwordx4 v[76:79], v1, s[4:7], s54 offen offset:3072 sc1
s_waitcnt vmcnt(13)
v_mfma_f32_16x16x32_bf16 v[96:99], v[32:35], v[16:19], v[80:83]
v_mfma_f32_16x16x32_bf16 v[100:103], v[48:51], v[16:19], v[84:87]
s_waitcnt vmcnt(10)
v_mfma_f32_16x16x32_bf16 v[96:99], v[36:39], v[20:23], v[96:99]
v_mfma_f32_16x16x32_bf16 v[100:103], v[52:55], v[20:23], v[100:103]
s_waitcnt vmcnt(7)
v_mfma_f32_16x16x32_bf16 v[96:99], v[40:43], v[24:27], v[96:99]
v_mfma_f32_16x16x32_bf16 v[100:103], v[56:59], v[24:27], v[100:103]
s_waitcnt vmcnt(4)
v_mfma_f32_16x16x32_bf16 v[96:99], v[44:47], v[28:31], v[96:99]
v_mfma_f32_16x16x32_bf16 v[100:103], v[60:63], v[28:31], v[100:103]
s_nop 3
v_max3_f32 v160, v96, v97, v98
s_nop 2
v_max3_f32 v160, v160, v99, v100
v_max3_f32 v160, v160, v101, v102
v_max_f32 v160, v160, v103
s_branch L_at_in
L_at_poll:
s_sleep 2
L_at_in:
buffer_load_dwordx4 v[164:167], v6, s[4:7], s55 offen sc0 sc1
buffer_load_dwordx4 v[168:171], v6, s[4:7], s60 offen sc0 sc1
buffer_load_dword v172, v15, s[4:7], s57 offen sc0 sc1
s_sub_u32 s36, s36, 1
s_cbranch_scc1 L_exit_w
s_waitcnt vmcnt(0)
v_bitop3_b32 v12, v164, v168, s59 bitop3:0x7e
v_bitop3_b32 v13, v172, s59, v5 bitop3:0x28
v_and_or_b32 v12, v12, 1, v13
v_cmp_ne_u32 vcc, 0, v12
s_cbranch_vccnz L_at_poll
ds_write_b128 v6, v[164:167]
ds_write_b128 v6, v[168:171] offset:4096
ds_write_b32 v15, v172 offset:8192
s_waitcnt lgkmcnt(0)
s_barrier
ds_read_b128 v[176:179], v14 offset:0
ds_read_b128 v[180:183], v14 offset:512
ds_read_b128 v[184:187], v14 offset:1024
ds_read_b128 v[188:191], v14 offset:1536
s_waitcnt lgkmcnt(3)
v_mfma_f32_16x16x32_bf16 v[192:195], v[224:227], v[176:179], 0
v_mfma_f32_16x16x32_bf16 v[196:199], a[40:43], v[176:179], 0
v_mfma_f32_16x16x32_bf16 v[200:203], v[176:179], a[112:115], 0
v_mfma_f32_16x16x32_bf16 v[204:207], v[176:179], a[184:187], 0
ds_read_b128 v[176:179], v14 offset:2048
s_waitcnt lgkmcnt(3)
v_mfma_f32_16x16x32_bf16 v[192:195], v[228:231], v[180:183], v[192:195]
v_mfma_f32_16x16x32_bf16 v[196:199], a[44:47], v[180:183], v[196:199]
v_mfma_f32_16x16x32_bf16 v[200:203], v[180:183], a[116:119], v[200:203]
v_mfma_f32_16x16x32_bf16 v[204:207], v[180:183], a[188:191], v[204:207]
ds_read_b128 v[180:183], v14 offset:2560
s_waitcnt lgkmcnt(3)
v_mfma_f32_16x16x32_bf16 v[192:195], v[232:235], v[184:187], v[192:195]
v_mfma_f32_16x16x32_bf16 v[196:199], a[48:51], v[184:187], v[196:199]
v_mfma_f32_16x16x32_bf16 v[200:203], v[184:187], a[120:123], v[200:203]
v_mfma_f32_16x16x32_bf16 v[204:207], v[184:187], a[192:195], v[204:207]
ds_read_b128 v[184:187], v14 offset:3072
s_waitcnt lgkmcnt(3)
v_mfma_f32_16x16x32_bf16 v[192:195], v[236:239], v[188:191], v[192:195]
v_mfma_f32_16x16x32_bf16 v[196:199], a[52:55], v[188:191], v[196:199]
v_mfma_f32_16x16x32_bf16 v[200:203], v[188:191], a[124:127], v[200:203]
v_mfma_f32_16x16x32_bf16 v[204:207], v[188:191], a[196:199], v[204:207]
ds_read_b128 v[188:191], v14 offset:3584
s_waitcnt lgkmcnt(3)
v_mfma_f32_16x16x32_bf16 v[192:195], v[240:243], v[176:179], v[192:195]
v_mfma_f32_16x16x32_bf16 v[196:199], a[56:59], v[176:179], v[196:199]
v_mfma_f32_16x16x32_bf16 v[200:203], v[176:179], a[128:131], v[200:203]
v_mfma_f32_16x16x32_bf16 v[204:207], v[176:179], a[200:203], v[204:207]
ds_read_b128 v[176:179], v14 offset:4096
s_waitcnt lgkmcnt(3)
v_mfma_f32_16x16x32_bf16 v[192:195], v[244:247], v[180:183], v[192:195]
v_mfma_f32_16x16x32_bf16 v[196:199], a[60:63], v[180:183], v[196:199]
v_mfma_f32_16x16x32_bf16 v[200:203], v[180:183], a[132:135], v[200:203]
v_mfma_f32_16x16x32_bf16 v[204:207], v[180:183], a[204:207], v[204:207]
ds_read_b128 v[180:183], v14 offset:4608
s_waitcnt lgkmcnt(3)
v_mfma_f32_16x16x32_bf16 v[192:195], v[248:251], v[184:187], v[192:195]
v_mfma_f32_16x16x32_bf16 v[196:199], a[64:67], v[184:187], v[196:199]
v_mfma_f32_16x16x32_bf16 v[200:203], v[184:187], a[136:139], v[200:203]
v_mfma_f32_16x16x32_bf16 v[204:207], v[184:187], a[208:211], v[204:207]
ds_read_b128 v[184:187], v14 offset:5120
s_waitcnt lgkmcnt(3)
v_mfma_f32_16x16x32_bf16 v[192:195], v[252:255], v[188:191], v[192:195]
v_mfma_f32_16x16x32_bf16 v[196:199], a[68:71], v[188:191], v[196:199]
v_mfma_f32_16x16x32_bf16 v[200:203], v[188:191], a[140:143], v[200:203]
v_mfma_f32_16x16x32_bf16 v[204:207], v[188:191], a[212:215], v[204:207]
ds_read_b128 v[188:191], v14 offset:5632
s_waitcnt lgkmcnt(3)
v_mfma_f32_16x16x32_bf16 v[192:195], a[0:3], v[176:179], v[192:195]
v_mfma_f32_16x16x32_bf16 v[196:199], a[72:75], v[176:179], v[196:199]
v_mfma_f32_16x16x32_bf16 v[200:203], v[176:179], a[144:147], v[200:203]
v_mfma_f32_16x16x32_bf16 v[204:207], v[176:179], a[216:219], v[204:207]
ds_read_b128 v[176:179], v14 offset:6144
s_waitcnt lgkmcnt(3)
v_mfma_f32_16x16x32_bf16 v[192:195], a[4:7], v[180:183], v[192:195]
v_mfma_f32_16x16x32_bf16 v[196:199], a[76:79], v[180:183], v[196:199]
v_mfma_f32_16x16x32_bf16 v[200:203], v[180:183], a[148:151], v[200:203]
v_mfma_f32_16x16x32_bf16 v[204:207], v[180:183], a[220:223], v[204:207]
ds_read_b128 v[180:183], v14 offset:6656
s_waitcnt lgkmcnt(3)
v_mfma_f32_16x16x32_bf16 v[192:195], a[8:11], v[184:187], v[192:195]
v_mfma_f32_16x16x32_bf16 v[196:199], a[80:83], v[184:187], v[196:199]
v_mfma_f32_16x16x32_bf16 v[200:203], v[184:187], a[152:155], v[200:203]
v_mfma_f32_16x16x32_bf16 v[204:207], v[184:187], a[224:227], v[204:207]
ds_read_b128 v[184:187], v14 offset:7168
s_waitcnt lgkmcnt(3)
v_mfma_f32_16x16x32_bf16 v[192:195], a[12:15], v[188:191], v[192:195]
v_mfma_f32_16x16x32_bf16 v[196:199], a[84:87], v[188:191], v[196:199]
v_mfma_f32_16x16x32_bf16 v[200:203], v[188:191], a[156:159], v[200:203]
v_mfma_f32_16x16x32_bf16 v[204:207], v[188:191], a[228:231], v[204:207]
ds_read_b128 v[188:191], v14 offset:7680
s_waitcnt lgkmcnt(3)
v_mfma_f32_16x16x32_bf16 v[192:195], a[16:19], v[176:179], v[192:195]
v_mfma_f32_16x16x32_bf16 v[196:199], a[88:91], v[176:179], v[196:199]
v_mfma_f32_16x16x32_bf16 v[200:203], v[176:179], a[160:163], v[200:203]
v_mfma_f32_16x16x32_bf16 v[204:207], v[176:179], a[232:235], v[204:207]
ds_read_b128 v[176:179], v14 offset:8192
s_waitcnt lgkmcnt(3)
v_mfma_f32_16x16x32_bf16 v[192:195], a[20:23], v[180:183], v[192:195]
v_mfma_f32_16x16x32_bf16 v[196:199], a[92:95], v[180:183], v[196:199]
v_mfma_f32_16x16x32_bf16 v[200:203], v[180:183], a[164:167], v[200:203]
v_mfma_f32_16x16x32_bf16 v[204:207], v[180:183], a[236:239], v[204:207]
ds_read_b128 v[180:183], v14 offset:8704
s_waitcnt lgkmcnt(3)
v_mfma_f32_16x16x32_bf16 v[192:195], a[24:27], v[184:187], v[192:195]
v_mfma_f32_16x16x32_bf16 v[196:199], a[96:99], v[184:187], v[196:199]
v_mfma_f32_16x16x32_bf16 v[200:203], v[184:187], a[168:171], v[200:203]
v_mfma_f32_16x16x32_bf16 v[204:207], v[184:187], a[240:243], v[204:207]
s_waitcnt lgkmcnt(2)
v_mfma_f32_16x16x32_bf16 v[192:195], a[28:31], v[188:191], v[192:195]
v_mfma_f32_16x16x32_bf16 v[196:199], a[100:103], v[188:191], v[196:199]
v_mfma_f32_16x16x32_bf16 v[200:203], v[188:191], a[172:175], v[200:203]
v_mfma_f32_16x16x32_bf16 v[204:207], v[188:191], a[244:247], v[204:207]
s_waitcnt lgkmcnt(1)
v_mfma_f32_16x16x32_bf16 v[192:195], a[32:35], v[176:179], v[192:195]
v_mfma_f32_16x16x32_bf16 v[196:199], a[104:107], v[176:179], v[196:199]
v_mfma_f32_16x16x32_bf16 v[200:203], v[176:179], a[176:179], v[200:203]
v_mfma_f32_16x16x32_bf16 v[204:207], v[176:179], a[248:251], v[204:207]
s_waitcnt lgkmcnt(0)
v_mfma_f32_16x16x32_bf16 v[192:195], a[36:39], v[180:183], v[192:195]
v_mfma_f32_16x16x32_bf16 v[196:199], a[108:111], v[180:183], v[196:199]
v_mfma_f32_16x16x32_bf16 v[200:203], v[180:183], a[180:183], v[200:203]
v_mfma_f32_16x16x32_bf16 v[204:207], v[180:183], a[252:255], v[204:207]
v_mul_f32 v192, s46, v192
v_mul_f32 v193, s46, v193
v_mul_f32 v194, s46, v194
v_mul_f32 v195, s46, v195
v_mul_f32 v196, s46, v196
v_mul_f32 v197, s46, v197
v_mul_f32 v198, s46, v198
v_mul_f32 v199, s46, v199
v_cvt_pk_bf16_f32 v208, v192, v193
v_cvt_pk_bf16_f32 v209, v194, v195
v_cvt_pk_bf16_f32 v210, v196, v197
v_cvt_pk_bf16_f32 v211, v198, v199
ds_write_b128 v6, v[208:211] offset:9216
v_cvt_pk_bf16_f32 v212, v200, v201
v_cvt_pk_bf16_f32 v213, v202, v203
v_cvt_pk_bf16_f32 v214, v204, v205
v_cvt_pk_bf16_f32 v215, v206, v207
ds_write_b128 v6, v[212:215] offset:13312
s_waitcnt lgkmcnt(0)
s_barrier
ds_read_b128 v[108:111], v1 offset:9216
ds_read_b128 v[112:115], v1 offset:10240
ds_read_b128 v[116:119], v1 offset:11264
ds_read_b128 v[120:123], v1 offset:12288
ds_read_b128 v[124:127], v3 offset:13312
ds_read_b128 v[128:131], v3 offset:14336
s_waitcnt lgkmcnt(5)
v_mfma_f32_16x16x32_bf16 v[104:107], v[108:111], v[16:19], v[88:91]
s_waitcnt lgkmcnt(4)
v_mfma_f32_16x16x32_bf16 v[104:107], v[112:115], v[20:23], v[104:107]
s_waitcnt lgkmcnt(3)
v_mfma_f32_16x16x32_bf16 v[104:107], v[116:119], v[24:27], v[104:107]
s_waitcnt lgkmcnt(2)
v_mfma_f32_16x16x32_bf16 v[104:107], v[120:123], v[28:31], v[104:107]
s_nop 7
v_max3_f32 v160, v160, v104, v105
v_max3_f32 v161, v160, v106, v107
v_max3_f32 v160, v160, v106, v107
s_nop 1
v_permlane16_swap_b32 v160, v161
v_max_f32 v162, v160, v161
v_max_f32 v163, v160, v161
s_nop 1
v_permlane32_swap_b32 v162, v163
v_max_f32 v160, v162, v163
v_pk_add_f32 v[96:97], v[96:97], v[160:161] op_sel_hi:[1,0] neg_lo:[0,1] neg_hi:[0,1]
v_pk_add_f32 v[98:99], v[98:99], v[160:161] op_sel_hi:[1,0] neg_lo:[0,1] neg_hi:[0,1]
v_pk_add_f32 v[100:101], v[100:101], v[160:161] op_sel_hi:[1,0] neg_lo:[0,1] neg_hi:[0,1]
v_pk_add_f32 v[102:103], v[102:103], v[160:161] op_sel_hi:[1,0] neg_lo:[0,1] neg_hi:[0,1]
v_pk_add_f32 v[104:105], v[104:105], v[160:161] op_sel_hi:[1,0] neg_lo:[0,1] neg_hi:[0,1]
v_pk_add_f32 v[106:107], v[106:107], v[160:161] op_sel_hi:[1,0] neg_lo:[0,1] neg_hi:[0,1]
v_exp_f32 v96, v96
v_exp_f32 v97, v97
v_exp_f32 v98, v98
v_exp_f32 v99, v99
v_exp_f32 v100, v100
v_exp_f32 v101, v101
v_exp_f32 v102, v102
v_exp_f32 v103, v103
v_exp_f32 v104, v104
v_exp_f32 v105, v105
v_exp_f32 v106, v106
v_exp_f32 v107, v107
v_cvt_pk_bf16_f32 v132, v96, v97
v_cvt_pk_bf16_f32 v133, v98, v99
v_cvt_pk_bf16_f32 v134, v100, v101
v_cvt_pk_bf16_f32 v135, v102, v103
v_cvt_pk_bf16_f32 v136, v104, v105
v_cvt_pk_bf16_f32 v137, v106, v107
v_mfma_f32_16x16x32_bf16 v[156:159], v[92:95], v[132:135], 0
v_mfma_f32_16x16x32_bf16 v[140:143], v[64:67], v[132:135], 0
v_mfma_f32_16x16x32_bf16 v[144:147], v[68:71], v[132:135], 0
v_mfma_f32_16x16x32_bf16 v[148:151], v[72:75], v[132:135], 0
v_mfma_f32_16x16x32_bf16 v[152:155], v[76:79], v[132:135], 0
s_waitcnt lgkmcnt(0)
v_mfma_f32_16x16x16_bf16 v[156:159], v[92:93], v[136:137], v[156:159]
v_mfma_f32_16x16x16_bf16 v[140:143], v[124:125], v[136:137], v[140:143]
v_mfma_f32_16x16x16_bf16 v[144:147], v[126:127], v[136:137], v[144:147]
v_mfma_f32_16x16x16_bf16 v[148:151], v[128:129], v[136:137], v[148:151]
v_mfma_f32_16x16x16_bf16 v[152:155], v[130:131], v[136:137], v[152:155]
v_rcp_f32 v156, v156
s_nop 0
v_mul_f32 v140, v140, v156
v_mul_f32 v141, v141, v156
v_mul_f32 v142, v142, v156
v_mul_f32 v143, v143, v156
v_mul_f32 v144, v144, v156
v_mul_f32 v145, v145, v156
v_mul_f32 v146, v146, v156
v_mul_f32 v147, v147, v156
v_cvt_pk_bf16_f32 v140, v140, v141
v_cvt_pk_bf16_f32 v141, v142, v143
v_cvt_pk_bf16_f32 v142, v144, v145
v_cvt_pk_bf16_f32 v143, v146, v147
buffer_store_dwordx4 v[140:143], v1, s[4:7], s56 offen offset:0 sc0 sc1
v_mul_f32 v148, v148, v156
v_mul_f32 v149, v149, v156
v_mul_f32 v150, v150, v156
v_mul_f32 v151, v151, v156
v_mul_f32 v152, v152, v156
v_mul_f32 v153, v153, v156
v_mul_f32 v154, v154, v156
v_mul_f32 v155, v155, v156
v_cvt_pk_bf16_f32 v148, v148, v149
v_cvt_pk_bf16_f32 v149, v150, v151
v_cvt_pk_bf16_f32 v150, v152, v153
v_cvt_pk_bf16_f32 v151, v154, v155
buffer_store_dwordx4 v[148:151], v1, s[4:7], s56 offen offset:1024 sc0 sc1
s_add_u32 s35, s35, 1
v_mov_b32 v13, s35
s_add_u32 s50, s50, 1048576
s_add_u32 s52, s52, 2097152
s_add_u32 s53, s53, 2097152
s_add_u32 s55, s55, 40960
s_add_u32 s56, s56, 1048576
s_waitcnt vmcnt(0)
s_mov_b64 exec, 1
buffer_store_dword v13, v8, s[4:7], s58 offen sc0 sc1
s_mov_b64 exec, -1
s_cmp_lt_u32 s35, 16
s_cbranch_scc1 L_at_loop
s_waitcnt vmcnt(0)
s_endpgm
L_role_aw:
s_load_dwordx2 s[4:5], s[0:1], 104
s_mov_b32 s6, 268435456
s_mov_b32 s7, 0x20000
s_load_dwordx2 s[8:9], s[0:1], 0
s_mov_b32 s10, 2359296
s_mov_b32 s11, 0x20000
s_load_dwordx2 s[12:13], s[0:1], 8
s_mov_b32 s14, 1990656
s_mov_b32 s15, 0x20000
s_load_dwordx2 s[16:17], s[0:1], 16
s_mov_b32 s18, 663552
s_mov_b32 s19, 0x20000
s_load_dwordx2 s[20:21], s[0:1], 64
s_mov_b32 s22, 4718592
s_mov_b32 s23, 0x20000
s_load_dwordx2 s[24:25], s[0:1], 96
s_mov_b32 s26, 256
s_mov_b32 s27, 0x20000
s_load_dwordx2 s[28:29], s[0:1], 88
s_mov_b32 s30, 2359296
s_mov_b32 s31, 0x20000
s_load_dwordx2 s[64:65], s[0:1], 80
s_mov_b32 s66, 1152
s_mov_b32 s67, 0x20000
v_and_b32 v9, 63, v0
v_and_b32 v10, 15, v0
v_bfe_u32 v11, v0, 4, 2
v_lshrrev_b32 v1, 6, v0
s_nop 0
v_readfirstlane_b32 s34, v1
v_lshrrev_b32 v12, 2, v9
v_mul_u32_u24 v2, 1152, v12
v_lshrrev_b32 v12, 5, v9
v_lshlrev_b32 v12, 1, v12
v_and_b32 v13, 3, v9
v_xor_b32 v12, v12, v13
v_lshl_add_u32 v2, v12, 4, v2
v_lshrrev_b32 v12, 3, v10
v_lshlrev_b32 v12, 1, v12
v_xor_b32 v12, v12, v11
v_lshlrev_b32 v12, 4, v12
v_lshl_add_u32 v3, v10, 6, v12
v_lshrrev_b32 v12, 2, v10
v_lshl_add_u32 v12, v11, 3, v12
v_mul_u32_u24 v7, 64, v12
v_and_b32 v12, 3, v10
v_lshl_add_u32 v7, v12, 3, v7
v_lshlrev_b32 v1, 4, v9
s_mul_i32 s38, s34, 20480
s_add_u32 s38, s38, 73728
v_add_u32 v7, s38, v7
v_mov_b32 v8, 0
s_lshl_b32 s37, s34, 3
s_add_u32 s37, s37, 0
v_and_b32 v12, 3, v9
v_add_u32 v12, s37, v12
v_min_u32 v12, 26, v12
v_mul_u32_u24 v13, 57, v12
v_lshrrev_b32 v13, 9, v13
v_mul_u32_u24 v13, 1008, v13
v_lshl_add_u32 v13, v12, 4, v13
v_lshrrev_b32 v12, 2, v9
v_mul_u32_u24 v12, 3456, v12
v_add_u32 v5, v12, v13
s_lshl_b32 s37, s34, 3
s_add_u32 s37, s37, 4
v_and_b32 v12, 3, v9
v_add_u32 v12, s37, v12
v_min_u32 v12, 26, v12
v_mul_u32_u24 v13, 57, v12
v_lshrrev_b32 v13, 9, v13
v_mul_u32_u24 v13, 1008, v13
v_lshl_add_u32 v13, v12, 4, v13
v_lshrrev_b32 v12, 2, v9
v_mul_u32_u24 v12, 3456, v12
v_add_u32 v6, v12, v13
s_mul_i32 s39, s32, 144
s_mul_i32 s40, s33, 11
s_and_b32 s41, s34, 1
s_add_u32 s40, s40, s41
s_sub_u32 s40, s40, 1
s_max_i32 s41, s40, 0
s_lshr_b32 s42, s34, 1
s_lshl_b32 s42, s42, 6
s_mul_i32 s43, s41, 18432
s_add_u32 s43, s43, s42
s_mul_i32 s40, s40, 18432
s_add_u32 s40, s40, s42
s_lshl_b32 s44, s34, 10
s_mov_b32 s36, 400000
v_mul_u32_u24 v4, 456, v10
v_lshl_add_u32 v4, v11, 3, v4
s_lshl_b32 s37, s34, 7
s_add_u32 s37, s37, 73728
v_add_u32 v4, s37, v4
v_lshlrev_b32 v14, 2, v10
v_add_u32 v14, 161280, v14
s_waitcnt lgkmcnt(0)
s_add_u32 s37, s39, 0
s_add_u32 m0, s38, 0
s_nop 0
buffer_load_dwordx4 v5, s[12:15], s37 offen lds
s_add_u32 s37, s39, 55296
s_add_u32 m0, s38, 1024
s_nop 0
buffer_load_dwordx4 v5, s[12:15], s37 offen lds
s_add_u32 s37, s39, 110592
s_add_u32 m0, s38, 2048
s_nop 0
buffer_load_dwordx4 v5, s[12:15], s37 offen lds
s_add_u32 s37, s39, 165888
s_add_u32 m0, s38, 3072
s_nop 0
buffer_load_dwordx4 v5, s[12:15], s37 offen lds
s_add_u32 s37, s39, 221184
s_add_u32 m0, s38, 4096
s_nop 0
buffer_load_dwordx4 v5, s[12:15], s37 offen lds
s_add_u32 s37, s39, 276480
s_add_u32 m0, s38, 5120
s_nop 0
buffer_load_dwordx4 v5, s[12:15], s37 offen lds
s_add_u32 s37, s39, 331776
s_add_u32 m0, s38, 6144
s_nop 0
buffer_load_dwordx4 v5, s[12:15], s37 offen lds
s_add_u32 s37, s39, 387072
s_add_u32 m0, s38, 7168
s_nop 0
buffer_load_dwordx4 v5, s[12:15], s37 offen lds
s_add_u32 s37, s39, 442368
s_add_u32 m0, s38, 8192
s_nop 0
buffer_load_dwordx4 v5, s[12:15], s37 offen lds
s_add_u32 s37, s39, 497664
s_add_u32 m0, s38, 9216
s_nop 0
buffer_load_dwordx4 v5, s[12:15], s37 offen lds
s_add_u32 s37, s39, 552960
s_add_u32 m0, s38, 10240
s_nop 0
buffer_load_dwordx4 v5, s[12:15], s37 offen lds
s_add_u32 s37, s39, 608256
s_add_u32 m0, s38, 11264
s_nop 0
buffer_load_dwordx4 v5, s[12:15], s37 offen lds
s_add_u32 s37, s39, 663552
s_add_u32 m0, s38, 12288
s_nop 0
buffer_load_dwordx4 v5, s[12:15], s37 offen lds
s_add_u32 s37, s39, 718848
s_add_u32 m0, s38, 13312
s_nop 0
buffer_load_dwordx4 v5, s[12:15], s37 offen lds
s_add_u32 s37, s39, 774144
s_add_u32 m0, s38, 14336
s_nop 0
buffer_load_dwordx4 v5, s[12:15], s37 offen lds
s_add_u32 s37, s39, 829440
s_add_u32 m0, s38, 15360
s_nop 0
buffer_load_dwordx4 v5, s[12:15], s37 offen lds
s_add_u32 s37, s43, 0
s_add_u32 m0, s44, 0
s_nop 0
buffer_load_dwordx4 v2, s[8:11], s37 offen lds
s_add_u32 s37, s43, 128
s_add_u32 m0, s44, 4096
s_nop 0
buffer_load_dwordx4 v2, s[8:11], s37 offen lds
s_add_u32 s37, s43, 256
s_add_u32 m0, s44, 8192
s_nop 0
buffer_load_dwordx4 v2, s[8:11], s37 offen lds
s_add_u32 s37, s43, 384
s_add_u32 m0, s44, 12288
s_nop 0
buffer_load_dwordx4 v2, s[8:11], s37 offen lds
s_add_u32 s37, s43, 512
s_add_u32 m0, s44, 16384
s_nop 0
buffer_load_dwordx4 v2, s[8:11], s37 offen lds
s_add_u32 s37, s43, 640
s_add_u32 m0, s44, 20480
s_nop 0
buffer_load_dwordx4 v2, s[8:11], s37 offen lds
s_add_u32 s37, s43, 768
s_add_u32 m0, s44, 24576
s_nop 0
buffer_load_dwordx4 v2, s[8:11], s37 offen lds
s_add_u32 s37, s43, 896
s_add_u32 m0, s44, 28672
s_nop 0
buffer_load_dwordx4 v2, s[8:11], s37 offen lds
s_add_u32 s37, s43, 1024
s_add_u32 m0, s44, 32768
s_nop 0
buffer_load_dwordx4 v2, s[8:11], s37 offen lds
s_waitcnt vmcnt(21)
ds_read_b64_tr_b16 v[80:81], v7 offset:0
ds_read_b64_tr_b16 v[82:83], v7 offset:256
ds_read_b64_tr_b16 v[84:85], v7 offset:2048
ds_read_b64_tr_b16 v[86:87], v7 offset:2304
ds_read_b64_tr_b16 v[152:153], v7 offset:32
ds_read_b64_tr_b16 v[154:155], v7 offset:288
ds_read_b64_tr_b16 v[156:157], v7 offset:2080
ds_read_b64_tr_b16 v[158:159], v7 offset:2336
s_waitcnt lgkmcnt(0)
s_add_u32 s37, s39, 884736
s_add_u32 m0, s38, 16384
s_nop 0
buffer_load_dwordx4 v5, s[12:15], s37 offen lds
s_add_u32 s37, s39, 940032
s_add_u32 m0, s38, 17408
s_nop 0
buffer_load_dwordx4 v5, s[12:15], s37 offen lds
s_add_u32 s37, s39, 995328
s_add_u32 m0, s38, 18432
s_nop 0
buffer_load_dwordx4 v5, s[12:15], s37 offen lds
s_add_u32 s37, s39, 1050624
s_add_u32 m0, s38, 19456
s_nop 0
buffer_load_dwordx4 v5, s[12:15], s37 offen lds
s_waitcnt vmcnt(21)
ds_read_b64_tr_b16 v[88:89], v7 offset:4096
ds_read_b64_tr_b16 v[90:91], v7 offset:4352
ds_read_b64_tr_b16 v[92:93], v7 offset:6144
ds_read_b64_tr_b16 v[94:95], v7 offset:6400
ds_read_b64_tr_b16 v[160:161], v7 offset:4128
ds_read_b64_tr_b16 v[162:163], v7 offset:4384
ds_read_b64_tr_b16 v[164:165], v7 offset:6176
ds_read_b64_tr_b16 v[166:167], v7 offset:6432
s_waitcnt lgkmcnt(0)
s_add_u32 s37, s39, 1105920
s_add_u32 m0, s38, 0
s_nop 0
buffer_load_dwordx4 v5, s[12:15], s37 offen lds
s_add_u32 s37, s39, 1161216
s_add_u32 m0, s38, 1024
s_nop 0
buffer_load_dwordx4 v5, s[12:15], s37 offen lds
s_add_u32 s37, s39, 1216512
s_add_u32 m0, s38, 2048
s_nop 0
buffer_load_dwordx4 v5, s[12:15], s37 offen lds
s_add_u32 s37, s39, 1271808
s_add_u32 m0, s38, 3072
s_nop 0
buffer_load_dwordx4 v5, s[12:15], s37 offen lds
s_waitcnt vmcnt(21)
ds_read_b64_tr_b16 v[96:97], v7 offset:8192
ds_read_b64_tr_b16 v[98:99], v7 offset:8448
ds_read_b64_tr_b16 v[100:101], v7 offset:10240
ds_read_b64_tr_b16 v[102:103], v7 offset:10496
ds_read_b64_tr_b16 v[168:169], v7 offset:8224
ds_read_b64_tr_b16 v[170:171], v7 offset:8480
ds_read_b64_tr_b16 v[172:173], v7 offset:10272
ds_read_b64_tr_b16 v[174:175], v7 offset:10528
s_waitcnt lgkmcnt(0)
s_add_u32 s37, s39, 1327104
s_add_u32 m0, s38, 4096
s_nop 0
buffer_load_dwordx4 v5, s[12:15], s37 offen lds
s_add_u32 s37, s39, 1382400
s_add_u32 m0, s38, 5120
s_nop 0
buffer_load_dwordx4 v5, s[12:15], s37 offen lds
s_add_u32 s37, s39, 1437696
s_add_u32 m0, s38, 6144
s_nop 0
buffer_load_dwordx4 v5, s[12:15], s37 offen lds
s_add_u32 s37, s39, 1492992
s_add_u32 m0, s38, 7168
s_nop 0
buffer_load_dwordx4 v5, s[12:15], s37 offen lds
s_waitcnt vmcnt(21)
ds_read_b64_tr_b16 v[104:105], v7 offset:12288
ds_read_b64_tr_b16 v[106:107], v7 offset:12544
ds_read_b64_tr_b16 v[108:109], v7 offset:14336
ds_read_b64_tr_b16 v[110:111], v7 offset:14592
ds_read_b64_tr_b16 v[176:177], v7 offset:12320
ds_read_b64_tr_b16 v[178:179], v7 offset:12576
ds_read_b64_tr_b16 v[180:181], v7 offset:14368
ds_read_b64_tr_b16 v[182:183], v7 offset:14624
s_waitcnt lgkmcnt(0)
s_add_u32 s37, s39, 1548288
s_add_u32 m0, s38, 8192
s_nop 0
buffer_load_dwordx4 v5, s[12:15], s37 offen lds
s_add_u32 s37, s39, 1603584
s_add_u32 m0, s38, 9216
s_nop 0
buffer_load_dwordx4 v5, s[12:15], s37 offen lds
s_add_u32 s37, s39, 1658880
s_add_u32 m0, s38, 10240
s_nop 0
buffer_load_dwordx4 v5, s[12:15], s37 offen lds
s_add_u32 s37, s39, 1714176
s_add_u32 m0, s38, 11264
s_nop 0
buffer_load_dwordx4 v5, s[12:15], s37 offen lds
s_waitcnt vmcnt(12)
ds_read_b64_tr_b16 v[112:113], v7 offset:16384
ds_read_b64_tr_b16 v[114:115], v7 offset:16640
ds_read_b64_tr_b16 v[116:117], v7 offset:18432
ds_read_b64_tr_b16 v[118:119], v7 offset:18688
ds_read_b64_tr_b16 v[184:185], v7 offset:16416
ds_read_b64_tr_b16 v[186:187], v7 offset:16672
ds_read_b64_tr_b16 v[188:189], v7 offset:18464
ds_read_b64_tr_b16 v[190:191], v7 offset:18720
s_waitcnt lgkmcnt(0)
s_add_u32 s37, s39, 1769472
s_add_u32 m0, s38, 12288
s_nop 0
buffer_load_dwordx4 v5, s[12:15], s37 offen lds
s_add_u32 s37, s39, 1824768
s_add_u32 m0, s38, 13312
s_nop 0
buffer_load_dwordx4 v5, s[12:15], s37 offen lds
s_add_u32 s37, s39, 1880064
s_add_u32 m0, s38, 14336
s_nop 0
buffer_load_dwordx4 v5, s[12:15], s37 offen lds
s_add_u32 s37, s39, 1935360
s_add_u32 m0, s38, 15360
s_nop 0
buffer_load_dwordx4 v5, s[12:15], s37 offen lds
s_waitcnt vmcnt(12)
ds_read_b64_tr_b16 v[120:121], v7 offset:0
ds_read_b64_tr_b16 v[122:123], v7 offset:256
ds_read_b64_tr_b16 v[124:125], v7 offset:2048
ds_read_b64_tr_b16 v[126:127], v7 offset:2304
ds_read_b64_tr_b16 v[192:193], v7 offset:32
ds_read_b64_tr_b16 v[194:195], v7 offset:288
ds_read_b64_tr_b16 v[196:197], v7 offset:2080
ds_read_b64_tr_b16 v[198:199], v7 offset:2336
s_waitcnt lgkmcnt(0)
s_add_u32 s37, s39, 0
s_add_u32 m0, s38, 16384
s_nop 0
buffer_load_dwordx4 v6, s[12:15], s37 offen lds
s_add_u32 s37, s39, 55296
s_add_u32 m0, s38, 17408
s_nop 0
buffer_load_dwordx4 v6, s[12:15], s37 offen lds
s_add_u32 s37, s39, 110592
s_add_u32 m0, s38, 18432
s_nop 0
buffer_load_dwordx4 v6, s[12:15], s37 offen lds
s_add_u32 s37, s39, 165888
s_add_u32 m0, s38, 19456
s_nop 0
buffer_load_dwordx4 v6, s[12:15], s37 offen lds
s_waitcnt vmcnt(12)
ds_read_b64_tr_b16 v[128:129], v7 offset:4096
ds_read_b64_tr_b16 v[130:131], v7 offset:4352
ds_read_b64_tr_b16 v[132:133], v7 offset:6144
ds_read_b64_tr_b16 v[134:135], v7 offset:6400
ds_read_b64_tr_b16 v[200:201], v7 offset:4128
ds_read_b64_tr_b16 v[202:203], v7 offset:4384
ds_read_b64_tr_b16 v[204:205], v7 offset:6176
ds_read_b64_tr_b16 v[206:207], v7 offset:6432
s_waitcnt lgkmcnt(0)
s_add_u32 s37, s39, 221184
s_add_u32 m0, s38, 0
s_nop 0
buffer_load_dwordx4 v6, s[12:15], s37 offen lds
s_add_u32 s37, s39, 276480
s_add_u32 m0, s38, 1024
s_nop 0
buffer_load_dwordx4 v6, s[12:15], s37 offen lds
s_add_u32 s37, s39, 331776
s_add_u32 m0, s38, 2048
s_nop 0
buffer_load_dwordx4 v6, s[12:15], s37 offen lds
s_add_u32 s37, s39, 387072
s_add_u32 m0, s38, 3072
s_nop 0
buffer_load_dwordx4 v6, s[12:15], s37 offen lds
s_waitcnt vmcnt(12)
ds_read_b64_tr_b16 v[136:137], v7 offset:8192
ds_read_b64_tr_b16 v[138:139], v7 offset:8448
ds_read_b64_tr_b16 v[140:141], v7 offset:10240
ds_read_b64_tr_b16 v[142:143], v7 offset:10496
ds_read_b64_tr_b16 v[208:209], v7 offset:8224
ds_read_b64_tr_b16 v[210:211], v7 offset:8480
ds_read_b64_tr_b16 v[212:213], v7 offset:10272
ds_read_b64_tr_b16 v[214:215], v7 offset:10528
s_waitcnt lgkmcnt(0)
s_add_u32 s37, s39, 442368
s_add_u32 m0, s38, 4096
s_nop 0
buffer_load_dwordx4 v6, s[12:15], s37 offen lds
s_add_u32 s37, s39, 497664
s_add_u32 m0, s38, 5120
s_nop 0
buffer_load_dwordx4 v6, s[12:15], s37 offen lds
s_add_u32 s37, s39, 552960
s_add_u32 m0, s38, 6144
s_nop 0
buffer_load_dwordx4 v6, s[12:15], s37 offen lds
s_add_u32 s37, s39, 608256
s_add_u32 m0, s38, 7168
s_nop 0
buffer_load_dwordx4 v6, s[12:15], s37 offen lds
s_waitcnt vmcnt(12)
ds_read_b64_tr_b16 v[144:145], v7 offset:12288
ds_read_b64_tr_b16 v[146:147], v7 offset:12544
ds_read_b64_tr_b16 v[148:149], v7 offset:14336
ds_read_b64_tr_b16 v[150:151], v7 offset:14592
ds_read_b64_tr_b16 v[216:217], v7 offset:12320
ds_read_b64_tr_b16 v[218:219], v7 offset:12576
ds_read_b64_tr_b16 v[220:221], v7 offset:14368
ds_read_b64_tr_b16 v[222:223], v7 offset:14624
s_waitcnt lgkmcnt(0)
s_add_u32 s37, s39, 663552
s_add_u32 m0, s38, 8192
s_nop 0
buffer_load_dwordx4 v6, s[12:15], s37 offen lds
s_add_u32 s37, s39, 718848
s_add_u32 m0, s38, 9216
s_nop 0
buffer_load_dwordx4 v6, s[12:15], s37 offen lds
s_add_u32 s37, s39, 774144
s_add_u32 m0, s38, 10240
s_nop 0
buffer_load_dwordx4 v6, s[12:15], s37 offen lds
s_add_u32 s37, s39, 829440
s_add_u32 m0, s38, 11264
s_nop 0
buffer_load_dwordx4 v6, s[12:15], s37 offen lds
s_waitcnt vmcnt(12)
ds_read_b64_tr_b16 v[224:225], v7 offset:16384
ds_read_b64_tr_b16 v[226:227], v7 offset:16640
ds_read_b64_tr_b16 v[228:229], v7 offset:18432
ds_read_b64_tr_b16 v[230:231], v7 offset:18688
ds_read_b64_tr_b16 a[40:41], v7 offset:16416
ds_read_b64_tr_b16 a[42:43], v7 offset:16672
ds_read_b64_tr_b16 a[44:45], v7 offset:18464
ds_read_b64_tr_b16 a[46:47], v7 offset:18720
s_waitcnt lgkmcnt(0)
s_add_u32 s37, s39, 884736
s_add_u32 m0, s38, 12288
s_nop 0
buffer_load_dwordx4 v6, s[12:15], s37 offen lds
s_add_u32 s37, s39, 940032
s_add_u32 m0, s38, 13312
s_nop 0
buffer_load_dwordx4 v6, s[12:15], s37 offen lds
s_add_u32 s37, s39, 995328
s_add_u32 m0, s38, 14336
s_nop 0
buffer_load_dwordx4 v6, s[12:15], s37 offen lds
s_add_u32 s37, s39, 1050624
s_add_u32 m0, s38, 15360
s_nop 0
buffer_load_dwordx4 v6, s[12:15], s37 offen lds
s_waitcnt vmcnt(12)
ds_read_b64_tr_b16 v[232:233], v7 offset:0
ds_read_b64_tr_b16 v[234:235], v7 offset:256
ds_read_b64_tr_b16 v[236:237], v7 offset:2048
ds_read_b64_tr_b16 v[238:239], v7 offset:2304
ds_read_b64_tr_b16 a[48:49], v7 offset:32
ds_read_b64_tr_b16 a[50:51], v7 offset:288
ds_read_b64_tr_b16 a[52:53], v7 offset:2080
ds_read_b64_tr_b16 a[54:55], v7 offset:2336
s_waitcnt lgkmcnt(0)
s_add_u32 s37, s39, 1105920
s_add_u32 m0, s38, 16384
s_nop 0
buffer_load_dwordx4 v6, s[12:15], s37 offen lds
s_add_u32 s37, s39, 1161216
s_add_u32 m0, s38, 17408
s_nop 0
buffer_load_dwordx4 v6, s[12:15], s37 offen lds
s_add_u32 s37, s39, 1216512
s_add_u32 m0, s38, 18432
s_nop 0
buffer_load_dwordx4 v6, s[12:15], s37 offen lds
s_add_u32 s37, s39, 1271808
s_add_u32 m0, s38, 19456
s_nop 0
buffer_load_dwordx4 v6, s[12:15], s37 offen lds
s_waitcnt vmcnt(12)
ds_read_b64_tr_b16 v[240:241], v7 offset:4096
ds_read_b64_tr_b16 v[242:243], v7 offset:4352
ds_read_b64_tr_b16 v[244:245], v7 offset:6144
ds_read_b64_tr_b16 v[246:247], v7 offset:6400
ds_read_b64_tr_b16 a[56:57], v7 offset:4128
ds_read_b64_tr_b16 a[58:59], v7 offset:4384
ds_read_b64_tr_b16 a[60:61], v7 offset:6176
ds_read_b64_tr_b16 a[62:63], v7 offset:6432
s_waitcnt lgkmcnt(0)
s_add_u32 s37, s39, 1327104
s_add_u32 m0, s38, 0
s_nop 0
buffer_load_dwordx4 v6, s[12:15], s37 offen lds
s_add_u32 s37, s39, 1382400
s_add_u32 m0, s38, 1024
s_nop 0
buffer_load_dwordx4 v6, s[12:15], s37 offen lds
s_add_u32 s37, s39, 1437696
s_add_u32 m0, s38, 2048
s_nop 0
buffer_load_dwordx4 v6, s[12:15], s37 offen lds
s_add_u32 s37, s39, 1492992
s_add_u32 m0, s38, 3072
s_nop 0
buffer_load_dwordx4 v6, s[12:15], s37 offen lds
s_waitcnt vmcnt(12)
ds_read_b64_tr_b16 v[248:249], v7 offset:8192
ds_read_b64_tr_b16 v[250:251], v7 offset:8448
ds_read_b64_tr_b16 v[252:253], v7 offset:10240
ds_read_b64_tr_b16 v[254:255], v7 offset:10496
ds_read_b64_tr_b16 a[64:65], v7 offset:8224
ds_read_b64_tr_b16 a[66:67], v7 offset:8480
ds_read_b64_tr_b16 a[68:69], v7 offset:10272
ds_read_b64_tr_b16 a[70:71], v7 offset:10528
s_waitcnt lgkmcnt(0)
s_add_u32 s37, s39, 1548288
s_add_u32 m0, s38, 4096
s_nop 0
buffer_load_dwordx4 v6, s[12:15], s37 offen lds
s_add_u32 s37, s39, 1603584
s_add_u32 m0, s38, 5120
s_nop 0
buffer_load_dwordx4 v6, s[12:15], s37 offen lds
s_add_u32 s37, s39, 1658880
s_add_u32 m0, s38, 6144
s_nop 0
buffer_load_dwordx4 v6, s[12:15], s37 offen lds
s_add_u32 s37, s39, 1714176
s_add_u32 m0, s38, 7168
s_nop 0
buffer_load_dwordx4 v6, s[12:15], s37 offen lds
s_waitcnt vmcnt(12)
ds_read_b64_tr_b16 a[0:1], v7 offset:12288
ds_read_b64_tr_b16 a[2:3], v7 offset:12544
ds_read_b64_tr_b16 a[4:5], v7 offset:14336
ds_read_b64_tr_b16 a[6:7], v7 offset:14592
ds_read_b64_tr_b16 a[72:73], v7 offset:12320
ds_read_b64_tr_b16 a[74:75], v7 offset:12576
ds_read_b64_tr_b16 a[76:77], v7 offset:14368
ds_read_b64_tr_b16 a[78:79], v7 offset:14624
s_waitcnt lgkmcnt(0)
s_add_u32 s37, s39, 1769472
s_add_u32 m0, s38, 8192
s_nop 0
buffer_load_dwordx4 v6, s[12:15], s37 offen lds
s_add_u32 s37, s39, 1824768
s_add_u32 m0, s38, 9216
s_nop 0
buffer_load_dwordx4 v6, s[12:15], s37 offen lds
s_add_u32 s37, s39, 1880064
s_add_u32 m0, s38, 10240
s_nop 0
buffer_load_dwordx4 v6, s[12:15], s37 offen lds
s_add_u32 s37, s39, 1935360
s_add_u32 m0, s38, 11264
s_nop 0
buffer_load_dwordx4 v6, s[12:15], s37 offen lds
s_waitcnt vmcnt(12)
ds_read_b64_tr_b16 a[8:9], v7 offset:16384
ds_read_b64_tr_b16 a[10:11], v7 offset:16640
ds_read_b64_tr_b16 a[12:13], v7 offset:18432
ds_read_b64_tr_b16 a[14:15], v7 offset:18688
ds_read_b64_tr_b16 a[80:81], v7 offset:16416
ds_read_b64_tr_b16 a[82:83], v7 offset:16672
ds_read_b64_tr_b16 a[84:85], v7 offset:18464
ds_read_b64_tr_b16 a[86:87], v7 offset:18720
s_waitcnt lgkmcnt(0)
s_waitcnt vmcnt(8)
ds_read_b64_tr_b16 a[16:17], v7 offset:0
ds_read_b64_tr_b16 a[18:19], v7 offset:256
ds_read_b64_tr_b16 a[20:21], v7 offset:2048
ds_read_b64_tr_b16 a[22:23], v7 offset:2304
ds_read_b64_tr_b16 a[88:89], v7 offset:32
ds_read_b64_tr_b16 a[90:91], v7 offset:288
ds_read_b64_tr_b16 a[92:93], v7 offset:2080
ds_read_b64_tr_b16 a[94:95], v7 offset:2336
s_waitcnt lgkmcnt(0)
s_waitcnt vmcnt(4)
ds_read_b64_tr_b16 a[24:25], v7 offset:4096
ds_read_b64_tr_b16 a[26:27], v7 offset:4352
ds_read_b64_tr_b16 a[28:29], v7 offset:6144
ds_read_b64_tr_b16 a[30:31], v7 offset:6400
ds_read_b64_tr_b16 a[96:97], v7 offset:4128
ds_read_b64_tr_b16 a[98:99], v7 offset:4384
ds_read_b64_tr_b16 a[100:101], v7 offset:6176
ds_read_b64_tr_b16 a[102:103], v7 offset:6432
s_waitcnt lgkmcnt(0)
s_waitcnt vmcnt(0)
ds_read_b64_tr_b16 a[32:33], v7 offset:8192
ds_read_b64_tr_b16 a[34:35], v7 offset:8448
ds_read_b64_tr_b16 a[36:37], v7 offset:10240
ds_read_b64_tr_b16 a[38:39], v7 offset:10496
ds_read_b64_tr_b16 a[104:105], v7 offset:8224
ds_read_b64_tr_b16 a[106:107], v7 offset:8480
ds_read_b64_tr_b16 a[108:109], v7 offset:10272
ds_read_b64_tr_b16 a[110:111], v7 offset:10528
s_waitcnt lgkmcnt(0)
s_cmp_lg_u32 s34, 3
s_cbranch_scc1 L_a_nogate
v_lshlrev_b32 v12, 4, v11
buffer_load_dwordx4 v[224:227], v12, s[64:67], 0 offen offset:0
buffer_load_dwordx4 v[228:231], v12, s[64:67], 0 offen offset:64
buffer_load_dwordx4 v[232:235], v12, s[64:67], 0 offen offset:128
buffer_load_dwordx4 v[236:239], v12, s[64:67], 0 offen offset:192
buffer_load_dwordx4 v[240:243], v12, s[64:67], 0 offen offset:256
buffer_load_dwordx4 v[244:247], v12, s[64:67], 0 offen offset:320
buffer_load_dwordx4 v[248:251], v12, s[64:67], 0 offen offset:384
buffer_load_dwordx4 v[252:255], v12, s[64:67], 0 offen offset:448
buffer_load_dwordx4 a[0:3], v12, s[64:67], 0 offen offset:512
buffer_load_dwordx4 a[4:7], v12, s[64:67], 0 offen offset:576
buffer_load_dwordx4 a[8:11], v12, s[64:67], 0 offen offset:640
buffer_load_dwordx4 a[12:15], v12, s[64:67], 0 offen offset:704
buffer_load_dwordx4 a[16:19], v12, s[64:67], 0 offen offset:768
buffer_load_dwordx4 a[20:23], v12, s[64:67], 0 offen offset:832
buffer_load_dwordx4 a[24:27], v12, s[64:67], 0 offen offset:896
buffer_load_dwordx4 a[28:31], v12, s[64:67], 0 offen offset:960
buffer_load_dwordx4 a[32:35], v12, s[64:67], 0 offen offset:1024
buffer_load_dwordx4 a[36:39], v12, s[64:67], 0 offen offset:1088
L_a_nogate:
s_mov_b32 s43, s40
s_mov_b32 s35, 0
s_mov_b32 s50, 36864
.p2align 6
L_a_loop:
s_waitcnt vmcnt(0)
s_barrier
s_add_u32 s43, s43, 36864
s_add_u32 s44, s44, s50
ds_read_b128 v[64:67], v3 offset:0
ds_read_b128 v[68:71], v3 offset:1024
ds_read_b128 v[72:75], v3 offset:2048
ds_read_b128 v[76:79], v3 offset:3072
s_waitcnt lgkmcnt(2)
v_mfma_f32_16x16x32_bf16 v[16:19], v[80:83], v[64:67], 0
v_mfma_f32_16x16x32_bf16 v[20:23], v[80:83], v[68:71], 0
v_mfma_f32_16x16x32_bf16 v[24:27], v[152:155], v[64:67], 0
v_mfma_f32_16x16x32_bf16 v[28:31], v[152:155], v[68:71], 0
s_add_u32 s37, s43, 0
s_add_u32 m0, s44, 0
s_nop 0
buffer_load_dwordx4 v2, s[8:11], s37 offen lds
v_mfma_f32_16x16x32_bf16 v[32:35], v[224:227], v[64:67], 0
v_mfma_f32_16x16x32_bf16 v[36:39], v[224:227], v[68:71], 0
v_mfma_f32_16x16x32_bf16 v[40:43], a[40:43], v[64:67], 0
v_mfma_f32_16x16x32_bf16 v[44:47], a[40:43], v[68:71], 0
ds_read_b128 v[64:67], v3 offset:4096
ds_read_b128 v[68:71], v3 offset:5120
s_waitcnt lgkmcnt(2)
v_mfma_f32_16x16x32_bf16 v[16:19], v[84:87], v[72:75], v[16:19]
v_mfma_f32_16x16x32_bf16 v[20:23], v[84:87], v[76:79], v[20:23]
v_mfma_f32_16x16x32_bf16 v[24:27], v[156:159], v[72:75], v[24:27]
v_mfma_f32_16x16x32_bf16 v[28:31], v[156:159], v[76:79], v[28:31]
s_add_u32 s37, s43, 128
s_add_u32 m0, s44, 4096
s_nop 0
buffer_load_dwordx4 v2, s[8:11], s37 offen lds
v_mfma_f32_16x16x32_bf16 v[32:35], v[228:231], v[72:75], v[32:35]
v_mfma_f32_16x16x32_bf16 v[36:39], v[228:231], v[76:79], v[36:39]
v_mfma_f32_16x16x32_bf16 v[40:43], a[44:47], v[72:75], v[40:43]
v_mfma_f32_16x16x32_bf16 v[44:47], a[44:47], v[76:79], v[44:47]
ds_read_b128 v[72:75], v3 offset:6144
ds_read_b128 v[76:79], v3 offset:7168
s_waitcnt lgkmcnt(2)
v_mfma_f32_16x16x32_bf16 v[16:19], v[88:91], v[64:67], v[16:19]
v_mfma_f32_16x16x32_bf16 v[20:23], v[88:91], v[68:71], v[20:23]
v_mfma_f32_16x16x32_bf16 v[24:27], v[160:163], v[64:67], v[24:27]
v_mfma_f32_16x16x32_bf16 v[28:31], v[160:163], v[68:71], v[28:31]
s_add_u32 s37, s43, 256
s_add_u32 m0, s44, 8192
s_nop 0
buffer_load_dwordx4 v2, s[8:11], s37 offen lds
v_mfma_f32_16x16x32_bf16 v[32:35], v[232:235], v[64:67], v[32:35]
v_mfma_f32_16x16x32_bf16 v[36:39], v[232:235], v[68:71], v[36:39]
v_mfma_f32_16x16x32_bf16 v[40:43], a[48:51], v[64:67], v[40:43]
v_mfma_f32_16x16x32_bf16 v[44:47], a[48:51], v[68:71], v[44:47]
ds_read_b128 v[64:67], v3 offset:8192
ds_read_b128 v[68:71], v3 offset:9216
s_waitcnt lgkmcnt(2)
v_mfma_f32_16x16x32_bf16 v[16:19], v[92:95], v[72:75], v[16:19]
v_mfma_f32_16x16x32_bf16 v[20:23], v[92:95], v[76:79], v[20:23]
v_mfma_f32_16x16x32_bf16 v[24:27], v[164:167], v[72:75], v[24:27]
v_mfma_f32_16x16x32_bf16 v[28:31], v[164:167], v[76:79], v[28:31]
s_add_u32 s37, s43, 384
s_add_u32 m0, s44, 12288
s_nop 0
buffer_load_dwordx4 v2, s[8:11], s37 offen lds
v_mfma_f32_16x16x32_bf16 v[32:35], v[236:239], v[72:75], v[32:35]
v_mfma_f32_16x16x32_bf16 v[36:39], v[236:239], v[76:79], v[36:39]
v_mfma_f32_16x16x32_bf16 v[40:43], a[52:55], v[72:75], v[40:43]
v_mfma_f32_16x16x32_bf16 v[44:47], a[52:55], v[76:79], v[44:47]
ds_read_b128 v[72:75], v3 offset:10240
ds_read_b128 v[76:79], v3 offset:11264
s_waitcnt lgkmcnt(2)
v_mfma_f32_16x16x32_bf16 v[16:19], v[96:99], v[64:67], v[16:19]
v_mfma_f32_16x16x32_bf16 v[20:23], v[96:99], v[68:71], v[20:23]
v_mfma_f32_16x16x32_bf16 v[24:27], v[168:171], v[64:67], v[24:27]
v_mfma_f32_16x16x32_bf16 v[28:31], v[168:171], v[68:71], v[28:31]
s_add_u32 s37, s43, 512
s_add_u32 m0, s44, 16384
s_nop 0
buffer_load_dwordx4 v2, s[8:11], s37 offen lds
v_mfma_f32_16x16x32_bf16 v[32:35], v[240:243], v[64:67], v[32:35]
v_mfma_f32_16x16x32_bf16 v[36:39], v[240:243], v[68:71], v[36:39]
v_mfma_f32_16x16x32_bf16 v[40:43], a[56:59], v[64:67], v[40:43]
v_mfma_f32_16x16x32_bf16 v[44:47], a[56:59], v[68:71], v[44:47]
ds_read_b128 v[64:67], v3 offset:12288
ds_read_b128 v[68:71], v3 offset:13312
s_waitcnt lgkmcnt(2)
v_mfma_f32_16x16x32_bf16 v[16:19], v[100:103], v[72:75], v[16:19]
v_mfma_f32_16x16x32_bf16 v[20:23], v[100:103], v[76:79], v[20:23]
v_mfma_f32_16x16x32_bf16 v[24:27], v[172:175], v[72:75], v[24:27]
v_mfma_f32_16x16x32_bf16 v[28:31], v[172:175], v[76:79], v[28:31]
s_add_u32 s37, s43, 640
s_add_u32 m0, s44, 20480
s_nop 0
buffer_load_dwordx4 v2, s[8:11], s37 offen lds
v_mfma_f32_16x16x32_bf16 v[32:35], v[244:247], v[72:75], v[32:35]
v_mfma_f32_16x16x32_bf16 v[36:39], v[244:247], v[76:79], v[36:39]
v_mfma_f32_16x16x32_bf16 v[40:43], a[60:63], v[72:75], v[40:43]
v_mfma_f32_16x16x32_bf16 v[44:47], a[60:63], v[76:79], v[44:47]
ds_read_b128 v[72:75], v3 offset:14336
ds_read_b128 v[76:79], v3 offset:15360
s_waitcnt lgkmcnt(2)
v_mfma_f32_16x16x32_bf16 v[16:19], v[104:107], v[64:67], v[16:19]
v_mfma_f32_16x16x32_bf16 v[20:23], v[104:107], v[68:71], v[20:23]
v_mfma_f32_16x16x32_bf16 v[24:27], v[176:179], v[64:67], v[24:27]
v_mfma_f32_16x16x32_bf16 v[28:31], v[176:179], v[68:71], v[28:31]
s_add_u32 s37, s43, 768
s_add_u32 m0, s44, 24576
s_nop 0
buffer_load_dwordx4 v2, s[8:11], s37 offen lds
v_mfma_f32_16x16x32_bf16 v[32:35], v[248:251], v[64:67], v[32:35]
v_mfma_f32_16x16x32_bf16 v[36:39], v[248:251], v[68:71], v[36:39]
v_mfma_f32_16x16x32_bf16 v[40:43], a[64:67], v[64:67], v[40:43]
v_mfma_f32_16x16x32_bf16 v[44:47], a[64:67], v[68:71], v[44:47]
ds_read_b128 v[64:67], v3 offset:16384
ds_read_b128 v[68:71], v3 offset:17408
s_waitcnt lgkmcnt(2)
v_mfma_f32_16x16x32_bf16 v[16:19], v[108:111], v[72:75], v[16:19]
v_mfma_f32_16x16x32_bf16 v[20:23], v[108:111], v[76:79], v[20:23]
v_mfma_f32_16x16x32_bf16 v[24:27], v[180:183], v[72:75], v[24:27]
v_mfma_f32_16x16x32_bf16 v[28:31], v[180:183], v[76:79], v[28:31]
s_add_u32 s37, s43, 896
s_add_u32 m0, s44, 28672
s_nop 0
buffer_load_dwordx4 v2, s[8:11], s37 offen lds
v_mfma_f32_16x16x32_bf16 v[32:35], v[252:255], v[72:75], v[32:35]
v_mfma_f32_16x16x32_bf16 v[36:39], v[252:255], v[76:79], v[36:39]
v_mfma_f32_16x16x32_bf16 v[40:43], a[68:71], v[72:75], v[40:43]
v_mfma_f32_16x16x32_bf16 v[44:47], a[68:71], v[76:79], v[44:47]
ds_read_b128 v[72:75], v3 offset:18432
ds_read_b128 v[76:79], v3 offset:19456
s_waitcnt lgkmcnt(2)
v_mfma_f32_16x16x32_bf16 v[16:19], v[112:115], v[64:67], v[16:19]
v_mfma_f32_16x16x32_bf16 v[20:23], v[112:115], v[68:71], v[20:23]
v_mfma_f32_16x16x32_bf16 v[24:27], v[184:187], v[64:67], v[24:27]
v_mfma_f32_16x16x32_bf16 v[28:31], v[184:187], v[68:71], v[28:31]
s_add_u32 s37, s43, 1024
s_add_u32 m0, s44, 32768
s_nop 0
buffer_load_dwordx4 v2, s[8:11], s37 offen lds
v_mfma_f32_16x16x32_bf16 v[32:35], a[0:3], v[64:67], v[32:35]
v_mfma_f32_16x16x32_bf16 v[36:39], a[0:3], v[68:71], v[36:39]
v_mfma_f32_16x16x32_bf16 v[40:43], a[72:75], v[64:67], v[40:43]
v_mfma_f32_16x16x32_bf16 v[44:47], a[72:75], v[68:71], v[44:47]
ds_read_b128 v[64:67], v3 offset:20480
ds_read_b128 v[68:71], v3 offset:21504
s_waitcnt lgkmcnt(2)
v_mfma_f32_16x16x32_bf16 v[16:19], v[116:119], v[72:75], v[16:19]
v_mfma_f32_16x16x32_bf16 v[20:23], v[116:119], v[76:79], v[20:23]
v_mfma_f32_16x16x32_bf16 v[24:27], v[188:191], v[72:75], v[24:27]
v_mfma_f32_16x16x32_bf16 v[28:31], v[188:191], v[76:79], v[28:31]
v_mfma_f32_16x16x32_bf16 v[32:35], a[4:7], v[72:75], v[32:35]
v_mfma_f32_16x16x32_bf16 v[36:39], a[4:7], v[76:79], v[36:39]
v_mfma_f32_16x16x32_bf16 v[40:43], a[76:79], v[72:75], v[40:43]
v_mfma_f32_16x16x32_bf16 v[44:47], a[76:79], v[76:79], v[44:47]
ds_read_b128 v[72:75], v3 offset:22528
ds_read_b128 v[76:79], v3 offset:23552
s_waitcnt lgkmcnt(2)
v_mfma_f32_16x16x32_bf16 v[16:19], v[120:123], v[64:67], v[16:19]
v_mfma_f32_16x16x32_bf16 v[20:23], v[120:123], v[68:71], v[20:23]
v_mfma_f32_16x16x32_bf16 v[24:27], v[192:195], v[64:67], v[24:27]
v_mfma_f32_16x16x32_bf16 v[28:31], v[192:195], v[68:71], v[28:31]
v_mfma_f32_16x16x32_bf16 v[32:35], a[8:11], v[64:67], v[32:35]
v_mfma_f32_16x16x32_bf16 v[36:39], a[8:11], v[68:71], v[36:39]
v_mfma_f32_16x16x32_bf16 v[40:43], a[80:83], v[64:67], v[40:43]
v_mfma_f32_16x16x32_bf16 v[44:47], a[80:83], v[68:71], v[44:47]
ds_read_b128 v[64:67], v3 offset:24576
ds_read_b128 v[68:71], v3 offset:25600
s_waitcnt lgkmcnt(2)
v_mfma_f32_16x16x32_bf16 v[16:19], v[124:127], v[72:75], v[16:19]
v_mfma_f32_16x16x32_bf16 v[20:23], v[124:127], v[76:79], v[20:23]
v_mfma_f32_16x16x32_bf16 v[24:27], v[196:199], v[72:75], v[24:27]
v_mfma_f32_16x16x32_bf16 v[28:31], v[196:199], v[76:79], v[28:31]
v_mfma_f32_16x16x32_bf16 v[32:35], a[12:15], v[72:75], v[32:35]
v_mfma_f32_16x16x32_bf16 v[36:39], a[12:15], v[76:79], v[36:39]
v_mfma_f32_16x16x32_bf16 v[40:43], a[84:87], v[72:75], v[40:43]
v_mfma_f32_16x16x32_bf16 v[44:47], a[84:87], v[76:79], v[44:47]
ds_read_b128 v[72:75], v3 offset:26624
ds_read_b128 v[76:79], v3 offset:27648
s_waitcnt lgkmcnt(2)
v_mfma_f32_16x16x32_bf16 v[16:19], v[128:131], v[64:67], v[16:19]
v_mfma_f32_16x16x32_bf16 v[20:23], v[128:131], v[68:71], v[20:23]
v_mfma_f32_16x16x32_bf16 v[24:27], v[200:203], v[64:67], v[24:27]
v_mfma_f32_16x16x32_bf16 v[28:31], v[200:203], v[68:71], v[28:31]
v_mfma_f32_16x16x32_bf16 v[32:35], a[16:19], v[64:67], v[32:35]
v_mfma_f32_16x16x32_bf16 v[36:39], a[16:19], v[68:71], v[36:39]
v_mfma_f32_16x16x32_bf16 v[40:43], a[88:91], v[64:67], v[40:43]
v_mfma_f32_16x16x32_bf16 v[44:47], a[88:91], v[68:71], v[44:47]
ds_read_b128 v[64:67], v3 offset:28672
ds_read_b128 v[68:71], v3 offset:29696
s_waitcnt lgkmcnt(2)
v_mfma_f32_16x16x32_bf16 v[16:19], v[132:135], v[72:75], v[16:19]
v_mfma_f32_16x16x32_bf16 v[20:23], v[132:135], v[76:79], v[20:23]
v_mfma_f32_16x16x32_bf16 v[24:27], v[204:207], v[72:75], v[24:27]
v_mfma_f32_16x16x32_bf16 v[28:31], v[204:207], v[76:79], v[28:31]
v_mfma_f32_16x16x32_bf16 v[32:35], a[20:23], v[72:75], v[32:35]
v_mfma_f32_16x16x32_bf16 v[36:39], a[20:23], v[76:79], v[36:39]
v_mfma_f32_16x16x32_bf16 v[40:43], a[92:95], v[72:75], v[40:43]
v_mfma_f32_16x16x32_bf16 v[44:47], a[92:95], v[76:79], v[44:47]
ds_read_b128 v[72:75], v3 offset:30720
ds_read_b128 v[76:79], v3 offset:31744
s_waitcnt lgkmcnt(2)
v_mfma_f32_16x16x32_bf16 v[16:19], v[136:139], v[64:67], v[16:19]
v_mfma_f32_16x16x32_bf16 v[20:23], v[136:139], v[68:71], v[20:23]
v_mfma_f32_16x16x32_bf16 v[24:27], v[208:211], v[64:67], v[24:27]
v_mfma_f32_16x16x32_bf16 v[28:31], v[208:211], v[68:71], v[28:31]
v_mfma_f32_16x16x32_bf16 v[32:35], a[24:27], v[64:67], v[32:35]
v_mfma_f32_16x16x32_bf16 v[36:39], a[24:27], v[68:71], v[36:39]
v_mfma_f32_16x16x32_bf16 v[40:43], a[96:99], v[64:67], v[40:43]
v_mfma_f32_16x16x32_bf16 v[44:47], a[96:99], v[68:71], v[44:47]
ds_read_b128 v[64:67], v3 offset:32768
ds_read_b128 v[68:71], v3 offset:33792
s_waitcnt lgkmcnt(2)
v_mfma_f32_16x16x32_bf16 v[16:19], v[140:143], v[72:75], v[16:19]
v_mfma_f32_16x16x32_bf16 v[20:23], v[140:143], v[76:79], v[20:23]
v_mfma_f32_16x16x32_bf16 v[24:27], v[212:215], v[72:75], v[24:27]
v_mfma_f32_16x16x32_bf16 v[28:31], v[212:215], v[76:79], v[28:31]
v_mfma_f32_16x16x32_bf16 v[32:35], a[28:31], v[72:75], v[32:35]
v_mfma_f32_16x16x32_bf16 v[36:39], a[28:31], v[76:79], v[36:39]
v_mfma_f32_16x16x32_bf16 v[40:43], a[100:103], v[72:75], v[40:43]
v_mfma_f32_16x16x32_bf16 v[44:47], a[100:103], v[76:79], v[44:47]
ds_read_b128 v[72:75], v3 offset:34816
ds_read_b128 v[76:79], v3 offset:35840
s_waitcnt lgkmcnt(2)
v_mfma_f32_16x16x32_bf16 v[16:19], v[144:147], v[64:67], v[16:19]
v_mfma_f32_16x16x32_bf16 v[20:23], v[144:147], v[68:71], v[20:23]
v_mfma_f32_16x16x32_bf16 v[24:27], v[216:219], v[64:67], v[24:27]
v_mfma_f32_16x16x32_bf16 v[28:31], v[216:219], v[68:71], v[28:31]
v_mfma_f32_16x16x32_bf16 v[32:35], a[32:35], v[64:67], v[32:35]
v_mfma_f32_16x16x32_bf16 v[36:39], a[32:35], v[68:71], v[36:39]
v_mfma_f32_16x16x32_bf16 v[40:43], a[104:107], v[64:67], v[40:43]
v_mfma_f32_16x16x32_bf16 v[44:47], a[104:107], v[68:71], v[44:47]
s_waitcnt lgkmcnt(0)
v_mfma_f32_16x16x32_bf16 v[16:19], v[148:151], v[72:75], v[16:19]
v_mfma_f32_16x16x32_bf16 v[20:23], v[148:151], v[76:79], v[20:23]
v_mfma_f32_16x16x32_bf16 v[24:27], v[220:223], v[72:75], v[24:27]
v_mfma_f32_16x16x32_bf16 v[28:31], v[220:223], v[76:79], v[28:31]
v_mfma_f32_16x16x32_bf16 v[32:35], a[36:39], v[72:75], v[32:35]
v_mfma_f32_16x16x32_bf16 v[36:39], a[36:39], v[76:79], v[36:39]
v_mfma_f32_16x16x32_bf16 v[40:43], a[108:111], v[72:75], v[40:43]
v_mfma_f32_16x16x32_bf16 v[44:47], a[108:111], v[76:79], v[44:47]
v_add_u32 v3, s50, v3
s_sub_u32 s50, 0, s50
v_cvt_pk_bf16_f32 v16, v16, v17
v_cvt_pk_bf16_f32 v17, v18, v19
ds_write_b64 v4, v[16:17] offset:0
v_cvt_pk_bf16_f32 v20, v20, v21
v_cvt_pk_bf16_f32 v21, v22, v23
ds_write_b64 v4, v[20:21] offset:7296
v_cvt_pk_bf16_f32 v24, v24, v25
v_cvt_pk_bf16_f32 v25, v26, v27
ds_write_b64 v4, v[24:25] offset:32
v_cvt_pk_bf16_f32 v28, v28, v29
v_cvt_pk_bf16_f32 v29, v30, v31
ds_write_b64 v4, v[28:29] offset:7328
s_cmp_eq_u32 s34, 3
s_cbranch_scc1 L_a_gate
v_cvt_pk_bf16_f32 v32, v32, v33
v_cvt_pk_bf16_f32 v33, v34, v35
ds_write_b64 v4, v[32:33] offset:64
v_cvt_pk_bf16_f32 v36, v36, v37
v_cvt_pk_bf16_f32 v37, v38, v39
ds_write_b64 v4, v[36:37] offset:7360
v_cvt_pk_bf16_f32 v40, v40, v41
v_cvt_pk_bf16_f32 v41, v42, v43
ds_write_b64 v4, v[40:41] offset:96
v_cvt_pk_bf16_f32 v44, v44, v45
v_cvt_pk_bf16_f32 v45, v46, v47
ds_write_b64 v4, v[44:45] offset:7392
s_branch L_a_nog2
L_a_gate:
ds_write_b32 v14, v32
ds_write_b32 v14, v36 offset:64
L_a_nog2:
v_add_u32 v4, 14592, v4
v_add_u32 v14, 128, v14
s_add_u32 s35, s35, 1
s_cmp_lt_u32 s35, 6
s_cbranch_scc1 L_a_loop
s_waitcnt vmcnt(0) lgkmcnt(0)
s_barrier
s_mov_b32 s35, 0
s_mul_i32 s39, s34, 36
s_add_u32 s39, s39, 73728
s_mul_i32 s40, s33, 176
s_mov_b32 s41, 0x3eae1a93
s_mov_b32 s42, 0xbfb8aa3b
L_la_loop:
v_add_u32 v12, s35, v9
v_min_u32 v12, 175, v12
v_add_u32 v2, s40, v12
v_add_u32 v12, 16, v12
v_mul_u32_u24 v14, 456, v12
v_add_u32 v14, s39, v14
v_lshlrev_b32 v12, 2, v12
v_add_u32 v12, 161280, v12
ds_read_b32 v3, v12
ds_read2_b32 v[16:17], v14 offset0:0 offset1:1
ds_read2_b32 v[18:19], v14 offset0:2 offset1:3
ds_read2_b32 v[20:21], v14 offset0:4 offset1:5
ds_read2_b32 v[22:23], v14 offset0:6 offset1:7
ds_read_b32 v24, v14 offset:32
v_subrev_u32 v15, 0, v14
ds_read2_b32 v[26:27], v15 offset0:36 offset1:37
ds_read2_b32 v[28:29], v15 offset0:38 offset1:39
ds_read2_b32 v[30:31], v15 offset0:40 offset1:41
ds_read2_b32 v[32:33], v15 offset0:42 offset1:43
ds_read_b32 v34, v15 offset:176
v_subrev_u32 v15, 912, v14
ds_read2_b32 v[36:37], v15 offset0:36 offset1:37
ds_read2_b32 v[38:39], v15 offset0:38 offset1:39
ds_read2_b32 v[40:41], v15 offset0:40 offset1:41
ds_read2_b32 v[42:43], v15 offset0:42 offset1:43
ds_read_b32 v44, v15 offset:176
s_waitcnt lgkmcnt(5)
v_dot2_f32_bf16 v176, v16, v26, 0
v_dot2_f32_bf16 v176, v17, v27, v176
v_dot2_f32_bf16 v176, v18, v28, v176
v_dot2_f32_bf16 v176, v19, v29, v176
v_dot2_f32_bf16 v176, v20, v30, v176
v_dot2_f32_bf16 v176, v21, v31, v176
v_dot2_f32_bf16 v176, v22, v32, v176
v_dot2_f32_bf16 v176, v23, v33, v176
v_dot2_f32_bf16 v176, v24, v34, v176
v_subrev_u32 v15, 1824, v14
ds_read2_b32 v[46:47], v15 offset0:36 offset1:37
ds_read2_b32 v[48:49], v15 offset0:38 offset1:39
ds_read2_b32 v[50:51], v15 offset0:40 offset1:41
ds_read2_b32 v[52:53], v15 offset0:42 offset1:43
ds_read_b32 v54, v15 offset:176
s_waitcnt lgkmcnt(5)
v_dot2_f32_bf16 v177, v16, v36, 0
v_dot2_f32_bf16 v177, v17, v37, v177
v_dot2_f32_bf16 v177, v18, v38, v177
v_dot2_f32_bf16 v177, v19, v39, v177
v_dot2_f32_bf16 v177, v20, v40, v177
v_dot2_f32_bf16 v177, v21, v41, v177
v_dot2_f32_bf16 v177, v22, v42, v177
v_dot2_f32_bf16 v177, v23, v43, v177
v_dot2_f32_bf16 v177, v24, v44, v177
v_subrev_u32 v15, 2736, v14
ds_read2_b32 v[56:57], v15 offset0:36 offset1:37
ds_read2_b32 v[58:59], v15 offset0:38 offset1:39
ds_read2_b32 v[60:61], v15 offset0:40 offset1:41
ds_read2_b32 v[62:63], v15 offset0:42 offset1:43
ds_read_b32 v64, v15 offset:176
s_waitcnt lgkmcnt(5)
v_dot2_f32_bf16 v178, v16, v46, 0
v_dot2_f32_bf16 v178, v17, v47, v178
v_dot2_f32_bf16 v178, v18, v48, v178
v_dot2_f32_bf16 v178, v19, v49, v178
v_dot2_f32_bf16 v178, v20, v50, v178
v_dot2_f32_bf16 v178, v21, v51, v178
v_dot2_f32_bf16 v178, v22, v52, v178
v_dot2_f32_bf16 v178, v23, v53, v178
v_dot2_f32_bf16 v178, v24, v54, v178
v_subrev_u32 v15, 3648, v14
ds_read2_b32 v[26:27], v15 offset0:36 offset1:37
ds_read2_b32 v[28:29], v15 offset0:38 offset1:39
ds_read2_b32 v[30:31], v15 offset0:40 offset1:41
ds_read2_b32 v[32:33], v15 offset0:42 offset1:43
ds_read_b32 v34, v15 offset:176
s_waitcnt lgkmcnt(5)
v_dot2_f32_bf16 v179, v16, v56, 0
v_dot2_f32_bf16 v179, v17, v57, v179
v_dot2_f32_bf16 v179, v18, v58, v179
v_dot2_f32_bf16 v179, v19, v59, v179
v_dot2_f32_bf16 v179, v20, v60, v179
v_dot2_f32_bf16 v179, v21, v61, v179
v_dot2_f32_bf16 v179, v22, v62, v179
v_dot2_f32_bf16 v179, v23, v63, v179
v_dot2_f32_bf16 v179, v24, v64, v179
v_subrev_u32 v15, 4560, v14
ds_read2_b32 v[36:37], v15 offset0:36 offset1:37
ds_read2_b32 v[38:39], v15 offset0:38 offset1:39
ds_read2_b32 v[40:41], v15 offset0:40 offset1:41
ds_read2_b32 v[42:43], v15 offset0:42 offset1:43
ds_read_b32 v44, v15 offset:176
s_waitcnt lgkmcnt(5)
v_dot2_f32_bf16 v180, v16, v26, 0
v_dot2_f32_bf16 v180, v17, v27, v180
v_dot2_f32_bf16 v180, v18, v28, v180
v_dot2_f32_bf16 v180, v19, v29, v180
v_dot2_f32_bf16 v180, v20, v30, v180
v_dot2_f32_bf16 v180, v21, v31, v180
v_dot2_f32_bf16 v180, v22, v32, v180
v_dot2_f32_bf16 v180, v23, v33, v180
v_dot2_f32_bf16 v180, v24, v34, v180
v_subrev_u32 v15, 5472, v14
ds_read2_b32 v[46:47], v15 offset0:36 offset1:37
ds_read2_b32 v[48:49], v15 offset0:38 offset1:39
ds_read2_b32 v[50:51], v15 offset0:40 offset1:41
ds_read2_b32 v[52:53], v15 offset0:42 offset1:43
ds_read_b32 v54, v15 offset:176
s_waitcnt lgkmcnt(5)
v_dot2_f32_bf16 v181, v16, v36, 0
v_dot2_f32_bf16 v181, v17, v37, v181
v_dot2_f32_bf16 v181, v18, v38, v181
v_dot2_f32_bf16 v181, v19, v39, v181
v_dot2_f32_bf16 v181, v20, v40, v181
v_dot2_f32_bf16 v181, v21, v41, v181
v_dot2_f32_bf16 v181, v22, v42, v181
v_dot2_f32_bf16 v181, v23, v43, v181
v_dot2_f32_bf16 v181, v24, v44, v181
v_subrev_u32 v15, 6384, v14
ds_read2_b32 v[56:57], v15 offset0:36 offset1:37
ds_read2_b32 v[58:59], v15 offset0:38 offset1:39
ds_read2_b32 v[60:61], v15 offset0:40 offset1:41
ds_read2_b32 v[62:63], v15 offset0:42 offset1:43
ds_read_b32 v64, v15 offset:176
s_waitcnt lgkmcnt(5)
v_dot2_f32_bf16 v182, v16, v46, 0
v_dot2_f32_bf16 v182, v17, v47, v182
v_dot2_f32_bf16 v182, v18, v48, v182
v_dot2_f32_bf16 v182, v19, v49, v182
v_dot2_f32_bf16 v182, v20, v50, v182
v_dot2_f32_bf16 v182, v21, v51, v182
v_dot2_f32_bf16 v182, v22, v52, v182
v_dot2_f32_bf16 v182, v23, v53, v182
v_dot2_f32_bf16 v182, v24, v54, v182
s_waitcnt lgkmcnt(0)
v_dot2_f32_bf16 v183, v16, v56, 0
v_dot2_f32_bf16 v183, v17, v57, v183
v_dot2_f32_bf16 v183, v18, v58, v183
v_dot2_f32_bf16 v183, v19, v59, v183
v_dot2_f32_bf16 v183, v20, v60, v183
v_dot2_f32_bf16 v183, v21, v61, v183
v_dot2_f32_bf16 v183, v22, v62, v183
v_dot2_f32_bf16 v183, v23, v63, v183
v_dot2_f32_bf16 v183, v24, v64, v183
v_subrev_u32 v15, 0, v14
ds_read2_b32 v[100:101], v15 offset0:72 offset1:73
ds_read2_b32 v[102:103], v15 offset0:74 offset1:75
ds_read2_b32 v[104:105], v15 offset0:76 offset1:77
ds_read2_b32 v[106:107], v15 offset0:78 offset1:79
ds_read_b32 v108, v15 offset:320
v_subrev_u32 v15, 912, v14
ds_read2_b32 v[110:111], v15 offset0:72 offset1:73
ds_read2_b32 v[112:113], v15 offset0:74 offset1:75
ds_read2_b32 v[114:115], v15 offset0:76 offset1:77
ds_read2_b32 v[116:117], v15 offset0:78 offset1:79
ds_read_b32 v118, v15 offset:320
v_mov_b32 v13, 0xf149f2ca
v_mul_f32 v176, s41, v176
v_mul_f32 v177, s41, v177
v_mul_f32 v178, s41, v178
v_mul_f32 v179, s41, v179
v_mul_f32 v180, s41, v180
v_mul_f32 v181, s41, v181
v_mul_f32 v182, s41, v182
v_mul_f32 v183, s41, v183
v_cmp_le_u32 vcc, 2, v2
s_nop 1
v_cndmask_b32 v177, v13, v177, vcc
v_cmp_le_u32 vcc, 4, v2
s_nop 1
v_cndmask_b32 v178, v13, v178, vcc
v_cmp_le_u32 vcc, 6, v2
s_nop 1
v_cndmask_b32 v179, v13, v179, vcc
v_cmp_le_u32 vcc, 8, v2
s_nop 1
v_cndmask_b32 v180, v13, v180, vcc
v_cmp_le_u32 vcc, 10, v2
s_nop 1
v_cndmask_b32 v181, v13, v181, vcc
v_cmp_le_u32 vcc, 12, v2
s_nop 1
v_cndmask_b32 v182, v13, v182, vcc
v_cmp_le_u32 vcc, 14, v2
s_nop 1
v_cndmask_b32 v183, v13, v183, vcc
v_max3_f32 v12, v176, v177, v178
v_max3_f32 v12, v12, v179, v180
v_max3_f32 v12, v12, v181, v182
v_max_f32 v12, v12, v183
v_sub_f32 v176, v176, v12
v_sub_f32 v177, v177, v12
v_sub_f32 v178, v178, v12
v_sub_f32 v179, v179, v12
v_sub_f32 v180, v180, v12
v_sub_f32 v181, v181, v12
v_sub_f32 v182, v182, v12
v_sub_f32 v183, v183, v12
v_exp_f32 v176, v176
v_exp_f32 v177, v177
v_exp_f32 v178, v178
v_exp_f32 v179, v179
v_exp_f32 v180, v180
v_exp_f32 v181, v181
v_exp_f32 v182, v182
v_exp_f32 v183, v183
v_cvt_pk_bf16_f32 v204, v176, v8
v_cvt_pk_bf16_f32 v205, v177, v8
v_cvt_pk_bf16_f32 v206, v178, v8
v_cvt_pk_bf16_f32 v207, v179, v8
v_cvt_pk_bf16_f32 v208, v180, v8
v_cvt_pk_bf16_f32 v209, v181, v8
v_cvt_pk_bf16_f32 v210, v182, v8
v_cvt_pk_bf16_f32 v211, v183, v8
v_lshlrev_b32 v212, 16, v204
v_lshlrev_b32 v213, 16, v205
v_lshlrev_b32 v214, 16, v206
v_lshlrev_b32 v215, 16, v207
v_lshlrev_b32 v216, 16, v208
v_lshlrev_b32 v217, 16, v209
v_lshlrev_b32 v218, 16, v210
v_lshlrev_b32 v219, 16, v211
v_add_f32 v12, v212, v213
v_add_f32 v13, v214, v215
v_add_f32 v12, v12, v216
v_add_f32 v13, v13, v217
v_add_f32 v12, v12, v218
v_add_f32 v13, v13, v219
v_add_f32 v12, v12, v13
v_mul_f32 v13, s42, v3
v_exp_f32 v3, v13
v_exp_f32 v13, -v13
v_add_f32 v3, 1.0, v3
v_add_f32 v13, 1.0, v13
v_mul_f32 v12, v12, v3
v_rcp_f32 v12, v12
v_rcp_f32 v13, v13
v_subrev_u32 v15, 1824, v14
ds_read2_b32 v[120:121], v15 offset0:72 offset1:73
ds_read2_b32 v[122:123], v15 offset0:74 offset1:75
ds_read2_b32 v[124:125], v15 offset0:76 offset1:77
ds_read2_b32 v[126:127], v15 offset0:78 offset1:79
ds_read_b32 v128, v15 offset:320
s_waitcnt lgkmcnt(10)
v_dot2_f32_bf16 v184, v100, v204, 0
v_dot2_f32_bf16 v185, v100, v212, 0
v_dot2_f32_bf16 v186, v101, v204, 0
v_dot2_f32_bf16 v187, v101, v212, 0
v_dot2_f32_bf16 v188, v102, v204, 0
v_dot2_f32_bf16 v189, v102, v212, 0
v_dot2_f32_bf16 v190, v103, v204, 0
v_dot2_f32_bf16 v191, v103, v212, 0
v_dot2_f32_bf16 v192, v104, v204, 0
v_dot2_f32_bf16 v193, v104, v212, 0
v_dot2_f32_bf16 v194, v105, v204, 0
v_dot2_f32_bf16 v195, v105, v212, 0
v_dot2_f32_bf16 v196, v106, v204, 0
v_dot2_f32_bf16 v197, v106, v212, 0
v_dot2_f32_bf16 v198, v107, v204, 0
v_dot2_f32_bf16 v199, v107, v212, 0
v_dot2_f32_bf16 v200, v108, v204, 0
v_dot2_f32_bf16 v201, v108, v212, 0
v_subrev_u32 v15, 2736, v14
ds_read2_b32 v[130:131], v15 offset0:72 offset1:73
ds_read2_b32 v[132:133], v15 offset0:74 offset1:75
ds_read2_b32 v[134:135], v15 offset0:76 offset1:77
ds_read2_b32 v[136:137], v15 offset0:78 offset1:79
ds_read_b32 v138, v15 offset:320
s_waitcnt lgkmcnt(10)
v_dot2_f32_bf16 v184, v110, v205, v184
v_dot2_f32_bf16 v185, v110, v213, v185
v_dot2_f32_bf16 v186, v111, v205, v186
v_dot2_f32_bf16 v187, v111, v213, v187
v_dot2_f32_bf16 v188, v112, v205, v188
v_dot2_f32_bf16 v189, v112, v213, v189
v_dot2_f32_bf16 v190, v113, v205, v190
v_dot2_f32_bf16 v191, v113, v213, v191
v_dot2_f32_bf16 v192, v114, v205, v192
v_dot2_f32_bf16 v193, v114, v213, v193
v_dot2_f32_bf16 v194, v115, v205, v194
v_dot2_f32_bf16 v195, v115, v213, v195
v_dot2_f32_bf16 v196, v116, v205, v196
v_dot2_f32_bf16 v197, v116, v213, v197
v_dot2_f32_bf16 v198, v117, v205, v198
v_dot2_f32_bf16 v199, v117, v213, v199
v_dot2_f32_bf16 v200, v118, v205, v200
v_dot2_f32_bf16 v201, v118, v213, v201
v_subrev_u32 v15, 3648, v14
ds_read2_b32 v[100:101], v15 offset0:72 offset1:73
ds_read2_b32 v[102:103], v15 offset0:74 offset1:75
ds_read2_b32 v[104:105], v15 offset0:76 offset1:77
ds_read2_b32 v[106:107], v15 offset0:78 offset1:79
ds_read_b32 v108, v15 offset:320
s_waitcnt lgkmcnt(10)
v_dot2_f32_bf16 v184, v120, v206, v184
v_dot2_f32_bf16 v185, v120, v214, v185
v_dot2_f32_bf16 v186, v121, v206, v186
v_dot2_f32_bf16 v187, v121, v214, v187
v_dot2_f32_bf16 v188, v122, v206, v188
v_dot2_f32_bf16 v189, v122, v214, v189
v_dot2_f32_bf16 v190, v123, v206, v190
v_dot2_f32_bf16 v191, v123, v214, v191
v_dot2_f32_bf16 v192, v124, v206, v192
v_dot2_f32_bf16 v193, v124, v214, v193
v_dot2_f32_bf16 v194, v125, v206, v194
v_dot2_f32_bf16 v195, v125, v214, v195
v_dot2_f32_bf16 v196, v126, v206, v196
v_dot2_f32_bf16 v197, v126, v214, v197
v_dot2_f32_bf16 v198, v127, v206, v198
v_dot2_f32_bf16 v199, v127, v214, v199
v_dot2_f32_bf16 v200, v128, v206, v200
v_dot2_f32_bf16 v201, v128, v214, v201
v_subrev_u32 v15, 4560, v14
ds_read2_b32 v[110:111], v15 offset0:72 offset1:73
ds_read2_b32 v[112:113], v15 offset0:74 offset1:75
ds_read2_b32 v[114:115], v15 offset0:76 offset1:77
ds_read2_b32 v[116:117], v15 offset0:78 offset1:79
ds_read_b32 v118, v15 offset:320
s_waitcnt lgkmcnt(10)
v_dot2_f32_bf16 v184, v130, v207, v184
v_dot2_f32_bf16 v185, v130, v215, v185
v_dot2_f32_bf16 v186, v131, v207, v186
v_dot2_f32_bf16 v187, v131, v215, v187
v_dot2_f32_bf16 v188, v132, v207, v188
v_dot2_f32_bf16 v189, v132, v215, v189
v_dot2_f32_bf16 v190, v133, v207, v190
v_dot2_f32_bf16 v191, v133, v215, v191
v_dot2_f32_bf16 v192, v134, v207, v192
v_dot2_f32_bf16 v193, v134, v215, v193
v_dot2_f32_bf16 v194, v135, v207, v194
v_dot2_f32_bf16 v195, v135, v215, v195
v_dot2_f32_bf16 v196, v136, v207, v196
v_dot2_f32_bf16 v197, v136, v215, v197
v_dot2_f32_bf16 v198, v137, v207, v198
v_dot2_f32_bf16 v199, v137, v215, v199
v_dot2_f32_bf16 v200, v138, v207, v200
v_dot2_f32_bf16 v201, v138, v215, v201
v_subrev_u32 v15, 5472, v14
ds_read2_b32 v[120:121], v15 offset0:72 offset1:73
ds_read2_b32 v[122:123], v15 offset0:74 offset1:75
ds_read2_b32 v[124:125], v15 offset0:76 offset1:77
ds_read2_b32 v[126:127], v15 offset0:78 offset1:79
ds_read_b32 v128, v15 offset:320
s_waitcnt lgkmcnt(10)
v_dot2_f32_bf16 v184, v100, v208, v184
v_dot2_f32_bf16 v185, v100, v216, v185
v_dot2_f32_bf16 v186, v101, v208, v186
v_dot2_f32_bf16 v187, v101, v216, v187
v_dot2_f32_bf16 v188, v102, v208, v188
v_dot2_f32_bf16 v189, v102, v216, v189
v_dot2_f32_bf16 v190, v103, v208, v190
v_dot2_f32_bf16 v191, v103, v216, v191
v_dot2_f32_bf16 v192, v104, v208, v192
v_dot2_f32_bf16 v193, v104, v216, v193
v_dot2_f32_bf16 v194, v105, v208, v194
v_dot2_f32_bf16 v195, v105, v216, v195
v_dot2_f32_bf16 v196, v106, v208, v196
v_dot2_f32_bf16 v197, v106, v216, v197
v_dot2_f32_bf16 v198, v107, v208, v198
v_dot2_f32_bf16 v199, v107, v216, v199
v_dot2_f32_bf16 v200, v108, v208, v200
v_dot2_f32_bf16 v201, v108, v216, v201
v_subrev_u32 v15, 6384, v14
ds_read2_b32 v[130:131], v15 offset0:72 offset1:73
ds_read2_b32 v[132:133], v15 offset0:74 offset1:75
ds_read2_b32 v[134:135], v15 offset0:76 offset1:77
ds_read2_b32 v[136:137], v15 offset0:78 offset1:79
ds_read_b32 v138, v15 offset:320
s_waitcnt lgkmcnt(10)
v_dot2_f32_bf16 v184, v110, v209, v184
v_dot2_f32_bf16 v185, v110, v217, v185
v_dot2_f32_bf16 v186, v111, v209, v186
v_dot2_f32_bf16 v187, v111, v217, v187
v_dot2_f32_bf16 v188, v112, v209, v188
v_dot2_f32_bf16 v189, v112, v217, v189
v_dot2_f32_bf16 v190, v113, v209, v190
v_dot2_f32_bf16 v191, v113, v217, v191
v_dot2_f32_bf16 v192, v114, v209, v192
v_dot2_f32_bf16 v193, v114, v217, v193
v_dot2_f32_bf16 v194, v115, v209, v194
v_dot2_f32_bf16 v195, v115, v217, v195
v_dot2_f32_bf16 v196, v116, v209, v196
v_dot2_f32_bf16 v197, v116, v217, v197
v_dot2_f32_bf16 v198, v117, v209, v198
v_dot2_f32_bf16 v199, v117, v217, v199
v_dot2_f32_bf16 v200, v118, v209, v200
v_dot2_f32_bf16 v201, v118, v217, v201
s_waitcnt lgkmcnt(5)
v_dot2_f32_bf16 v184, v120, v210, v184
v_dot2_f32_bf16 v185, v120, v218, v185
v_dot2_f32_bf16 v186, v121, v210, v186
v_dot2_f32_bf16 v187, v121, v218, v187
v_dot2_f32_bf16 v188, v122, v210, v188
v_dot2_f32_bf16 v189, v122, v218, v189
v_dot2_f32_bf16 v190, v123, v210, v190
v_dot2_f32_bf16 v191, v123, v218, v191
v_dot2_f32_bf16 v192, v124, v210, v192
v_dot2_f32_bf16 v193, v124, v218, v193
v_dot2_f32_bf16 v194, v125, v210, v194
v_dot2_f32_bf16 v195, v125, v218, v195
v_dot2_f32_bf16 v196, v126, v210, v196
v_dot2_f32_bf16 v197, v126, v218, v197
v_dot2_f32_bf16 v198, v127, v210, v198
v_dot2_f32_bf16 v199, v127, v218, v199
v_dot2_f32_bf16 v200, v128, v210, v200
v_dot2_f32_bf16 v201, v128, v218, v201
s_waitcnt lgkmcnt(0)
v_dot2_f32_bf16 v184, v130, v211, v184
v_dot2_f32_bf16 v185, v130, v219, v185
v_dot2_f32_bf16 v186, v131, v211, v186
v_dot2_f32_bf16 v187, v131, v219, v187
v_dot2_f32_bf16 v188, v132, v211, v188
v_dot2_f32_bf16 v189, v132, v219, v189
v_dot2_f32_bf16 v190, v133, v211, v190
v_dot2_f32_bf16 v191, v133, v219, v191
v_dot2_f32_bf16 v192, v134, v211, v192
v_dot2_f32_bf16 v193, v134, v219, v193
v_dot2_f32_bf16 v194, v135, v211, v194
v_dot2_f32_bf16 v195, v135, v219, v195
v_dot2_f32_bf16 v196, v136, v211, v196
v_dot2_f32_bf16 v197, v136, v219, v197
v_dot2_f32_bf16 v198, v137, v211, v198
v_dot2_f32_bf16 v199, v137, v219, v199
v_dot2_f32_bf16 v200, v138, v211, v200
v_dot2_f32_bf16 v201, v138, v219, v201
s_or_b32 s37, s32, s34
s_cmp_lg_u32 s37, 0
s_cbranch_scc1 L_la_noomg
v_lshlrev_b32 v15, 2, v2
v_min_u32 v15, 8192, v15
s_mov_b32 s37, 87031808
buffer_store_dword v13, v15, s[4:7], s37 offen sc0 sc1
L_la_noomg:
v_mul_f32 v184, v184, v12
v_mul_f32 v185, v185, v12
v_mul_f32 v186, v186, v12
v_mul_f32 v187, v187, v12
v_mul_f32 v188, v188, v12
v_mul_f32 v189, v189, v12
v_mul_f32 v190, v190, v12
v_mul_f32 v191, v191, v12
v_mul_f32 v192, v192, v12
v_mul_f32 v193, v193, v12
v_mul_f32 v194, v194, v12
v_mul_f32 v195, v195, v12
v_mul_f32 v196, v196, v12
v_mul_f32 v197, v197, v12
v_mul_f32 v198, v198, v12
v_mul_f32 v199, v199, v12
v_mul_f32 v200, v200, v12
v_mul_f32 v201, v201, v12
v_cvt_pk_bf16_f32 v184, v184, v185
v_cvt_pk_bf16_f32 v185, v186, v187
v_cvt_pk_bf16_f32 v186, v188, v189
v_cvt_pk_bf16_f32 v187, v190, v191
v_cvt_pk_bf16_f32 v188, v192, v193
v_cvt_pk_bf16_f32 v189, v194, v195
v_cvt_pk_bf16_f32 v190, v196, v197
v_cvt_pk_bf16_f32 v191, v198, v199
v_cvt_pk_bf16_f32 v192, v200, v201
ds_write2_b32 v14, v184, v185 offset0:0 offset1:1
ds_write2_b32 v14, v186, v187 offset0:2 offset1:3
ds_write2_b32 v14, v188, v189 offset0:4 offset1:5
ds_write2_b32 v14, v190, v191 offset0:6 offset1:7
ds_write_b32 v14, v192 offset:32
s_add_u32 s35, s35, 64
s_cmp_lt_u32 s35, 192
s_cbranch_scc1 L_la_loop
s_waitcnt lgkmcnt(0)
s_barrier
v_mul_u32_u24 v14, 456, v10
v_lshl_add_u32 v14, v11, 4, v14
s_add_u32 s37, s34, 1
s_mul_i32 s37, s37, 7296
s_add_u32 s37, s37, 73728
v_add_u32 v14, s37, v14
s_mul_i32 s40, s33, 11
s_add_u32 s40, s40, s34
s_mov_b32 s35, s34
s_mul_i32 s41, s32, 2304
s_add_u32 s41, s41, 83886080
L_oa_loop:
s_cmp_ge_u32 s40, 128
s_cbranch_scc1 L_oa_done
ds_read2_b64 v[16:19], v14 offset0:0 offset1:1
ds_read2_b64 v[20:23], v14 offset0:8 offset1:9
ds_read2_b64 v[24:27], v14 offset0:16 offset1:17
s_mul_i32 s37, s40, 18432
s_add_u32 s37, s37, s41
s_waitcnt lgkmcnt(2)
buffer_store_dwordx4 v[16:19], v1, s[4:7], s37 offen offset:0 sc0 sc1
s_waitcnt lgkmcnt(1)
buffer_store_dwordx4 v[20:23], v1, s[4:7], s37 offen offset:1024 sc0 sc1
s_waitcnt lgkmcnt(0)
s_mov_b64 exec, 0xffff
buffer_store_dwordx4 v[24:27], v1, s[4:7], s37 offen offset:2048 sc0 sc1
s_mov_b64 exec, -1
v_add_u32 v14, 29184, v14
s_add_u32 s40, s40, 4
s_add_u32 s35, s35, 4
s_cmp_lt_u32 s35, 11
s_cbranch_scc1 L_oa_loop
L_oa_done:
s_waitcnt vmcnt(0)
s_barrier
s_cmp_lg_u32 s34, 0
s_cbranch_scc1 L_a_sig
v_mov_b32 v12, 1
s_mov_b64 exec, 1
buffer_atomic_add v12, v8, s[24:27], 0 offen offset:4 sc1
s_mov_b64 exec, -1
L_a_sig:
v_add_u32 v12, 0, v9
v_mul_u32_u24 v13, 171, v12
v_lshrrev_b32 v13, 10, v13
v_mul_u32_u24 v13, 1056, v13
v_lshl_add_u32 v2, v12, 4, v13
v_add_u32 v12, 64, v9
v_mul_u32_u24 v13, 171, v12
v_lshrrev_b32 v13, 10, v13
v_mul_u32_u24 v13, 1056, v13
v_lshl_add_u32 v3, v12, 4, v13
v_add_u32 v12, 128, v9
v_mul_u32_u24 v13, 171, v12
v_lshrrev_b32 v13, 10, v13
v_mul_u32_u24 v13, 1056, v13
v_lshl_add_u32 v4, v12, 4, v13
v_lshrrev_b32 v12, 2, v10
v_lshl_add_u32 v12, v11, 2, v12
v_mul_u32_u24 v5, 96, v12
v_and_b32 v12, 3, v10
v_lshl_add_u32 v5, v12, 3, v5
v_lshrrev_b32 v12, 2, v10
v_lshl_add_u32 v12, v11, 3, v12
v_mul_u32_u24 v6, 96, v12
v_and_b32 v12, 3, v10
v_lshl_add_u32 v6, v12, 3, v6
s_lshl_b32 s50, s34, 15
v_add_u32 v5, s50, v5
v_add_u32 v6, s50, v6
v_add_u32 v7, s50, v1
s_mul_i32 s37, s49, 96
s_mul_i32 s51, s34, 1179648
s_add_u32 s51, s51, s37
s_mul_i32 s52, s34, 184320
s_add_u32 s52, s52, s37
v_mul_u32_u24 v15, 1152, v10
v_lshl_add_u32 v15, v11, 3, v15
s_lshl_b32 s38, s34, 5
s_add_u32 s37, s37, s38
s_mul_i32 s55, s48, 18432
s_add_u32 s54, s55, 83886080
s_add_u32 s55, s55, s37
s_lshl_b32 s53, s48, 17
s_add_u32 s53, s53, s50
s_add_u32 s53, s53, 67108864
s_lshl_b32 s56, s48, 6
s_add_u32 s56, s56, 87031808
s_lshl_b32 s57, s48, 8
s_add_u32 s57, s57, 331776
v_lshlrev_b32 v9, 2, v9
v_lshlrev_b32 v10, 2, v10
v_add_u32 v14, 131072, v1
s_add_u32 s37, s52, 0
s_add_u32 m0, s50, 0
s_nop 0
buffer_load_dwordx4 v2, s[16:19], s37 offen lds
s_add_u32 m0, s50, 1024
s_nop 0
buffer_load_dwordx4 v3, s[16:19], s37 offen lds
s_add_u32 m0, s50, 2048
s_nop 0
buffer_load_dwordx4 v4, s[16:19], s37 offen lds
s_add_u32 s37, s52, 36864
s_add_u32 m0, s50, 3072
s_nop 0
buffer_load_dwordx4 v2, s[16:19], s37 offen lds
s_add_u32 m0, s50, 4096
s_nop 0
buffer_load_dwordx4 v3, s[16:19], s37 offen lds
s_add_u32 m0, s50, 5120
s_nop 0
buffer_load_dwordx4 v4, s[16:19], s37 offen lds
s_add_u32 s37, s52, 73728
s_add_u32 m0, s50, 6144
s_nop 0
buffer_load_dwordx4 v2, s[16:19], s37 offen lds
s_add_u32 m0, s50, 7168
s_nop 0
buffer_load_dwordx4 v3, s[16:19], s37 offen lds
s_add_u32 m0, s50, 8192
s_nop 0
buffer_load_dwordx4 v4, s[16:19], s37 offen lds
s_add_u32 s37, s52, 110592
s_add_u32 m0, s50, 9216
s_nop 0
buffer_load_dwordx4 v2, s[16:19], s37 offen lds
s_add_u32 m0, s50, 10240
s_nop 0
buffer_load_dwordx4 v3, s[16:19], s37 offen lds
s_add_u32 m0, s50, 11264
s_nop 0
buffer_load_dwordx4 v4, s[16:19], s37 offen lds
s_add_u32 s37, s52, 147456
s_add_u32 m0, s50, 12288
s_nop 0
buffer_load_dwordx4 v2, s[16:19], s37 offen lds
s_add_u32 m0, s50, 13312
s_nop 0
buffer_load_dwordx4 v3, s[16:19], s37 offen lds
s_add_u32 m0, s50, 14336
s_nop 0
buffer_load_dwordx4 v4, s[16:19], s37 offen lds
s_add_u32 s37, s51, 0
s_add_u32 m0, s50, 15360
s_nop 0
buffer_load_dwordx4 v2, s[20:23], s37 offen lds
s_add_u32 m0, s50, 16384
s_nop 0
buffer_load_dwordx4 v3, s[20:23], s37 offen lds
s_add_u32 m0, s50, 17408
s_nop 0
buffer_load_dwordx4 v4, s[20:23], s37 offen lds
s_add_u32 s37, s51, 36864
s_add_u32 m0, s50, 18432
s_nop 0
buffer_load_dwordx4 v2, s[20:23], s37 offen lds
s_add_u32 m0, s50, 19456
s_nop 0
buffer_load_dwordx4 v3, s[20:23], s37 offen lds
s_add_u32 m0, s50, 20480
s_nop 0
buffer_load_dwordx4 v4, s[20:23], s37 offen lds
s_add_u32 s37, s51, 73728
s_add_u32 m0, s50, 21504
s_nop 0
buffer_load_dwordx4 v2, s[20:23], s37 offen lds
s_add_u32 m0, s50, 22528
s_nop 0
buffer_load_dwordx4 v3, s[20:23], s37 offen lds
s_add_u32 m0, s50, 23552
s_nop 0
buffer_load_dwordx4 v4, s[20:23], s37 offen lds
s_add_u32 s37, s51, 110592
s_add_u32 m0, s50, 24576
s_nop 0
buffer_load_dwordx4 v2, s[20:23], s37 offen lds
s_add_u32 m0, s50, 25600
s_nop 0
buffer_load_dwordx4 v3, s[20:23], s37 offen lds
s_add_u32 m0, s50, 26624
s_nop 0
buffer_load_dwordx4 v4, s[20:23], s37 offen lds
s_waitcnt vmcnt(24)
ds_read_b64_tr_b16 v[68:69], v6 offset:0
ds_read_b64_tr_b16 v[70:71], v6 offset:384
ds_read_b64_tr_b16 v[72:73], v6 offset:32
ds_read_b64_tr_b16 v[74:75], v6 offset:416
ds_read_b64_tr_b16 v[76:77], v6 offset:64
ds_read_b64_tr_b16 v[78:79], v6 offset:448
s_waitcnt lgkmcnt(0)
s_add_u32 s37, s51, 147456
s_add_u32 m0, s50, 27648
s_nop 0
buffer_load_dwordx4 v2, s[20:23], s37 offen lds
s_add_u32 m0, s50, 28672
s_nop 0
buffer_load_dwordx4 v3, s[20:23], s37 offen lds
s_add_u32 m0, s50, 29696
s_nop 0
buffer_load_dwordx4 v4, s[20:23], s37 offen lds
s_waitcnt vmcnt(24)
ds_read_b64_tr_b16 v[80:81], v6 offset:3072
ds_read_b64_tr_b16 v[82:83], v6 offset:3456
ds_read_b64_tr_b16 v[84:85], v6 offset:3104
ds_read_b64_tr_b16 v[86:87], v6 offset:3488
ds_read_b64_tr_b16 v[88:89], v6 offset:3136
ds_read_b64_tr_b16 v[90:91], v6 offset:3520
s_waitcnt lgkmcnt(0)
s_add_u32 s37, s51, 184320
s_add_u32 m0, s50, 0
s_nop 0
buffer_load_dwordx4 v2, s[20:23], s37 offen lds
s_add_u32 m0, s50, 1024
s_nop 0
buffer_load_dwordx4 v3, s[20:23], s37 offen lds
s_add_u32 m0, s50, 2048
s_nop 0
buffer_load_dwordx4 v4, s[20:23], s37 offen lds
s_waitcnt vmcnt(24)
ds_read_b64_tr_b16 v[92:93], v6 offset:6144
ds_read_b64_tr_b16 v[94:95], v6 offset:6528
ds_read_b64_tr_b16 v[96:97], v6 offset:6176
ds_read_b64_tr_b16 v[98:99], v6 offset:6560
ds_read_b64_tr_b16 v[100:101], v6 offset:6208
ds_read_b64_tr_b16 v[102:103], v6 offset:6592
s_waitcnt lgkmcnt(0)
s_add_u32 s37, s51, 221184
s_add_u32 m0, s50, 3072
s_nop 0
buffer_load_dwordx4 v2, s[20:23], s37 offen lds
s_add_u32 m0, s50, 4096
s_nop 0
buffer_load_dwordx4 v3, s[20:23], s37 offen lds
s_add_u32 m0, s50, 5120
s_nop 0
buffer_load_dwordx4 v4, s[20:23], s37 offen lds
s_waitcnt vmcnt(24)
ds_read_b64_tr_b16 v[104:105], v6 offset:9216
ds_read_b64_tr_b16 v[106:107], v6 offset:9600
ds_read_b64_tr_b16 v[108:109], v6 offset:9248
ds_read_b64_tr_b16 v[110:111], v6 offset:9632
ds_read_b64_tr_b16 v[112:113], v6 offset:9280
ds_read_b64_tr_b16 v[114:115], v6 offset:9664
s_waitcnt lgkmcnt(0)
s_add_u32 s37, s51, 258048
s_add_u32 m0, s50, 6144
s_nop 0
buffer_load_dwordx4 v2, s[20:23], s37 offen lds
s_add_u32 m0, s50, 7168
s_nop 0
buffer_load_dwordx4 v3, s[20:23], s37 offen lds
s_add_u32 m0, s50, 8192
s_nop 0
buffer_load_dwordx4 v4, s[20:23], s37 offen lds
s_waitcnt vmcnt(24)
ds_read_b64_tr_b16 v[116:117], v6 offset:12288
ds_read_b64_tr_b16 v[118:119], v6 offset:12672
ds_read_b64_tr_b16 v[120:121], v6 offset:12320
ds_read_b64_tr_b16 v[122:123], v6 offset:12704
ds_read_b64_tr_b16 v[124:125], v6 offset:12352
ds_read_b64_tr_b16 v[126:127], v6 offset:12736
s_waitcnt lgkmcnt(0)
s_add_u32 s37, s51, 294912
s_add_u32 m0, s50, 9216
s_nop 0
buffer_load_dwordx4 v2, s[20:23], s37 offen lds
s_add_u32 m0, s50, 10240
s_nop 0
buffer_load_dwordx4 v3, s[20:23], s37 offen lds
s_add_u32 m0, s50, 11264
s_nop 0
buffer_load_dwordx4 v4, s[20:23], s37 offen lds
s_waitcnt vmcnt(24)
ds_read_b64_tr_b16 v[128:129], v5 offset:15360
ds_read_b64_tr_b16 v[130:131], v5 offset:16896
ds_read_b64_tr_b16 v[132:133], v5 offset:15392
ds_read_b64_tr_b16 v[134:135], v5 offset:16928
ds_read_b64_tr_b16 v[136:137], v5 offset:15424
ds_read_b64_tr_b16 v[138:139], v5 offset:16960
s_waitcnt lgkmcnt(0)
s_add_u32 s37, s51, 331776
s_add_u32 m0, s50, 12288
s_nop 0
buffer_load_dwordx4 v2, s[20:23], s37 offen lds
s_add_u32 m0, s50, 13312
s_nop 0
buffer_load_dwordx4 v3, s[20:23], s37 offen lds
s_add_u32 m0, s50, 14336
s_nop 0
buffer_load_dwordx4 v4, s[20:23], s37 offen lds
s_waitcnt vmcnt(24)
ds_read_b64_tr_b16 v[140:141], v5 offset:18432
ds_read_b64_tr_b16 v[142:143], v5 offset:19968
ds_read_b64_tr_b16 v[144:145], v5 offset:18464
ds_read_b64_tr_b16 v[146:147], v5 offset:20000
ds_read_b64_tr_b16 v[148:149], v5 offset:18496
ds_read_b64_tr_b16 v[150:151], v5 offset:20032
s_waitcnt lgkmcnt(0)
s_add_u32 s37, s51, 368640
s_add_u32 m0, s50, 15360
s_nop 0
buffer_load_dwordx4 v2, s[20:23], s37 offen lds
s_add_u32 m0, s50, 16384
s_nop 0
buffer_load_dwordx4 v3, s[20:23], s37 offen lds
s_add_u32 m0, s50, 17408
s_nop 0
buffer_load_dwordx4 v4, s[20:23], s37 offen lds
s_waitcnt vmcnt(24)
ds_read_b64_tr_b16 v[152:153], v5 offset:21504
ds_read_b64_tr_b16 v[154:155], v5 offset:23040
ds_read_b64_tr_b16 v[156:157], v5 offset:21536
ds_read_b64_tr_b16 v[158:159], v5 offset:23072
ds_read_b64_tr_b16 v[160:161], v5 offset:21568
ds_read_b64_tr_b16 v[162:163], v5 offset:23104
s_waitcnt lgkmcnt(0)
s_add_u32 s37, s51, 405504
s_add_u32 m0, s50, 18432
s_nop 0
buffer_load_dwordx4 v2, s[20:23], s37 offen lds
s_add_u32 m0, s50, 19456
s_nop 0
buffer_load_dwordx4 v3, s[20:23], s37 offen lds
s_add_u32 m0, s50, 20480
s_nop 0
buffer_load_dwordx4 v4, s[20:23], s37 offen lds
s_waitcnt vmcnt(24)
ds_read_b64_tr_b16 v[164:165], v5 offset:24576
ds_read_b64_tr_b16 v[166:167], v5 offset:26112
ds_read_b64_tr_b16 v[168:169], v5 offset:24608
ds_read_b64_tr_b16 v[170:171], v5 offset:26144
ds_read_b64_tr_b16 v[172:173], v5 offset:24640
ds_read_b64_tr_b16 v[174:175], v5 offset:26176
s_waitcnt lgkmcnt(0)
s_add_u32 s37, s51, 442368
s_add_u32 m0, s50, 21504
s_nop 0
buffer_load_dwordx4 v2, s[20:23], s37 offen lds
s_add_u32 m0, s50, 22528
s_nop 0
buffer_load_dwordx4 v3, s[20:23], s37 offen lds
s_add_u32 m0, s50, 23552
s_nop 0
buffer_load_dwordx4 v4, s[20:23], s37 offen lds
s_waitcnt vmcnt(24)
ds_read_b64_tr_b16 v[176:177], v5 offset:27648
ds_read_b64_tr_b16 v[178:179], v5 offset:29184
ds_read_b64_tr_b16 v[180:181], v5 offset:27680
ds_read_b64_tr_b16 v[182:183], v5 offset:29216
ds_read_b64_tr_b16 v[184:185], v5 offset:27712
ds_read_b64_tr_b16 v[186:187], v5 offset:29248
s_waitcnt lgkmcnt(0)
s_add_u32 s37, s51, 479232
s_add_u32 m0, s50, 24576
s_nop 0
buffer_load_dwordx4 v2, s[20:23], s37 offen lds
s_add_u32 m0, s50, 25600
s_nop 0
buffer_load_dwordx4 v3, s[20:23], s37 offen lds
s_add_u32 m0, s50, 26624
s_nop 0
buffer_load_dwordx4 v4, s[20:23], s37 offen lds
s_waitcnt vmcnt(24)
ds_read_b64_tr_b16 v[188:189], v5 offset:0
ds_read_b64_tr_b16 v[190:191], v5 offset:1536
ds_read_b64_tr_b16 v[192:193], v5 offset:32
ds_read_b64_tr_b16 v[194:195], v5 offset:1568
ds_read_b64_tr_b16 v[196:197], v5 offset:64
ds_read_b64_tr_b16 v[198:199], v5 offset:1600
s_waitcnt lgkmcnt(0)
s_add_u32 s37, s51, 516096
s_add_u32 m0, s50, 27648
s_nop 0
buffer_load_dwordx4 v2, s[20:23], s37 offen lds
s_add_u32 m0, s50, 28672
s_nop 0
buffer_load_dwordx4 v3, s[20:23], s37 offen lds
s_add_u32 m0, s50, 29696
s_nop 0
buffer_load_dwordx4 v4, s[20:23], s37 offen lds
s_waitcnt vmcnt(24)
ds_read_b64_tr_b16 v[200:201], v5 offset:3072
ds_read_b64_tr_b16 v[202:203], v5 offset:4608
ds_read_b64_tr_b16 v[204:205], v5 offset:3104
ds_read_b64_tr_b16 v[206:207], v5 offset:4640
ds_read_b64_tr_b16 v[208:209], v5 offset:3136
ds_read_b64_tr_b16 v[210:211], v5 offset:4672
s_waitcnt lgkmcnt(0)
s_add_u32 s37, s51, 552960
s_add_u32 m0, s50, 0
s_nop 0
buffer_load_dwordx4 v2, s[20:23], s37 offen lds
s_add_u32 m0, s50, 1024
s_nop 0
buffer_load_dwordx4 v3, s[20:23], s37 offen lds
s_add_u32 m0, s50, 2048
s_nop 0
buffer_load_dwordx4 v4, s[20:23], s37 offen lds
s_waitcnt vmcnt(24)
ds_read_b64_tr_b16 v[212:213], v5 offset:6144
ds_read_b64_tr_b16 v[214:215], v5 offset:7680
ds_read_b64_tr_b16 v[216:217], v5 offset:6176
ds_read_b64_tr_b16 v[218:219], v5 offset:7712
ds_read_b64_tr_b16 v[220:221], v5 offset:6208
ds_read_b64_tr_b16 v[222:223], v5 offset:7744
s_waitcnt lgkmcnt(0)
s_add_u32 s37, s51, 589824
s_add_u32 m0, s50, 3072
s_nop 0
buffer_load_dwordx4 v2, s[20:23], s37 offen lds
s_add_u32 m0, s50, 4096
s_nop 0
buffer_load_dwordx4 v3, s[20:23], s37 offen lds
s_add_u32 m0, s50, 5120
s_nop 0
buffer_load_dwordx4 v4, s[20:23], s37 offen lds
s_waitcnt vmcnt(24)
ds_read_b64_tr_b16 v[224:225], v5 offset:9216
ds_read_b64_tr_b16 v[226:227], v5 offset:10752
ds_read_b64_tr_b16 v[228:229], v5 offset:9248
ds_read_b64_tr_b16 v[230:231], v5 offset:10784
ds_read_b64_tr_b16 v[232:233], v5 offset:9280
ds_read_b64_tr_b16 v[234:235], v5 offset:10816
s_waitcnt lgkmcnt(0)
s_add_u32 s37, s51, 626688
s_add_u32 m0, s50, 6144
s_nop 0
buffer_load_dwordx4 v2, s[20:23], s37 offen lds
s_add_u32 m0, s50, 7168
s_nop 0
buffer_load_dwordx4 v3, s[20:23], s37 offen lds
s_add_u32 m0, s50, 8192
s_nop 0
buffer_load_dwordx4 v4, s[20:23], s37 offen lds
s_waitcnt vmcnt(24)
ds_read_b64_tr_b16 v[236:237], v5 offset:12288
ds_read_b64_tr_b16 v[238:239], v5 offset:13824
ds_read_b64_tr_b16 v[240:241], v5 offset:12320
ds_read_b64_tr_b16 v[242:243], v5 offset:13856
ds_read_b64_tr_b16 v[244:245], v5 offset:12352
ds_read_b64_tr_b16 v[246:247], v5 offset:13888
s_waitcnt lgkmcnt(0)
s_add_u32 s37, s51, 663552
s_add_u32 m0, s50, 9216
s_nop 0
buffer_load_dwordx4 v2, s[20:23], s37 offen lds
s_add_u32 m0, s50, 10240
s_nop 0
buffer_load_dwordx4 v3, s[20:23], s37 offen lds
s_add_u32 m0, s50, 11264
s_nop 0
buffer_load_dwordx4 v4, s[20:23], s37 offen lds
s_waitcnt vmcnt(24)
ds_read_b64_tr_b16 v[248:249], v5 offset:15360
ds_read_b64_tr_b16 v[250:251], v5 offset:16896
ds_read_b64_tr_b16 v[252:253], v5 offset:15392
ds_read_b64_tr_b16 v[254:255], v5 offset:16928
ds_read_b64_tr_b16 a[0:1], v5 offset:15424
ds_read_b64_tr_b16 a[2:3], v5 offset:16960
s_waitcnt lgkmcnt(0)
s_add_u32 s37, s51, 700416
s_add_u32 m0, s50, 12288
s_nop 0
buffer_load_dwordx4 v2, s[20:23], s37 offen lds
s_add_u32 m0, s50, 13312
s_nop 0
buffer_load_dwordx4 v3, s[20:23], s37 offen lds
s_add_u32 m0, s50, 14336
s_nop 0
buffer_load_dwordx4 v4, s[20:23], s37 offen lds
s_waitcnt vmcnt(24)
ds_read_b64_tr_b16 a[4:5], v5 offset:18432
ds_read_b64_tr_b16 a[6:7], v5 offset:19968
ds_read_b64_tr_b16 a[8:9], v5 offset:18464
ds_read_b64_tr_b16 a[10:11], v5 offset:20000
ds_read_b64_tr_b16 a[12:13], v5 offset:18496
ds_read_b64_tr_b16 a[14:15], v5 offset:20032
s_waitcnt lgkmcnt(0)
s_add_u32 s37, s51, 737280
s_add_u32 m0, s50, 15360
s_nop 0
buffer_load_dwordx4 v2, s[20:23], s37 offen lds
s_add_u32 m0, s50, 16384
s_nop 0
buffer_load_dwordx4 v3, s[20:23], s37 offen lds
s_add_u32 m0, s50, 17408
s_nop 0
buffer_load_dwordx4 v4, s[20:23], s37 offen lds
s_waitcnt vmcnt(24)
ds_read_b64_tr_b16 a[16:17], v5 offset:21504
ds_read_b64_tr_b16 a[18:19], v5 offset:23040
ds_read_b64_tr_b16 a[20:21], v5 offset:21536
ds_read_b64_tr_b16 a[22:23], v5 offset:23072
ds_read_b64_tr_b16 a[24:25], v5 offset:21568
ds_read_b64_tr_b16 a[26:27], v5 offset:23104
s_waitcnt lgkmcnt(0)
s_add_u32 s37, s51, 774144
s_add_u32 m0, s50, 18432
s_nop 0
buffer_load_dwordx4 v2, s[20:23], s37 offen lds
s_add_u32 m0, s50, 19456
s_nop 0
buffer_load_dwordx4 v3, s[20:23], s37 offen lds
s_add_u32 m0, s50, 20480
s_nop 0
buffer_load_dwordx4 v4, s[20:23], s37 offen lds
s_waitcnt vmcnt(24)
ds_read_b64_tr_b16 a[28:29], v5 offset:24576
ds_read_b64_tr_b16 a[30:31], v5 offset:26112
ds_read_b64_tr_b16 a[32:33], v5 offset:24608
ds_read_b64_tr_b16 a[34:35], v5 offset:26144
ds_read_b64_tr_b16 a[36:37], v5 offset:24640
ds_read_b64_tr_b16 a[38:39], v5 offset:26176
s_waitcnt lgkmcnt(0)
s_add_u32 s37, s51, 811008
s_add_u32 m0, s50, 21504
s_nop 0
buffer_load_dwordx4 v2, s[20:23], s37 offen lds
s_add_u32 m0, s50, 22528
s_nop 0
buffer_load_dwordx4 v3, s[20:23], s37 offen lds
s_add_u32 m0, s50, 23552
s_nop 0
buffer_load_dwordx4 v4, s[20:23], s37 offen lds
s_waitcnt vmcnt(24)
ds_read_b64_tr_b16 a[40:41], v5 offset:27648
ds_read_b64_tr_b16 a[42:43], v5 offset:29184
ds_read_b64_tr_b16 a[44:45], v5 offset:27680
ds_read_b64_tr_b16 a[46:47], v5 offset:29216
ds_read_b64_tr_b16 a[48:49], v5 offset:27712
ds_read_b64_tr_b16 a[50:51], v5 offset:29248
s_waitcnt lgkmcnt(0)
s_add_u32 s37, s51, 847872
s_add_u32 m0, s50, 24576
s_nop 0
buffer_load_dwordx4 v2, s[20:23], s37 offen lds
s_add_u32 m0, s50, 25600
s_nop 0
buffer_load_dwordx4 v3, s[20:23], s37 offen lds
s_add_u32 m0, s50, 26624
s_nop 0
buffer_load_dwordx4 v4, s[20:23], s37 offen lds
s_waitcnt vmcnt(24)
ds_read_b64_tr_b16 a[52:53], v5 offset:0
ds_read_b64_tr_b16 a[54:55], v5 offset:1536
ds_read_b64_tr_b16 a[56:57], v5 offset:32
ds_read_b64_tr_b16 a[58:59], v5 offset:1568
ds_read_b64_tr_b16 a[60:61], v5 offset:64
ds_read_b64_tr_b16 a[62:63], v5 offset:1600
s_waitcnt lgkmcnt(0)
s_add_u32 s37, s51, 884736
s_add_u32 m0, s50, 27648
s_nop 0
buffer_load_dwordx4 v2, s[20:23], s37 offen lds
s_add_u32 m0, s50, 28672
s_nop 0
buffer_load_dwordx4 v3, s[20:23], s37 offen lds
s_add_u32 m0, s50, 29696
s_nop 0
buffer_load_dwordx4 v4, s[20:23], s37 offen lds
s_waitcnt vmcnt(24)
ds_read_b64_tr_b16 a[64:65], v5 offset:3072
ds_read_b64_tr_b16 a[66:67], v5 offset:4608
ds_read_b64_tr_b16 a[68:69], v5 offset:3104
ds_read_b64_tr_b16 a[70:71], v5 offset:4640
ds_read_b64_tr_b16 a[72:73], v5 offset:3136
ds_read_b64_tr_b16 a[74:75], v5 offset:4672
s_waitcnt lgkmcnt(0)
s_add_u32 s37, s51, 921600
s_add_u32 m0, s50, 0
s_nop 0
buffer_load_dwordx4 v2, s[20:23], s37 offen lds
s_add_u32 m0, s50, 1024
s_nop 0
buffer_load_dwordx4 v3, s[20:23], s37 offen lds
s_add_u32 m0, s50, 2048
s_nop 0
buffer_load_dwordx4 v4, s[20:23], s37 offen lds
s_waitcnt vmcnt(24)
ds_read_b64_tr_b16 a[76:77], v5 offset:6144
ds_read_b64_tr_b16 a[78:79], v5 offset:7680
ds_read_b64_tr_b16 a[80:81], v5 offset:6176
ds_read_b64_tr_b16 a[82:83], v5 offset:7712
ds_read_b64_tr_b16 a[84:85], v5 offset:6208
ds_read_b64_tr_b16 a[86:87], v5 offset:7744
s_waitcnt lgkmcnt(0)
s_add_u32 s37, s51, 958464
s_add_u32 m0, s50, 3072
s_nop 0
buffer_load_dwordx4 v2, s[20:23], s37 offen lds
s_add_u32 m0, s50, 4096
s_nop 0
buffer_load_dwordx4 v3, s[20:23], s37 offen lds
s_add_u32 m0, s50, 5120
s_nop 0
buffer_load_dwordx4 v4, s[20:23], s37 offen lds
s_waitcnt vmcnt(24)
ds_read_b64_tr_b16 a[88:89], v5 offset:9216
ds_read_b64_tr_b16 a[90:91], v5 offset:10752
ds_read_b64_tr_b16 a[92:93], v5 offset:9248
ds_read_b64_tr_b16 a[94:95], v5 offset:10784
ds_read_b64_tr_b16 a[96:97], v5 offset:9280
ds_read_b64_tr_b16 a[98:99], v5 offset:10816
s_waitcnt lgkmcnt(0)
s_add_u32 s37, s51, 995328
s_add_u32 m0, s50, 6144
s_nop 0
buffer_load_dwordx4 v2, s[20:23], s37 offen lds
s_add_u32 m0, s50, 7168
s_nop 0
buffer_load_dwordx4 v3, s[20:23], s37 offen lds
s_add_u32 m0, s50, 8192
s_nop 0
buffer_load_dwordx4 v4, s[20:23], s37 offen lds
s_waitcnt vmcnt(24)
ds_read_b64_tr_b16 a[100:101], v5 offset:12288
ds_read_b64_tr_b16 a[102:103], v5 offset:13824
ds_read_b64_tr_b16 a[104:105], v5 offset:12320
ds_read_b64_tr_b16 a[106:107], v5 offset:13856
ds_read_b64_tr_b16 a[108:109], v5 offset:12352
ds_read_b64_tr_b16 a[110:111], v5 offset:13888
s_waitcnt lgkmcnt(0)
s_add_u32 s37, s51, 1032192
s_add_u32 m0, s50, 9216
s_nop 0
buffer_load_dwordx4 v2, s[20:23], s37 offen lds
s_add_u32 m0, s50, 10240
s_nop 0
buffer_load_dwordx4 v3, s[20:23], s37 offen lds
s_add_u32 m0, s50, 11264
s_nop 0
buffer_load_dwordx4 v4, s[20:23], s37 offen lds
s_waitcnt vmcnt(24)
ds_read_b64_tr_b16 a[112:113], v5 offset:15360
ds_read_b64_tr_b16 a[114:115], v5 offset:16896
ds_read_b64_tr_b16 a[116:117], v5 offset:15392
ds_read_b64_tr_b16 a[118:119], v5 offset:16928
ds_read_b64_tr_b16 a[120:121], v5 offset:15424
ds_read_b64_tr_b16 a[122:123], v5 offset:16960
s_waitcnt lgkmcnt(0)
s_add_u32 s37, s51, 1069056
s_add_u32 m0, s50, 12288
s_nop 0
buffer_load_dwordx4 v2, s[20:23], s37 offen lds
s_add_u32 m0, s50, 13312
s_nop 0
buffer_load_dwordx4 v3, s[20:23], s37 offen lds
s_add_u32 m0, s50, 14336
s_nop 0
buffer_load_dwordx4 v4, s[20:23], s37 offen lds
s_waitcnt vmcnt(24)
ds_read_b64_tr_b16 a[124:125], v5 offset:18432
ds_read_b64_tr_b16 a[126:127], v5 offset:19968
ds_read_b64_tr_b16 a[128:129], v5 offset:18464
ds_read_b64_tr_b16 a[130:131], v5 offset:20000
ds_read_b64_tr_b16 a[132:133], v5 offset:18496
ds_read_b64_tr_b16 a[134:135], v5 offset:20032
s_waitcnt lgkmcnt(0)
s_add_u32 s37, s51, 1105920
s_add_u32 m0, s50, 15360
s_nop 0
buffer_load_dwordx4 v2, s[20:23], s37 offen lds
s_add_u32 m0, s50, 16384
s_nop 0
buffer_load_dwordx4 v3, s[20:23], s37 offen lds
s_add_u32 m0, s50, 17408
s_nop 0
buffer_load_dwordx4 v4, s[20:23], s37 offen lds
s_waitcnt vmcnt(24)
ds_read_b64_tr_b16 a[136:137], v5 offset:21504
ds_read_b64_tr_b16 a[138:139], v5 offset:23040
ds_read_b64_tr_b16 a[140:141], v5 offset:21536
ds_read_b64_tr_b16 a[142:143], v5 offset:23072
ds_read_b64_tr_b16 a[144:145], v5 offset:21568
ds_read_b64_tr_b16 a[146:147], v5 offset:23104
s_waitcnt lgkmcnt(0)
s_add_u32 s37, s51, 1142784
s_add_u32 m0, s50, 18432
s_nop 0
buffer_load_dwordx4 v2, s[20:23], s37 offen lds
s_add_u32 m0, s50, 19456
s_nop 0
buffer_load_dwordx4 v3, s[20:23], s37 offen lds
s_add_u32 m0, s50, 20480
s_nop 0
buffer_load_dwordx4 v4, s[20:23], s37 offen lds
s_waitcnt vmcnt(24)
ds_read_b64_tr_b16 a[148:149], v5 offset:24576
ds_read_b64_tr_b16 a[150:151], v5 offset:26112
ds_read_b64_tr_b16 a[152:153], v5 offset:24608
ds_read_b64_tr_b16 a[154:155], v5 offset:26144
ds_read_b64_tr_b16 a[156:157], v5 offset:24640
ds_read_b64_tr_b16 a[158:159], v5 offset:26176
s_waitcnt lgkmcnt(0)
s_waitcnt vmcnt(21)
ds_read_b64_tr_b16 a[160:161], v5 offset:27648
ds_read_b64_tr_b16 a[162:163], v5 offset:29184
ds_read_b64_tr_b16 a[164:165], v5 offset:27680
ds_read_b64_tr_b16 a[166:167], v5 offset:29216
ds_read_b64_tr_b16 a[168:169], v5 offset:27712
ds_read_b64_tr_b16 a[170:171], v5 offset:29248
s_waitcnt lgkmcnt(0)
s_waitcnt vmcnt(18)
ds_read_b64_tr_b16 a[172:173], v5 offset:0
ds_read_b64_tr_b16 a[174:175], v5 offset:1536
ds_read_b64_tr_b16 a[176:177], v5 offset:32
ds_read_b64_tr_b16 a[178:179], v5 offset:1568
ds_read_b64_tr_b16 a[180:181], v5 offset:64
ds_read_b64_tr_b16 a[182:183], v5 offset:1600
s_waitcnt lgkmcnt(0)
s_waitcnt vmcnt(15)
ds_read_b64_tr_b16 a[184:185], v5 offset:3072
ds_read_b64_tr_b16 a[186:187], v5 offset:4608
ds_read_b64_tr_b16 a[188:189], v5 offset:3104
ds_read_b64_tr_b16 a[190:191], v5 offset:4640
ds_read_b64_tr_b16 a[192:193], v5 offset:3136
ds_read_b64_tr_b16 a[194:195], v5 offset:4672
s_waitcnt lgkmcnt(0)
s_waitcnt vmcnt(12)
ds_read_b64_tr_b16 a[196:197], v5 offset:6144
ds_read_b64_tr_b16 a[198:199], v5 offset:7680
ds_read_b64_tr_b16 a[200:201], v5 offset:6176
ds_read_b64_tr_b16 a[202:203], v5 offset:7712
ds_read_b64_tr_b16 a[204:205], v5 offset:6208
ds_read_b64_tr_b16 a[206:207], v5 offset:7744
s_waitcnt lgkmcnt(0)
s_waitcnt vmcnt(9)
ds_read_b64_tr_b16 a[208:209], v5 offset:9216
ds_read_b64_tr_b16 a[210:211], v5 offset:10752
ds_read_b64_tr_b16 a[212:213], v5 offset:9248
ds_read_b64_tr_b16 a[214:215], v5 offset:10784
ds_read_b64_tr_b16 a[216:217], v5 offset:9280
ds_read_b64_tr_b16 a[218:219], v5 offset:10816
s_waitcnt lgkmcnt(0)
s_waitcnt vmcnt(6)
ds_read_b64_tr_b16 a[220:221], v5 offset:12288
ds_read_b64_tr_b16 a[222:223], v5 offset:13824
ds_read_b64_tr_b16 a[224:225], v5 offset:12320
ds_read_b64_tr_b16 a[226:227], v5 offset:13856
ds_read_b64_tr_b16 a[228:229], v5 offset:12352
ds_read_b64_tr_b16 a[230:231], v5 offset:13888
s_waitcnt lgkmcnt(0)
s_waitcnt vmcnt(3)
ds_read_b64_tr_b16 a[232:233], v5 offset:15360
ds_read_b64_tr_b16 a[234:235], v5 offset:16896
ds_read_b64_tr_b16 a[236:237], v5 offset:15392
ds_read_b64_tr_b16 a[238:239], v5 offset:16928
ds_read_b64_tr_b16 a[240:241], v5 offset:15424
ds_read_b64_tr_b16 a[242:243], v5 offset:16960
s_waitcnt lgkmcnt(0)
s_waitcnt vmcnt(0)
ds_read_b64_tr_b16 a[244:245], v5 offset:18432
ds_read_b64_tr_b16 a[246:247], v5 offset:19968
ds_read_b64_tr_b16 a[248:249], v5 offset:18464
ds_read_b64_tr_b16 a[250:251], v5 offset:20000
ds_read_b64_tr_b16 a[252:253], v5 offset:18496
ds_read_b64_tr_b16 a[254:255], v5 offset:20032
s_waitcnt lgkmcnt(0)
s_branch L_w_init_in
L_w_init:
s_sleep 4
L_w_init_in:
buffer_load_dword v12, v8, s[24:27], 0 offen offset:0 sc0 sc1
s_sub_u32 s36, s36, 1
s_cbranch_scc1 L_exit_w
s_waitcnt vmcnt(0)
v_readfirstlane_b32 s37, v12
s_nop 0
s_and_b32 s37, s37, 0xff
s_cmp_eq_u32 s37, 32
s_cbranch_scc0 L_w_init
s_branch L_w_adone_in
L_w_adone:
s_sleep 4
L_w_adone_in:
buffer_load_dword v12, v8, s[24:27], 0 offen offset:4 sc0 sc1
s_sub_u32 s36, s36, 1
s_cbranch_scc1 L_exit_w
s_waitcnt vmcnt(0)
v_readfirstlane_b32 s37, v12
s_nop 0
s_cmp_eq_u32 s37, 96
s_cbranch_scc0 L_w_adone
s_mov_b32 s35, 0
s_mul_i32 s52, s34, 5
s_mul_i32 s58, s34, 3072
v_add_u32 v2, s58, v14
s_lshl_b32 s37, s34, 10
v_add_u32 v14, s37, v14
L_w_loop:
s_add_u32 s37, s52, 0
s_min_u32 s37, s37, 17
s_lshl_b32 s37, s37, 10
s_add_u32 s37, s37, s54
buffer_load_dwordx4 v[40:43], v1, s[4:7], s37 offen sc1
s_add_u32 s37, s52, 1
s_min_u32 s37, s37, 17
s_lshl_b32 s37, s37, 10
s_add_u32 s37, s37, s54
buffer_load_dwordx4 v[44:47], v1, s[4:7], s37 offen sc1
s_add_u32 s37, s52, 2
s_min_u32 s37, s37, 17
s_lshl_b32 s37, s37, 10
s_add_u32 s37, s37, s54
buffer_load_dwordx4 v[48:51], v1, s[4:7], s37 offen sc1
s_add_u32 s37, s52, 3
s_min_u32 s37, s37, 17
s_lshl_b32 s37, s37, 10
s_add_u32 s37, s37, s54
buffer_load_dwordx4 v[52:55], v1, s[4:7], s37 offen sc1
s_add_u32 s37, s52, 4
s_min_u32 s37, s37, 17
s_lshl_b32 s37, s37, 10
s_add_u32 s37, s37, s54
buffer_load_dwordx4 v[56:59], v1, s[4:7], s37 offen sc1
buffer_load_dword v13, v10, s[4:7], s56 offen sc1
s_waitcnt vmcnt(5)
v_mfma_f32_16x16x32_bf16 v[28:31], v[68:71], v[40:43], 0
v_mfma_f32_16x16x32_bf16 v[32:35], v[72:75], v[40:43], 0
v_mfma_f32_16x16x32_bf16 v[36:39], v[76:79], v[40:43], 0
s_waitcnt vmcnt(4)
v_mfma_f32_16x16x32_bf16 v[28:31], v[80:83], v[44:47], v[28:31]
v_mfma_f32_16x16x32_bf16 v[32:35], v[84:87], v[44:47], v[32:35]
v_mfma_f32_16x16x32_bf16 v[36:39], v[88:91], v[44:47], v[36:39]
s_waitcnt vmcnt(3)
v_mfma_f32_16x16x32_bf16 v[28:31], v[92:95], v[48:51], v[28:31]
v_mfma_f32_16x16x32_bf16 v[32:35], v[96:99], v[48:51], v[32:35]
v_mfma_f32_16x16x32_bf16 v[36:39], v[100:103], v[48:51], v[36:39]
s_waitcnt vmcnt(2)
v_mfma_f32_16x16x32_bf16 v[28:31], v[104:107], v[52:55], v[28:31]
v_mfma_f32_16x16x32_bf16 v[32:35], v[108:111], v[52:55], v[32:35]
v_mfma_f32_16x16x32_bf16 v[36:39], v[112:115], v[52:55], v[36:39]
s_waitcnt vmcnt(1)
v_mfma_f32_16x16x32_bf16 v[28:31], v[116:119], v[56:59], v[28:31]
v_mfma_f32_16x16x32_bf16 v[32:35], v[120:123], v[56:59], v[32:35]
v_mfma_f32_16x16x32_bf16 v[36:39], v[124:127], v[56:59], v[36:39]
s_branch L_w_poll_in
L_w_poll:
s_sleep 2
L_w_poll_in:
buffer_load_dword v12, v9, s[4:7], s57 offen offset:0 sc0 sc1
s_sub_u32 s36, s36, 1
s_cbranch_scc1 L_exit_w
s_waitcnt vmcnt(0)
v_cmp_ge_u32 vcc, s35, v12
s_nop 1
s_cmp_eq_u64 vcc, 0
s_cbranch_scc0 L_w_poll
s_add_u32 s37, s53, 0
s_add_u32 m0, s50, 0
s_nop 0
buffer_load_dwordx4 v1, s[4:7], s37 offen offset:0 sc1 lds
buffer_load_dwordx4 v1, s[4:7], s37 offen offset:1024 sc1 lds
buffer_load_dwordx4 v1, s[4:7], s37 offen offset:2048 sc1 lds
buffer_load_dwordx4 v1, s[4:7], s37 offen offset:3072 sc1 lds
s_add_u32 s37, s53, 4096
s_add_u32 m0, s50, 4096
s_nop 0
buffer_load_dwordx4 v1, s[4:7], s37 offen offset:0 sc1 lds
buffer_load_dwordx4 v1, s[4:7], s37 offen offset:1024 sc1 lds
buffer_load_dwordx4 v1, s[4:7], s37 offen offset:2048 sc1 lds
buffer_load_dwordx4 v1, s[4:7], s37 offen offset:3072 sc1 lds
s_add_u32 s37, s53, 8192
s_add_u32 m0, s50, 8192
s_nop 0
buffer_load_dwordx4 v1, s[4:7], s37 offen offset:0 sc1 lds
buffer_load_dwordx4 v1, s[4:7], s37 offen offset:1024 sc1 lds
buffer_load_dwordx4 v1, s[4:7], s37 offen offset:2048 sc1 lds
buffer_load_dwordx4 v1, s[4:7], s37 offen offset:3072 sc1 lds
s_add_u32 s37, s53, 12288
s_add_u32 m0, s50, 12288
s_nop 0
buffer_load_dwordx4 v1, s[4:7], s37 offen offset:0 sc1 lds
buffer_load_dwordx4 v1, s[4:7], s37 offen offset:1024 sc1 lds
buffer_load_dwordx4 v1, s[4:7], s37 offen offset:2048 sc1 lds
buffer_load_dwordx4 v1, s[4:7], s37 offen offset:3072 sc1 lds
s_add_u32 s37, s53, 16384
s_add_u32 m0, s50, 16384
s_nop 0
buffer_load_dwordx4 v1, s[4:7], s37 offen offset:0 sc1 lds
buffer_load_dwordx4 v1, s[4:7], s37 offen offset:1024 sc1 lds
buffer_load_dwordx4 v1, s[4:7], s37 offen offset:2048 sc1 lds
buffer_load_dwordx4 v1, s[4:7], s37 offen offset:3072 sc1 lds
s_add_u32 s37, s53, 20480
s_add_u32 m0, s50, 20480
s_nop 0
buffer_load_dwordx4 v1, s[4:7], s37 offen offset:0 sc1 lds
buffer_load_dwordx4 v1, s[4:7], s37 offen offset:1024 sc1 lds
buffer_load_dwordx4 v1, s[4:7], s37 offen offset:2048 sc1 lds
buffer_load_dwordx4 v1, s[4:7], s37 offen offset:3072 sc1 lds
s_add_u32 s37, s53, 24576
s_add_u32 m0, s50, 24576
s_nop 0
buffer_load_dwordx4 v1, s[4:7], s37 offen offset:0 sc1 lds
buffer_load_dwordx4 v1, s[4:7], s37 offen offset:1024 sc1 lds
buffer_load_dwordx4 v1, s[4:7], s37 offen offset:2048 sc1 lds
buffer_load_dwordx4 v1, s[4:7], s37 offen offset:3072 sc1 lds
s_add_u32 s37, s53, 28672
s_add_u32 m0, s50, 28672
s_nop 0
buffer_load_dwordx4 v1, s[4:7], s37 offen offset:0 sc1 lds
buffer_load_dwordx4 v1, s[4:7], s37 offen offset:1024 sc1 lds
buffer_load_dwordx4 v1, s[4:7], s37 offen offset:2048 sc1 lds
buffer_load_dwordx4 v1, s[4:7], s37 offen offset:3072 sc1 lds
s_waitcnt vmcnt(31)
ds_read_b128 v[40:43], v7 offset:0
s_waitcnt vmcnt(30)
ds_read_b128 v[44:47], v7 offset:1024
s_waitcnt vmcnt(29)
ds_read_b128 v[48:51], v7 offset:2048
s_waitcnt lgkmcnt(2)
v_mfma_f32_16x16x32_bf16 v[16:19], v[128:131], v[40:43], 0
v_mfma_f32_16x16x32_bf16 v[20:23], v[132:135], v[40:43], 0
v_mfma_f32_16x16x32_bf16 v[24:27], v[136:139], v[40:43], 0
s_waitcnt vmcnt(28)
ds_read_b128 v[52:55], v7 offset:3072
s_waitcnt lgkmcnt(2)
v_mfma_f32_16x16x32_bf16 v[16:19], v[140:143], v[44:47], v[16:19]
v_mfma_f32_16x16x32_bf16 v[20:23], v[144:147], v[44:47], v[20:23]
v_mfma_f32_16x16x32_bf16 v[24:27], v[148:151], v[44:47], v[24:27]
s_waitcnt vmcnt(27)
ds_read_b128 v[40:43], v7 offset:4096
s_waitcnt lgkmcnt(2)
v_mfma_f32_16x16x32_bf16 v[16:19], v[152:155], v[48:51], v[16:19]
v_mfma_f32_16x16x32_bf16 v[20:23], v[156:159], v[48:51], v[20:23]
v_mfma_f32_16x16x32_bf16 v[24:27], v[160:163], v[48:51], v[24:27]
s_waitcnt vmcnt(26)
ds_read_b128 v[44:47], v7 offset:5120
s_waitcnt lgkmcnt(2)
v_mfma_f32_16x16x32_bf16 v[16:19], v[164:167], v[52:55], v[16:19]
v_mfma_f32_16x16x32_bf16 v[20:23], v[168:171], v[52:55], v[20:23]
v_mfma_f32_16x16x32_bf16 v[24:27], v[172:175], v[52:55], v[24:27]
s_waitcnt vmcnt(25)
ds_read_b128 v[48:51], v7 offset:6144
s_waitcnt lgkmcnt(2)
v_mfma_f32_16x16x32_bf16 v[16:19], v[176:179], v[40:43], v[16:19]
v_mfma_f32_16x16x32_bf16 v[20:23], v[180:183], v[40:43], v[20:23]
v_mfma_f32_16x16x32_bf16 v[24:27], v[184:187], v[40:43], v[24:27]
s_waitcnt vmcnt(24)
ds_read_b128 v[52:55], v7 offset:7168
s_waitcnt lgkmcnt(2)
v_mfma_f32_16x16x32_bf16 v[16:19], v[188:191], v[44:47], v[16:19]
v_mfma_f32_16x16x32_bf16 v[20:23], v[192:195], v[44:47], v[20:23]
v_mfma_f32_16x16x32_bf16 v[24:27], v[196:199], v[44:47], v[24:27]
s_waitcnt vmcnt(23)
ds_read_b128 v[40:43], v7 offset:8192
s_waitcnt lgkmcnt(2)
v_mfma_f32_16x16x32_bf16 v[16:19], v[200:203], v[48:51], v[16:19]
v_mfma_f32_16x16x32_bf16 v[20:23], v[204:207], v[48:51], v[20:23]
v_mfma_f32_16x16x32_bf16 v[24:27], v[208:211], v[48:51], v[24:27]
s_waitcnt vmcnt(22)
ds_read_b128 v[44:47], v7 offset:9216
s_waitcnt lgkmcnt(2)
v_mfma_f32_16x16x32_bf16 v[16:19], v[212:215], v[52:55], v[16:19]
v_mfma_f32_16x16x32_bf16 v[20:23], v[216:219], v[52:55], v[20:23]
v_mfma_f32_16x16x32_bf16 v[24:27], v[220:223], v[52:55], v[24:27]
s_waitcnt vmcnt(21)
ds_read_b128 v[48:51], v7 offset:10240
s_waitcnt lgkmcnt(2)
v_mfma_f32_16x16x32_bf16 v[16:19], v[224:227], v[40:43], v[16:19]
v_mfma_f32_16x16x32_bf16 v[20:23], v[228:231], v[40:43], v[20:23]
v_mfma_f32_16x16x32_bf16 v[24:27], v[232:235], v[40:43], v[24:27]
s_waitcnt vmcnt(20)
ds_read_b128 v[52:55], v7 offset:11264
s_waitcnt lgkmcnt(2)
v_mfma_f32_16x16x32_bf16 v[16:19], v[236:239], v[44:47], v[16:19]
v_mfma_f32_16x16x32_bf16 v[20:23], v[240:243], v[44:47], v[20:23]
v_mfma_f32_16x16x32_bf16 v[24:27], v[244:247], v[44:47], v[24:27]
s_waitcnt vmcnt(19)
ds_read_b128 v[40:43], v7 offset:12288
s_waitcnt lgkmcnt(2)
v_mfma_f32_16x16x32_bf16 v[16:19], v[248:251], v[48:51], v[16:19]
v_mfma_f32_16x16x32_bf16 v[20:23], v[252:255], v[48:51], v[20:23]
v_mfma_f32_16x16x32_bf16 v[24:27], a[0:3], v[48:51], v[24:27]
s_waitcnt vmcnt(18)
ds_read_b128 v[44:47], v7 offset:13312
s_waitcnt lgkmcnt(2)
v_mfma_f32_16x16x32_bf16 v[16:19], a[4:7], v[52:55], v[16:19]
v_mfma_f32_16x16x32_bf16 v[20:23], a[8:11], v[52:55], v[20:23]
v_mfma_f32_16x16x32_bf16 v[24:27], a[12:15], v[52:55], v[24:27]
s_waitcnt vmcnt(17)
ds_read_b128 v[48:51], v7 offset:14336
s_waitcnt lgkmcnt(2)
v_mfma_f32_16x16x32_bf16 v[16:19], a[16:19], v[40:43], v[16:19]
v_mfma_f32_16x16x32_bf16 v[20:23], a[20:23], v[40:43], v[20:23]
v_mfma_f32_16x16x32_bf16 v[24:27], a[24:27], v[40:43], v[24:27]
s_waitcnt vmcnt(16)
ds_read_b128 v[52:55], v7 offset:15360
s_waitcnt lgkmcnt(2)
v_mfma_f32_16x16x32_bf16 v[16:19], a[28:31], v[44:47], v[16:19]
v_mfma_f32_16x16x32_bf16 v[20:23], a[32:35], v[44:47], v[20:23]
v_mfma_f32_16x16x32_bf16 v[24:27], a[36:39], v[44:47], v[24:27]
s_waitcnt vmcnt(15)
ds_read_b128 v[40:43], v7 offset:16384
s_waitcnt lgkmcnt(2)
v_mfma_f32_16x16x32_bf16 v[16:19], a[40:43], v[48:51], v[16:19]
v_mfma_f32_16x16x32_bf16 v[20:23], a[44:47], v[48:51], v[20:23]
v_mfma_f32_16x16x32_bf16 v[24:27], a[48:51], v[48:51], v[24:27]
s_waitcnt vmcnt(14)
ds_read_b128 v[44:47], v7 offset:17408
s_waitcnt lgkmcnt(2)
v_mfma_f32_16x16x32_bf16 v[16:19], a[52:55], v[52:55], v[16:19]
v_mfma_f32_16x16x32_bf16 v[20:23], a[56:59], v[52:55], v[20:23]
v_mfma_f32_16x16x32_bf16 v[24:27], a[60:63], v[52:55], v[24:27]
s_waitcnt vmcnt(13)
ds_read_b128 v[48:51], v7 offset:18432
s_waitcnt lgkmcnt(2)
v_mfma_f32_16x16x32_bf16 v[16:19], a[64:67], v[40:43], v[16:19]
v_mfma_f32_16x16x32_bf16 v[20:23], a[68:71], v[40:43], v[20:23]
v_mfma_f32_16x16x32_bf16 v[24:27], a[72:75], v[40:43], v[24:27]
s_waitcnt vmcnt(12)
ds_read_b128 v[52:55], v7 offset:19456
s_waitcnt lgkmcnt(2)
v_mfma_f32_16x16x32_bf16 v[16:19], a[76:79], v[44:47], v[16:19]
v_mfma_f32_16x16x32_bf16 v[20:23], a[80:83], v[44:47], v[20:23]
v_mfma_f32_16x16x32_bf16 v[24:27], a[84:87], v[44:47], v[24:27]
s_waitcnt vmcnt(11)
ds_read_b128 v[40:43], v7 offset:20480
s_waitcnt lgkmcnt(2)
v_mfma_f32_16x16x32_bf16 v[16:19], a[88:91], v[48:51], v[16:19]
v_mfma_f32_16x16x32_bf16 v[20:23], a[92:95], v[48:51], v[20:23]
v_mfma_f32_16x16x32_bf16 v[24:27], a[96:99], v[48:51], v[24:27]
s_waitcnt vmcnt(10)
ds_read_b128 v[44:47], v7 offset:21504
s_waitcnt lgkmcnt(2)
v_mfma_f32_16x16x32_bf16 v[16:19], a[100:103], v[52:55], v[16:19]
v_mfma_f32_16x16x32_bf16 v[20:23], a[104:107], v[52:55], v[20:23]
v_mfma_f32_16x16x32_bf16 v[24:27], a[108:111], v[52:55], v[24:27]
s_waitcnt vmcnt(9)
ds_read_b128 v[48:51], v7 offset:22528
s_waitcnt lgkmcnt(2)
v_mfma_f32_16x16x32_bf16 v[16:19], a[112:115], v[40:43], v[16:19]
v_mfma_f32_16x16x32_bf16 v[20:23], a[116:119], v[40:43], v[20:23]
v_mfma_f32_16x16x32_bf16 v[24:27], a[120:123], v[40:43], v[24:27]
s_waitcnt vmcnt(8)
ds_read_b128 v[52:55], v7 offset:23552
s_waitcnt lgkmcnt(2)
v_mfma_f32_16x16x32_bf16 v[16:19], a[124:127], v[44:47], v[16:19]
v_mfma_f32_16x16x32_bf16 v[20:23], a[128:131], v[44:47], v[20:23]
v_mfma_f32_16x16x32_bf16 v[24:27], a[132:135], v[44:47], v[24:27]
s_waitcnt vmcnt(7)
ds_read_b128 v[40:43], v7 offset:24576
s_waitcnt lgkmcnt(2)
v_mfma_f32_16x16x32_bf16 v[16:19], a[136:139], v[48:51], v[16:19]
v_mfma_f32_16x16x32_bf16 v[20:23], a[140:143], v[48:51], v[20:23]
v_mfma_f32_16x16x32_bf16 v[24:27], a[144:147], v[48:51], v[24:27]
s_waitcnt vmcnt(6)
ds_read_b128 v[44:47], v7 offset:25600
s_waitcnt lgkmcnt(2)
v_mfma_f32_16x16x32_bf16 v[16:19], a[148:151], v[52:55], v[16:19]
v_mfma_f32_16x16x32_bf16 v[20:23], a[152:155], v[52:55], v[20:23]
v_mfma_f32_16x16x32_bf16 v[24:27], a[156:159], v[52:55], v[24:27]
s_waitcnt vmcnt(5)
ds_read_b128 v[48:51], v7 offset:26624
s_waitcnt lgkmcnt(2)
v_mfma_f32_16x16x32_bf16 v[16:19], a[160:163], v[40:43], v[16:19]
v_mfma_f32_16x16x32_bf16 v[20:23], a[164:167], v[40:43], v[20:23]
v_mfma_f32_16x16x32_bf16 v[24:27], a[168:171], v[40:43], v[24:27]
s_waitcnt vmcnt(4)
ds_read_b128 v[52:55], v7 offset:27648
s_waitcnt lgkmcnt(2)
v_mfma_f32_16x16x32_bf16 v[16:19], a[172:175], v[44:47], v[16:19]
v_mfma_f32_16x16x32_bf16 v[20:23], a[176:179], v[44:47], v[20:23]
v_mfma_f32_16x16x32_bf16 v[24:27], a[180:183], v[44:47], v[24:27]
s_waitcnt vmcnt(3)
ds_read_b128 v[40:43], v7 offset:28672
s_waitcnt lgkmcnt(2)
v_mfma_f32_16x16x32_bf16 v[16:19], a[184:187], v[48:51], v[16:19]
v_mfma_f32_16x16x32_bf16 v[20:23], a[188:191], v[48:51], v[20:23]
v_mfma_f32_16x16x32_bf16 v[24:27], a[192:195], v[48:51], v[24:27]
s_waitcnt vmcnt(2)
ds_read_b128 v[44:47], v7 offset:29696
s_waitcnt lgkmcnt(2)
v_mfma_f32_16x16x32_bf16 v[16:19], a[196:199], v[52:55], v[16:19]
v_mfma_f32_16x16x32_bf16 v[20:23], a[200:203], v[52:55], v[20:23]
v_mfma_f32_16x16x32_bf16 v[24:27], a[204:207], v[52:55], v[24:27]
s_waitcnt vmcnt(1)
ds_read_b128 v[48:51], v7 offset:30720
s_waitcnt lgkmcnt(2)
v_mfma_f32_16x16x32_bf16 v[16:19], a[208:211], v[40:43], v[16:19]
v_mfma_f32_16x16x32_bf16 v[20:23], a[212:215], v[40:43], v[20:23]
v_mfma_f32_16x16x32_bf16 v[24:27], a[216:219], v[40:43], v[24:27]
s_waitcnt vmcnt(0)
ds_read_b128 v[52:55], v7 offset:31744
s_waitcnt lgkmcnt(2)
v_mfma_f32_16x16x32_bf16 v[16:19], a[220:223], v[44:47], v[16:19]
v_mfma_f32_16x16x32_bf16 v[20:23], a[224:227], v[44:47], v[20:23]
v_mfma_f32_16x16x32_bf16 v[24:27], a[228:231], v[44:47], v[24:27]
s_waitcnt lgkmcnt(1)
v_mfma_f32_16x16x32_bf16 v[16:19], a[232:235], v[48:51], v[16:19]
v_mfma_f32_16x16x32_bf16 v[20:23], a[236:239], v[48:51], v[20:23]
v_mfma_f32_16x16x32_bf16 v[24:27], a[240:243], v[48:51], v[24:27]
s_waitcnt lgkmcnt(0)
v_mfma_f32_16x16x32_bf16 v[16:19], a[244:247], v[52:55], v[16:19]
v_mfma_f32_16x16x32_bf16 v[20:23], a[248:251], v[52:55], v[20:23]
v_mfma_f32_16x16x32_bf16 v[24:27], a[252:255], v[52:55], v[24:27]
v_fma_f32 v16, v16, v13, v28
v_fma_f32 v17, v17, v13, v29
v_fma_f32 v18, v18, v13, v30
v_fma_f32 v19, v19, v13, v31
ds_write_b128 v2, v[16:19] offset:0
v_fma_f32 v20, v20, v13, v32
v_fma_f32 v21, v21, v13, v33
v_fma_f32 v22, v22, v13, v34
v_fma_f32 v23, v23, v13, v35
ds_write_b128 v2, v[20:23] offset:1024
v_fma_f32 v24, v24, v13, v36
v_fma_f32 v25, v25, v13, v37
v_fma_f32 v26, v26, v13, v38
v_fma_f32 v27, v27, v13, v39
ds_write_b128 v2, v[24:27] offset:2048
s_waitcnt lgkmcnt(0)
s_barrier
s_cmp_eq_u32 s34, 3
s_cbranch_scc1 L_w_next
ds_read_b128 v[40:43], v14 offset:0
ds_read_b128 v[44:47], v14 offset:3072
ds_read_b128 v[48:51], v14 offset:6144
ds_read_b128 v[52:55], v14 offset:9216
s_waitcnt lgkmcnt(0)
v_pk_add_f32 v[40:41], v[40:41], v[44:45]
v_pk_add_f32 v[42:43], v[42:43], v[46:47]
v_pk_add_f32 v[48:49], v[48:49], v[52:53]
v_pk_add_f32 v[50:51], v[50:51], v[54:55]
v_pk_add_f32 v[40:41], v[40:41], v[48:49]
v_pk_add_f32 v[42:43], v[42:43], v[50:51]
v_cvt_pk_bf16_f32 v60, v40, v41
v_cvt_pk_bf16_f32 v61, v42, v43
buffer_store_dwordx2 v[60:61], v15, s[28:31], s55 offen
L_w_next:
v_xor_b32 v2, 16384, v2
v_xor_b32 v14, 16384, v14
s_add_u32 s55, s55, 147456
s_add_u32 s54, s54, 147456
s_add_u32 s53, s53, 1048576
s_add_u32 s56, s56, 512
s_add_u32 s35, s35, 1
s_cmp_lt_u32 s35, 16
s_cbranch_scc1 L_w_loop
s_waitcnt vmcnt(0)
s_endpgm
L_role_chain:
s_load_dwordx2 s[24:25], s[0:1], 32
s_load_dwordx2 s[8:9], s[0:1], 40
s_load_dwordx2 s[12:13], s[0:1], 48
s_load_dwordx2 s[16:17], s[0:1], 56
s_load_dwordx2 s[20:21], s[0:1], 64
s_load_dwordx2 s[28:29], s[0:1], 96
s_load_dwordx2 s[4:5], s[0:1], 104
s_mov_b32 s26, 9216
s_mov_b32 s27, 0x20000
s_mov_b32 s10, 4718592
s_mov_b32 s11, 0x20000
s_mov_b32 s14, 4718592
s_mov_b32 s15, 0x20000
s_mov_b32 s18, 4718592
s_mov_b32 s19, 0x20000
s_mov_b32 s22, 4718592
s_mov_b32 s23, 0x20000
s_mov_b32 s30, 256
s_mov_b32 s31, 0x20000
s_mov_b32 s6, 268435456
s_mov_b32 s7, 0x20000
v_lshrrev_b32 v1, 6, v0
s_nop 0
v_readfirstlane_b32 s33, v1
s_nop 0
s_cmp_eq_u32 s33, 0
s_cbranch_scc1 L_pro_w0
s_cmp_eq_u32 s33, 2
s_cbranch_scc1 L_pro_w2r
s_cmp_eq_u32 s33, 3
s_cbranch_scc1 L_pro_w3r
s_cmp_lt_u32 s32, 8
s_cbranch_scc1 L_pro_w1r
s_branch L_pro_w1
L_exit:
s_endpgm
L_pro_w0:
v_and_b32 v20, 63, v0
v_and_b32 v21, 15, v0
v_bfe_u32 v22, v0, 4, 2
v_lshlrev_b32 v1, 4, v20
v_add_u32 v2, 16384, v1
v_lshrrev_b32 v24, 1, v22
v_and_b32 v23, 1, v22
v_lshl_add_u32 v23, v24, 3, v23
v_lshlrev_b32 v23, 13, v23
v_lshlrev_b32 v26, 1, v22
v_xor_b32 v26, v26, v21
v_lshl_add_u32 v26, v26, 4, v23
v_xor_b32 v27, 128, v26
v_and_b32 v23, 1, v22
v_lshl_add_u32 v23, v24, 4, v23
v_mul_u32_u24 v23, 1152, v23
v_lshlrev_b32 v28, 2, v22
v_xor_b32 v28, v28, v21
v_lshl_add_u32 v28, v28, 4, v23
s_lshl_b32 s54, s32, 8
s_mul_i32 s55, s32, 147456
v_lshrrev_b32 v23, 2, v21
v_and_b32 v24, 1, v21
v_lshl_add_u32 v23, v23, 1, v24
v_mul_u32_u24 v23, 1152, v23
v_lshl_add_u32 v23, v22, 5, v23
v_bfe_u32 v24, v21, 1, 1
v_lshl_add_u32 v23, v24, 4, v23
s_lshl_b32 s56, s32, 7
s_waitcnt lgkmcnt(0)
buffer_load_dwordx4 v[12:15], v23, s[24:27], s56 offen
s_add_u32 s56, s54, 524288
s_mov_b32 m0, 36864
s_nop 0
buffer_load_dwordx4 v26, s[8:11], s56 offen lds
s_add_u32 s56, s54, 540672
s_mov_b32 m0, 37888
s_nop 0
buffer_load_dwordx4 v26, s[8:11], s56 offen lds
s_add_u32 s56, s54, 557056
s_mov_b32 m0, 38912
s_nop 0
buffer_load_dwordx4 v27, s[8:11], s56 offen lds
s_add_u32 s56, s54, 573440
s_mov_b32 m0, 39936
s_nop 0
buffer_load_dwordx4 v27, s[8:11], s56 offen lds
s_add_u32 s56, s54, 1048576
s_mov_b32 m0, 40960
s_nop 0
buffer_load_dwordx4 v26, s[8:11], s56 offen lds
s_add_u32 s56, s54, 1064960
s_mov_b32 m0, 41984
s_nop 0
buffer_load_dwordx4 v26, s[8:11], s56 offen lds
s_add_u32 s56, s54, 1081344
s_mov_b32 m0, 43008
s_nop 0
buffer_load_dwordx4 v27, s[8:11], s56 offen lds
s_add_u32 s56, s54, 1097728
s_mov_b32 m0, 44032
s_nop 0
buffer_load_dwordx4 v27, s[8:11], s56 offen lds
v_and_b32 v23, 1, v22
v_lshrrev_b32 v24, 2, v21
v_lshl_add_u32 v23, v23, 2, v24
v_lshlrev_b32 v23, 1, v23
v_bfe_u32 v44, v21, 1, 1
v_add_u32 v44, 0, v44
v_xor_b32 v44, v44, v23
v_lshlrev_b32 v44, 4, v44
v_lshl_add_u32 v44, v24, 8, v44
v_and_b32 v23, 1, v22
v_lshl_add_u32 v44, v23, 11, v44
v_and_b32 v23, 1, v21
v_lshl_add_u32 v44, v23, 3, v44
v_lshrrev_b32 v23, 1, v22
v_mul_u32_u24 v23, 40960, v23
v_add_u32 v23, 16384, v23
v_add_u32 v44, v44, v23
v_and_b32 v23, 1, v22
v_lshrrev_b32 v24, 2, v21
v_lshl_add_u32 v23, v23, 2, v24
v_lshlrev_b32 v23, 1, v23
v_bfe_u32 v45, v21, 1, 1
v_add_u32 v45, 2, v45
v_xor_b32 v45, v45, v23
v_lshlrev_b32 v45, 4, v45
v_lshl_add_u32 v45, v24, 8, v45
v_and_b32 v23, 1, v22
v_lshl_add_u32 v45, v23, 11, v45
v_and_b32 v23, 1, v21
v_lshl_add_u32 v45, v23, 3, v45
v_lshrrev_b32 v23, 1, v22
v_mul_u32_u24 v23, 40960, v23
v_add_u32 v23, 16384, v23
v_add_u32 v45, v45, v23
v_and_b32 v23, 1, v22
v_lshrrev_b32 v24, 2, v21
v_lshl_add_u32 v23, v23, 2, v24
v_lshlrev_b32 v23, 1, v23
v_bfe_u32 v46, v21, 1, 1
v_add_u32 v46, 0, v46
v_xor_b32 v46, v46, v23
v_lshlrev_b32 v46, 4, v46
v_lshl_add_u32 v46, v24, 8, v46
v_and_b32 v23, 1, v22
v_lshl_add_u32 v46, v23, 11, v46
v_and_b32 v23, 1, v21
v_lshl_add_u32 v46, v23, 3, v46
v_lshrrev_b32 v23, 1, v22
v_mul_u32_u24 v23, 32768, v23
v_add_u32 v23, 98304, v23
v_add_u32 v46, v46, v23
v_and_b32 v23, 1, v22
v_lshrrev_b32 v24, 2, v21
v_lshl_add_u32 v23, v23, 2, v24
v_lshlrev_b32 v23, 1, v23
v_bfe_u32 v47, v21, 1, 1
v_add_u32 v47, 2, v47
v_xor_b32 v47, v47, v23
v_lshlrev_b32 v47, 4, v47
v_lshl_add_u32 v47, v24, 8, v47
v_and_b32 v23, 1, v22
v_lshl_add_u32 v47, v23, 11, v47
v_and_b32 v23, 1, v21
v_lshl_add_u32 v47, v23, 3, v47
v_lshrrev_b32 v23, 1, v22
v_mul_u32_u24 v23, 32768, v23
v_add_u32 v23, 98304, v23
v_add_u32 v47, v47, v23
v_and_b32 v23, 1, v22
v_bfe_u32 v24, v21, 2, 1
v_lshl_add_u32 v23, v23, 1, v24
v_xor_b32 v24, 0, v23
v_lshlrev_b32 v24, 6, v24
v_lshl_add_u32 v48, v23, 8, v24
v_and_b32 v23, 3, v21
v_lshl_add_u32 v48, v23, 4, v48
v_and_b32 v23, 8, v21
v_add_u32 v48, v48, v23
v_lshrrev_b32 v23, 1, v22
v_mul_u32_u24 v23, 40960, v23
v_add_u32 v23, 16384, v23
v_add_u32 v48, v48, v23
v_and_b32 v23, 1, v22
v_bfe_u32 v24, v21, 2, 1
v_lshl_add_u32 v23, v23, 1, v24
v_xor_b32 v24, 0, v23
v_lshlrev_b32 v24, 6, v24
v_lshl_add_u32 v49, v23, 8, v24
v_and_b32 v23, 3, v21
v_lshl_add_u32 v49, v23, 4, v49
v_and_b32 v23, 8, v21
v_add_u32 v49, v49, v23
v_lshrrev_b32 v23, 1, v22
v_mul_u32_u24 v23, 32768, v23
v_add_u32 v23, 98304, v23
v_add_u32 v49, v49, v23
v_bfe_u32 v23, v21, 1, 1
v_and_b32 v24, 1, v21
v_lshl_add_u32 v23, v24, 16, v23
v_mul_u32_u24 v23, 0xaaaa, v23
v_add_u32 v0, 0x44444444, v23
v_lshlrev_b32 v3, 3, v20
v_lshrrev_b32 v25, 5, v20
v_lshlrev_b32 v25, 6, v25
v_xor_b32 v3, v3, v25
v_lshrrev_b32 v25, 2, v20
v_and_b32 v4, 3, v21
v_lshl_add_u32 v4, v4, 4, v25
v_lshlrev_b32 v4, 3, v4
v_bfe_u32 v25, v21, 1, 1
v_lshlrev_b32 v23, 6, v25
v_xor_b32 v4, v4, v23
v_lshlrev_b32 v5, 4, v21
v_lshl_add_u32 v5, v22, 2, v5
v_mul_u32_u24 v23, 1024, v25
v_add_u32 v5, v5, v23
v_lshlrev_b32 v9, 8, v22
v_lshl_add_u32 v9, v25, 6, v9
v_bfe_u32 v23, v21, 3, 1
v_lshl_add_u32 v9, v23, 7, v9
v_bfe_u32 v23, v21, 2, 1
v_lshl_add_u32 v9, v23, 5, v9
v_and_b32 v23, 1, v21
v_lshl_add_u32 v9, v23, 4, v9
v_lshrrev_b32 v23, 1, v22
v_and_b32 v24, 1, v22
v_and_b32 v25, 7, v21
v_lshrrev_b32 v7, 3, v21
v_lshl_add_u32 v8, v7, 1, v23
v_lshlrev_b32 v8, 12, v8
v_lshl_add_u32 v8, v24, 7, v8
v_and_b32 v25, 4, v21
v_lshl_add_u32 v8, v25, 3, v8
v_and_b32 v25, 1, v21
v_lshl_add_u32 v8, v25, 4, v8
v_bfe_u32 v25, v21, 1, 1
v_lshl_add_u32 v8, v25, 3, v8
s_lshr_b32 s56, s32, 1
s_lshl_b32 s56, s56, 8
s_and_b32 s57, s32, 1
s_lshl_b32 s57, s57, 6
s_add_u32 s56, s56, s57
s_add_u32 s56, s56, 0
v_add_u32 v8, s56, v8
v_and_b32 v7, 12, v21
v_bfe_u32 v25, v21, 1, 1
v_add_u32 v7, v7, v25
v_lshlrev_b32 v7, 4, v7
v_lshl_add_u32 v7, v22, 8, v7
s_mov_b32 s42, 0
s_mov_b32 s43, 65536
s_mov_b32 s44, 131072
s_mov_b32 s45, 196608
s_mov_b32 s46, 262144
s_mov_b32 s47, 294912
s_mov_b32 s48, 299008
s_mov_b32 s49, 303104
s_mov_b32 s50, 0x3e0293ee
s_mov_b32 s51, 0x3e0293ee
s_mov_b32 s52, 0x3f803f80
s_mov_b32 s53, 0x3f803f80
v_and_b32 v11, 3, v21
v_cmp_eq_u32 vcc, 0, v11
s_nop 1
v_cndmask_b32 v11, 0, 1, vcc
s_mov_b32 s34, 0
s_mov_b32 s35, -1
s_mov_b32 s36, 0
s_mov_b32 s41, 300000
s_lshl_b32 s37, s32, 14
s_add_u32 s39, s37, 17301504
s_add_u32 s37, s37, 16777216
s_mov_b32 s40, 8749056
v_mov_b64 v[36:37], 0
v_mov_b64 v[38:39], 0
ds_write_b128 v1, v[36:39] offset:14336
s_lshl_b32 s56, s32, 1
s_add_u32 s56, s56, 0
s_cmp_eq_u32 s56, 0
s_cselect_b32 s56, 64, s56
s_mul_i32 s56, s56, 10240
s_add_u32 s56, s56, 8388608
s_add_u32 s57, s56, 4096
v_mov_b32 v40, 0
v_mov_b32 v41, 0
v_mov_b32 v42, 0
v_mov_b32 v43, 0
buffer_store_dwordx4 v[40:43], v1, s[4:7], s56 offen offset:0 sc0 sc1
buffer_store_dwordx4 v[40:43], v1, s[4:7], s56 offen offset:1024 sc0 sc1
buffer_store_dwordx4 v[40:43], v1, s[4:7], s56 offen offset:2048 sc0 sc1
buffer_store_dwordx4 v[40:43], v1, s[4:7], s56 offen offset:3072 sc0 sc1
v_lshlrev_b32 v23, 2, v20
s_lshl_b32 s56, s32, 8
s_add_u32 s56, s56, 327680
buffer_store_dword v36, v23, s[4:7], s56 offen sc0 sc1
s_lshl_b32 s56, s32, 10
s_cmp_ge_u32 s32, 9
s_cselect_b32 s56, 268435456, s56
s_add_u32 s57, s56, 8388608
s_add_u32 s56, s56, 294912
s_waitcnt vmcnt(13)
v_or_b32 v12, 1, v12
buffer_store_dwordx4 v[12:15], v1, s[4:7], s56 offen sc0 sc1
buffer_store_dwordx4 v[12:15], v1, s[4:7], s57 offen sc0 sc1
s_getreg_b32 s56, hwreg(HW_REG_XCC_ID)
s_and_b32 s56, s56, 15
s_mul_i32 s57, s56, s56
s_lshl_b32 s57, s57, 18
s_lshl_b32 s56, s56, 8
s_add_u32 s57, s57, s56
s_add_u32 s58, s57, 1
s_lshl_b32 s101, s32, 7
s_add_u32 s101, s101, 327680
v_mov_b32 v24, 0
s_add_u32 s56, s54, 2621440
s_mov_b32 m0, 45056
s_nop 0
buffer_load_dwordx4 v26, s[8:11], s56 offen lds
s_add_u32 s56, s54, 2637824
s_mov_b32 m0, 46080
s_nop 0
buffer_load_dwordx4 v26, s[8:11], s56 offen lds
s_add_u32 s56, s54, 2654208
s_mov_b32 m0, 47104
s_nop 0
buffer_load_dwordx4 v27, s[8:11], s56 offen lds
s_add_u32 s56, s54, 2670592
s_mov_b32 m0, 48128
s_nop 0
buffer_load_dwordx4 v27, s[8:11], s56 offen lds
s_add_u32 s56, s54, 3145728
s_mov_b32 m0, 16384
s_nop 0
buffer_load_dwordx4 v26, s[8:11], s56 offen lds
s_add_u32 s56, s54, 3162112
s_mov_b32 m0, 17408
s_nop 0
buffer_load_dwordx4 v26, s[8:11], s56 offen lds
s_add_u32 s56, s54, 3178496
s_mov_b32 m0, 18432
s_nop 0
buffer_load_dwordx4 v27, s[8:11], s56 offen lds
s_add_u32 s56, s54, 3194880
s_mov_b32 m0, 19456
s_nop 0
buffer_load_dwordx4 v27, s[8:11], s56 offen lds
s_add_u32 s56, s54, 3670016
s_mov_b32 m0, 20480
s_nop 0
buffer_load_dwordx4 v26, s[8:11], s56 offen lds
s_add_u32 s56, s54, 3686400
s_mov_b32 m0, 21504
s_nop 0
buffer_load_dwordx4 v26, s[8:11], s56 offen lds
s_add_u32 s56, s54, 3702784
s_mov_b32 m0, 22528
s_nop 0
buffer_load_dwordx4 v27, s[8:11], s56 offen lds
s_add_u32 s56, s54, 3719168
s_mov_b32 m0, 23552
s_nop 0
buffer_load_dwordx4 v27, s[8:11], s56 offen lds
s_add_u32 s56, s54, 4194304
s_mov_b32 m0, 24576
s_nop 0
buffer_load_dwordx4 v26, s[8:11], s56 offen lds
s_add_u32 s56, s54, 4210688
s_mov_b32 m0, 25600
s_nop 0
buffer_load_dwordx4 v26, s[8:11], s56 offen lds
s_add_u32 s56, s54, 4227072
s_mov_b32 m0, 26624
s_nop 0
buffer_load_dwordx4 v27, s[8:11], s56 offen lds
s_add_u32 s56, s54, 4243456
s_mov_b32 m0, 27648
s_nop 0
buffer_load_dwordx4 v27, s[8:11], s56 offen lds
s_add_u32 s56, s54, 0
s_mov_b32 m0, 28672
s_nop 0
buffer_load_dwordx4 v26, s[12:15], s56 offen lds
s_add_u32 s56, s54, 16384
s_mov_b32 m0, 29696
s_nop 0
buffer_load_dwordx4 v26, s[12:15], s56 offen lds
s_add_u32 s56, s54, 32768
s_mov_b32 m0, 30720
s_nop 0
buffer_load_dwordx4 v27, s[12:15], s56 offen lds
s_add_u32 s56, s54, 49152
s_mov_b32 m0, 31744
s_nop 0
buffer_load_dwordx4 v27, s[12:15], s56 offen lds
s_add_u32 s56, s54, 524288
s_mov_b32 m0, 32768
s_nop 0
buffer_load_dwordx4 v26, s[12:15], s56 offen lds
s_add_u32 s56, s54, 540672
s_mov_b32 m0, 33792
s_nop 0
buffer_load_dwordx4 v26, s[12:15], s56 offen lds
s_add_u32 s56, s54, 557056
s_mov_b32 m0, 34816
s_nop 0
buffer_load_dwordx4 v27, s[12:15], s56 offen lds
s_add_u32 s56, s54, 573440
s_mov_b32 m0, 35840
s_nop 0
buffer_load_dwordx4 v27, s[12:15], s56 offen lds
v_and_b32 v23, 3, v20
v_lshrrev_b32 v24, 2, v20
v_mul_u32_u24 v29, 1152, v24
v_lshl_add_u32 v29, v23, 4, v29
v_lshrrev_b32 v24, 2, v21
v_and_b32 v25, 1, v22
v_lshlrev_b32 v31, 10, v25
v_lshrrev_b32 v25, 1, v22
v_lshl_add_u32 v31, v25, 8, v31
v_and_b32 v25, 1, v24
v_lshl_add_u32 v31, v25, 6, v31
v_lshrrev_b32 v25, 1, v24
v_lshl_add_u32 v31, v25, 3, v31
v_lshl_add_u32 v31, v23, 4, v31
v_add_u32 v31, 16384, v31
s_add_u32 s56, s55, 1024
s_mov_b32 m0, 49152
s_nop 0
buffer_load_dwordx4 v29, s[20:23], s56 offen lds
s_add_u32 s56, s55, 19456
s_mov_b32 m0, 50176
s_nop 0
buffer_load_dwordx4 v29, s[20:23], s56 offen lds
s_add_u32 s56, s55, 37888
s_mov_b32 m0, 53248
s_nop 0
buffer_load_dwordx4 v29, s[20:23], s56 offen lds
s_add_u32 s56, s55, 56320
s_mov_b32 m0, 54272
s_nop 0
buffer_load_dwordx4 v29, s[20:23], s56 offen lds
s_add_u32 s56, s55, 74752
s_mov_b32 m0, 51200
s_nop 0
buffer_load_dwordx4 v29, s[20:23], s56 offen lds
s_add_u32 s56, s55, 93184
s_mov_b32 m0, 52224
s_nop 0
buffer_load_dwordx4 v29, s[20:23], s56 offen lds
s_add_u32 s56, s55, 111616
s_mov_b32 m0, 55296
s_nop 0
buffer_load_dwordx4 v29, s[20:23], s56 offen lds
s_add_u32 s56, s55, 130048
s_mov_b32 m0, 56320
s_nop 0
buffer_load_dwordx4 v29, s[20:23], s56 offen lds
v_mov_b32 v24, 0
s_waitcnt vmcnt(43)
s_barrier
ds_read_b64_tr_b16 v[80:81], v44 offset:20480
ds_read_b64_tr_b16 v[82:83], v44 offset:21504
ds_read_b64_tr_b16 v[84:85], v46 offset:20480
ds_read_b64_tr_b16 v[86:87], v46 offset:21504
ds_read_b64_tr_b16 v[88:89], v45 offset:20480
ds_read_b64_tr_b16 v[90:91], v45 offset:21504
ds_read_b64_tr_b16 v[92:93], v47 offset:20480
ds_read_b64_tr_b16 v[94:95], v47 offset:21504
s_waitcnt lgkmcnt(0)
s_waitcnt vmcnt(39)
s_barrier
s_add_u32 s56, s54, 1048576
s_mov_b32 m0, 36864
s_nop 0
buffer_load_dwordx4 v26, s[12:15], s56 offen lds
s_add_u32 s56, s54, 1064960
s_mov_b32 m0, 37888
s_nop 0
buffer_load_dwordx4 v26, s[12:15], s56 offen lds
s_add_u32 s56, s54, 1081344
s_mov_b32 m0, 38912
s_nop 0
buffer_load_dwordx4 v27, s[12:15], s56 offen lds
s_add_u32 s56, s54, 1097728
s_mov_b32 m0, 39936
s_nop 0
buffer_load_dwordx4 v27, s[12:15], s56 offen lds
ds_read_b64_tr_b16 v[96:97], v44 offset:24576
ds_read_b64_tr_b16 v[98:99], v44 offset:25600
ds_read_b64_tr_b16 v[100:101], v46 offset:24576
ds_read_b64_tr_b16 v[102:103], v46 offset:25600
ds_read_b64_tr_b16 v[104:105], v45 offset:24576
ds_read_b64_tr_b16 v[106:107], v45 offset:25600
ds_read_b64_tr_b16 v[108:109], v47 offset:24576
ds_read_b64_tr_b16 v[110:111], v47 offset:25600
s_waitcnt lgkmcnt(0)
s_waitcnt vmcnt(32)
s_barrier
s_add_u32 s56, s54, 1572864
s_mov_b32 m0, 40960
s_nop 0
buffer_load_dwordx4 v26, s[12:15], s56 offen lds
s_add_u32 s56, s54, 1589248
s_mov_b32 m0, 41984
s_nop 0
buffer_load_dwordx4 v26, s[12:15], s56 offen lds
s_add_u32 s56, s54, 1605632
s_mov_b32 m0, 43008
s_nop 0
buffer_load_dwordx4 v27, s[12:15], s56 offen lds
s_add_u32 s56, s54, 1622016
s_mov_b32 m0, 44032
s_nop 0
buffer_load_dwordx4 v27, s[12:15], s56 offen lds
ds_read_b64_tr_b16 v[112:113], v44 offset:28672
ds_read_b64_tr_b16 v[114:115], v44 offset:29696
ds_read_b64_tr_b16 v[116:117], v46 offset:28672
ds_read_b64_tr_b16 v[118:119], v46 offset:29696
ds_read_b64_tr_b16 v[120:121], v45 offset:28672
ds_read_b64_tr_b16 v[122:123], v45 offset:29696
ds_read_b64_tr_b16 v[124:125], v47 offset:28672
ds_read_b64_tr_b16 v[126:127], v47 offset:29696
v_mov_b32 v23, s58
s_mov_b64 exec, 1
buffer_atomic_add v23, v24, s[28:31], 0 offen sc1
s_mov_b64 exec, -1
s_waitcnt lgkmcnt(0)
s_waitcnt vmcnt(33)
s_barrier
s_add_u32 s56, s54, 2097152
s_mov_b32 m0, 45056
s_nop 0
buffer_load_dwordx4 v26, s[12:15], s56 offen lds
s_add_u32 s56, s54, 2113536
s_mov_b32 m0, 46080
s_nop 0
buffer_load_dwordx4 v26, s[12:15], s56 offen lds
s_add_u32 s56, s54, 2129920
s_mov_b32 m0, 47104
s_nop 0
buffer_load_dwordx4 v27, s[12:15], s56 offen lds
s_add_u32 s56, s54, 2146304
s_mov_b32 m0, 48128
s_nop 0
buffer_load_dwordx4 v27, s[12:15], s56 offen lds
ds_read_b64_tr_b16 v[128:129], v44 offset:0
ds_read_b64_tr_b16 v[130:131], v44 offset:1024
ds_read_b64_tr_b16 v[132:133], v46 offset:0
ds_read_b64_tr_b16 v[134:135], v46 offset:1024
ds_read_b64_tr_b16 v[136:137], v45 offset:0
ds_read_b64_tr_b16 v[138:139], v45 offset:1024
ds_read_b64_tr_b16 v[140:141], v47 offset:0
ds_read_b64_tr_b16 v[142:143], v47 offset:1024
s_waitcnt lgkmcnt(0)
s_waitcnt vmcnt(33)
s_barrier
s_add_u32 s56, s54, 3145728
s_mov_b32 m0, 16384
s_nop 0
buffer_load_dwordx4 v26, s[12:15], s56 offen lds
s_add_u32 s56, s54, 3162112
s_mov_b32 m0, 17408
s_nop 0
buffer_load_dwordx4 v26, s[12:15], s56 offen lds
s_add_u32 s56, s54, 3178496
s_mov_b32 m0, 18432
s_nop 0
buffer_load_dwordx4 v27, s[12:15], s56 offen lds
s_add_u32 s56, s54, 3194880
s_mov_b32 m0, 19456
s_nop 0
buffer_load_dwordx4 v27, s[12:15], s56 offen lds
ds_read_b64_tr_b16 v[144:145], v44 offset:4096
ds_read_b64_tr_b16 v[146:147], v44 offset:5120
ds_read_b64_tr_b16 v[148:149], v46 offset:4096
ds_read_b64_tr_b16 v[150:151], v46 offset:5120
ds_read_b64_tr_b16 v[152:153], v45 offset:4096
ds_read_b64_tr_b16 v[154:155], v45 offset:5120
ds_read_b64_tr_b16 v[156:157], v47 offset:4096
ds_read_b64_tr_b16 v[158:159], v47 offset:5120
s_waitcnt lgkmcnt(0)
s_waitcnt vmcnt(33)
s_barrier
s_add_u32 s56, s54, 3670016
s_mov_b32 m0, 20480
s_nop 0
buffer_load_dwordx4 v26, s[12:15], s56 offen lds
s_add_u32 s56, s54, 3686400
s_mov_b32 m0, 21504
s_nop 0
buffer_load_dwordx4 v26, s[12:15], s56 offen lds
s_add_u32 s56, s54, 3702784
s_mov_b32 m0, 22528
s_nop 0
buffer_load_dwordx4 v27, s[12:15], s56 offen lds
s_add_u32 s56, s54, 3719168
s_mov_b32 m0, 23552
s_nop 0
buffer_load_dwordx4 v27, s[12:15], s56 offen lds
ds_read_b64_tr_b16 v[160:161], v44 offset:8192
ds_read_b64_tr_b16 v[162:163], v44 offset:9216
ds_read_b64_tr_b16 v[164:165], v46 offset:8192
ds_read_b64_tr_b16 v[166:167], v46 offset:9216
ds_read_b64_tr_b16 v[168:169], v45 offset:8192
ds_read_b64_tr_b16 v[170:171], v45 offset:9216
ds_read_b64_tr_b16 v[172:173], v47 offset:8192
ds_read_b64_tr_b16 v[174:175], v47 offset:9216
s_waitcnt lgkmcnt(0)
s_waitcnt vmcnt(33)
s_barrier
s_add_u32 s56, s54, 4194304
s_mov_b32 m0, 24576
s_nop 0
buffer_load_dwordx4 v26, s[12:15], s56 offen lds
s_add_u32 s56, s54, 4210688
s_mov_b32 m0, 25600
s_nop 0
buffer_load_dwordx4 v26, s[12:15], s56 offen lds
s_add_u32 s56, s54, 4227072
s_mov_b32 m0, 26624
s_nop 0
buffer_load_dwordx4 v27, s[12:15], s56 offen lds
s_add_u32 s56, s54, 4243456
s_mov_b32 m0, 27648
s_nop 0
buffer_load_dwordx4 v27, s[12:15], s56 offen lds
ds_read_b64_tr_b16 v[176:177], v44 offset:12288
ds_read_b64_tr_b16 v[178:179], v44 offset:13312
ds_read_b64_tr_b16 v[180:181], v46 offset:12288
ds_read_b64_tr_b16 v[182:183], v46 offset:13312
ds_read_b64_tr_b16 v[184:185], v45 offset:12288
ds_read_b64_tr_b16 v[186:187], v45 offset:13312
ds_read_b64_tr_b16 v[188:189], v47 offset:12288
ds_read_b64_tr_b16 v[190:191], v47 offset:13312
s_waitcnt lgkmcnt(0)
s_waitcnt vmcnt(33)
s_barrier
s_add_u32 s56, s54, 0
s_mov_b32 m0, 28672
s_nop 0
buffer_load_dwordx4 v26, s[16:19], s56 offen lds
s_add_u32 s56, s54, 16384
s_mov_b32 m0, 29696
s_nop 0
buffer_load_dwordx4 v26, s[16:19], s56 offen lds
s_add_u32 s56, s54, 32768
s_mov_b32 m0, 30720
s_nop 0
buffer_load_dwordx4 v27, s[16:19], s56 offen lds
s_add_u32 s56, s54, 49152
s_mov_b32 m0, 31744
s_nop 0
buffer_load_dwordx4 v27, s[16:19], s56 offen lds
ds_read_b64_tr_b16 v[192:193], v44 offset:16384
ds_read_b64_tr_b16 v[194:195], v44 offset:17408
ds_read_b64_tr_b16 v[196:197], v46 offset:16384
ds_read_b64_tr_b16 v[198:199], v46 offset:17408
ds_read_b64_tr_b16 v[200:201], v45 offset:16384
ds_read_b64_tr_b16 v[202:203], v45 offset:17408
ds_read_b64_tr_b16 v[204:205], v47 offset:16384
ds_read_b64_tr_b16 v[206:207], v47 offset:17408
s_waitcnt lgkmcnt(0)
s_waitcnt vmcnt(25)
s_barrier
s_add_u32 s56, s54, 524288
s_mov_b32 m0, 32768
s_nop 0
buffer_load_dwordx4 v26, s[16:19], s56 offen lds
s_add_u32 s56, s54, 540672
s_mov_b32 m0, 33792
s_nop 0
buffer_load_dwordx4 v26, s[16:19], s56 offen lds
s_add_u32 s56, s54, 557056
s_mov_b32 m0, 34816
s_nop 0
buffer_load_dwordx4 v27, s[16:19], s56 offen lds
s_add_u32 s56, s54, 573440
s_mov_b32 m0, 35840
s_nop 0
buffer_load_dwordx4 v27, s[16:19], s56 offen lds
ds_read_b64_tr_b16 v[208:209], v44 offset:20480
ds_read_b64_tr_b16 v[210:211], v44 offset:21504
ds_read_b64_tr_b16 v[212:213], v46 offset:20480
ds_read_b64_tr_b16 v[214:215], v46 offset:21504
ds_read_b64_tr_b16 v[216:217], v45 offset:20480
ds_read_b64_tr_b16 v[218:219], v45 offset:21504
ds_read_b64_tr_b16 v[220:221], v47 offset:20480
ds_read_b64_tr_b16 v[222:223], v47 offset:21504
s_waitcnt lgkmcnt(0)
s_waitcnt vmcnt(25)
s_barrier
s_add_u32 s56, s54, 1048576
s_mov_b32 m0, 36864
s_nop 0
buffer_load_dwordx4 v26, s[16:19], s56 offen lds
s_add_u32 s56, s54, 1064960
s_mov_b32 m0, 37888
s_nop 0
buffer_load_dwordx4 v26, s[16:19], s56 offen lds
s_add_u32 s56, s54, 1081344
s_mov_b32 m0, 38912
s_nop 0
buffer_load_dwordx4 v27, s[16:19], s56 offen lds
s_add_u32 s56, s54, 1097728
s_mov_b32 m0, 39936
s_nop 0
buffer_load_dwordx4 v27, s[16:19], s56 offen lds
ds_read_b64_tr_b16 v[224:225], v44 offset:24576
ds_read_b64_tr_b16 v[226:227], v44 offset:25600
ds_read_b64_tr_b16 v[228:229], v46 offset:24576
ds_read_b64_tr_b16 v[230:231], v46 offset:25600
ds_read_b64_tr_b16 v[232:233], v45 offset:24576
ds_read_b64_tr_b16 v[234:235], v45 offset:25600
ds_read_b64_tr_b16 v[236:237], v47 offset:24576
ds_read_b64_tr_b16 v[238:239], v47 offset:25600
ds_read_b64_tr_b16 v[60:61], v31 offset:32768
ds_read_b64_tr_b16 v[62:63], v31 offset:32896
ds_read_b64_tr_b16 v[64:65], v31 offset:33280
ds_read_b64_tr_b16 v[66:67], v31 offset:33408
ds_read_b64_tr_b16 v[68:69], v31 offset:34816
ds_read_b64_tr_b16 v[70:71], v31 offset:34944
ds_read_b64_tr_b16 v[72:73], v31 offset:35328
ds_read_b64_tr_b16 v[74:75], v31 offset:35456
s_waitcnt lgkmcnt(0)
ds_write_b128 v2, v[60:63] offset:32768
ds_write_b128 v2, v[64:67] offset:33792
ds_write_b128 v2, v[68:71] offset:34816
ds_write_b128 v2, v[72:75] offset:35840
s_waitcnt lgkmcnt(0)
s_waitcnt vmcnt(24)
s_barrier
s_add_u32 s56, s54, 1572864
s_mov_b32 m0, 40960
s_nop 0
buffer_load_dwordx4 v26, s[16:19], s56 offen lds
s_add_u32 s56, s54, 1589248
s_mov_b32 m0, 41984
s_nop 0
buffer_load_dwordx4 v26, s[16:19], s56 offen lds
s_add_u32 s56, s54, 1605632
s_mov_b32 m0, 43008
s_nop 0
buffer_load_dwordx4 v27, s[16:19], s56 offen lds
s_add_u32 s56, s54, 1622016
s_mov_b32 m0, 44032
s_nop 0
buffer_load_dwordx4 v27, s[16:19], s56 offen lds
ds_read_b64_tr_b16 v[240:241], v44 offset:28672
ds_read_b64_tr_b16 v[242:243], v44 offset:29696
ds_read_b64_tr_b16 v[244:245], v46 offset:28672
ds_read_b64_tr_b16 v[246:247], v46 offset:29696
ds_read_b64_tr_b16 v[248:249], v45 offset:28672
ds_read_b64_tr_b16 v[250:251], v45 offset:29696
ds_read_b64_tr_b16 v[252:253], v47 offset:28672
ds_read_b64_tr_b16 v[254:255], v47 offset:29696
ds_read_b64_tr_b16 v[60:61], v31 offset:36864
ds_read_b64_tr_b16 v[62:63], v31 offset:36992
ds_read_b64_tr_b16 v[64:65], v31 offset:37376
ds_read_b64_tr_b16 v[66:67], v31 offset:37504
ds_read_b64_tr_b16 v[68:69], v31 offset:38912
ds_read_b64_tr_b16 v[70:71], v31 offset:39040
ds_read_b64_tr_b16 v[72:73], v31 offset:39424
ds_read_b64_tr_b16 v[74:75], v31 offset:39552
s_waitcnt lgkmcnt(0)
ds_write_b128 v2, v[60:63] offset:36864
ds_write_b128 v2, v[64:67] offset:37888
ds_write_b128 v2, v[68:71] offset:38912
ds_write_b128 v2, v[72:75] offset:39936
s_waitcnt lgkmcnt(0)
s_waitcnt vmcnt(24)
s_barrier
s_add_u32 s56, s54, 2097152
s_mov_b32 m0, 45056
s_nop 0
buffer_load_dwordx4 v26, s[16:19], s56 offen lds
s_add_u32 s56, s54, 2113536
s_mov_b32 m0, 46080
s_nop 0
buffer_load_dwordx4 v26, s[16:19], s56 offen lds
s_add_u32 s56, s54, 2129920
s_mov_b32 m0, 47104
s_nop 0
buffer_load_dwordx4 v27, s[16:19], s56 offen lds
s_add_u32 s56, s54, 2146304
s_mov_b32 m0, 48128
s_nop 0
buffer_load_dwordx4 v27, s[16:19], s56 offen lds
ds_read_b64_tr_b16 a[0:1], v44 offset:0
ds_read_b64_tr_b16 a[2:3], v44 offset:1024
ds_read_b64_tr_b16 a[4:5], v46 offset:0
ds_read_b64_tr_b16 a[6:7], v46 offset:1024
ds_read_b64_tr_b16 a[8:9], v45 offset:0
ds_read_b64_tr_b16 a[10:11], v45 offset:1024
ds_read_b64_tr_b16 a[12:13], v47 offset:0
ds_read_b64_tr_b16 a[14:15], v47 offset:1024
s_waitcnt lgkmcnt(0)
s_waitcnt vmcnt(24)
s_barrier
s_add_u32 s56, s54, 2621440
s_mov_b32 m0, 16384
s_nop 0
buffer_load_dwordx4 v26, s[16:19], s56 offen lds
s_add_u32 s56, s54, 2637824
s_mov_b32 m0, 17408
s_nop 0
buffer_load_dwordx4 v26, s[16:19], s56 offen lds
s_add_u32 s56, s54, 2654208
s_mov_b32 m0, 18432
s_nop 0
buffer_load_dwordx4 v27, s[16:19], s56 offen lds
s_add_u32 s56, s54, 2670592
s_mov_b32 m0, 19456
s_nop 0
buffer_load_dwordx4 v27, s[16:19], s56 offen lds
ds_read_b64_tr_b16 a[16:17], v44 offset:4096
ds_read_b64_tr_b16 a[18:19], v44 offset:5120
ds_read_b64_tr_b16 a[20:21], v46 offset:4096
ds_read_b64_tr_b16 a[22:23], v46 offset:5120
ds_read_b64_tr_b16 a[24:25], v45 offset:4096
ds_read_b64_tr_b16 a[26:27], v45 offset:5120
ds_read_b64_tr_b16 a[28:29], v47 offset:4096
ds_read_b64_tr_b16 a[30:31], v47 offset:5120
s_waitcnt lgkmcnt(0)
s_waitcnt vmcnt(24)
s_barrier
s_add_u32 s56, s54, 3145728
s_mov_b32 m0, 20480
s_nop 0
buffer_load_dwordx4 v26, s[16:19], s56 offen lds
s_add_u32 s56, s54, 3162112
s_mov_b32 m0, 21504
s_nop 0
buffer_load_dwordx4 v26, s[16:19], s56 offen lds
s_add_u32 s56, s54, 3178496
s_mov_b32 m0, 22528
s_nop 0
buffer_load_dwordx4 v27, s[16:19], s56 offen lds
s_add_u32 s56, s54, 3194880
s_mov_b32 m0, 23552
s_nop 0
buffer_load_dwordx4 v27, s[16:19], s56 offen lds
ds_read_b64_tr_b16 a[32:33], v44 offset:8192
ds_read_b64_tr_b16 a[34:35], v44 offset:9216
ds_read_b64_tr_b16 a[36:37], v46 offset:8192
ds_read_b64_tr_b16 a[38:39], v46 offset:9216
ds_read_b64_tr_b16 a[40:41], v45 offset:8192
ds_read_b64_tr_b16 a[42:43], v45 offset:9216
ds_read_b64_tr_b16 a[44:45], v47 offset:8192
ds_read_b64_tr_b16 a[46:47], v47 offset:9216
s_waitcnt lgkmcnt(0)
s_waitcnt vmcnt(24)
s_barrier
s_add_u32 s56, s54, 3670016
s_mov_b32 m0, 24576
s_nop 0
buffer_load_dwordx4 v26, s[16:19], s56 offen lds
s_add_u32 s56, s54, 3686400
s_mov_b32 m0, 25600
s_nop 0
buffer_load_dwordx4 v26, s[16:19], s56 offen lds
s_add_u32 s56, s54, 3702784
s_mov_b32 m0, 26624
s_nop 0
buffer_load_dwordx4 v27, s[16:19], s56 offen lds
s_add_u32 s56, s54, 3719168
s_mov_b32 m0, 27648
s_nop 0
buffer_load_dwordx4 v27, s[16:19], s56 offen lds
ds_read_b64_tr_b16 a[48:49], v44 offset:12288
ds_read_b64_tr_b16 a[50:51], v44 offset:13312
ds_read_b64_tr_b16 a[52:53], v46 offset:12288
ds_read_b64_tr_b16 a[54:55], v46 offset:13312
ds_read_b64_tr_b16 a[56:57], v45 offset:12288
ds_read_b64_tr_b16 a[58:59], v45 offset:13312
ds_read_b64_tr_b16 a[60:61], v47 offset:12288
ds_read_b64_tr_b16 a[62:63], v47 offset:13312
s_waitcnt lgkmcnt(0)
s_waitcnt vmcnt(24)
s_barrier
s_add_u32 s56, s55, 36864
s_mov_b32 m0, 28672
s_nop 0
buffer_load_dwordx4 v28, s[20:23], s56 offen lds
s_add_u32 s56, s55, 39168
s_mov_b32 m0, 29696
s_nop 0
buffer_load_dwordx4 v28, s[20:23], s56 offen lds
s_add_u32 s56, s55, 46080
s_mov_b32 m0, 30720
s_nop 0
buffer_load_dwordx4 v28, s[20:23], s56 offen lds
s_add_u32 s56, s55, 48384
s_mov_b32 m0, 31744
s_nop 0
buffer_load_dwordx4 v28, s[20:23], s56 offen lds
ds_read_b64_tr_b16 a[64:65], v44 offset:16384
ds_read_b64_tr_b16 a[66:67], v44 offset:17408
ds_read_b64_tr_b16 a[68:69], v46 offset:16384
ds_read_b64_tr_b16 a[70:71], v46 offset:17408
ds_read_b64_tr_b16 a[72:73], v45 offset:16384
ds_read_b64_tr_b16 a[74:75], v45 offset:17408
ds_read_b64_tr_b16 a[76:77], v47 offset:16384
ds_read_b64_tr_b16 a[78:79], v47 offset:17408
s_waitcnt lgkmcnt(0)
s_waitcnt vmcnt(24)
s_barrier
s_add_u32 s56, s55, 37120
s_mov_b32 m0, 32768
s_nop 0
buffer_load_dwordx4 v28, s[20:23], s56 offen lds
s_add_u32 s56, s55, 39424
s_mov_b32 m0, 33792
s_nop 0
buffer_load_dwordx4 v28, s[20:23], s56 offen lds
s_add_u32 s56, s55, 46336
s_mov_b32 m0, 34816
s_nop 0
buffer_load_dwordx4 v28, s[20:23], s56 offen lds
s_add_u32 s56, s55, 48640
s_mov_b32 m0, 35840
s_nop 0
buffer_load_dwordx4 v28, s[20:23], s56 offen lds
ds_read_b64_tr_b16 a[80:81], v44 offset:20480
ds_read_b64_tr_b16 a[82:83], v44 offset:21504
ds_read_b64_tr_b16 a[84:85], v46 offset:20480
ds_read_b64_tr_b16 a[86:87], v46 offset:21504
ds_read_b64_tr_b16 a[88:89], v45 offset:20480
ds_read_b64_tr_b16 a[90:91], v45 offset:21504
ds_read_b64_tr_b16 a[92:93], v47 offset:20480
ds_read_b64_tr_b16 a[94:95], v47 offset:21504
s_waitcnt lgkmcnt(0)
s_waitcnt vmcnt(24)
s_barrier
s_add_u32 s56, s55, 37376
s_mov_b32 m0, 36864
s_nop 0
buffer_load_dwordx4 v28, s[20:23], s56 offen lds
s_add_u32 s56, s55, 39680
s_mov_b32 m0, 37888
s_nop 0
buffer_load_dwordx4 v28, s[20:23], s56 offen lds
s_add_u32 s56, s55, 46592
s_mov_b32 m0, 38912
s_nop 0
buffer_load_dwordx4 v28, s[20:23], s56 offen lds
s_add_u32 s56, s55, 48896
s_mov_b32 m0, 39936
s_nop 0
buffer_load_dwordx4 v28, s[20:23], s56 offen lds
ds_read_b64_tr_b16 a[96:97], v44 offset:24576
ds_read_b64_tr_b16 a[98:99], v44 offset:25600
ds_read_b64_tr_b16 a[100:101], v46 offset:24576
ds_read_b64_tr_b16 a[102:103], v46 offset:25600
ds_read_b64_tr_b16 a[104:105], v45 offset:24576
ds_read_b64_tr_b16 a[106:107], v45 offset:25600
ds_read_b64_tr_b16 a[108:109], v47 offset:24576
ds_read_b64_tr_b16 a[110:111], v47 offset:25600
s_waitcnt lgkmcnt(0)
s_waitcnt vmcnt(24)
s_barrier
s_add_u32 s56, s55, 37632
s_mov_b32 m0, 40960
s_nop 0
buffer_load_dwordx4 v28, s[20:23], s56 offen lds
s_add_u32 s56, s55, 39936
s_mov_b32 m0, 41984
s_nop 0
buffer_load_dwordx4 v28, s[20:23], s56 offen lds
s_add_u32 s56, s55, 46848
s_mov_b32 m0, 43008
s_nop 0
buffer_load_dwordx4 v28, s[20:23], s56 offen lds
s_add_u32 s56, s55, 49152
s_mov_b32 m0, 44032
s_nop 0
buffer_load_dwordx4 v28, s[20:23], s56 offen lds
ds_read_b64_tr_b16 a[112:113], v44 offset:28672
ds_read_b64_tr_b16 a[114:115], v44 offset:29696
ds_read_b64_tr_b16 a[116:117], v46 offset:28672
ds_read_b64_tr_b16 a[118:119], v46 offset:29696
ds_read_b64_tr_b16 a[120:121], v45 offset:28672
ds_read_b64_tr_b16 a[122:123], v45 offset:29696
ds_read_b64_tr_b16 a[124:125], v47 offset:28672
ds_read_b64_tr_b16 a[126:127], v47 offset:29696
s_waitcnt lgkmcnt(0)
s_waitcnt vmcnt(24)
s_barrier
s_add_u32 s56, s55, 768
s_mov_b32 m0, 45056
s_nop 0
buffer_load_dwordx4 v28, s[20:23], s56 offen lds
s_add_u32 s56, s55, 3072
s_mov_b32 m0, 46080
s_nop 0
buffer_load_dwordx4 v28, s[20:23], s56 offen lds
s_add_u32 s56, s55, 9984
s_mov_b32 m0, 47104
s_nop 0
buffer_load_dwordx4 v28, s[20:23], s56 offen lds
s_add_u32 s56, s55, 12288
s_mov_b32 m0, 48128
s_nop 0
buffer_load_dwordx4 v28, s[20:23], s56 offen lds
ds_read_b64_tr_b16 a[128:129], v44 offset:0
ds_read_b64_tr_b16 a[130:131], v44 offset:1024
ds_read_b64_tr_b16 a[132:133], v46 offset:0
ds_read_b64_tr_b16 a[134:135], v46 offset:1024
ds_read_b64_tr_b16 a[136:137], v45 offset:0
ds_read_b64_tr_b16 a[138:139], v45 offset:1024
ds_read_b64_tr_b16 a[140:141], v47 offset:0
ds_read_b64_tr_b16 a[142:143], v47 offset:1024
buffer_load_dword v32, v24, s[28:31], 0 offen sc0 sc1
s_waitcnt lgkmcnt(0)
s_waitcnt vmcnt(25)
s_barrier
s_add_u32 s56, s54, 0
s_mov_b32 m0, 16384
s_nop 0
buffer_load_dwordx4 v26, s[8:11], s56 offen lds
s_add_u32 s56, s54, 16384
s_mov_b32 m0, 17408
s_nop 0
buffer_load_dwordx4 v26, s[8:11], s56 offen lds
s_add_u32 s56, s54, 32768
s_mov_b32 m0, 18432
s_nop 0
buffer_load_dwordx4 v27, s[8:11], s56 offen lds
s_add_u32 s56, s54, 49152
s_mov_b32 m0, 19456
s_nop 0
buffer_load_dwordx4 v27, s[8:11], s56 offen lds
ds_read_b64_tr_b16 a[144:145], v44 offset:4096
ds_read_b64_tr_b16 a[146:147], v44 offset:5120
ds_read_b64_tr_b16 a[148:149], v46 offset:4096
ds_read_b64_tr_b16 a[150:151], v46 offset:5120
ds_read_b64_tr_b16 a[152:153], v45 offset:4096
ds_read_b64_tr_b16 a[154:155], v45 offset:5120
ds_read_b64_tr_b16 a[156:157], v47 offset:4096
ds_read_b64_tr_b16 a[158:159], v47 offset:5120
s_waitcnt lgkmcnt(0)
s_waitcnt vmcnt(25)
s_barrier
s_add_u32 s56, s54, 1572864
s_mov_b32 m0, 20480
s_nop 0
buffer_load_dwordx4 v26, s[8:11], s56 offen lds
s_add_u32 s56, s54, 1589248
s_mov_b32 m0, 21504
s_nop 0
buffer_load_dwordx4 v26, s[8:11], s56 offen lds
s_add_u32 s56, s54, 1605632
s_mov_b32 m0, 22528
s_nop 0
buffer_load_dwordx4 v27, s[8:11], s56 offen lds
s_add_u32 s56, s54, 1622016
s_mov_b32 m0, 23552
s_nop 0
buffer_load_dwordx4 v27, s[8:11], s56 offen lds
ds_read_b64_tr_b16 a[160:161], v44 offset:8192
ds_read_b64_tr_b16 a[162:163], v44 offset:9216
ds_read_b64_tr_b16 a[164:165], v46 offset:8192
ds_read_b64_tr_b16 a[166:167], v46 offset:9216
ds_read_b64_tr_b16 a[168:169], v45 offset:8192
ds_read_b64_tr_b16 a[170:171], v45 offset:9216
ds_read_b64_tr_b16 a[172:173], v47 offset:8192
ds_read_b64_tr_b16 a[174:175], v47 offset:9216
s_waitcnt lgkmcnt(0)
s_waitcnt vmcnt(25)
s_barrier
s_add_u32 s56, s54, 2097152
s_mov_b32 m0, 24576
s_nop 0
buffer_load_dwordx4 v26, s[8:11], s56 offen lds
s_add_u32 s56, s54, 2113536
s_mov_b32 m0, 25600
s_nop 0
buffer_load_dwordx4 v26, s[8:11], s56 offen lds
s_add_u32 s56, s54, 2129920
s_mov_b32 m0, 26624
s_nop 0
buffer_load_dwordx4 v27, s[8:11], s56 offen lds
s_add_u32 s56, s54, 2146304
s_mov_b32 m0, 27648
s_nop 0
buffer_load_dwordx4 v27, s[8:11], s56 offen lds
ds_read_b64_tr_b16 a[176:177], v48 offset:12288
ds_read_b64_tr_b16 a[178:179], v48 offset:13312
ds_read_b64_tr_b16 a[180:181], v48 offset:14336
ds_read_b64_tr_b16 a[182:183], v48 offset:15360
ds_read_b64_tr_b16 a[192:193], v49 offset:12288
ds_read_b64_tr_b16 a[194:195], v49 offset:13312
ds_read_b64_tr_b16 a[196:197], v49 offset:14336
ds_read_b64_tr_b16 a[198:199], v49 offset:15360
s_waitcnt lgkmcnt(0)
s_waitcnt vmcnt(25)
s_barrier
s_add_u32 s56, s54, 2621440
s_mov_b32 m0, 28672
s_nop 0
buffer_load_dwordx4 v26, s[12:15], s56 offen lds
s_add_u32 s56, s54, 2637824
s_mov_b32 m0, 29696
s_nop 0
buffer_load_dwordx4 v26, s[12:15], s56 offen lds
s_add_u32 s56, s54, 2654208
s_mov_b32 m0, 30720
s_nop 0
buffer_load_dwordx4 v27, s[12:15], s56 offen lds
s_add_u32 s56, s54, 2670592
s_mov_b32 m0, 31744
s_nop 0
buffer_load_dwordx4 v27, s[12:15], s56 offen lds
ds_read_b64_tr_b16 a[184:185], v48 offset:16384
ds_read_b64_tr_b16 a[186:187], v48 offset:17408
ds_read_b64_tr_b16 a[188:189], v48 offset:18432
ds_read_b64_tr_b16 a[190:191], v48 offset:19456
ds_read_b64_tr_b16 a[200:201], v49 offset:16384
ds_read_b64_tr_b16 a[202:203], v49 offset:17408
ds_read_b64_tr_b16 a[204:205], v49 offset:18432
ds_read_b64_tr_b16 a[206:207], v49 offset:19456
s_waitcnt lgkmcnt(0)
s_waitcnt vmcnt(25)
s_barrier
s_add_u32 s56, s54, 4194304
s_mov_b32 m0, 32768
s_nop 0
buffer_load_dwordx4 v26, s[16:19], s56 offen lds
s_add_u32 s56, s54, 4210688
s_mov_b32 m0, 33792
s_nop 0
buffer_load_dwordx4 v26, s[16:19], s56 offen lds
s_add_u32 s56, s54, 4227072
s_mov_b32 m0, 34816
s_nop 0
buffer_load_dwordx4 v27, s[16:19], s56 offen lds
s_add_u32 s56, s54, 4243456
s_mov_b32 m0, 35840
s_nop 0
buffer_load_dwordx4 v27, s[16:19], s56 offen lds
ds_read_b64_tr_b16 a[208:209], v48 offset:20480
ds_read_b64_tr_b16 a[210:211], v48 offset:21504
ds_read_b64_tr_b16 a[212:213], v48 offset:22528
ds_read_b64_tr_b16 a[214:215], v48 offset:23552
ds_read_b64_tr_b16 a[216:217], v49 offset:20480
ds_read_b64_tr_b16 a[218:219], v49 offset:21504
ds_read_b64_tr_b16 a[220:221], v49 offset:22528
ds_read_b64_tr_b16 a[222:223], v49 offset:23552
s_waitcnt lgkmcnt(0)
s_waitcnt vmcnt(25)
s_barrier
s_add_u32 s56, s55, 0
s_mov_b32 m0, 36864
s_nop 0
buffer_load_dwordx4 v28, s[20:23], s56 offen lds
s_add_u32 s56, s55, 2304
s_mov_b32 m0, 37888
s_nop 0
buffer_load_dwordx4 v28, s[20:23], s56 offen lds
s_add_u32 s56, s55, 9216
s_mov_b32 m0, 38912
s_nop 0
buffer_load_dwordx4 v28, s[20:23], s56 offen lds
s_add_u32 s56, s55, 11520
s_mov_b32 m0, 39936
s_nop 0
buffer_load_dwordx4 v28, s[20:23], s56 offen lds
ds_read_b64_tr_b16 a[232:233], v48 offset:24576
ds_read_b64_tr_b16 a[234:235], v48 offset:25600
ds_read_b64_tr_b16 a[236:237], v48 offset:26624
ds_read_b64_tr_b16 a[238:239], v48 offset:27648
ds_read_b64_tr_b16 a[248:249], v49 offset:24576
ds_read_b64_tr_b16 a[250:251], v49 offset:25600
ds_read_b64_tr_b16 a[252:253], v49 offset:26624
ds_read_b64_tr_b16 a[254:255], v49 offset:27648
s_waitcnt lgkmcnt(0)
s_waitcnt vmcnt(25)
s_barrier
s_add_u32 s56, s55, 256
s_mov_b32 m0, 40960
s_nop 0
buffer_load_dwordx4 v28, s[20:23], s56 offen lds
s_add_u32 s56, s55, 2560
s_mov_b32 m0, 41984
s_nop 0
buffer_load_dwordx4 v28, s[20:23], s56 offen lds
s_add_u32 s56, s55, 9472
s_mov_b32 m0, 43008
s_nop 0
buffer_load_dwordx4 v28, s[20:23], s56 offen lds
s_add_u32 s56, s55, 11776
s_mov_b32 m0, 44032
s_nop 0
buffer_load_dwordx4 v28, s[20:23], s56 offen lds
ds_read_b64_tr_b16 a[224:225], v48 offset:28672
ds_read_b64_tr_b16 a[226:227], v48 offset:29696
ds_read_b64_tr_b16 a[228:229], v48 offset:30720
ds_read_b64_tr_b16 a[230:231], v48 offset:31744
ds_read_b64_tr_b16 a[240:241], v49 offset:28672
ds_read_b64_tr_b16 a[242:243], v49 offset:29696
ds_read_b64_tr_b16 a[244:245], v49 offset:30720
ds_read_b64_tr_b16 a[246:247], v49 offset:31744
s_waitcnt lgkmcnt(0)
s_waitcnt vmcnt(24)
s_barrier
s_add_u32 s56, s55, 512
s_mov_b32 m0, 45056
s_nop 0
buffer_load_dwordx4 v28, s[20:23], s56 offen lds
s_add_u32 s56, s55, 2816
s_mov_b32 m0, 46080
s_nop 0
buffer_load_dwordx4 v28, s[20:23], s56 offen lds
s_add_u32 s56, s55, 9728
s_mov_b32 m0, 47104
s_nop 0
buffer_load_dwordx4 v28, s[20:23], s56 offen lds
s_add_u32 s56, s55, 12032
s_mov_b32 m0, 48128
s_nop 0
buffer_load_dwordx4 v28, s[20:23], s56 offen lds
ds_read_b64_tr_b16 v[60:61], v44 offset:0
ds_read_b64_tr_b16 v[62:63], v44 offset:1024
ds_read_b64_tr_b16 v[64:65], v46 offset:0
ds_read_b64_tr_b16 v[66:67], v46 offset:1024
ds_read_b64_tr_b16 v[68:69], v45 offset:0
ds_read_b64_tr_b16 v[70:71], v45 offset:1024
ds_read_b64_tr_b16 v[72:73], v47 offset:0
ds_read_b64_tr_b16 v[74:75], v47 offset:1024
s_waitcnt lgkmcnt(0)
s_waitcnt vmcnt(24)
s_barrier
ds_write_b128 v2, v[60:63] offset:0
ds_write_b128 v2, v[64:67] offset:1024
ds_write_b128 v2, v[68:71] offset:2048
ds_write_b128 v2, v[72:75] offset:3072
ds_read_b64_tr_b16 v[60:61], v44 offset:4096
ds_read_b64_tr_b16 v[62:63], v44 offset:5120
ds_read_b64_tr_b16 v[64:65], v46 offset:4096
ds_read_b64_tr_b16 v[66:67], v46 offset:5120
ds_read_b64_tr_b16 v[68:69], v45 offset:4096
ds_read_b64_tr_b16 v[70:71], v45 offset:5120
ds_read_b64_tr_b16 v[72:73], v47 offset:4096
ds_read_b64_tr_b16 v[74:75], v47 offset:5120
L_rdv_w0:
v_readfirstlane_b32 s38, v32
s_nop 0
s_and_b32 s57, s38, 0xff
s_cmp_lg_u32 s57, 32
s_cbranch_scc1 L_rdv2_w0
L_kvw_w0p:
s_load_dwordx16 s[64:79], s[4:5], s101 glc
s_sub_u32 s41, s41, 1
s_cbranch_scc1 L_exit
s_waitcnt lgkmcnt(0)
s_min_u32 s64, s64, s65
s_min_u32 s64, s64, s66
s_min_u32 s64, s64, s67
s_min_u32 s64, s64, s68
s_min_u32 s64, s64, s69
s_min_u32 s64, s64, s70
s_min_u32 s64, s64, s71
s_min_u32 s64, s64, s72
s_min_u32 s64, s64, s73
s_min_u32 s64, s64, s74
s_min_u32 s64, s64, s75
s_min_u32 s64, s64, s76
s_min_u32 s64, s64, s77
s_min_u32 s64, s64, s78
s_min_u32 s64, s64, s79
s_lshl_b32 s100, s64, 2
s_sub_u32 s100, s100, 1
s_cmp_ge_i32 s34, s100
s_cbranch_scc1 L_kvw_w0p
s_waitcnt lgkmcnt(0)
s_waitcnt vmcnt(20)
s_barrier
ds_write_b128 v2, v[60:63] offset:4096
ds_write_b128 v2, v[64:67] offset:5120
ds_write_b128 v2, v[68:71] offset:6144
ds_write_b128 v2, v[72:75] offset:7168
ds_read_b64_tr_b16 v[60:61], v44 offset:8192
ds_read_b64_tr_b16 v[62:63], v44 offset:9216
ds_read_b64_tr_b16 v[64:65], v46 offset:8192
ds_read_b64_tr_b16 v[66:67], v46 offset:9216
ds_read_b64_tr_b16 v[68:69], v45 offset:8192
ds_read_b64_tr_b16 v[70:71], v45 offset:9216
ds_read_b64_tr_b16 v[72:73], v47 offset:8192
ds_read_b64_tr_b16 v[74:75], v47 offset:9216
buffer_load_dwordx4 v[12:15], v9, s[4:7], s37 offen offset:0
buffer_load_dwordx4 v[16:19], v9, s[4:7], s37 offen offset:1024
buffer_load_dwordx4 v[52:55], v1, s[4:7], s37 offen offset:2048
buffer_load_dwordx4 v[56:59], v1, s[4:7], s37 offen offset:3072
s_mov_b32 m0, 1024
s_nop 0
buffer_load_dwordx4 v1, s[4:7], s47 offen offset:0 sc0 sc1 lds
s_waitcnt lgkmcnt(0)
s_waitcnt vmcnt(21)
s_barrier
ds_write_b128 v2, v[60:63] offset:8192
ds_write_b128 v2, v[64:67] offset:9216
ds_write_b128 v2, v[68:71] offset:10240
ds_write_b128 v2, v[72:75] offset:11264
ds_read_b64_tr_b16 v[60:61], v44 offset:12288
ds_read_b64_tr_b16 v[62:63], v44 offset:13312
ds_read_b64_tr_b16 v[64:65], v46 offset:12288
ds_read_b64_tr_b16 v[66:67], v46 offset:13312
ds_read_b64_tr_b16 v[68:69], v45 offset:12288
ds_read_b64_tr_b16 v[70:71], v45 offset:13312
ds_read_b64_tr_b16 v[72:73], v47 offset:12288
ds_read_b64_tr_b16 v[74:75], v47 offset:13312
s_waitcnt lgkmcnt(0)
s_waitcnt vmcnt(17)
s_barrier
ds_write_b128 v2, v[60:63] offset:12288
ds_write_b128 v2, v[64:67] offset:13312
ds_write_b128 v2, v[68:71] offset:14336
ds_write_b128 v2, v[72:75] offset:15360
ds_read_b64_tr_b16 v[60:61], v44 offset:16384
ds_read_b64_tr_b16 v[62:63], v44 offset:17408
ds_read_b64_tr_b16 v[64:65], v46 offset:16384
ds_read_b64_tr_b16 v[66:67], v46 offset:17408
ds_read_b64_tr_b16 v[68:69], v45 offset:16384
ds_read_b64_tr_b16 v[70:71], v45 offset:17408
ds_read_b64_tr_b16 v[72:73], v47 offset:16384
ds_read_b64_tr_b16 v[74:75], v47 offset:17408
s_waitcnt lgkmcnt(0)
s_waitcnt vmcnt(13)
s_barrier
ds_write_b128 v2, v[60:63] offset:16384
ds_write_b128 v2, v[64:67] offset:17408
ds_write_b128 v2, v[68:71] offset:18432
ds_write_b128 v2, v[72:75] offset:19456
ds_read_b64_tr_b16 v[60:61], v48 offset:20480
ds_read_b64_tr_b16 v[62:63], v48 offset:21504
ds_read_b64_tr_b16 v[64:65], v48 offset:22528
ds_read_b64_tr_b16 v[66:67], v48 offset:23552
ds_read_b64_tr_b16 v[68:69], v49 offset:20480
ds_read_b64_tr_b16 v[70:71], v49 offset:21504
ds_read_b64_tr_b16 v[72:73], v49 offset:22528
ds_read_b64_tr_b16 v[74:75], v49 offset:23552
s_waitcnt lgkmcnt(0)
s_waitcnt vmcnt(9)
s_barrier
ds_write_b128 v2, v[60:63] offset:20480
ds_write_b128 v2, v[64:67] offset:21504
ds_write_b128 v2, v[68:71] offset:22528
ds_write_b128 v2, v[72:75] offset:23552
ds_read_b64_tr_b16 v[60:61], v48 offset:24576
ds_read_b64_tr_b16 v[62:63], v48 offset:25600
ds_read_b64_tr_b16 v[64:65], v48 offset:26624
ds_read_b64_tr_b16 v[66:67], v48 offset:27648
ds_read_b64_tr_b16 v[68:69], v49 offset:24576
ds_read_b64_tr_b16 v[70:71], v49 offset:25600
ds_read_b64_tr_b16 v[72:73], v49 offset:26624
ds_read_b64_tr_b16 v[74:75], v49 offset:27648
s_waitcnt lgkmcnt(0)
s_waitcnt vmcnt(5)
s_barrier
ds_write_b128 v2, v[60:63] offset:24576
ds_write_b128 v2, v[64:67] offset:25600
ds_write_b128 v2, v[68:71] offset:26624
ds_write_b128 v2, v[72:75] offset:27648
ds_read_b64_tr_b16 v[60:61], v48 offset:28672
ds_read_b64_tr_b16 v[62:63], v48 offset:29696
ds_read_b64_tr_b16 v[64:65], v48 offset:30720
ds_read_b64_tr_b16 v[66:67], v48 offset:31744
ds_read_b64_tr_b16 v[68:69], v49 offset:28672
ds_read_b64_tr_b16 v[70:71], v49 offset:29696
ds_read_b64_tr_b16 v[72:73], v49 offset:30720
ds_read_b64_tr_b16 v[74:75], v49 offset:31744
s_waitcnt lgkmcnt(0)
s_barrier
ds_write_b128 v2, v[60:63] offset:28672
ds_write_b128 v2, v[64:67] offset:29696
ds_write_b128 v2, v[68:71] offset:30720
ds_write_b128 v2, v[72:75] offset:31744
s_lshl_b32 s57, s58, 5
s_mov_b32 s0, 0x3f003f00
s_mov_b32 s1, 0x3f003f00
s_mov_b32 s58, 304128
s_cmp_eq_u32 s38, s57
s_mov_b32 s56, 0x33333333
s_mov_b32 s57, 0x33333333
s_mov_b32 s2, 0x21800000
s_mov_b32 s55, -24
s_cbranch_scc0 L_slow_w0
v_mov_b64 v[20:21], 0
v_mov_b64 v[22:23], 0
v_mov_b64 v[24:25], 0
v_mov_b64 v[26:27], 0
v_mov_b64 v[28:29], 0
v_mov_b64 v[30:31], 0
v_mov_b64 v[32:33], 0
v_mov_b64 v[34:35], 0
v_mov_b64 v[36:37], 0
v_mov_b64 v[38:39], 0
v_mov_b64 v[40:41], 0
v_mov_b64 v[42:43], 0
ds_read_b128 v[44:47], v2 offset:0
ds_read_b128 v[48:51], v2 offset:1024
v_bfe_u32 v77, v1, 6, 1
v_lshl_add_u32 v77, v77, 3, v1
v_lshlrev_b32 v77, 1, v77
s_waitcnt vmcnt(0) lgkmcnt(0)
s_branch L_top_w0f
L_done_w0f:
s_waitcnt vmcnt(0) lgkmcnt(0)
s_endpgm
L_rdv2_w0:
buffer_load_dword v32, v24, s[28:31], 0 offen sc0 sc1
s_sub_u32 s41, s41, 1
s_cbranch_scc1 L_exit
s_waitcnt vmcnt(0)
s_branch L_rdv_w0
L_ra0_w0f:
s_mov_b32 m0, 1024
s_nop 0
buffer_load_dwordx4 v1, s[4:7], s47 offen offset:0 sc1 lds
buffer_load_dwordx4 v1, s[4:7], s47 offen offset:1024 sc1 lds
buffer_load_dwordx4 v1, s[4:7], s47 offen offset:2048 sc1 lds
buffer_load_dwordx4 v1, s[4:7], s47 offen offset:3072 sc1 lds
s_sub_u32 s41, s41, 1
s_cbranch_scc1 L_exit
ds_read_b128 v[44:47], v2 offset:0
ds_read_b128 v[48:51], v2 offset:1024
v_mov_b64 v[20:21], 0
v_mov_b64 v[22:23], 0
v_mov_b64 v[24:25], 0
v_mov_b64 v[26:27], 0
v_mov_b64 v[28:29], 0
v_mov_b64 v[30:31], 0
v_mov_b64 v[32:33], 0
v_mov_b64 v[34:35], 0
v_mov_b64 v[36:37], 0
v_mov_b64 v[38:39], 0
v_mov_b64 v[40:41], 0
v_mov_b64 v[42:43], 0
s_waitcnt vmcnt(0)
ds_read_b128 v[60:63], v1 offset:1024
ds_read_b128 v[64:67], v1 offset:2048
ds_read_b128 v[68:71], v1 offset:3072
ds_read_b128 v[72:75], v1 offset:4096
s_branch L_s0_w0f
L_ra1_w0f:
s_waitcnt lgkmcnt(0)
s_barrier
s_mov_b32 m0, 5120
s_nop 0
buffer_load_dwordx4 v1, s[4:7], s48 offen offset:0 sc1 lds
s_mov_b32 m0, 9216
s_nop 0
buffer_load_dwordx4 v1, s[4:7], s49 offen offset:0 sc1 lds
s_sub_u32 s41, s41, 1
s_cbranch_scc1 L_exit
s_waitcnt vmcnt(0)
s_barrier
ds_read_b128 v[76:79], v1 offset:5120
ds_read_b128 v[60:63], v1 offset:6144
ds_read_b128 v[64:67], v1 offset:7168
ds_read_b128 v[68:71], v1 offset:8192
ds_read_b128 v[72:75], v1 offset:9216
s_waitcnt lgkmcnt(0)
v_bitop3_b32 v6, v76, v60, s35 bitop3:0x7e
v_bitop3_b32 v6, v6, v64, s35 bitop3:0xf6
v_bitop3_b32 v6, v6, v68, s35 bitop3:0xf6
v_bitop3_b32 v6, v6, v72, s35 bitop3:0xf6
v_and_b32 v6, 1, v6
v_cmp_ne_u32 vcc, 0, v6
s_mov_b32 m0, 0
v_lshlrev_b32 v6, 3, v1
s_cbranch_vccnz L_ra1_w0f
s_branch L_a1_w0f
L_mx_w0f:
s_waitcnt lgkmcnt(0)
v_max3_f32 v30, v12, v13, v28
v_max_f32 v30, v30, v29
v_mov_b32 v31, v30
s_nop 1
v_permlane16_swap_b32 v30, v31
v_max_f32 v30, v30, v31
v_mov_b32 v31, v30
s_nop 1
v_permlane32_swap_b32 v30, v31
v_max_f32 v30, v30, v31
ds_write_b32 v1, v30 offset:10240
s_waitcnt lgkmcnt(0)
s_barrier
ds_read_b128 v[32:35], v1 offset:10240
s_waitcnt lgkmcnt(0)
v_max3_f32 v32, v32, v33, v34
v_max_f32 v32, v32, v35
v_sub_f32 v14, v12, v32
v_sub_f32 v15, v13, v32
v_sub_f32 v30, v28, v32
v_sub_f32 v31, v29, v32
v_exp_f32 v14, v14
v_exp_f32 v15, v15
v_exp_f32 v30, v30
v_exp_f32 v31, v31
v_cvt_pk_bf16_f32 v14, v14, v15
v_cvt_pk_bf16_f32 v30, v30, v31
ds_write_b32 v5, v14 offset:14368
v_cndmask_b32_e64 v24, 0, v30, s[56:57]
v_cndmask_b32_e64 v25, 0, v30, s[56:57]
v_mov_b64 v[76:77], s[52:53]
v_mov_b64 v[78:79], s[52:53]
v_mov_b32_dpp v26, v24 quad_perm:[2,3,0,1] row_mask:0xf bank_mask:0xf
v_mov_b32_dpp v27, v24 quad_perm:[2,3,0,1] row_mask:0xf bank_mask:0xf
s_waitcnt lgkmcnt(0)
s_barrier
v_mov_b64 v[14:15], s[0:1]
ds_read_b128 v[16:19], v1 offset:14368
ds_read_b128 v[40:43], v1 offset:14336
s_waitcnt lgkmcnt(0)
v_mfma_f32_16x16x32_bf16 v[32:35], v[76:79], v[16:19], 0
v_mfma_f32_16x16x32_bf16 v[20:23], v[52:55], v[16:19], 0
v_mfma_f32_16x16x32_bf16 v[20:23], v[56:59], v[40:43], v[20:23]
v_mfma_f32_16x16x16_bf16 v[32:35], v[14:15], v[24:25], v[32:35]
v_mfma_f32_16x16x32_bf16 v[20:23], v[36:39], v[24:27], v[20:23]
s_nop 3
v_rcp_f32 v33, v32
s_nop 2
v_mul_f32_dpp v20, v33, v20 quad_perm:[0,1,0,1] row_mask:0xf bank_mask:0xf
v_mul_f32_dpp v21, v33, v21 quad_perm:[0,1,0,1] row_mask:0xf bank_mask:0xf
v_mul_f32_dpp v22, v33, v22 quad_perm:[0,1,0,1] row_mask:0xf bank_mask:0xf
v_mul_f32_dpp v23, v33, v23 quad_perm:[0,1,0,1] row_mask:0xf bank_mask:0xf
v_cvt_pk_bf16_f32 v20, v20, v21
v_cvt_pk_bf16_f32 v21, v22, v23
ds_write_b64 v6, v[20:21] offset:5120
ds_read_b128 v[16:19], v7 offset:5120
v_mov_b64 v[76:77], 0
v_mov_b64 v[78:79], 0
v_mov_b64 v[40:41], 0
v_mov_b64 v[42:43], 0
v_mov_b64 v[24:25], 0
v_mov_b64 v[26:27], 0
v_mov_b64 v[32:33], 0
v_mov_b64 v[34:35], 0
s_waitcnt lgkmcnt(0)
s_branch L_mxb_w0f

L_ev_w0f:

L_kvw_w0f:
s_load_dwordx16 s[64:79], s[4:5], s101 glc
s_sub_u32 s41, s41, 1
s_cbranch_scc1 L_exit
s_waitcnt lgkmcnt(0)
s_min_u32 s64, s64, s65
s_min_u32 s64, s64, s66
s_min_u32 s64, s64, s67
s_min_u32 s64, s64, s68
s_min_u32 s64, s64, s69
s_min_u32 s64, s64, s70
s_min_u32 s64, s64, s71
s_min_u32 s64, s64, s72
s_min_u32 s64, s64, s73
s_min_u32 s64, s64, s74
s_min_u32 s64, s64, s75
s_min_u32 s64, s64, s76
s_min_u32 s64, s64, s77
s_min_u32 s64, s64, s78
s_min_u32 s64, s64, s79
s_lshl_b32 s100, s64, 2
s_sub_u32 s100, s100, 1
s_cmp_ge_i32 s34, s100
s_cbranch_scc1 L_kvw_w0f
s_branch L_evb_w0f
L_slow_w0:
v_mov_b64 v[20:21], 0
v_mov_b64 v[22:23], 0
v_mov_b64 v[24:25], 0
v_mov_b64 v[26:27], 0
v_mov_b64 v[28:29], 0
v_mov_b64 v[30:31], 0
v_mov_b64 v[32:33], 0
v_mov_b64 v[34:35], 0
v_mov_b64 v[36:37], 0
v_mov_b64 v[38:39], 0
v_mov_b64 v[40:41], 0
v_mov_b64 v[42:43], 0
ds_read_b128 v[44:47], v2 offset:0
ds_read_b128 v[48:51], v2 offset:1024
v_bfe_u32 v77, v1, 6, 1
v_lshl_add_u32 v77, v77, 3, v1
v_lshlrev_b32 v77, 1, v77
s_waitcnt vmcnt(0) lgkmcnt(0)
s_branch L_top_w0s
L_done_w0s:
s_waitcnt vmcnt(0) lgkmcnt(0)
s_endpgm
L_ra0_w0s:
s_mov_b32 m0, 1024
s_nop 0
buffer_load_dwordx4 v1, s[4:7], s47 offen offset:0 sc0 sc1 lds
buffer_load_dwordx4 v1, s[4:7], s47 offen offset:1024 sc0 sc1 lds
buffer_load_dwordx4 v1, s[4:7], s47 offen offset:2048 sc0 sc1 lds
buffer_load_dwordx4 v1, s[4:7], s47 offen offset:3072 sc0 sc1 lds
s_sub_u32 s41, s41, 1
s_cbranch_scc1 L_exit
ds_read_b128 v[44:47], v2 offset:0
ds_read_b128 v[48:51], v2 offset:1024
v_mov_b64 v[20:21], 0
v_mov_b64 v[22:23], 0
v_mov_b64 v[24:25], 0
v_mov_b64 v[26:27], 0
v_mov_b64 v[28:29], 0
v_mov_b64 v[30:31], 0
v_mov_b64 v[32:33], 0
v_mov_b64 v[34:35], 0
v_mov_b64 v[36:37], 0
v_mov_b64 v[38:39], 0
v_mov_b64 v[40:41], 0
v_mov_b64 v[42:43], 0
s_waitcnt vmcnt(0)
ds_read_b128 v[60:63], v1 offset:1024
ds_read_b128 v[64:67], v1 offset:2048
ds_read_b128 v[68:71], v1 offset:3072
ds_read_b128 v[72:75], v1 offset:4096
s_branch L_s0_w0s
L_ra1_w0s:
s_waitcnt lgkmcnt(0)
s_barrier
s_mov_b32 m0, 5120
s_nop 0
buffer_load_dwordx4 v1, s[4:7], s48 offen offset:0 sc0 sc1 lds
s_mov_b32 m0, 9216
s_nop 0
buffer_load_dwordx4 v1, s[4:7], s49 offen offset:0 sc0 sc1 lds
s_sub_u32 s41, s41, 1
s_cbranch_scc1 L_exit
s_waitcnt vmcnt(0)
s_barrier
ds_read_b128 v[76:79], v1 offset:5120
ds_read_b128 v[60:63], v1 offset:6144
ds_read_b128 v[64:67], v1 offset:7168
ds_read_b128 v[68:71], v1 offset:8192
ds_read_b128 v[72:75], v1 offset:9216
s_waitcnt lgkmcnt(0)
v_bitop3_b32 v6, v76, v60, s35 bitop3:0x7e
v_bitop3_b32 v6, v6, v64, s35 bitop3:0xf6
v_bitop3_b32 v6, v6, v68, s35 bitop3:0xf6
v_bitop3_b32 v6, v6, v72, s35 bitop3:0xf6
v_and_b32 v6, 1, v6
v_cmp_ne_u32 vcc, 0, v6
s_mov_b32 m0, 0
v_lshlrev_b32 v6, 3, v1
s_cbranch_vccnz L_ra1_w0s
s_branch L_a1_w0s
L_mx_w0s:
s_waitcnt lgkmcnt(0)
v_max3_f32 v30, v12, v13, v28
v_max_f32 v30, v30, v29
v_mov_b32 v31, v30
s_nop 1
v_permlane16_swap_b32 v30, v31
v_max_f32 v30, v30, v31
v_mov_b32 v31, v30
s_nop 1
v_permlane32_swap_b32 v30, v31
v_max_f32 v30, v30, v31
ds_write_b32 v1, v30 offset:10240
s_waitcnt lgkmcnt(0)
s_barrier
ds_read_b128 v[32:35], v1 offset:10240
s_waitcnt lgkmcnt(0)
v_max3_f32 v32, v32, v33, v34
v_max_f32 v32, v32, v35
v_sub_f32 v14, v12, v32
v_sub_f32 v15, v13, v32
v_sub_f32 v30, v28, v32
v_sub_f32 v31, v29, v32
v_exp_f32 v14, v14
v_exp_f32 v15, v15
v_exp_f32 v30, v30
v_exp_f32 v31, v31
v_cvt_pk_bf16_f32 v14, v14, v15
v_cvt_pk_bf16_f32 v30, v30, v31
ds_write_b32 v5, v14 offset:14368
v_cndmask_b32_e64 v24, 0, v30, s[56:57]
v_cndmask_b32_e64 v25, 0, v30, s[56:57]
v_mov_b64 v[76:77], s[52:53]
v_mov_b64 v[78:79], s[52:53]
v_mov_b32_dpp v26, v24 quad_perm:[2,3,0,1] row_mask:0xf bank_mask:0xf
v_mov_b32_dpp v27, v24 quad_perm:[2,3,0,1] row_mask:0xf bank_mask:0xf
s_waitcnt lgkmcnt(0)
s_barrier
v_mov_b64 v[14:15], s[0:1]
ds_read_b128 v[16:19], v1 offset:14368
ds_read_b128 v[40:43], v1 offset:14336
s_waitcnt lgkmcnt(0)
v_mfma_f32_16x16x32_bf16 v[32:35], v[76:79], v[16:19], 0
v_mfma_f32_16x16x32_bf16 v[20:23], v[52:55], v[16:19], 0
v_mfma_f32_16x16x32_bf16 v[20:23], v[56:59], v[40:43], v[20:23]
v_mfma_f32_16x16x16_bf16 v[32:35], v[14:15], v[24:25], v[32:35]
v_mfma_f32_16x16x32_bf16 v[20:23], v[36:39], v[24:27], v[20:23]
s_nop 3
v_rcp_f32 v33, v32
s_nop 2
v_mul_f32_dpp v20, v33, v20 quad_perm:[0,1,0,1] row_mask:0xf bank_mask:0xf
v_mul_f32_dpp v21, v33, v21 quad_perm:[0,1,0,1] row_mask:0xf bank_mask:0xf
v_mul_f32_dpp v22, v33, v22 quad_perm:[0,1,0,1] row_mask:0xf bank_mask:0xf
v_mul_f32_dpp v23, v33, v23 quad_perm:[0,1,0,1] row_mask:0xf bank_mask:0xf
v_cvt_pk_bf16_f32 v20, v20, v21
v_cvt_pk_bf16_f32 v21, v22, v23
ds_write_b64 v6, v[20:21] offset:5120
ds_read_b128 v[16:19], v7 offset:5120
v_mov_b64 v[76:77], 0
v_mov_b64 v[78:79], 0
v_mov_b64 v[40:41], 0
v_mov_b64 v[42:43], 0
v_mov_b64 v[24:25], 0
v_mov_b64 v[26:27], 0
v_mov_b64 v[32:33], 0
v_mov_b64 v[34:35], 0
s_waitcnt lgkmcnt(0)
s_branch L_mxb_w0s

L_ev_w0s:

L_kvw_w0s:
s_load_dwordx16 s[64:79], s[4:5], s101 glc
s_sub_u32 s41, s41, 1
s_cbranch_scc1 L_exit
s_waitcnt lgkmcnt(0)
s_min_u32 s64, s64, s65
s_min_u32 s64, s64, s66
s_min_u32 s64, s64, s67
s_min_u32 s64, s64, s68
s_min_u32 s64, s64, s69
s_min_u32 s64, s64, s70
s_min_u32 s64, s64, s71
s_min_u32 s64, s64, s72
s_min_u32 s64, s64, s73
s_min_u32 s64, s64, s74
s_min_u32 s64, s64, s75
s_min_u32 s64, s64, s76
s_min_u32 s64, s64, s77
s_min_u32 s64, s64, s78
s_min_u32 s64, s64, s79
s_lshl_b32 s100, s64, 2
s_sub_u32 s100, s100, 1
s_cmp_ge_i32 s34, s100
s_cbranch_scc1 L_kvw_w0s
s_branch L_evb_w0s
L_pro_w1:
v_and_b32 v20, 63, v0
v_and_b32 v21, 15, v0
v_bfe_u32 v22, v0, 4, 2
v_lshlrev_b32 v1, 4, v20
v_add_u32 v2, 57344, v1
v_lshrrev_b32 v24, 1, v22
v_and_b32 v23, 1, v22
v_lshl_add_u32 v23, v24, 3, v23
v_lshlrev_b32 v23, 13, v23
v_lshlrev_b32 v26, 1, v22
v_xor_b32 v26, v26, v21
v_lshl_add_u32 v26, v26, 4, v23
v_xor_b32 v27, 128, v26
v_and_b32 v23, 1, v22
v_lshl_add_u32 v23, v24, 4, v23
v_mul_u32_u24 v23, 1152, v23
v_lshlrev_b32 v28, 2, v22
v_xor_b32 v28, v28, v21
v_lshl_add_u32 v28, v28, 4, v23
s_lshl_b32 s54, s32, 8
s_mul_i32 s55, s32, 147456
s_waitcnt lgkmcnt(0)
s_add_u32 s56, s54, 655360
s_mov_b32 m0, 77824
s_nop 0
buffer_load_dwordx4 v26, s[8:11], s56 offen lds
s_add_u32 s56, s54, 671744
s_mov_b32 m0, 78848
s_nop 0
buffer_load_dwordx4 v26, s[8:11], s56 offen lds
s_add_u32 s56, s54, 688128
s_mov_b32 m0, 79872
s_nop 0
buffer_load_dwordx4 v27, s[8:11], s56 offen lds
s_add_u32 s56, s54, 704512
s_mov_b32 m0, 80896
s_nop 0
buffer_load_dwordx4 v27, s[8:11], s56 offen lds
s_add_u32 s56, s54, 1179648
s_mov_b32 m0, 81920
s_nop 0
buffer_load_dwordx4 v26, s[8:11], s56 offen lds
s_add_u32 s56, s54, 1196032
s_mov_b32 m0, 82944
s_nop 0
buffer_load_dwordx4 v26, s[8:11], s56 offen lds
s_add_u32 s56, s54, 1212416
s_mov_b32 m0, 83968
s_nop 0
buffer_load_dwordx4 v27, s[8:11], s56 offen lds
s_add_u32 s56, s54, 1228800
s_mov_b32 m0, 84992
s_nop 0
buffer_load_dwordx4 v27, s[8:11], s56 offen lds
v_and_b32 v23, 1, v22
v_lshrrev_b32 v24, 2, v21
v_lshl_add_u32 v23, v23, 2, v24
v_lshlrev_b32 v23, 1, v23
v_bfe_u32 v44, v21, 1, 1
v_add_u32 v44, 4, v44
v_xor_b32 v44, v44, v23
v_lshlrev_b32 v44, 4, v44
v_lshl_add_u32 v44, v24, 8, v44
v_and_b32 v23, 1, v22
v_lshl_add_u32 v44, v23, 11, v44
v_and_b32 v23, 1, v21
v_lshl_add_u32 v44, v23, 3, v44
v_lshrrev_b32 v23, 1, v22
v_mul_u32_u24 v23, 40960, v23
v_add_u32 v23, 16384, v23
v_add_u32 v44, v44, v23
v_and_b32 v23, 1, v22
v_lshrrev_b32 v24, 2, v21
v_lshl_add_u32 v23, v23, 2, v24
v_lshlrev_b32 v23, 1, v23
v_bfe_u32 v45, v21, 1, 1
v_add_u32 v45, 6, v45
v_xor_b32 v45, v45, v23
v_lshlrev_b32 v45, 4, v45
v_lshl_add_u32 v45, v24, 8, v45
v_and_b32 v23, 1, v22
v_lshl_add_u32 v45, v23, 11, v45
v_and_b32 v23, 1, v21
v_lshl_add_u32 v45, v23, 3, v45
v_lshrrev_b32 v23, 1, v22
v_mul_u32_u24 v23, 40960, v23
v_add_u32 v23, 16384, v23
v_add_u32 v45, v45, v23
v_and_b32 v23, 1, v22
v_lshrrev_b32 v24, 2, v21
v_lshl_add_u32 v23, v23, 2, v24
v_lshlrev_b32 v23, 1, v23
v_bfe_u32 v46, v21, 1, 1
v_add_u32 v46, 4, v46
v_xor_b32 v46, v46, v23
v_lshlrev_b32 v46, 4, v46
v_lshl_add_u32 v46, v24, 8, v46
v_and_b32 v23, 1, v22
v_lshl_add_u32 v46, v23, 11, v46
v_and_b32 v23, 1, v21
v_lshl_add_u32 v46, v23, 3, v46
v_lshrrev_b32 v23, 1, v22
v_mul_u32_u24 v23, 32768, v23
v_add_u32 v23, 98304, v23
v_add_u32 v46, v46, v23
v_and_b32 v23, 1, v22
v_lshrrev_b32 v24, 2, v21
v_lshl_add_u32 v23, v23, 2, v24
v_lshlrev_b32 v23, 1, v23
v_bfe_u32 v47, v21, 1, 1
v_add_u32 v47, 6, v47
v_xor_b32 v47, v47, v23
v_lshlrev_b32 v47, 4, v47
v_lshl_add_u32 v47, v24, 8, v47
v_and_b32 v23, 1, v22
v_lshl_add_u32 v47, v23, 11, v47
v_and_b32 v23, 1, v21
v_lshl_add_u32 v47, v23, 3, v47
v_lshrrev_b32 v23, 1, v22
v_mul_u32_u24 v23, 32768, v23
v_add_u32 v23, 98304, v23
v_add_u32 v47, v47, v23
v_and_b32 v23, 1, v22
v_bfe_u32 v24, v21, 2, 1
v_lshl_add_u32 v23, v23, 1, v24
v_xor_b32 v24, 1, v23
v_lshlrev_b32 v24, 6, v24
v_lshl_add_u32 v48, v23, 8, v24
v_and_b32 v23, 3, v21
v_lshl_add_u32 v48, v23, 4, v48
v_and_b32 v23, 8, v21
v_add_u32 v48, v48, v23
v_lshrrev_b32 v23, 1, v22
v_mul_u32_u24 v23, 40960, v23
v_add_u32 v23, 16384, v23
v_add_u32 v48, v48, v23
v_and_b32 v23, 1, v22
v_bfe_u32 v24, v21, 2, 1
v_lshl_add_u32 v23, v23, 1, v24
v_xor_b32 v24, 1, v23
v_lshlrev_b32 v24, 6, v24
v_lshl_add_u32 v49, v23, 8, v24
v_and_b32 v23, 3, v21
v_lshl_add_u32 v49, v23, 4, v49
v_and_b32 v23, 8, v21
v_add_u32 v49, v49, v23
v_lshrrev_b32 v23, 1, v22
v_mul_u32_u24 v23, 32768, v23
v_add_u32 v23, 98304, v23
v_add_u32 v49, v49, v23
v_bfe_u32 v23, v21, 1, 1
v_and_b32 v24, 1, v21
v_lshl_add_u32 v23, v24, 16, v23
v_mul_u32_u24 v23, 0xaaaa, v23
v_add_u32 v0, 0x44444444, v23
v_lshlrev_b32 v3, 3, v20
v_lshrrev_b32 v25, 5, v20
v_lshlrev_b32 v25, 6, v25
v_xor_b32 v3, v3, v25
v_lshrrev_b32 v25, 2, v20
v_and_b32 v4, 3, v21
v_lshl_add_u32 v4, v4, 4, v25
v_lshlrev_b32 v4, 3, v4
v_bfe_u32 v25, v21, 1, 1
v_lshlrev_b32 v23, 6, v25
v_xor_b32 v4, v4, v23
v_lshlrev_b32 v5, 4, v21
v_lshl_add_u32 v5, v22, 2, v5
v_mul_u32_u24 v23, 768, v25
v_add_u32 v5, v5, v23
v_lshlrev_b32 v9, 8, v22
v_lshl_add_u32 v9, v25, 6, v9
v_bfe_u32 v23, v21, 3, 1
v_lshl_add_u32 v9, v23, 7, v9
v_bfe_u32 v23, v21, 2, 1
v_lshl_add_u32 v9, v23, 5, v9
v_and_b32 v23, 1, v21
v_lshl_add_u32 v9, v23, 4, v9
v_lshrrev_b32 v23, 1, v22
v_and_b32 v24, 1, v22
v_and_b32 v25, 7, v21
v_lshrrev_b32 v7, 3, v21
v_lshl_add_u32 v8, v7, 1, v23
v_lshlrev_b32 v8, 12, v8
v_lshl_add_u32 v8, v24, 7, v8
v_and_b32 v25, 4, v21
v_lshl_add_u32 v8, v25, 3, v8
v_and_b32 v25, 1, v21
v_lshl_add_u32 v8, v25, 4, v8
v_bfe_u32 v25, v21, 1, 1
v_lshl_add_u32 v8, v25, 3, v8
s_lshr_b32 s56, s32, 1
s_lshl_b32 s56, s56, 8
s_and_b32 s57, s32, 1
s_lshl_b32 s57, s57, 6
s_add_u32 s56, s56, s57
s_add_u32 s56, s56, 16384
v_add_u32 v8, s56, v8
v_and_b32 v7, 12, v21
v_bfe_u32 v25, v21, 1, 1
v_add_u32 v7, v7, v25
v_lshlrev_b32 v7, 4, v7
v_lshl_add_u32 v7, v22, 8, v7
s_mov_b32 s42, 0
s_mov_b32 s43, 65536
s_mov_b32 s44, 131072
s_mov_b32 s45, 196608
s_mov_b32 s46, 262144
s_mov_b32 s47, 294912
s_mov_b32 s48, 299008
s_mov_b32 s49, 303104
s_mov_b32 s50, 0x3e0293ee
s_mov_b32 s51, 0x3e0293ee
s_mov_b32 s52, 0x3f803f80
s_mov_b32 s53, 0x3f803f80
v_and_b32 v11, 3, v21
v_cmp_eq_u32 vcc, 0, v11
s_nop 1
v_cndmask_b32 v11, 0, 1, vcc
s_mov_b32 s34, 0
s_mov_b32 s35, -1
s_mov_b32 s36, 0
s_mov_b32 s41, 300000
s_lshl_b32 s37, s32, 14
s_add_u32 s39, s37, 17309696
s_add_u32 s37, s37, 16781312
s_mov_b32 s40, 8749056
v_mov_b64 v[36:37], 0
v_mov_b64 v[38:39], 0
ds_write_b128 v1, v[36:39] offset:15360
s_lshl_b32 s56, s32, 1
s_add_u32 s56, s56, 0
s_cmp_eq_u32 s56, 0
s_cselect_b32 s56, 64, s56
s_mul_i32 s56, s56, 10240
s_add_u32 s56, s56, 8392704
s_add_u32 s57, s56, 4096
v_mov_b32 v40, 0
v_mov_b32 v41, 0
v_mov_b32 v42, 0
v_mov_b32 v43, 0
buffer_store_dwordx4 v[40:43], v1, s[4:7], s56 offen offset:0 sc0 sc1
buffer_store_dwordx4 v[40:43], v1, s[4:7], s56 offen offset:1024 sc0 sc1
buffer_store_dwordx4 v[40:43], v1, s[4:7], s56 offen offset:2048 sc0 sc1
buffer_store_dwordx4 v[40:43], v1, s[4:7], s56 offen offset:3072 sc0 sc1
buffer_store_dwordx4 v[40:43], v1, s[4:7], s57 offen offset:0 sc0 sc1
s_getreg_b32 s56, hwreg(HW_REG_XCC_ID)
s_and_b32 s56, s56, 15
s_mul_i32 s57, s56, s56
s_lshl_b32 s57, s57, 18
s_lshl_b32 s56, s56, 8
s_add_u32 s57, s57, s56
s_add_u32 s58, s57, 1
s_lshl_b32 s101, s32, 7
s_add_u32 s101, s101, 327680
v_mov_b32 v24, 0
s_add_u32 s56, s54, 2752512
s_mov_b32 m0, 86016
s_nop 0
buffer_load_dwordx4 v26, s[8:11], s56 offen lds
s_add_u32 s56, s54, 2768896
s_mov_b32 m0, 87040
s_nop 0
buffer_load_dwordx4 v26, s[8:11], s56 offen lds
s_add_u32 s56, s54, 2785280
s_mov_b32 m0, 88064
s_nop 0
buffer_load_dwordx4 v27, s[8:11], s56 offen lds
s_add_u32 s56, s54, 2801664
s_mov_b32 m0, 89088
s_nop 0
buffer_load_dwordx4 v27, s[8:11], s56 offen lds
s_add_u32 s56, s54, 3276800
s_mov_b32 m0, 57344
s_nop 0
buffer_load_dwordx4 v26, s[8:11], s56 offen lds
s_add_u32 s56, s54, 3293184
s_mov_b32 m0, 58368
s_nop 0
buffer_load_dwordx4 v26, s[8:11], s56 offen lds
s_add_u32 s56, s54, 3309568
s_mov_b32 m0, 59392
s_nop 0
buffer_load_dwordx4 v27, s[8:11], s56 offen lds
s_add_u32 s56, s54, 3325952
s_mov_b32 m0, 60416
s_nop 0
buffer_load_dwordx4 v27, s[8:11], s56 offen lds
s_add_u32 s56, s54, 3801088
s_mov_b32 m0, 61440
s_nop 0
buffer_load_dwordx4 v26, s[8:11], s56 offen lds
s_add_u32 s56, s54, 3817472
s_mov_b32 m0, 62464
s_nop 0
buffer_load_dwordx4 v26, s[8:11], s56 offen lds
s_add_u32 s56, s54, 3833856
s_mov_b32 m0, 63488
s_nop 0
buffer_load_dwordx4 v27, s[8:11], s56 offen lds
s_add_u32 s56, s54, 3850240
s_mov_b32 m0, 64512
s_nop 0
buffer_load_dwordx4 v27, s[8:11], s56 offen lds
s_add_u32 s56, s54, 4325376
s_mov_b32 m0, 65536
s_nop 0
buffer_load_dwordx4 v26, s[8:11], s56 offen lds
s_add_u32 s56, s54, 4341760
s_mov_b32 m0, 66560
s_nop 0
buffer_load_dwordx4 v26, s[8:11], s56 offen lds
s_add_u32 s56, s54, 4358144
s_mov_b32 m0, 67584
s_nop 0
buffer_load_dwordx4 v27, s[8:11], s56 offen lds
s_add_u32 s56, s54, 4374528
s_mov_b32 m0, 68608
s_nop 0
buffer_load_dwordx4 v27, s[8:11], s56 offen lds
s_add_u32 s56, s54, 131072
s_mov_b32 m0, 69632
s_nop 0
buffer_load_dwordx4 v26, s[12:15], s56 offen lds
s_add_u32 s56, s54, 147456
s_mov_b32 m0, 70656
s_nop 0
buffer_load_dwordx4 v26, s[12:15], s56 offen lds
s_add_u32 s56, s54, 163840
s_mov_b32 m0, 71680
s_nop 0
buffer_load_dwordx4 v27, s[12:15], s56 offen lds
s_add_u32 s56, s54, 180224
s_mov_b32 m0, 72704
s_nop 0
buffer_load_dwordx4 v27, s[12:15], s56 offen lds
s_add_u32 s56, s54, 655360
s_mov_b32 m0, 73728
s_nop 0
buffer_load_dwordx4 v26, s[12:15], s56 offen lds
s_add_u32 s56, s54, 671744
s_mov_b32 m0, 74752
s_nop 0
buffer_load_dwordx4 v26, s[12:15], s56 offen lds
s_add_u32 s56, s54, 688128
s_mov_b32 m0, 75776
s_nop 0
buffer_load_dwordx4 v27, s[12:15], s56 offen lds
s_add_u32 s56, s54, 704512
s_mov_b32 m0, 76800
s_nop 0
buffer_load_dwordx4 v27, s[12:15], s56 offen lds
v_and_b32 v23, 3, v20
v_lshrrev_b32 v24, 2, v20
v_mul_u32_u24 v29, 1152, v24
v_lshl_add_u32 v29, v23, 4, v29
v_lshrrev_b32 v24, 2, v21
v_and_b32 v25, 1, v22
v_lshlrev_b32 v31, 10, v25
v_lshrrev_b32 v25, 1, v22
v_lshl_add_u32 v31, v25, 8, v31
v_and_b32 v25, 1, v24
v_lshl_add_u32 v31, v25, 6, v31
v_lshrrev_b32 v25, 1, v24
v_lshl_add_u32 v31, v25, 3, v31
v_lshl_add_u32 v31, v23, 4, v31
v_add_u32 v31, 57344, v31
s_add_u32 s56, s55, 1088
s_mov_b32 m0, 90112
s_nop 0
buffer_load_dwordx4 v29, s[20:23], s56 offen lds
s_add_u32 s56, s55, 19520
s_mov_b32 m0, 91136
s_nop 0
buffer_load_dwordx4 v29, s[20:23], s56 offen lds
s_add_u32 s56, s55, 37952
s_mov_b32 m0, 94208
s_nop 0
buffer_load_dwordx4 v29, s[20:23], s56 offen lds
s_add_u32 s56, s55, 56384
s_mov_b32 m0, 95232
s_nop 0
buffer_load_dwordx4 v29, s[20:23], s56 offen lds
s_add_u32 s56, s55, 74816
s_mov_b32 m0, 92160
s_nop 0
buffer_load_dwordx4 v29, s[20:23], s56 offen lds
s_add_u32 s56, s55, 93248
s_mov_b32 m0, 93184
s_nop 0
buffer_load_dwordx4 v29, s[20:23], s56 offen lds
s_add_u32 s56, s55, 111680
s_mov_b32 m0, 96256
s_nop 0
buffer_load_dwordx4 v29, s[20:23], s56 offen lds
s_add_u32 s56, s55, 130112
s_mov_b32 m0, 97280
s_nop 0
buffer_load_dwordx4 v29, s[20:23], s56 offen lds
v_mov_b32 v24, 0
s_waitcnt vmcnt(41)
s_barrier
ds_read_b64_tr_b16 v[80:81], v44 offset:20480
ds_read_b64_tr_b16 v[82:83], v44 offset:21504
ds_read_b64_tr_b16 v[84:85], v46 offset:20480
ds_read_b64_tr_b16 v[86:87], v46 offset:21504
ds_read_b64_tr_b16 v[88:89], v45 offset:20480
ds_read_b64_tr_b16 v[90:91], v45 offset:21504
ds_read_b64_tr_b16 v[92:93], v47 offset:20480
ds_read_b64_tr_b16 v[94:95], v47 offset:21504
s_waitcnt lgkmcnt(0)
s_waitcnt vmcnt(37)
s_barrier
s_add_u32 s56, s54, 1179648
s_mov_b32 m0, 77824
s_nop 0
buffer_load_dwordx4 v26, s[12:15], s56 offen lds
s_add_u32 s56, s54, 1196032
s_mov_b32 m0, 78848
s_nop 0
buffer_load_dwordx4 v26, s[12:15], s56 offen lds
s_add_u32 s56, s54, 1212416
s_mov_b32 m0, 79872
s_nop 0
buffer_load_dwordx4 v27, s[12:15], s56 offen lds
s_add_u32 s56, s54, 1228800
s_mov_b32 m0, 80896
s_nop 0
buffer_load_dwordx4 v27, s[12:15], s56 offen lds
ds_read_b64_tr_b16 v[96:97], v44 offset:24576
ds_read_b64_tr_b16 v[98:99], v44 offset:25600
ds_read_b64_tr_b16 v[100:101], v46 offset:24576
ds_read_b64_tr_b16 v[102:103], v46 offset:25600
ds_read_b64_tr_b16 v[104:105], v45 offset:24576
ds_read_b64_tr_b16 v[106:107], v45 offset:25600
ds_read_b64_tr_b16 v[108:109], v47 offset:24576
ds_read_b64_tr_b16 v[110:111], v47 offset:25600
s_waitcnt lgkmcnt(0)
s_waitcnt vmcnt(32)
s_barrier
s_add_u32 s56, s54, 1703936
s_mov_b32 m0, 81920
s_nop 0
buffer_load_dwordx4 v26, s[12:15], s56 offen lds
s_add_u32 s56, s54, 1720320
s_mov_b32 m0, 82944
s_nop 0
buffer_load_dwordx4 v26, s[12:15], s56 offen lds
s_add_u32 s56, s54, 1736704
s_mov_b32 m0, 83968
s_nop 0
buffer_load_dwordx4 v27, s[12:15], s56 offen lds
s_add_u32 s56, s54, 1753088
s_mov_b32 m0, 84992
s_nop 0
buffer_load_dwordx4 v27, s[12:15], s56 offen lds
ds_read_b64_tr_b16 v[112:113], v44 offset:28672
ds_read_b64_tr_b16 v[114:115], v44 offset:29696
ds_read_b64_tr_b16 v[116:117], v46 offset:28672
ds_read_b64_tr_b16 v[118:119], v46 offset:29696
ds_read_b64_tr_b16 v[120:121], v45 offset:28672
ds_read_b64_tr_b16 v[122:123], v45 offset:29696
ds_read_b64_tr_b16 v[124:125], v47 offset:28672
ds_read_b64_tr_b16 v[126:127], v47 offset:29696
s_waitcnt lgkmcnt(0)
s_waitcnt vmcnt(32)
s_barrier
s_add_u32 s56, s54, 2228224
s_mov_b32 m0, 86016
s_nop 0
buffer_load_dwordx4 v26, s[12:15], s56 offen lds
s_add_u32 s56, s54, 2244608
s_mov_b32 m0, 87040
s_nop 0
buffer_load_dwordx4 v26, s[12:15], s56 offen lds
s_add_u32 s56, s54, 2260992
s_mov_b32 m0, 88064
s_nop 0
buffer_load_dwordx4 v27, s[12:15], s56 offen lds
s_add_u32 s56, s54, 2277376
s_mov_b32 m0, 89088
s_nop 0
buffer_load_dwordx4 v27, s[12:15], s56 offen lds
ds_read_b64_tr_b16 v[128:129], v44 offset:0
ds_read_b64_tr_b16 v[130:131], v44 offset:1024
ds_read_b64_tr_b16 v[132:133], v46 offset:0
ds_read_b64_tr_b16 v[134:135], v46 offset:1024
ds_read_b64_tr_b16 v[136:137], v45 offset:0
ds_read_b64_tr_b16 v[138:139], v45 offset:1024
ds_read_b64_tr_b16 v[140:141], v47 offset:0
ds_read_b64_tr_b16 v[142:143], v47 offset:1024
s_waitcnt lgkmcnt(0)
s_waitcnt vmcnt(32)
s_barrier
s_add_u32 s56, s54, 3276800
s_mov_b32 m0, 57344
s_nop 0
buffer_load_dwordx4 v26, s[12:15], s56 offen lds
s_add_u32 s56, s54, 3293184
s_mov_b32 m0, 58368
s_nop 0
buffer_load_dwordx4 v26, s[12:15], s56 offen lds
s_add_u32 s56, s54, 3309568
s_mov_b32 m0, 59392
s_nop 0
buffer_load_dwordx4 v27, s[12:15], s56 offen lds
s_add_u32 s56, s54, 3325952
s_mov_b32 m0, 60416
s_nop 0
buffer_load_dwordx4 v27, s[12:15], s56 offen lds
ds_read_b64_tr_b16 v[144:145], v44 offset:4096
ds_read_b64_tr_b16 v[146:147], v44 offset:5120
ds_read_b64_tr_b16 v[148:149], v46 offset:4096
ds_read_b64_tr_b16 v[150:151], v46 offset:5120
ds_read_b64_tr_b16 v[152:153], v45 offset:4096
ds_read_b64_tr_b16 v[154:155], v45 offset:5120
ds_read_b64_tr_b16 v[156:157], v47 offset:4096
ds_read_b64_tr_b16 v[158:159], v47 offset:5120
s_waitcnt lgkmcnt(0)
s_waitcnt vmcnt(32)
s_barrier
s_add_u32 s56, s54, 3801088
s_mov_b32 m0, 61440
s_nop 0
buffer_load_dwordx4 v26, s[12:15], s56 offen lds
s_add_u32 s56, s54, 3817472
s_mov_b32 m0, 62464
s_nop 0
buffer_load_dwordx4 v26, s[12:15], s56 offen lds
s_add_u32 s56, s54, 3833856
s_mov_b32 m0, 63488
s_nop 0
buffer_load_dwordx4 v27, s[12:15], s56 offen lds
s_add_u32 s56, s54, 3850240
s_mov_b32 m0, 64512
s_nop 0
buffer_load_dwordx4 v27, s[12:15], s56 offen lds
ds_read_b64_tr_b16 v[160:161], v44 offset:8192
ds_read_b64_tr_b16 v[162:163], v44 offset:9216
ds_read_b64_tr_b16 v[164:165], v46 offset:8192
ds_read_b64_tr_b16 v[166:167], v46 offset:9216
ds_read_b64_tr_b16 v[168:169], v45 offset:8192
ds_read_b64_tr_b16 v[170:171], v45 offset:9216
ds_read_b64_tr_b16 v[172:173], v47 offset:8192
ds_read_b64_tr_b16 v[174:175], v47 offset:9216
s_waitcnt lgkmcnt(0)
s_waitcnt vmcnt(32)
s_barrier
s_add_u32 s56, s54, 4325376
s_mov_b32 m0, 65536
s_nop 0
buffer_load_dwordx4 v26, s[12:15], s56 offen lds
s_add_u32 s56, s54, 4341760
s_mov_b32 m0, 66560
s_nop 0
buffer_load_dwordx4 v26, s[12:15], s56 offen lds
s_add_u32 s56, s54, 4358144
s_mov_b32 m0, 67584
s_nop 0
buffer_load_dwordx4 v27, s[12:15], s56 offen lds
s_add_u32 s56, s54, 4374528
s_mov_b32 m0, 68608
s_nop 0
buffer_load_dwordx4 v27, s[12:15], s56 offen lds
ds_read_b64_tr_b16 v[176:177], v44 offset:12288
ds_read_b64_tr_b16 v[178:179], v44 offset:13312
ds_read_b64_tr_b16 v[180:181], v46 offset:12288
ds_read_b64_tr_b16 v[182:183], v46 offset:13312
ds_read_b64_tr_b16 v[184:185], v45 offset:12288
ds_read_b64_tr_b16 v[186:187], v45 offset:13312
ds_read_b64_tr_b16 v[188:189], v47 offset:12288
ds_read_b64_tr_b16 v[190:191], v47 offset:13312
s_waitcnt lgkmcnt(0)
s_waitcnt vmcnt(32)
s_barrier
s_add_u32 s56, s54, 131072
s_mov_b32 m0, 69632
s_nop 0
buffer_load_dwordx4 v26, s[16:19], s56 offen lds
s_add_u32 s56, s54, 147456
s_mov_b32 m0, 70656
s_nop 0
buffer_load_dwordx4 v26, s[16:19], s56 offen lds
s_add_u32 s56, s54, 163840
s_mov_b32 m0, 71680
s_nop 0
buffer_load_dwordx4 v27, s[16:19], s56 offen lds
s_add_u32 s56, s54, 180224
s_mov_b32 m0, 72704
s_nop 0
buffer_load_dwordx4 v27, s[16:19], s56 offen lds
ds_read_b64_tr_b16 v[192:193], v44 offset:16384
ds_read_b64_tr_b16 v[194:195], v44 offset:17408
ds_read_b64_tr_b16 v[196:197], v46 offset:16384
ds_read_b64_tr_b16 v[198:199], v46 offset:17408
ds_read_b64_tr_b16 v[200:201], v45 offset:16384
ds_read_b64_tr_b16 v[202:203], v45 offset:17408
ds_read_b64_tr_b16 v[204:205], v47 offset:16384
ds_read_b64_tr_b16 v[206:207], v47 offset:17408
s_waitcnt lgkmcnt(0)
s_waitcnt vmcnt(24)
s_barrier
s_add_u32 s56, s54, 655360
s_mov_b32 m0, 73728
s_nop 0
buffer_load_dwordx4 v26, s[16:19], s56 offen lds
s_add_u32 s56, s54, 671744
s_mov_b32 m0, 74752
s_nop 0
buffer_load_dwordx4 v26, s[16:19], s56 offen lds
s_add_u32 s56, s54, 688128
s_mov_b32 m0, 75776
s_nop 0
buffer_load_dwordx4 v27, s[16:19], s56 offen lds
s_add_u32 s56, s54, 704512
s_mov_b32 m0, 76800
s_nop 0
buffer_load_dwordx4 v27, s[16:19], s56 offen lds
ds_read_b64_tr_b16 v[208:209], v44 offset:20480
ds_read_b64_tr_b16 v[210:211], v44 offset:21504
ds_read_b64_tr_b16 v[212:213], v46 offset:20480
ds_read_b64_tr_b16 v[214:215], v46 offset:21504
ds_read_b64_tr_b16 v[216:217], v45 offset:20480
ds_read_b64_tr_b16 v[218:219], v45 offset:21504
ds_read_b64_tr_b16 v[220:221], v47 offset:20480
ds_read_b64_tr_b16 v[222:223], v47 offset:21504
s_waitcnt lgkmcnt(0)
s_waitcnt vmcnt(24)
s_barrier
s_add_u32 s56, s54, 1179648
s_mov_b32 m0, 77824
s_nop 0
buffer_load_dwordx4 v26, s[16:19], s56 offen lds
s_add_u32 s56, s54, 1196032
s_mov_b32 m0, 78848
s_nop 0
buffer_load_dwordx4 v26, s[16:19], s56 offen lds
s_add_u32 s56, s54, 1212416
s_mov_b32 m0, 79872
s_nop 0
buffer_load_dwordx4 v27, s[16:19], s56 offen lds
s_add_u32 s56, s54, 1228800
s_mov_b32 m0, 80896
s_nop 0
buffer_load_dwordx4 v27, s[16:19], s56 offen lds
ds_read_b64_tr_b16 v[224:225], v44 offset:24576
ds_read_b64_tr_b16 v[226:227], v44 offset:25600
ds_read_b64_tr_b16 v[228:229], v46 offset:24576
ds_read_b64_tr_b16 v[230:231], v46 offset:25600
ds_read_b64_tr_b16 v[232:233], v45 offset:24576
ds_read_b64_tr_b16 v[234:235], v45 offset:25600
ds_read_b64_tr_b16 v[236:237], v47 offset:24576
ds_read_b64_tr_b16 v[238:239], v47 offset:25600
ds_read_b64_tr_b16 v[60:61], v31 offset:32768
ds_read_b64_tr_b16 v[62:63], v31 offset:32896
ds_read_b64_tr_b16 v[64:65], v31 offset:33280
ds_read_b64_tr_b16 v[66:67], v31 offset:33408
ds_read_b64_tr_b16 v[68:69], v31 offset:34816
ds_read_b64_tr_b16 v[70:71], v31 offset:34944
ds_read_b64_tr_b16 v[72:73], v31 offset:35328
ds_read_b64_tr_b16 v[74:75], v31 offset:35456
s_waitcnt lgkmcnt(0)
ds_write_b128 v2, v[60:63] offset:32768
ds_write_b128 v2, v[64:67] offset:33792
ds_write_b128 v2, v[68:71] offset:34816
ds_write_b128 v2, v[72:75] offset:35840
s_waitcnt lgkmcnt(0)
s_waitcnt vmcnt(24)
s_barrier
s_add_u32 s56, s54, 1703936
s_mov_b32 m0, 81920
s_nop 0
buffer_load_dwordx4 v26, s[16:19], s56 offen lds
s_add_u32 s56, s54, 1720320
s_mov_b32 m0, 82944
s_nop 0
buffer_load_dwordx4 v26, s[16:19], s56 offen lds
s_add_u32 s56, s54, 1736704
s_mov_b32 m0, 83968
s_nop 0
buffer_load_dwordx4 v27, s[16:19], s56 offen lds
s_add_u32 s56, s54, 1753088
s_mov_b32 m0, 84992
s_nop 0
buffer_load_dwordx4 v27, s[16:19], s56 offen lds
ds_read_b64_tr_b16 v[240:241], v44 offset:28672
ds_read_b64_tr_b16 v[242:243], v44 offset:29696
ds_read_b64_tr_b16 v[244:245], v46 offset:28672
ds_read_b64_tr_b16 v[246:247], v46 offset:29696
ds_read_b64_tr_b16 v[248:249], v45 offset:28672
ds_read_b64_tr_b16 v[250:251], v45 offset:29696
ds_read_b64_tr_b16 v[252:253], v47 offset:28672
ds_read_b64_tr_b16 v[254:255], v47 offset:29696
ds_read_b64_tr_b16 v[60:61], v31 offset:36864
ds_read_b64_tr_b16 v[62:63], v31 offset:36992
ds_read_b64_tr_b16 v[64:65], v31 offset:37376
ds_read_b64_tr_b16 v[66:67], v31 offset:37504
ds_read_b64_tr_b16 v[68:69], v31 offset:38912
ds_read_b64_tr_b16 v[70:71], v31 offset:39040
ds_read_b64_tr_b16 v[72:73], v31 offset:39424
ds_read_b64_tr_b16 v[74:75], v31 offset:39552
s_waitcnt lgkmcnt(0)
ds_write_b128 v2, v[60:63] offset:36864
ds_write_b128 v2, v[64:67] offset:37888
ds_write_b128 v2, v[68:71] offset:38912
ds_write_b128 v2, v[72:75] offset:39936
s_waitcnt lgkmcnt(0)
s_waitcnt vmcnt(24)
s_barrier
s_add_u32 s56, s54, 2228224
s_mov_b32 m0, 86016
s_nop 0
buffer_load_dwordx4 v26, s[16:19], s56 offen lds
s_add_u32 s56, s54, 2244608
s_mov_b32 m0, 87040
s_nop 0
buffer_load_dwordx4 v26, s[16:19], s56 offen lds
s_add_u32 s56, s54, 2260992
s_mov_b32 m0, 88064
s_nop 0
buffer_load_dwordx4 v27, s[16:19], s56 offen lds
s_add_u32 s56, s54, 2277376
s_mov_b32 m0, 89088
s_nop 0
buffer_load_dwordx4 v27, s[16:19], s56 offen lds
ds_read_b64_tr_b16 a[0:1], v44 offset:0
ds_read_b64_tr_b16 a[2:3], v44 offset:1024
ds_read_b64_tr_b16 a[4:5], v46 offset:0
ds_read_b64_tr_b16 a[6:7], v46 offset:1024
ds_read_b64_tr_b16 a[8:9], v45 offset:0
ds_read_b64_tr_b16 a[10:11], v45 offset:1024
ds_read_b64_tr_b16 a[12:13], v47 offset:0
ds_read_b64_tr_b16 a[14:15], v47 offset:1024
s_waitcnt lgkmcnt(0)
s_waitcnt vmcnt(24)
s_barrier
s_add_u32 s56, s54, 2752512
s_mov_b32 m0, 57344
s_nop 0
buffer_load_dwordx4 v26, s[16:19], s56 offen lds
s_add_u32 s56, s54, 2768896
s_mov_b32 m0, 58368
s_nop 0
buffer_load_dwordx4 v26, s[16:19], s56 offen lds
s_add_u32 s56, s54, 2785280
s_mov_b32 m0, 59392
s_nop 0
buffer_load_dwordx4 v27, s[16:19], s56 offen lds
s_add_u32 s56, s54, 2801664
s_mov_b32 m0, 60416
s_nop 0
buffer_load_dwordx4 v27, s[16:19], s56 offen lds
ds_read_b64_tr_b16 a[16:17], v44 offset:4096
ds_read_b64_tr_b16 a[18:19], v44 offset:5120
ds_read_b64_tr_b16 a[20:21], v46 offset:4096
ds_read_b64_tr_b16 a[22:23], v46 offset:5120
ds_read_b64_tr_b16 a[24:25], v45 offset:4096
ds_read_b64_tr_b16 a[26:27], v45 offset:5120
ds_read_b64_tr_b16 a[28:29], v47 offset:4096
ds_read_b64_tr_b16 a[30:31], v47 offset:5120
s_waitcnt lgkmcnt(0)
s_waitcnt vmcnt(24)
s_barrier
s_add_u32 s56, s54, 3276800
s_mov_b32 m0, 61440
s_nop 0
buffer_load_dwordx4 v26, s[16:19], s56 offen lds
s_add_u32 s56, s54, 3293184
s_mov_b32 m0, 62464
s_nop 0
buffer_load_dwordx4 v26, s[16:19], s56 offen lds
s_add_u32 s56, s54, 3309568
s_mov_b32 m0, 63488
s_nop 0
buffer_load_dwordx4 v27, s[16:19], s56 offen lds
s_add_u32 s56, s54, 3325952
s_mov_b32 m0, 64512
s_nop 0
buffer_load_dwordx4 v27, s[16:19], s56 offen lds
ds_read_b64_tr_b16 a[32:33], v44 offset:8192
ds_read_b64_tr_b16 a[34:35], v44 offset:9216
ds_read_b64_tr_b16 a[36:37], v46 offset:8192
ds_read_b64_tr_b16 a[38:39], v46 offset:9216
ds_read_b64_tr_b16 a[40:41], v45 offset:8192
ds_read_b64_tr_b16 a[42:43], v45 offset:9216
ds_read_b64_tr_b16 a[44:45], v47 offset:8192
ds_read_b64_tr_b16 a[46:47], v47 offset:9216
s_waitcnt lgkmcnt(0)
s_waitcnt vmcnt(24)
s_barrier
s_add_u32 s56, s54, 3801088
s_mov_b32 m0, 65536
s_nop 0
buffer_load_dwordx4 v26, s[16:19], s56 offen lds
s_add_u32 s56, s54, 3817472
s_mov_b32 m0, 66560
s_nop 0
buffer_load_dwordx4 v26, s[16:19], s56 offen lds
s_add_u32 s56, s54, 3833856
s_mov_b32 m0, 67584
s_nop 0
buffer_load_dwordx4 v27, s[16:19], s56 offen lds
s_add_u32 s56, s54, 3850240
s_mov_b32 m0, 68608
s_nop 0
buffer_load_dwordx4 v27, s[16:19], s56 offen lds
ds_read_b64_tr_b16 a[48:49], v44 offset:12288
ds_read_b64_tr_b16 a[50:51], v44 offset:13312
ds_read_b64_tr_b16 a[52:53], v46 offset:12288
ds_read_b64_tr_b16 a[54:55], v46 offset:13312
ds_read_b64_tr_b16 a[56:57], v45 offset:12288
ds_read_b64_tr_b16 a[58:59], v45 offset:13312
ds_read_b64_tr_b16 a[60:61], v47 offset:12288
ds_read_b64_tr_b16 a[62:63], v47 offset:13312
s_waitcnt lgkmcnt(0)
s_waitcnt vmcnt(24)
s_barrier
s_add_u32 s56, s55, 41472
s_mov_b32 m0, 69632
s_nop 0
buffer_load_dwordx4 v28, s[20:23], s56 offen lds
s_add_u32 s56, s55, 43776
s_mov_b32 m0, 70656
s_nop 0
buffer_load_dwordx4 v28, s[20:23], s56 offen lds
s_add_u32 s56, s55, 50688
s_mov_b32 m0, 71680
s_nop 0
buffer_load_dwordx4 v28, s[20:23], s56 offen lds
s_add_u32 s56, s55, 52992
s_mov_b32 m0, 72704
s_nop 0
buffer_load_dwordx4 v28, s[20:23], s56 offen lds
ds_read_b64_tr_b16 a[64:65], v44 offset:16384
ds_read_b64_tr_b16 a[66:67], v44 offset:17408
ds_read_b64_tr_b16 a[68:69], v46 offset:16384
ds_read_b64_tr_b16 a[70:71], v46 offset:17408
ds_read_b64_tr_b16 a[72:73], v45 offset:16384
ds_read_b64_tr_b16 a[74:75], v45 offset:17408
ds_read_b64_tr_b16 a[76:77], v47 offset:16384
ds_read_b64_tr_b16 a[78:79], v47 offset:17408
s_waitcnt lgkmcnt(0)
s_waitcnt vmcnt(24)
s_barrier
s_add_u32 s56, s55, 41728
s_mov_b32 m0, 73728
s_nop 0
buffer_load_dwordx4 v28, s[20:23], s56 offen lds
s_add_u32 s56, s55, 44032
s_mov_b32 m0, 74752
s_nop 0
buffer_load_dwordx4 v28, s[20:23], s56 offen lds
s_add_u32 s56, s55, 50944
s_mov_b32 m0, 75776
s_nop 0
buffer_load_dwordx4 v28, s[20:23], s56 offen lds
s_add_u32 s56, s55, 53248
s_mov_b32 m0, 76800
s_nop 0
buffer_load_dwordx4 v28, s[20:23], s56 offen lds
ds_read_b64_tr_b16 a[80:81], v44 offset:20480
ds_read_b64_tr_b16 a[82:83], v44 offset:21504
ds_read_b64_tr_b16 a[84:85], v46 offset:20480
ds_read_b64_tr_b16 a[86:87], v46 offset:21504
ds_read_b64_tr_b16 a[88:89], v45 offset:20480
ds_read_b64_tr_b16 a[90:91], v45 offset:21504
ds_read_b64_tr_b16 a[92:93], v47 offset:20480
ds_read_b64_tr_b16 a[94:95], v47 offset:21504
s_waitcnt lgkmcnt(0)
s_waitcnt vmcnt(24)
s_barrier
s_add_u32 s56, s55, 41984
s_mov_b32 m0, 77824
s_nop 0
buffer_load_dwordx4 v28, s[20:23], s56 offen lds
s_add_u32 s56, s55, 44288
s_mov_b32 m0, 78848
s_nop 0
buffer_load_dwordx4 v28, s[20:23], s56 offen lds
s_add_u32 s56, s55, 51200
s_mov_b32 m0, 79872
s_nop 0
buffer_load_dwordx4 v28, s[20:23], s56 offen lds
s_add_u32 s56, s55, 53504
s_mov_b32 m0, 80896
s_nop 0
buffer_load_dwordx4 v28, s[20:23], s56 offen lds
ds_read_b64_tr_b16 a[96:97], v44 offset:24576
ds_read_b64_tr_b16 a[98:99], v44 offset:25600
ds_read_b64_tr_b16 a[100:101], v46 offset:24576
ds_read_b64_tr_b16 a[102:103], v46 offset:25600
ds_read_b64_tr_b16 a[104:105], v45 offset:24576
ds_read_b64_tr_b16 a[106:107], v45 offset:25600
ds_read_b64_tr_b16 a[108:109], v47 offset:24576
ds_read_b64_tr_b16 a[110:111], v47 offset:25600
s_waitcnt lgkmcnt(0)
s_waitcnt vmcnt(24)
s_barrier
s_add_u32 s56, s55, 42240
s_mov_b32 m0, 81920
s_nop 0
buffer_load_dwordx4 v28, s[20:23], s56 offen lds
s_add_u32 s56, s55, 44544
s_mov_b32 m0, 82944
s_nop 0
buffer_load_dwordx4 v28, s[20:23], s56 offen lds
s_add_u32 s56, s55, 51456
s_mov_b32 m0, 83968
s_nop 0
buffer_load_dwordx4 v28, s[20:23], s56 offen lds
s_add_u32 s56, s55, 53760
s_mov_b32 m0, 84992
s_nop 0
buffer_load_dwordx4 v28, s[20:23], s56 offen lds
ds_read_b64_tr_b16 a[112:113], v44 offset:28672
ds_read_b64_tr_b16 a[114:115], v44 offset:29696
ds_read_b64_tr_b16 a[116:117], v46 offset:28672
ds_read_b64_tr_b16 a[118:119], v46 offset:29696
ds_read_b64_tr_b16 a[120:121], v45 offset:28672
ds_read_b64_tr_b16 a[122:123], v45 offset:29696
ds_read_b64_tr_b16 a[124:125], v47 offset:28672
ds_read_b64_tr_b16 a[126:127], v47 offset:29696
s_waitcnt lgkmcnt(0)
s_waitcnt vmcnt(24)
s_barrier
s_add_u32 s56, s55, 5376
s_mov_b32 m0, 86016
s_nop 0
buffer_load_dwordx4 v28, s[20:23], s56 offen lds
s_add_u32 s56, s55, 7680
s_mov_b32 m0, 87040
s_nop 0
buffer_load_dwordx4 v28, s[20:23], s56 offen lds
s_add_u32 s56, s55, 14592
s_mov_b32 m0, 88064
s_nop 0
buffer_load_dwordx4 v28, s[20:23], s56 offen lds
s_add_u32 s56, s55, 16896
s_mov_b32 m0, 89088
s_nop 0
buffer_load_dwordx4 v28, s[20:23], s56 offen lds
ds_read_b64_tr_b16 a[128:129], v44 offset:0
ds_read_b64_tr_b16 a[130:131], v44 offset:1024
ds_read_b64_tr_b16 a[132:133], v46 offset:0
ds_read_b64_tr_b16 a[134:135], v46 offset:1024
ds_read_b64_tr_b16 a[136:137], v45 offset:0
ds_read_b64_tr_b16 a[138:139], v45 offset:1024
ds_read_b64_tr_b16 a[140:141], v47 offset:0
ds_read_b64_tr_b16 a[142:143], v47 offset:1024
buffer_load_dword v32, v24, s[28:31], 0 offen sc0 sc1
s_waitcnt lgkmcnt(0)
s_waitcnt vmcnt(25)
s_barrier
s_add_u32 s56, s54, 131072
s_mov_b32 m0, 57344
s_nop 0
buffer_load_dwordx4 v26, s[8:11], s56 offen lds
s_add_u32 s56, s54, 147456
s_mov_b32 m0, 58368
s_nop 0
buffer_load_dwordx4 v26, s[8:11], s56 offen lds
s_add_u32 s56, s54, 163840
s_mov_b32 m0, 59392
s_nop 0
buffer_load_dwordx4 v27, s[8:11], s56 offen lds
s_add_u32 s56, s54, 180224
s_mov_b32 m0, 60416
s_nop 0
buffer_load_dwordx4 v27, s[8:11], s56 offen lds
ds_read_b64_tr_b16 a[144:145], v44 offset:4096
ds_read_b64_tr_b16 a[146:147], v44 offset:5120
ds_read_b64_tr_b16 a[148:149], v46 offset:4096
ds_read_b64_tr_b16 a[150:151], v46 offset:5120
ds_read_b64_tr_b16 a[152:153], v45 offset:4096
ds_read_b64_tr_b16 a[154:155], v45 offset:5120
ds_read_b64_tr_b16 a[156:157], v47 offset:4096
ds_read_b64_tr_b16 a[158:159], v47 offset:5120
s_waitcnt lgkmcnt(0)
s_waitcnt vmcnt(25)
s_barrier
s_add_u32 s56, s54, 1703936
s_mov_b32 m0, 61440
s_nop 0
buffer_load_dwordx4 v26, s[8:11], s56 offen lds
s_add_u32 s56, s54, 1720320
s_mov_b32 m0, 62464
s_nop 0
buffer_load_dwordx4 v26, s[8:11], s56 offen lds
s_add_u32 s56, s54, 1736704
s_mov_b32 m0, 63488
s_nop 0
buffer_load_dwordx4 v27, s[8:11], s56 offen lds
s_add_u32 s56, s54, 1753088
s_mov_b32 m0, 64512
s_nop 0
buffer_load_dwordx4 v27, s[8:11], s56 offen lds
ds_read_b64_tr_b16 a[160:161], v44 offset:8192
ds_read_b64_tr_b16 a[162:163], v44 offset:9216
ds_read_b64_tr_b16 a[164:165], v46 offset:8192
ds_read_b64_tr_b16 a[166:167], v46 offset:9216
ds_read_b64_tr_b16 a[168:169], v45 offset:8192
ds_read_b64_tr_b16 a[170:171], v45 offset:9216
ds_read_b64_tr_b16 a[172:173], v47 offset:8192
ds_read_b64_tr_b16 a[174:175], v47 offset:9216
s_waitcnt lgkmcnt(0)
s_waitcnt vmcnt(25)
s_barrier
s_add_u32 s56, s54, 2228224
s_mov_b32 m0, 65536
s_nop 0
buffer_load_dwordx4 v26, s[8:11], s56 offen lds
s_add_u32 s56, s54, 2244608
s_mov_b32 m0, 66560
s_nop 0
buffer_load_dwordx4 v26, s[8:11], s56 offen lds
s_add_u32 s56, s54, 2260992
s_mov_b32 m0, 67584
s_nop 0
buffer_load_dwordx4 v27, s[8:11], s56 offen lds
s_add_u32 s56, s54, 2277376
s_mov_b32 m0, 68608
s_nop 0
buffer_load_dwordx4 v27, s[8:11], s56 offen lds
ds_read_b64_tr_b16 a[176:177], v48 offset:12288
ds_read_b64_tr_b16 a[178:179], v48 offset:13312
ds_read_b64_tr_b16 a[180:181], v48 offset:14336
ds_read_b64_tr_b16 a[182:183], v48 offset:15360
ds_read_b64_tr_b16 a[192:193], v49 offset:12288
ds_read_b64_tr_b16 a[194:195], v49 offset:13312
ds_read_b64_tr_b16 a[196:197], v49 offset:14336
ds_read_b64_tr_b16 a[198:199], v49 offset:15360
s_waitcnt lgkmcnt(0)
s_waitcnt vmcnt(25)
s_barrier
s_add_u32 s56, s54, 2752512
s_mov_b32 m0, 69632
s_nop 0
buffer_load_dwordx4 v26, s[12:15], s56 offen lds
s_add_u32 s56, s54, 2768896
s_mov_b32 m0, 70656
s_nop 0
buffer_load_dwordx4 v26, s[12:15], s56 offen lds
s_add_u32 s56, s54, 2785280
s_mov_b32 m0, 71680
s_nop 0
buffer_load_dwordx4 v27, s[12:15], s56 offen lds
s_add_u32 s56, s54, 2801664
s_mov_b32 m0, 72704
s_nop 0
buffer_load_dwordx4 v27, s[12:15], s56 offen lds
ds_read_b64_tr_b16 a[184:185], v48 offset:16384
ds_read_b64_tr_b16 a[186:187], v48 offset:17408
ds_read_b64_tr_b16 a[188:189], v48 offset:18432
ds_read_b64_tr_b16 a[190:191], v48 offset:19456
ds_read_b64_tr_b16 a[200:201], v49 offset:16384
ds_read_b64_tr_b16 a[202:203], v49 offset:17408
ds_read_b64_tr_b16 a[204:205], v49 offset:18432
ds_read_b64_tr_b16 a[206:207], v49 offset:19456
s_waitcnt lgkmcnt(0)
s_waitcnt vmcnt(25)
s_barrier
s_add_u32 s56, s54, 4325376
s_mov_b32 m0, 73728
s_nop 0
buffer_load_dwordx4 v26, s[16:19], s56 offen lds
s_add_u32 s56, s54, 4341760
s_mov_b32 m0, 74752
s_nop 0
buffer_load_dwordx4 v26, s[16:19], s56 offen lds
s_add_u32 s56, s54, 4358144
s_mov_b32 m0, 75776
s_nop 0
buffer_load_dwordx4 v27, s[16:19], s56 offen lds
s_add_u32 s56, s54, 4374528
s_mov_b32 m0, 76800
s_nop 0
buffer_load_dwordx4 v27, s[16:19], s56 offen lds
ds_read_b64_tr_b16 a[208:209], v48 offset:20480
ds_read_b64_tr_b16 a[210:211], v48 offset:21504
ds_read_b64_tr_b16 a[212:213], v48 offset:22528
ds_read_b64_tr_b16 a[214:215], v48 offset:23552
ds_read_b64_tr_b16 a[216:217], v49 offset:20480
ds_read_b64_tr_b16 a[218:219], v49 offset:21504
ds_read_b64_tr_b16 a[220:221], v49 offset:22528
ds_read_b64_tr_b16 a[222:223], v49 offset:23552
s_waitcnt lgkmcnt(0)
s_waitcnt vmcnt(25)
s_barrier
s_add_u32 s56, s55, 4608
s_mov_b32 m0, 77824
s_nop 0
buffer_load_dwordx4 v28, s[20:23], s56 offen lds
s_add_u32 s56, s55, 6912
s_mov_b32 m0, 78848
s_nop 0
buffer_load_dwordx4 v28, s[20:23], s56 offen lds
s_add_u32 s56, s55, 13824
s_mov_b32 m0, 79872
s_nop 0
buffer_load_dwordx4 v28, s[20:23], s56 offen lds
s_add_u32 s56, s55, 16128
s_mov_b32 m0, 80896
s_nop 0
buffer_load_dwordx4 v28, s[20:23], s56 offen lds
ds_read_b64_tr_b16 a[224:225], v48 offset:24576
ds_read_b64_tr_b16 a[226:227], v48 offset:25600
ds_read_b64_tr_b16 a[228:229], v48 offset:26624
ds_read_b64_tr_b16 a[230:231], v48 offset:27648
ds_read_b64_tr_b16 a[240:241], v49 offset:24576
ds_read_b64_tr_b16 a[242:243], v49 offset:25600
ds_read_b64_tr_b16 a[244:245], v49 offset:26624
ds_read_b64_tr_b16 a[246:247], v49 offset:27648
s_waitcnt lgkmcnt(0)
s_waitcnt vmcnt(25)
s_barrier
s_add_u32 s56, s55, 4864
s_mov_b32 m0, 81920
s_nop 0
buffer_load_dwordx4 v28, s[20:23], s56 offen lds
s_add_u32 s56, s55, 7168
s_mov_b32 m0, 82944
s_nop 0
buffer_load_dwordx4 v28, s[20:23], s56 offen lds
s_add_u32 s56, s55, 14080
s_mov_b32 m0, 83968
s_nop 0
buffer_load_dwordx4 v28, s[20:23], s56 offen lds
s_add_u32 s56, s55, 16384
s_mov_b32 m0, 84992
s_nop 0
buffer_load_dwordx4 v28, s[20:23], s56 offen lds
ds_read_b64_tr_b16 a[248:249], v48 offset:28672
ds_read_b64_tr_b16 a[250:251], v48 offset:29696
ds_read_b64_tr_b16 a[252:253], v48 offset:30720
ds_read_b64_tr_b16 a[254:255], v48 offset:31744
ds_read_b64_tr_b16 a[232:233], v49 offset:28672
ds_read_b64_tr_b16 a[234:235], v49 offset:29696
ds_read_b64_tr_b16 a[236:237], v49 offset:30720
ds_read_b64_tr_b16 a[238:239], v49 offset:31744
s_waitcnt lgkmcnt(0)
s_waitcnt vmcnt(24)
s_barrier
s_add_u32 s56, s55, 5120
s_mov_b32 m0, 86016
s_nop 0
buffer_load_dwordx4 v28, s[20:23], s56 offen lds
s_add_u32 s56, s55, 7424
s_mov_b32 m0, 87040
s_nop 0
buffer_load_dwordx4 v28, s[20:23], s56 offen lds
s_add_u32 s56, s55, 14336
s_mov_b32 m0, 88064
s_nop 0
buffer_load_dwordx4 v28, s[20:23], s56 offen lds
s_add_u32 s56, s55, 16640
s_mov_b32 m0, 89088
s_nop 0
buffer_load_dwordx4 v28, s[20:23], s56 offen lds
ds_read_b64_tr_b16 v[60:61], v44 offset:0
ds_read_b64_tr_b16 v[62:63], v44 offset:1024
ds_read_b64_tr_b16 v[64:65], v46 offset:0
ds_read_b64_tr_b16 v[66:67], v46 offset:1024
ds_read_b64_tr_b16 v[68:69], v45 offset:0
ds_read_b64_tr_b16 v[70:71], v45 offset:1024
ds_read_b64_tr_b16 v[72:73], v47 offset:0
ds_read_b64_tr_b16 v[74:75], v47 offset:1024
s_waitcnt lgkmcnt(0)
s_waitcnt vmcnt(24)
s_barrier
ds_write_b128 v2, v[60:63] offset:0
ds_write_b128 v2, v[64:67] offset:1024
ds_write_b128 v2, v[68:71] offset:2048
ds_write_b128 v2, v[72:75] offset:3072
ds_read_b64_tr_b16 v[60:61], v44 offset:4096
ds_read_b64_tr_b16 v[62:63], v44 offset:5120
ds_read_b64_tr_b16 v[64:65], v46 offset:4096
ds_read_b64_tr_b16 v[66:67], v46 offset:5120
ds_read_b64_tr_b16 v[68:69], v45 offset:4096
ds_read_b64_tr_b16 v[70:71], v45 offset:5120
ds_read_b64_tr_b16 v[72:73], v47 offset:4096
ds_read_b64_tr_b16 v[74:75], v47 offset:5120
L_rdv_w1:
v_readfirstlane_b32 s38, v32
s_nop 0
s_and_b32 s57, s38, 0xff
s_cmp_lg_u32 s57, 32
s_cbranch_scc1 L_rdv2_w1
s_waitcnt lgkmcnt(0)
s_waitcnt vmcnt(20)
s_barrier
ds_write_b128 v2, v[60:63] offset:4096
ds_write_b128 v2, v[64:67] offset:5120
ds_write_b128 v2, v[68:71] offset:6144
ds_write_b128 v2, v[72:75] offset:7168
ds_read_b64_tr_b16 v[60:61], v44 offset:8192
ds_read_b64_tr_b16 v[62:63], v44 offset:9216
ds_read_b64_tr_b16 v[64:65], v46 offset:8192
ds_read_b64_tr_b16 v[66:67], v46 offset:9216
ds_read_b64_tr_b16 v[68:69], v45 offset:8192
ds_read_b64_tr_b16 v[70:71], v45 offset:9216
ds_read_b64_tr_b16 v[72:73], v47 offset:8192
ds_read_b64_tr_b16 v[74:75], v47 offset:9216
buffer_load_dwordx4 v[12:15], v9, s[4:7], s37 offen offset:0
buffer_load_dwordx4 v[16:19], v9, s[4:7], s37 offen offset:1024
buffer_load_dwordx4 v[52:55], v1, s[4:7], s37 offen offset:2048
buffer_load_dwordx4 v[56:59], v1, s[4:7], s37 offen offset:3072
s_mov_b32 m0, 1024
s_nop 0
buffer_load_dwordx4 v1, s[4:7], s47 offen offset:1024 sc0 sc1 lds
s_waitcnt lgkmcnt(0)
s_waitcnt vmcnt(21)
s_barrier
ds_write_b128 v2, v[60:63] offset:8192
ds_write_b128 v2, v[64:67] offset:9216
ds_write_b128 v2, v[68:71] offset:10240
ds_write_b128 v2, v[72:75] offset:11264
ds_read_b64_tr_b16 v[60:61], v44 offset:12288
ds_read_b64_tr_b16 v[62:63], v44 offset:13312
ds_read_b64_tr_b16 v[64:65], v46 offset:12288
ds_read_b64_tr_b16 v[66:67], v46 offset:13312
ds_read_b64_tr_b16 v[68:69], v45 offset:12288
ds_read_b64_tr_b16 v[70:71], v45 offset:13312
ds_read_b64_tr_b16 v[72:73], v47 offset:12288
ds_read_b64_tr_b16 v[74:75], v47 offset:13312
s_waitcnt lgkmcnt(0)
s_waitcnt vmcnt(17)
s_barrier
ds_write_b128 v2, v[60:63] offset:12288
ds_write_b128 v2, v[64:67] offset:13312
ds_write_b128 v2, v[68:71] offset:14336
ds_write_b128 v2, v[72:75] offset:15360
ds_read_b64_tr_b16 v[60:61], v44 offset:16384
ds_read_b64_tr_b16 v[62:63], v44 offset:17408
ds_read_b64_tr_b16 v[64:65], v46 offset:16384
ds_read_b64_tr_b16 v[66:67], v46 offset:17408
ds_read_b64_tr_b16 v[68:69], v45 offset:16384
ds_read_b64_tr_b16 v[70:71], v45 offset:17408
ds_read_b64_tr_b16 v[72:73], v47 offset:16384
ds_read_b64_tr_b16 v[74:75], v47 offset:17408
s_waitcnt lgkmcnt(0)
s_waitcnt vmcnt(13)
s_barrier
ds_write_b128 v2, v[60:63] offset:16384
ds_write_b128 v2, v[64:67] offset:17408
ds_write_b128 v2, v[68:71] offset:18432
ds_write_b128 v2, v[72:75] offset:19456
ds_read_b64_tr_b16 v[60:61], v48 offset:20480
ds_read_b64_tr_b16 v[62:63], v48 offset:21504
ds_read_b64_tr_b16 v[64:65], v48 offset:22528
ds_read_b64_tr_b16 v[66:67], v48 offset:23552
ds_read_b64_tr_b16 v[68:69], v49 offset:20480
ds_read_b64_tr_b16 v[70:71], v49 offset:21504
ds_read_b64_tr_b16 v[72:73], v49 offset:22528
ds_read_b64_tr_b16 v[74:75], v49 offset:23552
s_waitcnt lgkmcnt(0)
s_waitcnt vmcnt(9)
s_barrier
ds_write_b128 v2, v[60:63] offset:20480
ds_write_b128 v2, v[64:67] offset:21504
ds_write_b128 v2, v[68:71] offset:22528
ds_write_b128 v2, v[72:75] offset:23552
ds_read_b64_tr_b16 v[60:61], v48 offset:24576
ds_read_b64_tr_b16 v[62:63], v48 offset:25600
ds_read_b64_tr_b16 v[64:65], v48 offset:26624
ds_read_b64_tr_b16 v[66:67], v48 offset:27648
ds_read_b64_tr_b16 v[68:69], v49 offset:24576
ds_read_b64_tr_b16 v[70:71], v49 offset:25600
ds_read_b64_tr_b16 v[72:73], v49 offset:26624
ds_read_b64_tr_b16 v[74:75], v49 offset:27648
s_waitcnt lgkmcnt(0)
s_waitcnt vmcnt(5)
s_barrier
ds_write_b128 v2, v[60:63] offset:24576
ds_write_b128 v2, v[64:67] offset:25600
ds_write_b128 v2, v[68:71] offset:26624
ds_write_b128 v2, v[72:75] offset:27648
ds_read_b64_tr_b16 v[60:61], v48 offset:28672
ds_read_b64_tr_b16 v[62:63], v48 offset:29696
ds_read_b64_tr_b16 v[64:65], v48 offset:30720
ds_read_b64_tr_b16 v[66:67], v48 offset:31744
ds_read_b64_tr_b16 v[68:69], v49 offset:28672
ds_read_b64_tr_b16 v[70:71], v49 offset:29696
ds_read_b64_tr_b16 v[72:73], v49 offset:30720
ds_read_b64_tr_b16 v[74:75], v49 offset:31744
s_waitcnt lgkmcnt(0)
s_barrier
ds_write_b128 v2, v[60:63] offset:28672
ds_write_b128 v2, v[64:67] offset:29696
ds_write_b128 v2, v[68:71] offset:30720
ds_write_b128 v2, v[72:75] offset:31744
s_lshl_b32 s57, s58, 5
s_mov_b32 s0, 0x3f003f00
s_mov_b32 s1, 0x3f003f00
s_mov_b32 s58, 304128
s_cmp_eq_u32 s38, s57
s_mov_b32 s56, 0x33333333
s_mov_b32 s57, 0x33333333
s_mov_b32 s2, 0x21800000
s_mov_b32 s55, -24
s_cbranch_scc0 L_slow_w1
v_mov_b64 v[20:21], 0
v_mov_b64 v[22:23], 0
v_mov_b64 v[24:25], 0
v_mov_b64 v[26:27], 0
v_mov_b64 v[28:29], 0
v_mov_b64 v[30:31], 0
v_mov_b64 v[32:33], 0
v_mov_b64 v[34:35], 0
v_mov_b64 v[36:37], 0
v_mov_b64 v[38:39], 0
v_mov_b64 v[40:41], 0
v_mov_b64 v[42:43], 0
ds_read_b128 v[44:47], v2 offset:0
ds_read_b128 v[48:51], v2 offset:1024
v_bfe_u32 v77, v1, 6, 1
v_lshl_add_u32 v77, v77, 3, v1
v_lshlrev_b32 v77, 1, v77
s_waitcnt vmcnt(0) lgkmcnt(0)
s_branch L_top_w1f
L_done_w1f:
s_waitcnt vmcnt(0) lgkmcnt(0)
s_endpgm
L_rdv2_w1:
buffer_load_dword v32, v24, s[28:31], 0 offen sc0 sc1
s_sub_u32 s41, s41, 1
s_cbranch_scc1 L_exit
s_waitcnt vmcnt(0)
s_branch L_rdv_w1
L_ra0_w1f:
s_mov_b32 m0, 1024
s_nop 0
buffer_load_dwordx4 v1, s[4:7], s47 offen offset:0 sc1 lds
buffer_load_dwordx4 v1, s[4:7], s47 offen offset:1024 sc1 lds
buffer_load_dwordx4 v1, s[4:7], s47 offen offset:2048 sc1 lds
buffer_load_dwordx4 v1, s[4:7], s47 offen offset:3072 sc1 lds
s_sub_u32 s41, s41, 1
s_cbranch_scc1 L_exit
ds_read_b128 v[44:47], v2 offset:0
ds_read_b128 v[48:51], v2 offset:1024
v_mov_b64 v[20:21], 0
v_mov_b64 v[22:23], 0
v_mov_b64 v[24:25], 0
v_mov_b64 v[26:27], 0
v_mov_b64 v[28:29], 0
v_mov_b64 v[30:31], 0
v_mov_b64 v[32:33], 0
v_mov_b64 v[34:35], 0
v_mov_b64 v[36:37], 0
v_mov_b64 v[38:39], 0
v_mov_b64 v[40:41], 0
v_mov_b64 v[42:43], 0
s_waitcnt vmcnt(0)
ds_read_b128 v[60:63], v1 offset:1024
ds_read_b128 v[64:67], v1 offset:2048
ds_read_b128 v[68:71], v1 offset:3072
ds_read_b128 v[72:75], v1 offset:4096
s_branch L_s0_w1f
L_ra1_w1f:
s_waitcnt lgkmcnt(0)
s_barrier
s_mov_b32 m0, 5120
s_nop 0
buffer_load_dwordx4 v1, s[4:7], s48 offen offset:1024 sc1 lds
s_sub_u32 s41, s41, 1
s_cbranch_scc1 L_exit
s_waitcnt vmcnt(0)
s_barrier
ds_read_b128 v[76:79], v1 offset:5120
ds_read_b128 v[60:63], v1 offset:6144
ds_read_b128 v[64:67], v1 offset:7168
ds_read_b128 v[68:71], v1 offset:8192
ds_read_b128 v[72:75], v1 offset:9216
s_waitcnt lgkmcnt(0)
v_bitop3_b32 v6, v76, v60, s35 bitop3:0x7e
v_bitop3_b32 v6, v6, v64, s35 bitop3:0xf6
v_bitop3_b32 v6, v6, v68, s35 bitop3:0xf6
v_bitop3_b32 v6, v6, v72, s35 bitop3:0xf6
v_and_b32 v6, 1, v6
v_cmp_ne_u32 vcc, 0, v6
s_mov_b32 m0, 0
v_lshlrev_b32 v6, 3, v1
s_cbranch_vccnz L_ra1_w1f
s_branch L_a1_w1f
L_mx_w1f:
s_waitcnt lgkmcnt(0)
v_max3_f32 v30, v12, v13, v28
v_max_f32 v30, v30, v29
v_mov_b32 v31, v30
s_nop 1
v_permlane16_swap_b32 v30, v31
v_max_f32 v30, v30, v31
v_mov_b32 v31, v30
s_nop 1
v_permlane32_swap_b32 v30, v31
v_max_f32 v30, v30, v31
ds_write_b32 v1, v30 offset:10244
s_waitcnt lgkmcnt(0)
s_barrier
ds_read_b128 v[32:35], v1 offset:10240
s_waitcnt lgkmcnt(0)
v_max3_f32 v32, v32, v33, v34
v_max_f32 v32, v32, v35
v_sub_f32 v14, v12, v32
v_sub_f32 v15, v13, v32
v_sub_f32 v30, v28, v32
v_sub_f32 v31, v29, v32
v_exp_f32 v14, v14
v_exp_f32 v15, v15
v_exp_f32 v30, v30
v_exp_f32 v31, v31
v_cvt_pk_bf16_f32 v14, v14, v15
v_cvt_pk_bf16_f32 v30, v30, v31
ds_write_b32 v5, v14 offset:14624
v_cndmask_b32_e64 v24, 0, v30, s[56:57]
v_cndmask_b32_e64 v25, 0, v30, s[56:57]
v_mov_b64 v[76:77], s[52:53]
v_mov_b64 v[78:79], s[52:53]
v_mov_b32_dpp v26, v24 quad_perm:[2,3,0,1] row_mask:0xf bank_mask:0xf
v_mov_b32_dpp v27, v24 quad_perm:[2,3,0,1] row_mask:0xf bank_mask:0xf
s_waitcnt lgkmcnt(0)
s_barrier
v_mov_b64 v[14:15], s[0:1]
ds_read_b128 v[16:19], v1 offset:14368
ds_read_b128 v[40:43], v1 offset:14336
s_waitcnt lgkmcnt(0)
v_mfma_f32_16x16x32_bf16 v[32:35], v[76:79], v[16:19], 0
v_mfma_f32_16x16x32_bf16 v[20:23], v[52:55], v[16:19], 0
v_mfma_f32_16x16x32_bf16 v[20:23], v[56:59], v[40:43], v[20:23]
v_mfma_f32_16x16x16_bf16 v[32:35], v[14:15], v[24:25], v[32:35]
v_mfma_f32_16x16x32_bf16 v[20:23], v[36:39], v[24:27], v[20:23]
s_nop 3
v_rcp_f32 v33, v32
s_nop 2
v_mul_f32_dpp v20, v33, v20 quad_perm:[0,1,0,1] row_mask:0xf bank_mask:0xf
v_mul_f32_dpp v21, v33, v21 quad_perm:[0,1,0,1] row_mask:0xf bank_mask:0xf
v_mul_f32_dpp v22, v33, v22 quad_perm:[0,1,0,1] row_mask:0xf bank_mask:0xf
v_mul_f32_dpp v23, v33, v23 quad_perm:[0,1,0,1] row_mask:0xf bank_mask:0xf
v_cvt_pk_bf16_f32 v20, v20, v21
v_cvt_pk_bf16_f32 v21, v22, v23
ds_write_b64 v6, v[20:21] offset:6144
ds_read_b128 v[16:19], v7 offset:6144
v_mov_b64 v[76:77], 0
v_mov_b64 v[78:79], 0
v_mov_b64 v[40:41], 0
v_mov_b64 v[42:43], 0
v_mov_b64 v[24:25], 0
v_mov_b64 v[26:27], 0
v_mov_b64 v[32:33], 0
v_mov_b64 v[34:35], 0
s_waitcnt lgkmcnt(0)
s_branch L_mxb_w1f

L_slow_w1:
v_mov_b64 v[20:21], 0
v_mov_b64 v[22:23], 0
v_mov_b64 v[24:25], 0
v_mov_b64 v[26:27], 0
v_mov_b64 v[28:29], 0
v_mov_b64 v[30:31], 0
v_mov_b64 v[32:33], 0
v_mov_b64 v[34:35], 0
v_mov_b64 v[36:37], 0
v_mov_b64 v[38:39], 0
v_mov_b64 v[40:41], 0
v_mov_b64 v[42:43], 0
ds_read_b128 v[44:47], v2 offset:0
ds_read_b128 v[48:51], v2 offset:1024
v_bfe_u32 v77, v1, 6, 1
v_lshl_add_u32 v77, v77, 3, v1
v_lshlrev_b32 v77, 1, v77
s_waitcnt vmcnt(0) lgkmcnt(0)
s_branch L_top_w1s
L_done_w1s:
s_waitcnt vmcnt(0) lgkmcnt(0)
s_endpgm
L_ra0_w1s:
s_mov_b32 m0, 1024
s_nop 0
buffer_load_dwordx4 v1, s[4:7], s47 offen offset:0 sc0 sc1 lds
buffer_load_dwordx4 v1, s[4:7], s47 offen offset:1024 sc0 sc1 lds
buffer_load_dwordx4 v1, s[4:7], s47 offen offset:2048 sc0 sc1 lds
buffer_load_dwordx4 v1, s[4:7], s47 offen offset:3072 sc0 sc1 lds
s_sub_u32 s41, s41, 1
s_cbranch_scc1 L_exit
ds_read_b128 v[44:47], v2 offset:0
ds_read_b128 v[48:51], v2 offset:1024
v_mov_b64 v[20:21], 0
v_mov_b64 v[22:23], 0
v_mov_b64 v[24:25], 0
v_mov_b64 v[26:27], 0
v_mov_b64 v[28:29], 0
v_mov_b64 v[30:31], 0
v_mov_b64 v[32:33], 0
v_mov_b64 v[34:35], 0
v_mov_b64 v[36:37], 0
v_mov_b64 v[38:39], 0
v_mov_b64 v[40:41], 0
v_mov_b64 v[42:43], 0
s_waitcnt vmcnt(0)
ds_read_b128 v[60:63], v1 offset:1024
ds_read_b128 v[64:67], v1 offset:2048
ds_read_b128 v[68:71], v1 offset:3072
ds_read_b128 v[72:75], v1 offset:4096
s_branch L_s0_w1s
L_ra1_w1s:
s_waitcnt lgkmcnt(0)
s_barrier
s_mov_b32 m0, 5120
s_nop 0
buffer_load_dwordx4 v1, s[4:7], s48 offen offset:1024 sc0 sc1 lds
s_sub_u32 s41, s41, 1
s_cbranch_scc1 L_exit
s_waitcnt vmcnt(0)
s_barrier
ds_read_b128 v[76:79], v1 offset:5120
ds_read_b128 v[60:63], v1 offset:6144
ds_read_b128 v[64:67], v1 offset:7168
ds_read_b128 v[68:71], v1 offset:8192
ds_read_b128 v[72:75], v1 offset:9216
s_waitcnt lgkmcnt(0)
v_bitop3_b32 v6, v76, v60, s35 bitop3:0x7e
v_bitop3_b32 v6, v6, v64, s35 bitop3:0xf6
v_bitop3_b32 v6, v6, v68, s35 bitop3:0xf6
v_bitop3_b32 v6, v6, v72, s35 bitop3:0xf6
v_and_b32 v6, 1, v6
v_cmp_ne_u32 vcc, 0, v6
s_mov_b32 m0, 0
v_lshlrev_b32 v6, 3, v1
s_cbranch_vccnz L_ra1_w1s
s_branch L_a1_w1s
L_mx_w1s:
s_waitcnt lgkmcnt(0)
v_max3_f32 v30, v12, v13, v28
v_max_f32 v30, v30, v29
v_mov_b32 v31, v30
s_nop 1
v_permlane16_swap_b32 v30, v31
v_max_f32 v30, v30, v31
v_mov_b32 v31, v30
s_nop 1
v_permlane32_swap_b32 v30, v31
v_max_f32 v30, v30, v31
ds_write_b32 v1, v30 offset:10244
s_waitcnt lgkmcnt(0)
s_barrier
ds_read_b128 v[32:35], v1 offset:10240
s_waitcnt lgkmcnt(0)
v_max3_f32 v32, v32, v33, v34
v_max_f32 v32, v32, v35
v_sub_f32 v14, v12, v32
v_sub_f32 v15, v13, v32
v_sub_f32 v30, v28, v32
v_sub_f32 v31, v29, v32
v_exp_f32 v14, v14
v_exp_f32 v15, v15
v_exp_f32 v30, v30
v_exp_f32 v31, v31
v_cvt_pk_bf16_f32 v14, v14, v15
v_cvt_pk_bf16_f32 v30, v30, v31
ds_write_b32 v5, v14 offset:14624
v_cndmask_b32_e64 v24, 0, v30, s[56:57]
v_cndmask_b32_e64 v25, 0, v30, s[56:57]
v_mov_b64 v[76:77], s[52:53]
v_mov_b64 v[78:79], s[52:53]
v_mov_b32_dpp v26, v24 quad_perm:[2,3,0,1] row_mask:0xf bank_mask:0xf
v_mov_b32_dpp v27, v24 quad_perm:[2,3,0,1] row_mask:0xf bank_mask:0xf
s_waitcnt lgkmcnt(0)
s_barrier
v_mov_b64 v[14:15], s[0:1]
ds_read_b128 v[16:19], v1 offset:14368
ds_read_b128 v[40:43], v1 offset:14336
s_waitcnt lgkmcnt(0)
v_mfma_f32_16x16x32_bf16 v[32:35], v[76:79], v[16:19], 0
v_mfma_f32_16x16x32_bf16 v[20:23], v[52:55], v[16:19], 0
v_mfma_f32_16x16x32_bf16 v[20:23], v[56:59], v[40:43], v[20:23]
v_mfma_f32_16x16x16_bf16 v[32:35], v[14:15], v[24:25], v[32:35]
v_mfma_f32_16x16x32_bf16 v[20:23], v[36:39], v[24:27], v[20:23]
s_nop 3
v_rcp_f32 v33, v32
s_nop 2
v_mul_f32_dpp v20, v33, v20 quad_perm:[0,1,0,1] row_mask:0xf bank_mask:0xf
v_mul_f32_dpp v21, v33, v21 quad_perm:[0,1,0,1] row_mask:0xf bank_mask:0xf
v_mul_f32_dpp v22, v33, v22 quad_perm:[0,1,0,1] row_mask:0xf bank_mask:0xf
v_mul_f32_dpp v23, v33, v23 quad_perm:[0,1,0,1] row_mask:0xf bank_mask:0xf
v_cvt_pk_bf16_f32 v20, v20, v21
v_cvt_pk_bf16_f32 v21, v22, v23
ds_write_b64 v6, v[20:21] offset:6144
ds_read_b128 v[16:19], v7 offset:6144
v_mov_b64 v[76:77], 0
v_mov_b64 v[78:79], 0
v_mov_b64 v[40:41], 0
v_mov_b64 v[42:43], 0
v_mov_b64 v[24:25], 0
v_mov_b64 v[26:27], 0
v_mov_b64 v[32:33], 0
v_mov_b64 v[34:35], 0
s_waitcnt lgkmcnt(0)
s_branch L_mxb_w1s

L_pro_w1r:
v_and_b32 v20, 63, v0
v_and_b32 v21, 15, v0
v_bfe_u32 v22, v0, 4, 2
v_lshlrev_b32 v1, 4, v20
v_add_u32 v2, 57344, v1
v_lshrrev_b32 v24, 1, v22
v_and_b32 v23, 1, v22
v_lshl_add_u32 v23, v24, 3, v23
v_lshlrev_b32 v23, 13, v23
v_lshlrev_b32 v26, 1, v22
v_xor_b32 v26, v26, v21
v_lshl_add_u32 v26, v26, 4, v23
v_xor_b32 v27, 128, v26
v_and_b32 v23, 1, v22
v_lshl_add_u32 v23, v24, 4, v23
v_mul_u32_u24 v23, 1152, v23
v_lshlrev_b32 v28, 2, v22
v_xor_b32 v28, v28, v21
v_lshl_add_u32 v28, v28, 4, v23
s_lshl_b32 s54, s32, 8
s_mul_i32 s55, s32, 147456
s_waitcnt lgkmcnt(0)
s_add_u32 s56, s54, 655360
s_mov_b32 m0, 77824
s_nop 0
buffer_load_dwordx4 v26, s[8:11], s56 offen lds
s_add_u32 s56, s54, 671744
s_mov_b32 m0, 78848
s_nop 0
buffer_load_dwordx4 v26, s[8:11], s56 offen lds
s_add_u32 s56, s54, 688128
s_mov_b32 m0, 79872
s_nop 0
buffer_load_dwordx4 v27, s[8:11], s56 offen lds
s_add_u32 s56, s54, 704512
s_mov_b32 m0, 80896
s_nop 0
buffer_load_dwordx4 v27, s[8:11], s56 offen lds
s_add_u32 s56, s54, 1179648
s_mov_b32 m0, 81920
s_nop 0
buffer_load_dwordx4 v26, s[8:11], s56 offen lds
s_add_u32 s56, s54, 1196032
s_mov_b32 m0, 82944
s_nop 0
buffer_load_dwordx4 v26, s[8:11], s56 offen lds
s_add_u32 s56, s54, 1212416
s_mov_b32 m0, 83968
s_nop 0
buffer_load_dwordx4 v27, s[8:11], s56 offen lds
s_add_u32 s56, s54, 1228800
s_mov_b32 m0, 84992
s_nop 0
buffer_load_dwordx4 v27, s[8:11], s56 offen lds
v_and_b32 v23, 1, v22
v_lshrrev_b32 v24, 2, v21
v_lshl_add_u32 v23, v23, 2, v24
v_lshlrev_b32 v23, 1, v23
v_bfe_u32 v44, v21, 1, 1
v_add_u32 v44, 4, v44
v_xor_b32 v44, v44, v23
v_lshlrev_b32 v44, 4, v44
v_lshl_add_u32 v44, v24, 8, v44
v_and_b32 v23, 1, v22
v_lshl_add_u32 v44, v23, 11, v44
v_and_b32 v23, 1, v21
v_lshl_add_u32 v44, v23, 3, v44
v_lshrrev_b32 v23, 1, v22
v_mul_u32_u24 v23, 40960, v23
v_add_u32 v23, 16384, v23
v_add_u32 v44, v44, v23
v_and_b32 v23, 1, v22
v_lshrrev_b32 v24, 2, v21
v_lshl_add_u32 v23, v23, 2, v24
v_lshlrev_b32 v23, 1, v23
v_bfe_u32 v45, v21, 1, 1
v_add_u32 v45, 6, v45
v_xor_b32 v45, v45, v23
v_lshlrev_b32 v45, 4, v45
v_lshl_add_u32 v45, v24, 8, v45
v_and_b32 v23, 1, v22
v_lshl_add_u32 v45, v23, 11, v45
v_and_b32 v23, 1, v21
v_lshl_add_u32 v45, v23, 3, v45
v_lshrrev_b32 v23, 1, v22
v_mul_u32_u24 v23, 40960, v23
v_add_u32 v23, 16384, v23
v_add_u32 v45, v45, v23
v_and_b32 v23, 1, v22
v_lshrrev_b32 v24, 2, v21
v_lshl_add_u32 v23, v23, 2, v24
v_lshlrev_b32 v23, 1, v23
v_bfe_u32 v46, v21, 1, 1
v_add_u32 v46, 4, v46
v_xor_b32 v46, v46, v23
v_lshlrev_b32 v46, 4, v46
v_lshl_add_u32 v46, v24, 8, v46
v_and_b32 v23, 1, v22
v_lshl_add_u32 v46, v23, 11, v46
v_and_b32 v23, 1, v21
v_lshl_add_u32 v46, v23, 3, v46
v_lshrrev_b32 v23, 1, v22
v_mul_u32_u24 v23, 32768, v23
v_add_u32 v23, 98304, v23
v_add_u32 v46, v46, v23
v_and_b32 v23, 1, v22
v_lshrrev_b32 v24, 2, v21
v_lshl_add_u32 v23, v23, 2, v24
v_lshlrev_b32 v23, 1, v23
v_bfe_u32 v47, v21, 1, 1
v_add_u32 v47, 6, v47
v_xor_b32 v47, v47, v23
v_lshlrev_b32 v47, 4, v47
v_lshl_add_u32 v47, v24, 8, v47
v_and_b32 v23, 1, v22
v_lshl_add_u32 v47, v23, 11, v47
v_and_b32 v23, 1, v21
v_lshl_add_u32 v47, v23, 3, v47
v_lshrrev_b32 v23, 1, v22
v_mul_u32_u24 v23, 32768, v23
v_add_u32 v23, 98304, v23
v_add_u32 v47, v47, v23
v_and_b32 v23, 1, v22
v_bfe_u32 v24, v21, 2, 1
v_lshl_add_u32 v23, v23, 1, v24
v_xor_b32 v24, 1, v23
v_lshlrev_b32 v24, 6, v24
v_lshl_add_u32 v48, v23, 8, v24
v_and_b32 v23, 3, v21
v_lshl_add_u32 v48, v23, 4, v48
v_and_b32 v23, 8, v21
v_add_u32 v48, v48, v23
v_lshrrev_b32 v23, 1, v22
v_mul_u32_u24 v23, 40960, v23
v_add_u32 v23, 16384, v23
v_add_u32 v48, v48, v23
v_and_b32 v23, 1, v22
v_bfe_u32 v24, v21, 2, 1
v_lshl_add_u32 v23, v23, 1, v24
v_xor_b32 v24, 1, v23
v_lshlrev_b32 v24, 6, v24
v_lshl_add_u32 v49, v23, 8, v24
v_and_b32 v23, 3, v21
v_lshl_add_u32 v49, v23, 4, v49
v_and_b32 v23, 8, v21
v_add_u32 v49, v49, v23
v_lshrrev_b32 v23, 1, v22
v_mul_u32_u24 v23, 32768, v23
v_add_u32 v23, 98304, v23
v_add_u32 v49, v49, v23
v_bfe_u32 v23, v21, 1, 1
v_and_b32 v24, 1, v21
v_lshl_add_u32 v23, v24, 16, v23
v_mul_u32_u24 v23, 0xaaaa, v23
v_add_u32 v0, 0x44444444, v23
v_lshlrev_b32 v3, 3, v20
v_lshrrev_b32 v25, 5, v20
v_lshlrev_b32 v25, 6, v25
v_xor_b32 v3, v3, v25
v_lshrrev_b32 v25, 2, v20
v_and_b32 v4, 3, v21
v_lshl_add_u32 v4, v4, 4, v25
v_lshlrev_b32 v4, 3, v4
v_bfe_u32 v25, v21, 1, 1
v_lshlrev_b32 v23, 6, v25
v_xor_b32 v4, v4, v23
v_lshlrev_b32 v5, 4, v21
v_lshl_add_u32 v5, v22, 2, v5
v_mul_u32_u24 v23, 768, v25
v_add_u32 v5, v5, v23
v_lshlrev_b32 v9, 8, v22
v_lshl_add_u32 v9, v25, 6, v9
v_bfe_u32 v23, v21, 3, 1
v_lshl_add_u32 v9, v23, 7, v9
v_bfe_u32 v23, v21, 2, 1
v_lshl_add_u32 v9, v23, 5, v9
v_and_b32 v23, 1, v21
v_lshl_add_u32 v9, v23, 4, v9
v_lshrrev_b32 v23, 1, v22
v_and_b32 v24, 1, v22
v_and_b32 v25, 7, v21
v_lshrrev_b32 v7, 3, v21
v_lshl_add_u32 v8, v7, 1, v23
v_lshlrev_b32 v8, 12, v8
v_lshl_add_u32 v8, v24, 7, v8
v_and_b32 v25, 4, v21
v_lshl_add_u32 v8, v25, 3, v8
v_and_b32 v25, 1, v21
v_lshl_add_u32 v8, v25, 4, v8
v_bfe_u32 v25, v21, 1, 1
v_lshl_add_u32 v8, v25, 3, v8
s_lshr_b32 s56, s32, 1
s_lshl_b32 s56, s56, 8
s_and_b32 s57, s32, 1
s_lshl_b32 s57, s57, 6
s_add_u32 s56, s56, s57
s_add_u32 s56, s56, 16384
v_add_u32 v8, s56, v8
v_and_b32 v7, 12, v21
v_bfe_u32 v25, v21, 1, 1
v_add_u32 v7, v7, v25
v_lshlrev_b32 v7, 4, v7
v_lshl_add_u32 v7, v22, 8, v7
s_mov_b32 s42, 0
s_mov_b32 s43, 65536
s_mov_b32 s44, 131072
s_mov_b32 s45, 196608
s_mov_b32 s46, 262144
s_mov_b32 s47, 294912
s_mov_b32 s48, 299008
s_mov_b32 s49, 303104
s_mov_b32 s50, 0x3e0293ee
s_mov_b32 s51, 0x3e0293ee
s_mov_b32 s52, 0x3f803f80
s_mov_b32 s53, 0x3f803f80
v_and_b32 v11, 3, v21
v_cmp_eq_u32 vcc, 0, v11
s_nop 1
v_cndmask_b32 v11, 0, 1, vcc
s_mov_b32 s34, 0
s_mov_b32 s35, -1
s_mov_b32 s36, 0
s_mov_b32 s41, 300000
s_lshl_b32 s37, s32, 14
s_add_u32 s39, s37, 17309696
s_add_u32 s37, s37, 16781312
s_mov_b32 s40, 8749056
v_mov_b64 v[36:37], 0
v_mov_b64 v[38:39], 0
ds_write_b128 v1, v[36:39] offset:15360
s_lshl_b32 s56, s32, 1
s_add_u32 s56, s56, 0
s_cmp_eq_u32 s56, 0
s_cselect_b32 s56, 64, s56
s_mul_i32 s56, s56, 10240
s_add_u32 s56, s56, 8392704
s_add_u32 s57, s56, 4096
v_mov_b32 v40, 0
v_mov_b32 v41, 0
v_mov_b32 v42, 0
v_mov_b32 v43, 0
buffer_store_dwordx4 v[40:43], v1, s[4:7], s56 offen offset:0 sc0 sc1
buffer_store_dwordx4 v[40:43], v1, s[4:7], s56 offen offset:1024 sc0 sc1
buffer_store_dwordx4 v[40:43], v1, s[4:7], s56 offen offset:2048 sc0 sc1
buffer_store_dwordx4 v[40:43], v1, s[4:7], s56 offen offset:3072 sc0 sc1
buffer_store_dwordx4 v[40:43], v1, s[4:7], s57 offen offset:0 sc0 sc1
s_add_u32 s56, s32, 64
s_lshl_b32 s3, s56, 12
v_and_b32 v23, 1, v21
v_bfe_u32 v24, v21, 2, 1
v_bfe_u32 v25, v21, 1, 1
s_lshl_b32 s57, s56, 7
s_add_u32 s57, s57, 294912
v_and_b32 v10, 7, v21
v_lshlrev_b32 v10, 2, v10
v_lshl_add_u32 v10, v22, 5, v10
v_add_u32 v10, s57, v10
s_lshl_b32 s33, s56, 2
s_add_u32 s33, s33, 304128
v_mov_b32 v30, -1
s_mov_b64 exec, 1
buffer_store_dword v30, v1, s[4:7], s33 offen sc0 sc1
s_mov_b64 exec, -1
v_lshl_add_u32 v23, v23, 1, v24
v_lshlrev_b32 v25, 4, v25
v_mov_b32 v24, 0x3f80
v_lshlrev_b32 v24, v25, v24
v_cmp_eq_u32 vcc, 0, v23
s_nop 1
v_cndmask_b32 v76, 0, v24, vcc
v_cmp_eq_u32 vcc, 1, v23
s_nop 1
v_cndmask_b32 v77, 0, v24, vcc
v_cmp_eq_u32 vcc, 2, v23
s_nop 1
v_cndmask_b32 v78, 0, v24, vcc
v_cmp_eq_u32 vcc, 3, v23
s_nop 1
v_cndmask_b32 v79, 0, v24, vcc
buffer_store_dwordx4 v[36:39], v9, s[4:7], s3 offen offset:0 sc0 sc1
buffer_store_dwordx4 v[36:39], v9, s[4:7], s3 offen offset:1024 sc0 sc1
buffer_store_dwordx4 v[36:39], v9, s[4:7], s3 offen offset:2048 sc0 sc1
buffer_store_dwordx4 v[36:39], v9, s[4:7], s3 offen offset:3072 sc0 sc1
s_getreg_b32 s56, hwreg(HW_REG_XCC_ID)
s_and_b32 s56, s56, 15
s_mul_i32 s57, s56, s56
s_lshl_b32 s57, s57, 18
s_lshl_b32 s56, s56, 8
s_add_u32 s57, s57, s56
s_add_u32 s58, s57, 1
s_lshl_b32 s101, s32, 7
s_add_u32 s101, s101, 327680
v_mov_b32 v24, 0
s_add_u32 s56, s54, 2752512
s_mov_b32 m0, 86016
s_nop 0
buffer_load_dwordx4 v26, s[8:11], s56 offen lds
s_add_u32 s56, s54, 2768896
s_mov_b32 m0, 87040
s_nop 0
buffer_load_dwordx4 v26, s[8:11], s56 offen lds
s_add_u32 s56, s54, 2785280
s_mov_b32 m0, 88064
s_nop 0
buffer_load_dwordx4 v27, s[8:11], s56 offen lds
s_add_u32 s56, s54, 2801664
s_mov_b32 m0, 89088
s_nop 0
buffer_load_dwordx4 v27, s[8:11], s56 offen lds
s_add_u32 s56, s54, 3276800
s_mov_b32 m0, 57344
s_nop 0
buffer_load_dwordx4 v26, s[8:11], s56 offen lds
s_add_u32 s56, s54, 3293184
s_mov_b32 m0, 58368
s_nop 0
buffer_load_dwordx4 v26, s[8:11], s56 offen lds
s_add_u32 s56, s54, 3309568
s_mov_b32 m0, 59392
s_nop 0
buffer_load_dwordx4 v27, s[8:11], s56 offen lds
s_add_u32 s56, s54, 3325952
s_mov_b32 m0, 60416
s_nop 0
buffer_load_dwordx4 v27, s[8:11], s56 offen lds
s_add_u32 s56, s54, 3801088
s_mov_b32 m0, 61440
s_nop 0
buffer_load_dwordx4 v26, s[8:11], s56 offen lds
s_add_u32 s56, s54, 3817472
s_mov_b32 m0, 62464
s_nop 0
buffer_load_dwordx4 v26, s[8:11], s56 offen lds
s_add_u32 s56, s54, 3833856
s_mov_b32 m0, 63488
s_nop 0
buffer_load_dwordx4 v27, s[8:11], s56 offen lds
s_add_u32 s56, s54, 3850240
s_mov_b32 m0, 64512
s_nop 0
buffer_load_dwordx4 v27, s[8:11], s56 offen lds
s_add_u32 s56, s54, 4325376
s_mov_b32 m0, 65536
s_nop 0
buffer_load_dwordx4 v26, s[8:11], s56 offen lds
s_add_u32 s56, s54, 4341760
s_mov_b32 m0, 66560
s_nop 0
buffer_load_dwordx4 v26, s[8:11], s56 offen lds
s_add_u32 s56, s54, 4358144
s_mov_b32 m0, 67584
s_nop 0
buffer_load_dwordx4 v27, s[8:11], s56 offen lds
s_add_u32 s56, s54, 4374528
s_mov_b32 m0, 68608
s_nop 0
buffer_load_dwordx4 v27, s[8:11], s56 offen lds
s_add_u32 s56, s54, 131072
s_mov_b32 m0, 69632
s_nop 0
buffer_load_dwordx4 v26, s[12:15], s56 offen lds
s_add_u32 s56, s54, 147456
s_mov_b32 m0, 70656
s_nop 0
buffer_load_dwordx4 v26, s[12:15], s56 offen lds
s_add_u32 s56, s54, 163840
s_mov_b32 m0, 71680
s_nop 0
buffer_load_dwordx4 v27, s[12:15], s56 offen lds
s_add_u32 s56, s54, 180224
s_mov_b32 m0, 72704
s_nop 0
buffer_load_dwordx4 v27, s[12:15], s56 offen lds
s_add_u32 s56, s54, 655360
s_mov_b32 m0, 73728
s_nop 0
buffer_load_dwordx4 v26, s[12:15], s56 offen lds
s_add_u32 s56, s54, 671744
s_mov_b32 m0, 74752
s_nop 0
buffer_load_dwordx4 v26, s[12:15], s56 offen lds
s_add_u32 s56, s54, 688128
s_mov_b32 m0, 75776
s_nop 0
buffer_load_dwordx4 v27, s[12:15], s56 offen lds
s_add_u32 s56, s54, 704512
s_mov_b32 m0, 76800
s_nop 0
buffer_load_dwordx4 v27, s[12:15], s56 offen lds
v_and_b32 v23, 3, v20
v_lshrrev_b32 v24, 2, v20
v_mul_u32_u24 v29, 1152, v24
v_lshl_add_u32 v29, v23, 4, v29
v_lshrrev_b32 v24, 2, v21
v_and_b32 v25, 1, v22
v_lshlrev_b32 v31, 10, v25
v_lshrrev_b32 v25, 1, v22
v_lshl_add_u32 v31, v25, 8, v31
v_and_b32 v25, 1, v24
v_lshl_add_u32 v31, v25, 6, v31
v_lshrrev_b32 v25, 1, v24
v_lshl_add_u32 v31, v25, 3, v31
v_lshl_add_u32 v31, v23, 4, v31
v_add_u32 v31, 57344, v31
s_add_u32 s56, s55, 1088
s_mov_b32 m0, 90112
s_nop 0
buffer_load_dwordx4 v29, s[20:23], s56 offen lds
s_add_u32 s56, s55, 19520
s_mov_b32 m0, 91136
s_nop 0
buffer_load_dwordx4 v29, s[20:23], s56 offen lds
s_add_u32 s56, s55, 37952
s_mov_b32 m0, 94208
s_nop 0
buffer_load_dwordx4 v29, s[20:23], s56 offen lds
s_add_u32 s56, s55, 56384
s_mov_b32 m0, 95232
s_nop 0
buffer_load_dwordx4 v29, s[20:23], s56 offen lds
s_add_u32 s56, s55, 74816
s_mov_b32 m0, 92160
s_nop 0
buffer_load_dwordx4 v29, s[20:23], s56 offen lds
s_add_u32 s56, s55, 93248
s_mov_b32 m0, 93184
s_nop 0
buffer_load_dwordx4 v29, s[20:23], s56 offen lds
s_add_u32 s56, s55, 111680
s_mov_b32 m0, 96256
s_nop 0
buffer_load_dwordx4 v29, s[20:23], s56 offen lds
s_add_u32 s56, s55, 130112
s_mov_b32 m0, 97280
s_nop 0
buffer_load_dwordx4 v29, s[20:23], s56 offen lds
v_mov_b32 v24, 0
s_waitcnt vmcnt(46)
s_barrier
ds_read_b64_tr_b16 v[80:81], v44 offset:20480
ds_read_b64_tr_b16 v[82:83], v44 offset:21504
ds_read_b64_tr_b16 v[84:85], v46 offset:20480
ds_read_b64_tr_b16 v[86:87], v46 offset:21504
ds_read_b64_tr_b16 v[88:89], v45 offset:20480
ds_read_b64_tr_b16 v[90:91], v45 offset:21504
ds_read_b64_tr_b16 v[92:93], v47 offset:20480
ds_read_b64_tr_b16 v[94:95], v47 offset:21504
s_waitcnt lgkmcnt(0)
s_waitcnt vmcnt(42)
s_barrier
s_add_u32 s56, s54, 1179648
s_mov_b32 m0, 77824
s_nop 0
buffer_load_dwordx4 v26, s[12:15], s56 offen lds
s_add_u32 s56, s54, 1196032
s_mov_b32 m0, 78848
s_nop 0
buffer_load_dwordx4 v26, s[12:15], s56 offen lds
s_add_u32 s56, s54, 1212416
s_mov_b32 m0, 79872
s_nop 0
buffer_load_dwordx4 v27, s[12:15], s56 offen lds
s_add_u32 s56, s54, 1228800
s_mov_b32 m0, 80896
s_nop 0
buffer_load_dwordx4 v27, s[12:15], s56 offen lds
ds_read_b64_tr_b16 v[96:97], v44 offset:24576
ds_read_b64_tr_b16 v[98:99], v44 offset:25600
ds_read_b64_tr_b16 v[100:101], v46 offset:24576
ds_read_b64_tr_b16 v[102:103], v46 offset:25600
ds_read_b64_tr_b16 v[104:105], v45 offset:24576
ds_read_b64_tr_b16 v[106:107], v45 offset:25600
ds_read_b64_tr_b16 v[108:109], v47 offset:24576
ds_read_b64_tr_b16 v[110:111], v47 offset:25600
s_waitcnt lgkmcnt(0)
s_waitcnt vmcnt(32)
s_barrier
s_add_u32 s56, s54, 1703936
s_mov_b32 m0, 81920
s_nop 0
buffer_load_dwordx4 v26, s[12:15], s56 offen lds
s_add_u32 s56, s54, 1720320
s_mov_b32 m0, 82944
s_nop 0
buffer_load_dwordx4 v26, s[12:15], s56 offen lds
s_add_u32 s56, s54, 1736704
s_mov_b32 m0, 83968
s_nop 0
buffer_load_dwordx4 v27, s[12:15], s56 offen lds
s_add_u32 s56, s54, 1753088
s_mov_b32 m0, 84992
s_nop 0
buffer_load_dwordx4 v27, s[12:15], s56 offen lds
ds_read_b64_tr_b16 v[112:113], v44 offset:28672
ds_read_b64_tr_b16 v[114:115], v44 offset:29696
ds_read_b64_tr_b16 v[116:117], v46 offset:28672
ds_read_b64_tr_b16 v[118:119], v46 offset:29696
ds_read_b64_tr_b16 v[120:121], v45 offset:28672
ds_read_b64_tr_b16 v[122:123], v45 offset:29696
ds_read_b64_tr_b16 v[124:125], v47 offset:28672
ds_read_b64_tr_b16 v[126:127], v47 offset:29696
s_waitcnt lgkmcnt(0)
s_waitcnt vmcnt(32)
s_barrier
s_add_u32 s56, s54, 2228224
s_mov_b32 m0, 86016
s_nop 0
buffer_load_dwordx4 v26, s[12:15], s56 offen lds
s_add_u32 s56, s54, 2244608
s_mov_b32 m0, 87040
s_nop 0
buffer_load_dwordx4 v26, s[12:15], s56 offen lds
s_add_u32 s56, s54, 2260992
s_mov_b32 m0, 88064
s_nop 0
buffer_load_dwordx4 v27, s[12:15], s56 offen lds
s_add_u32 s56, s54, 2277376
s_mov_b32 m0, 89088
s_nop 0
buffer_load_dwordx4 v27, s[12:15], s56 offen lds
ds_read_b64_tr_b16 v[128:129], v44 offset:0
ds_read_b64_tr_b16 v[130:131], v44 offset:1024
ds_read_b64_tr_b16 v[132:133], v46 offset:0
ds_read_b64_tr_b16 v[134:135], v46 offset:1024
ds_read_b64_tr_b16 v[136:137], v45 offset:0
ds_read_b64_tr_b16 v[138:139], v45 offset:1024
ds_read_b64_tr_b16 v[140:141], v47 offset:0
ds_read_b64_tr_b16 v[142:143], v47 offset:1024
s_waitcnt lgkmcnt(0)
s_waitcnt vmcnt(32)
s_barrier
s_add_u32 s56, s54, 3276800
s_mov_b32 m0, 57344
s_nop 0
buffer_load_dwordx4 v26, s[12:15], s56 offen lds
s_add_u32 s56, s54, 3293184
s_mov_b32 m0, 58368
s_nop 0
buffer_load_dwordx4 v26, s[12:15], s56 offen lds
s_add_u32 s56, s54, 3309568
s_mov_b32 m0, 59392
s_nop 0
buffer_load_dwordx4 v27, s[12:15], s56 offen lds
s_add_u32 s56, s54, 3325952
s_mov_b32 m0, 60416
s_nop 0
buffer_load_dwordx4 v27, s[12:15], s56 offen lds
ds_read_b64_tr_b16 v[144:145], v44 offset:4096
ds_read_b64_tr_b16 v[146:147], v44 offset:5120
ds_read_b64_tr_b16 v[148:149], v46 offset:4096
ds_read_b64_tr_b16 v[150:151], v46 offset:5120
ds_read_b64_tr_b16 v[152:153], v45 offset:4096
ds_read_b64_tr_b16 v[154:155], v45 offset:5120
ds_read_b64_tr_b16 v[156:157], v47 offset:4096
ds_read_b64_tr_b16 v[158:159], v47 offset:5120
s_waitcnt lgkmcnt(0)
s_waitcnt vmcnt(32)
s_barrier
s_add_u32 s56, s54, 3801088
s_mov_b32 m0, 61440
s_nop 0
buffer_load_dwordx4 v26, s[12:15], s56 offen lds
s_add_u32 s56, s54, 3817472
s_mov_b32 m0, 62464
s_nop 0
buffer_load_dwordx4 v26, s[12:15], s56 offen lds
s_add_u32 s56, s54, 3833856
s_mov_b32 m0, 63488
s_nop 0
buffer_load_dwordx4 v27, s[12:15], s56 offen lds
s_add_u32 s56, s54, 3850240
s_mov_b32 m0, 64512
s_nop 0
buffer_load_dwordx4 v27, s[12:15], s56 offen lds
ds_read_b64_tr_b16 v[160:161], v44 offset:8192
ds_read_b64_tr_b16 v[162:163], v44 offset:9216
ds_read_b64_tr_b16 v[164:165], v46 offset:8192
ds_read_b64_tr_b16 v[166:167], v46 offset:9216
ds_read_b64_tr_b16 v[168:169], v45 offset:8192
ds_read_b64_tr_b16 v[170:171], v45 offset:9216
ds_read_b64_tr_b16 v[172:173], v47 offset:8192
ds_read_b64_tr_b16 v[174:175], v47 offset:9216
s_waitcnt lgkmcnt(0)
s_waitcnt vmcnt(32)
s_barrier
s_add_u32 s56, s54, 4325376
s_mov_b32 m0, 65536
s_nop 0
buffer_load_dwordx4 v26, s[12:15], s56 offen lds
s_add_u32 s56, s54, 4341760
s_mov_b32 m0, 66560
s_nop 0
buffer_load_dwordx4 v26, s[12:15], s56 offen lds
s_add_u32 s56, s54, 4358144
s_mov_b32 m0, 67584
s_nop 0
buffer_load_dwordx4 v27, s[12:15], s56 offen lds
s_add_u32 s56, s54, 4374528
s_mov_b32 m0, 68608
s_nop 0
buffer_load_dwordx4 v27, s[12:15], s56 offen lds
ds_read_b64_tr_b16 v[176:177], v44 offset:12288
ds_read_b64_tr_b16 v[178:179], v44 offset:13312
ds_read_b64_tr_b16 v[180:181], v46 offset:12288
ds_read_b64_tr_b16 v[182:183], v46 offset:13312
ds_read_b64_tr_b16 v[184:185], v45 offset:12288
ds_read_b64_tr_b16 v[186:187], v45 offset:13312
ds_read_b64_tr_b16 v[188:189], v47 offset:12288
ds_read_b64_tr_b16 v[190:191], v47 offset:13312
s_waitcnt lgkmcnt(0)
s_waitcnt vmcnt(32)
s_barrier
s_add_u32 s56, s54, 131072
s_mov_b32 m0, 69632
s_nop 0
buffer_load_dwordx4 v26, s[16:19], s56 offen lds
s_add_u32 s56, s54, 147456
s_mov_b32 m0, 70656
s_nop 0
buffer_load_dwordx4 v26, s[16:19], s56 offen lds
s_add_u32 s56, s54, 163840
s_mov_b32 m0, 71680
s_nop 0
buffer_load_dwordx4 v27, s[16:19], s56 offen lds
s_add_u32 s56, s54, 180224
s_mov_b32 m0, 72704
s_nop 0
buffer_load_dwordx4 v27, s[16:19], s56 offen lds
ds_read_b64_tr_b16 v[192:193], v44 offset:16384
ds_read_b64_tr_b16 v[194:195], v44 offset:17408
ds_read_b64_tr_b16 v[196:197], v46 offset:16384
ds_read_b64_tr_b16 v[198:199], v46 offset:17408
ds_read_b64_tr_b16 v[200:201], v45 offset:16384
ds_read_b64_tr_b16 v[202:203], v45 offset:17408
ds_read_b64_tr_b16 v[204:205], v47 offset:16384
ds_read_b64_tr_b16 v[206:207], v47 offset:17408
s_waitcnt lgkmcnt(0)
s_waitcnt vmcnt(24)
s_barrier
s_add_u32 s56, s54, 655360
s_mov_b32 m0, 73728
s_nop 0
buffer_load_dwordx4 v26, s[16:19], s56 offen lds
s_add_u32 s56, s54, 671744
s_mov_b32 m0, 74752
s_nop 0
buffer_load_dwordx4 v26, s[16:19], s56 offen lds
s_add_u32 s56, s54, 688128
s_mov_b32 m0, 75776
s_nop 0
buffer_load_dwordx4 v27, s[16:19], s56 offen lds
s_add_u32 s56, s54, 704512
s_mov_b32 m0, 76800
s_nop 0
buffer_load_dwordx4 v27, s[16:19], s56 offen lds
ds_read_b64_tr_b16 v[208:209], v44 offset:20480
ds_read_b64_tr_b16 v[210:211], v44 offset:21504
ds_read_b64_tr_b16 v[212:213], v46 offset:20480
ds_read_b64_tr_b16 v[214:215], v46 offset:21504
ds_read_b64_tr_b16 v[216:217], v45 offset:20480
ds_read_b64_tr_b16 v[218:219], v45 offset:21504
ds_read_b64_tr_b16 v[220:221], v47 offset:20480
ds_read_b64_tr_b16 v[222:223], v47 offset:21504
s_waitcnt lgkmcnt(0)
s_waitcnt vmcnt(24)
s_barrier
s_add_u32 s56, s54, 1179648
s_mov_b32 m0, 77824
s_nop 0
buffer_load_dwordx4 v26, s[16:19], s56 offen lds
s_add_u32 s56, s54, 1196032
s_mov_b32 m0, 78848
s_nop 0
buffer_load_dwordx4 v26, s[16:19], s56 offen lds
s_add_u32 s56, s54, 1212416
s_mov_b32 m0, 79872
s_nop 0
buffer_load_dwordx4 v27, s[16:19], s56 offen lds
s_add_u32 s56, s54, 1228800
s_mov_b32 m0, 80896
s_nop 0
buffer_load_dwordx4 v27, s[16:19], s56 offen lds
ds_read_b64_tr_b16 v[224:225], v44 offset:24576
ds_read_b64_tr_b16 v[226:227], v44 offset:25600
ds_read_b64_tr_b16 v[228:229], v46 offset:24576
ds_read_b64_tr_b16 v[230:231], v46 offset:25600
ds_read_b64_tr_b16 v[232:233], v45 offset:24576
ds_read_b64_tr_b16 v[234:235], v45 offset:25600
ds_read_b64_tr_b16 v[236:237], v47 offset:24576
ds_read_b64_tr_b16 v[238:239], v47 offset:25600
ds_read_b64_tr_b16 v[60:61], v31 offset:32768
ds_read_b64_tr_b16 v[62:63], v31 offset:32896
ds_read_b64_tr_b16 v[64:65], v31 offset:33280
ds_read_b64_tr_b16 v[66:67], v31 offset:33408
ds_read_b64_tr_b16 v[68:69], v31 offset:34816
ds_read_b64_tr_b16 v[70:71], v31 offset:34944
ds_read_b64_tr_b16 v[72:73], v31 offset:35328
ds_read_b64_tr_b16 v[74:75], v31 offset:35456
s_waitcnt lgkmcnt(0)
ds_write_b128 v2, v[60:63] offset:32768
ds_write_b128 v2, v[64:67] offset:33792
ds_write_b128 v2, v[68:71] offset:34816
ds_write_b128 v2, v[72:75] offset:35840
s_waitcnt lgkmcnt(0)
s_waitcnt vmcnt(24)
s_barrier
s_add_u32 s56, s54, 1703936
s_mov_b32 m0, 81920
s_nop 0
buffer_load_dwordx4 v26, s[16:19], s56 offen lds
s_add_u32 s56, s54, 1720320
s_mov_b32 m0, 82944
s_nop 0
buffer_load_dwordx4 v26, s[16:19], s56 offen lds
s_add_u32 s56, s54, 1736704
s_mov_b32 m0, 83968
s_nop 0
buffer_load_dwordx4 v27, s[16:19], s56 offen lds
s_add_u32 s56, s54, 1753088
s_mov_b32 m0, 84992
s_nop 0
buffer_load_dwordx4 v27, s[16:19], s56 offen lds
ds_read_b64_tr_b16 v[240:241], v44 offset:28672
ds_read_b64_tr_b16 v[242:243], v44 offset:29696
ds_read_b64_tr_b16 v[244:245], v46 offset:28672
ds_read_b64_tr_b16 v[246:247], v46 offset:29696
ds_read_b64_tr_b16 v[248:249], v45 offset:28672
ds_read_b64_tr_b16 v[250:251], v45 offset:29696
ds_read_b64_tr_b16 v[252:253], v47 offset:28672
ds_read_b64_tr_b16 v[254:255], v47 offset:29696
ds_read_b64_tr_b16 v[60:61], v31 offset:36864
ds_read_b64_tr_b16 v[62:63], v31 offset:36992
ds_read_b64_tr_b16 v[64:65], v31 offset:37376
ds_read_b64_tr_b16 v[66:67], v31 offset:37504
ds_read_b64_tr_b16 v[68:69], v31 offset:38912
ds_read_b64_tr_b16 v[70:71], v31 offset:39040
ds_read_b64_tr_b16 v[72:73], v31 offset:39424
ds_read_b64_tr_b16 v[74:75], v31 offset:39552
s_waitcnt lgkmcnt(0)
ds_write_b128 v2, v[60:63] offset:36864
ds_write_b128 v2, v[64:67] offset:37888
ds_write_b128 v2, v[68:71] offset:38912
ds_write_b128 v2, v[72:75] offset:39936
s_waitcnt lgkmcnt(0)
s_waitcnt vmcnt(24)
s_barrier
s_add_u32 s56, s54, 2228224
s_mov_b32 m0, 86016
s_nop 0
buffer_load_dwordx4 v26, s[16:19], s56 offen lds
s_add_u32 s56, s54, 2244608
s_mov_b32 m0, 87040
s_nop 0
buffer_load_dwordx4 v26, s[16:19], s56 offen lds
s_add_u32 s56, s54, 2260992
s_mov_b32 m0, 88064
s_nop 0
buffer_load_dwordx4 v27, s[16:19], s56 offen lds
s_add_u32 s56, s54, 2277376
s_mov_b32 m0, 89088
s_nop 0
buffer_load_dwordx4 v27, s[16:19], s56 offen lds
ds_read_b64_tr_b16 a[0:1], v44 offset:0
ds_read_b64_tr_b16 a[2:3], v44 offset:1024
ds_read_b64_tr_b16 a[4:5], v46 offset:0
ds_read_b64_tr_b16 a[6:7], v46 offset:1024
ds_read_b64_tr_b16 a[8:9], v45 offset:0
ds_read_b64_tr_b16 a[10:11], v45 offset:1024
ds_read_b64_tr_b16 a[12:13], v47 offset:0
ds_read_b64_tr_b16 a[14:15], v47 offset:1024
s_waitcnt lgkmcnt(0)
s_waitcnt vmcnt(24)
s_barrier
s_add_u32 s56, s54, 2752512
s_mov_b32 m0, 57344
s_nop 0
buffer_load_dwordx4 v26, s[16:19], s56 offen lds
s_add_u32 s56, s54, 2768896
s_mov_b32 m0, 58368
s_nop 0
buffer_load_dwordx4 v26, s[16:19], s56 offen lds
s_add_u32 s56, s54, 2785280
s_mov_b32 m0, 59392
s_nop 0
buffer_load_dwordx4 v27, s[16:19], s56 offen lds
s_add_u32 s56, s54, 2801664
s_mov_b32 m0, 60416
s_nop 0
buffer_load_dwordx4 v27, s[16:19], s56 offen lds
ds_read_b64_tr_b16 a[16:17], v44 offset:4096
ds_read_b64_tr_b16 a[18:19], v44 offset:5120
ds_read_b64_tr_b16 a[20:21], v46 offset:4096
ds_read_b64_tr_b16 a[22:23], v46 offset:5120
ds_read_b64_tr_b16 a[24:25], v45 offset:4096
ds_read_b64_tr_b16 a[26:27], v45 offset:5120
ds_read_b64_tr_b16 a[28:29], v47 offset:4096
ds_read_b64_tr_b16 a[30:31], v47 offset:5120
s_waitcnt lgkmcnt(0)
s_waitcnt vmcnt(24)
s_barrier
s_add_u32 s56, s54, 3276800
s_mov_b32 m0, 61440
s_nop 0
buffer_load_dwordx4 v26, s[16:19], s56 offen lds
s_add_u32 s56, s54, 3293184
s_mov_b32 m0, 62464
s_nop 0
buffer_load_dwordx4 v26, s[16:19], s56 offen lds
s_add_u32 s56, s54, 3309568
s_mov_b32 m0, 63488
s_nop 0
buffer_load_dwordx4 v27, s[16:19], s56 offen lds
s_add_u32 s56, s54, 3325952
s_mov_b32 m0, 64512
s_nop 0
buffer_load_dwordx4 v27, s[16:19], s56 offen lds
ds_read_b64_tr_b16 a[32:33], v44 offset:8192
ds_read_b64_tr_b16 a[34:35], v44 offset:9216
ds_read_b64_tr_b16 a[36:37], v46 offset:8192
ds_read_b64_tr_b16 a[38:39], v46 offset:9216
ds_read_b64_tr_b16 a[40:41], v45 offset:8192
ds_read_b64_tr_b16 a[42:43], v45 offset:9216
ds_read_b64_tr_b16 a[44:45], v47 offset:8192
ds_read_b64_tr_b16 a[46:47], v47 offset:9216
s_waitcnt lgkmcnt(0)
s_waitcnt vmcnt(24)
s_barrier
s_add_u32 s56, s54, 3801088
s_mov_b32 m0, 65536
s_nop 0
buffer_load_dwordx4 v26, s[16:19], s56 offen lds
s_add_u32 s56, s54, 3817472
s_mov_b32 m0, 66560
s_nop 0
buffer_load_dwordx4 v26, s[16:19], s56 offen lds
s_add_u32 s56, s54, 3833856
s_mov_b32 m0, 67584
s_nop 0
buffer_load_dwordx4 v27, s[16:19], s56 offen lds
s_add_u32 s56, s54, 3850240
s_mov_b32 m0, 68608
s_nop 0
buffer_load_dwordx4 v27, s[16:19], s56 offen lds
ds_read_b64_tr_b16 a[48:49], v44 offset:12288
ds_read_b64_tr_b16 a[50:51], v44 offset:13312
ds_read_b64_tr_b16 a[52:53], v46 offset:12288
ds_read_b64_tr_b16 a[54:55], v46 offset:13312
ds_read_b64_tr_b16 a[56:57], v45 offset:12288
ds_read_b64_tr_b16 a[58:59], v45 offset:13312
ds_read_b64_tr_b16 a[60:61], v47 offset:12288
ds_read_b64_tr_b16 a[62:63], v47 offset:13312
s_waitcnt lgkmcnt(0)
s_waitcnt vmcnt(24)
s_barrier
s_add_u32 s56, s55, 41472
s_mov_b32 m0, 69632
s_nop 0
buffer_load_dwordx4 v28, s[20:23], s56 offen lds
s_add_u32 s56, s55, 43776
s_mov_b32 m0, 70656
s_nop 0
buffer_load_dwordx4 v28, s[20:23], s56 offen lds
s_add_u32 s56, s55, 50688
s_mov_b32 m0, 71680
s_nop 0
buffer_load_dwordx4 v28, s[20:23], s56 offen lds
s_add_u32 s56, s55, 52992
s_mov_b32 m0, 72704
s_nop 0
buffer_load_dwordx4 v28, s[20:23], s56 offen lds
ds_read_b64_tr_b16 a[64:65], v44 offset:16384
ds_read_b64_tr_b16 a[66:67], v44 offset:17408
ds_read_b64_tr_b16 a[68:69], v46 offset:16384
ds_read_b64_tr_b16 a[70:71], v46 offset:17408
ds_read_b64_tr_b16 a[72:73], v45 offset:16384
ds_read_b64_tr_b16 a[74:75], v45 offset:17408
ds_read_b64_tr_b16 a[76:77], v47 offset:16384
ds_read_b64_tr_b16 a[78:79], v47 offset:17408
s_waitcnt lgkmcnt(0)
s_waitcnt vmcnt(24)
s_barrier
s_add_u32 s56, s55, 41728
s_mov_b32 m0, 73728
s_nop 0
buffer_load_dwordx4 v28, s[20:23], s56 offen lds
s_add_u32 s56, s55, 44032
s_mov_b32 m0, 74752
s_nop 0
buffer_load_dwordx4 v28, s[20:23], s56 offen lds
s_add_u32 s56, s55, 50944
s_mov_b32 m0, 75776
s_nop 0
buffer_load_dwordx4 v28, s[20:23], s56 offen lds
s_add_u32 s56, s55, 53248
s_mov_b32 m0, 76800
s_nop 0
buffer_load_dwordx4 v28, s[20:23], s56 offen lds
ds_read_b64_tr_b16 a[80:81], v44 offset:20480
ds_read_b64_tr_b16 a[82:83], v44 offset:21504
ds_read_b64_tr_b16 a[84:85], v46 offset:20480
ds_read_b64_tr_b16 a[86:87], v46 offset:21504
ds_read_b64_tr_b16 a[88:89], v45 offset:20480
ds_read_b64_tr_b16 a[90:91], v45 offset:21504
ds_read_b64_tr_b16 a[92:93], v47 offset:20480
ds_read_b64_tr_b16 a[94:95], v47 offset:21504
s_waitcnt lgkmcnt(0)
s_waitcnt vmcnt(24)
s_barrier
s_add_u32 s56, s55, 41984
s_mov_b32 m0, 77824
s_nop 0
buffer_load_dwordx4 v28, s[20:23], s56 offen lds
s_add_u32 s56, s55, 44288
s_mov_b32 m0, 78848
s_nop 0
buffer_load_dwordx4 v28, s[20:23], s56 offen lds
s_add_u32 s56, s55, 51200
s_mov_b32 m0, 79872
s_nop 0
buffer_load_dwordx4 v28, s[20:23], s56 offen lds
s_add_u32 s56, s55, 53504
s_mov_b32 m0, 80896
s_nop 0
buffer_load_dwordx4 v28, s[20:23], s56 offen lds
ds_read_b64_tr_b16 a[96:97], v44 offset:24576
ds_read_b64_tr_b16 a[98:99], v44 offset:25600
ds_read_b64_tr_b16 a[100:101], v46 offset:24576
ds_read_b64_tr_b16 a[102:103], v46 offset:25600
ds_read_b64_tr_b16 a[104:105], v45 offset:24576
ds_read_b64_tr_b16 a[106:107], v45 offset:25600
ds_read_b64_tr_b16 a[108:109], v47 offset:24576
ds_read_b64_tr_b16 a[110:111], v47 offset:25600
s_waitcnt lgkmcnt(0)
s_waitcnt vmcnt(24)
s_barrier
s_add_u32 s56, s55, 42240
s_mov_b32 m0, 81920
s_nop 0
buffer_load_dwordx4 v28, s[20:23], s56 offen lds
s_add_u32 s56, s55, 44544
s_mov_b32 m0, 82944
s_nop 0
buffer_load_dwordx4 v28, s[20:23], s56 offen lds
s_add_u32 s56, s55, 51456
s_mov_b32 m0, 83968
s_nop 0
buffer_load_dwordx4 v28, s[20:23], s56 offen lds
s_add_u32 s56, s55, 53760
s_mov_b32 m0, 84992
s_nop 0
buffer_load_dwordx4 v28, s[20:23], s56 offen lds
ds_read_b64_tr_b16 a[112:113], v44 offset:28672
ds_read_b64_tr_b16 a[114:115], v44 offset:29696
ds_read_b64_tr_b16 a[116:117], v46 offset:28672
ds_read_b64_tr_b16 a[118:119], v46 offset:29696
ds_read_b64_tr_b16 a[120:121], v45 offset:28672
ds_read_b64_tr_b16 a[122:123], v45 offset:29696
ds_read_b64_tr_b16 a[124:125], v47 offset:28672
ds_read_b64_tr_b16 a[126:127], v47 offset:29696
s_waitcnt lgkmcnt(0)
s_waitcnt vmcnt(24)
s_barrier
s_add_u32 s56, s55, 5376
s_mov_b32 m0, 86016
s_nop 0
buffer_load_dwordx4 v28, s[20:23], s56 offen lds
s_add_u32 s56, s55, 7680
s_mov_b32 m0, 87040
s_nop 0
buffer_load_dwordx4 v28, s[20:23], s56 offen lds
s_add_u32 s56, s55, 14592
s_mov_b32 m0, 88064
s_nop 0
buffer_load_dwordx4 v28, s[20:23], s56 offen lds
s_add_u32 s56, s55, 16896
s_mov_b32 m0, 89088
s_nop 0
buffer_load_dwordx4 v28, s[20:23], s56 offen lds
ds_read_b64_tr_b16 a[128:129], v44 offset:0
ds_read_b64_tr_b16 a[130:131], v44 offset:1024
ds_read_b64_tr_b16 a[132:133], v46 offset:0
ds_read_b64_tr_b16 a[134:135], v46 offset:1024
ds_read_b64_tr_b16 a[136:137], v45 offset:0
ds_read_b64_tr_b16 a[138:139], v45 offset:1024
ds_read_b64_tr_b16 a[140:141], v47 offset:0
ds_read_b64_tr_b16 a[142:143], v47 offset:1024
buffer_load_dword v32, v24, s[28:31], 0 offen sc0 sc1
s_waitcnt lgkmcnt(0)
s_waitcnt vmcnt(25)
s_barrier
s_add_u32 s56, s54, 131072
s_mov_b32 m0, 57344
s_nop 0
buffer_load_dwordx4 v26, s[8:11], s56 offen lds
s_add_u32 s56, s54, 147456
s_mov_b32 m0, 58368
s_nop 0
buffer_load_dwordx4 v26, s[8:11], s56 offen lds
s_add_u32 s56, s54, 163840
s_mov_b32 m0, 59392
s_nop 0
buffer_load_dwordx4 v27, s[8:11], s56 offen lds
s_add_u32 s56, s54, 180224
s_mov_b32 m0, 60416
s_nop 0
buffer_load_dwordx4 v27, s[8:11], s56 offen lds
ds_read_b64_tr_b16 a[144:145], v44 offset:4096
ds_read_b64_tr_b16 a[146:147], v44 offset:5120
ds_read_b64_tr_b16 a[148:149], v46 offset:4096
ds_read_b64_tr_b16 a[150:151], v46 offset:5120
ds_read_b64_tr_b16 a[152:153], v45 offset:4096
ds_read_b64_tr_b16 a[154:155], v45 offset:5120
ds_read_b64_tr_b16 a[156:157], v47 offset:4096
ds_read_b64_tr_b16 a[158:159], v47 offset:5120
s_waitcnt lgkmcnt(0)
s_waitcnt vmcnt(25)
s_barrier
s_add_u32 s56, s54, 1703936
s_mov_b32 m0, 61440
s_nop 0
buffer_load_dwordx4 v26, s[8:11], s56 offen lds
s_add_u32 s56, s54, 1720320
s_mov_b32 m0, 62464
s_nop 0
buffer_load_dwordx4 v26, s[8:11], s56 offen lds
s_add_u32 s56, s54, 1736704
s_mov_b32 m0, 63488
s_nop 0
buffer_load_dwordx4 v27, s[8:11], s56 offen lds
s_add_u32 s56, s54, 1753088
s_mov_b32 m0, 64512
s_nop 0
buffer_load_dwordx4 v27, s[8:11], s56 offen lds
ds_read_b64_tr_b16 a[160:161], v44 offset:8192
ds_read_b64_tr_b16 a[162:163], v44 offset:9216
ds_read_b64_tr_b16 a[164:165], v46 offset:8192
ds_read_b64_tr_b16 a[166:167], v46 offset:9216
ds_read_b64_tr_b16 a[168:169], v45 offset:8192
ds_read_b64_tr_b16 a[170:171], v45 offset:9216
ds_read_b64_tr_b16 a[172:173], v47 offset:8192
ds_read_b64_tr_b16 a[174:175], v47 offset:9216
s_waitcnt lgkmcnt(0)
s_waitcnt vmcnt(25)
s_barrier
s_add_u32 s56, s54, 2228224
s_mov_b32 m0, 65536
s_nop 0
buffer_load_dwordx4 v26, s[8:11], s56 offen lds
s_add_u32 s56, s54, 2244608
s_mov_b32 m0, 66560
s_nop 0
buffer_load_dwordx4 v26, s[8:11], s56 offen lds
s_add_u32 s56, s54, 2260992
s_mov_b32 m0, 67584
s_nop 0
buffer_load_dwordx4 v27, s[8:11], s56 offen lds
s_add_u32 s56, s54, 2277376
s_mov_b32 m0, 68608
s_nop 0
buffer_load_dwordx4 v27, s[8:11], s56 offen lds
ds_read_b64_tr_b16 a[176:177], v48 offset:12288
ds_read_b64_tr_b16 a[178:179], v48 offset:13312
ds_read_b64_tr_b16 a[180:181], v48 offset:14336
ds_read_b64_tr_b16 a[182:183], v48 offset:15360
ds_read_b64_tr_b16 a[192:193], v49 offset:12288
ds_read_b64_tr_b16 a[194:195], v49 offset:13312
ds_read_b64_tr_b16 a[196:197], v49 offset:14336
ds_read_b64_tr_b16 a[198:199], v49 offset:15360
s_waitcnt lgkmcnt(0)
s_waitcnt vmcnt(25)
s_barrier
s_add_u32 s56, s54, 2752512
s_mov_b32 m0, 69632
s_nop 0
buffer_load_dwordx4 v26, s[12:15], s56 offen lds
s_add_u32 s56, s54, 2768896
s_mov_b32 m0, 70656
s_nop 0
buffer_load_dwordx4 v26, s[12:15], s56 offen lds
s_add_u32 s56, s54, 2785280
s_mov_b32 m0, 71680
s_nop 0
buffer_load_dwordx4 v27, s[12:15], s56 offen lds
s_add_u32 s56, s54, 2801664
s_mov_b32 m0, 72704
s_nop 0
buffer_load_dwordx4 v27, s[12:15], s56 offen lds
ds_read_b64_tr_b16 a[184:185], v48 offset:16384
ds_read_b64_tr_b16 a[186:187], v48 offset:17408
ds_read_b64_tr_b16 a[188:189], v48 offset:18432
ds_read_b64_tr_b16 a[190:191], v48 offset:19456
ds_read_b64_tr_b16 a[200:201], v49 offset:16384
ds_read_b64_tr_b16 a[202:203], v49 offset:17408
ds_read_b64_tr_b16 a[204:205], v49 offset:18432
ds_read_b64_tr_b16 a[206:207], v49 offset:19456
s_waitcnt lgkmcnt(0)
s_waitcnt vmcnt(25)
s_barrier
s_add_u32 s56, s54, 4325376
s_mov_b32 m0, 73728
s_nop 0
buffer_load_dwordx4 v26, s[16:19], s56 offen lds
s_add_u32 s56, s54, 4341760
s_mov_b32 m0, 74752
s_nop 0
buffer_load_dwordx4 v26, s[16:19], s56 offen lds
s_add_u32 s56, s54, 4358144
s_mov_b32 m0, 75776
s_nop 0
buffer_load_dwordx4 v27, s[16:19], s56 offen lds
s_add_u32 s56, s54, 4374528
s_mov_b32 m0, 76800
s_nop 0
buffer_load_dwordx4 v27, s[16:19], s56 offen lds
ds_read_b64_tr_b16 a[208:209], v48 offset:20480
ds_read_b64_tr_b16 a[210:211], v48 offset:21504
ds_read_b64_tr_b16 a[212:213], v48 offset:22528
ds_read_b64_tr_b16 a[214:215], v48 offset:23552
ds_read_b64_tr_b16 a[216:217], v49 offset:20480
ds_read_b64_tr_b16 a[218:219], v49 offset:21504
ds_read_b64_tr_b16 a[220:221], v49 offset:22528
ds_read_b64_tr_b16 a[222:223], v49 offset:23552
s_waitcnt lgkmcnt(0)
s_waitcnt vmcnt(25)
s_barrier
s_add_u32 s56, s55, 4608
s_mov_b32 m0, 77824
s_nop 0
buffer_load_dwordx4 v28, s[20:23], s56 offen lds
s_add_u32 s56, s55, 6912
s_mov_b32 m0, 78848
s_nop 0
buffer_load_dwordx4 v28, s[20:23], s56 offen lds
s_add_u32 s56, s55, 13824
s_mov_b32 m0, 79872
s_nop 0
buffer_load_dwordx4 v28, s[20:23], s56 offen lds
s_add_u32 s56, s55, 16128
s_mov_b32 m0, 80896
s_nop 0
buffer_load_dwordx4 v28, s[20:23], s56 offen lds
ds_read_b64_tr_b16 a[224:225], v48 offset:24576
ds_read_b64_tr_b16 a[226:227], v48 offset:25600
ds_read_b64_tr_b16 a[228:229], v48 offset:26624
ds_read_b64_tr_b16 a[230:231], v48 offset:27648
ds_read_b64_tr_b16 a[240:241], v49 offset:24576
ds_read_b64_tr_b16 a[242:243], v49 offset:25600
ds_read_b64_tr_b16 a[244:245], v49 offset:26624
ds_read_b64_tr_b16 a[246:247], v49 offset:27648
s_waitcnt lgkmcnt(0)
s_waitcnt vmcnt(25)
s_barrier
s_add_u32 s56, s55, 4864
s_mov_b32 m0, 81920
s_nop 0
buffer_load_dwordx4 v28, s[20:23], s56 offen lds
s_add_u32 s56, s55, 7168
s_mov_b32 m0, 82944
s_nop 0
buffer_load_dwordx4 v28, s[20:23], s56 offen lds
s_add_u32 s56, s55, 14080
s_mov_b32 m0, 83968
s_nop 0
buffer_load_dwordx4 v28, s[20:23], s56 offen lds
s_add_u32 s56, s55, 16384
s_mov_b32 m0, 84992
s_nop 0
buffer_load_dwordx4 v28, s[20:23], s56 offen lds
ds_read_b64_tr_b16 a[248:249], v48 offset:28672
ds_read_b64_tr_b16 a[250:251], v48 offset:29696
ds_read_b64_tr_b16 a[252:253], v48 offset:30720
ds_read_b64_tr_b16 a[254:255], v48 offset:31744
ds_read_b64_tr_b16 a[232:233], v49 offset:28672
ds_read_b64_tr_b16 a[234:235], v49 offset:29696
ds_read_b64_tr_b16 a[236:237], v49 offset:30720
ds_read_b64_tr_b16 a[238:239], v49 offset:31744
s_waitcnt lgkmcnt(0)
s_waitcnt vmcnt(24)
s_barrier
s_add_u32 s56, s55, 5120
s_mov_b32 m0, 86016
s_nop 0
buffer_load_dwordx4 v28, s[20:23], s56 offen lds
s_add_u32 s56, s55, 7424
s_mov_b32 m0, 87040
s_nop 0
buffer_load_dwordx4 v28, s[20:23], s56 offen lds
s_add_u32 s56, s55, 14336
s_mov_b32 m0, 88064
s_nop 0
buffer_load_dwordx4 v28, s[20:23], s56 offen lds
s_add_u32 s56, s55, 16640
s_mov_b32 m0, 89088
s_nop 0
buffer_load_dwordx4 v28, s[20:23], s56 offen lds
ds_read_b64_tr_b16 v[60:61], v44 offset:0
ds_read_b64_tr_b16 v[62:63], v44 offset:1024
ds_read_b64_tr_b16 v[64:65], v46 offset:0
ds_read_b64_tr_b16 v[66:67], v46 offset:1024
ds_read_b64_tr_b16 v[68:69], v45 offset:0
ds_read_b64_tr_b16 v[70:71], v45 offset:1024
ds_read_b64_tr_b16 v[72:73], v47 offset:0
ds_read_b64_tr_b16 v[74:75], v47 offset:1024
s_waitcnt lgkmcnt(0)
s_waitcnt vmcnt(24)
s_barrier
ds_write_b128 v2, v[60:63] offset:0
ds_write_b128 v2, v[64:67] offset:1024
ds_write_b128 v2, v[68:71] offset:2048
ds_write_b128 v2, v[72:75] offset:3072
ds_read_b64_tr_b16 v[60:61], v44 offset:4096
ds_read_b64_tr_b16 v[62:63], v44 offset:5120
ds_read_b64_tr_b16 v[64:65], v46 offset:4096
ds_read_b64_tr_b16 v[66:67], v46 offset:5120
ds_read_b64_tr_b16 v[68:69], v45 offset:4096
ds_read_b64_tr_b16 v[70:71], v45 offset:5120
ds_read_b64_tr_b16 v[72:73], v47 offset:4096
ds_read_b64_tr_b16 v[74:75], v47 offset:5120
L_rdv_w1r:
v_readfirstlane_b32 s38, v32
s_nop 0
s_and_b32 s57, s38, 0xff
s_cmp_lg_u32 s57, 32
s_cbranch_scc1 L_rdv2_w1r
s_waitcnt lgkmcnt(0)
s_waitcnt vmcnt(20)
s_barrier
ds_write_b128 v2, v[60:63] offset:4096
ds_write_b128 v2, v[64:67] offset:5120
ds_write_b128 v2, v[68:71] offset:6144
ds_write_b128 v2, v[72:75] offset:7168
ds_read_b64_tr_b16 v[60:61], v44 offset:8192
ds_read_b64_tr_b16 v[62:63], v44 offset:9216
ds_read_b64_tr_b16 v[64:65], v46 offset:8192
ds_read_b64_tr_b16 v[66:67], v46 offset:9216
ds_read_b64_tr_b16 v[68:69], v45 offset:8192
ds_read_b64_tr_b16 v[70:71], v45 offset:9216
ds_read_b64_tr_b16 v[72:73], v47 offset:8192
ds_read_b64_tr_b16 v[74:75], v47 offset:9216
buffer_load_dwordx4 v[12:15], v9, s[4:7], s37 offen offset:0
buffer_load_dwordx4 v[16:19], v9, s[4:7], s37 offen offset:1024
buffer_load_dwordx4 v[52:55], v1, s[4:7], s37 offen offset:2048
buffer_load_dwordx4 v[56:59], v1, s[4:7], s37 offen offset:3072
s_mov_b32 m0, 1024
s_nop 0
buffer_load_dwordx4 v1, s[4:7], s47 offen offset:1024 sc0 sc1 lds
s_waitcnt lgkmcnt(0)
s_waitcnt vmcnt(21)
s_barrier
ds_write_b128 v2, v[60:63] offset:8192
ds_write_b128 v2, v[64:67] offset:9216
ds_write_b128 v2, v[68:71] offset:10240
ds_write_b128 v2, v[72:75] offset:11264
ds_read_b64_tr_b16 v[60:61], v44 offset:12288
ds_read_b64_tr_b16 v[62:63], v44 offset:13312
ds_read_b64_tr_b16 v[64:65], v46 offset:12288
ds_read_b64_tr_b16 v[66:67], v46 offset:13312
ds_read_b64_tr_b16 v[68:69], v45 offset:12288
ds_read_b64_tr_b16 v[70:71], v45 offset:13312
ds_read_b64_tr_b16 v[72:73], v47 offset:12288
ds_read_b64_tr_b16 v[74:75], v47 offset:13312
s_waitcnt lgkmcnt(0)
s_waitcnt vmcnt(17)
s_barrier
ds_write_b128 v2, v[60:63] offset:12288
ds_write_b128 v2, v[64:67] offset:13312
ds_write_b128 v2, v[68:71] offset:14336
ds_write_b128 v2, v[72:75] offset:15360
ds_read_b64_tr_b16 v[60:61], v44 offset:16384
ds_read_b64_tr_b16 v[62:63], v44 offset:17408
ds_read_b64_tr_b16 v[64:65], v46 offset:16384
ds_read_b64_tr_b16 v[66:67], v46 offset:17408
ds_read_b64_tr_b16 v[68:69], v45 offset:16384
ds_read_b64_tr_b16 v[70:71], v45 offset:17408
ds_read_b64_tr_b16 v[72:73], v47 offset:16384
ds_read_b64_tr_b16 v[74:75], v47 offset:17408
s_waitcnt lgkmcnt(0)
s_waitcnt vmcnt(13)
s_barrier
ds_write_b128 v2, v[60:63] offset:16384
ds_write_b128 v2, v[64:67] offset:17408
ds_write_b128 v2, v[68:71] offset:18432
ds_write_b128 v2, v[72:75] offset:19456
ds_read_b64_tr_b16 v[60:61], v48 offset:20480
ds_read_b64_tr_b16 v[62:63], v48 offset:21504
ds_read_b64_tr_b16 v[64:65], v48 offset:22528
ds_read_b64_tr_b16 v[66:67], v48 offset:23552
ds_read_b64_tr_b16 v[68:69], v49 offset:20480
ds_read_b64_tr_b16 v[70:71], v49 offset:21504
ds_read_b64_tr_b16 v[72:73], v49 offset:22528
ds_read_b64_tr_b16 v[74:75], v49 offset:23552
s_waitcnt lgkmcnt(0)
s_waitcnt vmcnt(9)
s_barrier
ds_write_b128 v2, v[60:63] offset:20480
ds_write_b128 v2, v[64:67] offset:21504
ds_write_b128 v2, v[68:71] offset:22528
ds_write_b128 v2, v[72:75] offset:23552
ds_read_b64_tr_b16 v[60:61], v48 offset:24576
ds_read_b64_tr_b16 v[62:63], v48 offset:25600
ds_read_b64_tr_b16 v[64:65], v48 offset:26624
ds_read_b64_tr_b16 v[66:67], v48 offset:27648
ds_read_b64_tr_b16 v[68:69], v49 offset:24576
ds_read_b64_tr_b16 v[70:71], v49 offset:25600
ds_read_b64_tr_b16 v[72:73], v49 offset:26624
ds_read_b64_tr_b16 v[74:75], v49 offset:27648
s_waitcnt lgkmcnt(0)
s_waitcnt vmcnt(5)
s_barrier
ds_write_b128 v2, v[60:63] offset:24576
ds_write_b128 v2, v[64:67] offset:25600
ds_write_b128 v2, v[68:71] offset:26624
ds_write_b128 v2, v[72:75] offset:27648
ds_read_b64_tr_b16 v[60:61], v48 offset:28672
ds_read_b64_tr_b16 v[62:63], v48 offset:29696
ds_read_b64_tr_b16 v[64:65], v48 offset:30720
ds_read_b64_tr_b16 v[66:67], v48 offset:31744
ds_read_b64_tr_b16 v[68:69], v49 offset:28672
ds_read_b64_tr_b16 v[70:71], v49 offset:29696
ds_read_b64_tr_b16 v[72:73], v49 offset:30720
ds_read_b64_tr_b16 v[74:75], v49 offset:31744
s_waitcnt lgkmcnt(0)
s_barrier
ds_write_b128 v2, v[60:63] offset:28672
ds_write_b128 v2, v[64:67] offset:29696
ds_write_b128 v2, v[68:71] offset:30720
ds_write_b128 v2, v[72:75] offset:31744
s_lshl_b32 s57, s58, 5
s_mov_b32 s0, 0x3f003f00
s_mov_b32 s1, 0x3f003f00
s_mov_b32 s58, 304128
s_cmp_eq_u32 s38, s57
s_mov_b32 s56, 0x33333333
s_mov_b32 s57, 0x33333333
s_mov_b32 s2, 0x21800000
s_mov_b32 s55, -24
s_cbranch_scc0 L_slow_w1r
v_mov_b64 v[20:21], 0
v_mov_b64 v[22:23], 0
v_mov_b64 v[24:25], 0
v_mov_b64 v[26:27], 0
v_mov_b64 v[28:29], 0
v_mov_b64 v[30:31], 0
v_mov_b64 v[32:33], 0
v_mov_b64 v[34:35], 0
v_mov_b64 v[36:37], 0
v_mov_b64 v[38:39], 0
v_mov_b64 v[40:41], 0
v_mov_b64 v[42:43], 0
ds_read_b128 v[44:47], v2 offset:0
ds_read_b128 v[48:51], v2 offset:1024
v_bfe_u32 v77, v1, 6, 1
v_lshl_add_u32 v77, v77, 3, v1
v_lshlrev_b32 v77, 1, v77
s_waitcnt vmcnt(0) lgkmcnt(0)
s_branch L_top_w1rf
L_done_w1rf:
buffer_store_dword v11, v10, s[4:7], s40 offen sc0 sc1
s_waitcnt vmcnt(0) lgkmcnt(0)
s_endpgm
L_rdv2_w1r:
buffer_load_dword v32, v24, s[28:31], 0 offen sc0 sc1
s_sub_u32 s41, s41, 1
s_cbranch_scc1 L_exit
s_waitcnt vmcnt(0)
s_branch L_rdv_w1r
L_ra0_w1rf:
s_mov_b32 m0, 1024
s_nop 0
buffer_load_dwordx4 v1, s[4:7], s47 offen offset:0 sc1 lds
buffer_load_dwordx4 v1, s[4:7], s47 offen offset:1024 sc1 lds
buffer_load_dwordx4 v1, s[4:7], s47 offen offset:2048 sc1 lds
buffer_load_dwordx4 v1, s[4:7], s47 offen offset:3072 sc1 lds
s_sub_u32 s41, s41, 1
s_cbranch_scc1 L_exit
ds_read_b128 v[44:47], v2 offset:0
ds_read_b128 v[48:51], v2 offset:1024
v_mov_b64 v[20:21], 0
v_mov_b64 v[22:23], 0
v_mov_b64 v[24:25], 0
v_mov_b64 v[26:27], 0
v_mov_b64 v[28:29], 0
v_mov_b64 v[30:31], 0
v_mov_b64 v[32:33], 0
v_mov_b64 v[34:35], 0
v_mov_b64 v[36:37], 0
v_mov_b64 v[38:39], 0
v_mov_b64 v[40:41], 0
v_mov_b64 v[42:43], 0
s_waitcnt vmcnt(0)
ds_read_b128 v[60:63], v1 offset:1024
ds_read_b128 v[64:67], v1 offset:2048
ds_read_b128 v[68:71], v1 offset:3072
ds_read_b128 v[72:75], v1 offset:4096
s_branch L_s0_w1rf
L_ra1_w1rf:
s_waitcnt lgkmcnt(0)
s_barrier
s_mov_b32 m0, 5120
s_nop 0
buffer_load_dwordx4 v1, s[4:7], s48 offen offset:1024 sc1 lds
s_sub_u32 s41, s41, 1
s_cbranch_scc1 L_exit
s_waitcnt vmcnt(0)
s_barrier
ds_read_b128 v[76:79], v1 offset:5120
ds_read_b128 v[60:63], v1 offset:6144
ds_read_b128 v[64:67], v1 offset:7168
ds_read_b128 v[68:71], v1 offset:8192
ds_read_b128 v[72:75], v1 offset:9216
s_waitcnt lgkmcnt(0)
v_bitop3_b32 v6, v76, v60, s35 bitop3:0x7e
v_bitop3_b32 v6, v6, v64, s35 bitop3:0xf6
v_bitop3_b32 v6, v6, v68, s35 bitop3:0xf6
v_bitop3_b32 v6, v6, v72, s35 bitop3:0xf6
v_and_b32 v6, 1, v6
v_cmp_ne_u32 vcc, 0, v6
s_mov_b32 m0, 0
v_lshlrev_b32 v6, 3, v1
s_cbranch_vccnz L_ra1_w1rf
s_branch L_a1_w1rf
L_mx_w1rf:
s_waitcnt lgkmcnt(0)
v_max3_f32 v30, v12, v13, v28
v_max_f32 v30, v30, v29
v_mov_b32 v31, v30
s_nop 1
v_permlane16_swap_b32 v30, v31
v_max_f32 v30, v30, v31
v_mov_b32 v31, v30
s_nop 1
v_permlane32_swap_b32 v30, v31
v_max_f32 v30, v30, v31
ds_write_b32 v1, v30 offset:10244
s_waitcnt lgkmcnt(0)
s_barrier
ds_read_b128 v[32:35], v1 offset:10240
s_waitcnt lgkmcnt(0)
v_max3_f32 v32, v32, v33, v34
v_max_f32 v32, v32, v35
v_sub_f32 v14, v12, v32
v_sub_f32 v15, v13, v32
v_sub_f32 v30, v28, v32
v_sub_f32 v31, v29, v32
v_exp_f32 v14, v14
v_exp_f32 v15, v15
v_exp_f32 v30, v30
v_exp_f32 v31, v31
v_cvt_pk_bf16_f32 v14, v14, v15
v_cvt_pk_bf16_f32 v30, v30, v31
ds_write_b32 v5, v14 offset:14624
v_cndmask_b32_e64 v24, 0, v30, s[56:57]
v_cndmask_b32_e64 v25, 0, v30, s[56:57]
v_mov_b64 v[76:77], s[52:53]
v_mov_b64 v[78:79], s[52:53]
v_mov_b32_dpp v26, v24 quad_perm:[2,3,0,1] row_mask:0xf bank_mask:0xf
v_mov_b32_dpp v27, v24 quad_perm:[2,3,0,1] row_mask:0xf bank_mask:0xf
s_waitcnt lgkmcnt(0)
s_barrier
v_mov_b64 v[14:15], s[0:1]
ds_read_b128 v[16:19], v1 offset:14368
ds_read_b128 v[40:43], v1 offset:14336
s_waitcnt lgkmcnt(0)
v_mfma_f32_16x16x32_bf16 v[32:35], v[76:79], v[16:19], 0
v_mfma_f32_16x16x32_bf16 v[20:23], v[52:55], v[16:19], 0
v_mfma_f32_16x16x32_bf16 v[20:23], v[56:59], v[40:43], v[20:23]
v_mfma_f32_16x16x16_bf16 v[32:35], v[14:15], v[24:25], v[32:35]
v_mfma_f32_16x16x32_bf16 v[20:23], v[36:39], v[24:27], v[20:23]
s_nop 3
v_rcp_f32 v33, v32
s_nop 2
v_mul_f32_dpp v20, v33, v20 quad_perm:[0,1,0,1] row_mask:0xf bank_mask:0xf
v_mul_f32_dpp v21, v33, v21 quad_perm:[0,1,0,1] row_mask:0xf bank_mask:0xf
v_mul_f32_dpp v22, v33, v22 quad_perm:[0,1,0,1] row_mask:0xf bank_mask:0xf
v_mul_f32_dpp v23, v33, v23 quad_perm:[0,1,0,1] row_mask:0xf bank_mask:0xf
v_cvt_pk_bf16_f32 v20, v20, v21
v_cvt_pk_bf16_f32 v21, v22, v23
ds_write_b64 v6, v[20:21] offset:6144
ds_read_b128 v[16:19], v7 offset:6144
v_mov_b64 v[76:77], 0
v_mov_b64 v[78:79], 0
v_mov_b64 v[40:41], 0
v_mov_b64 v[42:43], 0
v_mov_b64 v[24:25], 0
v_mov_b64 v[26:27], 0
v_mov_b64 v[32:33], 0
v_mov_b64 v[34:35], 0
s_waitcnt lgkmcnt(0)
s_branch L_mxb_w1rf

L_rr_w1rf:
buffer_load_dwordx4 v[60:63], v9, s[4:7], s3 offen offset:0 sc1
buffer_load_dwordx4 v[64:67], v9, s[4:7], s3 offen offset:1024 sc1
buffer_load_dwordx4 v[68:71], v9, s[4:7], s3 offen offset:2048 sc1
buffer_load_dwordx4 v[72:75], v9, s[4:7], s3 offen offset:3072 sc1
s_sub_u32 s41, s41, 1
s_cbranch_scc1 L_exit
s_waitcnt vmcnt(0)
s_branch L_r_w1rf
L_slow_w1r:
v_mov_b64 v[20:21], 0
v_mov_b64 v[22:23], 0
v_mov_b64 v[24:25], 0
v_mov_b64 v[26:27], 0
v_mov_b64 v[28:29], 0
v_mov_b64 v[30:31], 0
v_mov_b64 v[32:33], 0
v_mov_b64 v[34:35], 0
v_mov_b64 v[36:37], 0
v_mov_b64 v[38:39], 0
v_mov_b64 v[40:41], 0
v_mov_b64 v[42:43], 0
ds_read_b128 v[44:47], v2 offset:0
ds_read_b128 v[48:51], v2 offset:1024
v_bfe_u32 v77, v1, 6, 1
v_lshl_add_u32 v77, v77, 3, v1
v_lshlrev_b32 v77, 1, v77
s_waitcnt vmcnt(0) lgkmcnt(0)
s_branch L_top_w1rs
L_done_w1rs:
buffer_store_dword v11, v10, s[4:7], s40 offen sc0 sc1
s_waitcnt vmcnt(0) lgkmcnt(0)
s_endpgm
L_ra0_w1rs:
s_mov_b32 m0, 1024
s_nop 0
buffer_load_dwordx4 v1, s[4:7], s47 offen offset:0 sc0 sc1 lds
buffer_load_dwordx4 v1, s[4:7], s47 offen offset:1024 sc0 sc1 lds
buffer_load_dwordx4 v1, s[4:7], s47 offen offset:2048 sc0 sc1 lds
buffer_load_dwordx4 v1, s[4:7], s47 offen offset:3072 sc0 sc1 lds
s_sub_u32 s41, s41, 1
s_cbranch_scc1 L_exit
ds_read_b128 v[44:47], v2 offset:0
ds_read_b128 v[48:51], v2 offset:1024
v_mov_b64 v[20:21], 0
v_mov_b64 v[22:23], 0
v_mov_b64 v[24:25], 0
v_mov_b64 v[26:27], 0
v_mov_b64 v[28:29], 0
v_mov_b64 v[30:31], 0
v_mov_b64 v[32:33], 0
v_mov_b64 v[34:35], 0
v_mov_b64 v[36:37], 0
v_mov_b64 v[38:39], 0
v_mov_b64 v[40:41], 0
v_mov_b64 v[42:43], 0
s_waitcnt vmcnt(0)
ds_read_b128 v[60:63], v1 offset:1024
ds_read_b128 v[64:67], v1 offset:2048
ds_read_b128 v[68:71], v1 offset:3072
ds_read_b128 v[72:75], v1 offset:4096
s_branch L_s0_w1rs
L_ra1_w1rs:
s_waitcnt lgkmcnt(0)
s_barrier
s_mov_b32 m0, 5120
s_nop 0
buffer_load_dwordx4 v1, s[4:7], s48 offen offset:1024 sc0 sc1 lds
s_sub_u32 s41, s41, 1
s_cbranch_scc1 L_exit
s_waitcnt vmcnt(0)
s_barrier
ds_read_b128 v[76:79], v1 offset:5120
ds_read_b128 v[60:63], v1 offset:6144
ds_read_b128 v[64:67], v1 offset:7168
ds_read_b128 v[68:71], v1 offset:8192
ds_read_b128 v[72:75], v1 offset:9216
s_waitcnt lgkmcnt(0)
v_bitop3_b32 v6, v76, v60, s35 bitop3:0x7e
v_bitop3_b32 v6, v6, v64, s35 bitop3:0xf6
v_bitop3_b32 v6, v6, v68, s35 bitop3:0xf6
v_bitop3_b32 v6, v6, v72, s35 bitop3:0xf6
v_and_b32 v6, 1, v6
v_cmp_ne_u32 vcc, 0, v6
s_mov_b32 m0, 0
v_lshlrev_b32 v6, 3, v1
s_cbranch_vccnz L_ra1_w1rs
s_branch L_a1_w1rs
L_mx_w1rs:
s_waitcnt lgkmcnt(0)
v_max3_f32 v30, v12, v13, v28
v_max_f32 v30, v30, v29
v_mov_b32 v31, v30
s_nop 1
v_permlane16_swap_b32 v30, v31
v_max_f32 v30, v30, v31
v_mov_b32 v31, v30
s_nop 1
v_permlane32_swap_b32 v30, v31
v_max_f32 v30, v30, v31
ds_write_b32 v1, v30 offset:10244
s_waitcnt lgkmcnt(0)
s_barrier
ds_read_b128 v[32:35], v1 offset:10240
s_waitcnt lgkmcnt(0)
v_max3_f32 v32, v32, v33, v34
v_max_f32 v32, v32, v35
v_sub_f32 v14, v12, v32
v_sub_f32 v15, v13, v32
v_sub_f32 v30, v28, v32
v_sub_f32 v31, v29, v32
v_exp_f32 v14, v14
v_exp_f32 v15, v15
v_exp_f32 v30, v30
v_exp_f32 v31, v31
v_cvt_pk_bf16_f32 v14, v14, v15
v_cvt_pk_bf16_f32 v30, v30, v31
ds_write_b32 v5, v14 offset:14624
v_cndmask_b32_e64 v24, 0, v30, s[56:57]
v_cndmask_b32_e64 v25, 0, v30, s[56:57]
v_mov_b64 v[76:77], s[52:53]
v_mov_b64 v[78:79], s[52:53]
v_mov_b32_dpp v26, v24 quad_perm:[2,3,0,1] row_mask:0xf bank_mask:0xf
v_mov_b32_dpp v27, v24 quad_perm:[2,3,0,1] row_mask:0xf bank_mask:0xf
s_waitcnt lgkmcnt(0)
s_barrier
v_mov_b64 v[14:15], s[0:1]
ds_read_b128 v[16:19], v1 offset:14368
ds_read_b128 v[40:43], v1 offset:14336
s_waitcnt lgkmcnt(0)
v_mfma_f32_16x16x32_bf16 v[32:35], v[76:79], v[16:19], 0
v_mfma_f32_16x16x32_bf16 v[20:23], v[52:55], v[16:19], 0
v_mfma_f32_16x16x32_bf16 v[20:23], v[56:59], v[40:43], v[20:23]
v_mfma_f32_16x16x16_bf16 v[32:35], v[14:15], v[24:25], v[32:35]
v_mfma_f32_16x16x32_bf16 v[20:23], v[36:39], v[24:27], v[20:23]
s_nop 3
v_rcp_f32 v33, v32
s_nop 2
v_mul_f32_dpp v20, v33, v20 quad_perm:[0,1,0,1] row_mask:0xf bank_mask:0xf
v_mul_f32_dpp v21, v33, v21 quad_perm:[0,1,0,1] row_mask:0xf bank_mask:0xf
v_mul_f32_dpp v22, v33, v22 quad_perm:[0,1,0,1] row_mask:0xf bank_mask:0xf
v_mul_f32_dpp v23, v33, v23 quad_perm:[0,1,0,1] row_mask:0xf bank_mask:0xf
v_cvt_pk_bf16_f32 v20, v20, v21
v_cvt_pk_bf16_f32 v21, v22, v23
ds_write_b64 v6, v[20:21] offset:6144
ds_read_b128 v[16:19], v7 offset:6144
v_mov_b64 v[76:77], 0
v_mov_b64 v[78:79], 0
v_mov_b64 v[40:41], 0
v_mov_b64 v[42:43], 0
v_mov_b64 v[24:25], 0
v_mov_b64 v[26:27], 0
v_mov_b64 v[32:33], 0
v_mov_b64 v[34:35], 0
s_waitcnt lgkmcnt(0)
s_branch L_mxb_w1rs

L_rr_w1rs:
buffer_load_dwordx4 v[60:63], v9, s[4:7], s3 offen offset:0 sc0 sc1
buffer_load_dwordx4 v[64:67], v9, s[4:7], s3 offen offset:1024 sc0 sc1
buffer_load_dwordx4 v[68:71], v9, s[4:7], s3 offen offset:2048 sc0 sc1
buffer_load_dwordx4 v[72:75], v9, s[4:7], s3 offen offset:3072 sc0 sc1
s_sub_u32 s41, s41, 1
s_cbranch_scc1 L_exit
s_waitcnt vmcnt(0)
s_branch L_r_w1rs
.p2align 6
L_ex_w0f:
s_add_u32 s34, s34, 1
s_add_u32 s37, s37, 524288
s_add_u32 s39, s39, 524288
s_mul_i32 s40, s34, 10240
s_add_u32 s40, s40, 8093696
s_not_b32 s35, s35
s_not_b32 s36, s36
v_mov_b64 v[20:21], 0
v_mov_b64 v[22:23], 0
v_mov_b64 v[24:25], 0
v_mov_b64 v[26:27], 0
v_mov_b64 v[28:29], 0
v_mov_b64 v[30:31], 0
v_mov_b64 v[32:33], 0
v_mov_b64 v[34:35], 0
v_mov_b64 v[36:37], 0
v_mov_b64 v[38:39], 0
v_mov_b64 v[40:41], 0
v_mov_b64 v[42:43], 0
s_cmp_eq_u32 s34, 63
s_cbranch_scc1 L_done_w0f
ds_read_b128 v[44:47], v2 offset:0
ds_read_b128 v[48:51], v2 offset:1024
v_bfe_u32 v77, v1, 6, 1
v_lshl_add_u32 v77, v77, 3, v1
v_lshlrev_b32 v77, 1, v77
s_barrier
s_cmp_ge_u32 s34, s100
s_cbranch_scc1 L_ev_w0f
L_evb_w0f:
L_top_w0f:
s_barrier
ds_read_b128 v[60:63], v1 offset:1024
ds_read_b128 v[64:67], v1 offset:2048
s_mov_b32 m0, 5120
s_nop 0
buffer_load_dwordx4 v1, s[4:7], s48 offen offset:0 sc1 lds
s_barrier
ds_read_b128 v[68:71], v1 offset:3072
ds_read_b128 v[72:75], v1 offset:4096
L_s0_w0f:
s_waitcnt lgkmcnt(3)
v_smfmac_f32_16x16x64_bf16 v[28:31], v[60:63], v[176:183], v0
v_smfmac_f32_16x16x64_bf16 v[32:35], v[60:63], v[184:191], v0
v_smfmac_f32_16x16x64_bf16 v[36:39], v[60:63], a[48:55], v0
v_smfmac_f32_16x16x64_bf16 v[40:43], v[60:63], a[56:63], v0
s_waitcnt lgkmcnt(2)
v_smfmac_f32_16x16x64_bf16 v[20:23], v[64:67], v[80:87], v0
buffer_load_dwordx4 v[12:15], v9, s[4:7], s37 offen offset:0
v_smfmac_f32_16x16x64_bf16 v[20:23], v[60:63], v[44:51], v0
ds_read_b128 v[44:47], v2 offset:2048
v_smfmac_f32_16x16x64_bf16 v[24:27], v[64:67], v[88:95], v0
ds_read_b128 v[48:51], v2 offset:3072
v_smfmac_f32_16x16x64_bf16 v[28:31], v[64:67], v[192:199], v0
s_waitcnt lgkmcnt(2)
v_bitop3_b32 v6, v60, v64, s35 bitop3:0x7e
v_smfmac_f32_16x16x64_bf16 v[32:35], v[64:67], v[200:207], v0
v_bitop3_b32 v76, v68, v72, s35 bitop3:0x7e
buffer_load_dwordx4 v[16:19], v9, s[4:7], s37 offen offset:1024
v_smfmac_f32_16x16x64_bf16 v[36:39], v[64:67], a[64:71], v0
v_bitop3_b32 v6, v6, v76, 1 bitop3:0xa8
s_waitcnt lgkmcnt(0)
v_smfmac_f32_16x16x64_bf16 v[24:27], v[60:63], v[44:51], v0
ds_read_b128 v[44:47], v2 offset:4096
v_cmp_ne_u32 vcc, 0, v6
v_smfmac_f32_16x16x64_bf16 v[40:43], v[64:67], a[72:79], v0
ds_read_b128 v[48:51], v2 offset:5120
v_smfmac_f32_16x16x64_bf16 v[20:23], v[68:71], v[96:103], v0
s_cbranch_vccnz L_ra0_w0f
buffer_load_dwordx4 v[52:55], v1, s[4:7], s37 offen offset:2048
v_smfmac_f32_16x16x64_bf16 v[24:27], v[68:71], v[104:111], v0
s_waitcnt vmcnt(3)
s_barrier
ds_read_b32 v6, v77 offset:8192
v_smfmac_f32_16x16x64_bf16 v[28:31], v[68:71], v[208:215], v0
ds_read_b128 v[60:63], v1 offset:6144
s_waitcnt lgkmcnt(2)
v_smfmac_f32_16x16x64_bf16 v[20:23], v[72:75], v[44:51], v0
ds_read_b128 v[64:67], v1 offset:7168
v_smfmac_f32_16x16x64_bf16 v[32:35], v[68:71], v[216:223], v0
ds_read_b128 v[44:47], v2 offset:6144
ds_read_b128 v[76:79], v1 offset:5120
buffer_load_dwordx4 v[56:59], v1, s[4:7], s37 offen offset:3072
v_smfmac_f32_16x16x64_bf16 v[36:39], v[68:71], a[80:87], v0
ds_read_b128 v[48:51], v2 offset:7168
v_smfmac_f32_16x16x64_bf16 v[40:43], v[68:71], a[88:95], v0
ds_read_b128 v[68:71], v1 offset:8192
s_waitcnt lgkmcnt(5)
v_bitop3_b32 v6, v6, v60, s35 bitop3:0x7e
v_smfmac_f32_16x16x64_bf16 v[28:31], v[72:75], v[224:231], v0
s_waitcnt lgkmcnt(4)
v_bitop3_b32 v6, v6, v64, s35 bitop3:0xf6
v_smfmac_f32_16x16x64_bf16 v[32:35], v[72:75], v[232:239], v0
s_mov_b32 m0, 0
s_waitcnt lgkmcnt(2)
v_bitop3_b32 v6, v6, v76, s35 bitop3:0xf6
v_and_b32 v6, 1, v6
s_waitcnt lgkmcnt(1)
v_smfmac_f32_16x16x64_bf16 v[24:27], v[72:75], v[44:51], v0
ds_read_b128 v[44:47], v2 offset:8192
v_cmp_ne_u32 vcc, 0, v6
v_smfmac_f32_16x16x64_bf16 v[36:39], v[72:75], a[96:103], v0
ds_read_b128 v[48:51], v2 offset:9216
v_lshlrev_b32 v6, 3, v1
v_smfmac_f32_16x16x64_bf16 v[40:43], v[72:75], a[104:111], v0
ds_read_b128 v[72:75], v1 offset:9216
s_cbranch_vccnz L_ra1_w0f
L_a1_w0f:
buffer_load_dword v6, s[4:7], s39 offen lds
v_smfmac_f32_16x16x64_bf16 v[20:23], v[60:63], v[112:119], v0
v_smfmac_f32_16x16x64_bf16 v[20:23], v[64:67], v[128:135], v0
v_bfe_u32 v6, v1, 5, 1
s_waitcnt lgkmcnt(3)
v_smfmac_f32_16x16x64_bf16 v[20:23], v[68:71], v[144:151], v0
v_mad_i32_i24 v6, v6, s55, v1
s_waitcnt lgkmcnt(0)
v_smfmac_f32_16x16x64_bf16 v[20:23], v[72:75], v[160:167], v0
v_smfmac_f32_16x16x64_bf16 v[20:23], v[76:79], v[44:51], v0
ds_read_b128 v[44:47], v2 offset:10240
v_smfmac_f32_16x16x64_bf16 v[24:27], v[60:63], v[120:127], v0
ds_read_b128 v[48:51], v2 offset:11264
v_smfmac_f32_16x16x64_bf16 v[24:27], v[64:67], v[136:143], v0
v_add_f32 v20, v20, v22
v_smfmac_f32_16x16x64_bf16 v[24:27], v[68:71], v[152:159], v0
v_add_f32 v21, v21, v23
v_smfmac_f32_16x16x64_bf16 v[24:27], v[72:75], v[168:175], v0
v_cvt_pk_bf16_f32 v22, v20, v21
s_waitcnt lgkmcnt(0)
v_smfmac_f32_16x16x64_bf16 v[24:27], v[76:79], v[44:51], v0
ds_read_b128 v[44:47], v2 offset:12288
v_smfmac_f32_16x16x64_bf16 v[28:31], v[76:79], v[240:247], v0
ds_read_b128 v[48:51], v2 offset:13312
v_smfmac_f32_16x16x64_bf16 v[28:31], v[64:67], a[0:7], v0
v_add_f32 v24, v24, v26
v_add_f32 v25, v25, v27
v_cvt_pk_bf16_f32 v23, v24, v25
v_smfmac_f32_16x16x64_bf16 v[28:31], v[68:71], a[16:23], v0
ds_write_b64 v3, v[22:23] offset:10240
v_smfmac_f32_16x16x64_bf16 v[28:31], v[72:75], a[32:39], v0
s_waitcnt lgkmcnt(1)
v_smfmac_f32_16x16x64_bf16 v[28:31], v[60:63], v[44:51], v0
ds_read_b128 v[44:47], v2 offset:14336
v_smfmac_f32_16x16x64_bf16 v[32:35], v[76:79], v[248:255], v0
ds_read_b128 v[48:51], v2 offset:15360
v_smfmac_f32_16x16x64_bf16 v[32:35], v[64:67], a[8:15], v0
v_add_f32 v28, v28, v30
s_waitcnt lgkmcnt(2)
s_barrier
v_smfmac_f32_16x16x64_bf16 v[32:35], v[68:71], a[24:31], v0
ds_read_b64_tr_b16 v[20:21], v4 offset:10240
ds_read_b64_tr_b16 v[22:23], v4 offset:10752
v_add_f32 v29, v29, v31
v_smfmac_f32_16x16x64_bf16 v[32:35], v[72:75], a[40:47], v0
ds_read_b64_tr_b16 v[24:25], v4 offset:11264
ds_read_b64_tr_b16 v[26:27], v4 offset:11776
v_cvt_pk_bf16_f32 v30, v28, v29
s_waitcnt lgkmcnt(4)
v_smfmac_f32_16x16x64_bf16 v[32:35], v[60:63], v[44:51], v0
ds_read_b128 v[44:47], v2 offset:18432
s_waitcnt vmcnt(3)
s_waitcnt lgkmcnt(3)
v_mfma_f32_16x16x32_bf16 v[12:15], v[12:15], v[20:23], 0
ds_read_b128 v[48:51], v2 offset:19456
s_waitcnt lgkmcnt(2)
v_mfma_f32_16x16x32_bf16 v[12:15], v[16:19], v[24:27], v[12:15]
v_add_f32 v32, v32, v34
v_add_f32 v33, v33, v35
v_cvt_pk_bf16_f32 v31, v32, v33
ds_write_b64 v3, v[30:31] offset:12288
v_smfmac_f32_16x16x64_bf16 v[36:39], v[76:79], a[112:119], v0
s_nop 2
v_add_f32_dpp v12, v14, v12 quad_perm:[2,3,0,1] row_mask:0xf bank_mask:0xf
v_add_f32_dpp v13, v15, v13 quad_perm:[2,3,0,1] row_mask:0xf bank_mask:0xf
v_exp_f32 v14, v12
v_exp_f32 v15, v13
v_smfmac_f32_16x16x64_bf16 v[40:43], v[76:79], a[120:127], v0
v_cvt_pk_bf16_f32 v14, v14, v15
ds_write_b32 v5, v14 offset:14368
s_waitcnt lgkmcnt(1)
s_barrier
ds_read_b64_tr_b16 v[28:29], v4 offset:12288
v_smfmac_f32_16x16x64_bf16 v[36:39], v[60:63], a[128:135], v0
ds_read_b64_tr_b16 v[30:31], v4 offset:12800
ds_read_b64_tr_b16 v[32:33], v4 offset:13312
v_smfmac_f32_16x16x64_bf16 v[40:43], v[60:63], a[136:143], v0
ds_read_b64_tr_b16 v[34:35], v4 offset:13824
v_mov_b64 v[76:77], s[52:53]
v_smfmac_f32_16x16x64_bf16 v[40:43], v[72:75], v[44:51], v0
ds_read_b128 v[44:47], v2 offset:16384
v_mov_b64 v[78:79], s[52:53]
s_waitcnt lgkmcnt(3)
v_mfma_f32_16x16x32_bf16 v[28:31], v[28:31], v[20:23], 0
s_barrier
ds_read_b128 v[16:19], v1 offset:14368
s_waitcnt lgkmcnt(2)
v_mfma_f32_16x16x32_bf16 v[28:31], v[32:35], v[24:27], v[28:31]
ds_read_b128 v[60:63], v1 offset:14336
v_smfmac_f32_16x16x64_bf16 v[40:43], v[64:67], a[152:159], v0
ds_read_b128 v[48:51], v2 offset:17408
v_mov_b64 v[14:15], s[0:1]
v_smfmac_f32_16x16x64_bf16 v[40:43], v[68:71], a[168:175], v0
v_add_f32_dpp v28, v30, v28 quad_perm:[2,3,0,1] row_mask:0xf bank_mask:0xf
v_smfmac_f32_16x16x64_bf16 v[36:39], v[64:67], a[144:151], v0
ds_read_b128 v[64:67], v2 offset:25600
v_add_f32_dpp v29, v31, v29 quad_perm:[2,3,0,1] row_mask:0xf bank_mask:0xf
v_smfmac_f32_16x16x64_bf16 v[36:39], v[68:71], a[160:167], v0
ds_read_b128 v[68:71], v2 offset:22528
v_mul_f32 v28, s50, v28
s_waitcnt lgkmcnt(2)
v_smfmac_f32_16x16x64_bf16 v[36:39], v[72:75], v[44:51], v0
ds_read_b128 v[72:75], v2 offset:23552
v_mul_f32 v29, s50, v29
s_waitcnt vmcnt(1)
v_mfma_f32_16x16x32_bf16 v[32:35], v[76:79], v[16:19], 0
v_exp_f32 v30, v28
v_mfma_f32_16x16x32_bf16 v[20:23], v[52:55], v[16:19], 0
v_exp_f32 v31, v29
v_mfma_f32_16x16x32_bf16 v[20:23], v[56:59], v[60:63], v[20:23]
v_cvt_pk_bf16_f32 v30, v30, v31
v_cndmask_b32_e64 v24, 0, v30, s[56:57]
v_cndmask_b32_e64 v25, 0, v30, s[56:57]
v_cvt_pk_bf16_f32 v36, v36, v37
v_cvt_pk_bf16_f32 v37, v38, v39
v_mfma_f32_16x16x16_bf16 v[32:35], v[14:15], v[24:25], v[32:35]
v_cvt_pk_bf16_f32 v38, v40, v41
v_cvt_pk_bf16_f32 v39, v42, v43
v_mov_b32_dpp v26, v24 quad_perm:[2,3,0,1] row_mask:0xf bank_mask:0xf
v_mov_b32_dpp v27, v24 quad_perm:[2,3,0,1] row_mask:0xf bank_mask:0xf
ds_read_b128 v[44:47], v2 offset:20480
s_nop 0
v_mfma_f32_16x16x32_bf16 v[20:23], v[36:39], v[24:27], v[20:23]
ds_read_b128 v[48:51], v2 offset:21504
v_rcp_f32 v33, v32
ds_read_b128 v[60:63], v2 offset:24576
v_min_f32 v32, v32, v33
v_cmp_nlt_f32 vcc, s2, v32
v_mov_b64 v[76:77], 0
v_mov_b64 v[78:79], 0
v_mov_b64 v[40:41], 0
v_mul_f32_dpp v20, v33, v20 quad_perm:[0,1,0,1] row_mask:0xf bank_mask:0xf
v_mul_f32_dpp v21, v33, v21 quad_perm:[0,1,0,1] row_mask:0xf bank_mask:0xf
v_mul_f32_dpp v22, v33, v22 quad_perm:[0,1,0,1] row_mask:0xf bank_mask:0xf
v_mul_f32_dpp v23, v33, v23 quad_perm:[0,1,0,1] row_mask:0xf bank_mask:0xf
v_cvt_pk_bf16_f32 v20, v20, v21
v_cvt_pk_bf16_f32 v21, v22, v23
ds_write_b64 v6, v[20:21] offset:5120
v_mov_b64 v[42:43], 0
ds_read_b128 v[16:19], v7 offset:5120
s_and_b64 vcc, vcc, s[56:57]
v_mov_b64 v[24:25], 0
v_mov_b64 v[26:27], 0
s_cbranch_scc1 L_mx_w0f
L_mxb_w0f:
v_mov_b64 v[32:33], 0
v_mov_b64 v[34:35], 0
v_mov_b64 v[28:29], 0
v_mov_b64 v[30:31], 0
s_waitcnt lgkmcnt(1)
s_barrier
ds_read_b128 v[12:15], v7 offset:6144
s_waitcnt lgkmcnt(1)
v_smfmac_f32_16x16x64_bf16 v[76:79], v[16:19], v[44:51], v0 abid:1
ds_read_b128 v[52:55], v7 offset:7168
ds_read_b128 v[56:59], v7 offset:8192
v_smfmac_f32_16x16x64_bf16 v[40:43], v[16:19], v[60:67], v0 abid:1
ds_read_b128 v[44:47], v2 offset:26624
s_waitcnt lgkmcnt(3)
v_smfmac_f32_16x16x64_bf16 v[76:79], v[12:15], a[176:183], v0 abid:1
ds_read_b128 v[48:51], v2 offset:27648
v_smfmac_f32_16x16x64_bf16 v[40:43], v[12:15], a[184:191], v0 abid:1
ds_read_b128 v[60:63], v2 offset:28672
s_waitcnt lgkmcnt(4)
v_smfmac_f32_16x16x64_bf16 v[76:79], v[52:55], v[68:75], v0 abid:1
ds_read_b128 v[64:67], v2 offset:29696
s_waitcnt lgkmcnt(2)
v_smfmac_f32_16x16x64_bf16 v[40:43], v[52:55], v[44:51], v0 abid:1
ds_read_b128 v[68:71], v2 offset:30720
v_smfmac_f32_16x16x64_bf16 v[76:79], v[56:59], a[192:199], v0 abid:1
ds_read_b128 v[72:75], v2 offset:31744
v_smfmac_f32_16x16x64_bf16 v[40:43], v[56:59], a[200:207], v0 abid:1
ds_read_b128 v[44:47], v2 offset:32768
s_waitcnt lgkmcnt(3)
v_smfmac_f32_16x16x64_bf16 v[24:27], v[16:19], v[60:67], v0 abid:1
ds_read_b128 v[48:51], v2 offset:33792
v_cvt_pk_bf16_f32 v76, v76, v77
v_cvt_pk_bf16_f32 v77, v78, v79
v_bfi_b32 v76, 1, s35, v76
buffer_store_dwordx2 v[76:77], v8, s[4:7], s42 offen
v_smfmac_f32_16x16x64_bf16 v[24:27], v[12:15], a[208:215], v0 abid:1
ds_read_b128 v[60:63], v2 offset:36864
v_cvt_pk_bf16_f32 v40, v40, v41
v_cvt_pk_bf16_f32 v41, v42, v43
v_bfi_b32 v40, 1, s35, v40
buffer_store_dwordx2 v[40:41], v8, s[4:7], s43 offen
s_waitcnt lgkmcnt(3)
v_smfmac_f32_16x16x64_bf16 v[24:27], v[52:55], v[68:75], v0 abid:1
ds_read_b128 v[64:67], v2 offset:37888
v_smfmac_f32_16x16x64_bf16 v[24:27], v[56:59], a[216:223], v0 abid:1
ds_read_b128 v[68:71], v2 offset:34816
v_smfmac_f32_16x16x64_bf16 v[32:35], v[16:19], a[224:231], v0 abid:1
ds_read_b128 v[72:75], v2 offset:35840
v_smfmac_f32_16x16x64_bf16 v[32:35], v[12:15], a[232:239], v0 abid:1
v_cvt_pk_bf16_f32 v24, v24, v25
v_cvt_pk_bf16_f32 v25, v26, v27
v_bfi_b32 v24, 1, s35, v24
buffer_store_dwordx2 v[24:25], v8, s[4:7], s44 offen
v_smfmac_f32_16x16x64_bf16 v[32:35], v[52:55], a[240:247], v0 abid:1
v_smfmac_f32_16x16x64_bf16 v[32:35], v[56:59], a[248:255], v0 abid:1
s_waitcnt lgkmcnt(4)
v_smfmac_f32_16x16x64_bf16 v[28:31], v[16:19], v[44:51], v0 abid:1
ds_read_b128 v[44:47], v2 offset:38912
s_waitcnt lgkmcnt(3)
v_smfmac_f32_16x16x64_bf16 v[28:31], v[12:15], v[60:67], v0 abid:1
ds_read_b128 v[48:51], v2 offset:39936
v_cvt_pk_bf16_f32 v32, v32, v33
v_cvt_pk_bf16_f32 v33, v34, v35
v_bfi_b32 v32, 1, s35, v32
buffer_store_dwordx2 v[32:33], v8, s[4:7], s45 offen
s_waitcnt lgkmcnt(2)
v_smfmac_f32_16x16x64_bf16 v[28:31], v[52:55], v[68:75], v0 abid:1
s_waitcnt lgkmcnt(0)
v_smfmac_f32_16x16x64_bf16 v[28:31], v[56:59], v[44:51], v0 abid:1
s_nop 7
v_cvt_pk_bf16_f32 v28, v28, v29
v_cvt_pk_bf16_f32 v29, v30, v31
v_bfi_b32 v28, 1, s35, v28
buffer_store_dwordx2 v[28:29], v8, s[4:7], s46 offen
s_branch L_ex_w0f
.p2align 6
L_ex_w1f:
s_add_u32 s34, s34, 1
s_add_u32 s37, s37, 524288
s_add_u32 s39, s39, 524288
s_mul_i32 s40, s34, 10240
s_add_u32 s40, s40, 8093696
s_not_b32 s35, s35
s_not_b32 s36, s36
v_mov_b64 v[20:21], 0
v_mov_b64 v[22:23], 0
v_mov_b64 v[24:25], 0
v_mov_b64 v[26:27], 0
v_mov_b64 v[28:29], 0
v_mov_b64 v[30:31], 0
v_mov_b64 v[32:33], 0
v_mov_b64 v[34:35], 0
v_mov_b64 v[36:37], 0
v_mov_b64 v[38:39], 0
v_mov_b64 v[40:41], 0
v_mov_b64 v[42:43], 0
s_cmp_eq_u32 s34, 63
s_cbranch_scc1 L_done_w1f
ds_read_b128 v[44:47], v2 offset:0
ds_read_b128 v[48:51], v2 offset:1024
v_bfe_u32 v77, v1, 6, 1
v_lshl_add_u32 v77, v77, 3, v1
v_lshlrev_b32 v77, 1, v77
s_barrier
L_top_w1f:
s_barrier
ds_read_b128 v[60:63], v1 offset:1024
ds_read_b128 v[64:67], v1 offset:2048
s_mov_b32 m0, 5120
s_nop 0
buffer_load_dwordx4 v1, s[4:7], s48 offen offset:1024 sc1 lds
s_barrier
ds_read_b128 v[68:71], v1 offset:3072
ds_read_b128 v[72:75], v1 offset:4096
L_s0_w1f:
s_waitcnt lgkmcnt(3)
v_smfmac_f32_16x16x64_bf16 v[28:31], v[60:63], v[176:183], v0
v_smfmac_f32_16x16x64_bf16 v[32:35], v[60:63], v[184:191], v0
s_mov_b32 m0, 9216
s_nop 0
buffer_load_dwordx4 v1, s[4:7], s49 offen offset:0 sc1 lds
v_smfmac_f32_16x16x64_bf16 v[36:39], v[60:63], a[48:55], v0
v_smfmac_f32_16x16x64_bf16 v[40:43], v[60:63], a[56:63], v0
s_waitcnt lgkmcnt(2)
v_smfmac_f32_16x16x64_bf16 v[20:23], v[64:67], v[80:87], v0
v_smfmac_f32_16x16x64_bf16 v[20:23], v[60:63], v[44:51], v0
ds_read_b128 v[44:47], v2 offset:2048
buffer_load_dwordx4 v[12:15], v9, s[4:7], s37 offen offset:0
v_smfmac_f32_16x16x64_bf16 v[24:27], v[64:67], v[88:95], v0
ds_read_b128 v[48:51], v2 offset:3072
v_smfmac_f32_16x16x64_bf16 v[28:31], v[64:67], v[192:199], v0
s_waitcnt lgkmcnt(2)
v_bitop3_b32 v6, v60, v64, s35 bitop3:0x7e
v_smfmac_f32_16x16x64_bf16 v[32:35], v[64:67], v[200:207], v0
v_bitop3_b32 v76, v68, v72, s35 bitop3:0x7e
v_smfmac_f32_16x16x64_bf16 v[36:39], v[64:67], a[64:71], v0
v_bitop3_b32 v6, v6, v76, 1 bitop3:0xa8
s_waitcnt lgkmcnt(0)
buffer_load_dwordx4 v[16:19], v9, s[4:7], s37 offen offset:1024
v_smfmac_f32_16x16x64_bf16 v[24:27], v[60:63], v[44:51], v0
ds_read_b128 v[44:47], v2 offset:4096
v_cmp_ne_u32 vcc, 0, v6
v_smfmac_f32_16x16x64_bf16 v[40:43], v[64:67], a[72:79], v0
ds_read_b128 v[48:51], v2 offset:5120
v_smfmac_f32_16x16x64_bf16 v[20:23], v[68:71], v[96:103], v0
s_cbranch_vccnz L_ra0_w1f
v_smfmac_f32_16x16x64_bf16 v[24:27], v[68:71], v[104:111], v0
s_waitcnt vmcnt(2)
s_barrier
ds_read_b32 v6, v77 offset:8192
buffer_load_dwordx4 v[52:55], v1, s[4:7], s37 offen offset:2048
v_smfmac_f32_16x16x64_bf16 v[28:31], v[68:71], v[208:215], v0
ds_read_b128 v[60:63], v1 offset:6144
s_waitcnt lgkmcnt(2)
v_smfmac_f32_16x16x64_bf16 v[20:23], v[72:75], v[44:51], v0
ds_read_b128 v[64:67], v1 offset:7168
v_smfmac_f32_16x16x64_bf16 v[32:35], v[68:71], v[216:223], v0
ds_read_b128 v[44:47], v2 offset:6144
ds_read_b128 v[76:79], v1 offset:5120
v_smfmac_f32_16x16x64_bf16 v[36:39], v[68:71], a[80:87], v0
ds_read_b128 v[48:51], v2 offset:7168
buffer_load_dwordx4 v[56:59], v1, s[4:7], s37 offen offset:3072
v_smfmac_f32_16x16x64_bf16 v[40:43], v[68:71], a[88:95], v0
ds_read_b128 v[68:71], v1 offset:8192
s_waitcnt lgkmcnt(5)
v_bitop3_b32 v6, v6, v60, s35 bitop3:0x7e
v_smfmac_f32_16x16x64_bf16 v[28:31], v[72:75], v[224:231], v0
s_waitcnt lgkmcnt(4)
v_bitop3_b32 v6, v6, v64, s35 bitop3:0xf6
v_smfmac_f32_16x16x64_bf16 v[32:35], v[72:75], v[232:239], v0
s_mov_b32 m0, 0
s_waitcnt lgkmcnt(2)
v_bitop3_b32 v6, v6, v76, s35 bitop3:0xf6
v_and_b32 v6, 1, v6
s_waitcnt lgkmcnt(1)
v_smfmac_f32_16x16x64_bf16 v[24:27], v[72:75], v[44:51], v0
ds_read_b128 v[44:47], v2 offset:8192
v_cmp_ne_u32 vcc, 0, v6
v_smfmac_f32_16x16x64_bf16 v[36:39], v[72:75], a[96:103], v0
ds_read_b128 v[48:51], v2 offset:9216
v_lshlrev_b32 v6, 3, v1
v_smfmac_f32_16x16x64_bf16 v[40:43], v[72:75], a[104:111], v0
ds_read_b128 v[72:75], v1 offset:9216
s_cbranch_vccnz L_ra1_w1f
L_a1_w1f:
buffer_load_dword v6, s[4:7], s39 offen lds
v_smfmac_f32_16x16x64_bf16 v[20:23], v[60:63], v[112:119], v0
v_smfmac_f32_16x16x64_bf16 v[20:23], v[64:67], v[128:135], v0
v_bfe_u32 v6, v1, 5, 1
s_waitcnt lgkmcnt(3)
v_smfmac_f32_16x16x64_bf16 v[20:23], v[68:71], v[144:151], v0
v_mad_i32_i24 v6, v6, s55, v1
s_waitcnt lgkmcnt(0)
v_smfmac_f32_16x16x64_bf16 v[20:23], v[72:75], v[160:167], v0
v_smfmac_f32_16x16x64_bf16 v[20:23], v[76:79], v[44:51], v0
ds_read_b128 v[44:47], v2 offset:10240
v_smfmac_f32_16x16x64_bf16 v[24:27], v[60:63], v[120:127], v0
ds_read_b128 v[48:51], v2 offset:11264
v_smfmac_f32_16x16x64_bf16 v[24:27], v[64:67], v[136:143], v0
v_add_f32 v20, v20, v22
v_smfmac_f32_16x16x64_bf16 v[24:27], v[68:71], v[152:159], v0
v_add_f32 v21, v21, v23
v_smfmac_f32_16x16x64_bf16 v[24:27], v[72:75], v[168:175], v0
v_cvt_pk_bf16_f32 v22, v20, v21
s_waitcnt lgkmcnt(0)
v_smfmac_f32_16x16x64_bf16 v[24:27], v[76:79], v[44:51], v0
ds_read_b128 v[44:47], v2 offset:12288
v_smfmac_f32_16x16x64_bf16 v[28:31], v[76:79], v[240:247], v0
ds_read_b128 v[48:51], v2 offset:13312
v_smfmac_f32_16x16x64_bf16 v[28:31], v[64:67], a[0:7], v0
v_add_f32 v24, v24, v26
v_add_f32 v25, v25, v27
v_cvt_pk_bf16_f32 v23, v24, v25
v_smfmac_f32_16x16x64_bf16 v[28:31], v[68:71], a[16:23], v0
ds_write_b64 v3, v[22:23] offset:10752
v_smfmac_f32_16x16x64_bf16 v[28:31], v[72:75], a[32:39], v0
s_waitcnt lgkmcnt(1)
v_smfmac_f32_16x16x64_bf16 v[28:31], v[60:63], v[44:51], v0
ds_read_b128 v[44:47], v2 offset:14336
v_smfmac_f32_16x16x64_bf16 v[32:35], v[76:79], v[248:255], v0
ds_read_b128 v[48:51], v2 offset:15360
v_smfmac_f32_16x16x64_bf16 v[32:35], v[64:67], a[8:15], v0
v_add_f32 v28, v28, v30
s_waitcnt lgkmcnt(2)
s_barrier
v_smfmac_f32_16x16x64_bf16 v[32:35], v[68:71], a[24:31], v0
ds_read_b64_tr_b16 v[20:21], v4 offset:10240
ds_read_b64_tr_b16 v[22:23], v4 offset:10752
v_add_f32 v29, v29, v31
v_smfmac_f32_16x16x64_bf16 v[32:35], v[72:75], a[40:47], v0
ds_read_b64_tr_b16 v[24:25], v4 offset:11264
ds_read_b64_tr_b16 v[26:27], v4 offset:11776
v_cvt_pk_bf16_f32 v30, v28, v29
s_waitcnt lgkmcnt(4)
v_smfmac_f32_16x16x64_bf16 v[32:35], v[60:63], v[44:51], v0
ds_read_b128 v[44:47], v2 offset:18432
s_waitcnt vmcnt(3)
s_waitcnt lgkmcnt(3)
v_mfma_f32_16x16x32_bf16 v[12:15], v[12:15], v[20:23], 0
ds_read_b128 v[48:51], v2 offset:19456
s_waitcnt lgkmcnt(2)
v_mfma_f32_16x16x32_bf16 v[12:15], v[16:19], v[24:27], v[12:15]
v_add_f32 v32, v32, v34
v_add_f32 v33, v33, v35
v_cvt_pk_bf16_f32 v31, v32, v33
ds_write_b64 v3, v[30:31] offset:12800
v_smfmac_f32_16x16x64_bf16 v[36:39], v[76:79], a[112:119], v0
s_nop 2
v_add_f32_dpp v12, v14, v12 quad_perm:[2,3,0,1] row_mask:0xf bank_mask:0xf
v_add_f32_dpp v13, v15, v13 quad_perm:[2,3,0,1] row_mask:0xf bank_mask:0xf
v_exp_f32 v14, v12
v_exp_f32 v15, v13
v_smfmac_f32_16x16x64_bf16 v[40:43], v[76:79], a[120:127], v0
v_cvt_pk_bf16_f32 v14, v14, v15
ds_write_b32 v5, v14 offset:14624
s_waitcnt lgkmcnt(1)
s_barrier
ds_read_b64_tr_b16 v[28:29], v4 offset:12288
v_smfmac_f32_16x16x64_bf16 v[36:39], v[60:63], a[128:135], v0
ds_read_b64_tr_b16 v[30:31], v4 offset:12800
ds_read_b64_tr_b16 v[32:33], v4 offset:13312
v_smfmac_f32_16x16x64_bf16 v[40:43], v[60:63], a[136:143], v0
ds_read_b64_tr_b16 v[34:35], v4 offset:13824
v_mov_b64 v[76:77], s[52:53]
v_smfmac_f32_16x16x64_bf16 v[40:43], v[72:75], v[44:51], v0
ds_read_b128 v[44:47], v2 offset:16384
v_mov_b64 v[78:79], s[52:53]
s_waitcnt lgkmcnt(3)
v_mfma_f32_16x16x32_bf16 v[28:31], v[28:31], v[20:23], 0
s_barrier
ds_read_b128 v[16:19], v1 offset:14368
s_waitcnt lgkmcnt(2)
v_mfma_f32_16x16x32_bf16 v[28:31], v[32:35], v[24:27], v[28:31]
ds_read_b128 v[60:63], v1 offset:14336
v_smfmac_f32_16x16x64_bf16 v[40:43], v[64:67], a[152:159], v0
ds_read_b128 v[48:51], v2 offset:17408
v_mov_b64 v[14:15], s[0:1]
v_smfmac_f32_16x16x64_bf16 v[40:43], v[68:71], a[168:175], v0
v_add_f32_dpp v28, v30, v28 quad_perm:[2,3,0,1] row_mask:0xf bank_mask:0xf
v_smfmac_f32_16x16x64_bf16 v[36:39], v[64:67], a[144:151], v0
ds_read_b128 v[64:67], v2 offset:27648
v_add_f32_dpp v29, v31, v29 quad_perm:[2,3,0,1] row_mask:0xf bank_mask:0xf
v_smfmac_f32_16x16x64_bf16 v[36:39], v[68:71], a[160:167], v0
ds_read_b128 v[68:71], v2 offset:20480
v_mul_f32 v28, s50, v28
s_waitcnt lgkmcnt(2)
v_smfmac_f32_16x16x64_bf16 v[36:39], v[72:75], v[44:51], v0
ds_read_b128 v[72:75], v2 offset:21504
v_mul_f32 v29, s50, v29
s_waitcnt vmcnt(1)
v_mfma_f32_16x16x32_bf16 v[32:35], v[76:79], v[16:19], 0
v_exp_f32 v30, v28
v_mfma_f32_16x16x32_bf16 v[20:23], v[52:55], v[16:19], 0
v_exp_f32 v31, v29
v_mfma_f32_16x16x32_bf16 v[20:23], v[56:59], v[60:63], v[20:23]
v_cvt_pk_bf16_f32 v30, v30, v31
v_cndmask_b32_e64 v24, 0, v30, s[56:57]
v_cndmask_b32_e64 v25, 0, v30, s[56:57]
v_cvt_pk_bf16_f32 v36, v36, v37
v_cvt_pk_bf16_f32 v37, v38, v39
v_mfma_f32_16x16x16_bf16 v[32:35], v[14:15], v[24:25], v[32:35]
v_cvt_pk_bf16_f32 v38, v40, v41
v_cvt_pk_bf16_f32 v39, v42, v43
v_mov_b32_dpp v26, v24 quad_perm:[2,3,0,1] row_mask:0xf bank_mask:0xf
v_mov_b32_dpp v27, v24 quad_perm:[2,3,0,1] row_mask:0xf bank_mask:0xf
ds_read_b128 v[44:47], v2 offset:22528
s_nop 0
v_mfma_f32_16x16x32_bf16 v[20:23], v[36:39], v[24:27], v[20:23]
ds_read_b128 v[48:51], v2 offset:23552
v_rcp_f32 v33, v32
ds_read_b128 v[60:63], v2 offset:26624
v_min_f32 v32, v32, v33
v_cmp_nlt_f32 vcc, s2, v32
v_mov_b64 v[76:77], 0
v_mov_b64 v[78:79], 0
v_mov_b64 v[40:41], 0
v_mul_f32_dpp v20, v33, v20 quad_perm:[0,1,0,1] row_mask:0xf bank_mask:0xf
v_mul_f32_dpp v21, v33, v21 quad_perm:[0,1,0,1] row_mask:0xf bank_mask:0xf
v_mul_f32_dpp v22, v33, v22 quad_perm:[0,1,0,1] row_mask:0xf bank_mask:0xf
v_mul_f32_dpp v23, v33, v23 quad_perm:[0,1,0,1] row_mask:0xf bank_mask:0xf
v_cvt_pk_bf16_f32 v20, v20, v21
v_cvt_pk_bf16_f32 v21, v22, v23
ds_write_b64 v6, v[20:21] offset:6144
v_mov_b64 v[42:43], 0
ds_read_b128 v[16:19], v7 offset:6144
s_and_b64 vcc, vcc, s[56:57]
v_mov_b64 v[24:25], 0
v_mov_b64 v[26:27], 0
s_cbranch_scc1 L_mx_w1f
L_mxb_w1f:
v_mov_b64 v[32:33], 0
v_mov_b64 v[34:35], 0
v_mov_b64 v[28:29], 0
v_mov_b64 v[30:31], 0
s_waitcnt lgkmcnt(1)
s_barrier
ds_read_b128 v[12:15], v7 offset:7168
s_waitcnt lgkmcnt(1)
v_smfmac_f32_16x16x64_bf16 v[76:79], v[16:19], a[176:183], v0 abid:1
ds_read_b128 v[52:55], v7 offset:8192
ds_read_b128 v[56:59], v7 offset:5120
v_smfmac_f32_16x16x64_bf16 v[40:43], v[16:19], a[184:191], v0 abid:1
s_waitcnt lgkmcnt(2)
v_smfmac_f32_16x16x64_bf16 v[76:79], v[12:15], v[44:51], v0 abid:1
ds_read_b128 v[44:47], v2 offset:24576
v_smfmac_f32_16x16x64_bf16 v[40:43], v[12:15], v[60:67], v0 abid:1
ds_read_b128 v[48:51], v2 offset:25600
s_waitcnt lgkmcnt(3)
v_smfmac_f32_16x16x64_bf16 v[76:79], v[52:55], a[192:199], v0 abid:1
ds_read_b128 v[60:63], v2 offset:30720
v_smfmac_f32_16x16x64_bf16 v[40:43], v[52:55], a[200:207], v0 abid:1
ds_read_b128 v[64:67], v2 offset:31744
s_waitcnt lgkmcnt(4)
v_smfmac_f32_16x16x64_bf16 v[76:79], v[56:59], v[68:75], v0 abid:1
ds_read_b128 v[68:71], v2 offset:28672
s_waitcnt lgkmcnt(3)
v_smfmac_f32_16x16x64_bf16 v[40:43], v[56:59], v[44:51], v0 abid:1
ds_read_b128 v[72:75], v2 offset:29696
v_smfmac_f32_16x16x64_bf16 v[24:27], v[16:19], a[208:215], v0 abid:1
ds_read_b128 v[44:47], v2 offset:36864
v_cvt_pk_bf16_f32 v76, v76, v77
v_cvt_pk_bf16_f32 v77, v78, v79
v_bfi_b32 v76, 1, s35, v76
buffer_store_dwordx2 v[76:77], v8, s[4:7], s42 offen
s_waitcnt lgkmcnt(3)
v_smfmac_f32_16x16x64_bf16 v[24:27], v[12:15], v[60:67], v0 abid:1
ds_read_b128 v[48:51], v2 offset:37888
v_cvt_pk_bf16_f32 v40, v40, v41
v_cvt_pk_bf16_f32 v41, v42, v43
v_bfi_b32 v40, 1, s35, v40
buffer_store_dwordx2 v[40:41], v8, s[4:7], s43 offen
v_smfmac_f32_16x16x64_bf16 v[24:27], v[52:55], a[216:223], v0 abid:1
ds_read_b128 v[60:63], v2 offset:34816
s_waitcnt lgkmcnt(3)
v_smfmac_f32_16x16x64_bf16 v[24:27], v[56:59], v[68:75], v0 abid:1
ds_read_b128 v[64:67], v2 offset:35840
v_smfmac_f32_16x16x64_bf16 v[32:35], v[16:19], a[224:231], v0 abid:1
ds_read_b128 v[68:71], v2 offset:38912
v_smfmac_f32_16x16x64_bf16 v[32:35], v[12:15], a[232:239], v0 abid:1
ds_read_b128 v[72:75], v2 offset:39936
v_cvt_pk_bf16_f32 v24, v24, v25
v_cvt_pk_bf16_f32 v25, v26, v27
v_bfi_b32 v24, 1, s35, v24
buffer_store_dwordx2 v[24:25], v8, s[4:7], s44 offen
v_smfmac_f32_16x16x64_bf16 v[32:35], v[52:55], a[240:247], v0 abid:1
v_smfmac_f32_16x16x64_bf16 v[32:35], v[56:59], a[248:255], v0 abid:1
s_waitcnt lgkmcnt(4)
v_smfmac_f32_16x16x64_bf16 v[28:31], v[16:19], v[44:51], v0 abid:1
ds_read_b128 v[44:47], v2 offset:32768
s_waitcnt lgkmcnt(3)
v_smfmac_f32_16x16x64_bf16 v[28:31], v[12:15], v[60:67], v0 abid:1
ds_read_b128 v[48:51], v2 offset:33792
v_cvt_pk_bf16_f32 v32, v32, v33
v_cvt_pk_bf16_f32 v33, v34, v35
v_bfi_b32 v32, 1, s35, v32
buffer_store_dwordx2 v[32:33], v8, s[4:7], s45 offen
s_waitcnt lgkmcnt(2)
v_smfmac_f32_16x16x64_bf16 v[28:31], v[52:55], v[68:75], v0 abid:1
s_waitcnt lgkmcnt(0)
v_smfmac_f32_16x16x64_bf16 v[28:31], v[56:59], v[44:51], v0 abid:1
s_nop 7
v_cvt_pk_bf16_f32 v28, v28, v29
v_cvt_pk_bf16_f32 v29, v30, v31
v_bfi_b32 v28, 1, s35, v28
buffer_store_dwordx2 v[28:29], v8, s[4:7], s46 offen
s_branch L_ex_w1f
.p2align 6
L_ex_w1rf:
v_and_b32 v6, 0x70, v1
ds_read_b128 v[76:79], v6 offset:256
v_bfe_u32 v11, v1, 4, 2
v_lshrrev_b32_e64 v11, v11, 1
s_add_u32 s34, s34, 1
s_add_u32 s37, s37, 524288
s_add_u32 s39, s39, 524288
s_mul_i32 s40, s34, 10240
s_add_u32 s40, s40, 8093696
s_not_b32 s35, s35
s_not_b32 s36, s36
ds_read_b128 v[44:47], v2 offset:0
ds_read_b128 v[48:51], v2 offset:1024
s_barrier
s_waitcnt vmcnt(0)
v_mov_b64 v[20:21], 0
v_mov_b64 v[22:23], 0
v_mov_b64 v[24:25], 0
v_mov_b64 v[26:27], 0
v_mov_b64 v[28:29], 0
v_mov_b64 v[30:31], 0
v_mov_b64 v[32:33], 0
v_mov_b64 v[34:35], 0
buffer_load_dwordx4 v[60:63], v9, s[4:7], s3 offen offset:0 sc1
buffer_load_dwordx4 v[64:67], v9, s[4:7], s3 offen offset:1024 sc1
buffer_load_dwordx4 v[68:71], v9, s[4:7], s3 offen offset:2048 sc1
buffer_load_dwordx4 v[72:75], v9, s[4:7], s3 offen offset:3072 sc1
s_waitcnt lgkmcnt(2)
s_waitcnt vmcnt(3)
L_r_w1rf:
v_mfma_f32_16x16x32_bf16 v[36:39], v[60:63], v[76:79], 0
s_waitcnt vmcnt(2)
v_mfma_f32_16x16x32_bf16 v[36:39], v[64:67], v[76:79], v[36:39]
v_bitop3_b32 v40, v60, v64, s36 bitop3:0x7e
s_waitcnt vmcnt(1)
v_mfma_f32_16x16x32_bf16 v[36:39], v[68:71], v[76:79], v[36:39]
s_waitcnt vmcnt(0)
v_mfma_f32_16x16x32_bf16 v[36:39], v[72:75], v[76:79], v[36:39]
v_bitop3_b32 v41, v68, v72, s36 bitop3:0x7e
v_bitop3_b32 v40, v40, v41, 1 bitop3:0xa8
v_cmp_ne_u32 vcc, 0, v40
v_nop
v_nop
v_nop
v_nop
v_nop
v_pk_add_f32 v[36:37], v[36:37], v[38:39]
v_cvt_pk_bf16_f32 v40, v36, v37
v_bfi_b32 v40, v11, s35, v40
s_cbranch_vccnz L_rr_w1rf
buffer_store_dword v40, v10, s[4:7], 0 offen
s_cmp_eq_u32 s34, 63
v_mov_b32 v11, v40
s_cbranch_scc1 L_done_w1rf
v_mov_b64 v[36:37], 0
v_mov_b64 v[38:39], 0
v_mov_b64 v[40:41], 0
v_mov_b64 v[42:43], 0
v_bfe_u32 v77, v1, 6, 1
v_lshl_add_u32 v77, v77, 3, v1
v_lshlrev_b32 v77, 1, v77
L_top_w1rf:
s_barrier
ds_read_b128 v[60:63], v1 offset:1024
ds_read_b128 v[64:67], v1 offset:2048
s_mov_b32 m0, 5120
s_nop 0
buffer_load_dwordx4 v1, s[4:7], s48 offen offset:1024 sc1 lds
s_barrier
ds_read_b128 v[68:71], v1 offset:3072
ds_read_b128 v[72:75], v1 offset:4096
L_s0_w1rf:
s_waitcnt lgkmcnt(3)
v_smfmac_f32_16x16x64_bf16 v[28:31], v[60:63], v[176:183], v0
v_smfmac_f32_16x16x64_bf16 v[32:35], v[60:63], v[184:191], v0
s_mov_b32 m0, 9216
s_nop 0
buffer_load_dwordx4 v1, s[4:7], s49 offen offset:0 sc1 lds
v_smfmac_f32_16x16x64_bf16 v[36:39], v[60:63], a[48:55], v0
v_smfmac_f32_16x16x64_bf16 v[40:43], v[60:63], a[56:63], v0
s_waitcnt lgkmcnt(2)
v_smfmac_f32_16x16x64_bf16 v[20:23], v[64:67], v[80:87], v0
v_smfmac_f32_16x16x64_bf16 v[20:23], v[60:63], v[44:51], v0
ds_read_b128 v[44:47], v2 offset:2048
buffer_load_dwordx4 v[12:15], v9, s[4:7], s37 offen offset:0
v_smfmac_f32_16x16x64_bf16 v[24:27], v[64:67], v[88:95], v0
ds_read_b128 v[48:51], v2 offset:3072
v_smfmac_f32_16x16x64_bf16 v[28:31], v[64:67], v[192:199], v0
s_waitcnt lgkmcnt(2)
v_bitop3_b32 v6, v60, v64, s35 bitop3:0x7e
v_smfmac_f32_16x16x64_bf16 v[32:35], v[64:67], v[200:207], v0
v_bitop3_b32 v76, v68, v72, s35 bitop3:0x7e
v_smfmac_f32_16x16x64_bf16 v[36:39], v[64:67], a[64:71], v0
v_bitop3_b32 v6, v6, v76, 1 bitop3:0xa8
s_waitcnt lgkmcnt(0)
buffer_load_dwordx4 v[16:19], v9, s[4:7], s37 offen offset:1024
v_smfmac_f32_16x16x64_bf16 v[24:27], v[60:63], v[44:51], v0
ds_read_b128 v[44:47], v2 offset:4096
v_cmp_ne_u32 vcc, 0, v6
v_smfmac_f32_16x16x64_bf16 v[40:43], v[64:67], a[72:79], v0
ds_read_b128 v[48:51], v2 offset:5120
v_smfmac_f32_16x16x64_bf16 v[20:23], v[68:71], v[96:103], v0
s_cbranch_vccnz L_ra0_w1rf
v_smfmac_f32_16x16x64_bf16 v[24:27], v[68:71], v[104:111], v0
s_waitcnt vmcnt(2)
s_barrier
ds_read_b32 v6, v77 offset:8192
buffer_load_dwordx4 v[52:55], v1, s[4:7], s37 offen offset:2048
v_smfmac_f32_16x16x64_bf16 v[28:31], v[68:71], v[208:215], v0
ds_read_b128 v[60:63], v1 offset:6144
s_waitcnt lgkmcnt(2)
v_smfmac_f32_16x16x64_bf16 v[20:23], v[72:75], v[44:51], v0
ds_read_b128 v[64:67], v1 offset:7168
v_smfmac_f32_16x16x64_bf16 v[32:35], v[68:71], v[216:223], v0
ds_read_b128 v[44:47], v2 offset:6144
ds_read_b128 v[76:79], v1 offset:5120
v_smfmac_f32_16x16x64_bf16 v[36:39], v[68:71], a[80:87], v0
ds_read_b128 v[48:51], v2 offset:7168
buffer_load_dwordx4 v[56:59], v1, s[4:7], s37 offen offset:3072
v_smfmac_f32_16x16x64_bf16 v[40:43], v[68:71], a[88:95], v0
ds_read_b128 v[68:71], v1 offset:8192
s_waitcnt lgkmcnt(5)
v_bitop3_b32 v6, v6, v60, s35 bitop3:0x7e
v_smfmac_f32_16x16x64_bf16 v[28:31], v[72:75], v[224:231], v0
s_waitcnt lgkmcnt(4)
v_bitop3_b32 v6, v6, v64, s35 bitop3:0xf6
v_smfmac_f32_16x16x64_bf16 v[32:35], v[72:75], v[232:239], v0
s_mov_b32 m0, 0
s_waitcnt lgkmcnt(2)
v_bitop3_b32 v6, v6, v76, s35 bitop3:0xf6
v_and_b32 v6, 1, v6
s_waitcnt lgkmcnt(1)
v_smfmac_f32_16x16x64_bf16 v[24:27], v[72:75], v[44:51], v0
ds_read_b128 v[44:47], v2 offset:8192
v_cmp_ne_u32 vcc, 0, v6
v_smfmac_f32_16x16x64_bf16 v[36:39], v[72:75], a[96:103], v0
ds_read_b128 v[48:51], v2 offset:9216
v_lshlrev_b32 v6, 3, v1
v_smfmac_f32_16x16x64_bf16 v[40:43], v[72:75], a[104:111], v0
ds_read_b128 v[72:75], v1 offset:9216
s_cbranch_vccnz L_ra1_w1rf
L_a1_w1rf:
buffer_store_dword v11, v10, s[4:7], s40 offen sc0 sc1
buffer_load_dword v6, s[4:7], s39 offen lds
v_smfmac_f32_16x16x64_bf16 v[20:23], v[60:63], v[112:119], v0
v_smfmac_f32_16x16x64_bf16 v[20:23], v[64:67], v[128:135], v0
v_bfe_u32 v6, v1, 5, 1
s_waitcnt lgkmcnt(3)
v_smfmac_f32_16x16x64_bf16 v[20:23], v[68:71], v[144:151], v0
v_mad_i32_i24 v6, v6, s55, v1
s_waitcnt lgkmcnt(0)
v_smfmac_f32_16x16x64_bf16 v[20:23], v[72:75], v[160:167], v0
v_smfmac_f32_16x16x64_bf16 v[20:23], v[76:79], v[44:51], v0
ds_read_b128 v[44:47], v2 offset:10240
v_smfmac_f32_16x16x64_bf16 v[24:27], v[60:63], v[120:127], v0
ds_read_b128 v[48:51], v2 offset:11264
v_smfmac_f32_16x16x64_bf16 v[24:27], v[64:67], v[136:143], v0
v_add_f32 v20, v20, v22
v_smfmac_f32_16x16x64_bf16 v[24:27], v[68:71], v[152:159], v0
v_add_f32 v21, v21, v23
v_smfmac_f32_16x16x64_bf16 v[24:27], v[72:75], v[168:175], v0
v_cvt_pk_bf16_f32 v22, v20, v21
s_waitcnt lgkmcnt(0)
v_smfmac_f32_16x16x64_bf16 v[24:27], v[76:79], v[44:51], v0
ds_read_b128 v[44:47], v2 offset:12288
v_smfmac_f32_16x16x64_bf16 v[28:31], v[76:79], v[240:247], v0
ds_read_b128 v[48:51], v2 offset:13312
v_smfmac_f32_16x16x64_bf16 v[28:31], v[64:67], a[0:7], v0
v_add_f32 v24, v24, v26
v_add_f32 v25, v25, v27
v_cvt_pk_bf16_f32 v23, v24, v25
v_smfmac_f32_16x16x64_bf16 v[28:31], v[68:71], a[16:23], v0
ds_write_b64 v3, v[22:23] offset:10752
v_smfmac_f32_16x16x64_bf16 v[28:31], v[72:75], a[32:39], v0
s_waitcnt lgkmcnt(1)
v_smfmac_f32_16x16x64_bf16 v[28:31], v[60:63], v[44:51], v0
ds_read_b128 v[44:47], v2 offset:14336
v_smfmac_f32_16x16x64_bf16 v[32:35], v[76:79], v[248:255], v0
ds_read_b128 v[48:51], v2 offset:15360
v_smfmac_f32_16x16x64_bf16 v[32:35], v[64:67], a[8:15], v0
v_add_f32 v28, v28, v30
s_waitcnt lgkmcnt(2)
s_barrier
v_smfmac_f32_16x16x64_bf16 v[32:35], v[68:71], a[24:31], v0
ds_read_b64_tr_b16 v[20:21], v4 offset:10240
ds_read_b64_tr_b16 v[22:23], v4 offset:10752
v_add_f32 v29, v29, v31
v_smfmac_f32_16x16x64_bf16 v[32:35], v[72:75], a[40:47], v0
ds_read_b64_tr_b16 v[24:25], v4 offset:11264
ds_read_b64_tr_b16 v[26:27], v4 offset:11776
v_cvt_pk_bf16_f32 v30, v28, v29
s_waitcnt lgkmcnt(4)
v_smfmac_f32_16x16x64_bf16 v[32:35], v[60:63], v[44:51], v0
ds_read_b128 v[44:47], v2 offset:18432
s_waitcnt vmcnt(4)
s_waitcnt lgkmcnt(3)
v_mfma_f32_16x16x32_bf16 v[12:15], v[12:15], v[20:23], 0
ds_read_b128 v[48:51], v2 offset:19456
s_waitcnt lgkmcnt(2)
v_mfma_f32_16x16x32_bf16 v[12:15], v[16:19], v[24:27], v[12:15]
v_add_f32 v32, v32, v34
v_add_f32 v33, v33, v35
v_cvt_pk_bf16_f32 v31, v32, v33
ds_write_b64 v3, v[30:31] offset:12800
v_smfmac_f32_16x16x64_bf16 v[36:39], v[76:79], a[112:119], v0
s_nop 2
v_add_f32_dpp v12, v14, v12 quad_perm:[2,3,0,1] row_mask:0xf bank_mask:0xf
v_add_f32_dpp v13, v15, v13 quad_perm:[2,3,0,1] row_mask:0xf bank_mask:0xf
v_exp_f32 v14, v12
v_exp_f32 v15, v13
v_smfmac_f32_16x16x64_bf16 v[40:43], v[76:79], a[120:127], v0
v_cvt_pk_bf16_f32 v14, v14, v15
ds_write_b32 v5, v14 offset:14624
s_waitcnt lgkmcnt(1)
s_barrier
ds_read_b64_tr_b16 v[28:29], v4 offset:12288
v_smfmac_f32_16x16x64_bf16 v[36:39], v[60:63], a[128:135], v0
ds_read_b64_tr_b16 v[30:31], v4 offset:12800
ds_read_b64_tr_b16 v[32:33], v4 offset:13312
v_smfmac_f32_16x16x64_bf16 v[40:43], v[60:63], a[136:143], v0
ds_read_b64_tr_b16 v[34:35], v4 offset:13824
v_mov_b64 v[76:77], s[52:53]
v_smfmac_f32_16x16x64_bf16 v[40:43], v[72:75], v[44:51], v0
ds_read_b128 v[44:47], v2 offset:16384
v_mov_b64 v[78:79], s[52:53]
s_waitcnt lgkmcnt(3)
v_mfma_f32_16x16x32_bf16 v[28:31], v[28:31], v[20:23], 0
s_barrier
ds_read_b128 v[16:19], v1 offset:14368
s_waitcnt lgkmcnt(2)
v_mfma_f32_16x16x32_bf16 v[28:31], v[32:35], v[24:27], v[28:31]
ds_read_b128 v[60:63], v1 offset:14336
v_smfmac_f32_16x16x64_bf16 v[40:43], v[64:67], a[152:159], v0
ds_read_b128 v[48:51], v2 offset:17408
v_mov_b64 v[14:15], s[0:1]
v_smfmac_f32_16x16x64_bf16 v[40:43], v[68:71], a[168:175], v0
v_add_f32_dpp v28, v30, v28 quad_perm:[2,3,0,1] row_mask:0xf bank_mask:0xf
v_smfmac_f32_16x16x64_bf16 v[36:39], v[64:67], a[144:151], v0
ds_read_b128 v[64:67], v2 offset:27648
v_add_f32_dpp v29, v31, v29 quad_perm:[2,3,0,1] row_mask:0xf bank_mask:0xf
v_smfmac_f32_16x16x64_bf16 v[36:39], v[68:71], a[160:167], v0
ds_read_b128 v[68:71], v2 offset:20480
v_mul_f32 v28, s50, v28
s_waitcnt lgkmcnt(2)
v_smfmac_f32_16x16x64_bf16 v[36:39], v[72:75], v[44:51], v0
ds_read_b128 v[72:75], v2 offset:21504
v_mul_f32 v29, s50, v29
s_waitcnt vmcnt(2)
v_mfma_f32_16x16x32_bf16 v[32:35], v[76:79], v[16:19], 0
v_exp_f32 v30, v28
v_mfma_f32_16x16x32_bf16 v[20:23], v[52:55], v[16:19], 0
v_exp_f32 v31, v29
v_mfma_f32_16x16x32_bf16 v[20:23], v[56:59], v[60:63], v[20:23]
v_cvt_pk_bf16_f32 v30, v30, v31
v_cndmask_b32_e64 v24, 0, v30, s[56:57]
v_cndmask_b32_e64 v25, 0, v30, s[56:57]
v_cvt_pk_bf16_f32 v36, v36, v37
v_cvt_pk_bf16_f32 v37, v38, v39
v_mfma_f32_16x16x16_bf16 v[32:35], v[14:15], v[24:25], v[32:35]
v_cvt_pk_bf16_f32 v38, v40, v41
v_cvt_pk_bf16_f32 v39, v42, v43
v_mov_b32_dpp v26, v24 quad_perm:[2,3,0,1] row_mask:0xf bank_mask:0xf
v_mov_b32_dpp v27, v24 quad_perm:[2,3,0,1] row_mask:0xf bank_mask:0xf
ds_read_b128 v[44:47], v2 offset:22528
s_nop 0
v_mfma_f32_16x16x32_bf16 v[20:23], v[36:39], v[24:27], v[20:23]
ds_read_b128 v[48:51], v2 offset:23552
v_rcp_f32 v33, v32
ds_read_b128 v[60:63], v2 offset:26624
v_min_f32 v32, v32, v33
v_cmp_nlt_f32 vcc, s2, v32
v_mov_b64 v[76:77], 0
v_mov_b64 v[78:79], 0
v_mov_b64 v[40:41], 0
v_mul_f32_dpp v20, v33, v20 quad_perm:[0,1,0,1] row_mask:0xf bank_mask:0xf
v_mul_f32_dpp v21, v33, v21 quad_perm:[0,1,0,1] row_mask:0xf bank_mask:0xf
v_mul_f32_dpp v22, v33, v22 quad_perm:[0,1,0,1] row_mask:0xf bank_mask:0xf
v_mul_f32_dpp v23, v33, v23 quad_perm:[0,1,0,1] row_mask:0xf bank_mask:0xf
v_cvt_pk_bf16_f32 v20, v20, v21
v_cvt_pk_bf16_f32 v21, v22, v23
ds_write_b64 v6, v[20:21] offset:6144
v_mov_b64 v[42:43], 0
ds_read_b128 v[16:19], v7 offset:6144
s_and_b64 vcc, vcc, s[56:57]
v_mov_b64 v[24:25], 0
v_mov_b64 v[26:27], 0
s_cbranch_scc1 L_mx_w1rf
L_mxb_w1rf:
v_mov_b64 v[32:33], 0
v_mov_b64 v[34:35], 0
v_mov_b64 v[28:29], 0
v_mov_b64 v[30:31], 0
s_waitcnt lgkmcnt(1)
s_barrier
ds_read_b128 v[12:15], v7 offset:7168
s_waitcnt lgkmcnt(1)
v_smfmac_f32_16x16x64_bf16 v[76:79], v[16:19], a[176:183], v0 abid:1
ds_read_b128 v[52:55], v7 offset:8192
ds_read_b128 v[56:59], v7 offset:5120
v_smfmac_f32_16x16x64_bf16 v[40:43], v[16:19], a[184:191], v0 abid:1
s_waitcnt lgkmcnt(2)
v_smfmac_f32_16x16x64_bf16 v[76:79], v[12:15], v[44:51], v0 abid:1
ds_read_b128 v[44:47], v2 offset:24576
v_smfmac_f32_16x16x64_bf16 v[40:43], v[12:15], v[60:67], v0 abid:1
ds_read_b128 v[48:51], v2 offset:25600
s_waitcnt lgkmcnt(3)
v_smfmac_f32_16x16x64_bf16 v[76:79], v[52:55], a[192:199], v0 abid:1
ds_read_b128 v[60:63], v2 offset:30720
v_smfmac_f32_16x16x64_bf16 v[40:43], v[52:55], a[200:207], v0 abid:1
ds_read_b128 v[64:67], v2 offset:31744
s_waitcnt lgkmcnt(4)
v_smfmac_f32_16x16x64_bf16 v[76:79], v[56:59], v[68:75], v0 abid:1
ds_read_b128 v[68:71], v2 offset:28672
s_waitcnt lgkmcnt(3)
v_smfmac_f32_16x16x64_bf16 v[40:43], v[56:59], v[44:51], v0 abid:1
ds_read_b128 v[72:75], v2 offset:29696
v_smfmac_f32_16x16x64_bf16 v[24:27], v[16:19], a[208:215], v0 abid:1
ds_read_b128 v[44:47], v2 offset:36864
v_cvt_pk_bf16_f32 v76, v76, v77
v_cvt_pk_bf16_f32 v77, v78, v79
v_bfi_b32 v76, 1, s35, v76
buffer_store_dwordx2 v[76:77], v8, s[4:7], s42 offen
s_waitcnt lgkmcnt(3)
v_smfmac_f32_16x16x64_bf16 v[24:27], v[12:15], v[60:67], v0 abid:1
ds_read_b128 v[48:51], v2 offset:37888
v_cvt_pk_bf16_f32 v40, v40, v41
v_cvt_pk_bf16_f32 v41, v42, v43
v_bfi_b32 v40, 1, s35, v40
buffer_store_dwordx2 v[40:41], v8, s[4:7], s43 offen
v_smfmac_f32_16x16x64_bf16 v[24:27], v[52:55], a[216:223], v0 abid:1
ds_read_b128 v[60:63], v2 offset:34816
s_waitcnt lgkmcnt(3)
v_smfmac_f32_16x16x64_bf16 v[24:27], v[56:59], v[68:75], v0 abid:1
ds_read_b128 v[64:67], v2 offset:35840
v_smfmac_f32_16x16x64_bf16 v[32:35], v[16:19], a[224:231], v0 abid:1
ds_read_b128 v[68:71], v2 offset:38912
v_smfmac_f32_16x16x64_bf16 v[32:35], v[12:15], a[232:239], v0 abid:1
ds_read_b128 v[72:75], v2 offset:39936
v_cvt_pk_bf16_f32 v24, v24, v25
v_cvt_pk_bf16_f32 v25, v26, v27
v_bfi_b32 v24, 1, s35, v24
buffer_store_dwordx2 v[24:25], v8, s[4:7], s44 offen
v_smfmac_f32_16x16x64_bf16 v[32:35], v[52:55], a[240:247], v0 abid:1
v_smfmac_f32_16x16x64_bf16 v[32:35], v[56:59], a[248:255], v0 abid:1
s_waitcnt lgkmcnt(4)
v_smfmac_f32_16x16x64_bf16 v[28:31], v[16:19], v[44:51], v0 abid:1
ds_read_b128 v[44:47], v2 offset:32768
s_waitcnt lgkmcnt(3)
v_smfmac_f32_16x16x64_bf16 v[28:31], v[12:15], v[60:67], v0 abid:1
ds_read_b128 v[48:51], v2 offset:33792
v_cvt_pk_bf16_f32 v32, v32, v33
v_cvt_pk_bf16_f32 v33, v34, v35
v_bfi_b32 v32, 1, s35, v32
buffer_store_dwordx2 v[32:33], v8, s[4:7], s45 offen
s_waitcnt lgkmcnt(2)
v_smfmac_f32_16x16x64_bf16 v[28:31], v[52:55], v[68:75], v0 abid:1
s_waitcnt lgkmcnt(0)
v_smfmac_f32_16x16x64_bf16 v[28:31], v[56:59], v[44:51], v0 abid:1
s_nop 7
v_cvt_pk_bf16_f32 v28, v28, v29
v_cvt_pk_bf16_f32 v29, v30, v31
v_bfi_b32 v28, 1, s35, v28
buffer_store_dwordx2 v[28:29], v8, s[4:7], s46 offen
s_branch L_ex_w1rf
.p2align 6
L_ex_w2rf:
v_and_b32 v6, 0x70, v1
ds_read_b128 v[76:79], v6 offset:256
v_bfe_u32 v11, v1, 4, 2
v_lshrrev_b32_e64 v11, v11, 1
s_add_u32 s34, s34, 1
s_add_u32 s37, s37, 524288
s_add_u32 s39, s39, 524288
s_mul_i32 s40, s34, 10240
s_add_u32 s40, s40, 8093696
s_not_b32 s35, s35
s_not_b32 s36, s36
ds_read_b128 v[44:47], v2 offset:0
ds_read_b128 v[48:51], v2 offset:1024
v_bfe_u32 v6, v1, 2, 7
v_mov_b32 v42, s35
s_mov_b32 m0, 1024
s_waitcnt vmcnt(2)
buffer_load_dwordx4 v[60:63], v9, s[4:7], s3 offen offset:0 sc1
buffer_load_dwordx4 v[64:67], v9, s[4:7], s3 offen offset:1024 sc1
buffer_load_dwordx4 v[68:71], v9, s[4:7], s3 offen offset:2048 sc1
buffer_load_dwordx4 v[72:75], v9, s[4:7], s3 offen offset:3072 sc1
s_barrier
s_waitcnt lgkmcnt(2)
s_waitcnt vmcnt(3)
L_r_w2rf:
v_mfma_f32_16x16x32_bf16 v[36:39], v[60:63], v[76:79], 0
s_waitcnt vmcnt(2)
v_mfma_f32_16x16x32_bf16 v[36:39], v[64:67], v[76:79], v[36:39]
v_bitop3_b32 v40, v60, v64, s36 bitop3:0x7e
s_waitcnt vmcnt(1)
v_mfma_f32_16x16x32_bf16 v[36:39], v[68:71], v[76:79], v[36:39]
s_waitcnt vmcnt(0)
v_mfma_f32_16x16x32_bf16 v[36:39], v[72:75], v[76:79], v[36:39]
v_bitop3_b32 v41, v68, v72, s36 bitop3:0x7e
v_bitop3_b32 v40, v40, v41, 1 bitop3:0xa8
v_cmp_ne_u32 vcc, 0, v40
v_nop
v_nop
v_nop
v_nop
v_nop
v_pk_add_f32 v[36:37], v[36:37], v[38:39]
v_cvt_pk_bf16_f32 v40, v36, v37
v_bfi_b32 v40, v11, s35, v40
s_cbranch_vccnz L_rr_w2rf
buffer_store_dword v40, v10, s[4:7], 0 offen
s_cmp_eq_u32 s34, 63
v_mov_b32 v11, v40
s_cbranch_scc1 L_done_w2rf
s_mov_b64 exec, 1
buffer_store_dword v42, v1, s[4:7], s33 offen
s_mov_b64 exec, -1
v_mov_b64 v[20:21], 0
v_mov_b64 v[22:23], 0
v_mov_b64 v[24:25], 0
v_mov_b64 v[26:27], 0
v_mov_b64 v[28:29], 0
v_mov_b64 v[30:31], 0
v_mov_b64 v[32:33], 0
v_mov_b64 v[34:35], 0
v_mov_b64 v[36:37], 0
v_mov_b64 v[38:39], 0
v_mov_b64 v[40:41], 0
v_mov_b64 v[42:43], 0
v_bfe_u32 v77, v1, 6, 1
v_lshl_add_u32 v77, v77, 3, v1
v_lshlrev_b32 v77, 1, v77
v_mov_b32 v79, s36
L_sp_w2rf:
buffer_load_dword v79, v6, s[4:7], s58 offen sc1
s_sub_u32 s41, s41, 1
s_cbranch_scc1 L_exit
buffer_load_dwordx4 v1, s[4:7], s47 offen offset:0 sc1 lds
buffer_load_dwordx4 v1, s[4:7], s47 offen offset:1024 sc1 lds
buffer_load_dwordx4 v1, s[4:7], s47 offen offset:2048 sc1 lds
buffer_load_dwordx4 v1, s[4:7], s47 offen offset:3072 sc1 lds
s_waitcnt vmcnt(9)
v_cmp_ne_u32 vcc, s35, v79
s_cbranch_vccnz L_sp_w2rf
L_top_w2rf:
s_waitcnt vmcnt(7)
s_barrier
ds_read_b128 v[60:63], v1 offset:1024
ds_read_b128 v[64:67], v1 offset:2048
s_mov_b32 m0, 5120
s_nop 0
buffer_load_dwordx4 v1, s[4:7], s48 offen offset:2048 sc1 lds
s_waitcnt vmcnt(6)
s_barrier
ds_read_b128 v[68:71], v1 offset:3072
ds_read_b128 v[72:75], v1 offset:4096
L_s0_w2rf:
s_waitcnt lgkmcnt(3)
v_smfmac_f32_16x16x64_bf16 v[28:31], v[60:63], v[176:183], v0
v_smfmac_f32_16x16x64_bf16 v[32:35], v[60:63], v[184:191], v0
v_smfmac_f32_16x16x64_bf16 v[36:39], v[60:63], a[48:55], v0
v_smfmac_f32_16x16x64_bf16 v[40:43], v[60:63], a[56:63], v0
s_waitcnt lgkmcnt(2)
v_smfmac_f32_16x16x64_bf16 v[20:23], v[64:67], v[80:87], v0
v_smfmac_f32_16x16x64_bf16 v[20:23], v[60:63], v[44:51], v0
ds_read_b128 v[44:47], v2 offset:2048
v_smfmac_f32_16x16x64_bf16 v[24:27], v[64:67], v[88:95], v0
ds_read_b128 v[48:51], v2 offset:3072
buffer_load_dwordx4 v[12:15], v9, s[4:7], s37 offen offset:0
v_smfmac_f32_16x16x64_bf16 v[28:31], v[64:67], v[192:199], v0
s_waitcnt lgkmcnt(2)
v_bitop3_b32 v6, v60, v64, s35 bitop3:0x7e
v_smfmac_f32_16x16x64_bf16 v[32:35], v[64:67], v[200:207], v0
v_bitop3_b32 v76, v68, v72, s35 bitop3:0x7e
v_smfmac_f32_16x16x64_bf16 v[36:39], v[64:67], a[64:71], v0
v_bitop3_b32 v6, v6, v76, 1 bitop3:0xa8
s_waitcnt lgkmcnt(0)
v_smfmac_f32_16x16x64_bf16 v[24:27], v[60:63], v[44:51], v0
ds_read_b128 v[44:47], v2 offset:4096
v_cmp_ne_u32 vcc, 0, v6
buffer_load_dwordx4 v[16:19], v9, s[4:7], s37 offen offset:1024
v_smfmac_f32_16x16x64_bf16 v[40:43], v[64:67], a[72:79], v0
ds_read_b128 v[48:51], v2 offset:5120
v_smfmac_f32_16x16x64_bf16 v[20:23], v[68:71], v[96:103], v0
s_cbranch_vccnz L_ra0_w2rf
v_smfmac_f32_16x16x64_bf16 v[24:27], v[68:71], v[104:111], v0
s_waitcnt vmcnt(2)
s_barrier
ds_read_b32 v6, v77 offset:8192
v_smfmac_f32_16x16x64_bf16 v[28:31], v[68:71], v[208:215], v0
ds_read_b128 v[60:63], v1 offset:6144
s_waitcnt lgkmcnt(2)
buffer_load_dwordx4 v[52:55], v1, s[4:7], s37 offen offset:2048
v_smfmac_f32_16x16x64_bf16 v[20:23], v[72:75], v[44:51], v0
ds_read_b128 v[64:67], v1 offset:7168
v_smfmac_f32_16x16x64_bf16 v[32:35], v[68:71], v[216:223], v0
ds_read_b128 v[44:47], v2 offset:6144
ds_read_b128 v[76:79], v1 offset:5120
v_smfmac_f32_16x16x64_bf16 v[36:39], v[68:71], a[80:87], v0
ds_read_b128 v[48:51], v2 offset:7168
v_smfmac_f32_16x16x64_bf16 v[40:43], v[68:71], a[88:95], v0
ds_read_b128 v[68:71], v1 offset:8192
s_waitcnt lgkmcnt(5)
v_bitop3_b32 v6, v6, v60, s35 bitop3:0x7e
buffer_load_dwordx4 v[56:59], v1, s[4:7], s37 offen offset:3072
v_smfmac_f32_16x16x64_bf16 v[28:31], v[72:75], v[224:231], v0
s_waitcnt lgkmcnt(4)
v_bitop3_b32 v6, v6, v64, s35 bitop3:0xf6
v_smfmac_f32_16x16x64_bf16 v[32:35], v[72:75], v[232:239], v0
s_mov_b32 m0, 0
s_waitcnt lgkmcnt(2)
v_bitop3_b32 v6, v6, v76, s35 bitop3:0xf6
v_and_b32 v6, 1, v6
s_waitcnt lgkmcnt(1)
v_smfmac_f32_16x16x64_bf16 v[24:27], v[72:75], v[44:51], v0
ds_read_b128 v[44:47], v2 offset:8192
v_cmp_ne_u32 vcc, 0, v6
v_smfmac_f32_16x16x64_bf16 v[36:39], v[72:75], a[96:103], v0
ds_read_b128 v[48:51], v2 offset:9216
v_lshlrev_b32 v6, 3, v1
v_smfmac_f32_16x16x64_bf16 v[40:43], v[72:75], a[104:111], v0
ds_read_b128 v[72:75], v1 offset:9216
s_cbranch_vccnz L_ra1_w2rf
L_a1_w2rf:
buffer_store_dword v11, v10, s[4:7], s40 offen sc0 sc1
v_smfmac_f32_16x16x64_bf16 v[20:23], v[60:63], v[112:119], v0
v_smfmac_f32_16x16x64_bf16 v[20:23], v[64:67], v[128:135], v0
v_bfe_u32 v6, v1, 5, 1
s_waitcnt lgkmcnt(3)
v_smfmac_f32_16x16x64_bf16 v[20:23], v[68:71], v[144:151], v0
v_mad_i32_i24 v6, v6, s55, v1
s_waitcnt lgkmcnt(0)
v_smfmac_f32_16x16x64_bf16 v[20:23], v[72:75], v[160:167], v0
v_smfmac_f32_16x16x64_bf16 v[20:23], v[76:79], v[44:51], v0
ds_read_b128 v[44:47], v2 offset:10240
v_smfmac_f32_16x16x64_bf16 v[24:27], v[60:63], v[120:127], v0
ds_read_b128 v[48:51], v2 offset:11264
v_smfmac_f32_16x16x64_bf16 v[24:27], v[64:67], v[136:143], v0
v_add_f32 v20, v20, v22
v_smfmac_f32_16x16x64_bf16 v[24:27], v[68:71], v[152:159], v0
v_add_f32 v21, v21, v23
v_smfmac_f32_16x16x64_bf16 v[24:27], v[72:75], v[168:175], v0
v_cvt_pk_bf16_f32 v22, v20, v21
s_waitcnt lgkmcnt(0)
v_smfmac_f32_16x16x64_bf16 v[24:27], v[76:79], v[44:51], v0
ds_read_b128 v[44:47], v2 offset:12288
v_smfmac_f32_16x16x64_bf16 v[28:31], v[76:79], v[240:247], v0
ds_read_b128 v[48:51], v2 offset:13312
v_smfmac_f32_16x16x64_bf16 v[28:31], v[64:67], a[0:7], v0
v_add_f32 v24, v24, v26
v_add_f32 v25, v25, v27
v_cvt_pk_bf16_f32 v23, v24, v25
v_smfmac_f32_16x16x64_bf16 v[28:31], v[68:71], a[16:23], v0
ds_write_b64 v3, v[22:23] offset:11264
v_smfmac_f32_16x16x64_bf16 v[28:31], v[72:75], a[32:39], v0
s_waitcnt lgkmcnt(1)
v_smfmac_f32_16x16x64_bf16 v[28:31], v[60:63], v[44:51], v0
ds_read_b128 v[44:47], v2 offset:14336
v_smfmac_f32_16x16x64_bf16 v[32:35], v[76:79], v[248:255], v0
ds_read_b128 v[48:51], v2 offset:15360
v_smfmac_f32_16x16x64_bf16 v[32:35], v[64:67], a[8:15], v0
v_add_f32 v28, v28, v30
s_waitcnt lgkmcnt(2)
s_barrier
v_smfmac_f32_16x16x64_bf16 v[32:35], v[68:71], a[24:31], v0
ds_read_b64_tr_b16 v[20:21], v4 offset:10240
ds_read_b64_tr_b16 v[22:23], v4 offset:10752
v_add_f32 v29, v29, v31
v_smfmac_f32_16x16x64_bf16 v[32:35], v[72:75], a[40:47], v0
ds_read_b64_tr_b16 v[24:25], v4 offset:11264
ds_read_b64_tr_b16 v[26:27], v4 offset:11776
v_cvt_pk_bf16_f32 v30, v28, v29
s_waitcnt lgkmcnt(4)
v_smfmac_f32_16x16x64_bf16 v[32:35], v[60:63], v[44:51], v0
ds_read_b128 v[44:47], v2 offset:18432
s_waitcnt vmcnt(3)
s_waitcnt lgkmcnt(3)
v_mfma_f32_16x16x32_bf16 v[12:15], v[12:15], v[20:23], 0
ds_read_b128 v[48:51], v2 offset:19456
s_waitcnt lgkmcnt(2)
v_mfma_f32_16x16x32_bf16 v[12:15], v[16:19], v[24:27], v[12:15]
v_add_f32 v32, v32, v34
v_add_f32 v33, v33, v35
v_cvt_pk_bf16_f32 v31, v32, v33
ds_write_b64 v3, v[30:31] offset:13312
v_smfmac_f32_16x16x64_bf16 v[36:39], v[76:79], a[112:119], v0
s_nop 2
v_add_f32_dpp v12, v14, v12 quad_perm:[2,3,0,1] row_mask:0xf bank_mask:0xf
v_add_f32_dpp v13, v15, v13 quad_perm:[2,3,0,1] row_mask:0xf bank_mask:0xf
v_exp_f32 v14, v12
v_exp_f32 v15, v13
v_smfmac_f32_16x16x64_bf16 v[40:43], v[76:79], a[120:127], v0
v_cvt_pk_bf16_f32 v14, v14, v15
ds_write_b32 v5, v14 offset:14880
s_waitcnt lgkmcnt(1)
s_barrier
ds_read_b64_tr_b16 v[28:29], v4 offset:12288
v_smfmac_f32_16x16x64_bf16 v[36:39], v[60:63], a[128:135], v0
ds_read_b64_tr_b16 v[30:31], v4 offset:12800
ds_read_b64_tr_b16 v[32:33], v4 offset:13312
v_smfmac_f32_16x16x64_bf16 v[40:43], v[60:63], a[136:143], v0
ds_read_b64_tr_b16 v[34:35], v4 offset:13824
v_mov_b64 v[76:77], s[52:53]
v_smfmac_f32_16x16x64_bf16 v[40:43], v[72:75], v[44:51], v0
ds_read_b128 v[44:47], v2 offset:16384
v_mov_b64 v[78:79], s[52:53]
s_waitcnt lgkmcnt(3)
v_mfma_f32_16x16x32_bf16 v[28:31], v[28:31], v[20:23], 0
s_barrier
ds_read_b128 v[16:19], v1 offset:14368
s_waitcnt lgkmcnt(2)
v_mfma_f32_16x16x32_bf16 v[28:31], v[32:35], v[24:27], v[28:31]
ds_read_b128 v[60:63], v1 offset:14336
v_smfmac_f32_16x16x64_bf16 v[40:43], v[64:67], a[152:159], v0
ds_read_b128 v[48:51], v2 offset:17408
v_mov_b64 v[14:15], s[0:1]
v_smfmac_f32_16x16x64_bf16 v[40:43], v[68:71], a[168:175], v0
v_add_f32_dpp v28, v30, v28 quad_perm:[2,3,0,1] row_mask:0xf bank_mask:0xf
v_smfmac_f32_16x16x64_bf16 v[36:39], v[64:67], a[144:151], v0
ds_read_b128 v[64:67], v2 offset:27648
v_add_f32_dpp v29, v31, v29 quad_perm:[2,3,0,1] row_mask:0xf bank_mask:0xf
v_smfmac_f32_16x16x64_bf16 v[36:39], v[68:71], a[160:167], v0
ds_read_b128 v[68:71], v2 offset:20480
v_mul_f32 v28, s50, v28
s_waitcnt lgkmcnt(2)
v_smfmac_f32_16x16x64_bf16 v[36:39], v[72:75], v[44:51], v0
ds_read_b128 v[72:75], v2 offset:21504
v_mul_f32 v29, s50, v29
s_waitcnt vmcnt(1)
v_mfma_f32_16x16x32_bf16 v[32:35], v[76:79], v[16:19], 0
v_exp_f32 v30, v28
v_mfma_f32_16x16x32_bf16 v[20:23], v[52:55], v[16:19], 0
v_exp_f32 v31, v29
v_mfma_f32_16x16x32_bf16 v[20:23], v[56:59], v[60:63], v[20:23]
v_cvt_pk_bf16_f32 v30, v30, v31
v_cndmask_b32_e64 v24, 0, v30, s[56:57]
v_cndmask_b32_e64 v25, 0, v30, s[56:57]
v_cvt_pk_bf16_f32 v36, v36, v37
v_cvt_pk_bf16_f32 v37, v38, v39
v_mfma_f32_16x16x16_bf16 v[32:35], v[14:15], v[24:25], v[32:35]
v_cvt_pk_bf16_f32 v38, v40, v41
v_cvt_pk_bf16_f32 v39, v42, v43
v_mov_b32_dpp v26, v24 quad_perm:[2,3,0,1] row_mask:0xf bank_mask:0xf
v_mov_b32_dpp v27, v24 quad_perm:[2,3,0,1] row_mask:0xf bank_mask:0xf
ds_read_b128 v[44:47], v2 offset:22528
s_nop 0
v_mfma_f32_16x16x32_bf16 v[20:23], v[36:39], v[24:27], v[20:23]
ds_read_b128 v[48:51], v2 offset:23552
v_rcp_f32 v33, v32
ds_read_b128 v[60:63], v2 offset:26624
v_min_f32 v32, v32, v33
v_cmp_nlt_f32 vcc, s2, v32
v_mov_b64 v[76:77], 0
v_mov_b64 v[78:79], 0
v_mov_b64 v[40:41], 0
v_mul_f32_dpp v20, v33, v20 quad_perm:[0,1,0,1] row_mask:0xf bank_mask:0xf
v_mul_f32_dpp v21, v33, v21 quad_perm:[0,1,0,1] row_mask:0xf bank_mask:0xf
v_mul_f32_dpp v22, v33, v22 quad_perm:[0,1,0,1] row_mask:0xf bank_mask:0xf
v_mul_f32_dpp v23, v33, v23 quad_perm:[0,1,0,1] row_mask:0xf bank_mask:0xf
v_cvt_pk_bf16_f32 v20, v20, v21
v_cvt_pk_bf16_f32 v21, v22, v23
ds_write_b64 v6, v[20:21] offset:7168
v_mov_b64 v[42:43], 0
ds_read_b128 v[16:19], v7 offset:7168
s_and_b64 vcc, vcc, s[56:57]
v_mov_b64 v[24:25], 0
v_mov_b64 v[26:27], 0
s_cbranch_scc1 L_mx_w2rf
L_mxb_w2rf:
v_mov_b64 v[32:33], 0
v_mov_b64 v[34:35], 0
v_mov_b64 v[28:29], 0
v_mov_b64 v[30:31], 0
s_waitcnt lgkmcnt(1)
s_barrier
ds_read_b128 v[12:15], v7 offset:8192
s_waitcnt lgkmcnt(1)
v_smfmac_f32_16x16x64_bf16 v[76:79], v[16:19], v[44:51], v0 abid:1
ds_read_b128 v[52:55], v7 offset:5120
ds_read_b128 v[56:59], v7 offset:6144
v_smfmac_f32_16x16x64_bf16 v[40:43], v[16:19], v[60:67], v0 abid:1
ds_read_b128 v[44:47], v2 offset:24576
s_waitcnt lgkmcnt(3)
v_smfmac_f32_16x16x64_bf16 v[76:79], v[12:15], a[176:183], v0 abid:1
ds_read_b128 v[48:51], v2 offset:25600
v_smfmac_f32_16x16x64_bf16 v[40:43], v[12:15], a[184:191], v0 abid:1
ds_read_b128 v[60:63], v2 offset:30720
s_waitcnt lgkmcnt(4)
v_smfmac_f32_16x16x64_bf16 v[76:79], v[52:55], v[68:75], v0 abid:1
ds_read_b128 v[64:67], v2 offset:31744
s_waitcnt lgkmcnt(2)
v_smfmac_f32_16x16x64_bf16 v[40:43], v[52:55], v[44:51], v0 abid:1
ds_read_b128 v[68:71], v2 offset:28672
v_smfmac_f32_16x16x64_bf16 v[76:79], v[56:59], a[192:199], v0 abid:1
ds_read_b128 v[72:75], v2 offset:29696
v_smfmac_f32_16x16x64_bf16 v[40:43], v[56:59], a[200:207], v0 abid:1
s_waitcnt lgkmcnt(2)
v_smfmac_f32_16x16x64_bf16 v[24:27], v[16:19], v[60:67], v0 abid:1
v_cvt_pk_bf16_f32 v76, v76, v77
v_cvt_pk_bf16_f32 v77, v78, v79
v_bfi_b32 v76, 1, s35, v76
buffer_store_dwordx2 v[76:77], v8, s[4:7], s42 offen
v_smfmac_f32_16x16x64_bf16 v[24:27], v[12:15], a[208:215], v0 abid:1
v_cvt_pk_bf16_f32 v40, v40, v41
v_cvt_pk_bf16_f32 v41, v42, v43
v_bfi_b32 v40, 1, s35, v40
buffer_store_dwordx2 v[40:41], v8, s[4:7], s43 offen
s_waitcnt lgkmcnt(0)
v_smfmac_f32_16x16x64_bf16 v[24:27], v[52:55], v[68:75], v0 abid:1
v_smfmac_f32_16x16x64_bf16 v[24:27], v[56:59], a[216:223], v0 abid:1
v_smfmac_f32_16x16x64_bf16 v[32:35], v[16:19], a[224:231], v0 abid:1
v_smfmac_f32_16x16x64_bf16 v[32:35], v[12:15], a[232:239], v0 abid:1
v_cvt_pk_bf16_f32 v24, v24, v25
v_cvt_pk_bf16_f32 v25, v26, v27
v_bfi_b32 v24, 1, s35, v24
buffer_store_dwordx2 v[24:25], v8, s[4:7], s44 offen
v_smfmac_f32_16x16x64_bf16 v[32:35], v[52:55], a[240:247], v0 abid:1
v_smfmac_f32_16x16x64_bf16 v[32:35], v[56:59], a[248:255], v0 abid:1
s_nop 7
v_cvt_pk_bf16_f32 v32, v32, v33
v_cvt_pk_bf16_f32 v33, v34, v35
v_bfi_b32 v32, 1, s35, v32
buffer_store_dwordx2 v[32:33], v8, s[4:7], s45 offen
s_branch L_ex_w2rf
.p2align 6
L_ex_w3rf:
v_and_b32 v6, 0x70, v1
ds_read_b128 v[76:79], v6 offset:256
v_bfe_u32 v11, v1, 4, 2
v_lshrrev_b32_e64 v11, v11, 1
s_add_u32 s34, s34, 1
s_add_u32 s37, s37, 524288
s_add_u32 s39, s39, 524288
s_mul_i32 s40, s34, 10240
s_add_u32 s40, s40, 8093696
s_not_b32 s35, s35
s_not_b32 s36, s36
ds_read_b128 v[44:47], v2 offset:0
ds_read_b128 v[48:51], v2 offset:1024
s_barrier
s_waitcnt vmcnt(0)
v_mov_b64 v[20:21], 0
v_mov_b64 v[22:23], 0
v_mov_b64 v[24:25], 0
v_mov_b64 v[26:27], 0
v_mov_b64 v[28:29], 0
v_mov_b64 v[30:31], 0
v_mov_b64 v[32:33], 0
v_mov_b64 v[34:35], 0
buffer_load_dwordx4 v[60:63], v9, s[4:7], s3 offen offset:0 sc1
buffer_load_dwordx4 v[64:67], v9, s[4:7], s3 offen offset:1024 sc1
buffer_load_dwordx4 v[68:71], v9, s[4:7], s3 offen offset:2048 sc1
buffer_load_dwordx4 v[72:75], v9, s[4:7], s3 offen offset:3072 sc1
s_waitcnt lgkmcnt(2)
s_waitcnt vmcnt(3)
L_r_w3rf:
v_mfma_f32_16x16x32_bf16 v[36:39], v[60:63], v[76:79], 0
s_waitcnt vmcnt(2)
v_mfma_f32_16x16x32_bf16 v[36:39], v[64:67], v[76:79], v[36:39]
v_bitop3_b32 v40, v60, v64, s36 bitop3:0x7e
s_waitcnt vmcnt(1)
v_mfma_f32_16x16x32_bf16 v[36:39], v[68:71], v[76:79], v[36:39]
s_waitcnt vmcnt(0)
v_mfma_f32_16x16x32_bf16 v[36:39], v[72:75], v[76:79], v[36:39]
v_bitop3_b32 v41, v68, v72, s36 bitop3:0x7e
v_bitop3_b32 v40, v40, v41, 1 bitop3:0xa8
v_cmp_ne_u32 vcc, 0, v40
v_nop
v_nop
v_nop
v_nop
v_nop
v_pk_add_f32 v[36:37], v[36:37], v[38:39]
v_cvt_pk_bf16_f32 v40, v36, v37
v_bfi_b32 v40, v11, s35, v40
s_cbranch_vccnz L_rr_w3rf
buffer_store_dword v40, v10, s[4:7], 0 offen
s_cmp_eq_u32 s34, 63
v_mov_b32 v11, v40
s_cbranch_scc1 L_done_w3rf
v_mov_b64 v[36:37], 0
v_mov_b64 v[38:39], 0
v_mov_b64 v[40:41], 0
v_mov_b64 v[42:43], 0
v_bfe_u32 v77, v1, 6, 1
v_lshl_add_u32 v77, v77, 3, v1
v_lshlrev_b32 v77, 1, v77
L_top_w3rf:
s_barrier
ds_read_b128 v[60:63], v1 offset:1024
ds_read_b128 v[64:67], v1 offset:2048
s_mov_b32 m0, 5120
s_nop 0
buffer_load_dwordx4 v1, s[4:7], s48 offen offset:3072 sc1 lds
s_barrier
ds_read_b128 v[68:71], v1 offset:3072
ds_read_b128 v[72:75], v1 offset:4096
L_s0_w3rf:
s_waitcnt lgkmcnt(3)
v_smfmac_f32_16x16x64_bf16 v[28:31], v[60:63], v[176:183], v0
v_smfmac_f32_16x16x64_bf16 v[32:35], v[60:63], v[184:191], v0
v_smfmac_f32_16x16x64_bf16 v[36:39], v[60:63], a[48:55], v0
v_smfmac_f32_16x16x64_bf16 v[40:43], v[60:63], a[56:63], v0
s_waitcnt lgkmcnt(2)
v_smfmac_f32_16x16x64_bf16 v[20:23], v[64:67], v[80:87], v0
v_smfmac_f32_16x16x64_bf16 v[20:23], v[60:63], v[44:51], v0
ds_read_b128 v[44:47], v2 offset:2048
v_smfmac_f32_16x16x64_bf16 v[24:27], v[64:67], v[88:95], v0
ds_read_b128 v[48:51], v2 offset:3072
v_smfmac_f32_16x16x64_bf16 v[28:31], v[64:67], v[192:199], v0
s_waitcnt lgkmcnt(2)
v_bitop3_b32 v6, v60, v64, s35 bitop3:0x7e
buffer_load_dwordx4 v[12:15], v9, s[4:7], s37 offen offset:0
v_smfmac_f32_16x16x64_bf16 v[32:35], v[64:67], v[200:207], v0
v_bitop3_b32 v76, v68, v72, s35 bitop3:0x7e
v_smfmac_f32_16x16x64_bf16 v[36:39], v[64:67], a[64:71], v0
v_bitop3_b32 v6, v6, v76, 1 bitop3:0xa8
s_waitcnt lgkmcnt(0)
v_smfmac_f32_16x16x64_bf16 v[24:27], v[60:63], v[44:51], v0
ds_read_b128 v[44:47], v2 offset:4096
v_cmp_ne_u32 vcc, 0, v6
v_smfmac_f32_16x16x64_bf16 v[40:43], v[64:67], a[72:79], v0
ds_read_b128 v[48:51], v2 offset:5120
buffer_load_dwordx4 v[16:19], v9, s[4:7], s37 offen offset:1024
v_smfmac_f32_16x16x64_bf16 v[20:23], v[68:71], v[96:103], v0
s_cbranch_vccnz L_ra0_w3rf
v_smfmac_f32_16x16x64_bf16 v[24:27], v[68:71], v[104:111], v0
s_waitcnt vmcnt(2)
s_barrier
ds_read_b32 v6, v77 offset:8192
v_smfmac_f32_16x16x64_bf16 v[28:31], v[68:71], v[208:215], v0
ds_read_b128 v[60:63], v1 offset:6144
s_waitcnt lgkmcnt(2)
v_smfmac_f32_16x16x64_bf16 v[20:23], v[72:75], v[44:51], v0
ds_read_b128 v[64:67], v1 offset:7168
buffer_load_dwordx4 v[52:55], v1, s[4:7], s37 offen offset:2048
v_smfmac_f32_16x16x64_bf16 v[32:35], v[68:71], v[216:223], v0
ds_read_b128 v[44:47], v2 offset:6144
ds_read_b128 v[76:79], v1 offset:5120
v_smfmac_f32_16x16x64_bf16 v[36:39], v[68:71], a[80:87], v0
ds_read_b128 v[48:51], v2 offset:7168
v_smfmac_f32_16x16x64_bf16 v[40:43], v[68:71], a[88:95], v0
ds_read_b128 v[68:71], v1 offset:8192
s_waitcnt lgkmcnt(5)
v_bitop3_b32 v6, v6, v60, s35 bitop3:0x7e
v_smfmac_f32_16x16x64_bf16 v[28:31], v[72:75], v[224:231], v0
s_waitcnt lgkmcnt(4)
v_bitop3_b32 v6, v6, v64, s35 bitop3:0xf6
buffer_load_dwordx4 v[56:59], v1, s[4:7], s37 offen offset:3072
v_smfmac_f32_16x16x64_bf16 v[32:35], v[72:75], v[232:239], v0
s_mov_b32 m0, 0
s_waitcnt lgkmcnt(2)
v_bitop3_b32 v6, v6, v76, s35 bitop3:0xf6
v_and_b32 v6, 1, v6
s_waitcnt lgkmcnt(1)
v_smfmac_f32_16x16x64_bf16 v[24:27], v[72:75], v[44:51], v0
ds_read_b128 v[44:47], v2 offset:8192
v_cmp_ne_u32 vcc, 0, v6
v_smfmac_f32_16x16x64_bf16 v[36:39], v[72:75], a[96:103], v0
ds_read_b128 v[48:51], v2 offset:9216
v_lshlrev_b32 v6, 3, v1
v_smfmac_f32_16x16x64_bf16 v[40:43], v[72:75], a[104:111], v0
ds_read_b128 v[72:75], v1 offset:9216
s_cbranch_vccnz L_ra1_w3rf
L_a1_w3rf:
buffer_store_dword v11, v10, s[4:7], s40 offen sc0 sc1
v_smfmac_f32_16x16x64_bf16 v[20:23], v[60:63], v[112:119], v0
v_smfmac_f32_16x16x64_bf16 v[20:23], v[64:67], v[128:135], v0
v_bfe_u32 v6, v1, 5, 1
s_waitcnt lgkmcnt(3)
v_smfmac_f32_16x16x64_bf16 v[20:23], v[68:71], v[144:151], v0
v_mad_i32_i24 v6, v6, s55, v1
s_waitcnt lgkmcnt(0)
v_smfmac_f32_16x16x64_bf16 v[20:23], v[72:75], v[160:167], v0
v_smfmac_f32_16x16x64_bf16 v[20:23], v[76:79], v[44:51], v0
ds_read_b128 v[44:47], v2 offset:10240
v_smfmac_f32_16x16x64_bf16 v[24:27], v[60:63], v[120:127], v0
ds_read_b128 v[48:51], v2 offset:11264
v_smfmac_f32_16x16x64_bf16 v[24:27], v[64:67], v[136:143], v0
v_add_f32 v20, v20, v22
v_smfmac_f32_16x16x64_bf16 v[24:27], v[68:71], v[152:159], v0
v_add_f32 v21, v21, v23
v_smfmac_f32_16x16x64_bf16 v[24:27], v[72:75], v[168:175], v0
v_cvt_pk_bf16_f32 v22, v20, v21
s_waitcnt lgkmcnt(0)
v_smfmac_f32_16x16x64_bf16 v[24:27], v[76:79], v[44:51], v0
ds_read_b128 v[44:47], v2 offset:12288
v_smfmac_f32_16x16x64_bf16 v[28:31], v[76:79], v[240:247], v0
ds_read_b128 v[48:51], v2 offset:13312
v_smfmac_f32_16x16x64_bf16 v[28:31], v[64:67], a[0:7], v0
v_add_f32 v24, v24, v26
v_add_f32 v25, v25, v27
v_cvt_pk_bf16_f32 v23, v24, v25
v_smfmac_f32_16x16x64_bf16 v[28:31], v[68:71], a[16:23], v0
ds_write_b64 v3, v[22:23] offset:11776
v_smfmac_f32_16x16x64_bf16 v[28:31], v[72:75], a[32:39], v0
s_waitcnt lgkmcnt(1)
v_smfmac_f32_16x16x64_bf16 v[28:31], v[60:63], v[44:51], v0
ds_read_b128 v[44:47], v2 offset:14336
v_smfmac_f32_16x16x64_bf16 v[32:35], v[76:79], v[248:255], v0
ds_read_b128 v[48:51], v2 offset:15360
v_smfmac_f32_16x16x64_bf16 v[32:35], v[64:67], a[8:15], v0
v_add_f32 v28, v28, v30
s_waitcnt lgkmcnt(2)
s_barrier
v_smfmac_f32_16x16x64_bf16 v[32:35], v[68:71], a[24:31], v0
ds_read_b64_tr_b16 v[20:21], v4 offset:10240
ds_read_b64_tr_b16 v[22:23], v4 offset:10752
v_add_f32 v29, v29, v31
v_smfmac_f32_16x16x64_bf16 v[32:35], v[72:75], a[40:47], v0
ds_read_b64_tr_b16 v[24:25], v4 offset:11264
ds_read_b64_tr_b16 v[26:27], v4 offset:11776
v_cvt_pk_bf16_f32 v30, v28, v29
s_waitcnt lgkmcnt(4)
v_smfmac_f32_16x16x64_bf16 v[32:35], v[60:63], v[44:51], v0
ds_read_b128 v[44:47], v2 offset:18432
s_waitcnt vmcnt(3)
s_waitcnt lgkmcnt(3)
v_mfma_f32_16x16x32_bf16 v[12:15], v[12:15], v[20:23], 0
ds_read_b128 v[48:51], v2 offset:19456
s_waitcnt lgkmcnt(2)
v_mfma_f32_16x16x32_bf16 v[12:15], v[16:19], v[24:27], v[12:15]
v_add_f32 v32, v32, v34
v_add_f32 v33, v33, v35
v_cvt_pk_bf16_f32 v31, v32, v33
ds_write_b64 v3, v[30:31] offset:13824
v_smfmac_f32_16x16x64_bf16 v[36:39], v[76:79], a[112:119], v0
s_nop 2
v_add_f32_dpp v12, v14, v12 quad_perm:[2,3,0,1] row_mask:0xf bank_mask:0xf
v_add_f32_dpp v13, v15, v13 quad_perm:[2,3,0,1] row_mask:0xf bank_mask:0xf
v_exp_f32 v14, v12
v_exp_f32 v15, v13
v_smfmac_f32_16x16x64_bf16 v[40:43], v[76:79], a[120:127], v0
v_cvt_pk_bf16_f32 v14, v14, v15
ds_write_b32 v5, v14 offset:15136
s_waitcnt lgkmcnt(1)
s_barrier
ds_read_b64_tr_b16 v[28:29], v4 offset:12288
v_smfmac_f32_16x16x64_bf16 v[36:39], v[60:63], a[128:135], v0
ds_read_b64_tr_b16 v[30:31], v4 offset:12800
ds_read_b64_tr_b16 v[32:33], v4 offset:13312
v_smfmac_f32_16x16x64_bf16 v[40:43], v[60:63], a[136:143], v0
ds_read_b64_tr_b16 v[34:35], v4 offset:13824
v_mov_b64 v[76:77], s[52:53]
v_smfmac_f32_16x16x64_bf16 v[40:43], v[72:75], v[44:51], v0
ds_read_b128 v[44:47], v2 offset:16384
v_mov_b64 v[78:79], s[52:53]
s_waitcnt lgkmcnt(3)
v_mfma_f32_16x16x32_bf16 v[28:31], v[28:31], v[20:23], 0
s_barrier
ds_read_b128 v[16:19], v1 offset:14368
s_waitcnt lgkmcnt(2)
v_mfma_f32_16x16x32_bf16 v[28:31], v[32:35], v[24:27], v[28:31]
ds_read_b128 v[60:63], v1 offset:14336
v_smfmac_f32_16x16x64_bf16 v[40:43], v[64:67], a[152:159], v0
ds_read_b128 v[48:51], v2 offset:17408
v_mov_b64 v[14:15], s[0:1]
v_smfmac_f32_16x16x64_bf16 v[40:43], v[68:71], a[168:175], v0
v_add_f32_dpp v28, v30, v28 quad_perm:[2,3,0,1] row_mask:0xf bank_mask:0xf
v_smfmac_f32_16x16x64_bf16 v[36:39], v[64:67], a[144:151], v0
ds_read_b128 v[64:67], v2 offset:25600
v_add_f32_dpp v29, v31, v29 quad_perm:[2,3,0,1] row_mask:0xf bank_mask:0xf
v_smfmac_f32_16x16x64_bf16 v[36:39], v[68:71], a[160:167], v0
ds_read_b128 v[68:71], v2 offset:22528
v_mul_f32 v28, s50, v28
s_waitcnt lgkmcnt(2)
v_smfmac_f32_16x16x64_bf16 v[36:39], v[72:75], v[44:51], v0
ds_read_b128 v[72:75], v2 offset:23552
v_mul_f32 v29, s50, v29
s_waitcnt vmcnt(1)
v_mfma_f32_16x16x32_bf16 v[32:35], v[76:79], v[16:19], 0
v_exp_f32 v30, v28
v_mfma_f32_16x16x32_bf16 v[20:23], v[52:55], v[16:19], 0
v_exp_f32 v31, v29
v_mfma_f32_16x16x32_bf16 v[20:23], v[56:59], v[60:63], v[20:23]
v_cvt_pk_bf16_f32 v30, v30, v31
v_cndmask_b32_e64 v24, 0, v30, s[56:57]
v_cndmask_b32_e64 v25, 0, v30, s[56:57]
v_cvt_pk_bf16_f32 v36, v36, v37
v_cvt_pk_bf16_f32 v37, v38, v39
v_mfma_f32_16x16x16_bf16 v[32:35], v[14:15], v[24:25], v[32:35]
v_cvt_pk_bf16_f32 v38, v40, v41
v_cvt_pk_bf16_f32 v39, v42, v43
v_mov_b32_dpp v26, v24 quad_perm:[2,3,0,1] row_mask:0xf bank_mask:0xf
v_mov_b32_dpp v27, v24 quad_perm:[2,3,0,1] row_mask:0xf bank_mask:0xf
ds_read_b128 v[44:47], v2 offset:20480
s_nop 0
v_mfma_f32_16x16x32_bf16 v[20:23], v[36:39], v[24:27], v[20:23]
ds_read_b128 v[48:51], v2 offset:21504
v_rcp_f32 v33, v32
ds_read_b128 v[60:63], v2 offset:24576
v_min_f32 v32, v32, v33
v_cmp_nlt_f32 vcc, s2, v32
v_mov_b64 v[76:77], 0
v_mov_b64 v[78:79], 0
v_mov_b64 v[40:41], 0
v_mul_f32_dpp v20, v33, v20 quad_perm:[0,1,0,1] row_mask:0xf bank_mask:0xf
v_mul_f32_dpp v21, v33, v21 quad_perm:[0,1,0,1] row_mask:0xf bank_mask:0xf
v_mul_f32_dpp v22, v33, v22 quad_perm:[0,1,0,1] row_mask:0xf bank_mask:0xf
v_mul_f32_dpp v23, v33, v23 quad_perm:[0,1,0,1] row_mask:0xf bank_mask:0xf
v_cvt_pk_bf16_f32 v20, v20, v21
v_cvt_pk_bf16_f32 v21, v22, v23
ds_write_b64 v6, v[20:21] offset:8192
v_mov_b64 v[42:43], 0
ds_read_b128 v[16:19], v7 offset:8192
s_and_b64 vcc, vcc, s[56:57]
v_mov_b64 v[24:25], 0
v_mov_b64 v[26:27], 0
s_cbranch_scc1 L_mx_w3rf
L_mxb_w3rf:
v_mov_b64 v[32:33], 0
v_mov_b64 v[34:35], 0
v_mov_b64 v[28:29], 0
v_mov_b64 v[30:31], 0
s_waitcnt lgkmcnt(1)
s_barrier
ds_read_b128 v[12:15], v7 offset:5120
s_waitcnt lgkmcnt(1)
v_smfmac_f32_16x16x64_bf16 v[76:79], v[16:19], a[176:183], v0 abid:1
ds_read_b128 v[52:55], v7 offset:6144
ds_read_b128 v[56:59], v7 offset:7168
v_smfmac_f32_16x16x64_bf16 v[40:43], v[16:19], a[184:191], v0 abid:1
s_waitcnt lgkmcnt(2)
v_smfmac_f32_16x16x64_bf16 v[76:79], v[12:15], v[44:51], v0 abid:1
ds_read_b128 v[44:47], v2 offset:26624
v_smfmac_f32_16x16x64_bf16 v[40:43], v[12:15], v[60:67], v0 abid:1
ds_read_b128 v[48:51], v2 offset:27648
s_waitcnt lgkmcnt(3)
v_smfmac_f32_16x16x64_bf16 v[76:79], v[52:55], a[192:199], v0 abid:1
ds_read_b128 v[60:63], v2 offset:28672
v_smfmac_f32_16x16x64_bf16 v[40:43], v[52:55], a[200:207], v0 abid:1
ds_read_b128 v[64:67], v2 offset:29696
s_waitcnt lgkmcnt(4)
v_smfmac_f32_16x16x64_bf16 v[76:79], v[56:59], v[68:75], v0 abid:1
ds_read_b128 v[68:71], v2 offset:30720
s_waitcnt lgkmcnt(3)
v_smfmac_f32_16x16x64_bf16 v[40:43], v[56:59], v[44:51], v0 abid:1
ds_read_b128 v[72:75], v2 offset:31744
v_smfmac_f32_16x16x64_bf16 v[24:27], v[16:19], a[208:215], v0 abid:1
v_cvt_pk_bf16_f32 v76, v76, v77
v_cvt_pk_bf16_f32 v77, v78, v79
v_bfi_b32 v76, 1, s35, v76
buffer_store_dwordx2 v[76:77], v8, s[4:7], s42 offen
s_waitcnt lgkmcnt(2)
v_smfmac_f32_16x16x64_bf16 v[24:27], v[12:15], v[60:67], v0 abid:1
v_cvt_pk_bf16_f32 v40, v40, v41
v_cvt_pk_bf16_f32 v41, v42, v43
v_bfi_b32 v40, 1, s35, v40
buffer_store_dwordx2 v[40:41], v8, s[4:7], s43 offen
v_smfmac_f32_16x16x64_bf16 v[24:27], v[52:55], a[216:223], v0 abid:1
s_waitcnt lgkmcnt(0)
v_smfmac_f32_16x16x64_bf16 v[24:27], v[56:59], v[68:75], v0 abid:1
v_smfmac_f32_16x16x64_bf16 v[32:35], v[16:19], a[224:231], v0 abid:1
v_smfmac_f32_16x16x64_bf16 v[32:35], v[12:15], a[232:239], v0 abid:1
v_cvt_pk_bf16_f32 v24, v24, v25
v_cvt_pk_bf16_f32 v25, v26, v27
v_bfi_b32 v24, 1, s35, v24
buffer_store_dwordx2 v[24:25], v8, s[4:7], s44 offen
v_smfmac_f32_16x16x64_bf16 v[32:35], v[52:55], a[240:247], v0 abid:1
v_smfmac_f32_16x16x64_bf16 v[32:35], v[56:59], a[248:255], v0 abid:1
s_nop 7
v_cvt_pk_bf16_f32 v32, v32, v33
v_cvt_pk_bf16_f32 v33, v34, v35
v_bfi_b32 v32, 1, s35, v32
buffer_store_dwordx2 v[32:33], v8, s[4:7], s45 offen
s_branch L_ex_w3rf
.p2align 6
L_ex_w0s:
s_add_u32 s34, s34, 1
s_add_u32 s37, s37, 524288
s_add_u32 s39, s39, 524288
s_mul_i32 s40, s34, 10240
s_add_u32 s40, s40, 8093696
s_not_b32 s35, s35
s_not_b32 s36, s36
v_mov_b64 v[20:21], 0
v_mov_b64 v[22:23], 0
v_mov_b64 v[24:25], 0
v_mov_b64 v[26:27], 0
v_mov_b64 v[28:29], 0
v_mov_b64 v[30:31], 0
v_mov_b64 v[32:33], 0
v_mov_b64 v[34:35], 0
v_mov_b64 v[36:37], 0
v_mov_b64 v[38:39], 0
v_mov_b64 v[40:41], 0
v_mov_b64 v[42:43], 0
s_cmp_eq_u32 s34, 63
s_cbranch_scc1 L_done_w0s
ds_read_b128 v[44:47], v2 offset:0
ds_read_b128 v[48:51], v2 offset:1024
v_bfe_u32 v77, v1, 6, 1
v_lshl_add_u32 v77, v77, 3, v1
v_lshlrev_b32 v77, 1, v77
s_barrier
s_cmp_ge_u32 s34, s100
s_cbranch_scc1 L_ev_w0s
L_evb_w0s:
L_top_w0s:
s_barrier
ds_read_b128 v[60:63], v1 offset:1024
ds_read_b128 v[64:67], v1 offset:2048
s_mov_b32 m0, 5120
s_nop 0
buffer_load_dwordx4 v1, s[4:7], s48 offen offset:0 sc0 sc1 lds
s_barrier
ds_read_b128 v[68:71], v1 offset:3072
ds_read_b128 v[72:75], v1 offset:4096
L_s0_w0s:
s_waitcnt lgkmcnt(3)
v_smfmac_f32_16x16x64_bf16 v[28:31], v[60:63], v[176:183], v0
v_smfmac_f32_16x16x64_bf16 v[32:35], v[60:63], v[184:191], v0
v_smfmac_f32_16x16x64_bf16 v[36:39], v[60:63], a[48:55], v0
v_smfmac_f32_16x16x64_bf16 v[40:43], v[60:63], a[56:63], v0
s_waitcnt lgkmcnt(2)
v_smfmac_f32_16x16x64_bf16 v[20:23], v[64:67], v[80:87], v0
buffer_load_dwordx4 v[12:15], v9, s[4:7], s37 offen offset:0
v_smfmac_f32_16x16x64_bf16 v[20:23], v[60:63], v[44:51], v0
ds_read_b128 v[44:47], v2 offset:2048
v_smfmac_f32_16x16x64_bf16 v[24:27], v[64:67], v[88:95], v0
ds_read_b128 v[48:51], v2 offset:3072
v_smfmac_f32_16x16x64_bf16 v[28:31], v[64:67], v[192:199], v0
s_waitcnt lgkmcnt(2)
v_bitop3_b32 v6, v60, v64, s35 bitop3:0x7e
v_smfmac_f32_16x16x64_bf16 v[32:35], v[64:67], v[200:207], v0
v_bitop3_b32 v76, v68, v72, s35 bitop3:0x7e
buffer_load_dwordx4 v[16:19], v9, s[4:7], s37 offen offset:1024
v_smfmac_f32_16x16x64_bf16 v[36:39], v[64:67], a[64:71], v0
v_bitop3_b32 v6, v6, v76, 1 bitop3:0xa8
s_waitcnt lgkmcnt(0)
v_smfmac_f32_16x16x64_bf16 v[24:27], v[60:63], v[44:51], v0
ds_read_b128 v[44:47], v2 offset:4096
v_cmp_ne_u32 vcc, 0, v6
v_smfmac_f32_16x16x64_bf16 v[40:43], v[64:67], a[72:79], v0
ds_read_b128 v[48:51], v2 offset:5120
v_smfmac_f32_16x16x64_bf16 v[20:23], v[68:71], v[96:103], v0
s_cbranch_vccnz L_ra0_w0s
buffer_load_dwordx4 v[52:55], v1, s[4:7], s37 offen offset:2048
v_smfmac_f32_16x16x64_bf16 v[24:27], v[68:71], v[104:111], v0
s_waitcnt vmcnt(3)
s_barrier
ds_read_b32 v6, v77 offset:8192
v_smfmac_f32_16x16x64_bf16 v[28:31], v[68:71], v[208:215], v0
ds_read_b128 v[60:63], v1 offset:6144
s_waitcnt lgkmcnt(2)
v_smfmac_f32_16x16x64_bf16 v[20:23], v[72:75], v[44:51], v0
ds_read_b128 v[64:67], v1 offset:7168
v_smfmac_f32_16x16x64_bf16 v[32:35], v[68:71], v[216:223], v0
ds_read_b128 v[44:47], v2 offset:6144
ds_read_b128 v[76:79], v1 offset:5120
buffer_load_dwordx4 v[56:59], v1, s[4:7], s37 offen offset:3072
v_smfmac_f32_16x16x64_bf16 v[36:39], v[68:71], a[80:87], v0
ds_read_b128 v[48:51], v2 offset:7168
v_smfmac_f32_16x16x64_bf16 v[40:43], v[68:71], a[88:95], v0
ds_read_b128 v[68:71], v1 offset:8192
s_waitcnt lgkmcnt(5)
v_bitop3_b32 v6, v6, v60, s35 bitop3:0x7e
v_smfmac_f32_16x16x64_bf16 v[28:31], v[72:75], v[224:231], v0
s_waitcnt lgkmcnt(4)
v_bitop3_b32 v6, v6, v64, s35 bitop3:0xf6
v_smfmac_f32_16x16x64_bf16 v[32:35], v[72:75], v[232:239], v0
s_mov_b32 m0, 0
s_waitcnt lgkmcnt(2)
v_bitop3_b32 v6, v6, v76, s35 bitop3:0xf6
v_and_b32 v6, 1, v6
s_waitcnt lgkmcnt(1)
v_smfmac_f32_16x16x64_bf16 v[24:27], v[72:75], v[44:51], v0
ds_read_b128 v[44:47], v2 offset:8192
v_cmp_ne_u32 vcc, 0, v6
v_smfmac_f32_16x16x64_bf16 v[36:39], v[72:75], a[96:103], v0
ds_read_b128 v[48:51], v2 offset:9216
v_lshlrev_b32 v6, 3, v1
v_smfmac_f32_16x16x64_bf16 v[40:43], v[72:75], a[104:111], v0
ds_read_b128 v[72:75], v1 offset:9216
s_cbranch_vccnz L_ra1_w0s
L_a1_w0s:
buffer_load_dword v6, s[4:7], s39 offen lds
v_smfmac_f32_16x16x64_bf16 v[20:23], v[60:63], v[112:119], v0
v_smfmac_f32_16x16x64_bf16 v[20:23], v[64:67], v[128:135], v0
v_bfe_u32 v6, v1, 5, 1
s_waitcnt lgkmcnt(3)
v_smfmac_f32_16x16x64_bf16 v[20:23], v[68:71], v[144:151], v0
v_mad_i32_i24 v6, v6, s55, v1
s_waitcnt lgkmcnt(0)
v_smfmac_f32_16x16x64_bf16 v[20:23], v[72:75], v[160:167], v0
v_smfmac_f32_16x16x64_bf16 v[20:23], v[76:79], v[44:51], v0
ds_read_b128 v[44:47], v2 offset:10240
v_smfmac_f32_16x16x64_bf16 v[24:27], v[60:63], v[120:127], v0
ds_read_b128 v[48:51], v2 offset:11264
v_smfmac_f32_16x16x64_bf16 v[24:27], v[64:67], v[136:143], v0
v_add_f32 v20, v20, v22
v_smfmac_f32_16x16x64_bf16 v[24:27], v[68:71], v[152:159], v0
v_add_f32 v21, v21, v23
v_smfmac_f32_16x16x64_bf16 v[24:27], v[72:75], v[168:175], v0
v_cvt_pk_bf16_f32 v22, v20, v21
s_waitcnt lgkmcnt(0)
v_smfmac_f32_16x16x64_bf16 v[24:27], v[76:79], v[44:51], v0
ds_read_b128 v[44:47], v2 offset:12288
v_smfmac_f32_16x16x64_bf16 v[28:31], v[76:79], v[240:247], v0
ds_read_b128 v[48:51], v2 offset:13312
v_smfmac_f32_16x16x64_bf16 v[28:31], v[64:67], a[0:7], v0
v_add_f32 v24, v24, v26
v_add_f32 v25, v25, v27
v_cvt_pk_bf16_f32 v23, v24, v25
v_smfmac_f32_16x16x64_bf16 v[28:31], v[68:71], a[16:23], v0
ds_write_b64 v3, v[22:23] offset:10240
v_smfmac_f32_16x16x64_bf16 v[28:31], v[72:75], a[32:39], v0
s_waitcnt lgkmcnt(1)
v_smfmac_f32_16x16x64_bf16 v[28:31], v[60:63], v[44:51], v0
ds_read_b128 v[44:47], v2 offset:14336
v_smfmac_f32_16x16x64_bf16 v[32:35], v[76:79], v[248:255], v0
ds_read_b128 v[48:51], v2 offset:15360
v_smfmac_f32_16x16x64_bf16 v[32:35], v[64:67], a[8:15], v0
v_add_f32 v28, v28, v30
s_waitcnt lgkmcnt(2)
s_barrier
v_smfmac_f32_16x16x64_bf16 v[32:35], v[68:71], a[24:31], v0
ds_read_b64_tr_b16 v[20:21], v4 offset:10240
ds_read_b64_tr_b16 v[22:23], v4 offset:10752
v_add_f32 v29, v29, v31
v_smfmac_f32_16x16x64_bf16 v[32:35], v[72:75], a[40:47], v0
ds_read_b64_tr_b16 v[24:25], v4 offset:11264
ds_read_b64_tr_b16 v[26:27], v4 offset:11776
v_cvt_pk_bf16_f32 v30, v28, v29
s_waitcnt lgkmcnt(4)
v_smfmac_f32_16x16x64_bf16 v[32:35], v[60:63], v[44:51], v0
ds_read_b128 v[44:47], v2 offset:18432
s_waitcnt vmcnt(3)
s_waitcnt lgkmcnt(3)
v_mfma_f32_16x16x32_bf16 v[12:15], v[12:15], v[20:23], 0
ds_read_b128 v[48:51], v2 offset:19456
s_waitcnt lgkmcnt(2)
v_mfma_f32_16x16x32_bf16 v[12:15], v[16:19], v[24:27], v[12:15]
v_add_f32 v32, v32, v34
v_add_f32 v33, v33, v35
v_cvt_pk_bf16_f32 v31, v32, v33
ds_write_b64 v3, v[30:31] offset:12288
v_smfmac_f32_16x16x64_bf16 v[36:39], v[76:79], a[112:119], v0
s_nop 2
v_add_f32_dpp v12, v14, v12 quad_perm:[2,3,0,1] row_mask:0xf bank_mask:0xf
v_add_f32_dpp v13, v15, v13 quad_perm:[2,3,0,1] row_mask:0xf bank_mask:0xf
v_exp_f32 v14, v12
v_exp_f32 v15, v13
v_smfmac_f32_16x16x64_bf16 v[40:43], v[76:79], a[120:127], v0
v_cvt_pk_bf16_f32 v14, v14, v15
ds_write_b32 v5, v14 offset:14368
s_waitcnt lgkmcnt(1)
s_barrier
ds_read_b64_tr_b16 v[28:29], v4 offset:12288
v_smfmac_f32_16x16x64_bf16 v[36:39], v[60:63], a[128:135], v0
ds_read_b64_tr_b16 v[30:31], v4 offset:12800
ds_read_b64_tr_b16 v[32:33], v4 offset:13312
v_smfmac_f32_16x16x64_bf16 v[40:43], v[60:63], a[136:143], v0
ds_read_b64_tr_b16 v[34:35], v4 offset:13824
v_mov_b64 v[76:77], s[52:53]
v_smfmac_f32_16x16x64_bf16 v[40:43], v[72:75], v[44:51], v0
ds_read_b128 v[44:47], v2 offset:16384
v_mov_b64 v[78:79], s[52:53]
s_waitcnt lgkmcnt(3)
v_mfma_f32_16x16x32_bf16 v[28:31], v[28:31], v[20:23], 0
s_barrier
ds_read_b128 v[16:19], v1 offset:14368
s_waitcnt lgkmcnt(2)
v_mfma_f32_16x16x32_bf16 v[28:31], v[32:35], v[24:27], v[28:31]
ds_read_b128 v[60:63], v1 offset:14336
v_smfmac_f32_16x16x64_bf16 v[40:43], v[64:67], a[152:159], v0
ds_read_b128 v[48:51], v2 offset:17408
v_mov_b64 v[14:15], s[0:1]
v_smfmac_f32_16x16x64_bf16 v[40:43], v[68:71], a[168:175], v0
v_add_f32_dpp v28, v30, v28 quad_perm:[2,3,0,1] row_mask:0xf bank_mask:0xf
v_smfmac_f32_16x16x64_bf16 v[36:39], v[64:67], a[144:151], v0
ds_read_b128 v[64:67], v2 offset:25600
v_add_f32_dpp v29, v31, v29 quad_perm:[2,3,0,1] row_mask:0xf bank_mask:0xf
v_smfmac_f32_16x16x64_bf16 v[36:39], v[68:71], a[160:167], v0
ds_read_b128 v[68:71], v2 offset:22528
v_mul_f32 v28, s50, v28
s_waitcnt lgkmcnt(2)
v_smfmac_f32_16x16x64_bf16 v[36:39], v[72:75], v[44:51], v0
ds_read_b128 v[72:75], v2 offset:23552
v_mul_f32 v29, s50, v29
s_waitcnt vmcnt(1)
v_mfma_f32_16x16x32_bf16 v[32:35], v[76:79], v[16:19], 0
v_exp_f32 v30, v28
v_mfma_f32_16x16x32_bf16 v[20:23], v[52:55], v[16:19], 0
v_exp_f32 v31, v29
v_mfma_f32_16x16x32_bf16 v[20:23], v[56:59], v[60:63], v[20:23]
v_cvt_pk_bf16_f32 v30, v30, v31
v_cndmask_b32_e64 v24, 0, v30, s[56:57]
v_cndmask_b32_e64 v25, 0, v30, s[56:57]
v_cvt_pk_bf16_f32 v36, v36, v37
v_cvt_pk_bf16_f32 v37, v38, v39
v_mfma_f32_16x16x16_bf16 v[32:35], v[14:15], v[24:25], v[32:35]
v_cvt_pk_bf16_f32 v38, v40, v41
v_cvt_pk_bf16_f32 v39, v42, v43
v_mov_b32_dpp v26, v24 quad_perm:[2,3,0,1] row_mask:0xf bank_mask:0xf
v_mov_b32_dpp v27, v24 quad_perm:[2,3,0,1] row_mask:0xf bank_mask:0xf
ds_read_b128 v[44:47], v2 offset:20480
s_nop 0
v_mfma_f32_16x16x32_bf16 v[20:23], v[36:39], v[24:27], v[20:23]
ds_read_b128 v[48:51], v2 offset:21504
v_rcp_f32 v33, v32
ds_read_b128 v[60:63], v2 offset:24576
v_min_f32 v32, v32, v33
v_cmp_nlt_f32 vcc, s2, v32
v_mov_b64 v[76:77], 0
v_mov_b64 v[78:79], 0
v_mov_b64 v[40:41], 0
v_mul_f32_dpp v20, v33, v20 quad_perm:[0,1,0,1] row_mask:0xf bank_mask:0xf
v_mul_f32_dpp v21, v33, v21 quad_perm:[0,1,0,1] row_mask:0xf bank_mask:0xf
v_mul_f32_dpp v22, v33, v22 quad_perm:[0,1,0,1] row_mask:0xf bank_mask:0xf
v_mul_f32_dpp v23, v33, v23 quad_perm:[0,1,0,1] row_mask:0xf bank_mask:0xf
v_cvt_pk_bf16_f32 v20, v20, v21
v_cvt_pk_bf16_f32 v21, v22, v23
ds_write_b64 v6, v[20:21] offset:5120
v_mov_b64 v[42:43], 0
ds_read_b128 v[16:19], v7 offset:5120
s_and_b64 vcc, vcc, s[56:57]
v_mov_b64 v[24:25], 0
v_mov_b64 v[26:27], 0
s_cbranch_scc1 L_mx_w0s
L_mxb_w0s:
v_mov_b64 v[32:33], 0
v_mov_b64 v[34:35], 0
v_mov_b64 v[28:29], 0
v_mov_b64 v[30:31], 0
s_waitcnt lgkmcnt(1)
s_barrier
ds_read_b128 v[12:15], v7 offset:6144
s_waitcnt lgkmcnt(1)
v_smfmac_f32_16x16x64_bf16 v[76:79], v[16:19], v[44:51], v0 abid:1
ds_read_b128 v[52:55], v7 offset:7168
ds_read_b128 v[56:59], v7 offset:8192
v_smfmac_f32_16x16x64_bf16 v[40:43], v[16:19], v[60:67], v0 abid:1
ds_read_b128 v[44:47], v2 offset:26624
s_waitcnt lgkmcnt(3)
v_smfmac_f32_16x16x64_bf16 v[76:79], v[12:15], a[176:183], v0 abid:1
ds_read_b128 v[48:51], v2 offset:27648
v_smfmac_f32_16x16x64_bf16 v[40:43], v[12:15], a[184:191], v0 abid:1
ds_read_b128 v[60:63], v2 offset:28672
s_waitcnt lgkmcnt(4)
v_smfmac_f32_16x16x64_bf16 v[76:79], v[52:55], v[68:75], v0 abid:1
ds_read_b128 v[64:67], v2 offset:29696
s_waitcnt lgkmcnt(2)
v_smfmac_f32_16x16x64_bf16 v[40:43], v[52:55], v[44:51], v0 abid:1
ds_read_b128 v[68:71], v2 offset:30720
v_smfmac_f32_16x16x64_bf16 v[76:79], v[56:59], a[192:199], v0 abid:1
ds_read_b128 v[72:75], v2 offset:31744
v_smfmac_f32_16x16x64_bf16 v[40:43], v[56:59], a[200:207], v0 abid:1
ds_read_b128 v[44:47], v2 offset:32768
s_waitcnt lgkmcnt(3)
v_smfmac_f32_16x16x64_bf16 v[24:27], v[16:19], v[60:67], v0 abid:1
ds_read_b128 v[48:51], v2 offset:33792
v_cvt_pk_bf16_f32 v76, v76, v77
v_cvt_pk_bf16_f32 v77, v78, v79
v_bfi_b32 v76, 1, s35, v76
buffer_store_dwordx2 v[76:77], v8, s[4:7], s42 offen sc0 sc1
v_smfmac_f32_16x16x64_bf16 v[24:27], v[12:15], a[208:215], v0 abid:1
ds_read_b128 v[60:63], v2 offset:36864
v_cvt_pk_bf16_f32 v40, v40, v41
v_cvt_pk_bf16_f32 v41, v42, v43
v_bfi_b32 v40, 1, s35, v40
buffer_store_dwordx2 v[40:41], v8, s[4:7], s43 offen sc0 sc1
s_waitcnt lgkmcnt(3)
v_smfmac_f32_16x16x64_bf16 v[24:27], v[52:55], v[68:75], v0 abid:1
ds_read_b128 v[64:67], v2 offset:37888
v_smfmac_f32_16x16x64_bf16 v[24:27], v[56:59], a[216:223], v0 abid:1
ds_read_b128 v[68:71], v2 offset:34816
v_smfmac_f32_16x16x64_bf16 v[32:35], v[16:19], a[224:231], v0 abid:1
ds_read_b128 v[72:75], v2 offset:35840
v_smfmac_f32_16x16x64_bf16 v[32:35], v[12:15], a[232:239], v0 abid:1
v_cvt_pk_bf16_f32 v24, v24, v25
v_cvt_pk_bf16_f32 v25, v26, v27
v_bfi_b32 v24, 1, s35, v24
buffer_store_dwordx2 v[24:25], v8, s[4:7], s44 offen sc0 sc1
v_smfmac_f32_16x16x64_bf16 v[32:35], v[52:55], a[240:247], v0 abid:1
v_smfmac_f32_16x16x64_bf16 v[32:35], v[56:59], a[248:255], v0 abid:1
s_waitcnt lgkmcnt(4)
v_smfmac_f32_16x16x64_bf16 v[28:31], v[16:19], v[44:51], v0 abid:1
ds_read_b128 v[44:47], v2 offset:38912
s_waitcnt lgkmcnt(3)
v_smfmac_f32_16x16x64_bf16 v[28:31], v[12:15], v[60:67], v0 abid:1
ds_read_b128 v[48:51], v2 offset:39936
v_cvt_pk_bf16_f32 v32, v32, v33
v_cvt_pk_bf16_f32 v33, v34, v35
v_bfi_b32 v32, 1, s35, v32
buffer_store_dwordx2 v[32:33], v8, s[4:7], s45 offen sc0 sc1
s_waitcnt lgkmcnt(2)
v_smfmac_f32_16x16x64_bf16 v[28:31], v[52:55], v[68:75], v0 abid:1
s_waitcnt lgkmcnt(0)
v_smfmac_f32_16x16x64_bf16 v[28:31], v[56:59], v[44:51], v0 abid:1
s_nop 7
v_cvt_pk_bf16_f32 v28, v28, v29
v_cvt_pk_bf16_f32 v29, v30, v31
v_bfi_b32 v28, 1, s35, v28
buffer_store_dwordx2 v[28:29], v8, s[4:7], s46 offen sc0 sc1
s_branch L_ex_w0s
.p2align 6
L_ex_w1s:
s_add_u32 s34, s34, 1
s_add_u32 s37, s37, 524288
s_add_u32 s39, s39, 524288
s_mul_i32 s40, s34, 10240
s_add_u32 s40, s40, 8093696
s_not_b32 s35, s35
s_not_b32 s36, s36
v_mov_b64 v[20:21], 0
v_mov_b64 v[22:23], 0
v_mov_b64 v[24:25], 0
v_mov_b64 v[26:27], 0
v_mov_b64 v[28:29], 0
v_mov_b64 v[30:31], 0
v_mov_b64 v[32:33], 0
v_mov_b64 v[34:35], 0
v_mov_b64 v[36:37], 0
v_mov_b64 v[38:39], 0
v_mov_b64 v[40:41], 0
v_mov_b64 v[42:43], 0
s_cmp_eq_u32 s34, 63
s_cbranch_scc1 L_done_w1s
ds_read_b128 v[44:47], v2 offset:0
ds_read_b128 v[48:51], v2 offset:1024
v_bfe_u32 v77, v1, 6, 1
v_lshl_add_u32 v77, v77, 3, v1
v_lshlrev_b32 v77, 1, v77
s_barrier
L_top_w1s:
s_barrier
ds_read_b128 v[60:63], v1 offset:1024
ds_read_b128 v[64:67], v1 offset:2048
s_mov_b32 m0, 5120
s_nop 0
buffer_load_dwordx4 v1, s[4:7], s48 offen offset:1024 sc0 sc1 lds
s_barrier
ds_read_b128 v[68:71], v1 offset:3072
ds_read_b128 v[72:75], v1 offset:4096
L_s0_w1s:
s_waitcnt lgkmcnt(3)
v_smfmac_f32_16x16x64_bf16 v[28:31], v[60:63], v[176:183], v0
v_smfmac_f32_16x16x64_bf16 v[32:35], v[60:63], v[184:191], v0
s_mov_b32 m0, 9216
s_nop 0
buffer_load_dwordx4 v1, s[4:7], s49 offen offset:0 sc0 sc1 lds
v_smfmac_f32_16x16x64_bf16 v[36:39], v[60:63], a[48:55], v0
v_smfmac_f32_16x16x64_bf16 v[40:43], v[60:63], a[56:63], v0
s_waitcnt lgkmcnt(2)
v_smfmac_f32_16x16x64_bf16 v[20:23], v[64:67], v[80:87], v0
v_smfmac_f32_16x16x64_bf16 v[20:23], v[60:63], v[44:51], v0
ds_read_b128 v[44:47], v2 offset:2048
buffer_load_dwordx4 v[12:15], v9, s[4:7], s37 offen offset:0
v_smfmac_f32_16x16x64_bf16 v[24:27], v[64:67], v[88:95], v0
ds_read_b128 v[48:51], v2 offset:3072
v_smfmac_f32_16x16x64_bf16 v[28:31], v[64:67], v[192:199], v0
s_waitcnt lgkmcnt(2)
v_bitop3_b32 v6, v60, v64, s35 bitop3:0x7e
v_smfmac_f32_16x16x64_bf16 v[32:35], v[64:67], v[200:207], v0
v_bitop3_b32 v76, v68, v72, s35 bitop3:0x7e
v_smfmac_f32_16x16x64_bf16 v[36:39], v[64:67], a[64:71], v0
v_bitop3_b32 v6, v6, v76, 1 bitop3:0xa8
s_waitcnt lgkmcnt(0)
buffer_load_dwordx4 v[16:19], v9, s[4:7], s37 offen offset:1024
v_smfmac_f32_16x16x64_bf16 v[24:27], v[60:63], v[44:51], v0
ds_read_b128 v[44:47], v2 offset:4096
v_cmp_ne_u32 vcc, 0, v6
v_smfmac_f32_16x16x64_bf16 v[40:43], v[64:67], a[72:79], v0
ds_read_b128 v[48:51], v2 offset:5120
v_smfmac_f32_16x16x64_bf16 v[20:23], v[68:71], v[96:103], v0
s_cbranch_vccnz L_ra0_w1s
v_smfmac_f32_16x16x64_bf16 v[24:27], v[68:71], v[104:111], v0
s_waitcnt vmcnt(2)
s_barrier
ds_read_b32 v6, v77 offset:8192
buffer_load_dwordx4 v[52:55], v1, s[4:7], s37 offen offset:2048
v_smfmac_f32_16x16x64_bf16 v[28:31], v[68:71], v[208:215], v0
ds_read_b128 v[60:63], v1 offset:6144
s_waitcnt lgkmcnt(2)
v_smfmac_f32_16x16x64_bf16 v[20:23], v[72:75], v[44:51], v0
ds_read_b128 v[64:67], v1 offset:7168
v_smfmac_f32_16x16x64_bf16 v[32:35], v[68:71], v[216:223], v0
ds_read_b128 v[44:47], v2 offset:6144
ds_read_b128 v[76:79], v1 offset:5120
v_smfmac_f32_16x16x64_bf16 v[36:39], v[68:71], a[80:87], v0
ds_read_b128 v[48:51], v2 offset:7168
buffer_load_dwordx4 v[56:59], v1, s[4:7], s37 offen offset:3072
v_smfmac_f32_16x16x64_bf16 v[40:43], v[68:71], a[88:95], v0
ds_read_b128 v[68:71], v1 offset:8192
s_waitcnt lgkmcnt(5)
v_bitop3_b32 v6, v6, v60, s35 bitop3:0x7e
v_smfmac_f32_16x16x64_bf16 v[28:31], v[72:75], v[224:231], v0
s_waitcnt lgkmcnt(4)
v_bitop3_b32 v6, v6, v64, s35 bitop3:0xf6
v_smfmac_f32_16x16x64_bf16 v[32:35], v[72:75], v[232:239], v0
s_mov_b32 m0, 0
s_waitcnt lgkmcnt(2)
v_bitop3_b32 v6, v6, v76, s35 bitop3:0xf6
v_and_b32 v6, 1, v6
s_waitcnt lgkmcnt(1)
v_smfmac_f32_16x16x64_bf16 v[24:27], v[72:75], v[44:51], v0
ds_read_b128 v[44:47], v2 offset:8192
v_cmp_ne_u32 vcc, 0, v6
v_smfmac_f32_16x16x64_bf16 v[36:39], v[72:75], a[96:103], v0
ds_read_b128 v[48:51], v2 offset:9216
v_lshlrev_b32 v6, 3, v1
v_smfmac_f32_16x16x64_bf16 v[40:43], v[72:75], a[104:111], v0
ds_read_b128 v[72:75], v1 offset:9216
s_cbranch_vccnz L_ra1_w1s
L_a1_w1s:
buffer_load_dword v6, s[4:7], s39 offen lds
v_smfmac_f32_16x16x64_bf16 v[20:23], v[60:63], v[112:119], v0
v_smfmac_f32_16x16x64_bf16 v[20:23], v[64:67], v[128:135], v0
v_bfe_u32 v6, v1, 5, 1
s_waitcnt lgkmcnt(3)
v_smfmac_f32_16x16x64_bf16 v[20:23], v[68:71], v[144:151], v0
v_mad_i32_i24 v6, v6, s55, v1
s_waitcnt lgkmcnt(0)
v_smfmac_f32_16x16x64_bf16 v[20:23], v[72:75], v[160:167], v0
v_smfmac_f32_16x16x64_bf16 v[20:23], v[76:79], v[44:51], v0
ds_read_b128 v[44:47], v2 offset:10240
v_smfmac_f32_16x16x64_bf16 v[24:27], v[60:63], v[120:127], v0
ds_read_b128 v[48:51], v2 offset:11264
v_smfmac_f32_16x16x64_bf16 v[24:27], v[64:67], v[136:143], v0
v_add_f32 v20, v20, v22
v_smfmac_f32_16x16x64_bf16 v[24:27], v[68:71], v[152:159], v0
v_add_f32 v21, v21, v23
v_smfmac_f32_16x16x64_bf16 v[24:27], v[72:75], v[168:175], v0
v_cvt_pk_bf16_f32 v22, v20, v21
s_waitcnt lgkmcnt(0)
v_smfmac_f32_16x16x64_bf16 v[24:27], v[76:79], v[44:51], v0
ds_read_b128 v[44:47], v2 offset:12288
v_smfmac_f32_16x16x64_bf16 v[28:31], v[76:79], v[240:247], v0
ds_read_b128 v[48:51], v2 offset:13312
v_smfmac_f32_16x16x64_bf16 v[28:31], v[64:67], a[0:7], v0
v_add_f32 v24, v24, v26
v_add_f32 v25, v25, v27
v_cvt_pk_bf16_f32 v23, v24, v25
v_smfmac_f32_16x16x64_bf16 v[28:31], v[68:71], a[16:23], v0
ds_write_b64 v3, v[22:23] offset:10752
v_smfmac_f32_16x16x64_bf16 v[28:31], v[72:75], a[32:39], v0
s_waitcnt lgkmcnt(1)
v_smfmac_f32_16x16x64_bf16 v[28:31], v[60:63], v[44:51], v0
ds_read_b128 v[44:47], v2 offset:14336
v_smfmac_f32_16x16x64_bf16 v[32:35], v[76:79], v[248:255], v0
ds_read_b128 v[48:51], v2 offset:15360
v_smfmac_f32_16x16x64_bf16 v[32:35], v[64:67], a[8:15], v0
v_add_f32 v28, v28, v30
s_waitcnt lgkmcnt(2)
s_barrier
v_smfmac_f32_16x16x64_bf16 v[32:35], v[68:71], a[24:31], v0
ds_read_b64_tr_b16 v[20:21], v4 offset:10240
ds_read_b64_tr_b16 v[22:23], v4 offset:10752
v_add_f32 v29, v29, v31
v_smfmac_f32_16x16x64_bf16 v[32:35], v[72:75], a[40:47], v0
ds_read_b64_tr_b16 v[24:25], v4 offset:11264
ds_read_b64_tr_b16 v[26:27], v4 offset:11776
v_cvt_pk_bf16_f32 v30, v28, v29
s_waitcnt lgkmcnt(4)
v_smfmac_f32_16x16x64_bf16 v[32:35], v[60:63], v[44:51], v0
ds_read_b128 v[44:47], v2 offset:18432
s_waitcnt vmcnt(3)
s_waitcnt lgkmcnt(3)
v_mfma_f32_16x16x32_bf16 v[12:15], v[12:15], v[20:23], 0
ds_read_b128 v[48:51], v2 offset:19456
s_waitcnt lgkmcnt(2)
v_mfma_f32_16x16x32_bf16 v[12:15], v[16:19], v[24:27], v[12:15]
v_add_f32 v32, v32, v34
v_add_f32 v33, v33, v35
v_cvt_pk_bf16_f32 v31, v32, v33
ds_write_b64 v3, v[30:31] offset:12800
v_smfmac_f32_16x16x64_bf16 v[36:39], v[76:79], a[112:119], v0
s_nop 2
v_add_f32_dpp v12, v14, v12 quad_perm:[2,3,0,1] row_mask:0xf bank_mask:0xf
v_add_f32_dpp v13, v15, v13 quad_perm:[2,3,0,1] row_mask:0xf bank_mask:0xf
v_exp_f32 v14, v12
v_exp_f32 v15, v13
v_smfmac_f32_16x16x64_bf16 v[40:43], v[76:79], a[120:127], v0
v_cvt_pk_bf16_f32 v14, v14, v15
ds_write_b32 v5, v14 offset:14624
s_waitcnt lgkmcnt(1)
s_barrier
ds_read_b64_tr_b16 v[28:29], v4 offset:12288
v_smfmac_f32_16x16x64_bf16 v[36:39], v[60:63], a[128:135], v0
ds_read_b64_tr_b16 v[30:31], v4 offset:12800
ds_read_b64_tr_b16 v[32:33], v4 offset:13312
v_smfmac_f32_16x16x64_bf16 v[40:43], v[60:63], a[136:143], v0
ds_read_b64_tr_b16 v[34:35], v4 offset:13824
v_mov_b64 v[76:77], s[52:53]
v_smfmac_f32_16x16x64_bf16 v[40:43], v[72:75], v[44:51], v0
ds_read_b128 v[44:47], v2 offset:16384
v_mov_b64 v[78:79], s[52:53]
s_waitcnt lgkmcnt(3)
v_mfma_f32_16x16x32_bf16 v[28:31], v[28:31], v[20:23], 0
s_barrier
ds_read_b128 v[16:19], v1 offset:14368
s_waitcnt lgkmcnt(2)
v_mfma_f32_16x16x32_bf16 v[28:31], v[32:35], v[24:27], v[28:31]
ds_read_b128 v[60:63], v1 offset:14336
v_smfmac_f32_16x16x64_bf16 v[40:43], v[64:67], a[152:159], v0
ds_read_b128 v[48:51], v2 offset:17408
v_mov_b64 v[14:15], s[0:1]
v_smfmac_f32_16x16x64_bf16 v[40:43], v[68:71], a[168:175], v0
v_add_f32_dpp v28, v30, v28 quad_perm:[2,3,0,1] row_mask:0xf bank_mask:0xf
v_smfmac_f32_16x16x64_bf16 v[36:39], v[64:67], a[144:151], v0
ds_read_b128 v[64:67], v2 offset:27648
v_add_f32_dpp v29, v31, v29 quad_perm:[2,3,0,1] row_mask:0xf bank_mask:0xf
v_smfmac_f32_16x16x64_bf16 v[36:39], v[68:71], a[160:167], v0
ds_read_b128 v[68:71], v2 offset:20480
v_mul_f32 v28, s50, v28
s_waitcnt lgkmcnt(2)
v_smfmac_f32_16x16x64_bf16 v[36:39], v[72:75], v[44:51], v0
ds_read_b128 v[72:75], v2 offset:21504
v_mul_f32 v29, s50, v29
s_waitcnt vmcnt(1)
v_mfma_f32_16x16x32_bf16 v[32:35], v[76:79], v[16:19], 0
v_exp_f32 v30, v28
v_mfma_f32_16x16x32_bf16 v[20:23], v[52:55], v[16:19], 0
v_exp_f32 v31, v29
v_mfma_f32_16x16x32_bf16 v[20:23], v[56:59], v[60:63], v[20:23]
v_cvt_pk_bf16_f32 v30, v30, v31
v_cndmask_b32_e64 v24, 0, v30, s[56:57]
v_cndmask_b32_e64 v25, 0, v30, s[56:57]
v_cvt_pk_bf16_f32 v36, v36, v37
v_cvt_pk_bf16_f32 v37, v38, v39
v_mfma_f32_16x16x16_bf16 v[32:35], v[14:15], v[24:25], v[32:35]
v_cvt_pk_bf16_f32 v38, v40, v41
v_cvt_pk_bf16_f32 v39, v42, v43
v_mov_b32_dpp v26, v24 quad_perm:[2,3,0,1] row_mask:0xf bank_mask:0xf
v_mov_b32_dpp v27, v24 quad_perm:[2,3,0,1] row_mask:0xf bank_mask:0xf
ds_read_b128 v[44:47], v2 offset:22528
s_nop 0
v_mfma_f32_16x16x32_bf16 v[20:23], v[36:39], v[24:27], v[20:23]
ds_read_b128 v[48:51], v2 offset:23552
v_rcp_f32 v33, v32
ds_read_b128 v[60:63], v2 offset:26624
v_min_f32 v32, v32, v33
v_cmp_nlt_f32 vcc, s2, v32
v_mov_b64 v[76:77], 0
v_mov_b64 v[78:79], 0
v_mov_b64 v[40:41], 0
v_mul_f32_dpp v20, v33, v20 quad_perm:[0,1,0,1] row_mask:0xf bank_mask:0xf
v_mul_f32_dpp v21, v33, v21 quad_perm:[0,1,0,1] row_mask:0xf bank_mask:0xf
v_mul_f32_dpp v22, v33, v22 quad_perm:[0,1,0,1] row_mask:0xf bank_mask:0xf
v_mul_f32_dpp v23, v33, v23 quad_perm:[0,1,0,1] row_mask:0xf bank_mask:0xf
v_cvt_pk_bf16_f32 v20, v20, v21
v_cvt_pk_bf16_f32 v21, v22, v23
ds_write_b64 v6, v[20:21] offset:6144
v_mov_b64 v[42:43], 0
ds_read_b128 v[16:19], v7 offset:6144
s_and_b64 vcc, vcc, s[56:57]
v_mov_b64 v[24:25], 0
v_mov_b64 v[26:27], 0
s_cbranch_scc1 L_mx_w1s
L_mxb_w1s:
v_mov_b64 v[32:33], 0
v_mov_b64 v[34:35], 0
v_mov_b64 v[28:29], 0
v_mov_b64 v[30:31], 0
s_waitcnt lgkmcnt(1)
s_barrier
ds_read_b128 v[12:15], v7 offset:7168
s_waitcnt lgkmcnt(1)
v_smfmac_f32_16x16x64_bf16 v[76:79], v[16:19], a[176:183], v0 abid:1
ds_read_b128 v[52:55], v7 offset:8192
ds_read_b128 v[56:59], v7 offset:5120
v_smfmac_f32_16x16x64_bf16 v[40:43], v[16:19], a[184:191], v0 abid:1
s_waitcnt lgkmcnt(2)
v_smfmac_f32_16x16x64_bf16 v[76:79], v[12:15], v[44:51], v0 abid:1
ds_read_b128 v[44:47], v2 offset:24576
v_smfmac_f32_16x16x64_bf16 v[40:43], v[12:15], v[60:67], v0 abid:1
ds_read_b128 v[48:51], v2 offset:25600
s_waitcnt lgkmcnt(3)
v_smfmac_f32_16x16x64_bf16 v[76:79], v[52:55], a[192:199], v0 abid:1
ds_read_b128 v[60:63], v2 offset:30720
v_smfmac_f32_16x16x64_bf16 v[40:43], v[52:55], a[200:207], v0 abid:1
ds_read_b128 v[64:67], v2 offset:31744
s_waitcnt lgkmcnt(4)
v_smfmac_f32_16x16x64_bf16 v[76:79], v[56:59], v[68:75], v0 abid:1
ds_read_b128 v[68:71], v2 offset:28672
s_waitcnt lgkmcnt(3)
v_smfmac_f32_16x16x64_bf16 v[40:43], v[56:59], v[44:51], v0 abid:1
ds_read_b128 v[72:75], v2 offset:29696
v_smfmac_f32_16x16x64_bf16 v[24:27], v[16:19], a[208:215], v0 abid:1
ds_read_b128 v[44:47], v2 offset:36864
v_cvt_pk_bf16_f32 v76, v76, v77
v_cvt_pk_bf16_f32 v77, v78, v79
v_bfi_b32 v76, 1, s35, v76
buffer_store_dwordx2 v[76:77], v8, s[4:7], s42 offen sc0 sc1
s_waitcnt lgkmcnt(3)
v_smfmac_f32_16x16x64_bf16 v[24:27], v[12:15], v[60:67], v0 abid:1
ds_read_b128 v[48:51], v2 offset:37888
v_cvt_pk_bf16_f32 v40, v40, v41
v_cvt_pk_bf16_f32 v41, v42, v43
v_bfi_b32 v40, 1, s35, v40
buffer_store_dwordx2 v[40:41], v8, s[4:7], s43 offen sc0 sc1
v_smfmac_f32_16x16x64_bf16 v[24:27], v[52:55], a[216:223], v0 abid:1
ds_read_b128 v[60:63], v2 offset:34816
s_waitcnt lgkmcnt(3)
v_smfmac_f32_16x16x64_bf16 v[24:27], v[56:59], v[68:75], v0 abid:1
ds_read_b128 v[64:67], v2 offset:35840
v_smfmac_f32_16x16x64_bf16 v[32:35], v[16:19], a[224:231], v0 abid:1
ds_read_b128 v[68:71], v2 offset:38912
v_smfmac_f32_16x16x64_bf16 v[32:35], v[12:15], a[232:239], v0 abid:1
ds_read_b128 v[72:75], v2 offset:39936
v_cvt_pk_bf16_f32 v24, v24, v25
v_cvt_pk_bf16_f32 v25, v26, v27
v_bfi_b32 v24, 1, s35, v24
buffer_store_dwordx2 v[24:25], v8, s[4:7], s44 offen sc0 sc1
v_smfmac_f32_16x16x64_bf16 v[32:35], v[52:55], a[240:247], v0 abid:1
v_smfmac_f32_16x16x64_bf16 v[32:35], v[56:59], a[248:255], v0 abid:1
s_waitcnt lgkmcnt(4)
v_smfmac_f32_16x16x64_bf16 v[28:31], v[16:19], v[44:51], v0 abid:1
ds_read_b128 v[44:47], v2 offset:32768
s_waitcnt lgkmcnt(3)
v_smfmac_f32_16x16x64_bf16 v[28:31], v[12:15], v[60:67], v0 abid:1
ds_read_b128 v[48:51], v2 offset:33792
v_cvt_pk_bf16_f32 v32, v32, v33
v_cvt_pk_bf16_f32 v33, v34, v35
v_bfi_b32 v32, 1, s35, v32
buffer_store_dwordx2 v[32:33], v8, s[4:7], s45 offen sc0 sc1
s_waitcnt lgkmcnt(2)
v_smfmac_f32_16x16x64_bf16 v[28:31], v[52:55], v[68:75], v0 abid:1
s_waitcnt lgkmcnt(0)
v_smfmac_f32_16x16x64_bf16 v[28:31], v[56:59], v[44:51], v0 abid:1
s_nop 7
v_cvt_pk_bf16_f32 v28, v28, v29
v_cvt_pk_bf16_f32 v29, v30, v31
v_bfi_b32 v28, 1, s35, v28
buffer_store_dwordx2 v[28:29], v8, s[4:7], s46 offen sc0 sc1
s_branch L_ex_w1s
.p2align 6
L_ex_w1rs:
v_and_b32 v6, 0x70, v1
ds_read_b128 v[76:79], v6 offset:256
v_bfe_u32 v11, v1, 4, 2
v_lshrrev_b32_e64 v11, v11, 1
s_add_u32 s34, s34, 1
s_add_u32 s37, s37, 524288
s_add_u32 s39, s39, 524288
s_mul_i32 s40, s34, 10240
s_add_u32 s40, s40, 8093696
s_not_b32 s35, s35
s_not_b32 s36, s36
ds_read_b128 v[44:47], v2 offset:0
ds_read_b128 v[48:51], v2 offset:1024
s_barrier
s_waitcnt vmcnt(0)
v_mov_b64 v[20:21], 0
v_mov_b64 v[22:23], 0
v_mov_b64 v[24:25], 0
v_mov_b64 v[26:27], 0
v_mov_b64 v[28:29], 0
v_mov_b64 v[30:31], 0
v_mov_b64 v[32:33], 0
v_mov_b64 v[34:35], 0
buffer_load_dwordx4 v[60:63], v9, s[4:7], s3 offen offset:0 sc0 sc1
buffer_load_dwordx4 v[64:67], v9, s[4:7], s3 offen offset:1024 sc0 sc1
buffer_load_dwordx4 v[68:71], v9, s[4:7], s3 offen offset:2048 sc0 sc1
buffer_load_dwordx4 v[72:75], v9, s[4:7], s3 offen offset:3072 sc0 sc1
s_waitcnt lgkmcnt(2)
s_waitcnt vmcnt(3)
L_r_w1rs:
v_mfma_f32_16x16x32_bf16 v[36:39], v[60:63], v[76:79], 0
s_waitcnt vmcnt(2)
v_mfma_f32_16x16x32_bf16 v[36:39], v[64:67], v[76:79], v[36:39]
v_bitop3_b32 v40, v60, v64, s36 bitop3:0x7e
s_waitcnt vmcnt(1)
v_mfma_f32_16x16x32_bf16 v[36:39], v[68:71], v[76:79], v[36:39]
s_waitcnt vmcnt(0)
v_mfma_f32_16x16x32_bf16 v[36:39], v[72:75], v[76:79], v[36:39]
v_bitop3_b32 v41, v68, v72, s36 bitop3:0x7e
v_bitop3_b32 v40, v40, v41, 1 bitop3:0xa8
v_cmp_ne_u32 vcc, 0, v40
v_nop
v_nop
v_nop
v_nop
v_nop
v_pk_add_f32 v[36:37], v[36:37], v[38:39]
v_cvt_pk_bf16_f32 v40, v36, v37
v_bfi_b32 v40, v11, s35, v40
s_cbranch_vccnz L_rr_w1rs
buffer_store_dword v40, v10, s[4:7], 0 offen sc0 sc1
s_cmp_eq_u32 s34, 63
v_mov_b32 v11, v40
s_cbranch_scc1 L_done_w1rs
v_mov_b64 v[36:37], 0
v_mov_b64 v[38:39], 0
v_mov_b64 v[40:41], 0
v_mov_b64 v[42:43], 0
v_bfe_u32 v77, v1, 6, 1
v_lshl_add_u32 v77, v77, 3, v1
v_lshlrev_b32 v77, 1, v77
L_top_w1rs:
s_barrier
ds_read_b128 v[60:63], v1 offset:1024
ds_read_b128 v[64:67], v1 offset:2048
s_mov_b32 m0, 5120
s_nop 0
buffer_load_dwordx4 v1, s[4:7], s48 offen offset:1024 sc0 sc1 lds
s_barrier
ds_read_b128 v[68:71], v1 offset:3072
ds_read_b128 v[72:75], v1 offset:4096
L_s0_w1rs:
s_waitcnt lgkmcnt(3)
v_smfmac_f32_16x16x64_bf16 v[28:31], v[60:63], v[176:183], v0
v_smfmac_f32_16x16x64_bf16 v[32:35], v[60:63], v[184:191], v0
s_mov_b32 m0, 9216
s_nop 0
buffer_load_dwordx4 v1, s[4:7], s49 offen offset:0 sc0 sc1 lds
v_smfmac_f32_16x16x64_bf16 v[36:39], v[60:63], a[48:55], v0
v_smfmac_f32_16x16x64_bf16 v[40:43], v[60:63], a[56:63], v0
s_waitcnt lgkmcnt(2)
v_smfmac_f32_16x16x64_bf16 v[20:23], v[64:67], v[80:87], v0
v_smfmac_f32_16x16x64_bf16 v[20:23], v[60:63], v[44:51], v0
ds_read_b128 v[44:47], v2 offset:2048
buffer_load_dwordx4 v[12:15], v9, s[4:7], s37 offen offset:0
v_smfmac_f32_16x16x64_bf16 v[24:27], v[64:67], v[88:95], v0
ds_read_b128 v[48:51], v2 offset:3072
v_smfmac_f32_16x16x64_bf16 v[28:31], v[64:67], v[192:199], v0
s_waitcnt lgkmcnt(2)
v_bitop3_b32 v6, v60, v64, s35 bitop3:0x7e
v_smfmac_f32_16x16x64_bf16 v[32:35], v[64:67], v[200:207], v0
v_bitop3_b32 v76, v68, v72, s35 bitop3:0x7e
v_smfmac_f32_16x16x64_bf16 v[36:39], v[64:67], a[64:71], v0
v_bitop3_b32 v6, v6, v76, 1 bitop3:0xa8
s_waitcnt lgkmcnt(0)
buffer_load_dwordx4 v[16:19], v9, s[4:7], s37 offen offset:1024
v_smfmac_f32_16x16x64_bf16 v[24:27], v[60:63], v[44:51], v0
ds_read_b128 v[44:47], v2 offset:4096
v_cmp_ne_u32 vcc, 0, v6
v_smfmac_f32_16x16x64_bf16 v[40:43], v[64:67], a[72:79], v0
ds_read_b128 v[48:51], v2 offset:5120
v_smfmac_f32_16x16x64_bf16 v[20:23], v[68:71], v[96:103], v0
s_cbranch_vccnz L_ra0_w1rs
v_smfmac_f32_16x16x64_bf16 v[24:27], v[68:71], v[104:111], v0
s_waitcnt vmcnt(2)
s_barrier
ds_read_b32 v6, v77 offset:8192
buffer_load_dwordx4 v[52:55], v1, s[4:7], s37 offen offset:2048
v_smfmac_f32_16x16x64_bf16 v[28:31], v[68:71], v[208:215], v0
ds_read_b128 v[60:63], v1 offset:6144
s_waitcnt lgkmcnt(2)
v_smfmac_f32_16x16x64_bf16 v[20:23], v[72:75], v[44:51], v0
ds_read_b128 v[64:67], v1 offset:7168
v_smfmac_f32_16x16x64_bf16 v[32:35], v[68:71], v[216:223], v0
ds_read_b128 v[44:47], v2 offset:6144
ds_read_b128 v[76:79], v1 offset:5120
v_smfmac_f32_16x16x64_bf16 v[36:39], v[68:71], a[80:87], v0
ds_read_b128 v[48:51], v2 offset:7168
buffer_load_dwordx4 v[56:59], v1, s[4:7], s37 offen offset:3072
v_smfmac_f32_16x16x64_bf16 v[40:43], v[68:71], a[88:95], v0
ds_read_b128 v[68:71], v1 offset:8192
s_waitcnt lgkmcnt(5)
v_bitop3_b32 v6, v6, v60, s35 bitop3:0x7e
v_smfmac_f32_16x16x64_bf16 v[28:31], v[72:75], v[224:231], v0
s_waitcnt lgkmcnt(4)
v_bitop3_b32 v6, v6, v64, s35 bitop3:0xf6
v_smfmac_f32_16x16x64_bf16 v[32:35], v[72:75], v[232:239], v0
s_mov_b32 m0, 0
s_waitcnt lgkmcnt(2)
v_bitop3_b32 v6, v6, v76, s35 bitop3:0xf6
v_and_b32 v6, 1, v6
s_waitcnt lgkmcnt(1)
v_smfmac_f32_16x16x64_bf16 v[24:27], v[72:75], v[44:51], v0
ds_read_b128 v[44:47], v2 offset:8192
v_cmp_ne_u32 vcc, 0, v6
v_smfmac_f32_16x16x64_bf16 v[36:39], v[72:75], a[96:103], v0
ds_read_b128 v[48:51], v2 offset:9216
v_lshlrev_b32 v6, 3, v1
v_smfmac_f32_16x16x64_bf16 v[40:43], v[72:75], a[104:111], v0
ds_read_b128 v[72:75], v1 offset:9216
s_cbranch_vccnz L_ra1_w1rs
L_a1_w1rs:
buffer_store_dword v11, v10, s[4:7], s40 offen sc0 sc1
buffer_load_dword v6, s[4:7], s39 offen lds
v_smfmac_f32_16x16x64_bf16 v[20:23], v[60:63], v[112:119], v0
v_smfmac_f32_16x16x64_bf16 v[20:23], v[64:67], v[128:135], v0
v_bfe_u32 v6, v1, 5, 1
s_waitcnt lgkmcnt(3)
v_smfmac_f32_16x16x64_bf16 v[20:23], v[68:71], v[144:151], v0
v_mad_i32_i24 v6, v6, s55, v1
s_waitcnt lgkmcnt(0)
v_smfmac_f32_16x16x64_bf16 v[20:23], v[72:75], v[160:167], v0
v_smfmac_f32_16x16x64_bf16 v[20:23], v[76:79], v[44:51], v0
ds_read_b128 v[44:47], v2 offset:10240
v_smfmac_f32_16x16x64_bf16 v[24:27], v[60:63], v[120:127], v0
ds_read_b128 v[48:51], v2 offset:11264
v_smfmac_f32_16x16x64_bf16 v[24:27], v[64:67], v[136:143], v0
v_add_f32 v20, v20, v22
v_smfmac_f32_16x16x64_bf16 v[24:27], v[68:71], v[152:159], v0
v_add_f32 v21, v21, v23
v_smfmac_f32_16x16x64_bf16 v[24:27], v[72:75], v[168:175], v0
v_cvt_pk_bf16_f32 v22, v20, v21
s_waitcnt lgkmcnt(0)
v_smfmac_f32_16x16x64_bf16 v[24:27], v[76:79], v[44:51], v0
ds_read_b128 v[44:47], v2 offset:12288
v_smfmac_f32_16x16x64_bf16 v[28:31], v[76:79], v[240:247], v0
ds_read_b128 v[48:51], v2 offset:13312
v_smfmac_f32_16x16x64_bf16 v[28:31], v[64:67], a[0:7], v0
v_add_f32 v24, v24, v26
v_add_f32 v25, v25, v27
v_cvt_pk_bf16_f32 v23, v24, v25
v_smfmac_f32_16x16x64_bf16 v[28:31], v[68:71], a[16:23], v0
ds_write_b64 v3, v[22:23] offset:10752
v_smfmac_f32_16x16x64_bf16 v[28:31], v[72:75], a[32:39], v0
s_waitcnt lgkmcnt(1)
v_smfmac_f32_16x16x64_bf16 v[28:31], v[60:63], v[44:51], v0
ds_read_b128 v[44:47], v2 offset:14336
v_smfmac_f32_16x16x64_bf16 v[32:35], v[76:79], v[248:255], v0
ds_read_b128 v[48:51], v2 offset:15360
v_smfmac_f32_16x16x64_bf16 v[32:35], v[64:67], a[8:15], v0
v_add_f32 v28, v28, v30
s_waitcnt lgkmcnt(2)
s_barrier
v_smfmac_f32_16x16x64_bf16 v[32:35], v[68:71], a[24:31], v0
ds_read_b64_tr_b16 v[20:21], v4 offset:10240
ds_read_b64_tr_b16 v[22:23], v4 offset:10752
v_add_f32 v29, v29, v31
v_smfmac_f32_16x16x64_bf16 v[32:35], v[72:75], a[40:47], v0
ds_read_b64_tr_b16 v[24:25], v4 offset:11264
ds_read_b64_tr_b16 v[26:27], v4 offset:11776
v_cvt_pk_bf16_f32 v30, v28, v29
s_waitcnt lgkmcnt(4)
v_smfmac_f32_16x16x64_bf16 v[32:35], v[60:63], v[44:51], v0
ds_read_b128 v[44:47], v2 offset:18432
s_waitcnt vmcnt(4)
s_waitcnt lgkmcnt(3)
v_mfma_f32_16x16x32_bf16 v[12:15], v[12:15], v[20:23], 0
ds_read_b128 v[48:51], v2 offset:19456
s_waitcnt lgkmcnt(2)
v_mfma_f32_16x16x32_bf16 v[12:15], v[16:19], v[24:27], v[12:15]
v_add_f32 v32, v32, v34
v_add_f32 v33, v33, v35
v_cvt_pk_bf16_f32 v31, v32, v33
ds_write_b64 v3, v[30:31] offset:12800
v_smfmac_f32_16x16x64_bf16 v[36:39], v[76:79], a[112:119], v0
s_nop 2
v_add_f32_dpp v12, v14, v12 quad_perm:[2,3,0,1] row_mask:0xf bank_mask:0xf
v_add_f32_dpp v13, v15, v13 quad_perm:[2,3,0,1] row_mask:0xf bank_mask:0xf
v_exp_f32 v14, v12
v_exp_f32 v15, v13
v_smfmac_f32_16x16x64_bf16 v[40:43], v[76:79], a[120:127], v0
v_cvt_pk_bf16_f32 v14, v14, v15
ds_write_b32 v5, v14 offset:14624
s_waitcnt lgkmcnt(1)
s_barrier
ds_read_b64_tr_b16 v[28:29], v4 offset:12288
v_smfmac_f32_16x16x64_bf16 v[36:39], v[60:63], a[128:135], v0
ds_read_b64_tr_b16 v[30:31], v4 offset:12800
ds_read_b64_tr_b16 v[32:33], v4 offset:13312
v_smfmac_f32_16x16x64_bf16 v[40:43], v[60:63], a[136:143], v0
ds_read_b64_tr_b16 v[34:35], v4 offset:13824
v_mov_b64 v[76:77], s[52:53]
v_smfmac_f32_16x16x64_bf16 v[40:43], v[72:75], v[44:51], v0
ds_read_b128 v[44:47], v2 offset:16384
v_mov_b64 v[78:79], s[52:53]
s_waitcnt lgkmcnt(3)
v_mfma_f32_16x16x32_bf16 v[28:31], v[28:31], v[20:23], 0
s_barrier
ds_read_b128 v[16:19], v1 offset:14368
s_waitcnt lgkmcnt(2)
v_mfma_f32_16x16x32_bf16 v[28:31], v[32:35], v[24:27], v[28:31]
ds_read_b128 v[60:63], v1 offset:14336
v_smfmac_f32_16x16x64_bf16 v[40:43], v[64:67], a[152:159], v0
ds_read_b128 v[48:51], v2 offset:17408
v_mov_b64 v[14:15], s[0:1]
v_smfmac_f32_16x16x64_bf16 v[40:43], v[68:71], a[168:175], v0
v_add_f32_dpp v28, v30, v28 quad_perm:[2,3,0,1] row_mask:0xf bank_mask:0xf
v_smfmac_f32_16x16x64_bf16 v[36:39], v[64:67], a[144:151], v0
ds_read_b128 v[64:67], v2 offset:27648
v_add_f32_dpp v29, v31, v29 quad_perm:[2,3,0,1] row_mask:0xf bank_mask:0xf
v_smfmac_f32_16x16x64_bf16 v[36:39], v[68:71], a[160:167], v0
ds_read_b128 v[68:71], v2 offset:20480
v_mul_f32 v28, s50, v28
s_waitcnt lgkmcnt(2)
v_smfmac_f32_16x16x64_bf16 v[36:39], v[72:75], v[44:51], v0
ds_read_b128 v[72:75], v2 offset:21504
v_mul_f32 v29, s50, v29
s_waitcnt vmcnt(2)
v_mfma_f32_16x16x32_bf16 v[32:35], v[76:79], v[16:19], 0
v_exp_f32 v30, v28
v_mfma_f32_16x16x32_bf16 v[20:23], v[52:55], v[16:19], 0
v_exp_f32 v31, v29
v_mfma_f32_16x16x32_bf16 v[20:23], v[56:59], v[60:63], v[20:23]
v_cvt_pk_bf16_f32 v30, v30, v31
v_cndmask_b32_e64 v24, 0, v30, s[56:57]
v_cndmask_b32_e64 v25, 0, v30, s[56:57]
v_cvt_pk_bf16_f32 v36, v36, v37
v_cvt_pk_bf16_f32 v37, v38, v39
v_mfma_f32_16x16x16_bf16 v[32:35], v[14:15], v[24:25], v[32:35]
v_cvt_pk_bf16_f32 v38, v40, v41
v_cvt_pk_bf16_f32 v39, v42, v43
v_mov_b32_dpp v26, v24 quad_perm:[2,3,0,1] row_mask:0xf bank_mask:0xf
v_mov_b32_dpp v27, v24 quad_perm:[2,3,0,1] row_mask:0xf bank_mask:0xf
ds_read_b128 v[44:47], v2 offset:22528
s_nop 0
v_mfma_f32_16x16x32_bf16 v[20:23], v[36:39], v[24:27], v[20:23]
ds_read_b128 v[48:51], v2 offset:23552
v_rcp_f32 v33, v32
ds_read_b128 v[60:63], v2 offset:26624
v_min_f32 v32, v32, v33
v_cmp_nlt_f32 vcc, s2, v32
v_mov_b64 v[76:77], 0
v_mov_b64 v[78:79], 0
v_mov_b64 v[40:41], 0
v_mul_f32_dpp v20, v33, v20 quad_perm:[0,1,0,1] row_mask:0xf bank_mask:0xf
v_mul_f32_dpp v21, v33, v21 quad_perm:[0,1,0,1] row_mask:0xf bank_mask:0xf
v_mul_f32_dpp v22, v33, v22 quad_perm:[0,1,0,1] row_mask:0xf bank_mask:0xf
v_mul_f32_dpp v23, v33, v23 quad_perm:[0,1,0,1] row_mask:0xf bank_mask:0xf
v_cvt_pk_bf16_f32 v20, v20, v21
v_cvt_pk_bf16_f32 v21, v22, v23
ds_write_b64 v6, v[20:21] offset:6144
v_mov_b64 v[42:43], 0
ds_read_b128 v[16:19], v7 offset:6144
s_and_b64 vcc, vcc, s[56:57]
v_mov_b64 v[24:25], 0
v_mov_b64 v[26:27], 0
s_cbranch_scc1 L_mx_w1rs
L_mxb_w1rs:
v_mov_b64 v[32:33], 0
v_mov_b64 v[34:35], 0
v_mov_b64 v[28:29], 0
v_mov_b64 v[30:31], 0
s_waitcnt lgkmcnt(1)
s_barrier
ds_read_b128 v[12:15], v7 offset:7168
s_waitcnt lgkmcnt(1)
v_smfmac_f32_16x16x64_bf16 v[76:79], v[16:19], a[176:183], v0 abid:1
ds_read_b128 v[52:55], v7 offset:8192
ds_read_b128 v[56:59], v7 offset:5120
v_smfmac_f32_16x16x64_bf16 v[40:43], v[16:19], a[184:191], v0 abid:1
s_waitcnt lgkmcnt(2)
v_smfmac_f32_16x16x64_bf16 v[76:79], v[12:15], v[44:51], v0 abid:1
ds_read_b128 v[44:47], v2 offset:24576
v_smfmac_f32_16x16x64_bf16 v[40:43], v[12:15], v[60:67], v0 abid:1
ds_read_b128 v[48:51], v2 offset:25600
s_waitcnt lgkmcnt(3)
v_smfmac_f32_16x16x64_bf16 v[76:79], v[52:55], a[192:199], v0 abid:1
ds_read_b128 v[60:63], v2 offset:30720
v_smfmac_f32_16x16x64_bf16 v[40:43], v[52:55], a[200:207], v0 abid:1
ds_read_b128 v[64:67], v2 offset:31744
s_waitcnt lgkmcnt(4)
v_smfmac_f32_16x16x64_bf16 v[76:79], v[56:59], v[68:75], v0 abid:1
ds_read_b128 v[68:71], v2 offset:28672
s_waitcnt lgkmcnt(3)
v_smfmac_f32_16x16x64_bf16 v[40:43], v[56:59], v[44:51], v0 abid:1
ds_read_b128 v[72:75], v2 offset:29696
v_smfmac_f32_16x16x64_bf16 v[24:27], v[16:19], a[208:215], v0 abid:1
ds_read_b128 v[44:47], v2 offset:36864
v_cvt_pk_bf16_f32 v76, v76, v77
v_cvt_pk_bf16_f32 v77, v78, v79
v_bfi_b32 v76, 1, s35, v76
buffer_store_dwordx2 v[76:77], v8, s[4:7], s42 offen sc0 sc1
s_waitcnt lgkmcnt(3)
v_smfmac_f32_16x16x64_bf16 v[24:27], v[12:15], v[60:67], v0 abid:1
ds_read_b128 v[48:51], v2 offset:37888
v_cvt_pk_bf16_f32 v40, v40, v41
v_cvt_pk_bf16_f32 v41, v42, v43
v_bfi_b32 v40, 1, s35, v40
buffer_store_dwordx2 v[40:41], v8, s[4:7], s43 offen sc0 sc1
v_smfmac_f32_16x16x64_bf16 v[24:27], v[52:55], a[216:223], v0 abid:1
ds_read_b128 v[60:63], v2 offset:34816
s_waitcnt lgkmcnt(3)
v_smfmac_f32_16x16x64_bf16 v[24:27], v[56:59], v[68:75], v0 abid:1
ds_read_b128 v[64:67], v2 offset:35840
v_smfmac_f32_16x16x64_bf16 v[32:35], v[16:19], a[224:231], v0 abid:1
ds_read_b128 v[68:71], v2 offset:38912
v_smfmac_f32_16x16x64_bf16 v[32:35], v[12:15], a[232:239], v0 abid:1
ds_read_b128 v[72:75], v2 offset:39936
v_cvt_pk_bf16_f32 v24, v24, v25
v_cvt_pk_bf16_f32 v25, v26, v27
v_bfi_b32 v24, 1, s35, v24
buffer_store_dwordx2 v[24:25], v8, s[4:7], s44 offen sc0 sc1
v_smfmac_f32_16x16x64_bf16 v[32:35], v[52:55], a[240:247], v0 abid:1
v_smfmac_f32_16x16x64_bf16 v[32:35], v[56:59], a[248:255], v0 abid:1
s_waitcnt lgkmcnt(4)
v_smfmac_f32_16x16x64_bf16 v[28:31], v[16:19], v[44:51], v0 abid:1
ds_read_b128 v[44:47], v2 offset:32768
s_waitcnt lgkmcnt(3)
v_smfmac_f32_16x16x64_bf16 v[28:31], v[12:15], v[60:67], v0 abid:1
ds_read_b128 v[48:51], v2 offset:33792
v_cvt_pk_bf16_f32 v32, v32, v33
v_cvt_pk_bf16_f32 v33, v34, v35
v_bfi_b32 v32, 1, s35, v32
buffer_store_dwordx2 v[32:33], v8, s[4:7], s45 offen sc0 sc1
s_waitcnt lgkmcnt(2)
v_smfmac_f32_16x16x64_bf16 v[28:31], v[52:55], v[68:75], v0 abid:1
s_waitcnt lgkmcnt(0)
v_smfmac_f32_16x16x64_bf16 v[28:31], v[56:59], v[44:51], v0 abid:1
s_nop 7
v_cvt_pk_bf16_f32 v28, v28, v29
v_cvt_pk_bf16_f32 v29, v30, v31
v_bfi_b32 v28, 1, s35, v28
buffer_store_dwordx2 v[28:29], v8, s[4:7], s46 offen sc0 sc1
s_branch L_ex_w1rs
.p2align 6
L_ex_w2rs:
v_and_b32 v6, 0x70, v1
ds_read_b128 v[76:79], v6 offset:256
v_bfe_u32 v11, v1, 4, 2
v_lshrrev_b32_e64 v11, v11, 1
s_add_u32 s34, s34, 1
s_add_u32 s37, s37, 524288
s_add_u32 s39, s39, 524288
s_mul_i32 s40, s34, 10240
s_add_u32 s40, s40, 8093696
s_not_b32 s35, s35
s_not_b32 s36, s36
ds_read_b128 v[44:47], v2 offset:0
ds_read_b128 v[48:51], v2 offset:1024
v_bfe_u32 v6, v1, 2, 7
v_mov_b32 v42, s35
s_mov_b32 m0, 1024
s_waitcnt vmcnt(2)
buffer_load_dwordx4 v[60:63], v9, s[4:7], s3 offen offset:0 sc0 sc1
buffer_load_dwordx4 v[64:67], v9, s[4:7], s3 offen offset:1024 sc0 sc1
buffer_load_dwordx4 v[68:71], v9, s[4:7], s3 offen offset:2048 sc0 sc1
buffer_load_dwordx4 v[72:75], v9, s[4:7], s3 offen offset:3072 sc0 sc1
s_barrier
s_waitcnt lgkmcnt(2)
s_waitcnt vmcnt(3)
L_r_w2rs:
v_mfma_f32_16x16x32_bf16 v[36:39], v[60:63], v[76:79], 0
s_waitcnt vmcnt(2)
v_mfma_f32_16x16x32_bf16 v[36:39], v[64:67], v[76:79], v[36:39]
v_bitop3_b32 v40, v60, v64, s36 bitop3:0x7e
s_waitcnt vmcnt(1)
v_mfma_f32_16x16x32_bf16 v[36:39], v[68:71], v[76:79], v[36:39]
s_waitcnt vmcnt(0)
v_mfma_f32_16x16x32_bf16 v[36:39], v[72:75], v[76:79], v[36:39]
v_bitop3_b32 v41, v68, v72, s36 bitop3:0x7e
v_bitop3_b32 v40, v40, v41, 1 bitop3:0xa8
v_cmp_ne_u32 vcc, 0, v40
v_nop
v_nop
v_nop
v_nop
v_nop
v_pk_add_f32 v[36:37], v[36:37], v[38:39]
v_cvt_pk_bf16_f32 v40, v36, v37
v_bfi_b32 v40, v11, s35, v40
s_cbranch_vccnz L_rr_w2rs
buffer_store_dword v40, v10, s[4:7], 0 offen sc0 sc1
s_cmp_eq_u32 s34, 63
v_mov_b32 v11, v40
s_cbranch_scc1 L_done_w2rs
s_mov_b64 exec, 1
buffer_store_dword v42, v1, s[4:7], s33 offen sc0 sc1
s_mov_b64 exec, -1
v_mov_b64 v[20:21], 0
v_mov_b64 v[22:23], 0
v_mov_b64 v[24:25], 0
v_mov_b64 v[26:27], 0
v_mov_b64 v[28:29], 0
v_mov_b64 v[30:31], 0
v_mov_b64 v[32:33], 0
v_mov_b64 v[34:35], 0
v_mov_b64 v[36:37], 0
v_mov_b64 v[38:39], 0
v_mov_b64 v[40:41], 0
v_mov_b64 v[42:43], 0
v_bfe_u32 v77, v1, 6, 1
v_lshl_add_u32 v77, v77, 3, v1
v_lshlrev_b32 v77, 1, v77
v_mov_b32 v79, s36
L_sp_w2rs:
buffer_load_dword v79, v6, s[4:7], s58 offen sc0 sc1
s_sub_u32 s41, s41, 1
s_cbranch_scc1 L_exit
buffer_load_dwordx4 v1, s[4:7], s47 offen offset:0 sc0 sc1 lds
buffer_load_dwordx4 v1, s[4:7], s47 offen offset:1024 sc0 sc1 lds
buffer_load_dwordx4 v1, s[4:7], s47 offen offset:2048 sc0 sc1 lds
buffer_load_dwordx4 v1, s[4:7], s47 offen offset:3072 sc0 sc1 lds
s_waitcnt vmcnt(4)
v_cmp_ne_u32 vcc, s35, v79
s_cbranch_vccnz L_sp_w2rs
L_top_w2rs:
s_waitcnt vmcnt(2)
s_barrier
ds_read_b128 v[60:63], v1 offset:1024
ds_read_b128 v[64:67], v1 offset:2048
s_mov_b32 m0, 5120
s_nop 0
buffer_load_dwordx4 v1, s[4:7], s48 offen offset:2048 sc0 sc1 lds
s_waitcnt vmcnt(1)
s_barrier
ds_read_b128 v[68:71], v1 offset:3072
ds_read_b128 v[72:75], v1 offset:4096
L_s0_w2rs:
s_waitcnt lgkmcnt(3)
v_smfmac_f32_16x16x64_bf16 v[28:31], v[60:63], v[176:183], v0
v_smfmac_f32_16x16x64_bf16 v[32:35], v[60:63], v[184:191], v0
v_smfmac_f32_16x16x64_bf16 v[36:39], v[60:63], a[48:55], v0
v_smfmac_f32_16x16x64_bf16 v[40:43], v[60:63], a[56:63], v0
s_waitcnt lgkmcnt(2)
v_smfmac_f32_16x16x64_bf16 v[20:23], v[64:67], v[80:87], v0
v_smfmac_f32_16x16x64_bf16 v[20:23], v[60:63], v[44:51], v0
ds_read_b128 v[44:47], v2 offset:2048
v_smfmac_f32_16x16x64_bf16 v[24:27], v[64:67], v[88:95], v0
ds_read_b128 v[48:51], v2 offset:3072
buffer_load_dwordx4 v[12:15], v9, s[4:7], s37 offen offset:0
v_smfmac_f32_16x16x64_bf16 v[28:31], v[64:67], v[192:199], v0
s_waitcnt lgkmcnt(2)
v_bitop3_b32 v6, v60, v64, s35 bitop3:0x7e
v_smfmac_f32_16x16x64_bf16 v[32:35], v[64:67], v[200:207], v0
v_bitop3_b32 v76, v68, v72, s35 bitop3:0x7e
v_smfmac_f32_16x16x64_bf16 v[36:39], v[64:67], a[64:71], v0
v_bitop3_b32 v6, v6, v76, 1 bitop3:0xa8
s_waitcnt lgkmcnt(0)
v_smfmac_f32_16x16x64_bf16 v[24:27], v[60:63], v[44:51], v0
ds_read_b128 v[44:47], v2 offset:4096
v_cmp_ne_u32 vcc, 0, v6
buffer_load_dwordx4 v[16:19], v9, s[4:7], s37 offen offset:1024
v_smfmac_f32_16x16x64_bf16 v[40:43], v[64:67], a[72:79], v0
ds_read_b128 v[48:51], v2 offset:5120
v_smfmac_f32_16x16x64_bf16 v[20:23], v[68:71], v[96:103], v0
s_cbranch_vccnz L_ra0_w2rs
v_smfmac_f32_16x16x64_bf16 v[24:27], v[68:71], v[104:111], v0
s_waitcnt vmcnt(2)
s_barrier
ds_read_b32 v6, v77 offset:8192
v_smfmac_f32_16x16x64_bf16 v[28:31], v[68:71], v[208:215], v0
ds_read_b128 v[60:63], v1 offset:6144
s_waitcnt lgkmcnt(2)
buffer_load_dwordx4 v[52:55], v1, s[4:7], s37 offen offset:2048
v_smfmac_f32_16x16x64_bf16 v[20:23], v[72:75], v[44:51], v0
ds_read_b128 v[64:67], v1 offset:7168
v_smfmac_f32_16x16x64_bf16 v[32:35], v[68:71], v[216:223], v0
ds_read_b128 v[44:47], v2 offset:6144
ds_read_b128 v[76:79], v1 offset:5120
v_smfmac_f32_16x16x64_bf16 v[36:39], v[68:71], a[80:87], v0
ds_read_b128 v[48:51], v2 offset:7168
v_smfmac_f32_16x16x64_bf16 v[40:43], v[68:71], a[88:95], v0
ds_read_b128 v[68:71], v1 offset:8192
s_waitcnt lgkmcnt(5)
v_bitop3_b32 v6, v6, v60, s35 bitop3:0x7e
buffer_load_dwordx4 v[56:59], v1, s[4:7], s37 offen offset:3072
v_smfmac_f32_16x16x64_bf16 v[28:31], v[72:75], v[224:231], v0
s_waitcnt lgkmcnt(4)
v_bitop3_b32 v6, v6, v64, s35 bitop3:0xf6
v_smfmac_f32_16x16x64_bf16 v[32:35], v[72:75], v[232:239], v0
s_mov_b32 m0, 0
s_waitcnt lgkmcnt(2)
v_bitop3_b32 v6, v6, v76, s35 bitop3:0xf6
v_and_b32 v6, 1, v6
s_waitcnt lgkmcnt(1)
v_smfmac_f32_16x16x64_bf16 v[24:27], v[72:75], v[44:51], v0
ds_read_b128 v[44:47], v2 offset:8192
v_cmp_ne_u32 vcc, 0, v6
v_smfmac_f32_16x16x64_bf16 v[36:39], v[72:75], a[96:103], v0
ds_read_b128 v[48:51], v2 offset:9216
v_lshlrev_b32 v6, 3, v1
v_smfmac_f32_16x16x64_bf16 v[40:43], v[72:75], a[104:111], v0
ds_read_b128 v[72:75], v1 offset:9216
s_cbranch_vccnz L_ra1_w2rs
L_a1_w2rs:
buffer_store_dword v11, v10, s[4:7], s40 offen sc0 sc1
v_smfmac_f32_16x16x64_bf16 v[20:23], v[60:63], v[112:119], v0
v_smfmac_f32_16x16x64_bf16 v[20:23], v[64:67], v[128:135], v0
v_bfe_u32 v6, v1, 5, 1
s_waitcnt lgkmcnt(3)
v_smfmac_f32_16x16x64_bf16 v[20:23], v[68:71], v[144:151], v0
v_mad_i32_i24 v6, v6, s55, v1
s_waitcnt lgkmcnt(0)
v_smfmac_f32_16x16x64_bf16 v[20:23], v[72:75], v[160:167], v0
v_smfmac_f32_16x16x64_bf16 v[20:23], v[76:79], v[44:51], v0
ds_read_b128 v[44:47], v2 offset:10240
v_smfmac_f32_16x16x64_bf16 v[24:27], v[60:63], v[120:127], v0
ds_read_b128 v[48:51], v2 offset:11264
v_smfmac_f32_16x16x64_bf16 v[24:27], v[64:67], v[136:143], v0
v_add_f32 v20, v20, v22
v_smfmac_f32_16x16x64_bf16 v[24:27], v[68:71], v[152:159], v0
v_add_f32 v21, v21, v23
v_smfmac_f32_16x16x64_bf16 v[24:27], v[72:75], v[168:175], v0
v_cvt_pk_bf16_f32 v22, v20, v21
s_waitcnt lgkmcnt(0)
v_smfmac_f32_16x16x64_bf16 v[24:27], v[76:79], v[44:51], v0
ds_read_b128 v[44:47], v2 offset:12288
v_smfmac_f32_16x16x64_bf16 v[28:31], v[76:79], v[240:247], v0
ds_read_b128 v[48:51], v2 offset:13312
v_smfmac_f32_16x16x64_bf16 v[28:31], v[64:67], a[0:7], v0
v_add_f32 v24, v24, v26
v_add_f32 v25, v25, v27
v_cvt_pk_bf16_f32 v23, v24, v25
v_smfmac_f32_16x16x64_bf16 v[28:31], v[68:71], a[16:23], v0
ds_write_b64 v3, v[22:23] offset:11264
v_smfmac_f32_16x16x64_bf16 v[28:31], v[72:75], a[32:39], v0
s_waitcnt lgkmcnt(1)
v_smfmac_f32_16x16x64_bf16 v[28:31], v[60:63], v[44:51], v0
ds_read_b128 v[44:47], v2 offset:14336
v_smfmac_f32_16x16x64_bf16 v[32:35], v[76:79], v[248:255], v0
ds_read_b128 v[48:51], v2 offset:15360
v_smfmac_f32_16x16x64_bf16 v[32:35], v[64:67], a[8:15], v0
v_add_f32 v28, v28, v30
s_waitcnt lgkmcnt(2)
s_barrier
v_smfmac_f32_16x16x64_bf16 v[32:35], v[68:71], a[24:31], v0
ds_read_b64_tr_b16 v[20:21], v4 offset:10240
ds_read_b64_tr_b16 v[22:23], v4 offset:10752
v_add_f32 v29, v29, v31
v_smfmac_f32_16x16x64_bf16 v[32:35], v[72:75], a[40:47], v0
ds_read_b64_tr_b16 v[24:25], v4 offset:11264
ds_read_b64_tr_b16 v[26:27], v4 offset:11776
v_cvt_pk_bf16_f32 v30, v28, v29
s_waitcnt lgkmcnt(4)
v_smfmac_f32_16x16x64_bf16 v[32:35], v[60:63], v[44:51], v0
ds_read_b128 v[44:47], v2 offset:18432
s_waitcnt vmcnt(3)
s_waitcnt lgkmcnt(3)
v_mfma_f32_16x16x32_bf16 v[12:15], v[12:15], v[20:23], 0
ds_read_b128 v[48:51], v2 offset:19456
s_waitcnt lgkmcnt(2)
v_mfma_f32_16x16x32_bf16 v[12:15], v[16:19], v[24:27], v[12:15]
v_add_f32 v32, v32, v34
v_add_f32 v33, v33, v35
v_cvt_pk_bf16_f32 v31, v32, v33
ds_write_b64 v3, v[30:31] offset:13312
v_smfmac_f32_16x16x64_bf16 v[36:39], v[76:79], a[112:119], v0
s_nop 2
v_add_f32_dpp v12, v14, v12 quad_perm:[2,3,0,1] row_mask:0xf bank_mask:0xf
v_add_f32_dpp v13, v15, v13 quad_perm:[2,3,0,1] row_mask:0xf bank_mask:0xf
v_exp_f32 v14, v12
v_exp_f32 v15, v13
v_smfmac_f32_16x16x64_bf16 v[40:43], v[76:79], a[120:127], v0
v_cvt_pk_bf16_f32 v14, v14, v15
ds_write_b32 v5, v14 offset:14880
s_waitcnt lgkmcnt(1)
s_barrier
ds_read_b64_tr_b16 v[28:29], v4 offset:12288
v_smfmac_f32_16x16x64_bf16 v[36:39], v[60:63], a[128:135], v0
ds_read_b64_tr_b16 v[30:31], v4 offset:12800
ds_read_b64_tr_b16 v[32:33], v4 offset:13312
v_smfmac_f32_16x16x64_bf16 v[40:43], v[60:63], a[136:143], v0
ds_read_b64_tr_b16 v[34:35], v4 offset:13824
v_mov_b64 v[76:77], s[52:53]
v_smfmac_f32_16x16x64_bf16 v[40:43], v[72:75], v[44:51], v0
ds_read_b128 v[44:47], v2 offset:16384
v_mov_b64 v[78:79], s[52:53]
s_waitcnt lgkmcnt(3)
v_mfma_f32_16x16x32_bf16 v[28:31], v[28:31], v[20:23], 0
s_barrier
ds_read_b128 v[16:19], v1 offset:14368
s_waitcnt lgkmcnt(2)
v_mfma_f32_16x16x32_bf16 v[28:31], v[32:35], v[24:27], v[28:31]
ds_read_b128 v[60:63], v1 offset:14336
v_smfmac_f32_16x16x64_bf16 v[40:43], v[64:67], a[152:159], v0
ds_read_b128 v[48:51], v2 offset:17408
v_mov_b64 v[14:15], s[0:1]
v_smfmac_f32_16x16x64_bf16 v[40:43], v[68:71], a[168:175], v0
v_add_f32_dpp v28, v30, v28 quad_perm:[2,3,0,1] row_mask:0xf bank_mask:0xf
v_smfmac_f32_16x16x64_bf16 v[36:39], v[64:67], a[144:151], v0
ds_read_b128 v[64:67], v2 offset:27648
v_add_f32_dpp v29, v31, v29 quad_perm:[2,3,0,1] row_mask:0xf bank_mask:0xf
v_smfmac_f32_16x16x64_bf16 v[36:39], v[68:71], a[160:167], v0
ds_read_b128 v[68:71], v2 offset:20480
v_mul_f32 v28, s50, v28
s_waitcnt lgkmcnt(2)
v_smfmac_f32_16x16x64_bf16 v[36:39], v[72:75], v[44:51], v0
ds_read_b128 v[72:75], v2 offset:21504
v_mul_f32 v29, s50, v29
s_waitcnt vmcnt(1)
v_mfma_f32_16x16x32_bf16 v[32:35], v[76:79], v[16:19], 0
v_exp_f32 v30, v28
v_mfma_f32_16x16x32_bf16 v[20:23], v[52:55], v[16:19], 0
v_exp_f32 v31, v29
v_mfma_f32_16x16x32_bf16 v[20:23], v[56:59], v[60:63], v[20:23]
v_cvt_pk_bf16_f32 v30, v30, v31
v_cndmask_b32_e64 v24, 0, v30, s[56:57]
v_cndmask_b32_e64 v25, 0, v30, s[56:57]
v_cvt_pk_bf16_f32 v36, v36, v37
v_cvt_pk_bf16_f32 v37, v38, v39
v_mfma_f32_16x16x16_bf16 v[32:35], v[14:15], v[24:25], v[32:35]
v_cvt_pk_bf16_f32 v38, v40, v41
v_cvt_pk_bf16_f32 v39, v42, v43
v_mov_b32_dpp v26, v24 quad_perm:[2,3,0,1] row_mask:0xf bank_mask:0xf
v_mov_b32_dpp v27, v24 quad_perm:[2,3,0,1] row_mask:0xf bank_mask:0xf
ds_read_b128 v[44:47], v2 offset:22528
s_nop 0
v_mfma_f32_16x16x32_bf16 v[20:23], v[36:39], v[24:27], v[20:23]
ds_read_b128 v[48:51], v2 offset:23552
v_rcp_f32 v33, v32
ds_read_b128 v[60:63], v2 offset:26624
v_min_f32 v32, v32, v33
v_cmp_nlt_f32 vcc, s2, v32
v_mov_b64 v[76:77], 0
v_mov_b64 v[78:79], 0
v_mov_b64 v[40:41], 0
v_mul_f32_dpp v20, v33, v20 quad_perm:[0,1,0,1] row_mask:0xf bank_mask:0xf
v_mul_f32_dpp v21, v33, v21 quad_perm:[0,1,0,1] row_mask:0xf bank_mask:0xf
v_mul_f32_dpp v22, v33, v22 quad_perm:[0,1,0,1] row_mask:0xf bank_mask:0xf
v_mul_f32_dpp v23, v33, v23 quad_perm:[0,1,0,1] row_mask:0xf bank_mask:0xf
v_cvt_pk_bf16_f32 v20, v20, v21
v_cvt_pk_bf16_f32 v21, v22, v23
ds_write_b64 v6, v[20:21] offset:7168
v_mov_b64 v[42:43], 0
ds_read_b128 v[16:19], v7 offset:7168
s_and_b64 vcc, vcc, s[56:57]
v_mov_b64 v[24:25], 0
v_mov_b64 v[26:27], 0
s_cbranch_scc1 L_mx_w2rs
L_mxb_w2rs:
v_mov_b64 v[32:33], 0
v_mov_b64 v[34:35], 0
v_mov_b64 v[28:29], 0
v_mov_b64 v[30:31], 0
s_waitcnt lgkmcnt(1)
s_barrier
ds_read_b128 v[12:15], v7 offset:8192
s_waitcnt lgkmcnt(1)
v_smfmac_f32_16x16x64_bf16 v[76:79], v[16:19], v[44:51], v0 abid:1
ds_read_b128 v[52:55], v7 offset:5120
ds_read_b128 v[56:59], v7 offset:6144
v_smfmac_f32_16x16x64_bf16 v[40:43], v[16:19], v[60:67], v0 abid:1
ds_read_b128 v[44:47], v2 offset:24576
s_waitcnt lgkmcnt(3)
v_smfmac_f32_16x16x64_bf16 v[76:79], v[12:15], a[176:183], v0 abid:1
ds_read_b128 v[48:51], v2 offset:25600
v_smfmac_f32_16x16x64_bf16 v[40:43], v[12:15], a[184:191], v0 abid:1
ds_read_b128 v[60:63], v2 offset:30720
s_waitcnt lgkmcnt(4)
v_smfmac_f32_16x16x64_bf16 v[76:79], v[52:55], v[68:75], v0 abid:1
ds_read_b128 v[64:67], v2 offset:31744
s_waitcnt lgkmcnt(2)
v_smfmac_f32_16x16x64_bf16 v[40:43], v[52:55], v[44:51], v0 abid:1
ds_read_b128 v[68:71], v2 offset:28672
v_smfmac_f32_16x16x64_bf16 v[76:79], v[56:59], a[192:199], v0 abid:1
ds_read_b128 v[72:75], v2 offset:29696
v_smfmac_f32_16x16x64_bf16 v[40:43], v[56:59], a[200:207], v0 abid:1
s_waitcnt lgkmcnt(2)
v_smfmac_f32_16x16x64_bf16 v[24:27], v[16:19], v[60:67], v0 abid:1
v_cvt_pk_bf16_f32 v76, v76, v77
v_cvt_pk_bf16_f32 v77, v78, v79
v_bfi_b32 v76, 1, s35, v76
buffer_store_dwordx2 v[76:77], v8, s[4:7], s42 offen sc0 sc1
v_smfmac_f32_16x16x64_bf16 v[24:27], v[12:15], a[208:215], v0 abid:1
v_cvt_pk_bf16_f32 v40, v40, v41
v_cvt_pk_bf16_f32 v41, v42, v43
v_bfi_b32 v40, 1, s35, v40
buffer_store_dwordx2 v[40:41], v8, s[4:7], s43 offen sc0 sc1
s_waitcnt lgkmcnt(0)
v_smfmac_f32_16x16x64_bf16 v[24:27], v[52:55], v[68:75], v0 abid:1
v_smfmac_f32_16x16x64_bf16 v[24:27], v[56:59], a[216:223], v0 abid:1
v_smfmac_f32_16x16x64_bf16 v[32:35], v[16:19], a[224:231], v0 abid:1
v_smfmac_f32_16x16x64_bf16 v[32:35], v[12:15], a[232:239], v0 abid:1
v_cvt_pk_bf16_f32 v24, v24, v25
v_cvt_pk_bf16_f32 v25, v26, v27
v_bfi_b32 v24, 1, s35, v24
buffer_store_dwordx2 v[24:25], v8, s[4:7], s44 offen sc0 sc1
v_smfmac_f32_16x16x64_bf16 v[32:35], v[52:55], a[240:247], v0 abid:1
v_smfmac_f32_16x16x64_bf16 v[32:35], v[56:59], a[248:255], v0 abid:1
s_nop 7
v_cvt_pk_bf16_f32 v32, v32, v33
v_cvt_pk_bf16_f32 v33, v34, v35
v_bfi_b32 v32, 1, s35, v32
buffer_store_dwordx2 v[32:33], v8, s[4:7], s45 offen sc0 sc1
s_branch L_ex_w2rs
.p2align 6
L_ex_w3rs:
v_and_b32 v6, 0x70, v1
ds_read_b128 v[76:79], v6 offset:256
v_bfe_u32 v11, v1, 4, 2
v_lshrrev_b32_e64 v11, v11, 1
s_add_u32 s34, s34, 1
s_add_u32 s37, s37, 524288
s_add_u32 s39, s39, 524288
s_mul_i32 s40, s34, 10240
s_add_u32 s40, s40, 8093696
s_not_b32 s35, s35
s_not_b32 s36, s36
ds_read_b128 v[44:47], v2 offset:0
ds_read_b128 v[48:51], v2 offset:1024
s_barrier
s_waitcnt vmcnt(0)
v_mov_b64 v[20:21], 0
v_mov_b64 v[22:23], 0
v_mov_b64 v[24:25], 0
v_mov_b64 v[26:27], 0
v_mov_b64 v[28:29], 0
v_mov_b64 v[30:31], 0
v_mov_b64 v[32:33], 0
v_mov_b64 v[34:35], 0
buffer_load_dwordx4 v[60:63], v9, s[4:7], s3 offen offset:0 sc0 sc1
buffer_load_dwordx4 v[64:67], v9, s[4:7], s3 offen offset:1024 sc0 sc1
buffer_load_dwordx4 v[68:71], v9, s[4:7], s3 offen offset:2048 sc0 sc1
buffer_load_dwordx4 v[72:75], v9, s[4:7], s3 offen offset:3072 sc0 sc1
s_waitcnt lgkmcnt(2)
s_waitcnt vmcnt(3)
L_r_w3rs:
v_mfma_f32_16x16x32_bf16 v[36:39], v[60:63], v[76:79], 0
s_waitcnt vmcnt(2)
v_mfma_f32_16x16x32_bf16 v[36:39], v[64:67], v[76:79], v[36:39]
v_bitop3_b32 v40, v60, v64, s36 bitop3:0x7e
s_waitcnt vmcnt(1)
v_mfma_f32_16x16x32_bf16 v[36:39], v[68:71], v[76:79], v[36:39]
s_waitcnt vmcnt(0)
v_mfma_f32_16x16x32_bf16 v[36:39], v[72:75], v[76:79], v[36:39]
v_bitop3_b32 v41, v68, v72, s36 bitop3:0x7e
v_bitop3_b32 v40, v40, v41, 1 bitop3:0xa8
v_cmp_ne_u32 vcc, 0, v40
v_nop
v_nop
v_nop
v_nop
v_nop
v_pk_add_f32 v[36:37], v[36:37], v[38:39]
v_cvt_pk_bf16_f32 v40, v36, v37
v_bfi_b32 v40, v11, s35, v40
s_cbranch_vccnz L_rr_w3rs
buffer_store_dword v40, v10, s[4:7], 0 offen sc0 sc1
s_cmp_eq_u32 s34, 63
v_mov_b32 v11, v40
s_cbranch_scc1 L_done_w3rs
v_mov_b64 v[36:37], 0
v_mov_b64 v[38:39], 0
v_mov_b64 v[40:41], 0
v_mov_b64 v[42:43], 0
v_bfe_u32 v77, v1, 6, 1
v_lshl_add_u32 v77, v77, 3, v1
v_lshlrev_b32 v77, 1, v77
L_top_w3rs:
s_barrier
ds_read_b128 v[60:63], v1 offset:1024
ds_read_b128 v[64:67], v1 offset:2048
s_mov_b32 m0, 5120
s_nop 0
buffer_load_dwordx4 v1, s[4:7], s48 offen offset:3072 sc0 sc1 lds
s_barrier
ds_read_b128 v[68:71], v1 offset:3072
ds_read_b128 v[72:75], v1 offset:4096
L_s0_w3rs:
s_waitcnt lgkmcnt(3)
v_smfmac_f32_16x16x64_bf16 v[28:31], v[60:63], v[176:183], v0
v_smfmac_f32_16x16x64_bf16 v[32:35], v[60:63], v[184:191], v0
v_smfmac_f32_16x16x64_bf16 v[36:39], v[60:63], a[48:55], v0
v_smfmac_f32_16x16x64_bf16 v[40:43], v[60:63], a[56:63], v0
s_waitcnt lgkmcnt(2)
v_smfmac_f32_16x16x64_bf16 v[20:23], v[64:67], v[80:87], v0
v_smfmac_f32_16x16x64_bf16 v[20:23], v[60:63], v[44:51], v0
ds_read_b128 v[44:47], v2 offset:2048
v_smfmac_f32_16x16x64_bf16 v[24:27], v[64:67], v[88:95], v0
ds_read_b128 v[48:51], v2 offset:3072
v_smfmac_f32_16x16x64_bf16 v[28:31], v[64:67], v[192:199], v0
s_waitcnt lgkmcnt(2)
v_bitop3_b32 v6, v60, v64, s35 bitop3:0x7e
buffer_load_dwordx4 v[12:15], v9, s[4:7], s37 offen offset:0
v_smfmac_f32_16x16x64_bf16 v[32:35], v[64:67], v[200:207], v0
v_bitop3_b32 v76, v68, v72, s35 bitop3:0x7e
v_smfmac_f32_16x16x64_bf16 v[36:39], v[64:67], a[64:71], v0
v_bitop3_b32 v6, v6, v76, 1 bitop3:0xa8
s_waitcnt lgkmcnt(0)
v_smfmac_f32_16x16x64_bf16 v[24:27], v[60:63], v[44:51], v0
ds_read_b128 v[44:47], v2 offset:4096
v_cmp_ne_u32 vcc, 0, v6
v_smfmac_f32_16x16x64_bf16 v[40:43], v[64:67], a[72:79], v0
ds_read_b128 v[48:51], v2 offset:5120
buffer_load_dwordx4 v[16:19], v9, s[4:7], s37 offen offset:1024
v_smfmac_f32_16x16x64_bf16 v[20:23], v[68:71], v[96:103], v0
s_cbranch_vccnz L_ra0_w3rs
v_smfmac_f32_16x16x64_bf16 v[24:27], v[68:71], v[104:111], v0
s_waitcnt vmcnt(2)
s_barrier
ds_read_b32 v6, v77 offset:8192
v_smfmac_f32_16x16x64_bf16 v[28:31], v[68:71], v[208:215], v0
ds_read_b128 v[60:63], v1 offset:6144
s_waitcnt lgkmcnt(2)
v_smfmac_f32_16x16x64_bf16 v[20:23], v[72:75], v[44:51], v0
ds_read_b128 v[64:67], v1 offset:7168
buffer_load_dwordx4 v[52:55], v1, s[4:7], s37 offen offset:2048
v_smfmac_f32_16x16x64_bf16 v[32:35], v[68:71], v[216:223], v0
ds_read_b128 v[44:47], v2 offset:6144
ds_read_b128 v[76:79], v1 offset:5120
v_smfmac_f32_16x16x64_bf16 v[36:39], v[68:71], a[80:87], v0
ds_read_b128 v[48:51], v2 offset:7168
v_smfmac_f32_16x16x64_bf16 v[40:43], v[68:71], a[88:95], v0
ds_read_b128 v[68:71], v1 offset:8192
s_waitcnt lgkmcnt(5)
v_bitop3_b32 v6, v6, v60, s35 bitop3:0x7e
v_smfmac_f32_16x16x64_bf16 v[28:31], v[72:75], v[224:231], v0
s_waitcnt lgkmcnt(4)
v_bitop3_b32 v6, v6, v64, s35 bitop3:0xf6
buffer_load_dwordx4 v[56:59], v1, s[4:7], s37 offen offset:3072
v_smfmac_f32_16x16x64_bf16 v[32:35], v[72:75], v[232:239], v0
s_mov_b32 m0, 0
s_waitcnt lgkmcnt(2)
v_bitop3_b32 v6, v6, v76, s35 bitop3:0xf6
v_and_b32 v6, 1, v6
s_waitcnt lgkmcnt(1)
v_smfmac_f32_16x16x64_bf16 v[24:27], v[72:75], v[44:51], v0
ds_read_b128 v[44:47], v2 offset:8192
v_cmp_ne_u32 vcc, 0, v6
v_smfmac_f32_16x16x64_bf16 v[36:39], v[72:75], a[96:103], v0
ds_read_b128 v[48:51], v2 offset:9216
v_lshlrev_b32 v6, 3, v1
v_smfmac_f32_16x16x64_bf16 v[40:43], v[72:75], a[104:111], v0
ds_read_b128 v[72:75], v1 offset:9216
s_cbranch_vccnz L_ra1_w3rs
L_a1_w3rs:
buffer_store_dword v11, v10, s[4:7], s40 offen sc0 sc1
v_smfmac_f32_16x16x64_bf16 v[20:23], v[60:63], v[112:119], v0
v_smfmac_f32_16x16x64_bf16 v[20:23], v[64:67], v[128:135], v0
v_bfe_u32 v6, v1, 5, 1
s_waitcnt lgkmcnt(3)
v_smfmac_f32_16x16x64_bf16 v[20:23], v[68:71], v[144:151], v0
v_mad_i32_i24 v6, v6, s55, v1
s_waitcnt lgkmcnt(0)
v_smfmac_f32_16x16x64_bf16 v[20:23], v[72:75], v[160:167], v0
v_smfmac_f32_16x16x64_bf16 v[20:23], v[76:79], v[44:51], v0
ds_read_b128 v[44:47], v2 offset:10240
v_smfmac_f32_16x16x64_bf16 v[24:27], v[60:63], v[120:127], v0
ds_read_b128 v[48:51], v2 offset:11264
v_smfmac_f32_16x16x64_bf16 v[24:27], v[64:67], v[136:143], v0
v_add_f32 v20, v20, v22
v_smfmac_f32_16x16x64_bf16 v[24:27], v[68:71], v[152:159], v0
v_add_f32 v21, v21, v23
v_smfmac_f32_16x16x64_bf16 v[24:27], v[72:75], v[168:175], v0
v_cvt_pk_bf16_f32 v22, v20, v21
s_waitcnt lgkmcnt(0)
v_smfmac_f32_16x16x64_bf16 v[24:27], v[76:79], v[44:51], v0
ds_read_b128 v[44:47], v2 offset:12288
v_smfmac_f32_16x16x64_bf16 v[28:31], v[76:79], v[240:247], v0
ds_read_b128 v[48:51], v2 offset:13312
v_smfmac_f32_16x16x64_bf16 v[28:31], v[64:67], a[0:7], v0
v_add_f32 v24, v24, v26
v_add_f32 v25, v25, v27
v_cvt_pk_bf16_f32 v23, v24, v25
v_smfmac_f32_16x16x64_bf16 v[28:31], v[68:71], a[16:23], v0
ds_write_b64 v3, v[22:23] offset:11776
v_smfmac_f32_16x16x64_bf16 v[28:31], v[72:75], a[32:39], v0
s_waitcnt lgkmcnt(1)
v_smfmac_f32_16x16x64_bf16 v[28:31], v[60:63], v[44:51], v0
ds_read_b128 v[44:47], v2 offset:14336
v_smfmac_f32_16x16x64_bf16 v[32:35], v[76:79], v[248:255], v0
ds_read_b128 v[48:51], v2 offset:15360
v_smfmac_f32_16x16x64_bf16 v[32:35], v[64:67], a[8:15], v0
v_add_f32 v28, v28, v30
s_waitcnt lgkmcnt(2)
s_barrier
v_smfmac_f32_16x16x64_bf16 v[32:35], v[68:71], a[24:31], v0
ds_read_b64_tr_b16 v[20:21], v4 offset:10240
ds_read_b64_tr_b16 v[22:23], v4 offset:10752
v_add_f32 v29, v29, v31
v_smfmac_f32_16x16x64_bf16 v[32:35], v[72:75], a[40:47], v0
ds_read_b64_tr_b16 v[24:25], v4 offset:11264
ds_read_b64_tr_b16 v[26:27], v4 offset:11776
v_cvt_pk_bf16_f32 v30, v28, v29
s_waitcnt lgkmcnt(4)
v_smfmac_f32_16x16x64_bf16 v[32:35], v[60:63], v[44:51], v0
ds_read_b128 v[44:47], v2 offset:18432
s_waitcnt vmcnt(3)
s_waitcnt lgkmcnt(3)
v_mfma_f32_16x16x32_bf16 v[12:15], v[12:15], v[20:23], 0
ds_read_b128 v[48:51], v2 offset:19456
s_waitcnt lgkmcnt(2)
v_mfma_f32_16x16x32_bf16 v[12:15], v[16:19], v[24:27], v[12:15]
v_add_f32 v32, v32, v34
v_add_f32 v33, v33, v35
v_cvt_pk_bf16_f32 v31, v32, v33
ds_write_b64 v3, v[30:31] offset:13824
v_smfmac_f32_16x16x64_bf16 v[36:39], v[76:79], a[112:119], v0
s_nop 2
v_add_f32_dpp v12, v14, v12 quad_perm:[2,3,0,1] row_mask:0xf bank_mask:0xf
v_add_f32_dpp v13, v15, v13 quad_perm:[2,3,0,1] row_mask:0xf bank_mask:0xf
v_exp_f32 v14, v12
v_exp_f32 v15, v13
v_smfmac_f32_16x16x64_bf16 v[40:43], v[76:79], a[120:127], v0
v_cvt_pk_bf16_f32 v14, v14, v15
ds_write_b32 v5, v14 offset:15136
s_waitcnt lgkmcnt(1)
s_barrier
ds_read_b64_tr_b16 v[28:29], v4 offset:12288
v_smfmac_f32_16x16x64_bf16 v[36:39], v[60:63], a[128:135], v0
ds_read_b64_tr_b16 v[30:31], v4 offset:12800
ds_read_b64_tr_b16 v[32:33], v4 offset:13312
v_smfmac_f32_16x16x64_bf16 v[40:43], v[60:63], a[136:143], v0
ds_read_b64_tr_b16 v[34:35], v4 offset:13824
v_mov_b64 v[76:77], s[52:53]
v_smfmac_f32_16x16x64_bf16 v[40:43], v[72:75], v[44:51], v0
ds_read_b128 v[44:47], v2 offset:16384
v_mov_b64 v[78:79], s[52:53]
s_waitcnt lgkmcnt(3)
v_mfma_f32_16x16x32_bf16 v[28:31], v[28:31], v[20:23], 0
s_barrier
ds_read_b128 v[16:19], v1 offset:14368
s_waitcnt lgkmcnt(2)
v_mfma_f32_16x16x32_bf16 v[28:31], v[32:35], v[24:27], v[28:31]
ds_read_b128 v[60:63], v1 offset:14336
v_smfmac_f32_16x16x64_bf16 v[40:43], v[64:67], a[152:159], v0
ds_read_b128 v[48:51], v2 offset:17408
v_mov_b64 v[14:15], s[0:1]
v_smfmac_f32_16x16x64_bf16 v[40:43], v[68:71], a[168:175], v0
v_add_f32_dpp v28, v30, v28 quad_perm:[2,3,0,1] row_mask:0xf bank_mask:0xf
v_smfmac_f32_16x16x64_bf16 v[36:39], v[64:67], a[144:151], v0
ds_read_b128 v[64:67], v2 offset:25600
v_add_f32_dpp v29, v31, v29 quad_perm:[2,3,0,1] row_mask:0xf bank_mask:0xf
v_smfmac_f32_16x16x64_bf16 v[36:39], v[68:71], a[160:167], v0
ds_read_b128 v[68:71], v2 offset:22528
v_mul_f32 v28, s50, v28
s_waitcnt lgkmcnt(2)
v_smfmac_f32_16x16x64_bf16 v[36:39], v[72:75], v[44:51], v0
ds_read_b128 v[72:75], v2 offset:23552
v_mul_f32 v29, s50, v29
s_waitcnt vmcnt(1)
v_mfma_f32_16x16x32_bf16 v[32:35], v[76:79], v[16:19], 0
v_exp_f32 v30, v28
v_mfma_f32_16x16x32_bf16 v[20:23], v[52:55], v[16:19], 0
v_exp_f32 v31, v29
v_mfma_f32_16x16x32_bf16 v[20:23], v[56:59], v[60:63], v[20:23]
v_cvt_pk_bf16_f32 v30, v30, v31
v_cndmask_b32_e64 v24, 0, v30, s[56:57]
v_cndmask_b32_e64 v25, 0, v30, s[56:57]
v_cvt_pk_bf16_f32 v36, v36, v37
v_cvt_pk_bf16_f32 v37, v38, v39
v_mfma_f32_16x16x16_bf16 v[32:35], v[14:15], v[24:25], v[32:35]
v_cvt_pk_bf16_f32 v38, v40, v41
v_cvt_pk_bf16_f32 v39, v42, v43
v_mov_b32_dpp v26, v24 quad_perm:[2,3,0,1] row_mask:0xf bank_mask:0xf
v_mov_b32_dpp v27, v24 quad_perm:[2,3,0,1] row_mask:0xf bank_mask:0xf
ds_read_b128 v[44:47], v2 offset:20480
s_nop 0
v_mfma_f32_16x16x32_bf16 v[20:23], v[36:39], v[24:27], v[20:23]
ds_read_b128 v[48:51], v2 offset:21504
v_rcp_f32 v33, v32
ds_read_b128 v[60:63], v2 offset:24576
v_min_f32 v32, v32, v33
v_cmp_nlt_f32 vcc, s2, v32
v_mov_b64 v[76:77], 0
v_mov_b64 v[78:79], 0
v_mov_b64 v[40:41], 0
v_mul_f32_dpp v20, v33, v20 quad_perm:[0,1,0,1] row_mask:0xf bank_mask:0xf
v_mul_f32_dpp v21, v33, v21 quad_perm:[0,1,0,1] row_mask:0xf bank_mask:0xf
v_mul_f32_dpp v22, v33, v22 quad_perm:[0,1,0,1] row_mask:0xf bank_mask:0xf
v_mul_f32_dpp v23, v33, v23 quad_perm:[0,1,0,1] row_mask:0xf bank_mask:0xf
v_cvt_pk_bf16_f32 v20, v20, v21
v_cvt_pk_bf16_f32 v21, v22, v23
ds_write_b64 v6, v[20:21] offset:8192
v_mov_b64 v[42:43], 0
ds_read_b128 v[16:19], v7 offset:8192
s_and_b64 vcc, vcc, s[56:57]
v_mov_b64 v[24:25], 0
v_mov_b64 v[26:27], 0
s_cbranch_scc1 L_mx_w3rs
L_mxb_w3rs:
v_mov_b64 v[32:33], 0
v_mov_b64 v[34:35], 0
v_mov_b64 v[28:29], 0
v_mov_b64 v[30:31], 0
s_waitcnt lgkmcnt(1)
s_barrier
ds_read_b128 v[12:15], v7 offset:5120
s_waitcnt lgkmcnt(1)
v_smfmac_f32_16x16x64_bf16 v[76:79], v[16:19], a[176:183], v0 abid:1
ds_read_b128 v[52:55], v7 offset:6144
ds_read_b128 v[56:59], v7 offset:7168
v_smfmac_f32_16x16x64_bf16 v[40:43], v[16:19], a[184:191], v0 abid:1
s_waitcnt lgkmcnt(2)
v_smfmac_f32_16x16x64_bf16 v[76:79], v[12:15], v[44:51], v0 abid:1
ds_read_b128 v[44:47], v2 offset:26624
v_smfmac_f32_16x16x64_bf16 v[40:43], v[12:15], v[60:67], v0 abid:1
ds_read_b128 v[48:51], v2 offset:27648
s_waitcnt lgkmcnt(3)
v_smfmac_f32_16x16x64_bf16 v[76:79], v[52:55], a[192:199], v0 abid:1
ds_read_b128 v[60:63], v2 offset:28672
v_smfmac_f32_16x16x64_bf16 v[40:43], v[52:55], a[200:207], v0 abid:1
ds_read_b128 v[64:67], v2 offset:29696
s_waitcnt lgkmcnt(4)
v_smfmac_f32_16x16x64_bf16 v[76:79], v[56:59], v[68:75], v0 abid:1
ds_read_b128 v[68:71], v2 offset:30720
s_waitcnt lgkmcnt(3)
v_smfmac_f32_16x16x64_bf16 v[40:43], v[56:59], v[44:51], v0 abid:1
ds_read_b128 v[72:75], v2 offset:31744
v_smfmac_f32_16x16x64_bf16 v[24:27], v[16:19], a[208:215], v0 abid:1
v_cvt_pk_bf16_f32 v76, v76, v77
v_cvt_pk_bf16_f32 v77, v78, v79
v_bfi_b32 v76, 1, s35, v76
buffer_store_dwordx2 v[76:77], v8, s[4:7], s42 offen sc0 sc1
s_waitcnt lgkmcnt(2)
v_smfmac_f32_16x16x64_bf16 v[24:27], v[12:15], v[60:67], v0 abid:1
v_cvt_pk_bf16_f32 v40, v40, v41
v_cvt_pk_bf16_f32 v41, v42, v43
v_bfi_b32 v40, 1, s35, v40
buffer_store_dwordx2 v[40:41], v8, s[4:7], s43 offen sc0 sc1
v_smfmac_f32_16x16x64_bf16 v[24:27], v[52:55], a[216:223], v0 abid:1
s_waitcnt lgkmcnt(0)
v_smfmac_f32_16x16x64_bf16 v[24:27], v[56:59], v[68:75], v0 abid:1
v_smfmac_f32_16x16x64_bf16 v[32:35], v[16:19], a[224:231], v0 abid:1
v_smfmac_f32_16x16x64_bf16 v[32:35], v[12:15], a[232:239], v0 abid:1
v_cvt_pk_bf16_f32 v24, v24, v25
v_cvt_pk_bf16_f32 v25, v26, v27
v_bfi_b32 v24, 1, s35, v24
buffer_store_dwordx2 v[24:25], v8, s[4:7], s44 offen sc0 sc1
v_smfmac_f32_16x16x64_bf16 v[32:35], v[52:55], a[240:247], v0 abid:1
v_smfmac_f32_16x16x64_bf16 v[32:35], v[56:59], a[248:255], v0 abid:1
s_nop 7
v_cvt_pk_bf16_f32 v32, v32, v33
v_cvt_pk_bf16_f32 v33, v34, v35
v_bfi_b32 v32, 1, s35, v32
buffer_store_dwordx2 v[32:33], v8, s[4:7], s45 offen sc0 sc1
s_branch L_ex_w3rs
L_pro_w2r:
v_and_b32 v20, 63, v0
v_and_b32 v21, 15, v0
v_bfe_u32 v22, v0, 4, 2
v_lshlrev_b32 v1, 4, v20
v_add_u32 v2, 98304, v1
v_lshrrev_b32 v24, 1, v22
v_and_b32 v23, 1, v22
v_lshl_add_u32 v23, v24, 3, v23
v_lshlrev_b32 v23, 13, v23
v_lshlrev_b32 v26, 1, v22
v_xor_b32 v26, v26, v21
v_lshl_add_u32 v26, v26, 4, v23
v_xor_b32 v27, 128, v26
v_and_b32 v23, 1, v22
v_lshl_add_u32 v23, v24, 4, v23
v_mul_u32_u24 v23, 1152, v23
v_lshlrev_b32 v28, 2, v22
v_xor_b32 v28, v28, v21
v_lshl_add_u32 v28, v28, 4, v23
s_lshl_b32 s54, s32, 8
s_mul_i32 s55, s32, 147456
s_waitcnt lgkmcnt(0)
s_add_u32 s56, s54, 786432
s_mov_b32 m0, 118784
s_nop 0
buffer_load_dwordx4 v26, s[8:11], s56 offen lds
s_add_u32 s56, s54, 802816
s_mov_b32 m0, 119808
s_nop 0
buffer_load_dwordx4 v26, s[8:11], s56 offen lds
s_add_u32 s56, s54, 819200
s_mov_b32 m0, 120832
s_nop 0
buffer_load_dwordx4 v27, s[8:11], s56 offen lds
s_add_u32 s56, s54, 835584
s_mov_b32 m0, 121856
s_nop 0
buffer_load_dwordx4 v27, s[8:11], s56 offen lds
s_add_u32 s56, s54, 1310720
s_mov_b32 m0, 122880
s_nop 0
buffer_load_dwordx4 v26, s[8:11], s56 offen lds
s_add_u32 s56, s54, 1327104
s_mov_b32 m0, 123904
s_nop 0
buffer_load_dwordx4 v26, s[8:11], s56 offen lds
s_add_u32 s56, s54, 1343488
s_mov_b32 m0, 124928
s_nop 0
buffer_load_dwordx4 v27, s[8:11], s56 offen lds
s_add_u32 s56, s54, 1359872
s_mov_b32 m0, 125952
s_nop 0
buffer_load_dwordx4 v27, s[8:11], s56 offen lds
v_and_b32 v23, 1, v22
v_lshrrev_b32 v24, 2, v21
v_lshl_add_u32 v23, v23, 2, v24
v_lshlrev_b32 v23, 1, v23
v_bfe_u32 v44, v21, 1, 1
v_add_u32 v44, 8, v44
v_xor_b32 v44, v44, v23
v_lshlrev_b32 v44, 4, v44
v_lshl_add_u32 v44, v24, 8, v44
v_and_b32 v23, 1, v22
v_lshl_add_u32 v44, v23, 11, v44
v_and_b32 v23, 1, v21
v_lshl_add_u32 v44, v23, 3, v44
v_lshrrev_b32 v23, 1, v22
v_mul_u32_u24 v23, 40960, v23
v_add_u32 v23, 16384, v23
v_add_u32 v44, v44, v23
v_and_b32 v23, 1, v22
v_lshrrev_b32 v24, 2, v21
v_lshl_add_u32 v23, v23, 2, v24
v_lshlrev_b32 v23, 1, v23
v_bfe_u32 v45, v21, 1, 1
v_add_u32 v45, 10, v45
v_xor_b32 v45, v45, v23
v_lshlrev_b32 v45, 4, v45
v_lshl_add_u32 v45, v24, 8, v45
v_and_b32 v23, 1, v22
v_lshl_add_u32 v45, v23, 11, v45
v_and_b32 v23, 1, v21
v_lshl_add_u32 v45, v23, 3, v45
v_lshrrev_b32 v23, 1, v22
v_mul_u32_u24 v23, 40960, v23
v_add_u32 v23, 16384, v23
v_add_u32 v45, v45, v23
v_and_b32 v23, 1, v22
v_lshrrev_b32 v24, 2, v21
v_lshl_add_u32 v23, v23, 2, v24
v_lshlrev_b32 v23, 1, v23
v_bfe_u32 v46, v21, 1, 1
v_add_u32 v46, 8, v46
v_xor_b32 v46, v46, v23
v_lshlrev_b32 v46, 4, v46
v_lshl_add_u32 v46, v24, 8, v46
v_and_b32 v23, 1, v22
v_lshl_add_u32 v46, v23, 11, v46
v_and_b32 v23, 1, v21
v_lshl_add_u32 v46, v23, 3, v46
v_lshrrev_b32 v23, 1, v22
v_mul_u32_u24 v23, 32768, v23
v_add_u32 v23, 98304, v23
v_add_u32 v46, v46, v23
v_and_b32 v23, 1, v22
v_lshrrev_b32 v24, 2, v21
v_lshl_add_u32 v23, v23, 2, v24
v_lshlrev_b32 v23, 1, v23
v_bfe_u32 v47, v21, 1, 1
v_add_u32 v47, 10, v47
v_xor_b32 v47, v47, v23
v_lshlrev_b32 v47, 4, v47
v_lshl_add_u32 v47, v24, 8, v47
v_and_b32 v23, 1, v22
v_lshl_add_u32 v47, v23, 11, v47
v_and_b32 v23, 1, v21
v_lshl_add_u32 v47, v23, 3, v47
v_lshrrev_b32 v23, 1, v22
v_mul_u32_u24 v23, 32768, v23
v_add_u32 v23, 98304, v23
v_add_u32 v47, v47, v23
v_and_b32 v23, 1, v22
v_bfe_u32 v24, v21, 2, 1
v_lshl_add_u32 v23, v23, 1, v24
v_xor_b32 v24, 2, v23
v_lshlrev_b32 v24, 6, v24
v_lshl_add_u32 v48, v23, 8, v24
v_and_b32 v23, 3, v21
v_lshl_add_u32 v48, v23, 4, v48
v_and_b32 v23, 8, v21
v_add_u32 v48, v48, v23
v_lshrrev_b32 v23, 1, v22
v_mul_u32_u24 v23, 40960, v23
v_add_u32 v23, 16384, v23
v_add_u32 v48, v48, v23
v_and_b32 v23, 1, v22
v_bfe_u32 v24, v21, 2, 1
v_lshl_add_u32 v23, v23, 1, v24
v_xor_b32 v24, 2, v23
v_lshlrev_b32 v24, 6, v24
v_lshl_add_u32 v49, v23, 8, v24
v_and_b32 v23, 3, v21
v_lshl_add_u32 v49, v23, 4, v49
v_and_b32 v23, 8, v21
v_add_u32 v49, v49, v23
v_lshrrev_b32 v23, 1, v22
v_mul_u32_u24 v23, 32768, v23
v_add_u32 v23, 98304, v23
v_add_u32 v49, v49, v23
v_bfe_u32 v23, v21, 1, 1
v_and_b32 v24, 1, v21
v_lshl_add_u32 v23, v24, 16, v23
v_mul_u32_u24 v23, 0xaaaa, v23
v_add_u32 v0, 0x44444444, v23
v_lshlrev_b32 v3, 3, v20
v_lshrrev_b32 v25, 5, v20
v_lshlrev_b32 v25, 6, v25
v_xor_b32 v3, v3, v25
v_lshrrev_b32 v25, 2, v20
v_and_b32 v4, 3, v21
v_lshl_add_u32 v4, v4, 4, v25
v_lshlrev_b32 v4, 3, v4
v_bfe_u32 v25, v21, 1, 1
v_lshlrev_b32 v23, 6, v25
v_xor_b32 v4, v4, v23
v_lshlrev_b32 v5, 4, v21
v_lshl_add_u32 v5, v22, 2, v5
v_mul_u32_u24 v23, 512, v25
v_add_u32 v5, v5, v23
v_lshlrev_b32 v9, 8, v22
v_lshl_add_u32 v9, v25, 6, v9
v_bfe_u32 v23, v21, 3, 1
v_lshl_add_u32 v9, v23, 7, v9
v_bfe_u32 v23, v21, 2, 1
v_lshl_add_u32 v9, v23, 5, v9
v_and_b32 v23, 1, v21
v_lshl_add_u32 v9, v23, 4, v9
v_lshrrev_b32 v23, 1, v22
v_and_b32 v24, 1, v22
v_and_b32 v25, 7, v21
v_lshrrev_b32 v7, 3, v21
v_lshl_add_u32 v8, v7, 1, v23
v_lshlrev_b32 v8, 12, v8
v_lshl_add_u32 v8, v24, 7, v8
v_and_b32 v25, 4, v21
v_lshl_add_u32 v8, v25, 3, v8
v_and_b32 v25, 1, v21
v_lshl_add_u32 v8, v25, 4, v8
v_bfe_u32 v25, v21, 1, 1
v_lshl_add_u32 v8, v25, 3, v8
s_lshr_b32 s56, s32, 1
s_lshl_b32 s56, s56, 8
s_and_b32 s57, s32, 1
s_lshl_b32 s57, s57, 6
s_add_u32 s56, s56, s57
s_add_u32 s56, s56, 32768
v_add_u32 v8, s56, v8
v_and_b32 v7, 12, v21
v_bfe_u32 v25, v21, 1, 1
v_add_u32 v7, v7, v25
v_lshlrev_b32 v7, 4, v7
v_lshl_add_u32 v7, v22, 8, v7
s_mov_b32 s42, 0
s_mov_b32 s43, 65536
s_mov_b32 s44, 131072
s_mov_b32 s45, 196608
s_mov_b32 s46, 262144
s_mov_b32 s47, 294912
s_mov_b32 s48, 299008
s_mov_b32 s49, 303104
s_mov_b32 s50, 0x3e0293ee
s_mov_b32 s51, 0x3e0293ee
s_mov_b32 s52, 0x3f803f80
s_mov_b32 s53, 0x3f803f80
v_and_b32 v11, 3, v21
v_cmp_eq_u32 vcc, 0, v11
s_nop 1
v_cndmask_b32 v11, 0, 1, vcc
s_mov_b32 s34, 0
s_mov_b32 s35, -1
s_mov_b32 s36, 0
s_mov_b32 s41, 300000
s_lshl_b32 s37, s32, 14
s_add_u32 s39, s37, 17301504
s_add_u32 s37, s37, 16785408
s_mov_b32 s40, 8749056
v_mov_b64 v[36:37], 0
v_mov_b64 v[38:39], 0
s_lshl_b32 s56, s32, 1
s_add_u32 s56, s56, 1
s_cmp_eq_u32 s56, 0
s_cselect_b32 s56, 64, s56
s_mul_i32 s56, s56, 10240
s_add_u32 s56, s56, 8388608
s_add_u32 s57, s56, 4096
v_mov_b32 v40, 1
v_mov_b32 v41, 1
v_mov_b32 v42, 1
v_mov_b32 v43, 1
buffer_store_dwordx4 v[40:43], v1, s[4:7], s56 offen offset:0 sc0 sc1
buffer_store_dwordx4 v[40:43], v1, s[4:7], s56 offen offset:1024 sc0 sc1
buffer_store_dwordx4 v[40:43], v1, s[4:7], s56 offen offset:2048 sc0 sc1
buffer_store_dwordx4 v[40:43], v1, s[4:7], s56 offen offset:3072 sc0 sc1
s_add_u32 s56, s32, 0
s_lshl_b32 s3, s56, 12
v_and_b32 v23, 1, v21
v_bfe_u32 v24, v21, 2, 1
v_bfe_u32 v25, v21, 1, 1
s_lshl_b32 s57, s56, 7
s_add_u32 s57, s57, 294912
v_and_b32 v10, 7, v21
v_lshlrev_b32 v10, 2, v10
v_lshl_add_u32 v10, v22, 5, v10
v_add_u32 v10, s57, v10
s_lshl_b32 s33, s56, 2
s_add_u32 s33, s33, 304128
v_mov_b32 v30, -1
s_mov_b64 exec, 1
buffer_store_dword v30, v1, s[4:7], s33 offen sc0 sc1
s_mov_b64 exec, -1
v_lshl_add_u32 v23, v23, 1, v24
v_lshlrev_b32 v25, 4, v25
v_mov_b32 v24, 0x3f80
v_lshlrev_b32 v24, v25, v24
v_cmp_eq_u32 vcc, 0, v23
s_nop 1
v_cndmask_b32 v76, 0, v24, vcc
v_cmp_eq_u32 vcc, 1, v23
s_nop 1
v_cndmask_b32 v77, 0, v24, vcc
v_cmp_eq_u32 vcc, 2, v23
s_nop 1
v_cndmask_b32 v78, 0, v24, vcc
v_cmp_eq_u32 vcc, 3, v23
s_nop 1
v_cndmask_b32 v79, 0, v24, vcc
v_and_b32 v23, 0x70, v1
ds_write_b128 v23, v[76:79] offset:256
buffer_store_dwordx4 v[36:39], v9, s[4:7], s3 offen offset:0 sc0 sc1
buffer_store_dwordx4 v[36:39], v9, s[4:7], s3 offen offset:1024 sc0 sc1
buffer_store_dwordx4 v[36:39], v9, s[4:7], s3 offen offset:2048 sc0 sc1
buffer_store_dwordx4 v[36:39], v9, s[4:7], s3 offen offset:3072 sc0 sc1
s_getreg_b32 s56, hwreg(HW_REG_XCC_ID)
s_and_b32 s56, s56, 15
s_mul_i32 s57, s56, s56
s_lshl_b32 s57, s57, 18
s_lshl_b32 s56, s56, 8
s_add_u32 s57, s57, s56
s_add_u32 s58, s57, 1
s_lshl_b32 s101, s32, 7
s_add_u32 s101, s101, 327680
v_mov_b32 v24, 0
s_add_u32 s56, s54, 2883584
s_mov_b32 m0, 126976
s_nop 0
buffer_load_dwordx4 v26, s[8:11], s56 offen lds
s_add_u32 s56, s54, 2899968
s_mov_b32 m0, 128000
s_nop 0
buffer_load_dwordx4 v26, s[8:11], s56 offen lds
s_add_u32 s56, s54, 2916352
s_mov_b32 m0, 129024
s_nop 0
buffer_load_dwordx4 v27, s[8:11], s56 offen lds
s_add_u32 s56, s54, 2932736
s_mov_b32 m0, 130048
s_nop 0
buffer_load_dwordx4 v27, s[8:11], s56 offen lds
s_add_u32 s56, s54, 3407872
s_mov_b32 m0, 98304
s_nop 0
buffer_load_dwordx4 v26, s[8:11], s56 offen lds
s_add_u32 s56, s54, 3424256
s_mov_b32 m0, 99328
s_nop 0
buffer_load_dwordx4 v26, s[8:11], s56 offen lds
s_add_u32 s56, s54, 3440640
s_mov_b32 m0, 100352
s_nop 0
buffer_load_dwordx4 v27, s[8:11], s56 offen lds
s_add_u32 s56, s54, 3457024
s_mov_b32 m0, 101376
s_nop 0
buffer_load_dwordx4 v27, s[8:11], s56 offen lds
s_add_u32 s56, s54, 3932160
s_mov_b32 m0, 102400
s_nop 0
buffer_load_dwordx4 v26, s[8:11], s56 offen lds
s_add_u32 s56, s54, 3948544
s_mov_b32 m0, 103424
s_nop 0
buffer_load_dwordx4 v26, s[8:11], s56 offen lds
s_add_u32 s56, s54, 3964928
s_mov_b32 m0, 104448
s_nop 0
buffer_load_dwordx4 v27, s[8:11], s56 offen lds
s_add_u32 s56, s54, 3981312
s_mov_b32 m0, 105472
s_nop 0
buffer_load_dwordx4 v27, s[8:11], s56 offen lds
s_add_u32 s56, s54, 4456448
s_mov_b32 m0, 106496
s_nop 0
buffer_load_dwordx4 v26, s[8:11], s56 offen lds
s_add_u32 s56, s54, 4472832
s_mov_b32 m0, 107520
s_nop 0
buffer_load_dwordx4 v26, s[8:11], s56 offen lds
s_add_u32 s56, s54, 4489216
s_mov_b32 m0, 108544
s_nop 0
buffer_load_dwordx4 v27, s[8:11], s56 offen lds
s_add_u32 s56, s54, 4505600
s_mov_b32 m0, 109568
s_nop 0
buffer_load_dwordx4 v27, s[8:11], s56 offen lds
s_add_u32 s56, s54, 262144
s_mov_b32 m0, 110592
s_nop 0
buffer_load_dwordx4 v26, s[12:15], s56 offen lds
s_add_u32 s56, s54, 278528
s_mov_b32 m0, 111616
s_nop 0
buffer_load_dwordx4 v26, s[12:15], s56 offen lds
s_add_u32 s56, s54, 294912
s_mov_b32 m0, 112640
s_nop 0
buffer_load_dwordx4 v27, s[12:15], s56 offen lds
s_add_u32 s56, s54, 311296
s_mov_b32 m0, 113664
s_nop 0
buffer_load_dwordx4 v27, s[12:15], s56 offen lds
s_add_u32 s56, s54, 786432
s_mov_b32 m0, 114688
s_nop 0
buffer_load_dwordx4 v26, s[12:15], s56 offen lds
s_add_u32 s56, s54, 802816
s_mov_b32 m0, 115712
s_nop 0
buffer_load_dwordx4 v26, s[12:15], s56 offen lds
s_add_u32 s56, s54, 819200
s_mov_b32 m0, 116736
s_nop 0
buffer_load_dwordx4 v27, s[12:15], s56 offen lds
s_add_u32 s56, s54, 835584
s_mov_b32 m0, 117760
s_nop 0
buffer_load_dwordx4 v27, s[12:15], s56 offen lds
v_mov_b32 v24, 0
s_waitcnt vmcnt(37)
s_barrier
ds_read_b64_tr_b16 v[80:81], v44 offset:20480
ds_read_b64_tr_b16 v[82:83], v44 offset:21504
ds_read_b64_tr_b16 v[84:85], v46 offset:20480
ds_read_b64_tr_b16 v[86:87], v46 offset:21504
ds_read_b64_tr_b16 v[88:89], v45 offset:20480
ds_read_b64_tr_b16 v[90:91], v45 offset:21504
ds_read_b64_tr_b16 v[92:93], v47 offset:20480
ds_read_b64_tr_b16 v[94:95], v47 offset:21504
s_waitcnt lgkmcnt(0)
s_waitcnt vmcnt(33)
s_barrier
s_add_u32 s56, s54, 1310720
s_mov_b32 m0, 118784
s_nop 0
buffer_load_dwordx4 v26, s[12:15], s56 offen lds
s_add_u32 s56, s54, 1327104
s_mov_b32 m0, 119808
s_nop 0
buffer_load_dwordx4 v26, s[12:15], s56 offen lds
s_add_u32 s56, s54, 1343488
s_mov_b32 m0, 120832
s_nop 0
buffer_load_dwordx4 v27, s[12:15], s56 offen lds
s_add_u32 s56, s54, 1359872
s_mov_b32 m0, 121856
s_nop 0
buffer_load_dwordx4 v27, s[12:15], s56 offen lds
ds_read_b64_tr_b16 v[96:97], v44 offset:24576
ds_read_b64_tr_b16 v[98:99], v44 offset:25600
ds_read_b64_tr_b16 v[100:101], v46 offset:24576
ds_read_b64_tr_b16 v[102:103], v46 offset:25600
ds_read_b64_tr_b16 v[104:105], v45 offset:24576
ds_read_b64_tr_b16 v[106:107], v45 offset:25600
ds_read_b64_tr_b16 v[108:109], v47 offset:24576
ds_read_b64_tr_b16 v[110:111], v47 offset:25600
s_waitcnt lgkmcnt(0)
s_waitcnt vmcnt(24)
s_barrier
s_add_u32 s56, s54, 1835008
s_mov_b32 m0, 122880
s_nop 0
buffer_load_dwordx4 v26, s[12:15], s56 offen lds
s_add_u32 s56, s54, 1851392
s_mov_b32 m0, 123904
s_nop 0
buffer_load_dwordx4 v26, s[12:15], s56 offen lds
s_add_u32 s56, s54, 1867776
s_mov_b32 m0, 124928
s_nop 0
buffer_load_dwordx4 v27, s[12:15], s56 offen lds
s_add_u32 s56, s54, 1884160
s_mov_b32 m0, 125952
s_nop 0
buffer_load_dwordx4 v27, s[12:15], s56 offen lds
ds_read_b64_tr_b16 v[112:113], v44 offset:28672
ds_read_b64_tr_b16 v[114:115], v44 offset:29696
ds_read_b64_tr_b16 v[116:117], v46 offset:28672
ds_read_b64_tr_b16 v[118:119], v46 offset:29696
ds_read_b64_tr_b16 v[120:121], v45 offset:28672
ds_read_b64_tr_b16 v[122:123], v45 offset:29696
ds_read_b64_tr_b16 v[124:125], v47 offset:28672
ds_read_b64_tr_b16 v[126:127], v47 offset:29696
s_waitcnt lgkmcnt(0)
s_waitcnt vmcnt(24)
s_barrier
s_add_u32 s56, s54, 2359296
s_mov_b32 m0, 126976
s_nop 0
buffer_load_dwordx4 v26, s[12:15], s56 offen lds
s_add_u32 s56, s54, 2375680
s_mov_b32 m0, 128000
s_nop 0
buffer_load_dwordx4 v26, s[12:15], s56 offen lds
s_add_u32 s56, s54, 2392064
s_mov_b32 m0, 129024
s_nop 0
buffer_load_dwordx4 v27, s[12:15], s56 offen lds
s_add_u32 s56, s54, 2408448
s_mov_b32 m0, 130048
s_nop 0
buffer_load_dwordx4 v27, s[12:15], s56 offen lds
ds_read_b64_tr_b16 v[128:129], v44 offset:0
ds_read_b64_tr_b16 v[130:131], v44 offset:1024
ds_read_b64_tr_b16 v[132:133], v46 offset:0
ds_read_b64_tr_b16 v[134:135], v46 offset:1024
ds_read_b64_tr_b16 v[136:137], v45 offset:0
ds_read_b64_tr_b16 v[138:139], v45 offset:1024
ds_read_b64_tr_b16 v[140:141], v47 offset:0
ds_read_b64_tr_b16 v[142:143], v47 offset:1024
s_waitcnt lgkmcnt(0)
s_waitcnt vmcnt(24)
s_barrier
s_add_u32 s56, s54, 3407872
s_mov_b32 m0, 98304
s_nop 0
buffer_load_dwordx4 v26, s[12:15], s56 offen lds
s_add_u32 s56, s54, 3424256
s_mov_b32 m0, 99328
s_nop 0
buffer_load_dwordx4 v26, s[12:15], s56 offen lds
s_add_u32 s56, s54, 3440640
s_mov_b32 m0, 100352
s_nop 0
buffer_load_dwordx4 v27, s[12:15], s56 offen lds
s_add_u32 s56, s54, 3457024
s_mov_b32 m0, 101376
s_nop 0
buffer_load_dwordx4 v27, s[12:15], s56 offen lds
ds_read_b64_tr_b16 v[144:145], v44 offset:4096
ds_read_b64_tr_b16 v[146:147], v44 offset:5120
ds_read_b64_tr_b16 v[148:149], v46 offset:4096
ds_read_b64_tr_b16 v[150:151], v46 offset:5120
ds_read_b64_tr_b16 v[152:153], v45 offset:4096
ds_read_b64_tr_b16 v[154:155], v45 offset:5120
ds_read_b64_tr_b16 v[156:157], v47 offset:4096
ds_read_b64_tr_b16 v[158:159], v47 offset:5120
s_waitcnt lgkmcnt(0)
s_waitcnt vmcnt(24)
s_barrier
s_add_u32 s56, s54, 3932160
s_mov_b32 m0, 102400
s_nop 0
buffer_load_dwordx4 v26, s[12:15], s56 offen lds
s_add_u32 s56, s54, 3948544
s_mov_b32 m0, 103424
s_nop 0
buffer_load_dwordx4 v26, s[12:15], s56 offen lds
s_add_u32 s56, s54, 3964928
s_mov_b32 m0, 104448
s_nop 0
buffer_load_dwordx4 v27, s[12:15], s56 offen lds
s_add_u32 s56, s54, 3981312
s_mov_b32 m0, 105472
s_nop 0
buffer_load_dwordx4 v27, s[12:15], s56 offen lds
ds_read_b64_tr_b16 v[160:161], v44 offset:8192
ds_read_b64_tr_b16 v[162:163], v44 offset:9216
ds_read_b64_tr_b16 v[164:165], v46 offset:8192
ds_read_b64_tr_b16 v[166:167], v46 offset:9216
ds_read_b64_tr_b16 v[168:169], v45 offset:8192
ds_read_b64_tr_b16 v[170:171], v45 offset:9216
ds_read_b64_tr_b16 v[172:173], v47 offset:8192
ds_read_b64_tr_b16 v[174:175], v47 offset:9216
s_waitcnt lgkmcnt(0)
s_waitcnt vmcnt(24)
s_barrier
s_add_u32 s56, s54, 4456448
s_mov_b32 m0, 106496
s_nop 0
buffer_load_dwordx4 v26, s[12:15], s56 offen lds
s_add_u32 s56, s54, 4472832
s_mov_b32 m0, 107520
s_nop 0
buffer_load_dwordx4 v26, s[12:15], s56 offen lds
s_add_u32 s56, s54, 4489216
s_mov_b32 m0, 108544
s_nop 0
buffer_load_dwordx4 v27, s[12:15], s56 offen lds
s_add_u32 s56, s54, 4505600
s_mov_b32 m0, 109568
s_nop 0
buffer_load_dwordx4 v27, s[12:15], s56 offen lds
ds_read_b64_tr_b16 v[176:177], v44 offset:12288
ds_read_b64_tr_b16 v[178:179], v44 offset:13312
ds_read_b64_tr_b16 v[180:181], v46 offset:12288
ds_read_b64_tr_b16 v[182:183], v46 offset:13312
ds_read_b64_tr_b16 v[184:185], v45 offset:12288
ds_read_b64_tr_b16 v[186:187], v45 offset:13312
ds_read_b64_tr_b16 v[188:189], v47 offset:12288
ds_read_b64_tr_b16 v[190:191], v47 offset:13312
s_waitcnt lgkmcnt(0)
s_waitcnt vmcnt(24)
s_barrier
s_add_u32 s56, s54, 262144
s_mov_b32 m0, 110592
s_nop 0
buffer_load_dwordx4 v26, s[16:19], s56 offen lds
s_add_u32 s56, s54, 278528
s_mov_b32 m0, 111616
s_nop 0
buffer_load_dwordx4 v26, s[16:19], s56 offen lds
s_add_u32 s56, s54, 294912
s_mov_b32 m0, 112640
s_nop 0
buffer_load_dwordx4 v27, s[16:19], s56 offen lds
s_add_u32 s56, s54, 311296
s_mov_b32 m0, 113664
s_nop 0
buffer_load_dwordx4 v27, s[16:19], s56 offen lds
ds_read_b64_tr_b16 v[192:193], v44 offset:16384
ds_read_b64_tr_b16 v[194:195], v44 offset:17408
ds_read_b64_tr_b16 v[196:197], v46 offset:16384
ds_read_b64_tr_b16 v[198:199], v46 offset:17408
ds_read_b64_tr_b16 v[200:201], v45 offset:16384
ds_read_b64_tr_b16 v[202:203], v45 offset:17408
ds_read_b64_tr_b16 v[204:205], v47 offset:16384
ds_read_b64_tr_b16 v[206:207], v47 offset:17408
s_waitcnt lgkmcnt(0)
s_waitcnt vmcnt(24)
s_barrier
s_add_u32 s56, s54, 786432
s_mov_b32 m0, 114688
s_nop 0
buffer_load_dwordx4 v26, s[16:19], s56 offen lds
s_add_u32 s56, s54, 802816
s_mov_b32 m0, 115712
s_nop 0
buffer_load_dwordx4 v26, s[16:19], s56 offen lds
s_add_u32 s56, s54, 819200
s_mov_b32 m0, 116736
s_nop 0
buffer_load_dwordx4 v27, s[16:19], s56 offen lds
s_add_u32 s56, s54, 835584
s_mov_b32 m0, 117760
s_nop 0
buffer_load_dwordx4 v27, s[16:19], s56 offen lds
ds_read_b64_tr_b16 v[208:209], v44 offset:20480
ds_read_b64_tr_b16 v[210:211], v44 offset:21504
ds_read_b64_tr_b16 v[212:213], v46 offset:20480
ds_read_b64_tr_b16 v[214:215], v46 offset:21504
ds_read_b64_tr_b16 v[216:217], v45 offset:20480
ds_read_b64_tr_b16 v[218:219], v45 offset:21504
ds_read_b64_tr_b16 v[220:221], v47 offset:20480
ds_read_b64_tr_b16 v[222:223], v47 offset:21504
s_waitcnt lgkmcnt(0)
s_waitcnt vmcnt(24)
s_barrier
s_add_u32 s56, s54, 1310720
s_mov_b32 m0, 118784
s_nop 0
buffer_load_dwordx4 v26, s[16:19], s56 offen lds
s_add_u32 s56, s54, 1327104
s_mov_b32 m0, 119808
s_nop 0
buffer_load_dwordx4 v26, s[16:19], s56 offen lds
s_add_u32 s56, s54, 1343488
s_mov_b32 m0, 120832
s_nop 0
buffer_load_dwordx4 v27, s[16:19], s56 offen lds
s_add_u32 s56, s54, 1359872
s_mov_b32 m0, 121856
s_nop 0
buffer_load_dwordx4 v27, s[16:19], s56 offen lds
ds_read_b64_tr_b16 v[224:225], v44 offset:24576
ds_read_b64_tr_b16 v[226:227], v44 offset:25600
ds_read_b64_tr_b16 v[228:229], v46 offset:24576
ds_read_b64_tr_b16 v[230:231], v46 offset:25600
ds_read_b64_tr_b16 v[232:233], v45 offset:24576
ds_read_b64_tr_b16 v[234:235], v45 offset:25600
ds_read_b64_tr_b16 v[236:237], v47 offset:24576
ds_read_b64_tr_b16 v[238:239], v47 offset:25600
s_waitcnt lgkmcnt(0)
s_waitcnt vmcnt(24)
s_barrier
s_add_u32 s56, s54, 1835008
s_mov_b32 m0, 122880
s_nop 0
buffer_load_dwordx4 v26, s[16:19], s56 offen lds
s_add_u32 s56, s54, 1851392
s_mov_b32 m0, 123904
s_nop 0
buffer_load_dwordx4 v26, s[16:19], s56 offen lds
s_add_u32 s56, s54, 1867776
s_mov_b32 m0, 124928
s_nop 0
buffer_load_dwordx4 v27, s[16:19], s56 offen lds
s_add_u32 s56, s54, 1884160
s_mov_b32 m0, 125952
s_nop 0
buffer_load_dwordx4 v27, s[16:19], s56 offen lds
ds_read_b64_tr_b16 v[240:241], v44 offset:28672
ds_read_b64_tr_b16 v[242:243], v44 offset:29696
ds_read_b64_tr_b16 v[244:245], v46 offset:28672
ds_read_b64_tr_b16 v[246:247], v46 offset:29696
ds_read_b64_tr_b16 v[248:249], v45 offset:28672
ds_read_b64_tr_b16 v[250:251], v45 offset:29696
ds_read_b64_tr_b16 v[252:253], v47 offset:28672
ds_read_b64_tr_b16 v[254:255], v47 offset:29696
s_waitcnt lgkmcnt(0)
s_waitcnt vmcnt(24)
s_barrier
s_add_u32 s56, s54, 2359296
s_mov_b32 m0, 126976
s_nop 0
buffer_load_dwordx4 v26, s[16:19], s56 offen lds
s_add_u32 s56, s54, 2375680
s_mov_b32 m0, 128000
s_nop 0
buffer_load_dwordx4 v26, s[16:19], s56 offen lds
s_add_u32 s56, s54, 2392064
s_mov_b32 m0, 129024
s_nop 0
buffer_load_dwordx4 v27, s[16:19], s56 offen lds
s_add_u32 s56, s54, 2408448
s_mov_b32 m0, 130048
s_nop 0
buffer_load_dwordx4 v27, s[16:19], s56 offen lds
ds_read_b64_tr_b16 a[0:1], v44 offset:0
ds_read_b64_tr_b16 a[2:3], v44 offset:1024
ds_read_b64_tr_b16 a[4:5], v46 offset:0
ds_read_b64_tr_b16 a[6:7], v46 offset:1024
ds_read_b64_tr_b16 a[8:9], v45 offset:0
ds_read_b64_tr_b16 a[10:11], v45 offset:1024
ds_read_b64_tr_b16 a[12:13], v47 offset:0
ds_read_b64_tr_b16 a[14:15], v47 offset:1024
s_waitcnt lgkmcnt(0)
s_waitcnt vmcnt(24)
s_barrier
s_add_u32 s56, s54, 2883584
s_mov_b32 m0, 98304
s_nop 0
buffer_load_dwordx4 v26, s[16:19], s56 offen lds
s_add_u32 s56, s54, 2899968
s_mov_b32 m0, 99328
s_nop 0
buffer_load_dwordx4 v26, s[16:19], s56 offen lds
s_add_u32 s56, s54, 2916352
s_mov_b32 m0, 100352
s_nop 0
buffer_load_dwordx4 v27, s[16:19], s56 offen lds
s_add_u32 s56, s54, 2932736
s_mov_b32 m0, 101376
s_nop 0
buffer_load_dwordx4 v27, s[16:19], s56 offen lds
ds_read_b64_tr_b16 a[16:17], v44 offset:4096
ds_read_b64_tr_b16 a[18:19], v44 offset:5120
ds_read_b64_tr_b16 a[20:21], v46 offset:4096
ds_read_b64_tr_b16 a[22:23], v46 offset:5120
ds_read_b64_tr_b16 a[24:25], v45 offset:4096
ds_read_b64_tr_b16 a[26:27], v45 offset:5120
ds_read_b64_tr_b16 a[28:29], v47 offset:4096
ds_read_b64_tr_b16 a[30:31], v47 offset:5120
s_waitcnt lgkmcnt(0)
s_waitcnt vmcnt(24)
s_barrier
s_add_u32 s56, s54, 3407872
s_mov_b32 m0, 102400
s_nop 0
buffer_load_dwordx4 v26, s[16:19], s56 offen lds
s_add_u32 s56, s54, 3424256
s_mov_b32 m0, 103424
s_nop 0
buffer_load_dwordx4 v26, s[16:19], s56 offen lds
s_add_u32 s56, s54, 3440640
s_mov_b32 m0, 104448
s_nop 0
buffer_load_dwordx4 v27, s[16:19], s56 offen lds
s_add_u32 s56, s54, 3457024
s_mov_b32 m0, 105472
s_nop 0
buffer_load_dwordx4 v27, s[16:19], s56 offen lds
ds_read_b64_tr_b16 a[32:33], v44 offset:8192
ds_read_b64_tr_b16 a[34:35], v44 offset:9216
ds_read_b64_tr_b16 a[36:37], v46 offset:8192
ds_read_b64_tr_b16 a[38:39], v46 offset:9216
ds_read_b64_tr_b16 a[40:41], v45 offset:8192
ds_read_b64_tr_b16 a[42:43], v45 offset:9216
ds_read_b64_tr_b16 a[44:45], v47 offset:8192
ds_read_b64_tr_b16 a[46:47], v47 offset:9216
s_waitcnt lgkmcnt(0)
s_waitcnt vmcnt(24)
s_barrier
s_add_u32 s56, s54, 3932160
s_mov_b32 m0, 106496
s_nop 0
buffer_load_dwordx4 v26, s[16:19], s56 offen lds
s_add_u32 s56, s54, 3948544
s_mov_b32 m0, 107520
s_nop 0
buffer_load_dwordx4 v26, s[16:19], s56 offen lds
s_add_u32 s56, s54, 3964928
s_mov_b32 m0, 108544
s_nop 0
buffer_load_dwordx4 v27, s[16:19], s56 offen lds
s_add_u32 s56, s54, 3981312
s_mov_b32 m0, 109568
s_nop 0
buffer_load_dwordx4 v27, s[16:19], s56 offen lds
ds_read_b64_tr_b16 a[48:49], v44 offset:12288
ds_read_b64_tr_b16 a[50:51], v44 offset:13312
ds_read_b64_tr_b16 a[52:53], v46 offset:12288
ds_read_b64_tr_b16 a[54:55], v46 offset:13312
ds_read_b64_tr_b16 a[56:57], v45 offset:12288
ds_read_b64_tr_b16 a[58:59], v45 offset:13312
ds_read_b64_tr_b16 a[60:61], v47 offset:12288
ds_read_b64_tr_b16 a[62:63], v47 offset:13312
s_waitcnt lgkmcnt(0)
s_waitcnt vmcnt(24)
s_barrier
s_add_u32 s56, s55, 110592
s_mov_b32 m0, 110592
s_nop 0
buffer_load_dwordx4 v28, s[20:23], s56 offen lds
s_add_u32 s56, s55, 112896
s_mov_b32 m0, 111616
s_nop 0
buffer_load_dwordx4 v28, s[20:23], s56 offen lds
s_add_u32 s56, s55, 119808
s_mov_b32 m0, 112640
s_nop 0
buffer_load_dwordx4 v28, s[20:23], s56 offen lds
s_add_u32 s56, s55, 122112
s_mov_b32 m0, 113664
s_nop 0
buffer_load_dwordx4 v28, s[20:23], s56 offen lds
ds_read_b64_tr_b16 a[64:65], v44 offset:16384
ds_read_b64_tr_b16 a[66:67], v44 offset:17408
ds_read_b64_tr_b16 a[68:69], v46 offset:16384
ds_read_b64_tr_b16 a[70:71], v46 offset:17408
ds_read_b64_tr_b16 a[72:73], v45 offset:16384
ds_read_b64_tr_b16 a[74:75], v45 offset:17408
ds_read_b64_tr_b16 a[76:77], v47 offset:16384
ds_read_b64_tr_b16 a[78:79], v47 offset:17408
s_waitcnt lgkmcnt(0)
s_waitcnt vmcnt(24)
s_barrier
s_add_u32 s56, s55, 110848
s_mov_b32 m0, 114688
s_nop 0
buffer_load_dwordx4 v28, s[20:23], s56 offen lds
s_add_u32 s56, s55, 113152
s_mov_b32 m0, 115712
s_nop 0
buffer_load_dwordx4 v28, s[20:23], s56 offen lds
s_add_u32 s56, s55, 120064
s_mov_b32 m0, 116736
s_nop 0
buffer_load_dwordx4 v28, s[20:23], s56 offen lds
s_add_u32 s56, s55, 122368
s_mov_b32 m0, 117760
s_nop 0
buffer_load_dwordx4 v28, s[20:23], s56 offen lds
ds_read_b64_tr_b16 a[80:81], v44 offset:20480
ds_read_b64_tr_b16 a[82:83], v44 offset:21504
ds_read_b64_tr_b16 a[84:85], v46 offset:20480
ds_read_b64_tr_b16 a[86:87], v46 offset:21504
ds_read_b64_tr_b16 a[88:89], v45 offset:20480
ds_read_b64_tr_b16 a[90:91], v45 offset:21504
ds_read_b64_tr_b16 a[92:93], v47 offset:20480
ds_read_b64_tr_b16 a[94:95], v47 offset:21504
s_waitcnt lgkmcnt(0)
s_waitcnt vmcnt(24)
s_barrier
s_add_u32 s56, s55, 111104
s_mov_b32 m0, 118784
s_nop 0
buffer_load_dwordx4 v28, s[20:23], s56 offen lds
s_add_u32 s56, s55, 113408
s_mov_b32 m0, 119808
s_nop 0
buffer_load_dwordx4 v28, s[20:23], s56 offen lds
s_add_u32 s56, s55, 120320
s_mov_b32 m0, 120832
s_nop 0
buffer_load_dwordx4 v28, s[20:23], s56 offen lds
s_add_u32 s56, s55, 122624
s_mov_b32 m0, 121856
s_nop 0
buffer_load_dwordx4 v28, s[20:23], s56 offen lds
ds_read_b64_tr_b16 a[96:97], v44 offset:24576
ds_read_b64_tr_b16 a[98:99], v44 offset:25600
ds_read_b64_tr_b16 a[100:101], v46 offset:24576
ds_read_b64_tr_b16 a[102:103], v46 offset:25600
ds_read_b64_tr_b16 a[104:105], v45 offset:24576
ds_read_b64_tr_b16 a[106:107], v45 offset:25600
ds_read_b64_tr_b16 a[108:109], v47 offset:24576
ds_read_b64_tr_b16 a[110:111], v47 offset:25600
s_waitcnt lgkmcnt(0)
s_waitcnt vmcnt(24)
s_barrier
s_add_u32 s56, s55, 111360
s_mov_b32 m0, 122880
s_nop 0
buffer_load_dwordx4 v28, s[20:23], s56 offen lds
s_add_u32 s56, s55, 113664
s_mov_b32 m0, 123904
s_nop 0
buffer_load_dwordx4 v28, s[20:23], s56 offen lds
s_add_u32 s56, s55, 120576
s_mov_b32 m0, 124928
s_nop 0
buffer_load_dwordx4 v28, s[20:23], s56 offen lds
s_add_u32 s56, s55, 122880
s_mov_b32 m0, 125952
s_nop 0
buffer_load_dwordx4 v28, s[20:23], s56 offen lds
ds_read_b64_tr_b16 a[112:113], v44 offset:28672
ds_read_b64_tr_b16 a[114:115], v44 offset:29696
ds_read_b64_tr_b16 a[116:117], v46 offset:28672
ds_read_b64_tr_b16 a[118:119], v46 offset:29696
ds_read_b64_tr_b16 a[120:121], v45 offset:28672
ds_read_b64_tr_b16 a[122:123], v45 offset:29696
ds_read_b64_tr_b16 a[124:125], v47 offset:28672
ds_read_b64_tr_b16 a[126:127], v47 offset:29696
s_waitcnt lgkmcnt(0)
s_waitcnt vmcnt(24)
s_barrier
s_add_u32 s56, s55, 74496
s_mov_b32 m0, 126976
s_nop 0
buffer_load_dwordx4 v28, s[20:23], s56 offen lds
s_add_u32 s56, s55, 76800
s_mov_b32 m0, 128000
s_nop 0
buffer_load_dwordx4 v28, s[20:23], s56 offen lds
s_add_u32 s56, s55, 83712
s_mov_b32 m0, 129024
s_nop 0
buffer_load_dwordx4 v28, s[20:23], s56 offen lds
s_add_u32 s56, s55, 86016
s_mov_b32 m0, 130048
s_nop 0
buffer_load_dwordx4 v28, s[20:23], s56 offen lds
ds_read_b64_tr_b16 a[128:129], v44 offset:0
ds_read_b64_tr_b16 a[130:131], v44 offset:1024
ds_read_b64_tr_b16 a[132:133], v46 offset:0
ds_read_b64_tr_b16 a[134:135], v46 offset:1024
ds_read_b64_tr_b16 a[136:137], v45 offset:0
ds_read_b64_tr_b16 a[138:139], v45 offset:1024
ds_read_b64_tr_b16 a[140:141], v47 offset:0
ds_read_b64_tr_b16 a[142:143], v47 offset:1024
buffer_load_dword v32, v24, s[28:31], 0 offen sc0 sc1
s_waitcnt lgkmcnt(0)
s_waitcnt vmcnt(25)
s_barrier
s_add_u32 s56, s54, 262144
s_mov_b32 m0, 98304
s_nop 0
buffer_load_dwordx4 v26, s[8:11], s56 offen lds
s_add_u32 s56, s54, 278528
s_mov_b32 m0, 99328
s_nop 0
buffer_load_dwordx4 v26, s[8:11], s56 offen lds
s_add_u32 s56, s54, 294912
s_mov_b32 m0, 100352
s_nop 0
buffer_load_dwordx4 v27, s[8:11], s56 offen lds
s_add_u32 s56, s54, 311296
s_mov_b32 m0, 101376
s_nop 0
buffer_load_dwordx4 v27, s[8:11], s56 offen lds
ds_read_b64_tr_b16 a[144:145], v44 offset:4096
ds_read_b64_tr_b16 a[146:147], v44 offset:5120
ds_read_b64_tr_b16 a[148:149], v46 offset:4096
ds_read_b64_tr_b16 a[150:151], v46 offset:5120
ds_read_b64_tr_b16 a[152:153], v45 offset:4096
ds_read_b64_tr_b16 a[154:155], v45 offset:5120
ds_read_b64_tr_b16 a[156:157], v47 offset:4096
ds_read_b64_tr_b16 a[158:159], v47 offset:5120
s_waitcnt lgkmcnt(0)
s_waitcnt vmcnt(25)
s_barrier
s_add_u32 s56, s54, 1835008
s_mov_b32 m0, 102400
s_nop 0
buffer_load_dwordx4 v26, s[8:11], s56 offen lds
s_add_u32 s56, s54, 1851392
s_mov_b32 m0, 103424
s_nop 0
buffer_load_dwordx4 v26, s[8:11], s56 offen lds
s_add_u32 s56, s54, 1867776
s_mov_b32 m0, 104448
s_nop 0
buffer_load_dwordx4 v27, s[8:11], s56 offen lds
s_add_u32 s56, s54, 1884160
s_mov_b32 m0, 105472
s_nop 0
buffer_load_dwordx4 v27, s[8:11], s56 offen lds
ds_read_b64_tr_b16 a[160:161], v44 offset:8192
ds_read_b64_tr_b16 a[162:163], v44 offset:9216
ds_read_b64_tr_b16 a[164:165], v46 offset:8192
ds_read_b64_tr_b16 a[166:167], v46 offset:9216
ds_read_b64_tr_b16 a[168:169], v45 offset:8192
ds_read_b64_tr_b16 a[170:171], v45 offset:9216
ds_read_b64_tr_b16 a[172:173], v47 offset:8192
ds_read_b64_tr_b16 a[174:175], v47 offset:9216
s_waitcnt lgkmcnt(0)
s_waitcnt vmcnt(25)
s_barrier
s_add_u32 s56, s54, 2359296
s_mov_b32 m0, 106496
s_nop 0
buffer_load_dwordx4 v26, s[8:11], s56 offen lds
s_add_u32 s56, s54, 2375680
s_mov_b32 m0, 107520
s_nop 0
buffer_load_dwordx4 v26, s[8:11], s56 offen lds
s_add_u32 s56, s54, 2392064
s_mov_b32 m0, 108544
s_nop 0
buffer_load_dwordx4 v27, s[8:11], s56 offen lds
s_add_u32 s56, s54, 2408448
s_mov_b32 m0, 109568
s_nop 0
buffer_load_dwordx4 v27, s[8:11], s56 offen lds
ds_read_b64_tr_b16 a[192:193], v48 offset:12288
ds_read_b64_tr_b16 a[194:195], v48 offset:13312
ds_read_b64_tr_b16 a[196:197], v48 offset:14336
ds_read_b64_tr_b16 a[198:199], v48 offset:15360
ds_read_b64_tr_b16 a[176:177], v49 offset:12288
ds_read_b64_tr_b16 a[178:179], v49 offset:13312
ds_read_b64_tr_b16 a[180:181], v49 offset:14336
ds_read_b64_tr_b16 a[182:183], v49 offset:15360
s_waitcnt lgkmcnt(0)
s_waitcnt vmcnt(25)
s_barrier
s_add_u32 s56, s54, 2883584
s_mov_b32 m0, 110592
s_nop 0
buffer_load_dwordx4 v26, s[12:15], s56 offen lds
s_add_u32 s56, s54, 2899968
s_mov_b32 m0, 111616
s_nop 0
buffer_load_dwordx4 v26, s[12:15], s56 offen lds
s_add_u32 s56, s54, 2916352
s_mov_b32 m0, 112640
s_nop 0
buffer_load_dwordx4 v27, s[12:15], s56 offen lds
s_add_u32 s56, s54, 2932736
s_mov_b32 m0, 113664
s_nop 0
buffer_load_dwordx4 v27, s[12:15], s56 offen lds
ds_read_b64_tr_b16 a[200:201], v48 offset:16384
ds_read_b64_tr_b16 a[202:203], v48 offset:17408
ds_read_b64_tr_b16 a[204:205], v48 offset:18432
ds_read_b64_tr_b16 a[206:207], v48 offset:19456
ds_read_b64_tr_b16 a[184:185], v49 offset:16384
ds_read_b64_tr_b16 a[186:187], v49 offset:17408
ds_read_b64_tr_b16 a[188:189], v49 offset:18432
ds_read_b64_tr_b16 a[190:191], v49 offset:19456
s_waitcnt lgkmcnt(0)
s_waitcnt vmcnt(25)
s_barrier
s_add_u32 s56, s54, 4456448
s_mov_b32 m0, 114688
s_nop 0
buffer_load_dwordx4 v26, s[16:19], s56 offen lds
s_add_u32 s56, s54, 4472832
s_mov_b32 m0, 115712
s_nop 0
buffer_load_dwordx4 v26, s[16:19], s56 offen lds
s_add_u32 s56, s54, 4489216
s_mov_b32 m0, 116736
s_nop 0
buffer_load_dwordx4 v27, s[16:19], s56 offen lds
s_add_u32 s56, s54, 4505600
s_mov_b32 m0, 117760
s_nop 0
buffer_load_dwordx4 v27, s[16:19], s56 offen lds
ds_read_b64_tr_b16 a[216:217], v48 offset:20480
ds_read_b64_tr_b16 a[218:219], v48 offset:21504
ds_read_b64_tr_b16 a[220:221], v48 offset:22528
ds_read_b64_tr_b16 a[222:223], v48 offset:23552
ds_read_b64_tr_b16 a[208:209], v49 offset:20480
ds_read_b64_tr_b16 a[210:211], v49 offset:21504
ds_read_b64_tr_b16 a[212:213], v49 offset:22528
ds_read_b64_tr_b16 a[214:215], v49 offset:23552
s_waitcnt lgkmcnt(0)
s_waitcnt vmcnt(25)
s_barrier
s_add_u32 s56, s55, 73728
s_mov_b32 m0, 118784
s_nop 0
buffer_load_dwordx4 v28, s[20:23], s56 offen lds
s_add_u32 s56, s55, 76032
s_mov_b32 m0, 119808
s_nop 0
buffer_load_dwordx4 v28, s[20:23], s56 offen lds
s_add_u32 s56, s55, 82944
s_mov_b32 m0, 120832
s_nop 0
buffer_load_dwordx4 v28, s[20:23], s56 offen lds
s_add_u32 s56, s55, 85248
s_mov_b32 m0, 121856
s_nop 0
buffer_load_dwordx4 v28, s[20:23], s56 offen lds
ds_read_b64_tr_b16 a[248:249], v48 offset:24576
ds_read_b64_tr_b16 a[250:251], v48 offset:25600
ds_read_b64_tr_b16 a[252:253], v48 offset:26624
ds_read_b64_tr_b16 a[254:255], v48 offset:27648
ds_read_b64_tr_b16 a[232:233], v49 offset:24576
ds_read_b64_tr_b16 a[234:235], v49 offset:25600
ds_read_b64_tr_b16 a[236:237], v49 offset:26624
ds_read_b64_tr_b16 a[238:239], v49 offset:27648
s_waitcnt lgkmcnt(0)
s_waitcnt vmcnt(25)
s_barrier
s_add_u32 s56, s55, 73984
s_mov_b32 m0, 122880
s_nop 0
buffer_load_dwordx4 v28, s[20:23], s56 offen lds
s_add_u32 s56, s55, 76288
s_mov_b32 m0, 123904
s_nop 0
buffer_load_dwordx4 v28, s[20:23], s56 offen lds
s_add_u32 s56, s55, 83200
s_mov_b32 m0, 124928
s_nop 0
buffer_load_dwordx4 v28, s[20:23], s56 offen lds
s_add_u32 s56, s55, 85504
s_mov_b32 m0, 125952
s_nop 0
buffer_load_dwordx4 v28, s[20:23], s56 offen lds
ds_read_b64_tr_b16 a[240:241], v48 offset:28672
ds_read_b64_tr_b16 a[242:243], v48 offset:29696
ds_read_b64_tr_b16 a[244:245], v48 offset:30720
ds_read_b64_tr_b16 a[246:247], v48 offset:31744
ds_read_b64_tr_b16 a[224:225], v49 offset:28672
ds_read_b64_tr_b16 a[226:227], v49 offset:29696
ds_read_b64_tr_b16 a[228:229], v49 offset:30720
ds_read_b64_tr_b16 a[230:231], v49 offset:31744
s_waitcnt lgkmcnt(0)
s_waitcnt vmcnt(24)
s_barrier
s_add_u32 s56, s55, 74240
s_mov_b32 m0, 126976
s_nop 0
buffer_load_dwordx4 v28, s[20:23], s56 offen lds
s_add_u32 s56, s55, 76544
s_mov_b32 m0, 128000
s_nop 0
buffer_load_dwordx4 v28, s[20:23], s56 offen lds
s_add_u32 s56, s55, 83456
s_mov_b32 m0, 129024
s_nop 0
buffer_load_dwordx4 v28, s[20:23], s56 offen lds
s_add_u32 s56, s55, 85760
s_mov_b32 m0, 130048
s_nop 0
buffer_load_dwordx4 v28, s[20:23], s56 offen lds
ds_read_b64_tr_b16 v[60:61], v44 offset:0
ds_read_b64_tr_b16 v[62:63], v44 offset:1024
ds_read_b64_tr_b16 v[64:65], v46 offset:0
ds_read_b64_tr_b16 v[66:67], v46 offset:1024
ds_read_b64_tr_b16 v[68:69], v45 offset:0
ds_read_b64_tr_b16 v[70:71], v45 offset:1024
ds_read_b64_tr_b16 v[72:73], v47 offset:0
ds_read_b64_tr_b16 v[74:75], v47 offset:1024
s_waitcnt lgkmcnt(0)
s_waitcnt vmcnt(24)
s_barrier
ds_write_b128 v2, v[60:63] offset:0
ds_write_b128 v2, v[64:67] offset:1024
ds_write_b128 v2, v[68:71] offset:2048
ds_write_b128 v2, v[72:75] offset:3072
ds_read_b64_tr_b16 v[60:61], v44 offset:4096
ds_read_b64_tr_b16 v[62:63], v44 offset:5120
ds_read_b64_tr_b16 v[64:65], v46 offset:4096
ds_read_b64_tr_b16 v[66:67], v46 offset:5120
ds_read_b64_tr_b16 v[68:69], v45 offset:4096
ds_read_b64_tr_b16 v[70:71], v45 offset:5120
ds_read_b64_tr_b16 v[72:73], v47 offset:4096
ds_read_b64_tr_b16 v[74:75], v47 offset:5120
L_rdv_w2r:
v_readfirstlane_b32 s38, v32
s_nop 0
s_and_b32 s57, s38, 0xff
s_cmp_lg_u32 s57, 32
s_cbranch_scc1 L_rdv2_w2r
s_waitcnt lgkmcnt(0)
s_waitcnt vmcnt(20)
s_barrier
ds_write_b128 v2, v[60:63] offset:4096
ds_write_b128 v2, v[64:67] offset:5120
ds_write_b128 v2, v[68:71] offset:6144
ds_write_b128 v2, v[72:75] offset:7168
ds_read_b64_tr_b16 v[60:61], v44 offset:8192
ds_read_b64_tr_b16 v[62:63], v44 offset:9216
ds_read_b64_tr_b16 v[64:65], v46 offset:8192
ds_read_b64_tr_b16 v[66:67], v46 offset:9216
ds_read_b64_tr_b16 v[68:69], v45 offset:8192
ds_read_b64_tr_b16 v[70:71], v45 offset:9216
ds_read_b64_tr_b16 v[72:73], v47 offset:8192
ds_read_b64_tr_b16 v[74:75], v47 offset:9216
buffer_load_dwordx4 v[12:15], v9, s[4:7], s37 offen offset:0
buffer_load_dwordx4 v[16:19], v9, s[4:7], s37 offen offset:1024
buffer_load_dwordx4 v[52:55], v1, s[4:7], s37 offen offset:2048
buffer_load_dwordx4 v[56:59], v1, s[4:7], s37 offen offset:3072
s_mov_b32 m0, 1024
s_nop 0
buffer_load_dwordx4 v1, s[4:7], s47 offen offset:2048 sc0 sc1 lds
s_waitcnt lgkmcnt(0)
s_waitcnt vmcnt(21)
s_barrier
ds_write_b128 v2, v[60:63] offset:8192
ds_write_b128 v2, v[64:67] offset:9216
ds_write_b128 v2, v[68:71] offset:10240
ds_write_b128 v2, v[72:75] offset:11264
ds_read_b64_tr_b16 v[60:61], v44 offset:12288
ds_read_b64_tr_b16 v[62:63], v44 offset:13312
ds_read_b64_tr_b16 v[64:65], v46 offset:12288
ds_read_b64_tr_b16 v[66:67], v46 offset:13312
ds_read_b64_tr_b16 v[68:69], v45 offset:12288
ds_read_b64_tr_b16 v[70:71], v45 offset:13312
ds_read_b64_tr_b16 v[72:73], v47 offset:12288
ds_read_b64_tr_b16 v[74:75], v47 offset:13312
s_waitcnt lgkmcnt(0)
s_waitcnt vmcnt(17)
s_barrier
ds_write_b128 v2, v[60:63] offset:12288
ds_write_b128 v2, v[64:67] offset:13312
ds_write_b128 v2, v[68:71] offset:14336
ds_write_b128 v2, v[72:75] offset:15360
ds_read_b64_tr_b16 v[60:61], v44 offset:16384
ds_read_b64_tr_b16 v[62:63], v44 offset:17408
ds_read_b64_tr_b16 v[64:65], v46 offset:16384
ds_read_b64_tr_b16 v[66:67], v46 offset:17408
ds_read_b64_tr_b16 v[68:69], v45 offset:16384
ds_read_b64_tr_b16 v[70:71], v45 offset:17408
ds_read_b64_tr_b16 v[72:73], v47 offset:16384
ds_read_b64_tr_b16 v[74:75], v47 offset:17408
s_waitcnt lgkmcnt(0)
s_waitcnt vmcnt(13)
s_barrier
ds_write_b128 v2, v[60:63] offset:16384
ds_write_b128 v2, v[64:67] offset:17408
ds_write_b128 v2, v[68:71] offset:18432
ds_write_b128 v2, v[72:75] offset:19456
ds_read_b64_tr_b16 v[60:61], v48 offset:20480
ds_read_b64_tr_b16 v[62:63], v48 offset:21504
ds_read_b64_tr_b16 v[64:65], v48 offset:22528
ds_read_b64_tr_b16 v[66:67], v48 offset:23552
ds_read_b64_tr_b16 v[68:69], v49 offset:20480
ds_read_b64_tr_b16 v[70:71], v49 offset:21504
ds_read_b64_tr_b16 v[72:73], v49 offset:22528
ds_read_b64_tr_b16 v[74:75], v49 offset:23552
s_waitcnt lgkmcnt(0)
s_waitcnt vmcnt(9)
s_barrier
ds_write_b128 v2, v[60:63] offset:20480
ds_write_b128 v2, v[64:67] offset:21504
ds_write_b128 v2, v[68:71] offset:22528
ds_write_b128 v2, v[72:75] offset:23552
ds_read_b64_tr_b16 v[60:61], v48 offset:24576
ds_read_b64_tr_b16 v[62:63], v48 offset:25600
ds_read_b64_tr_b16 v[64:65], v48 offset:26624
ds_read_b64_tr_b16 v[66:67], v48 offset:27648
ds_read_b64_tr_b16 v[68:69], v49 offset:24576
ds_read_b64_tr_b16 v[70:71], v49 offset:25600
ds_read_b64_tr_b16 v[72:73], v49 offset:26624
ds_read_b64_tr_b16 v[74:75], v49 offset:27648
s_waitcnt lgkmcnt(0)
s_waitcnt vmcnt(5)
s_barrier
ds_write_b128 v2, v[60:63] offset:24576
ds_write_b128 v2, v[64:67] offset:25600
ds_write_b128 v2, v[68:71] offset:26624
ds_write_b128 v2, v[72:75] offset:27648
ds_read_b64_tr_b16 v[60:61], v48 offset:28672
ds_read_b64_tr_b16 v[62:63], v48 offset:29696
ds_read_b64_tr_b16 v[64:65], v48 offset:30720
ds_read_b64_tr_b16 v[66:67], v48 offset:31744
ds_read_b64_tr_b16 v[68:69], v49 offset:28672
ds_read_b64_tr_b16 v[70:71], v49 offset:29696
ds_read_b64_tr_b16 v[72:73], v49 offset:30720
ds_read_b64_tr_b16 v[74:75], v49 offset:31744
s_waitcnt lgkmcnt(0)
s_barrier
ds_write_b128 v2, v[60:63] offset:28672
ds_write_b128 v2, v[64:67] offset:29696
ds_write_b128 v2, v[68:71] offset:30720
ds_write_b128 v2, v[72:75] offset:31744
s_lshl_b32 s57, s58, 5
s_mov_b32 s0, 0x3f003f00
s_mov_b32 s1, 0x3f003f00
s_mov_b32 s58, 304128
s_cmp_eq_u32 s38, s57
s_mov_b32 s56, 0x33333333
s_mov_b32 s57, 0x33333333
s_mov_b32 s2, 0x21800000
s_mov_b32 s55, -24
s_cbranch_scc0 L_slow_w2r
v_mov_b64 v[20:21], 0
v_mov_b64 v[22:23], 0
v_mov_b64 v[24:25], 0
v_mov_b64 v[26:27], 0
v_mov_b64 v[28:29], 0
v_mov_b64 v[30:31], 0
v_mov_b64 v[32:33], 0
v_mov_b64 v[34:35], 0
v_mov_b64 v[36:37], 0
v_mov_b64 v[38:39], 0
v_mov_b64 v[40:41], 0
v_mov_b64 v[42:43], 0
ds_read_b128 v[44:47], v2 offset:0
ds_read_b128 v[48:51], v2 offset:1024
v_bfe_u32 v77, v1, 6, 1
v_lshl_add_u32 v77, v77, 3, v1
v_lshlrev_b32 v77, 1, v77
s_waitcnt vmcnt(0) lgkmcnt(0)
s_branch L_top_w2rf
L_done_w2rf:
buffer_store_dword v11, v10, s[4:7], s40 offen sc0 sc1
s_waitcnt vmcnt(0) lgkmcnt(0)
s_endpgm
L_rdv2_w2r:
buffer_load_dword v32, v24, s[28:31], 0 offen sc0 sc1
s_sub_u32 s41, s41, 1
s_cbranch_scc1 L_exit
s_waitcnt vmcnt(0)
s_branch L_rdv_w2r
L_ra0_w2rf:
s_mov_b32 m0, 1024
s_nop 0
buffer_load_dwordx4 v1, s[4:7], s47 offen offset:0 sc1 lds
buffer_load_dwordx4 v1, s[4:7], s47 offen offset:1024 sc1 lds
buffer_load_dwordx4 v1, s[4:7], s47 offen offset:2048 sc1 lds
buffer_load_dwordx4 v1, s[4:7], s47 offen offset:3072 sc1 lds
s_sub_u32 s41, s41, 1
s_cbranch_scc1 L_exit
ds_read_b128 v[44:47], v2 offset:0
ds_read_b128 v[48:51], v2 offset:1024
v_mov_b64 v[20:21], 0
v_mov_b64 v[22:23], 0
v_mov_b64 v[24:25], 0
v_mov_b64 v[26:27], 0
v_mov_b64 v[28:29], 0
v_mov_b64 v[30:31], 0
v_mov_b64 v[32:33], 0
v_mov_b64 v[34:35], 0
v_mov_b64 v[36:37], 0
v_mov_b64 v[38:39], 0
v_mov_b64 v[40:41], 0
v_mov_b64 v[42:43], 0
s_waitcnt vmcnt(0)
ds_read_b128 v[60:63], v1 offset:1024
ds_read_b128 v[64:67], v1 offset:2048
ds_read_b128 v[68:71], v1 offset:3072
ds_read_b128 v[72:75], v1 offset:4096
s_branch L_s0_w2rf
L_ra1_w2rf:
s_waitcnt lgkmcnt(0)
s_barrier
s_mov_b32 m0, 5120
s_nop 0
buffer_load_dwordx4 v1, s[4:7], s48 offen offset:2048 sc1 lds
s_sub_u32 s41, s41, 1
s_cbranch_scc1 L_exit
s_waitcnt vmcnt(0)
s_barrier
ds_read_b128 v[76:79], v1 offset:5120
ds_read_b128 v[60:63], v1 offset:6144
ds_read_b128 v[64:67], v1 offset:7168
ds_read_b128 v[68:71], v1 offset:8192
ds_read_b128 v[72:75], v1 offset:9216
s_waitcnt lgkmcnt(0)
v_bitop3_b32 v6, v76, v60, s35 bitop3:0x7e
v_bitop3_b32 v6, v6, v64, s35 bitop3:0xf6
v_bitop3_b32 v6, v6, v68, s35 bitop3:0xf6
v_bitop3_b32 v6, v6, v72, s35 bitop3:0xf6
v_and_b32 v6, 1, v6
v_cmp_ne_u32 vcc, 0, v6
s_mov_b32 m0, 0
v_lshlrev_b32 v6, 3, v1
s_cbranch_vccnz L_ra1_w2rf
s_branch L_a1_w2rf
L_mx_w2rf:
s_waitcnt lgkmcnt(0)
v_max3_f32 v30, v12, v13, v28
v_max_f32 v30, v30, v29
v_mov_b32 v31, v30
s_nop 1
v_permlane16_swap_b32 v30, v31
v_max_f32 v30, v30, v31
v_mov_b32 v31, v30
s_nop 1
v_permlane32_swap_b32 v30, v31
v_max_f32 v30, v30, v31
ds_write_b32 v1, v30 offset:10248
s_waitcnt lgkmcnt(0)
s_barrier
ds_read_b128 v[32:35], v1 offset:10240
s_waitcnt lgkmcnt(0)
v_max3_f32 v32, v32, v33, v34
v_max_f32 v32, v32, v35
v_sub_f32 v14, v12, v32
v_sub_f32 v15, v13, v32
v_sub_f32 v30, v28, v32
v_sub_f32 v31, v29, v32
v_exp_f32 v14, v14
v_exp_f32 v15, v15
v_exp_f32 v30, v30
v_exp_f32 v31, v31
v_cvt_pk_bf16_f32 v14, v14, v15
v_cvt_pk_bf16_f32 v30, v30, v31
ds_write_b32 v5, v14 offset:14880
v_cndmask_b32_e64 v24, 0, v30, s[56:57]
v_cndmask_b32_e64 v25, 0, v30, s[56:57]
v_mov_b64 v[76:77], s[52:53]
v_mov_b64 v[78:79], s[52:53]
v_mov_b32_dpp v26, v24 quad_perm:[2,3,0,1] row_mask:0xf bank_mask:0xf
v_mov_b32_dpp v27, v24 quad_perm:[2,3,0,1] row_mask:0xf bank_mask:0xf
s_waitcnt lgkmcnt(0)
s_barrier
v_mov_b64 v[14:15], s[0:1]
ds_read_b128 v[16:19], v1 offset:14368
ds_read_b128 v[40:43], v1 offset:14336
s_waitcnt lgkmcnt(0)
v_mfma_f32_16x16x32_bf16 v[32:35], v[76:79], v[16:19], 0
v_mfma_f32_16x16x32_bf16 v[20:23], v[52:55], v[16:19], 0
v_mfma_f32_16x16x32_bf16 v[20:23], v[56:59], v[40:43], v[20:23]
v_mfma_f32_16x16x16_bf16 v[32:35], v[14:15], v[24:25], v[32:35]
v_mfma_f32_16x16x32_bf16 v[20:23], v[36:39], v[24:27], v[20:23]
s_nop 3
v_rcp_f32 v33, v32
s_nop 2
v_mul_f32_dpp v20, v33, v20 quad_perm:[0,1,0,1] row_mask:0xf bank_mask:0xf
v_mul_f32_dpp v21, v33, v21 quad_perm:[0,1,0,1] row_mask:0xf bank_mask:0xf
v_mul_f32_dpp v22, v33, v22 quad_perm:[0,1,0,1] row_mask:0xf bank_mask:0xf
v_mul_f32_dpp v23, v33, v23 quad_perm:[0,1,0,1] row_mask:0xf bank_mask:0xf
v_cvt_pk_bf16_f32 v20, v20, v21
v_cvt_pk_bf16_f32 v21, v22, v23
ds_write_b64 v6, v[20:21] offset:7168
ds_read_b128 v[16:19], v7 offset:7168
v_mov_b64 v[76:77], 0
v_mov_b64 v[78:79], 0
v_mov_b64 v[40:41], 0
v_mov_b64 v[42:43], 0
v_mov_b64 v[24:25], 0
v_mov_b64 v[26:27], 0
v_mov_b64 v[32:33], 0
v_mov_b64 v[34:35], 0
s_waitcnt lgkmcnt(0)
s_branch L_mxb_w2rf

L_rr_w2rf:
buffer_load_dwordx4 v[60:63], v9, s[4:7], s3 offen offset:0 sc1
buffer_load_dwordx4 v[64:67], v9, s[4:7], s3 offen offset:1024 sc1
buffer_load_dwordx4 v[68:71], v9, s[4:7], s3 offen offset:2048 sc1
buffer_load_dwordx4 v[72:75], v9, s[4:7], s3 offen offset:3072 sc1
s_sub_u32 s41, s41, 1
s_cbranch_scc1 L_exit
s_waitcnt vmcnt(0)
s_branch L_r_w2rf
L_slow_w2r:
v_mov_b64 v[20:21], 0
v_mov_b64 v[22:23], 0
v_mov_b64 v[24:25], 0
v_mov_b64 v[26:27], 0
v_mov_b64 v[28:29], 0
v_mov_b64 v[30:31], 0
v_mov_b64 v[32:33], 0
v_mov_b64 v[34:35], 0
v_mov_b64 v[36:37], 0
v_mov_b64 v[38:39], 0
v_mov_b64 v[40:41], 0
v_mov_b64 v[42:43], 0
ds_read_b128 v[44:47], v2 offset:0
ds_read_b128 v[48:51], v2 offset:1024
v_bfe_u32 v77, v1, 6, 1
v_lshl_add_u32 v77, v77, 3, v1
v_lshlrev_b32 v77, 1, v77
s_waitcnt vmcnt(0) lgkmcnt(0)
s_branch L_top_w2rs
L_done_w2rs:
buffer_store_dword v11, v10, s[4:7], s40 offen sc0 sc1
s_waitcnt vmcnt(0) lgkmcnt(0)
s_endpgm
L_ra0_w2rs:
s_mov_b32 m0, 1024
s_nop 0
buffer_load_dwordx4 v1, s[4:7], s47 offen offset:0 sc0 sc1 lds
buffer_load_dwordx4 v1, s[4:7], s47 offen offset:1024 sc0 sc1 lds
buffer_load_dwordx4 v1, s[4:7], s47 offen offset:2048 sc0 sc1 lds
buffer_load_dwordx4 v1, s[4:7], s47 offen offset:3072 sc0 sc1 lds
s_sub_u32 s41, s41, 1
s_cbranch_scc1 L_exit
ds_read_b128 v[44:47], v2 offset:0
ds_read_b128 v[48:51], v2 offset:1024
v_mov_b64 v[20:21], 0
v_mov_b64 v[22:23], 0
v_mov_b64 v[24:25], 0
v_mov_b64 v[26:27], 0
v_mov_b64 v[28:29], 0
v_mov_b64 v[30:31], 0
v_mov_b64 v[32:33], 0
v_mov_b64 v[34:35], 0
v_mov_b64 v[36:37], 0
v_mov_b64 v[38:39], 0
v_mov_b64 v[40:41], 0
v_mov_b64 v[42:43], 0
s_waitcnt vmcnt(0)
ds_read_b128 v[60:63], v1 offset:1024
ds_read_b128 v[64:67], v1 offset:2048
ds_read_b128 v[68:71], v1 offset:3072
ds_read_b128 v[72:75], v1 offset:4096
s_branch L_s0_w2rs
L_ra1_w2rs:
s_waitcnt lgkmcnt(0)
s_barrier
s_mov_b32 m0, 5120
s_nop 0
buffer_load_dwordx4 v1, s[4:7], s48 offen offset:2048 sc0 sc1 lds
s_sub_u32 s41, s41, 1
s_cbranch_scc1 L_exit
s_waitcnt vmcnt(0)
s_barrier
ds_read_b128 v[76:79], v1 offset:5120
ds_read_b128 v[60:63], v1 offset:6144
ds_read_b128 v[64:67], v1 offset:7168
ds_read_b128 v[68:71], v1 offset:8192
ds_read_b128 v[72:75], v1 offset:9216
s_waitcnt lgkmcnt(0)
v_bitop3_b32 v6, v76, v60, s35 bitop3:0x7e
v_bitop3_b32 v6, v6, v64, s35 bitop3:0xf6
v_bitop3_b32 v6, v6, v68, s35 bitop3:0xf6
v_bitop3_b32 v6, v6, v72, s35 bitop3:0xf6
v_and_b32 v6, 1, v6
v_cmp_ne_u32 vcc, 0, v6
s_mov_b32 m0, 0
v_lshlrev_b32 v6, 3, v1
s_cbranch_vccnz L_ra1_w2rs
s_branch L_a1_w2rs
L_mx_w2rs:
s_waitcnt lgkmcnt(0)
v_max3_f32 v30, v12, v13, v28
v_max_f32 v30, v30, v29
v_mov_b32 v31, v30
s_nop 1
v_permlane16_swap_b32 v30, v31
v_max_f32 v30, v30, v31
v_mov_b32 v31, v30
s_nop 1
v_permlane32_swap_b32 v30, v31
v_max_f32 v30, v30, v31
ds_write_b32 v1, v30 offset:10248
s_waitcnt lgkmcnt(0)
s_barrier
ds_read_b128 v[32:35], v1 offset:10240
s_waitcnt lgkmcnt(0)
v_max3_f32 v32, v32, v33, v34
v_max_f32 v32, v32, v35
v_sub_f32 v14, v12, v32
v_sub_f32 v15, v13, v32
v_sub_f32 v30, v28, v32
v_sub_f32 v31, v29, v32
v_exp_f32 v14, v14
v_exp_f32 v15, v15
v_exp_f32 v30, v30
v_exp_f32 v31, v31
v_cvt_pk_bf16_f32 v14, v14, v15
v_cvt_pk_bf16_f32 v30, v30, v31
ds_write_b32 v5, v14 offset:14880
v_cndmask_b32_e64 v24, 0, v30, s[56:57]
v_cndmask_b32_e64 v25, 0, v30, s[56:57]
v_mov_b64 v[76:77], s[52:53]
v_mov_b64 v[78:79], s[52:53]
v_mov_b32_dpp v26, v24 quad_perm:[2,3,0,1] row_mask:0xf bank_mask:0xf
v_mov_b32_dpp v27, v24 quad_perm:[2,3,0,1] row_mask:0xf bank_mask:0xf
s_waitcnt lgkmcnt(0)
s_barrier
v_mov_b64 v[14:15], s[0:1]
ds_read_b128 v[16:19], v1 offset:14368
ds_read_b128 v[40:43], v1 offset:14336
s_waitcnt lgkmcnt(0)
v_mfma_f32_16x16x32_bf16 v[32:35], v[76:79], v[16:19], 0
v_mfma_f32_16x16x32_bf16 v[20:23], v[52:55], v[16:19], 0
v_mfma_f32_16x16x32_bf16 v[20:23], v[56:59], v[40:43], v[20:23]
v_mfma_f32_16x16x16_bf16 v[32:35], v[14:15], v[24:25], v[32:35]
v_mfma_f32_16x16x32_bf16 v[20:23], v[36:39], v[24:27], v[20:23]
s_nop 3
v_rcp_f32 v33, v32
s_nop 2
v_mul_f32_dpp v20, v33, v20 quad_perm:[0,1,0,1] row_mask:0xf bank_mask:0xf
v_mul_f32_dpp v21, v33, v21 quad_perm:[0,1,0,1] row_mask:0xf bank_mask:0xf
v_mul_f32_dpp v22, v33, v22 quad_perm:[0,1,0,1] row_mask:0xf bank_mask:0xf
v_mul_f32_dpp v23, v33, v23 quad_perm:[0,1,0,1] row_mask:0xf bank_mask:0xf
v_cvt_pk_bf16_f32 v20, v20, v21
v_cvt_pk_bf16_f32 v21, v22, v23
ds_write_b64 v6, v[20:21] offset:7168
ds_read_b128 v[16:19], v7 offset:7168
v_mov_b64 v[76:77], 0
v_mov_b64 v[78:79], 0
v_mov_b64 v[40:41], 0
v_mov_b64 v[42:43], 0
v_mov_b64 v[24:25], 0
v_mov_b64 v[26:27], 0
v_mov_b64 v[32:33], 0
v_mov_b64 v[34:35], 0
s_waitcnt lgkmcnt(0)
s_branch L_mxb_w2rs

L_rr_w2rs:
buffer_load_dwordx4 v[60:63], v9, s[4:7], s3 offen offset:0 sc0 sc1
buffer_load_dwordx4 v[64:67], v9, s[4:7], s3 offen offset:1024 sc0 sc1
buffer_load_dwordx4 v[68:71], v9, s[4:7], s3 offen offset:2048 sc0 sc1
buffer_load_dwordx4 v[72:75], v9, s[4:7], s3 offen offset:3072 sc0 sc1
s_sub_u32 s41, s41, 1
s_cbranch_scc1 L_exit
s_waitcnt vmcnt(0)
s_branch L_r_w2rs
L_pro_w3r:
v_and_b32 v20, 63, v0
v_and_b32 v21, 15, v0
v_bfe_u32 v22, v0, 4, 2
v_lshlrev_b32 v1, 4, v20
v_add_u32 v2, 131072, v1
v_lshrrev_b32 v24, 1, v22
v_and_b32 v23, 1, v22
v_lshl_add_u32 v23, v24, 3, v23
v_lshlrev_b32 v23, 13, v23
v_lshlrev_b32 v26, 1, v22
v_xor_b32 v26, v26, v21
v_lshl_add_u32 v26, v26, 4, v23
v_xor_b32 v27, 128, v26
v_and_b32 v23, 1, v22
v_lshl_add_u32 v23, v24, 4, v23
v_mul_u32_u24 v23, 1152, v23
v_lshlrev_b32 v28, 2, v22
v_xor_b32 v28, v28, v21
v_lshl_add_u32 v28, v28, 4, v23
s_lshl_b32 s54, s32, 8
s_mul_i32 s55, s32, 147456
s_waitcnt lgkmcnt(0)
s_add_u32 s56, s54, 917504
s_mov_b32 m0, 151552
s_nop 0
buffer_load_dwordx4 v26, s[8:11], s56 offen lds
s_add_u32 s56, s54, 933888
s_mov_b32 m0, 152576
s_nop 0
buffer_load_dwordx4 v26, s[8:11], s56 offen lds
s_add_u32 s56, s54, 950272
s_mov_b32 m0, 153600
s_nop 0
buffer_load_dwordx4 v27, s[8:11], s56 offen lds
s_add_u32 s56, s54, 966656
s_mov_b32 m0, 154624
s_nop 0
buffer_load_dwordx4 v27, s[8:11], s56 offen lds
s_add_u32 s56, s54, 1441792
s_mov_b32 m0, 155648
s_nop 0
buffer_load_dwordx4 v26, s[8:11], s56 offen lds
s_add_u32 s56, s54, 1458176
s_mov_b32 m0, 156672
s_nop 0
buffer_load_dwordx4 v26, s[8:11], s56 offen lds
s_add_u32 s56, s54, 1474560
s_mov_b32 m0, 157696
s_nop 0
buffer_load_dwordx4 v27, s[8:11], s56 offen lds
s_add_u32 s56, s54, 1490944
s_mov_b32 m0, 158720
s_nop 0
buffer_load_dwordx4 v27, s[8:11], s56 offen lds
v_and_b32 v23, 1, v22
v_lshrrev_b32 v24, 2, v21
v_lshl_add_u32 v23, v23, 2, v24
v_lshlrev_b32 v23, 1, v23
v_bfe_u32 v44, v21, 1, 1
v_add_u32 v44, 12, v44
v_xor_b32 v44, v44, v23
v_lshlrev_b32 v44, 4, v44
v_lshl_add_u32 v44, v24, 8, v44
v_and_b32 v23, 1, v22
v_lshl_add_u32 v44, v23, 11, v44
v_and_b32 v23, 1, v21
v_lshl_add_u32 v44, v23, 3, v44
v_lshrrev_b32 v23, 1, v22
v_mul_u32_u24 v23, 40960, v23
v_add_u32 v23, 16384, v23
v_add_u32 v44, v44, v23
v_and_b32 v23, 1, v22
v_lshrrev_b32 v24, 2, v21
v_lshl_add_u32 v23, v23, 2, v24
v_lshlrev_b32 v23, 1, v23
v_bfe_u32 v45, v21, 1, 1
v_add_u32 v45, 14, v45
v_xor_b32 v45, v45, v23
v_lshlrev_b32 v45, 4, v45
v_lshl_add_u32 v45, v24, 8, v45
v_and_b32 v23, 1, v22
v_lshl_add_u32 v45, v23, 11, v45
v_and_b32 v23, 1, v21
v_lshl_add_u32 v45, v23, 3, v45
v_lshrrev_b32 v23, 1, v22
v_mul_u32_u24 v23, 40960, v23
v_add_u32 v23, 16384, v23
v_add_u32 v45, v45, v23
v_and_b32 v23, 1, v22
v_lshrrev_b32 v24, 2, v21
v_lshl_add_u32 v23, v23, 2, v24
v_lshlrev_b32 v23, 1, v23
v_bfe_u32 v46, v21, 1, 1
v_add_u32 v46, 12, v46
v_xor_b32 v46, v46, v23
v_lshlrev_b32 v46, 4, v46
v_lshl_add_u32 v46, v24, 8, v46
v_and_b32 v23, 1, v22
v_lshl_add_u32 v46, v23, 11, v46
v_and_b32 v23, 1, v21
v_lshl_add_u32 v46, v23, 3, v46
v_lshrrev_b32 v23, 1, v22
v_mul_u32_u24 v23, 32768, v23
v_add_u32 v23, 98304, v23
v_add_u32 v46, v46, v23
v_and_b32 v23, 1, v22
v_lshrrev_b32 v24, 2, v21
v_lshl_add_u32 v23, v23, 2, v24
v_lshlrev_b32 v23, 1, v23
v_bfe_u32 v47, v21, 1, 1
v_add_u32 v47, 14, v47
v_xor_b32 v47, v47, v23
v_lshlrev_b32 v47, 4, v47
v_lshl_add_u32 v47, v24, 8, v47
v_and_b32 v23, 1, v22
v_lshl_add_u32 v47, v23, 11, v47
v_and_b32 v23, 1, v21
v_lshl_add_u32 v47, v23, 3, v47
v_lshrrev_b32 v23, 1, v22
v_mul_u32_u24 v23, 32768, v23
v_add_u32 v23, 98304, v23
v_add_u32 v47, v47, v23
v_and_b32 v23, 1, v22
v_bfe_u32 v24, v21, 2, 1
v_lshl_add_u32 v23, v23, 1, v24
v_xor_b32 v24, 3, v23
v_lshlrev_b32 v24, 6, v24
v_lshl_add_u32 v48, v23, 8, v24
v_and_b32 v23, 3, v21
v_lshl_add_u32 v48, v23, 4, v48
v_and_b32 v23, 8, v21
v_add_u32 v48, v48, v23
v_lshrrev_b32 v23, 1, v22
v_mul_u32_u24 v23, 40960, v23
v_add_u32 v23, 16384, v23
v_add_u32 v48, v48, v23
v_and_b32 v23, 1, v22
v_bfe_u32 v24, v21, 2, 1
v_lshl_add_u32 v23, v23, 1, v24
v_xor_b32 v24, 3, v23
v_lshlrev_b32 v24, 6, v24
v_lshl_add_u32 v49, v23, 8, v24
v_and_b32 v23, 3, v21
v_lshl_add_u32 v49, v23, 4, v49
v_and_b32 v23, 8, v21
v_add_u32 v49, v49, v23
v_lshrrev_b32 v23, 1, v22
v_mul_u32_u24 v23, 32768, v23
v_add_u32 v23, 98304, v23
v_add_u32 v49, v49, v23
v_bfe_u32 v23, v21, 1, 1
v_and_b32 v24, 1, v21
v_lshl_add_u32 v23, v24, 16, v23
v_mul_u32_u24 v23, 0xaaaa, v23
v_add_u32 v0, 0x44444444, v23
v_lshlrev_b32 v3, 3, v20
v_lshrrev_b32 v25, 5, v20
v_lshlrev_b32 v25, 6, v25
v_xor_b32 v3, v3, v25
v_lshrrev_b32 v25, 2, v20
v_and_b32 v4, 3, v21
v_lshl_add_u32 v4, v4, 4, v25
v_lshlrev_b32 v4, 3, v4
v_bfe_u32 v25, v21, 1, 1
v_lshlrev_b32 v23, 6, v25
v_xor_b32 v4, v4, v23
v_lshlrev_b32 v5, 4, v21
v_lshl_add_u32 v5, v22, 2, v5
v_mul_u32_u24 v23, 256, v25
v_add_u32 v5, v5, v23
v_lshlrev_b32 v9, 8, v22
v_lshl_add_u32 v9, v25, 6, v9
v_bfe_u32 v23, v21, 3, 1
v_lshl_add_u32 v9, v23, 7, v9
v_bfe_u32 v23, v21, 2, 1
v_lshl_add_u32 v9, v23, 5, v9
v_and_b32 v23, 1, v21
v_lshl_add_u32 v9, v23, 4, v9
v_lshrrev_b32 v23, 1, v22
v_and_b32 v24, 1, v22
v_and_b32 v25, 7, v21
v_lshrrev_b32 v7, 3, v21
v_lshl_add_u32 v8, v7, 1, v23
v_lshlrev_b32 v8, 12, v8
v_lshl_add_u32 v8, v24, 7, v8
v_and_b32 v25, 4, v21
v_lshl_add_u32 v8, v25, 3, v8
v_and_b32 v25, 1, v21
v_lshl_add_u32 v8, v25, 4, v8
v_bfe_u32 v25, v21, 1, 1
v_lshl_add_u32 v8, v25, 3, v8
s_lshr_b32 s56, s32, 1
s_lshl_b32 s56, s56, 8
s_and_b32 s57, s32, 1
s_lshl_b32 s57, s57, 6
s_add_u32 s56, s56, s57
s_add_u32 s56, s56, 49152
v_add_u32 v8, s56, v8
v_and_b32 v7, 12, v21
v_bfe_u32 v25, v21, 1, 1
v_add_u32 v7, v7, v25
v_lshlrev_b32 v7, 4, v7
v_lshl_add_u32 v7, v22, 8, v7
s_mov_b32 s42, 0
s_mov_b32 s43, 65536
s_mov_b32 s44, 131072
s_mov_b32 s45, 196608
s_mov_b32 s46, 262144
s_mov_b32 s47, 294912
s_mov_b32 s48, 299008
s_mov_b32 s49, 303104
s_mov_b32 s50, 0x3e0293ee
s_mov_b32 s51, 0x3e0293ee
s_mov_b32 s52, 0x3f803f80
s_mov_b32 s53, 0x3f803f80
v_and_b32 v11, 3, v21
v_cmp_eq_u32 vcc, 0, v11
s_nop 1
v_cndmask_b32 v11, 0, 1, vcc
s_mov_b32 s34, 0
s_mov_b32 s35, -1
s_mov_b32 s36, 0
s_mov_b32 s41, 300000
s_lshl_b32 s37, s32, 14
s_add_u32 s39, s37, 17309696
s_add_u32 s37, s37, 16789504
s_mov_b32 s40, 8749056
v_mov_b64 v[36:37], 0
v_mov_b64 v[38:39], 0
s_lshl_b32 s56, s32, 1
s_add_u32 s56, s56, 1
s_cmp_eq_u32 s56, 0
s_cselect_b32 s56, 64, s56
s_mul_i32 s56, s56, 10240
s_add_u32 s56, s56, 8392704
s_add_u32 s57, s56, 4096
v_mov_b32 v40, 1
v_mov_b32 v41, 1
v_mov_b32 v42, 1
v_mov_b32 v43, 1
buffer_store_dwordx4 v[40:43], v1, s[4:7], s56 offen offset:0 sc0 sc1
buffer_store_dwordx4 v[40:43], v1, s[4:7], s56 offen offset:1024 sc0 sc1
buffer_store_dwordx4 v[40:43], v1, s[4:7], s56 offen offset:2048 sc0 sc1
buffer_store_dwordx4 v[40:43], v1, s[4:7], s56 offen offset:3072 sc0 sc1
buffer_store_dwordx4 v[40:43], v1, s[4:7], s57 offen offset:0 sc0 sc1
s_add_u32 s56, s32, 32
s_lshl_b32 s3, s56, 12
v_and_b32 v23, 1, v21
v_bfe_u32 v24, v21, 2, 1
v_bfe_u32 v25, v21, 1, 1
s_lshl_b32 s57, s56, 7
s_add_u32 s57, s57, 294912
v_and_b32 v10, 7, v21
v_lshlrev_b32 v10, 2, v10
v_lshl_add_u32 v10, v22, 5, v10
v_add_u32 v10, s57, v10
s_lshl_b32 s33, s56, 2
s_add_u32 s33, s33, 304128
v_mov_b32 v30, -1
s_mov_b64 exec, 1
buffer_store_dword v30, v1, s[4:7], s33 offen sc0 sc1
s_mov_b64 exec, -1
v_lshl_add_u32 v23, v23, 1, v24
v_lshlrev_b32 v25, 4, v25
v_mov_b32 v24, 0x3f80
v_lshlrev_b32 v24, v25, v24
v_cmp_eq_u32 vcc, 0, v23
s_nop 1
v_cndmask_b32 v76, 0, v24, vcc
v_cmp_eq_u32 vcc, 1, v23
s_nop 1
v_cndmask_b32 v77, 0, v24, vcc
v_cmp_eq_u32 vcc, 2, v23
s_nop 1
v_cndmask_b32 v78, 0, v24, vcc
v_cmp_eq_u32 vcc, 3, v23
s_nop 1
v_cndmask_b32 v79, 0, v24, vcc
buffer_store_dwordx4 v[36:39], v9, s[4:7], s3 offen offset:0 sc0 sc1
buffer_store_dwordx4 v[36:39], v9, s[4:7], s3 offen offset:1024 sc0 sc1
buffer_store_dwordx4 v[36:39], v9, s[4:7], s3 offen offset:2048 sc0 sc1
buffer_store_dwordx4 v[36:39], v9, s[4:7], s3 offen offset:3072 sc0 sc1
s_getreg_b32 s56, hwreg(HW_REG_XCC_ID)
s_and_b32 s56, s56, 15
s_mul_i32 s57, s56, s56
s_lshl_b32 s57, s57, 18
s_lshl_b32 s56, s56, 8
s_add_u32 s57, s57, s56
s_add_u32 s58, s57, 1
s_lshl_b32 s101, s32, 7
s_add_u32 s101, s101, 327680
v_mov_b32 v24, 0
s_add_u32 s56, s54, 3014656
s_mov_b32 m0, 159744
s_nop 0
buffer_load_dwordx4 v26, s[8:11], s56 offen lds
s_add_u32 s56, s54, 3031040
s_mov_b32 m0, 160768
s_nop 0
buffer_load_dwordx4 v26, s[8:11], s56 offen lds
s_add_u32 s56, s54, 3047424
s_mov_b32 m0, 161792
s_nop 0
buffer_load_dwordx4 v27, s[8:11], s56 offen lds
s_add_u32 s56, s54, 3063808
s_mov_b32 m0, 162816
s_nop 0
buffer_load_dwordx4 v27, s[8:11], s56 offen lds
s_add_u32 s56, s54, 3538944
s_mov_b32 m0, 131072
s_nop 0
buffer_load_dwordx4 v26, s[8:11], s56 offen lds
s_add_u32 s56, s54, 3555328
s_mov_b32 m0, 132096
s_nop 0
buffer_load_dwordx4 v26, s[8:11], s56 offen lds
s_add_u32 s56, s54, 3571712
s_mov_b32 m0, 133120
s_nop 0
buffer_load_dwordx4 v27, s[8:11], s56 offen lds
s_add_u32 s56, s54, 3588096
s_mov_b32 m0, 134144
s_nop 0
buffer_load_dwordx4 v27, s[8:11], s56 offen lds
s_add_u32 s56, s54, 4063232
s_mov_b32 m0, 135168
s_nop 0
buffer_load_dwordx4 v26, s[8:11], s56 offen lds
s_add_u32 s56, s54, 4079616
s_mov_b32 m0, 136192
s_nop 0
buffer_load_dwordx4 v26, s[8:11], s56 offen lds
s_add_u32 s56, s54, 4096000
s_mov_b32 m0, 137216
s_nop 0
buffer_load_dwordx4 v27, s[8:11], s56 offen lds
s_add_u32 s56, s54, 4112384
s_mov_b32 m0, 138240
s_nop 0
buffer_load_dwordx4 v27, s[8:11], s56 offen lds
s_add_u32 s56, s54, 4587520
s_mov_b32 m0, 139264
s_nop 0
buffer_load_dwordx4 v26, s[8:11], s56 offen lds
s_add_u32 s56, s54, 4603904
s_mov_b32 m0, 140288
s_nop 0
buffer_load_dwordx4 v26, s[8:11], s56 offen lds
s_add_u32 s56, s54, 4620288
s_mov_b32 m0, 141312
s_nop 0
buffer_load_dwordx4 v27, s[8:11], s56 offen lds
s_add_u32 s56, s54, 4636672
s_mov_b32 m0, 142336
s_nop 0
buffer_load_dwordx4 v27, s[8:11], s56 offen lds
s_add_u32 s56, s54, 393216
s_mov_b32 m0, 143360
s_nop 0
buffer_load_dwordx4 v26, s[12:15], s56 offen lds
s_add_u32 s56, s54, 409600
s_mov_b32 m0, 144384
s_nop 0
buffer_load_dwordx4 v26, s[12:15], s56 offen lds
s_add_u32 s56, s54, 425984
s_mov_b32 m0, 145408
s_nop 0
buffer_load_dwordx4 v27, s[12:15], s56 offen lds
s_add_u32 s56, s54, 442368
s_mov_b32 m0, 146432
s_nop 0
buffer_load_dwordx4 v27, s[12:15], s56 offen lds
s_add_u32 s56, s54, 917504
s_mov_b32 m0, 147456
s_nop 0
buffer_load_dwordx4 v26, s[12:15], s56 offen lds
s_add_u32 s56, s54, 933888
s_mov_b32 m0, 148480
s_nop 0
buffer_load_dwordx4 v26, s[12:15], s56 offen lds
s_add_u32 s56, s54, 950272
s_mov_b32 m0, 149504
s_nop 0
buffer_load_dwordx4 v27, s[12:15], s56 offen lds
s_add_u32 s56, s54, 966656
s_mov_b32 m0, 150528
s_nop 0
buffer_load_dwordx4 v27, s[12:15], s56 offen lds
v_mov_b32 v24, 0
s_waitcnt vmcnt(38)
s_barrier
ds_read_b64_tr_b16 v[80:81], v44 offset:20480
ds_read_b64_tr_b16 v[82:83], v44 offset:21504
ds_read_b64_tr_b16 v[84:85], v46 offset:20480
ds_read_b64_tr_b16 v[86:87], v46 offset:21504
ds_read_b64_tr_b16 v[88:89], v45 offset:20480
ds_read_b64_tr_b16 v[90:91], v45 offset:21504
ds_read_b64_tr_b16 v[92:93], v47 offset:20480
ds_read_b64_tr_b16 v[94:95], v47 offset:21504
s_waitcnt lgkmcnt(0)
s_waitcnt vmcnt(34)
s_barrier
s_add_u32 s56, s54, 1441792
s_mov_b32 m0, 151552
s_nop 0
buffer_load_dwordx4 v26, s[12:15], s56 offen lds
s_add_u32 s56, s54, 1458176
s_mov_b32 m0, 152576
s_nop 0
buffer_load_dwordx4 v26, s[12:15], s56 offen lds
s_add_u32 s56, s54, 1474560
s_mov_b32 m0, 153600
s_nop 0
buffer_load_dwordx4 v27, s[12:15], s56 offen lds
s_add_u32 s56, s54, 1490944
s_mov_b32 m0, 154624
s_nop 0
buffer_load_dwordx4 v27, s[12:15], s56 offen lds
ds_read_b64_tr_b16 v[96:97], v44 offset:24576
ds_read_b64_tr_b16 v[98:99], v44 offset:25600
ds_read_b64_tr_b16 v[100:101], v46 offset:24576
ds_read_b64_tr_b16 v[102:103], v46 offset:25600
ds_read_b64_tr_b16 v[104:105], v45 offset:24576
ds_read_b64_tr_b16 v[106:107], v45 offset:25600
ds_read_b64_tr_b16 v[108:109], v47 offset:24576
ds_read_b64_tr_b16 v[110:111], v47 offset:25600
s_waitcnt lgkmcnt(0)
s_waitcnt vmcnt(24)
s_barrier
s_add_u32 s56, s54, 1966080
s_mov_b32 m0, 155648
s_nop 0
buffer_load_dwordx4 v26, s[12:15], s56 offen lds
s_add_u32 s56, s54, 1982464
s_mov_b32 m0, 156672
s_nop 0
buffer_load_dwordx4 v26, s[12:15], s56 offen lds
s_add_u32 s56, s54, 1998848
s_mov_b32 m0, 157696
s_nop 0
buffer_load_dwordx4 v27, s[12:15], s56 offen lds
s_add_u32 s56, s54, 2015232
s_mov_b32 m0, 158720
s_nop 0
buffer_load_dwordx4 v27, s[12:15], s56 offen lds
ds_read_b64_tr_b16 v[112:113], v44 offset:28672
ds_read_b64_tr_b16 v[114:115], v44 offset:29696
ds_read_b64_tr_b16 v[116:117], v46 offset:28672
ds_read_b64_tr_b16 v[118:119], v46 offset:29696
ds_read_b64_tr_b16 v[120:121], v45 offset:28672
ds_read_b64_tr_b16 v[122:123], v45 offset:29696
ds_read_b64_tr_b16 v[124:125], v47 offset:28672
ds_read_b64_tr_b16 v[126:127], v47 offset:29696
s_waitcnt lgkmcnt(0)
s_waitcnt vmcnt(24)
s_barrier
s_add_u32 s56, s54, 2490368
s_mov_b32 m0, 159744
s_nop 0
buffer_load_dwordx4 v26, s[12:15], s56 offen lds
s_add_u32 s56, s54, 2506752
s_mov_b32 m0, 160768
s_nop 0
buffer_load_dwordx4 v26, s[12:15], s56 offen lds
s_add_u32 s56, s54, 2523136
s_mov_b32 m0, 161792
s_nop 0
buffer_load_dwordx4 v27, s[12:15], s56 offen lds
s_add_u32 s56, s54, 2539520
s_mov_b32 m0, 162816
s_nop 0
buffer_load_dwordx4 v27, s[12:15], s56 offen lds
ds_read_b64_tr_b16 v[128:129], v44 offset:0
ds_read_b64_tr_b16 v[130:131], v44 offset:1024
ds_read_b64_tr_b16 v[132:133], v46 offset:0
ds_read_b64_tr_b16 v[134:135], v46 offset:1024
ds_read_b64_tr_b16 v[136:137], v45 offset:0
ds_read_b64_tr_b16 v[138:139], v45 offset:1024
ds_read_b64_tr_b16 v[140:141], v47 offset:0
ds_read_b64_tr_b16 v[142:143], v47 offset:1024
s_waitcnt lgkmcnt(0)
s_waitcnt vmcnt(24)
s_barrier
s_add_u32 s56, s54, 3538944
s_mov_b32 m0, 131072
s_nop 0
buffer_load_dwordx4 v26, s[12:15], s56 offen lds
s_add_u32 s56, s54, 3555328
s_mov_b32 m0, 132096
s_nop 0
buffer_load_dwordx4 v26, s[12:15], s56 offen lds
s_add_u32 s56, s54, 3571712
s_mov_b32 m0, 133120
s_nop 0
buffer_load_dwordx4 v27, s[12:15], s56 offen lds
s_add_u32 s56, s54, 3588096
s_mov_b32 m0, 134144
s_nop 0
buffer_load_dwordx4 v27, s[12:15], s56 offen lds
ds_read_b64_tr_b16 v[144:145], v44 offset:4096
ds_read_b64_tr_b16 v[146:147], v44 offset:5120
ds_read_b64_tr_b16 v[148:149], v46 offset:4096
ds_read_b64_tr_b16 v[150:151], v46 offset:5120
ds_read_b64_tr_b16 v[152:153], v45 offset:4096
ds_read_b64_tr_b16 v[154:155], v45 offset:5120
ds_read_b64_tr_b16 v[156:157], v47 offset:4096
ds_read_b64_tr_b16 v[158:159], v47 offset:5120
s_waitcnt lgkmcnt(0)
s_waitcnt vmcnt(24)
s_barrier
s_add_u32 s56, s54, 4063232
s_mov_b32 m0, 135168
s_nop 0
buffer_load_dwordx4 v26, s[12:15], s56 offen lds
s_add_u32 s56, s54, 4079616
s_mov_b32 m0, 136192
s_nop 0
buffer_load_dwordx4 v26, s[12:15], s56 offen lds
s_add_u32 s56, s54, 4096000
s_mov_b32 m0, 137216
s_nop 0
buffer_load_dwordx4 v27, s[12:15], s56 offen lds
s_add_u32 s56, s54, 4112384
s_mov_b32 m0, 138240
s_nop 0
buffer_load_dwordx4 v27, s[12:15], s56 offen lds
ds_read_b64_tr_b16 v[160:161], v44 offset:8192
ds_read_b64_tr_b16 v[162:163], v44 offset:9216
ds_read_b64_tr_b16 v[164:165], v46 offset:8192
ds_read_b64_tr_b16 v[166:167], v46 offset:9216
ds_read_b64_tr_b16 v[168:169], v45 offset:8192
ds_read_b64_tr_b16 v[170:171], v45 offset:9216
ds_read_b64_tr_b16 v[172:173], v47 offset:8192
ds_read_b64_tr_b16 v[174:175], v47 offset:9216
s_waitcnt lgkmcnt(0)
s_waitcnt vmcnt(24)
s_barrier
s_add_u32 s56, s54, 4587520
s_mov_b32 m0, 139264
s_nop 0
buffer_load_dwordx4 v26, s[12:15], s56 offen lds
s_add_u32 s56, s54, 4603904
s_mov_b32 m0, 140288
s_nop 0
buffer_load_dwordx4 v26, s[12:15], s56 offen lds
s_add_u32 s56, s54, 4620288
s_mov_b32 m0, 141312
s_nop 0
buffer_load_dwordx4 v27, s[12:15], s56 offen lds
s_add_u32 s56, s54, 4636672
s_mov_b32 m0, 142336
s_nop 0
buffer_load_dwordx4 v27, s[12:15], s56 offen lds
ds_read_b64_tr_b16 v[176:177], v44 offset:12288
ds_read_b64_tr_b16 v[178:179], v44 offset:13312
ds_read_b64_tr_b16 v[180:181], v46 offset:12288
ds_read_b64_tr_b16 v[182:183], v46 offset:13312
ds_read_b64_tr_b16 v[184:185], v45 offset:12288
ds_read_b64_tr_b16 v[186:187], v45 offset:13312
ds_read_b64_tr_b16 v[188:189], v47 offset:12288
ds_read_b64_tr_b16 v[190:191], v47 offset:13312
s_waitcnt lgkmcnt(0)
s_waitcnt vmcnt(24)
s_barrier
s_add_u32 s56, s54, 393216
s_mov_b32 m0, 143360
s_nop 0
buffer_load_dwordx4 v26, s[16:19], s56 offen lds
s_add_u32 s56, s54, 409600
s_mov_b32 m0, 144384
s_nop 0
buffer_load_dwordx4 v26, s[16:19], s56 offen lds
s_add_u32 s56, s54, 425984
s_mov_b32 m0, 145408
s_nop 0
buffer_load_dwordx4 v27, s[16:19], s56 offen lds
s_add_u32 s56, s54, 442368
s_mov_b32 m0, 146432
s_nop 0
buffer_load_dwordx4 v27, s[16:19], s56 offen lds
ds_read_b64_tr_b16 v[192:193], v44 offset:16384
ds_read_b64_tr_b16 v[194:195], v44 offset:17408
ds_read_b64_tr_b16 v[196:197], v46 offset:16384
ds_read_b64_tr_b16 v[198:199], v46 offset:17408
ds_read_b64_tr_b16 v[200:201], v45 offset:16384
ds_read_b64_tr_b16 v[202:203], v45 offset:17408
ds_read_b64_tr_b16 v[204:205], v47 offset:16384
ds_read_b64_tr_b16 v[206:207], v47 offset:17408
s_waitcnt lgkmcnt(0)
s_waitcnt vmcnt(24)
s_barrier
s_add_u32 s56, s54, 917504
s_mov_b32 m0, 147456
s_nop 0
buffer_load_dwordx4 v26, s[16:19], s56 offen lds
s_add_u32 s56, s54, 933888
s_mov_b32 m0, 148480
s_nop 0
buffer_load_dwordx4 v26, s[16:19], s56 offen lds
s_add_u32 s56, s54, 950272
s_mov_b32 m0, 149504
s_nop 0
buffer_load_dwordx4 v27, s[16:19], s56 offen lds
s_add_u32 s56, s54, 966656
s_mov_b32 m0, 150528
s_nop 0
buffer_load_dwordx4 v27, s[16:19], s56 offen lds
ds_read_b64_tr_b16 v[208:209], v44 offset:20480
ds_read_b64_tr_b16 v[210:211], v44 offset:21504
ds_read_b64_tr_b16 v[212:213], v46 offset:20480
ds_read_b64_tr_b16 v[214:215], v46 offset:21504
ds_read_b64_tr_b16 v[216:217], v45 offset:20480
ds_read_b64_tr_b16 v[218:219], v45 offset:21504
ds_read_b64_tr_b16 v[220:221], v47 offset:20480
ds_read_b64_tr_b16 v[222:223], v47 offset:21504
s_waitcnt lgkmcnt(0)
s_waitcnt vmcnt(24)
s_barrier
s_add_u32 s56, s54, 1441792
s_mov_b32 m0, 151552
s_nop 0
buffer_load_dwordx4 v26, s[16:19], s56 offen lds
s_add_u32 s56, s54, 1458176
s_mov_b32 m0, 152576
s_nop 0
buffer_load_dwordx4 v26, s[16:19], s56 offen lds
s_add_u32 s56, s54, 1474560
s_mov_b32 m0, 153600
s_nop 0
buffer_load_dwordx4 v27, s[16:19], s56 offen lds
s_add_u32 s56, s54, 1490944
s_mov_b32 m0, 154624
s_nop 0
buffer_load_dwordx4 v27, s[16:19], s56 offen lds
ds_read_b64_tr_b16 v[224:225], v44 offset:24576
ds_read_b64_tr_b16 v[226:227], v44 offset:25600
ds_read_b64_tr_b16 v[228:229], v46 offset:24576
ds_read_b64_tr_b16 v[230:231], v46 offset:25600
ds_read_b64_tr_b16 v[232:233], v45 offset:24576
ds_read_b64_tr_b16 v[234:235], v45 offset:25600
ds_read_b64_tr_b16 v[236:237], v47 offset:24576
ds_read_b64_tr_b16 v[238:239], v47 offset:25600
s_waitcnt lgkmcnt(0)
s_waitcnt vmcnt(24)
s_barrier
s_add_u32 s56, s54, 1966080
s_mov_b32 m0, 155648
s_nop 0
buffer_load_dwordx4 v26, s[16:19], s56 offen lds
s_add_u32 s56, s54, 1982464
s_mov_b32 m0, 156672
s_nop 0
buffer_load_dwordx4 v26, s[16:19], s56 offen lds
s_add_u32 s56, s54, 1998848
s_mov_b32 m0, 157696
s_nop 0
buffer_load_dwordx4 v27, s[16:19], s56 offen lds
s_add_u32 s56, s54, 2015232
s_mov_b32 m0, 158720
s_nop 0
buffer_load_dwordx4 v27, s[16:19], s56 offen lds
ds_read_b64_tr_b16 v[240:241], v44 offset:28672
ds_read_b64_tr_b16 v[242:243], v44 offset:29696
ds_read_b64_tr_b16 v[244:245], v46 offset:28672
ds_read_b64_tr_b16 v[246:247], v46 offset:29696
ds_read_b64_tr_b16 v[248:249], v45 offset:28672
ds_read_b64_tr_b16 v[250:251], v45 offset:29696
ds_read_b64_tr_b16 v[252:253], v47 offset:28672
ds_read_b64_tr_b16 v[254:255], v47 offset:29696
s_waitcnt lgkmcnt(0)
s_waitcnt vmcnt(24)
s_barrier
s_add_u32 s56, s54, 2490368
s_mov_b32 m0, 159744
s_nop 0
buffer_load_dwordx4 v26, s[16:19], s56 offen lds
s_add_u32 s56, s54, 2506752
s_mov_b32 m0, 160768
s_nop 0
buffer_load_dwordx4 v26, s[16:19], s56 offen lds
s_add_u32 s56, s54, 2523136
s_mov_b32 m0, 161792
s_nop 0
buffer_load_dwordx4 v27, s[16:19], s56 offen lds
s_add_u32 s56, s54, 2539520
s_mov_b32 m0, 162816
s_nop 0
buffer_load_dwordx4 v27, s[16:19], s56 offen lds
ds_read_b64_tr_b16 a[0:1], v44 offset:0
ds_read_b64_tr_b16 a[2:3], v44 offset:1024
ds_read_b64_tr_b16 a[4:5], v46 offset:0
ds_read_b64_tr_b16 a[6:7], v46 offset:1024
ds_read_b64_tr_b16 a[8:9], v45 offset:0
ds_read_b64_tr_b16 a[10:11], v45 offset:1024
ds_read_b64_tr_b16 a[12:13], v47 offset:0
ds_read_b64_tr_b16 a[14:15], v47 offset:1024
s_waitcnt lgkmcnt(0)
s_waitcnt vmcnt(24)
s_barrier
s_add_u32 s56, s54, 3014656
s_mov_b32 m0, 131072
s_nop 0
buffer_load_dwordx4 v26, s[16:19], s56 offen lds
s_add_u32 s56, s54, 3031040
s_mov_b32 m0, 132096
s_nop 0
buffer_load_dwordx4 v26, s[16:19], s56 offen lds
s_add_u32 s56, s54, 3047424
s_mov_b32 m0, 133120
s_nop 0
buffer_load_dwordx4 v27, s[16:19], s56 offen lds
s_add_u32 s56, s54, 3063808
s_mov_b32 m0, 134144
s_nop 0
buffer_load_dwordx4 v27, s[16:19], s56 offen lds
ds_read_b64_tr_b16 a[16:17], v44 offset:4096
ds_read_b64_tr_b16 a[18:19], v44 offset:5120
ds_read_b64_tr_b16 a[20:21], v46 offset:4096
ds_read_b64_tr_b16 a[22:23], v46 offset:5120
ds_read_b64_tr_b16 a[24:25], v45 offset:4096
ds_read_b64_tr_b16 a[26:27], v45 offset:5120
ds_read_b64_tr_b16 a[28:29], v47 offset:4096
ds_read_b64_tr_b16 a[30:31], v47 offset:5120
s_waitcnt lgkmcnt(0)
s_waitcnt vmcnt(24)
s_barrier
s_add_u32 s56, s54, 3538944
s_mov_b32 m0, 135168
s_nop 0
buffer_load_dwordx4 v26, s[16:19], s56 offen lds
s_add_u32 s56, s54, 3555328
s_mov_b32 m0, 136192
s_nop 0
buffer_load_dwordx4 v26, s[16:19], s56 offen lds
s_add_u32 s56, s54, 3571712
s_mov_b32 m0, 137216
s_nop 0
buffer_load_dwordx4 v27, s[16:19], s56 offen lds
s_add_u32 s56, s54, 3588096
s_mov_b32 m0, 138240
s_nop 0
buffer_load_dwordx4 v27, s[16:19], s56 offen lds
ds_read_b64_tr_b16 a[32:33], v44 offset:8192
ds_read_b64_tr_b16 a[34:35], v44 offset:9216
ds_read_b64_tr_b16 a[36:37], v46 offset:8192
ds_read_b64_tr_b16 a[38:39], v46 offset:9216
ds_read_b64_tr_b16 a[40:41], v45 offset:8192
ds_read_b64_tr_b16 a[42:43], v45 offset:9216
ds_read_b64_tr_b16 a[44:45], v47 offset:8192
ds_read_b64_tr_b16 a[46:47], v47 offset:9216
s_waitcnt lgkmcnt(0)
s_waitcnt vmcnt(24)
s_barrier
s_add_u32 s56, s54, 4063232
s_mov_b32 m0, 139264
s_nop 0
buffer_load_dwordx4 v26, s[16:19], s56 offen lds
s_add_u32 s56, s54, 4079616
s_mov_b32 m0, 140288
s_nop 0
buffer_load_dwordx4 v26, s[16:19], s56 offen lds
s_add_u32 s56, s54, 4096000
s_mov_b32 m0, 141312
s_nop 0
buffer_load_dwordx4 v27, s[16:19], s56 offen lds
s_add_u32 s56, s54, 4112384
s_mov_b32 m0, 142336
s_nop 0
buffer_load_dwordx4 v27, s[16:19], s56 offen lds
ds_read_b64_tr_b16 a[48:49], v44 offset:12288
ds_read_b64_tr_b16 a[50:51], v44 offset:13312
ds_read_b64_tr_b16 a[52:53], v46 offset:12288
ds_read_b64_tr_b16 a[54:55], v46 offset:13312
ds_read_b64_tr_b16 a[56:57], v45 offset:12288
ds_read_b64_tr_b16 a[58:59], v45 offset:13312
ds_read_b64_tr_b16 a[60:61], v47 offset:12288
ds_read_b64_tr_b16 a[62:63], v47 offset:13312
s_waitcnt lgkmcnt(0)
s_waitcnt vmcnt(24)
s_barrier
s_add_u32 s56, s55, 115200
s_mov_b32 m0, 143360
s_nop 0
buffer_load_dwordx4 v28, s[20:23], s56 offen lds
s_add_u32 s56, s55, 117504
s_mov_b32 m0, 144384
s_nop 0
buffer_load_dwordx4 v28, s[20:23], s56 offen lds
s_add_u32 s56, s55, 124416
s_mov_b32 m0, 145408
s_nop 0
buffer_load_dwordx4 v28, s[20:23], s56 offen lds
s_add_u32 s56, s55, 126720
s_mov_b32 m0, 146432
s_nop 0
buffer_load_dwordx4 v28, s[20:23], s56 offen lds
ds_read_b64_tr_b16 a[64:65], v44 offset:16384
ds_read_b64_tr_b16 a[66:67], v44 offset:17408
ds_read_b64_tr_b16 a[68:69], v46 offset:16384
ds_read_b64_tr_b16 a[70:71], v46 offset:17408
ds_read_b64_tr_b16 a[72:73], v45 offset:16384
ds_read_b64_tr_b16 a[74:75], v45 offset:17408
ds_read_b64_tr_b16 a[76:77], v47 offset:16384
ds_read_b64_tr_b16 a[78:79], v47 offset:17408
s_waitcnt lgkmcnt(0)
s_waitcnt vmcnt(24)
s_barrier
s_add_u32 s56, s55, 115456
s_mov_b32 m0, 147456
s_nop 0
buffer_load_dwordx4 v28, s[20:23], s56 offen lds
s_add_u32 s56, s55, 117760
s_mov_b32 m0, 148480
s_nop 0
buffer_load_dwordx4 v28, s[20:23], s56 offen lds
s_add_u32 s56, s55, 124672
s_mov_b32 m0, 149504
s_nop 0
buffer_load_dwordx4 v28, s[20:23], s56 offen lds
s_add_u32 s56, s55, 126976
s_mov_b32 m0, 150528
s_nop 0
buffer_load_dwordx4 v28, s[20:23], s56 offen lds
ds_read_b64_tr_b16 a[80:81], v44 offset:20480
ds_read_b64_tr_b16 a[82:83], v44 offset:21504
ds_read_b64_tr_b16 a[84:85], v46 offset:20480
ds_read_b64_tr_b16 a[86:87], v46 offset:21504
ds_read_b64_tr_b16 a[88:89], v45 offset:20480
ds_read_b64_tr_b16 a[90:91], v45 offset:21504
ds_read_b64_tr_b16 a[92:93], v47 offset:20480
ds_read_b64_tr_b16 a[94:95], v47 offset:21504
s_waitcnt lgkmcnt(0)
s_waitcnt vmcnt(24)
s_barrier
s_add_u32 s56, s55, 115712
s_mov_b32 m0, 151552
s_nop 0
buffer_load_dwordx4 v28, s[20:23], s56 offen lds
s_add_u32 s56, s55, 118016
s_mov_b32 m0, 152576
s_nop 0
buffer_load_dwordx4 v28, s[20:23], s56 offen lds
s_add_u32 s56, s55, 124928
s_mov_b32 m0, 153600
s_nop 0
buffer_load_dwordx4 v28, s[20:23], s56 offen lds
s_add_u32 s56, s55, 127232
s_mov_b32 m0, 154624
s_nop 0
buffer_load_dwordx4 v28, s[20:23], s56 offen lds
ds_read_b64_tr_b16 a[96:97], v44 offset:24576
ds_read_b64_tr_b16 a[98:99], v44 offset:25600
ds_read_b64_tr_b16 a[100:101], v46 offset:24576
ds_read_b64_tr_b16 a[102:103], v46 offset:25600
ds_read_b64_tr_b16 a[104:105], v45 offset:24576
ds_read_b64_tr_b16 a[106:107], v45 offset:25600
ds_read_b64_tr_b16 a[108:109], v47 offset:24576
ds_read_b64_tr_b16 a[110:111], v47 offset:25600
s_waitcnt lgkmcnt(0)
s_waitcnt vmcnt(24)
s_barrier
s_add_u32 s56, s55, 115968
s_mov_b32 m0, 155648
s_nop 0
buffer_load_dwordx4 v28, s[20:23], s56 offen lds
s_add_u32 s56, s55, 118272
s_mov_b32 m0, 156672
s_nop 0
buffer_load_dwordx4 v28, s[20:23], s56 offen lds
s_add_u32 s56, s55, 125184
s_mov_b32 m0, 157696
s_nop 0
buffer_load_dwordx4 v28, s[20:23], s56 offen lds
s_add_u32 s56, s55, 127488
s_mov_b32 m0, 158720
s_nop 0
buffer_load_dwordx4 v28, s[20:23], s56 offen lds
ds_read_b64_tr_b16 a[112:113], v44 offset:28672
ds_read_b64_tr_b16 a[114:115], v44 offset:29696
ds_read_b64_tr_b16 a[116:117], v46 offset:28672
ds_read_b64_tr_b16 a[118:119], v46 offset:29696
ds_read_b64_tr_b16 a[120:121], v45 offset:28672
ds_read_b64_tr_b16 a[122:123], v45 offset:29696
ds_read_b64_tr_b16 a[124:125], v47 offset:28672
ds_read_b64_tr_b16 a[126:127], v47 offset:29696
s_waitcnt lgkmcnt(0)
s_waitcnt vmcnt(24)
s_barrier
s_add_u32 s56, s55, 79104
s_mov_b32 m0, 159744
s_nop 0
buffer_load_dwordx4 v28, s[20:23], s56 offen lds
s_add_u32 s56, s55, 81408
s_mov_b32 m0, 160768
s_nop 0
buffer_load_dwordx4 v28, s[20:23], s56 offen lds
s_add_u32 s56, s55, 88320
s_mov_b32 m0, 161792
s_nop 0
buffer_load_dwordx4 v28, s[20:23], s56 offen lds
s_add_u32 s56, s55, 90624
s_mov_b32 m0, 162816
s_nop 0
buffer_load_dwordx4 v28, s[20:23], s56 offen lds
ds_read_b64_tr_b16 a[128:129], v44 offset:0
ds_read_b64_tr_b16 a[130:131], v44 offset:1024
ds_read_b64_tr_b16 a[132:133], v46 offset:0
ds_read_b64_tr_b16 a[134:135], v46 offset:1024
ds_read_b64_tr_b16 a[136:137], v45 offset:0
ds_read_b64_tr_b16 a[138:139], v45 offset:1024
ds_read_b64_tr_b16 a[140:141], v47 offset:0
ds_read_b64_tr_b16 a[142:143], v47 offset:1024
buffer_load_dword v32, v24, s[28:31], 0 offen sc0 sc1
s_waitcnt lgkmcnt(0)
s_waitcnt vmcnt(25)
s_barrier
s_add_u32 s56, s54, 393216
s_mov_b32 m0, 131072
s_nop 0
buffer_load_dwordx4 v26, s[8:11], s56 offen lds
s_add_u32 s56, s54, 409600
s_mov_b32 m0, 132096
s_nop 0
buffer_load_dwordx4 v26, s[8:11], s56 offen lds
s_add_u32 s56, s54, 425984
s_mov_b32 m0, 133120
s_nop 0
buffer_load_dwordx4 v27, s[8:11], s56 offen lds
s_add_u32 s56, s54, 442368
s_mov_b32 m0, 134144
s_nop 0
buffer_load_dwordx4 v27, s[8:11], s56 offen lds
ds_read_b64_tr_b16 a[144:145], v44 offset:4096
ds_read_b64_tr_b16 a[146:147], v44 offset:5120
ds_read_b64_tr_b16 a[148:149], v46 offset:4096
ds_read_b64_tr_b16 a[150:151], v46 offset:5120
ds_read_b64_tr_b16 a[152:153], v45 offset:4096
ds_read_b64_tr_b16 a[154:155], v45 offset:5120
ds_read_b64_tr_b16 a[156:157], v47 offset:4096
ds_read_b64_tr_b16 a[158:159], v47 offset:5120
s_waitcnt lgkmcnt(0)
s_waitcnt vmcnt(25)
s_barrier
s_add_u32 s56, s54, 1966080
s_mov_b32 m0, 135168
s_nop 0
buffer_load_dwordx4 v26, s[8:11], s56 offen lds
s_add_u32 s56, s54, 1982464
s_mov_b32 m0, 136192
s_nop 0
buffer_load_dwordx4 v26, s[8:11], s56 offen lds
s_add_u32 s56, s54, 1998848
s_mov_b32 m0, 137216
s_nop 0
buffer_load_dwordx4 v27, s[8:11], s56 offen lds
s_add_u32 s56, s54, 2015232
s_mov_b32 m0, 138240
s_nop 0
buffer_load_dwordx4 v27, s[8:11], s56 offen lds
ds_read_b64_tr_b16 a[160:161], v44 offset:8192
ds_read_b64_tr_b16 a[162:163], v44 offset:9216
ds_read_b64_tr_b16 a[164:165], v46 offset:8192
ds_read_b64_tr_b16 a[166:167], v46 offset:9216
ds_read_b64_tr_b16 a[168:169], v45 offset:8192
ds_read_b64_tr_b16 a[170:171], v45 offset:9216
ds_read_b64_tr_b16 a[172:173], v47 offset:8192
ds_read_b64_tr_b16 a[174:175], v47 offset:9216
s_waitcnt lgkmcnt(0)
s_waitcnt vmcnt(25)
s_barrier
s_add_u32 s56, s54, 2490368
s_mov_b32 m0, 139264
s_nop 0
buffer_load_dwordx4 v26, s[8:11], s56 offen lds
s_add_u32 s56, s54, 2506752
s_mov_b32 m0, 140288
s_nop 0
buffer_load_dwordx4 v26, s[8:11], s56 offen lds
s_add_u32 s56, s54, 2523136
s_mov_b32 m0, 141312
s_nop 0
buffer_load_dwordx4 v27, s[8:11], s56 offen lds
s_add_u32 s56, s54, 2539520
s_mov_b32 m0, 142336
s_nop 0
buffer_load_dwordx4 v27, s[8:11], s56 offen lds
ds_read_b64_tr_b16 a[192:193], v48 offset:12288
ds_read_b64_tr_b16 a[194:195], v48 offset:13312
ds_read_b64_tr_b16 a[196:197], v48 offset:14336
ds_read_b64_tr_b16 a[198:199], v48 offset:15360
ds_read_b64_tr_b16 a[176:177], v49 offset:12288
ds_read_b64_tr_b16 a[178:179], v49 offset:13312
ds_read_b64_tr_b16 a[180:181], v49 offset:14336
ds_read_b64_tr_b16 a[182:183], v49 offset:15360
s_waitcnt lgkmcnt(0)
s_waitcnt vmcnt(25)
s_barrier
s_add_u32 s56, s54, 3014656
s_mov_b32 m0, 143360
s_nop 0
buffer_load_dwordx4 v26, s[12:15], s56 offen lds
s_add_u32 s56, s54, 3031040
s_mov_b32 m0, 144384
s_nop 0
buffer_load_dwordx4 v26, s[12:15], s56 offen lds
s_add_u32 s56, s54, 3047424
s_mov_b32 m0, 145408
s_nop 0
buffer_load_dwordx4 v27, s[12:15], s56 offen lds
s_add_u32 s56, s54, 3063808
s_mov_b32 m0, 146432
s_nop 0
buffer_load_dwordx4 v27, s[12:15], s56 offen lds
ds_read_b64_tr_b16 a[200:201], v48 offset:16384
ds_read_b64_tr_b16 a[202:203], v48 offset:17408
ds_read_b64_tr_b16 a[204:205], v48 offset:18432
ds_read_b64_tr_b16 a[206:207], v48 offset:19456
ds_read_b64_tr_b16 a[184:185], v49 offset:16384
ds_read_b64_tr_b16 a[186:187], v49 offset:17408
ds_read_b64_tr_b16 a[188:189], v49 offset:18432
ds_read_b64_tr_b16 a[190:191], v49 offset:19456
s_waitcnt lgkmcnt(0)
s_waitcnt vmcnt(25)
s_barrier
s_add_u32 s56, s54, 4587520
s_mov_b32 m0, 147456
s_nop 0
buffer_load_dwordx4 v26, s[16:19], s56 offen lds
s_add_u32 s56, s54, 4603904
s_mov_b32 m0, 148480
s_nop 0
buffer_load_dwordx4 v26, s[16:19], s56 offen lds
s_add_u32 s56, s54, 4620288
s_mov_b32 m0, 149504
s_nop 0
buffer_load_dwordx4 v27, s[16:19], s56 offen lds
s_add_u32 s56, s54, 4636672
s_mov_b32 m0, 150528
s_nop 0
buffer_load_dwordx4 v27, s[16:19], s56 offen lds
ds_read_b64_tr_b16 a[216:217], v48 offset:20480
ds_read_b64_tr_b16 a[218:219], v48 offset:21504
ds_read_b64_tr_b16 a[220:221], v48 offset:22528
ds_read_b64_tr_b16 a[222:223], v48 offset:23552
ds_read_b64_tr_b16 a[208:209], v49 offset:20480
ds_read_b64_tr_b16 a[210:211], v49 offset:21504
ds_read_b64_tr_b16 a[212:213], v49 offset:22528
ds_read_b64_tr_b16 a[214:215], v49 offset:23552
s_waitcnt lgkmcnt(0)
s_waitcnt vmcnt(25)
s_barrier
s_add_u32 s56, s55, 78336
s_mov_b32 m0, 151552
s_nop 0
buffer_load_dwordx4 v28, s[20:23], s56 offen lds
s_add_u32 s56, s55, 80640
s_mov_b32 m0, 152576
s_nop 0
buffer_load_dwordx4 v28, s[20:23], s56 offen lds
s_add_u32 s56, s55, 87552
s_mov_b32 m0, 153600
s_nop 0
buffer_load_dwordx4 v28, s[20:23], s56 offen lds
s_add_u32 s56, s55, 89856
s_mov_b32 m0, 154624
s_nop 0
buffer_load_dwordx4 v28, s[20:23], s56 offen lds
ds_read_b64_tr_b16 a[240:241], v48 offset:24576
ds_read_b64_tr_b16 a[242:243], v48 offset:25600
ds_read_b64_tr_b16 a[244:245], v48 offset:26624
ds_read_b64_tr_b16 a[246:247], v48 offset:27648
ds_read_b64_tr_b16 a[224:225], v49 offset:24576
ds_read_b64_tr_b16 a[226:227], v49 offset:25600
ds_read_b64_tr_b16 a[228:229], v49 offset:26624
ds_read_b64_tr_b16 a[230:231], v49 offset:27648
s_waitcnt lgkmcnt(0)
s_waitcnt vmcnt(25)
s_barrier
s_add_u32 s56, s55, 78592
s_mov_b32 m0, 155648
s_nop 0
buffer_load_dwordx4 v28, s[20:23], s56 offen lds
s_add_u32 s56, s55, 80896
s_mov_b32 m0, 156672
s_nop 0
buffer_load_dwordx4 v28, s[20:23], s56 offen lds
s_add_u32 s56, s55, 87808
s_mov_b32 m0, 157696
s_nop 0
buffer_load_dwordx4 v28, s[20:23], s56 offen lds
s_add_u32 s56, s55, 90112
s_mov_b32 m0, 158720
s_nop 0
buffer_load_dwordx4 v28, s[20:23], s56 offen lds
ds_read_b64_tr_b16 a[232:233], v48 offset:28672
ds_read_b64_tr_b16 a[234:235], v48 offset:29696
ds_read_b64_tr_b16 a[236:237], v48 offset:30720
ds_read_b64_tr_b16 a[238:239], v48 offset:31744
ds_read_b64_tr_b16 a[248:249], v49 offset:28672
ds_read_b64_tr_b16 a[250:251], v49 offset:29696
ds_read_b64_tr_b16 a[252:253], v49 offset:30720
ds_read_b64_tr_b16 a[254:255], v49 offset:31744
s_waitcnt lgkmcnt(0)
s_waitcnt vmcnt(24)
s_barrier
s_add_u32 s56, s55, 78848
s_mov_b32 m0, 159744
s_nop 0
buffer_load_dwordx4 v28, s[20:23], s56 offen lds
s_add_u32 s56, s55, 81152
s_mov_b32 m0, 160768
s_nop 0
buffer_load_dwordx4 v28, s[20:23], s56 offen lds
s_add_u32 s56, s55, 88064
s_mov_b32 m0, 161792
s_nop 0
buffer_load_dwordx4 v28, s[20:23], s56 offen lds
s_add_u32 s56, s55, 90368
s_mov_b32 m0, 162816
s_nop 0
buffer_load_dwordx4 v28, s[20:23], s56 offen lds
ds_read_b64_tr_b16 v[60:61], v44 offset:0
ds_read_b64_tr_b16 v[62:63], v44 offset:1024
ds_read_b64_tr_b16 v[64:65], v46 offset:0
ds_read_b64_tr_b16 v[66:67], v46 offset:1024
ds_read_b64_tr_b16 v[68:69], v45 offset:0
ds_read_b64_tr_b16 v[70:71], v45 offset:1024
ds_read_b64_tr_b16 v[72:73], v47 offset:0
ds_read_b64_tr_b16 v[74:75], v47 offset:1024
s_waitcnt lgkmcnt(0)
s_waitcnt vmcnt(24)
s_barrier
ds_write_b128 v2, v[60:63] offset:0
ds_write_b128 v2, v[64:67] offset:1024
ds_write_b128 v2, v[68:71] offset:2048
ds_write_b128 v2, v[72:75] offset:3072
ds_read_b64_tr_b16 v[60:61], v44 offset:4096
ds_read_b64_tr_b16 v[62:63], v44 offset:5120
ds_read_b64_tr_b16 v[64:65], v46 offset:4096
ds_read_b64_tr_b16 v[66:67], v46 offset:5120
ds_read_b64_tr_b16 v[68:69], v45 offset:4096
ds_read_b64_tr_b16 v[70:71], v45 offset:5120
ds_read_b64_tr_b16 v[72:73], v47 offset:4096
ds_read_b64_tr_b16 v[74:75], v47 offset:5120
L_rdv_w3r:
v_readfirstlane_b32 s38, v32
s_nop 0
s_and_b32 s57, s38, 0xff
s_cmp_lg_u32 s57, 32
s_cbranch_scc1 L_rdv2_w3r
s_waitcnt lgkmcnt(0)
s_waitcnt vmcnt(20)
s_barrier
ds_write_b128 v2, v[60:63] offset:4096
ds_write_b128 v2, v[64:67] offset:5120
ds_write_b128 v2, v[68:71] offset:6144
ds_write_b128 v2, v[72:75] offset:7168
ds_read_b64_tr_b16 v[60:61], v44 offset:8192
ds_read_b64_tr_b16 v[62:63], v44 offset:9216
ds_read_b64_tr_b16 v[64:65], v46 offset:8192
ds_read_b64_tr_b16 v[66:67], v46 offset:9216
ds_read_b64_tr_b16 v[68:69], v45 offset:8192
ds_read_b64_tr_b16 v[70:71], v45 offset:9216
ds_read_b64_tr_b16 v[72:73], v47 offset:8192
ds_read_b64_tr_b16 v[74:75], v47 offset:9216
buffer_load_dwordx4 v[12:15], v9, s[4:7], s37 offen offset:0
buffer_load_dwordx4 v[16:19], v9, s[4:7], s37 offen offset:1024
buffer_load_dwordx4 v[52:55], v1, s[4:7], s37 offen offset:2048
buffer_load_dwordx4 v[56:59], v1, s[4:7], s37 offen offset:3072
s_mov_b32 m0, 1024
s_nop 0
buffer_load_dwordx4 v1, s[4:7], s47 offen offset:3072 sc0 sc1 lds
s_waitcnt lgkmcnt(0)
s_waitcnt vmcnt(21)
s_barrier
ds_write_b128 v2, v[60:63] offset:8192
ds_write_b128 v2, v[64:67] offset:9216
ds_write_b128 v2, v[68:71] offset:10240
ds_write_b128 v2, v[72:75] offset:11264
ds_read_b64_tr_b16 v[60:61], v44 offset:12288
ds_read_b64_tr_b16 v[62:63], v44 offset:13312
ds_read_b64_tr_b16 v[64:65], v46 offset:12288
ds_read_b64_tr_b16 v[66:67], v46 offset:13312
ds_read_b64_tr_b16 v[68:69], v45 offset:12288
ds_read_b64_tr_b16 v[70:71], v45 offset:13312
ds_read_b64_tr_b16 v[72:73], v47 offset:12288
ds_read_b64_tr_b16 v[74:75], v47 offset:13312
s_waitcnt lgkmcnt(0)
s_waitcnt vmcnt(17)
s_barrier
ds_write_b128 v2, v[60:63] offset:12288
ds_write_b128 v2, v[64:67] offset:13312
ds_write_b128 v2, v[68:71] offset:14336
ds_write_b128 v2, v[72:75] offset:15360
ds_read_b64_tr_b16 v[60:61], v44 offset:16384
ds_read_b64_tr_b16 v[62:63], v44 offset:17408
ds_read_b64_tr_b16 v[64:65], v46 offset:16384
ds_read_b64_tr_b16 v[66:67], v46 offset:17408
ds_read_b64_tr_b16 v[68:69], v45 offset:16384
ds_read_b64_tr_b16 v[70:71], v45 offset:17408
ds_read_b64_tr_b16 v[72:73], v47 offset:16384
ds_read_b64_tr_b16 v[74:75], v47 offset:17408
s_waitcnt lgkmcnt(0)
s_waitcnt vmcnt(13)
s_barrier
ds_write_b128 v2, v[60:63] offset:16384
ds_write_b128 v2, v[64:67] offset:17408
ds_write_b128 v2, v[68:71] offset:18432
ds_write_b128 v2, v[72:75] offset:19456
ds_read_b64_tr_b16 v[60:61], v48 offset:20480
ds_read_b64_tr_b16 v[62:63], v48 offset:21504
ds_read_b64_tr_b16 v[64:65], v48 offset:22528
ds_read_b64_tr_b16 v[66:67], v48 offset:23552
ds_read_b64_tr_b16 v[68:69], v49 offset:20480
ds_read_b64_tr_b16 v[70:71], v49 offset:21504
ds_read_b64_tr_b16 v[72:73], v49 offset:22528
ds_read_b64_tr_b16 v[74:75], v49 offset:23552
s_waitcnt lgkmcnt(0)
s_waitcnt vmcnt(9)
s_barrier
ds_write_b128 v2, v[60:63] offset:20480
ds_write_b128 v2, v[64:67] offset:21504
ds_write_b128 v2, v[68:71] offset:22528
ds_write_b128 v2, v[72:75] offset:23552
ds_read_b64_tr_b16 v[60:61], v48 offset:24576
ds_read_b64_tr_b16 v[62:63], v48 offset:25600
ds_read_b64_tr_b16 v[64:65], v48 offset:26624
ds_read_b64_tr_b16 v[66:67], v48 offset:27648
ds_read_b64_tr_b16 v[68:69], v49 offset:24576
ds_read_b64_tr_b16 v[70:71], v49 offset:25600
ds_read_b64_tr_b16 v[72:73], v49 offset:26624
ds_read_b64_tr_b16 v[74:75], v49 offset:27648
s_waitcnt lgkmcnt(0)
s_waitcnt vmcnt(5)
s_barrier
ds_write_b128 v2, v[60:63] offset:24576
ds_write_b128 v2, v[64:67] offset:25600
ds_write_b128 v2, v[68:71] offset:26624
ds_write_b128 v2, v[72:75] offset:27648
ds_read_b64_tr_b16 v[60:61], v48 offset:28672
ds_read_b64_tr_b16 v[62:63], v48 offset:29696
ds_read_b64_tr_b16 v[64:65], v48 offset:30720
ds_read_b64_tr_b16 v[66:67], v48 offset:31744
ds_read_b64_tr_b16 v[68:69], v49 offset:28672
ds_read_b64_tr_b16 v[70:71], v49 offset:29696
ds_read_b64_tr_b16 v[72:73], v49 offset:30720
ds_read_b64_tr_b16 v[74:75], v49 offset:31744
s_waitcnt lgkmcnt(0)
s_barrier
ds_write_b128 v2, v[60:63] offset:28672
ds_write_b128 v2, v[64:67] offset:29696
ds_write_b128 v2, v[68:71] offset:30720
ds_write_b128 v2, v[72:75] offset:31744
s_lshl_b32 s57, s58, 5
s_mov_b32 s0, 0x3f003f00
s_mov_b32 s1, 0x3f003f00
s_mov_b32 s58, 304128
s_cmp_eq_u32 s38, s57
s_mov_b32 s56, 0x33333333
s_mov_b32 s57, 0x33333333
s_mov_b32 s2, 0x21800000
s_mov_b32 s55, -24
s_cbranch_scc0 L_slow_w3r
v_mov_b64 v[20:21], 0
v_mov_b64 v[22:23], 0
v_mov_b64 v[24:25], 0
v_mov_b64 v[26:27], 0
v_mov_b64 v[28:29], 0
v_mov_b64 v[30:31], 0
v_mov_b64 v[32:33], 0
v_mov_b64 v[34:35], 0
v_mov_b64 v[36:37], 0
v_mov_b64 v[38:39], 0
v_mov_b64 v[40:41], 0
v_mov_b64 v[42:43], 0
ds_read_b128 v[44:47], v2 offset:0
ds_read_b128 v[48:51], v2 offset:1024
v_bfe_u32 v77, v1, 6, 1
v_lshl_add_u32 v77, v77, 3, v1
v_lshlrev_b32 v77, 1, v77
s_waitcnt vmcnt(0) lgkmcnt(0)
s_branch L_top_w3rf
L_done_w3rf:
buffer_store_dword v11, v10, s[4:7], s40 offen sc0 sc1
s_waitcnt vmcnt(0) lgkmcnt(0)
s_endpgm
L_rdv2_w3r:
buffer_load_dword v32, v24, s[28:31], 0 offen sc0 sc1
s_sub_u32 s41, s41, 1
s_cbranch_scc1 L_exit
s_waitcnt vmcnt(0)
s_branch L_rdv_w3r
L_ra0_w3rf:
s_mov_b32 m0, 1024
s_nop 0
buffer_load_dwordx4 v1, s[4:7], s47 offen offset:0 sc1 lds
buffer_load_dwordx4 v1, s[4:7], s47 offen offset:1024 sc1 lds
buffer_load_dwordx4 v1, s[4:7], s47 offen offset:2048 sc1 lds
buffer_load_dwordx4 v1, s[4:7], s47 offen offset:3072 sc1 lds
s_sub_u32 s41, s41, 1
s_cbranch_scc1 L_exit
ds_read_b128 v[44:47], v2 offset:0
ds_read_b128 v[48:51], v2 offset:1024
v_mov_b64 v[20:21], 0
v_mov_b64 v[22:23], 0
v_mov_b64 v[24:25], 0
v_mov_b64 v[26:27], 0
v_mov_b64 v[28:29], 0
v_mov_b64 v[30:31], 0
v_mov_b64 v[32:33], 0
v_mov_b64 v[34:35], 0
v_mov_b64 v[36:37], 0
v_mov_b64 v[38:39], 0
v_mov_b64 v[40:41], 0
v_mov_b64 v[42:43], 0
s_waitcnt vmcnt(0)
ds_read_b128 v[60:63], v1 offset:1024
ds_read_b128 v[64:67], v1 offset:2048
ds_read_b128 v[68:71], v1 offset:3072
ds_read_b128 v[72:75], v1 offset:4096
s_branch L_s0_w3rf
L_ra1_w3rf:
s_waitcnt lgkmcnt(0)
s_barrier
s_mov_b32 m0, 5120
s_nop 0
buffer_load_dwordx4 v1, s[4:7], s48 offen offset:3072 sc1 lds
s_sub_u32 s41, s41, 1
s_cbranch_scc1 L_exit
s_waitcnt vmcnt(0)
s_barrier
ds_read_b128 v[76:79], v1 offset:5120
ds_read_b128 v[60:63], v1 offset:6144
ds_read_b128 v[64:67], v1 offset:7168
ds_read_b128 v[68:71], v1 offset:8192
ds_read_b128 v[72:75], v1 offset:9216
s_waitcnt lgkmcnt(0)
v_bitop3_b32 v6, v76, v60, s35 bitop3:0x7e
v_bitop3_b32 v6, v6, v64, s35 bitop3:0xf6
v_bitop3_b32 v6, v6, v68, s35 bitop3:0xf6
v_bitop3_b32 v6, v6, v72, s35 bitop3:0xf6
v_and_b32 v6, 1, v6
v_cmp_ne_u32 vcc, 0, v6
s_mov_b32 m0, 0
v_lshlrev_b32 v6, 3, v1
s_cbranch_vccnz L_ra1_w3rf
s_branch L_a1_w3rf
L_mx_w3rf:
s_waitcnt lgkmcnt(0)
v_max3_f32 v30, v12, v13, v28
v_max_f32 v30, v30, v29
v_mov_b32 v31, v30
s_nop 1
v_permlane16_swap_b32 v30, v31
v_max_f32 v30, v30, v31
v_mov_b32 v31, v30
s_nop 1
v_permlane32_swap_b32 v30, v31
v_max_f32 v30, v30, v31
ds_write_b32 v1, v30 offset:10252
s_waitcnt lgkmcnt(0)
s_barrier
ds_read_b128 v[32:35], v1 offset:10240
s_waitcnt lgkmcnt(0)
v_max3_f32 v32, v32, v33, v34
v_max_f32 v32, v32, v35
v_sub_f32 v14, v12, v32
v_sub_f32 v15, v13, v32
v_sub_f32 v30, v28, v32
v_sub_f32 v31, v29, v32
v_exp_f32 v14, v14
v_exp_f32 v15, v15
v_exp_f32 v30, v30
v_exp_f32 v31, v31
v_cvt_pk_bf16_f32 v14, v14, v15
v_cvt_pk_bf16_f32 v30, v30, v31
ds_write_b32 v5, v14 offset:15136
v_cndmask_b32_e64 v24, 0, v30, s[56:57]
v_cndmask_b32_e64 v25, 0, v30, s[56:57]
v_mov_b64 v[76:77], s[52:53]
v_mov_b64 v[78:79], s[52:53]
v_mov_b32_dpp v26, v24 quad_perm:[2,3,0,1] row_mask:0xf bank_mask:0xf
v_mov_b32_dpp v27, v24 quad_perm:[2,3,0,1] row_mask:0xf bank_mask:0xf
s_waitcnt lgkmcnt(0)
s_barrier
v_mov_b64 v[14:15], s[0:1]
ds_read_b128 v[16:19], v1 offset:14368
ds_read_b128 v[40:43], v1 offset:14336
s_waitcnt lgkmcnt(0)
v_mfma_f32_16x16x32_bf16 v[32:35], v[76:79], v[16:19], 0
v_mfma_f32_16x16x32_bf16 v[20:23], v[52:55], v[16:19], 0
v_mfma_f32_16x16x32_bf16 v[20:23], v[56:59], v[40:43], v[20:23]
v_mfma_f32_16x16x16_bf16 v[32:35], v[14:15], v[24:25], v[32:35]
v_mfma_f32_16x16x32_bf16 v[20:23], v[36:39], v[24:27], v[20:23]
s_nop 3
v_rcp_f32 v33, v32
s_nop 2
v_mul_f32_dpp v20, v33, v20 quad_perm:[0,1,0,1] row_mask:0xf bank_mask:0xf
v_mul_f32_dpp v21, v33, v21 quad_perm:[0,1,0,1] row_mask:0xf bank_mask:0xf
v_mul_f32_dpp v22, v33, v22 quad_perm:[0,1,0,1] row_mask:0xf bank_mask:0xf
v_mul_f32_dpp v23, v33, v23 quad_perm:[0,1,0,1] row_mask:0xf bank_mask:0xf
v_cvt_pk_bf16_f32 v20, v20, v21
v_cvt_pk_bf16_f32 v21, v22, v23
ds_write_b64 v6, v[20:21] offset:8192
ds_read_b128 v[16:19], v7 offset:8192
v_mov_b64 v[76:77], 0
v_mov_b64 v[78:79], 0
v_mov_b64 v[40:41], 0
v_mov_b64 v[42:43], 0
v_mov_b64 v[24:25], 0
v_mov_b64 v[26:27], 0
v_mov_b64 v[32:33], 0
v_mov_b64 v[34:35], 0
s_waitcnt lgkmcnt(0)
s_branch L_mxb_w3rf

L_rr_w3rf:
buffer_load_dwordx4 v[60:63], v9, s[4:7], s3 offen offset:0 sc1
buffer_load_dwordx4 v[64:67], v9, s[4:7], s3 offen offset:1024 sc1
buffer_load_dwordx4 v[68:71], v9, s[4:7], s3 offen offset:2048 sc1
buffer_load_dwordx4 v[72:75], v9, s[4:7], s3 offen offset:3072 sc1
s_sub_u32 s41, s41, 1
s_cbranch_scc1 L_exit
s_waitcnt vmcnt(0)
s_branch L_r_w3rf
L_slow_w3r:
v_mov_b64 v[20:21], 0
v_mov_b64 v[22:23], 0
v_mov_b64 v[24:25], 0
v_mov_b64 v[26:27], 0
v_mov_b64 v[28:29], 0
v_mov_b64 v[30:31], 0
v_mov_b64 v[32:33], 0
v_mov_b64 v[34:35], 0
v_mov_b64 v[36:37], 0
v_mov_b64 v[38:39], 0
v_mov_b64 v[40:41], 0
v_mov_b64 v[42:43], 0
ds_read_b128 v[44:47], v2 offset:0
ds_read_b128 v[48:51], v2 offset:1024
v_bfe_u32 v77, v1, 6, 1
v_lshl_add_u32 v77, v77, 3, v1
v_lshlrev_b32 v77, 1, v77
s_waitcnt vmcnt(0) lgkmcnt(0)
s_branch L_top_w3rs
L_done_w3rs:
buffer_store_dword v11, v10, s[4:7], s40 offen sc0 sc1
s_waitcnt vmcnt(0) lgkmcnt(0)
s_endpgm
L_ra0_w3rs:
s_mov_b32 m0, 1024
s_nop 0
buffer_load_dwordx4 v1, s[4:7], s47 offen offset:0 sc0 sc1 lds
buffer_load_dwordx4 v1, s[4:7], s47 offen offset:1024 sc0 sc1 lds
buffer_load_dwordx4 v1, s[4:7], s47 offen offset:2048 sc0 sc1 lds
buffer_load_dwordx4 v1, s[4:7], s47 offen offset:3072 sc0 sc1 lds
s_sub_u32 s41, s41, 1
s_cbranch_scc1 L_exit
ds_read_b128 v[44:47], v2 offset:0
ds_read_b128 v[48:51], v2 offset:1024
v_mov_b64 v[20:21], 0
v_mov_b64 v[22:23], 0
v_mov_b64 v[24:25], 0
v_mov_b64 v[26:27], 0
v_mov_b64 v[28:29], 0
v_mov_b64 v[30:31], 0
v_mov_b64 v[32:33], 0
v_mov_b64 v[34:35], 0
v_mov_b64 v[36:37], 0
v_mov_b64 v[38:39], 0
v_mov_b64 v[40:41], 0
v_mov_b64 v[42:43], 0
s_waitcnt vmcnt(0)
ds_read_b128 v[60:63], v1 offset:1024
ds_read_b128 v[64:67], v1 offset:2048
ds_read_b128 v[68:71], v1 offset:3072
ds_read_b128 v[72:75], v1 offset:4096
s_branch L_s0_w3rs
L_ra1_w3rs:
s_waitcnt lgkmcnt(0)
s_barrier
s_mov_b32 m0, 5120
s_nop 0
buffer_load_dwordx4 v1, s[4:7], s48 offen offset:3072 sc0 sc1 lds
s_sub_u32 s41, s41, 1
s_cbranch_scc1 L_exit
s_waitcnt vmcnt(0)
s_barrier
ds_read_b128 v[76:79], v1 offset:5120
ds_read_b128 v[60:63], v1 offset:6144
ds_read_b128 v[64:67], v1 offset:7168
ds_read_b128 v[68:71], v1 offset:8192
ds_read_b128 v[72:75], v1 offset:9216
s_waitcnt lgkmcnt(0)
v_bitop3_b32 v6, v76, v60, s35 bitop3:0x7e
v_bitop3_b32 v6, v6, v64, s35 bitop3:0xf6
v_bitop3_b32 v6, v6, v68, s35 bitop3:0xf6
v_bitop3_b32 v6, v6, v72, s35 bitop3:0xf6
v_and_b32 v6, 1, v6
v_cmp_ne_u32 vcc, 0, v6
s_mov_b32 m0, 0
v_lshlrev_b32 v6, 3, v1
s_cbranch_vccnz L_ra1_w3rs
s_branch L_a1_w3rs
L_mx_w3rs:
s_waitcnt lgkmcnt(0)
v_max3_f32 v30, v12, v13, v28
v_max_f32 v30, v30, v29
v_mov_b32 v31, v30
s_nop 1
v_permlane16_swap_b32 v30, v31
v_max_f32 v30, v30, v31
v_mov_b32 v31, v30
s_nop 1
v_permlane32_swap_b32 v30, v31
v_max_f32 v30, v30, v31
ds_write_b32 v1, v30 offset:10252
s_waitcnt lgkmcnt(0)
s_barrier
ds_read_b128 v[32:35], v1 offset:10240
s_waitcnt lgkmcnt(0)
v_max3_f32 v32, v32, v33, v34
v_max_f32 v32, v32, v35
v_sub_f32 v14, v12, v32
v_sub_f32 v15, v13, v32
v_sub_f32 v30, v28, v32
v_sub_f32 v31, v29, v32
v_exp_f32 v14, v14
v_exp_f32 v15, v15
v_exp_f32 v30, v30
v_exp_f32 v31, v31
v_cvt_pk_bf16_f32 v14, v14, v15
v_cvt_pk_bf16_f32 v30, v30, v31
ds_write_b32 v5, v14 offset:15136
v_cndmask_b32_e64 v24, 0, v30, s[56:57]
v_cndmask_b32_e64 v25, 0, v30, s[56:57]
v_mov_b64 v[76:77], s[52:53]
v_mov_b64 v[78:79], s[52:53]
v_mov_b32_dpp v26, v24 quad_perm:[2,3,0,1] row_mask:0xf bank_mask:0xf
v_mov_b32_dpp v27, v24 quad_perm:[2,3,0,1] row_mask:0xf bank_mask:0xf
s_waitcnt lgkmcnt(0)
s_barrier
v_mov_b64 v[14:15], s[0:1]
ds_read_b128 v[16:19], v1 offset:14368
ds_read_b128 v[40:43], v1 offset:14336
s_waitcnt lgkmcnt(0)
v_mfma_f32_16x16x32_bf16 v[32:35], v[76:79], v[16:19], 0
v_mfma_f32_16x16x32_bf16 v[20:23], v[52:55], v[16:19], 0
v_mfma_f32_16x16x32_bf16 v[20:23], v[56:59], v[40:43], v[20:23]
v_mfma_f32_16x16x16_bf16 v[32:35], v[14:15], v[24:25], v[32:35]
v_mfma_f32_16x16x32_bf16 v[20:23], v[36:39], v[24:27], v[20:23]
s_nop 3
v_rcp_f32 v33, v32
s_nop 2
v_mul_f32_dpp v20, v33, v20 quad_perm:[0,1,0,1] row_mask:0xf bank_mask:0xf
v_mul_f32_dpp v21, v33, v21 quad_perm:[0,1,0,1] row_mask:0xf bank_mask:0xf
v_mul_f32_dpp v22, v33, v22 quad_perm:[0,1,0,1] row_mask:0xf bank_mask:0xf
v_mul_f32_dpp v23, v33, v23 quad_perm:[0,1,0,1] row_mask:0xf bank_mask:0xf
v_cvt_pk_bf16_f32 v20, v20, v21
v_cvt_pk_bf16_f32 v21, v22, v23
ds_write_b64 v6, v[20:21] offset:8192
ds_read_b128 v[16:19], v7 offset:8192
v_mov_b64 v[76:77], 0
v_mov_b64 v[78:79], 0
v_mov_b64 v[40:41], 0
v_mov_b64 v[42:43], 0
v_mov_b64 v[24:25], 0
v_mov_b64 v[26:27], 0
v_mov_b64 v[32:33], 0
v_mov_b64 v[34:35], 0
s_waitcnt lgkmcnt(0)
s_branch L_mxb_w3rs

L_rr_w3rs:
buffer_load_dwordx4 v[60:63], v9, s[4:7], s3 offen offset:0 sc0 sc1
buffer_load_dwordx4 v[64:67], v9, s[4:7], s3 offen offset:1024 sc0 sc1
buffer_load_dwordx4 v[68:71], v9, s[4:7], s3 offen offset:2048 sc0 sc1
buffer_load_dwordx4 v[72:75], v9, s[4:7], s3 offen offset:3072 sc0 sc1
s_sub_u32 s41, s41, 1
s_cbranch_scc1 L_exit
s_waitcnt vmcnt(0)
s_branch L_r_w3rs
s_endpgm

.section .rodata,"a"
.p2align 6
.amdhsa_kernel gated_mix__sliding_local_dilated__memory_aug_recurrent_mem_tr__prompt_kernel
  .amdhsa_next_free_vgpr 512
  .amdhsa_next_free_sgpr 102
  .amdhsa_accum_offset 256
  .amdhsa_group_segment_fixed_size 0
  .amdhsa_kernarg_size 112
  .amdhsa_user_sgpr_count 2
  .amdhsa_user_sgpr_kernarg_segment_ptr 1
  .amdhsa_system_sgpr_workgroup_id_x 1
  .amdhsa_float_denorm_mode_32 3
.end_amdhsa_kernel
```

```asm
; @launch grid=(256,1,1) block=(256,1,1) lds=163840
.amdgcn_target "amdgcn-amd-amdhsa--gfx950"
.text
.globl gated_mix__sliding_local_dilated__memory_aug_recurrent_mem_tr__prompt_kernel
.p2align 8
.type gated_mix__sliding_local_dilated__memory_aug_recurrent_mem_tr__prompt_kernel,@function
gated_mix__sliding_local_dilated__memory_aug_recurrent_mem_tr__prompt_kernel:

s_cmp_ge_u32 s2, 256
s_cbranch_scc1 L_exit_w
s_and_b32 s3, s2, 7
s_lshr_b32 s32, s2, 3
s_cmp_lg_u32 s3, 0
s_cbranch_scc1 L_other
s_load_dwordx2 s[24:25], s[0:1], 32
s_load_dwordx2 s[8:9], s[0:1], 40
s_load_dwordx2 s[12:13], s[0:1], 48
s_load_dwordx2 s[16:17], s[0:1], 56
s_load_dwordx2 s[20:21], s[0:1], 64
s_load_dwordx2 s[28:29], s[0:1], 96
s_load_dwordx2 s[4:5], s[0:1], 104
s_mov_b32 s26, 9216
s_mov_b32 s27, 0x20000
s_mov_b32 s10, 4718592
s_mov_b32 s11, 0x20000
s_mov_b32 s14, 4718592
s_mov_b32 s15, 0x20000
s_mov_b32 s18, 4718592
s_mov_b32 s19, 0x20000
s_mov_b32 s22, 4718592
s_mov_b32 s23, 0x20000
s_mov_b32 s30, 256
s_mov_b32 s31, 0x20000
s_mov_b32 s6, 268435456
s_mov_b32 s7, 0x20000
v_lshrrev_b32 v1, 6, v0
v_and_b32 v21, 15, v0
v_readfirstlane_b32 s33, v1
v_bfe_u32 v22, v0, 4, 2
v_lshrrev_b32 v24, 1, v22
v_and_b32 v23, 1, v22
v_lshl_add_u32 v23, v24, 3, v23
v_lshlrev_b32 v23, 13, v23
v_lshlrev_b32 v26, 1, v22
v_xor_b32 v26, v26, v21
v_lshl_add_u32 v26, v26, 4, v23
v_xor_b32 v27, 128, v26
s_lshl_b32 s54, s32, 8
s_lshl_b32 s55, s33, 17
s_add_u32 s55, s55, s54
s_mul_i32 s57, s33, 40960
s_min_u32 s57, s57, 114688
s_waitcnt lgkmcnt(0)
s_add_u32 s56, s55, 524288
s_add_u32 m0, s57, 36864
s_nop 0
buffer_load_dwordx4 v26, s[8:11], s56 offen lds
s_add_u32 s56, s55, 540672
s_add_u32 m0, s57, 37888
s_nop 0
buffer_load_dwordx4 v26, s[8:11], s56 offen lds
s_add_u32 s56, s55, 557056
s_add_u32 m0, s57, 38912
s_nop 0
buffer_load_dwordx4 v27, s[8:11], s56 offen lds
s_add_u32 s56, s55, 573440
s_add_u32 m0, s57, 39936
s_nop 0
buffer_load_dwordx4 v27, s[8:11], s56 offen lds
s_add_u32 s56, s55, 1048576
s_add_u32 m0, s57, 40960
s_nop 0
buffer_load_dwordx4 v26, s[8:11], s56 offen lds
s_add_u32 s56, s55, 1064960
s_add_u32 m0, s57, 41984
s_nop 0
buffer_load_dwordx4 v26, s[8:11], s56 offen lds
s_add_u32 s56, s55, 1081344
s_add_u32 m0, s57, 43008
s_nop 0
buffer_load_dwordx4 v27, s[8:11], s56 offen lds
s_add_u32 s56, s55, 1097728
s_add_u32 m0, s57, 44032
s_nop 0
buffer_load_dwordx4 v27, s[8:11], s56 offen lds
s_add_u32 s56, s55, 2621440
s_add_u32 m0, s57, 45056
s_nop 0
buffer_load_dwordx4 v26, s[8:11], s56 offen lds
s_add_u32 s56, s55, 2637824
s_add_u32 m0, s57, 46080
s_nop 0
buffer_load_dwordx4 v26, s[8:11], s56 offen lds
s_add_u32 s56, s55, 2654208
s_add_u32 m0, s57, 47104
s_nop 0
buffer_load_dwordx4 v27, s[8:11], s56 offen lds
s_add_u32 s56, s55, 2670592
s_add_u32 m0, s57, 48128
s_nop 0
buffer_load_dwordx4 v27, s[8:11], s56 offen lds
s_add_u32 s56, s55, 3145728
s_add_u32 m0, s57, 16384
s_nop 0
buffer_load_dwordx4 v26, s[8:11], s56 offen lds
s_add_u32 s56, s55, 3162112
s_add_u32 m0, s57, 17408
s_nop 0
buffer_load_dwordx4 v26, s[8:11], s56 offen lds
s_add_u32 s56, s55, 3178496
s_add_u32 m0, s57, 18432
s_nop 0
buffer_load_dwordx4 v27, s[8:11], s56 offen lds
s_add_u32 s56, s55, 3194880
s_add_u32 m0, s57, 19456
s_nop 0
buffer_load_dwordx4 v27, s[8:11], s56 offen lds
s_add_u32 s56, s55, 3670016
s_add_u32 m0, s57, 20480
s_nop 0
buffer_load_dwordx4 v26, s[8:11], s56 offen lds
s_add_u32 s56, s55, 3686400
s_add_u32 m0, s57, 21504
s_nop 0
buffer_load_dwordx4 v26, s[8:11], s56 offen lds
s_add_u32 s56, s55, 3702784
s_add_u32 m0, s57, 22528
s_nop 0
buffer_load_dwordx4 v27, s[8:11], s56 offen lds
s_add_u32 s56, s55, 3719168
s_add_u32 m0, s57, 23552
s_nop 0
buffer_load_dwordx4 v27, s[8:11], s56 offen lds
s_add_u32 s56, s55, 4194304
s_add_u32 m0, s57, 24576
s_nop 0
buffer_load_dwordx4 v26, s[8:11], s56 offen lds
s_add_u32 s56, s55, 4210688
s_add_u32 m0, s57, 25600
s_nop 0
buffer_load_dwordx4 v26, s[8:11], s56 offen lds
s_add_u32 s56, s55, 4227072
s_add_u32 m0, s57, 26624
s_nop 0
buffer_load_dwordx4 v27, s[8:11], s56 offen lds
s_add_u32 s56, s55, 4243456
s_add_u32 m0, s57, 27648
s_nop 0
buffer_load_dwordx4 v27, s[8:11], s56 offen lds
s_cmp_eq_u32 s33, 1
s_cbranch_scc1 L_pro_w1r
s_cmp_eq_u32 s33, 2
s_cbranch_scc1 L_pro_w2r
s_cmp_eq_u32 s33, 3
s_cbranch_scc1 L_pro_w3
s_cmp_lt_u32 s32, 8
s_cbranch_scc1 L_pro_w0r
s_branch L_pro_w0
L_exit:
s_endpgm

L_other:
s_lshl_b32 s3, s3, 2
s_lshr_b32 s3, 0x43652170, s3
s_and_b32 s3, s3, 7
s_cmp_ge_u32 s3, 5
s_cbranch_scc1 L_pre_aw
s_lshr_b32 s33, s32, 3
s_and_b32 s32, s32, 7
s_sub_u32 s3, s3, 1
s_lshl_b32 s3, s3, 3
s_add_u32 s32, s32, s3
s_branch L_role_q
L_pre_aw:
s_sub_u32 s3, s3, 5
s_lshl_b32 s49, s3, 5
s_add_u32 s49, s49, s32
s_lshr_b32 s33, s49, 3
s_and_b32 s32, s32, 7
s_mul_i32 s48, s49, 43
s_lshr_b32 s48, s48, 9
s_mul_i32 s3, s48, 12
s_sub_u32 s49, s49, s3
s_branch L_role_aw
L_exit_w:
s_endpgm
L_role_q:
s_load_dwordx2 s[4:5], s[0:1], 104
s_mov_b32 s6, 268435456
s_mov_b32 s7, 0x20000
s_load_dwordx2 s[8:9], s[0:1], 0
s_mov_b32 s10, 2359296
s_mov_b32 s11, 0x20000
s_load_dwordx2 s[12:13], s[0:1], 40
s_mov_b32 s14, 4718592
s_mov_b32 s15, 0x20000
s_load_dwordx2 s[16:17], s[0:1], 48
s_mov_b32 s18, 4718592
s_mov_b32 s19, 0x20000
s_load_dwordx2 s[20:21], s[0:1], 56
s_mov_b32 s22, 4718592
s_mov_b32 s23, 0x20000
s_load_dwordx2 s[24:25], s[0:1], 96
s_mov_b32 s26, 256
s_mov_b32 s27, 0x20000
v_and_b32 v9, 63, v0
v_and_b32 v10, 15, v0
v_bfe_u32 v11, v0, 4, 2
v_lshrrev_b32 v1, 6, v0
s_nop 0
v_readfirstlane_b32 s34, v1
v_lshrrev_b32 v12, 2, v9
v_mul_u32_u24 v2, 1152, v12
v_lshrrev_b32 v12, 5, v9
v_lshlrev_b32 v12, 1, v12
v_and_b32 v13, 3, v9
v_xor_b32 v12, v12, v13
v_lshl_add_u32 v2, v12, 4, v2
v_lshrrev_b32 v12, 3, v10
v_lshlrev_b32 v12, 1, v12
v_xor_b32 v12, v12, v11
v_lshlrev_b32 v12, 4, v12
v_lshl_add_u32 v3, v10, 6, v12
v_lshlrev_b32 v12, 13, v11
v_lshlrev_b32 v5, 1, v11
v_xor_b32 v5, v5, v10
v_lshl_add_u32 v5, v5, 4, v12
v_xor_b32 v6, 128, v5
v_lshlrev_b32 v1, 4, v9
s_mul_i32 s38, s34, 20480
s_add_u32 s38, s38, 73728
s_lshl_b32 s39, s32, 8
s_lshl_b32 s40, s34, 17
s_add_u32 s39, s39, s40
s_lshl_b32 s43, s33, 1
s_and_b32 s41, s34, 1
s_add_u32 s43, s43, s41
s_mul_i32 s43, s43, 18432
s_lshr_b32 s41, s34, 1
s_lshl_b32 s41, s41, 6
s_add_u32 s43, s43, s41
s_lshl_b32 s44, s34, 10
s_mov_b32 s36, 400000
s_mov_b32 s46, 0x3e0293ee
s_mov_b32 s47, 0x3e0293ee
v_mov_b32 v8, 0
v_lshrrev_b32 v12, 2, v10
v_lshlrev_b32 v4, 12, v12
v_lshl_add_u32 v4, v11, 8, v4
v_and_b32 v12, 3, v10
v_lshl_add_u32 v4, v12, 4, v4
s_waitcnt lgkmcnt(0)
s_add_u32 s37, s39, 0
s_add_u32 m0, s38, 0
s_nop 0
buffer_load_dwordx4 v5, s[12:15], s37 offen lds
s_add_u32 s37, s39, 32768
s_add_u32 m0, s38, 1024
s_nop 0
buffer_load_dwordx4 v5, s[12:15], s37 offen lds
s_add_u32 s37, s39, 65536
s_add_u32 m0, s38, 2048
s_nop 0
buffer_load_dwordx4 v6, s[12:15], s37 offen lds
s_add_u32 s37, s39, 98304
s_add_u32 m0, s38, 3072
s_nop 0
buffer_load_dwordx4 v6, s[12:15], s37 offen lds
s_add_u32 s37, s39, 524288
s_add_u32 m0, s38, 4096
s_nop 0
buffer_load_dwordx4 v5, s[12:15], s37 offen lds
s_add_u32 s37, s39, 557056
s_add_u32 m0, s38, 5120
s_nop 0
buffer_load_dwordx4 v5, s[12:15], s37 offen lds
s_add_u32 s37, s39, 589824
s_add_u32 m0, s38, 6144
s_nop 0
buffer_load_dwordx4 v6, s[12:15], s37 offen lds
s_add_u32 s37, s39, 622592
s_add_u32 m0, s38, 7168
s_nop 0
buffer_load_dwordx4 v6, s[12:15], s37 offen lds
s_add_u32 s37, s39, 1048576
s_add_u32 m0, s38, 8192
s_nop 0
buffer_load_dwordx4 v5, s[12:15], s37 offen lds
s_add_u32 s37, s39, 1081344
s_add_u32 m0, s38, 9216
s_nop 0
buffer_load_dwordx4 v5, s[12:15], s37 offen lds
s_add_u32 s37, s39, 1114112
s_add_u32 m0, s38, 10240
s_nop 0
buffer_load_dwordx4 v6, s[12:15], s37 offen lds
s_add_u32 s37, s39, 1146880
s_add_u32 m0, s38, 11264
s_nop 0
buffer_load_dwordx4 v6, s[12:15], s37 offen lds
s_add_u32 s37, s39, 1572864
s_add_u32 m0, s38, 12288
s_nop 0
buffer_load_dwordx4 v5, s[12:15], s37 offen lds
s_add_u32 s37, s39, 1605632
s_add_u32 m0, s38, 13312
s_nop 0
buffer_load_dwordx4 v5, s[12:15], s37 offen lds
s_add_u32 s37, s39, 1638400
s_add_u32 m0, s38, 14336
s_nop 0
buffer_load_dwordx4 v6, s[12:15], s37 offen lds
s_add_u32 s37, s39, 1671168
s_add_u32 m0, s38, 15360
s_nop 0
buffer_load_dwordx4 v6, s[12:15], s37 offen lds
s_add_u32 s37, s39, 2097152
s_add_u32 m0, s38, 16384
s_nop 0
buffer_load_dwordx4 v5, s[12:15], s37 offen lds
s_add_u32 s37, s39, 2129920
s_add_u32 m0, s38, 17408
s_nop 0
buffer_load_dwordx4 v5, s[12:15], s37 offen lds
s_add_u32 s37, s39, 2162688
s_add_u32 m0, s38, 18432
s_nop 0
buffer_load_dwordx4 v6, s[12:15], s37 offen lds
s_add_u32 s37, s39, 2195456
s_add_u32 m0, s38, 19456
s_nop 0
buffer_load_dwordx4 v6, s[12:15], s37 offen lds
s_add_u32 s37, s43, 0
s_add_u32 m0, s44, 0
s_nop 0
buffer_load_dwordx4 v2, s[8:11], s37 offen lds
s_add_u32 s37, s43, 128
s_add_u32 m0, s44, 4096
s_nop 0
buffer_load_dwordx4 v2, s[8:11], s37 offen lds
s_add_u32 s37, s43, 256
s_add_u32 m0, s44, 8192
s_nop 0
buffer_load_dwordx4 v2, s[8:11], s37 offen lds
s_add_u32 s37, s43, 384
s_add_u32 m0, s44, 12288
s_nop 0
buffer_load_dwordx4 v2, s[8:11], s37 offen lds
s_add_u32 s37, s43, 512
s_add_u32 m0, s44, 16384
s_nop 0
buffer_load_dwordx4 v2, s[8:11], s37 offen lds
s_add_u32 s37, s43, 640
s_add_u32 m0, s44, 20480
s_nop 0
buffer_load_dwordx4 v2, s[8:11], s37 offen lds
s_add_u32 s37, s43, 768
s_add_u32 m0, s44, 24576
s_nop 0
buffer_load_dwordx4 v2, s[8:11], s37 offen lds
s_add_u32 s37, s43, 896
s_add_u32 m0, s44, 28672
s_nop 0
buffer_load_dwordx4 v2, s[8:11], s37 offen lds
s_add_u32 s37, s43, 1024
s_add_u32 m0, s44, 32768
s_nop 0
buffer_load_dwordx4 v2, s[8:11], s37 offen lds
s_lshr_b32 s40, s34, 1
s_lshl_b32 s40, s40, 3
s_and_b32 s41, s34, 1
s_lshl_b32 s41, s41, 1
s_add_u32 s40, s40, s41
s_add_u32 s40, s40, 0
s_lshl_b32 s41, s34, 2
s_add_u32 s41, s41, 0
v_and_b32 v12, 1, v11
v_lshrrev_b32 v13, 2, v10
v_lshl_add_u32 v12, v12, 2, v13
v_lshlrev_b32 v12, 1, v12
v_bfe_u32 v16, v10, 1, 1
v_add_u32 v16, s40, v16
v_xor_b32 v16, v16, v12
v_lshlrev_b32 v16, 4, v16
v_lshl_add_u32 v16, v13, 8, v16
v_and_b32 v12, 1, v11
v_lshl_add_u32 v16, v12, 11, v16
v_and_b32 v12, 1, v10
v_lshl_add_u32 v16, v12, 3, v16
v_lshrrev_b32 v12, 1, v11
v_mul_u32_u24 v12, 20480, v12
v_add_u32 v12, 73728, v12
v_add_u32 v16, v16, v12
v_and_b32 v12, 1, v11
v_lshrrev_b32 v13, 2, v10
v_lshl_add_u32 v12, v12, 2, v13
v_lshlrev_b32 v12, 1, v12
v_bfe_u32 v20, v10, 1, 1
v_add_u32 v20, s41, v20
v_xor_b32 v20, v20, v12
v_lshlrev_b32 v20, 4, v20
v_lshl_add_u32 v20, v13, 8, v20
v_and_b32 v12, 1, v11
v_lshl_add_u32 v20, v12, 11, v20
v_and_b32 v12, 1, v10
v_lshl_add_u32 v20, v12, 3, v20
v_lshrrev_b32 v12, 1, v11
v_mul_u32_u24 v12, 20480, v12
v_add_u32 v12, 73728, v12
v_add_u32 v20, v20, v12
v_and_b32 v12, 1, v11
v_lshrrev_b32 v13, 2, v10
v_lshl_add_u32 v12, v12, 2, v13
v_lshlrev_b32 v12, 1, v12
v_bfe_u32 v18, v10, 1, 1
v_add_u32 v18, s40, v18
v_xor_b32 v18, v18, v12
v_lshlrev_b32 v18, 4, v18
v_lshl_add_u32 v18, v13, 8, v18
v_and_b32 v12, 1, v11
v_lshl_add_u32 v18, v12, 11, v18
v_and_b32 v12, 1, v10
v_lshl_add_u32 v18, v12, 3, v18
v_lshrrev_b32 v12, 1, v11
v_mul_u32_u24 v12, 20480, v12
v_add_u32 v12, 114688, v12
v_add_u32 v18, v18, v12
v_and_b32 v12, 1, v11
v_lshrrev_b32 v13, 2, v10
v_lshl_add_u32 v12, v12, 2, v13
v_lshlrev_b32 v12, 1, v12
v_bfe_u32 v22, v10, 1, 1
v_add_u32 v22, s41, v22
v_xor_b32 v22, v22, v12
v_lshlrev_b32 v22, 4, v22
v_lshl_add_u32 v22, v13, 8, v22
v_and_b32 v12, 1, v11
v_lshl_add_u32 v22, v12, 11, v22
v_and_b32 v12, 1, v10
v_lshl_add_u32 v22, v12, 3, v22
v_lshrrev_b32 v12, 1, v11
v_mul_u32_u24 v12, 20480, v12
v_add_u32 v12, 114688, v12
v_add_u32 v22, v22, v12
s_lshr_b32 s40, s34, 1
s_lshl_b32 s40, s40, 3
s_and_b32 s41, s34, 1
s_lshl_b32 s41, s41, 1
s_add_u32 s40, s40, s41
s_add_u32 s40, s40, 4
s_lshl_b32 s41, s34, 2
s_add_u32 s41, s41, 2
v_and_b32 v12, 1, v11
v_lshrrev_b32 v13, 2, v10
v_lshl_add_u32 v12, v12, 2, v13
v_lshlrev_b32 v12, 1, v12
v_bfe_u32 v17, v10, 1, 1
v_add_u32 v17, s40, v17
v_xor_b32 v17, v17, v12
v_lshlrev_b32 v17, 4, v17
v_lshl_add_u32 v17, v13, 8, v17
v_and_b32 v12, 1, v11
v_lshl_add_u32 v17, v12, 11, v17
v_and_b32 v12, 1, v10
v_lshl_add_u32 v17, v12, 3, v17
v_lshrrev_b32 v12, 1, v11
v_mul_u32_u24 v12, 20480, v12
v_add_u32 v12, 73728, v12
v_add_u32 v17, v17, v12
v_and_b32 v12, 1, v11
v_lshrrev_b32 v13, 2, v10
v_lshl_add_u32 v12, v12, 2, v13
v_lshlrev_b32 v12, 1, v12
v_bfe_u32 v21, v10, 1, 1
v_add_u32 v21, s41, v21
v_xor_b32 v21, v21, v12
v_lshlrev_b32 v21, 4, v21
v_lshl_add_u32 v21, v13, 8, v21
v_and_b32 v12, 1, v11
v_lshl_add_u32 v21, v12, 11, v21
v_and_b32 v12, 1, v10
v_lshl_add_u32 v21, v12, 3, v21
v_lshrrev_b32 v12, 1, v11
v_mul_u32_u24 v12, 20480, v12
v_add_u32 v12, 73728, v12
v_add_u32 v21, v21, v12
v_and_b32 v12, 1, v11
v_lshrrev_b32 v13, 2, v10
v_lshl_add_u32 v12, v12, 2, v13
v_lshlrev_b32 v12, 1, v12
v_bfe_u32 v19, v10, 1, 1
v_add_u32 v19, s40, v19
v_xor_b32 v19, v19, v12
v_lshlrev_b32 v19, 4, v19
v_lshl_add_u32 v19, v13, 8, v19
v_and_b32 v12, 1, v11
v_lshl_add_u32 v19, v12, 11, v19
v_and_b32 v12, 1, v10
v_lshl_add_u32 v19, v12, 3, v19
v_lshrrev_b32 v12, 1, v11
v_mul_u32_u24 v12, 20480, v12
v_add_u32 v12, 114688, v12
v_add_u32 v19, v19, v12
v_and_b32 v12, 1, v11
v_lshrrev_b32 v13, 2, v10
v_lshl_add_u32 v12, v12, 2, v13
v_lshlrev_b32 v12, 1, v12
v_bfe_u32 v23, v10, 1, 1
v_add_u32 v23, s41, v23
v_xor_b32 v23, v23, v12
v_lshlrev_b32 v23, 4, v23
v_lshl_add_u32 v23, v13, 8, v23
v_and_b32 v12, 1, v11
v_lshl_add_u32 v23, v12, 11, v23
v_and_b32 v12, 1, v10
v_lshl_add_u32 v23, v12, 3, v23
v_lshrrev_b32 v12, 1, v11
v_mul_u32_u24 v12, 20480, v12
v_add_u32 v12, 114688, v12
v_add_u32 v23, v23, v12
s_waitcnt vmcnt(25)
s_barrier
ds_read_b64_tr_b16 v[80:81], v16 offset:0
ds_read_b64_tr_b16 v[82:83], v16 offset:1024
ds_read_b64_tr_b16 v[84:85], v18 offset:0
ds_read_b64_tr_b16 v[86:87], v18 offset:1024
ds_read_b64_tr_b16 v[152:153], v17 offset:0
ds_read_b64_tr_b16 v[154:155], v17 offset:1024
ds_read_b64_tr_b16 v[156:157], v19 offset:0
ds_read_b64_tr_b16 v[158:159], v19 offset:1024
s_waitcnt lgkmcnt(0)
s_waitcnt vmcnt(21)
s_barrier
s_add_u32 s37, s39, 2621440
s_add_u32 m0, s38, 0
s_nop 0
buffer_load_dwordx4 v5, s[12:15], s37 offen lds
s_add_u32 s37, s39, 2654208
s_add_u32 m0, s38, 1024
s_nop 0
buffer_load_dwordx4 v5, s[12:15], s37 offen lds
s_add_u32 s37, s39, 2686976
s_add_u32 m0, s38, 2048
s_nop 0
buffer_load_dwordx4 v6, s[12:15], s37 offen lds
s_add_u32 s37, s39, 2719744
s_add_u32 m0, s38, 3072
s_nop 0
buffer_load_dwordx4 v6, s[12:15], s37 offen lds
ds_read_b64_tr_b16 v[88:89], v16 offset:4096
ds_read_b64_tr_b16 v[90:91], v16 offset:5120
ds_read_b64_tr_b16 v[92:93], v18 offset:4096
ds_read_b64_tr_b16 v[94:95], v18 offset:5120
ds_read_b64_tr_b16 v[160:161], v17 offset:4096
ds_read_b64_tr_b16 v[162:163], v17 offset:5120
ds_read_b64_tr_b16 v[164:165], v19 offset:4096
ds_read_b64_tr_b16 v[166:167], v19 offset:5120
s_waitcnt lgkmcnt(0)
s_waitcnt vmcnt(21)
s_barrier
s_add_u32 s37, s39, 3145728
s_add_u32 m0, s38, 4096
s_nop 0
buffer_load_dwordx4 v5, s[12:15], s37 offen lds
s_add_u32 s37, s39, 3178496
s_add_u32 m0, s38, 5120
s_nop 0
buffer_load_dwordx4 v5, s[12:15], s37 offen lds
s_add_u32 s37, s39, 3211264
s_add_u32 m0, s38, 6144
s_nop 0
buffer_load_dwordx4 v6, s[12:15], s37 offen lds
s_add_u32 s37, s39, 3244032
s_add_u32 m0, s38, 7168
s_nop 0
buffer_load_dwordx4 v6, s[12:15], s37 offen lds
ds_read_b64_tr_b16 v[96:97], v16 offset:8192
ds_read_b64_tr_b16 v[98:99], v16 offset:9216
ds_read_b64_tr_b16 v[100:101], v18 offset:8192
ds_read_b64_tr_b16 v[102:103], v18 offset:9216
ds_read_b64_tr_b16 v[168:169], v17 offset:8192
ds_read_b64_tr_b16 v[170:171], v17 offset:9216
ds_read_b64_tr_b16 v[172:173], v19 offset:8192
ds_read_b64_tr_b16 v[174:175], v19 offset:9216
s_waitcnt lgkmcnt(0)
s_waitcnt vmcnt(21)
s_barrier
s_add_u32 s37, s39, 3670016
s_add_u32 m0, s38, 8192
s_nop 0
buffer_load_dwordx4 v5, s[12:15], s37 offen lds
s_add_u32 s37, s39, 3702784
s_add_u32 m0, s38, 9216
s_nop 0
buffer_load_dwordx4 v5, s[12:15], s37 offen lds
s_add_u32 s37, s39, 3735552
s_add_u32 m0, s38, 10240
s_nop 0
buffer_load_dwordx4 v6, s[12:15], s37 offen lds
s_add_u32 s37, s39, 3768320
s_add_u32 m0, s38, 11264
s_nop 0
buffer_load_dwordx4 v6, s[12:15], s37 offen lds
ds_read_b64_tr_b16 v[104:105], v16 offset:12288
ds_read_b64_tr_b16 v[106:107], v16 offset:13312
ds_read_b64_tr_b16 v[108:109], v18 offset:12288
ds_read_b64_tr_b16 v[110:111], v18 offset:13312
ds_read_b64_tr_b16 v[176:177], v17 offset:12288
ds_read_b64_tr_b16 v[178:179], v17 offset:13312
ds_read_b64_tr_b16 v[180:181], v19 offset:12288
ds_read_b64_tr_b16 v[182:183], v19 offset:13312
s_waitcnt lgkmcnt(0)
s_waitcnt vmcnt(21)
s_barrier
s_add_u32 s37, s39, 4194304
s_add_u32 m0, s38, 12288
s_nop 0
buffer_load_dwordx4 v5, s[12:15], s37 offen lds
s_add_u32 s37, s39, 4227072
s_add_u32 m0, s38, 13312
s_nop 0
buffer_load_dwordx4 v5, s[12:15], s37 offen lds
s_add_u32 s37, s39, 4259840
s_add_u32 m0, s38, 14336
s_nop 0
buffer_load_dwordx4 v6, s[12:15], s37 offen lds
s_add_u32 s37, s39, 4292608
s_add_u32 m0, s38, 15360
s_nop 0
buffer_load_dwordx4 v6, s[12:15], s37 offen lds
ds_read_b64_tr_b16 v[112:113], v16 offset:16384
ds_read_b64_tr_b16 v[114:115], v16 offset:17408
ds_read_b64_tr_b16 v[116:117], v18 offset:16384
ds_read_b64_tr_b16 v[118:119], v18 offset:17408
ds_read_b64_tr_b16 v[184:185], v17 offset:16384
ds_read_b64_tr_b16 v[186:187], v17 offset:17408
ds_read_b64_tr_b16 v[188:189], v19 offset:16384
ds_read_b64_tr_b16 v[190:191], v19 offset:17408
s_waitcnt lgkmcnt(0)
s_waitcnt vmcnt(12)
s_barrier
s_add_u32 s37, s39, 0
s_add_u32 m0, s38, 16384
s_nop 0
buffer_load_dwordx4 v5, s[16:19], s37 offen lds
s_add_u32 s37, s39, 32768
s_add_u32 m0, s38, 17408
s_nop 0
buffer_load_dwordx4 v5, s[16:19], s37 offen lds
s_add_u32 s37, s39, 65536
s_add_u32 m0, s38, 18432
s_nop 0
buffer_load_dwordx4 v6, s[16:19], s37 offen lds
s_add_u32 s37, s39, 98304
s_add_u32 m0, s38, 19456
s_nop 0
buffer_load_dwordx4 v6, s[16:19], s37 offen lds
ds_read_b64_tr_b16 v[120:121], v16 offset:0
ds_read_b64_tr_b16 v[122:123], v16 offset:1024
ds_read_b64_tr_b16 v[124:125], v18 offset:0
ds_read_b64_tr_b16 v[126:127], v18 offset:1024
ds_read_b64_tr_b16 v[192:193], v17 offset:0
ds_read_b64_tr_b16 v[194:195], v17 offset:1024
ds_read_b64_tr_b16 v[196:197], v19 offset:0
ds_read_b64_tr_b16 v[198:199], v19 offset:1024
s_waitcnt lgkmcnt(0)
s_waitcnt vmcnt(12)
s_barrier
s_add_u32 s37, s39, 524288
s_add_u32 m0, s38, 0
s_nop 0
buffer_load_dwordx4 v5, s[16:19], s37 offen lds
s_add_u32 s37, s39, 557056
s_add_u32 m0, s38, 1024
s_nop 0
buffer_load_dwordx4 v5, s[16:19], s37 offen lds
s_add_u32 s37, s39, 589824
s_add_u32 m0, s38, 2048
s_nop 0
buffer_load_dwordx4 v6, s[16:19], s37 offen lds
s_add_u32 s37, s39, 622592
s_add_u32 m0, s38, 3072
s_nop 0
buffer_load_dwordx4 v6, s[16:19], s37 offen lds
ds_read_b64_tr_b16 v[128:129], v16 offset:4096
ds_read_b64_tr_b16 v[130:131], v16 offset:5120
ds_read_b64_tr_b16 v[132:133], v18 offset:4096
ds_read_b64_tr_b16 v[134:135], v18 offset:5120
ds_read_b64_tr_b16 v[200:201], v17 offset:4096
ds_read_b64_tr_b16 v[202:203], v17 offset:5120
ds_read_b64_tr_b16 v[204:205], v19 offset:4096
ds_read_b64_tr_b16 v[206:207], v19 offset:5120
s_waitcnt lgkmcnt(0)
s_waitcnt vmcnt(12)
s_barrier
s_add_u32 s37, s39, 1048576
s_add_u32 m0, s38, 4096
s_nop 0
buffer_load_dwordx4 v5, s[16:19], s37 offen lds
s_add_u32 s37, s39, 1081344
s_add_u32 m0, s38, 5120
s_nop 0
buffer_load_dwordx4 v5, s[16:19], s37 offen lds
s_add_u32 s37, s39, 1114112
s_add_u32 m0, s38, 6144
s_nop 0
buffer_load_dwordx4 v6, s[16:19], s37 offen lds
s_add_u32 s37, s39, 1146880
s_add_u32 m0, s38, 7168
s_nop 0
buffer_load_dwordx4 v6, s[16:19], s37 offen lds
ds_read_b64_tr_b16 v[136:137], v16 offset:8192
ds_read_b64_tr_b16 v[138:139], v16 offset:9216
ds_read_b64_tr_b16 v[140:141], v18 offset:8192
ds_read_b64_tr_b16 v[142:143], v18 offset:9216
ds_read_b64_tr_b16 v[208:209], v17 offset:8192
ds_read_b64_tr_b16 v[210:211], v17 offset:9216
ds_read_b64_tr_b16 v[212:213], v19 offset:8192
ds_read_b64_tr_b16 v[214:215], v19 offset:9216
s_waitcnt lgkmcnt(0)
s_waitcnt vmcnt(12)
s_barrier
s_add_u32 s37, s39, 1572864
s_add_u32 m0, s38, 8192
s_nop 0
buffer_load_dwordx4 v5, s[16:19], s37 offen lds
s_add_u32 s37, s39, 1605632
s_add_u32 m0, s38, 9216
s_nop 0
buffer_load_dwordx4 v5, s[16:19], s37 offen lds
s_add_u32 s37, s39, 1638400
s_add_u32 m0, s38, 10240
s_nop 0
buffer_load_dwordx4 v6, s[16:19], s37 offen lds
s_add_u32 s37, s39, 1671168
s_add_u32 m0, s38, 11264
s_nop 0
buffer_load_dwordx4 v6, s[16:19], s37 offen lds
ds_read_b64_tr_b16 v[144:145], v16 offset:12288
ds_read_b64_tr_b16 v[146:147], v16 offset:13312
ds_read_b64_tr_b16 v[148:149], v18 offset:12288
ds_read_b64_tr_b16 v[150:151], v18 offset:13312
ds_read_b64_tr_b16 v[216:217], v17 offset:12288
ds_read_b64_tr_b16 v[218:219], v17 offset:13312
ds_read_b64_tr_b16 v[220:221], v19 offset:12288
ds_read_b64_tr_b16 v[222:223], v19 offset:13312
s_waitcnt lgkmcnt(0)
s_waitcnt vmcnt(12)
s_barrier
s_add_u32 s37, s39, 2097152
s_add_u32 m0, s38, 12288
s_nop 0
buffer_load_dwordx4 v5, s[16:19], s37 offen lds
s_add_u32 s37, s39, 2129920
s_add_u32 m0, s38, 13312
s_nop 0
buffer_load_dwordx4 v5, s[16:19], s37 offen lds
s_add_u32 s37, s39, 2162688
s_add_u32 m0, s38, 14336
s_nop 0
buffer_load_dwordx4 v6, s[16:19], s37 offen lds
s_add_u32 s37, s39, 2195456
s_add_u32 m0, s38, 15360
s_nop 0
buffer_load_dwordx4 v6, s[16:19], s37 offen lds
ds_read_b64_tr_b16 v[224:225], v16 offset:16384
ds_read_b64_tr_b16 v[226:227], v16 offset:17408
ds_read_b64_tr_b16 v[228:229], v18 offset:16384
ds_read_b64_tr_b16 v[230:231], v18 offset:17408
ds_read_b64_tr_b16 a[40:41], v17 offset:16384
ds_read_b64_tr_b16 a[42:43], v17 offset:17408
ds_read_b64_tr_b16 a[44:45], v19 offset:16384
ds_read_b64_tr_b16 a[46:47], v19 offset:17408
s_waitcnt lgkmcnt(0)
s_waitcnt vmcnt(12)
s_barrier
s_add_u32 s37, s39, 2621440
s_add_u32 m0, s38, 16384
s_nop 0
buffer_load_dwordx4 v5, s[16:19], s37 offen lds
s_add_u32 s37, s39, 2654208
s_add_u32 m0, s38, 17408
s_nop 0
buffer_load_dwordx4 v5, s[16:19], s37 offen lds
s_add_u32 s37, s39, 2686976
s_add_u32 m0, s38, 18432
s_nop 0
buffer_load_dwordx4 v6, s[16:19], s37 offen lds
s_add_u32 s37, s39, 2719744
s_add_u32 m0, s38, 19456
s_nop 0
buffer_load_dwordx4 v6, s[16:19], s37 offen lds
ds_read_b64_tr_b16 v[232:233], v16 offset:0
ds_read_b64_tr_b16 v[234:235], v16 offset:1024
ds_read_b64_tr_b16 v[236:237], v18 offset:0
ds_read_b64_tr_b16 v[238:239], v18 offset:1024
ds_read_b64_tr_b16 a[48:49], v17 offset:0
ds_read_b64_tr_b16 a[50:51], v17 offset:1024
ds_read_b64_tr_b16 a[52:53], v19 offset:0
ds_read_b64_tr_b16 a[54:55], v19 offset:1024
s_waitcnt lgkmcnt(0)
s_waitcnt vmcnt(12)
s_barrier
s_add_u32 s37, s39, 3145728
s_add_u32 m0, s38, 0
s_nop 0
buffer_load_dwordx4 v5, s[16:19], s37 offen lds
s_add_u32 s37, s39, 3178496
s_add_u32 m0, s38, 1024
s_nop 0
buffer_load_dwordx4 v5, s[16:19], s37 offen lds
s_add_u32 s37, s39, 3211264
s_add_u32 m0, s38, 2048
s_nop 0
buffer_load_dwordx4 v6, s[16:19], s37 offen lds
s_add_u32 s37, s39, 3244032
s_add_u32 m0, s38, 3072
s_nop 0
buffer_load_dwordx4 v6, s[16:19], s37 offen lds
ds_read_b64_tr_b16 v[240:241], v16 offset:4096
ds_read_b64_tr_b16 v[242:243], v16 offset:5120
ds_read_b64_tr_b16 v[244:245], v18 offset:4096
ds_read_b64_tr_b16 v[246:247], v18 offset:5120
ds_read_b64_tr_b16 a[56:57], v17 offset:4096
ds_read_b64_tr_b16 a[58:59], v17 offset:5120
ds_read_b64_tr_b16 a[60:61], v19 offset:4096
ds_read_b64_tr_b16 a[62:63], v19 offset:5120
s_waitcnt lgkmcnt(0)
s_waitcnt vmcnt(12)
s_barrier
s_add_u32 s37, s39, 3670016
s_add_u32 m0, s38, 4096
s_nop 0
buffer_load_dwordx4 v5, s[16:19], s37 offen lds
s_add_u32 s37, s39, 3702784
s_add_u32 m0, s38, 5120
s_nop 0
buffer_load_dwordx4 v5, s[16:19], s37 offen lds
s_add_u32 s37, s39, 3735552
s_add_u32 m0, s38, 6144
s_nop 0
buffer_load_dwordx4 v6, s[16:19], s37 offen lds
s_add_u32 s37, s39, 3768320
s_add_u32 m0, s38, 7168
s_nop 0
buffer_load_dwordx4 v6, s[16:19], s37 offen lds
ds_read_b64_tr_b16 v[248:249], v16 offset:8192
ds_read_b64_tr_b16 v[250:251], v16 offset:9216
ds_read_b64_tr_b16 v[252:253], v18 offset:8192
ds_read_b64_tr_b16 v[254:255], v18 offset:9216
ds_read_b64_tr_b16 a[64:65], v17 offset:8192
ds_read_b64_tr_b16 a[66:67], v17 offset:9216
ds_read_b64_tr_b16 a[68:69], v19 offset:8192
ds_read_b64_tr_b16 a[70:71], v19 offset:9216
s_waitcnt lgkmcnt(0)
s_waitcnt vmcnt(12)
s_barrier
s_add_u32 s37, s39, 4194304
s_add_u32 m0, s38, 8192
s_nop 0
buffer_load_dwordx4 v5, s[16:19], s37 offen lds
s_add_u32 s37, s39, 4227072
s_add_u32 m0, s38, 9216
s_nop 0
buffer_load_dwordx4 v5, s[16:19], s37 offen lds
s_add_u32 s37, s39, 4259840
s_add_u32 m0, s38, 10240
s_nop 0
buffer_load_dwordx4 v6, s[16:19], s37 offen lds
s_add_u32 s37, s39, 4292608
s_add_u32 m0, s38, 11264
s_nop 0
buffer_load_dwordx4 v6, s[16:19], s37 offen lds
ds_read_b64_tr_b16 a[0:1], v16 offset:12288
ds_read_b64_tr_b16 a[2:3], v16 offset:13312
ds_read_b64_tr_b16 a[4:5], v18 offset:12288
ds_read_b64_tr_b16 a[6:7], v18 offset:13312
ds_read_b64_tr_b16 a[72:73], v17 offset:12288
ds_read_b64_tr_b16 a[74:75], v17 offset:13312
ds_read_b64_tr_b16 a[76:77], v19 offset:12288
ds_read_b64_tr_b16 a[78:79], v19 offset:13312
s_waitcnt lgkmcnt(0)
s_waitcnt vmcnt(12)
s_barrier
s_add_u32 s37, s39, 0
s_add_u32 m0, s38, 12288
s_nop 0
buffer_load_dwordx4 v5, s[20:23], s37 offen lds
s_add_u32 s37, s39, 32768
s_add_u32 m0, s38, 13312
s_nop 0
buffer_load_dwordx4 v5, s[20:23], s37 offen lds
s_add_u32 s37, s39, 65536
s_add_u32 m0, s38, 14336
s_nop 0
buffer_load_dwordx4 v6, s[20:23], s37 offen lds
s_add_u32 s37, s39, 98304
s_add_u32 m0, s38, 15360
s_nop 0
buffer_load_dwordx4 v6, s[20:23], s37 offen lds
ds_read_b64_tr_b16 a[8:9], v16 offset:16384
ds_read_b64_tr_b16 a[10:11], v16 offset:17408
ds_read_b64_tr_b16 a[12:13], v18 offset:16384
ds_read_b64_tr_b16 a[14:15], v18 offset:17408
ds_read_b64_tr_b16 a[80:81], v17 offset:16384
ds_read_b64_tr_b16 a[82:83], v17 offset:17408
ds_read_b64_tr_b16 a[84:85], v19 offset:16384
ds_read_b64_tr_b16 a[86:87], v19 offset:17408
s_waitcnt lgkmcnt(0)
s_waitcnt vmcnt(12)
s_barrier
s_add_u32 s37, s39, 524288
s_add_u32 m0, s38, 16384
s_nop 0
buffer_load_dwordx4 v5, s[20:23], s37 offen lds
s_add_u32 s37, s39, 557056
s_add_u32 m0, s38, 17408
s_nop 0
buffer_load_dwordx4 v5, s[20:23], s37 offen lds
s_add_u32 s37, s39, 589824
s_add_u32 m0, s38, 18432
s_nop 0
buffer_load_dwordx4 v6, s[20:23], s37 offen lds
s_add_u32 s37, s39, 622592
s_add_u32 m0, s38, 19456
s_nop 0
buffer_load_dwordx4 v6, s[20:23], s37 offen lds
ds_read_b64_tr_b16 a[16:17], v16 offset:0
ds_read_b64_tr_b16 a[18:19], v16 offset:1024
ds_read_b64_tr_b16 a[20:21], v18 offset:0
ds_read_b64_tr_b16 a[22:23], v18 offset:1024
ds_read_b64_tr_b16 a[88:89], v17 offset:0
ds_read_b64_tr_b16 a[90:91], v17 offset:1024
ds_read_b64_tr_b16 a[92:93], v19 offset:0
ds_read_b64_tr_b16 a[94:95], v19 offset:1024
s_waitcnt lgkmcnt(0)
s_waitcnt vmcnt(12)
s_barrier
s_add_u32 s37, s39, 1048576
s_add_u32 m0, s38, 0
s_nop 0
buffer_load_dwordx4 v5, s[20:23], s37 offen lds
s_add_u32 s37, s39, 1081344
s_add_u32 m0, s38, 1024
s_nop 0
buffer_load_dwordx4 v5, s[20:23], s37 offen lds
s_add_u32 s37, s39, 1114112
s_add_u32 m0, s38, 2048
s_nop 0
buffer_load_dwordx4 v6, s[20:23], s37 offen lds
s_add_u32 s37, s39, 1146880
s_add_u32 m0, s38, 3072
s_nop 0
buffer_load_dwordx4 v6, s[20:23], s37 offen lds
ds_read_b64_tr_b16 a[24:25], v16 offset:4096
ds_read_b64_tr_b16 a[26:27], v16 offset:5120
ds_read_b64_tr_b16 a[28:29], v18 offset:4096
ds_read_b64_tr_b16 a[30:31], v18 offset:5120
ds_read_b64_tr_b16 a[96:97], v17 offset:4096
ds_read_b64_tr_b16 a[98:99], v17 offset:5120
ds_read_b64_tr_b16 a[100:101], v19 offset:4096
ds_read_b64_tr_b16 a[102:103], v19 offset:5120
s_waitcnt lgkmcnt(0)
s_waitcnt vmcnt(12)
s_barrier
s_add_u32 s37, s39, 1572864
s_add_u32 m0, s38, 4096
s_nop 0
buffer_load_dwordx4 v5, s[20:23], s37 offen lds
s_add_u32 s37, s39, 1605632
s_add_u32 m0, s38, 5120
s_nop 0
buffer_load_dwordx4 v5, s[20:23], s37 offen lds
s_add_u32 s37, s39, 1638400
s_add_u32 m0, s38, 6144
s_nop 0
buffer_load_dwordx4 v6, s[20:23], s37 offen lds
s_add_u32 s37, s39, 1671168
s_add_u32 m0, s38, 7168
s_nop 0
buffer_load_dwordx4 v6, s[20:23], s37 offen lds
ds_read_b64_tr_b16 a[32:33], v16 offset:8192
ds_read_b64_tr_b16 a[34:35], v16 offset:9216
ds_read_b64_tr_b16 a[36:37], v18 offset:8192
ds_read_b64_tr_b16 a[38:39], v18 offset:9216
ds_read_b64_tr_b16 a[104:105], v17 offset:8192
ds_read_b64_tr_b16 a[106:107], v17 offset:9216
ds_read_b64_tr_b16 a[108:109], v19 offset:8192
ds_read_b64_tr_b16 a[110:111], v19 offset:9216
s_waitcnt lgkmcnt(0)
s_waitcnt vmcnt(12)
s_barrier
s_add_u32 s37, s39, 2097152
s_add_u32 m0, s38, 8192
s_nop 0
buffer_load_dwordx4 v5, s[20:23], s37 offen lds
s_add_u32 s37, s39, 2129920
s_add_u32 m0, s38, 9216
s_nop 0
buffer_load_dwordx4 v5, s[20:23], s37 offen lds
s_add_u32 s37, s39, 2162688
s_add_u32 m0, s38, 10240
s_nop 0
buffer_load_dwordx4 v6, s[20:23], s37 offen lds
s_add_u32 s37, s39, 2195456
s_add_u32 m0, s38, 11264
s_nop 0
buffer_load_dwordx4 v6, s[20:23], s37 offen lds
ds_read_b64_tr_b16 a[112:113], v20 offset:12288
ds_read_b64_tr_b16 a[114:115], v20 offset:13312
ds_read_b64_tr_b16 a[116:117], v22 offset:12288
ds_read_b64_tr_b16 a[118:119], v22 offset:13312
ds_read_b64_tr_b16 a[184:185], v21 offset:12288
ds_read_b64_tr_b16 a[186:187], v21 offset:13312
ds_read_b64_tr_b16 a[188:189], v23 offset:12288
ds_read_b64_tr_b16 a[190:191], v23 offset:13312
s_waitcnt lgkmcnt(0)
s_waitcnt vmcnt(12)
s_barrier
s_add_u32 s37, s39, 2621440
s_add_u32 m0, s38, 12288
s_nop 0
buffer_load_dwordx4 v5, s[20:23], s37 offen lds
s_add_u32 s37, s39, 2654208
s_add_u32 m0, s38, 13312
s_nop 0
buffer_load_dwordx4 v5, s[20:23], s37 offen lds
s_add_u32 s37, s39, 2686976
s_add_u32 m0, s38, 14336
s_nop 0
buffer_load_dwordx4 v6, s[20:23], s37 offen lds
s_add_u32 s37, s39, 2719744
s_add_u32 m0, s38, 15360
s_nop 0
buffer_load_dwordx4 v6, s[20:23], s37 offen lds
ds_read_b64_tr_b16 a[120:121], v20 offset:16384
ds_read_b64_tr_b16 a[122:123], v20 offset:17408
ds_read_b64_tr_b16 a[124:125], v22 offset:16384
ds_read_b64_tr_b16 a[126:127], v22 offset:17408
ds_read_b64_tr_b16 a[192:193], v21 offset:16384
ds_read_b64_tr_b16 a[194:195], v21 offset:17408
ds_read_b64_tr_b16 a[196:197], v23 offset:16384
ds_read_b64_tr_b16 a[198:199], v23 offset:17408
s_waitcnt lgkmcnt(0)
s_waitcnt vmcnt(12)
s_barrier
s_add_u32 s37, s39, 3145728
s_add_u32 m0, s38, 16384
s_nop 0
buffer_load_dwordx4 v5, s[20:23], s37 offen lds
s_add_u32 s37, s39, 3178496
s_add_u32 m0, s38, 17408
s_nop 0
buffer_load_dwordx4 v5, s[20:23], s37 offen lds
s_add_u32 s37, s39, 3211264
s_add_u32 m0, s38, 18432
s_nop 0
buffer_load_dwordx4 v6, s[20:23], s37 offen lds
s_add_u32 s37, s39, 3244032
s_add_u32 m0, s38, 19456
s_nop 0
buffer_load_dwordx4 v6, s[20:23], s37 offen lds
ds_read_b64_tr_b16 a[128:129], v20 offset:0
ds_read_b64_tr_b16 a[130:131], v20 offset:1024
ds_read_b64_tr_b16 a[132:133], v22 offset:0
ds_read_b64_tr_b16 a[134:135], v22 offset:1024
ds_read_b64_tr_b16 a[200:201], v21 offset:0
ds_read_b64_tr_b16 a[202:203], v21 offset:1024
ds_read_b64_tr_b16 a[204:205], v23 offset:0
ds_read_b64_tr_b16 a[206:207], v23 offset:1024
s_waitcnt lgkmcnt(0)
s_waitcnt vmcnt(12)
s_barrier
s_add_u32 s37, s39, 3670016
s_add_u32 m0, s38, 0
s_nop 0
buffer_load_dwordx4 v5, s[20:23], s37 offen lds
s_add_u32 s37, s39, 3702784
s_add_u32 m0, s38, 1024
s_nop 0
buffer_load_dwordx4 v5, s[20:23], s37 offen lds
s_add_u32 s37, s39, 3735552
s_add_u32 m0, s38, 2048
s_nop 0
buffer_load_dwordx4 v6, s[20:23], s37 offen lds
s_add_u32 s37, s39, 3768320
s_add_u32 m0, s38, 3072
s_nop 0
buffer_load_dwordx4 v6, s[20:23], s37 offen lds
ds_read_b64_tr_b16 a[136:137], v20 offset:4096
ds_read_b64_tr_b16 a[138:139], v20 offset:5120
ds_read_b64_tr_b16 a[140:141], v22 offset:4096
ds_read_b64_tr_b16 a[142:143], v22 offset:5120
ds_read_b64_tr_b16 a[208:209], v21 offset:4096
ds_read_b64_tr_b16 a[210:211], v21 offset:5120
ds_read_b64_tr_b16 a[212:213], v23 offset:4096
ds_read_b64_tr_b16 a[214:215], v23 offset:5120
s_waitcnt lgkmcnt(0)
s_waitcnt vmcnt(12)
s_barrier
s_add_u32 s37, s39, 4194304
s_add_u32 m0, s38, 4096
s_nop 0
buffer_load_dwordx4 v5, s[20:23], s37 offen lds
s_add_u32 s37, s39, 4227072
s_add_u32 m0, s38, 5120
s_nop 0
buffer_load_dwordx4 v5, s[20:23], s37 offen lds
s_add_u32 s37, s39, 4259840
s_add_u32 m0, s38, 6144
s_nop 0
buffer_load_dwordx4 v6, s[20:23], s37 offen lds
s_add_u32 s37, s39, 4292608
s_add_u32 m0, s38, 7168
s_nop 0
buffer_load_dwordx4 v6, s[20:23], s37 offen lds
ds_read_b64_tr_b16 a[144:145], v20 offset:8192
ds_read_b64_tr_b16 a[146:147], v20 offset:9216
ds_read_b64_tr_b16 a[148:149], v22 offset:8192
ds_read_b64_tr_b16 a[150:151], v22 offset:9216
ds_read_b64_tr_b16 a[216:217], v21 offset:8192
ds_read_b64_tr_b16 a[218:219], v21 offset:9216
ds_read_b64_tr_b16 a[220:221], v23 offset:8192
ds_read_b64_tr_b16 a[222:223], v23 offset:9216
s_waitcnt lgkmcnt(0)
s_waitcnt vmcnt(12)
s_barrier
ds_read_b64_tr_b16 a[152:153], v20 offset:12288
ds_read_b64_tr_b16 a[154:155], v20 offset:13312
ds_read_b64_tr_b16 a[156:157], v22 offset:12288
ds_read_b64_tr_b16 a[158:159], v22 offset:13312
ds_read_b64_tr_b16 a[224:225], v21 offset:12288
ds_read_b64_tr_b16 a[226:227], v21 offset:13312
ds_read_b64_tr_b16 a[228:229], v23 offset:12288
ds_read_b64_tr_b16 a[230:231], v23 offset:13312
s_waitcnt lgkmcnt(0)
s_waitcnt vmcnt(8)
s_barrier
ds_read_b64_tr_b16 a[160:161], v20 offset:16384
ds_read_b64_tr_b16 a[162:163], v20 offset:17408
ds_read_b64_tr_b16 a[164:165], v22 offset:16384
ds_read_b64_tr_b16 a[166:167], v22 offset:17408
ds_read_b64_tr_b16 a[232:233], v21 offset:16384
ds_read_b64_tr_b16 a[234:235], v21 offset:17408
ds_read_b64_tr_b16 a[236:237], v23 offset:16384
ds_read_b64_tr_b16 a[238:239], v23 offset:17408
s_waitcnt lgkmcnt(0)
s_waitcnt vmcnt(4)
s_barrier
ds_read_b64_tr_b16 a[168:169], v20 offset:0
ds_read_b64_tr_b16 a[170:171], v20 offset:1024
ds_read_b64_tr_b16 a[172:173], v22 offset:0
ds_read_b64_tr_b16 a[174:175], v22 offset:1024
ds_read_b64_tr_b16 a[240:241], v21 offset:0
ds_read_b64_tr_b16 a[242:243], v21 offset:1024
ds_read_b64_tr_b16 a[244:245], v23 offset:0
ds_read_b64_tr_b16 a[246:247], v23 offset:1024
s_waitcnt lgkmcnt(0)
s_waitcnt vmcnt(0)
s_barrier
ds_read_b64_tr_b16 a[176:177], v20 offset:4096
ds_read_b64_tr_b16 a[178:179], v20 offset:5120
ds_read_b64_tr_b16 a[180:181], v22 offset:4096
ds_read_b64_tr_b16 a[182:183], v22 offset:5120
ds_read_b64_tr_b16 a[248:249], v21 offset:4096
ds_read_b64_tr_b16 a[250:251], v21 offset:5120
ds_read_b64_tr_b16 a[252:253], v23 offset:4096
ds_read_b64_tr_b16 a[254:255], v23 offset:5120
s_waitcnt lgkmcnt(0)
s_lshl_b32 s42, s33, 5
s_add_u32 s42, s42, s32
s_lshl_b32 s39, s42, 13
s_lshl_b32 s37, s34, 11
s_add_u32 s39, s39, s37
s_add_u32 s39, s39, 50331648
s_lshl_b32 s40, s42, 14
s_add_u32 s40, s40, 16777216
s_lshl_b32 s37, s34, 12
s_add_u32 s41, s40, s37
s_lshr_b32 s37, s34, 1
s_lshl_b32 s37, s37, 10
s_add_u32 s40, s40, s37
s_and_b32 s37, s34, 1
s_lshl_b32 s37, s37, 6
s_add_u32 s40, s40, s37
s_mov_b32 s35, 0
s_mov_b32 s48, 36864
s_lshl_b32 s49, s32, 5
s_lshl_b32 s37, s33, 2
s_add_u32 s49, s49, s37
s_add_u32 s49, s49, s34
s_lshl_b32 s49, s49, 2
s_add_u32 s49, s49, 327680
s_waitcnt vmcnt(0)
.p2align 6
L_q_loop:
s_waitcnt vmcnt(7)
s_barrier
s_add_u32 s43, s43, 147456
s_add_u32 s44, s44, s48
ds_read_b128 v[64:67], v3 offset:0
ds_read_b128 v[68:71], v3 offset:1024
ds_read_b128 v[72:75], v3 offset:2048
ds_read_b128 v[76:79], v3 offset:3072
s_waitcnt lgkmcnt(2)
v_mfma_f32_16x16x32_bf16 v[16:19], v[80:83], v[64:67], 0
v_mfma_f32_16x16x32_bf16 v[20:23], v[80:83], v[68:71], 0
v_mfma_f32_16x16x32_bf16 v[24:27], v[152:155], v[64:67], 0
v_mfma_f32_16x16x32_bf16 v[28:31], v[152:155], v[68:71], 0
s_add_u32 s37, s43, 0
s_add_u32 m0, s44, 0
s_nop 0
buffer_load_dwordx4 v2, s[8:11], s37 offen lds
v_mfma_f32_16x16x32_bf16 v[32:35], v[224:227], v[64:67], 0
v_mfma_f32_16x16x32_bf16 v[36:39], v[224:227], v[68:71], 0
v_mfma_f32_16x16x32_bf16 v[40:43], a[40:43], v[64:67], 0
v_mfma_f32_16x16x32_bf16 v[44:47], a[40:43], v[68:71], 0
v_mfma_f32_16x16x32_bf16 v[48:51], v[64:67], a[112:115], 0
v_mfma_f32_16x16x32_bf16 v[52:55], v[68:71], a[112:115], 0
v_mfma_f32_16x16x32_bf16 v[56:59], v[64:67], a[184:187], 0
v_mfma_f32_16x16x32_bf16 v[60:63], v[68:71], a[184:187], 0
ds_read_b128 v[64:67], v3 offset:4096
ds_read_b128 v[68:71], v3 offset:5120
s_waitcnt lgkmcnt(2)
v_mfma_f32_16x16x32_bf16 v[16:19], v[84:87], v[72:75], v[16:19]
v_mfma_f32_16x16x32_bf16 v[20:23], v[84:87], v[76:79], v[20:23]
v_mfma_f32_16x16x32_bf16 v[24:27], v[156:159], v[72:75], v[24:27]
v_mfma_f32_16x16x32_bf16 v[28:31], v[156:159], v[76:79], v[28:31]
s_add_u32 s37, s43, 128
s_add_u32 m0, s44, 4096
s_nop 0
buffer_load_dwordx4 v2, s[8:11], s37 offen lds
v_mfma_f32_16x16x32_bf16 v[32:35], v[228:231], v[72:75], v[32:35]
v_mfma_f32_16x16x32_bf16 v[36:39], v[228:231], v[76:79], v[36:39]
v_mfma_f32_16x16x32_bf16 v[40:43], a[44:47], v[72:75], v[40:43]
v_mfma_f32_16x16x32_bf16 v[44:47], a[44:47], v[76:79], v[44:47]
v_mfma_f32_16x16x32_bf16 v[48:51], v[72:75], a[116:119], v[48:51]
v_mfma_f32_16x16x32_bf16 v[52:55], v[76:79], a[116:119], v[52:55]
v_mfma_f32_16x16x32_bf16 v[56:59], v[72:75], a[188:191], v[56:59]
v_mfma_f32_16x16x32_bf16 v[60:63], v[76:79], a[188:191], v[60:63]
ds_read_b128 v[72:75], v3 offset:6144
ds_read_b128 v[76:79], v3 offset:7168
s_waitcnt lgkmcnt(2)
v_mfma_f32_16x16x32_bf16 v[16:19], v[88:91], v[64:67], v[16:19]
v_mfma_f32_16x16x32_bf16 v[20:23], v[88:91], v[68:71], v[20:23]
v_mfma_f32_16x16x32_bf16 v[24:27], v[160:163], v[64:67], v[24:27]
v_mfma_f32_16x16x32_bf16 v[28:31], v[160:163], v[68:71], v[28:31]
s_add_u32 s37, s43, 256
s_add_u32 m0, s44, 8192
s_nop 0
buffer_load_dwordx4 v2, s[8:11], s37 offen lds
v_mfma_f32_16x16x32_bf16 v[32:35], v[232:235], v[64:67], v[32:35]
v_mfma_f32_16x16x32_bf16 v[36:39], v[232:235], v[68:71], v[36:39]
v_mfma_f32_16x16x32_bf16 v[40:43], a[48:51], v[64:67], v[40:43]
v_mfma_f32_16x16x32_bf16 v[44:47], a[48:51], v[68:71], v[44:47]
v_mfma_f32_16x16x32_bf16 v[48:51], v[64:67], a[120:123], v[48:51]
v_mfma_f32_16x16x32_bf16 v[52:55], v[68:71], a[120:123], v[52:55]
v_mfma_f32_16x16x32_bf16 v[56:59], v[64:67], a[192:195], v[56:59]
v_mfma_f32_16x16x32_bf16 v[60:63], v[68:71], a[192:195], v[60:63]
ds_read_b128 v[64:67], v3 offset:8192
ds_read_b128 v[68:71], v3 offset:9216
s_waitcnt lgkmcnt(2)
v_mfma_f32_16x16x32_bf16 v[16:19], v[92:95], v[72:75], v[16:19]
v_mfma_f32_16x16x32_bf16 v[20:23], v[92:95], v[76:79], v[20:23]
v_mfma_f32_16x16x32_bf16 v[24:27], v[164:167], v[72:75], v[24:27]
v_mfma_f32_16x16x32_bf16 v[28:31], v[164:167], v[76:79], v[28:31]
s_add_u32 s37, s43, 384
s_add_u32 m0, s44, 12288
s_nop 0
buffer_load_dwordx4 v2, s[8:11], s37 offen lds
v_mfma_f32_16x16x32_bf16 v[32:35], v[236:239], v[72:75], v[32:35]
v_mfma_f32_16x16x32_bf16 v[36:39], v[236:239], v[76:79], v[36:39]
v_mfma_f32_16x16x32_bf16 v[40:43], a[52:55], v[72:75], v[40:43]
v_mfma_f32_16x16x32_bf16 v[44:47], a[52:55], v[76:79], v[44:47]
v_mfma_f32_16x16x32_bf16 v[48:51], v[72:75], a[124:127], v[48:51]
v_mfma_f32_16x16x32_bf16 v[52:55], v[76:79], a[124:127], v[52:55]
v_mfma_f32_16x16x32_bf16 v[56:59], v[72:75], a[196:199], v[56:59]
v_mfma_f32_16x16x32_bf16 v[60:63], v[76:79], a[196:199], v[60:63]
ds_read_b128 v[72:75], v3 offset:10240
ds_read_b128 v[76:79], v3 offset:11264
s_waitcnt lgkmcnt(2)
v_mfma_f32_16x16x32_bf16 v[16:19], v[96:99], v[64:67], v[16:19]
v_mfma_f32_16x16x32_bf16 v[20:23], v[96:99], v[68:71], v[20:23]
v_mfma_f32_16x16x32_bf16 v[24:27], v[168:171], v[64:67], v[24:27]
v_mfma_f32_16x16x32_bf16 v[28:31], v[168:171], v[68:71], v[28:31]
s_add_u32 s37, s43, 512
s_add_u32 m0, s44, 16384
s_nop 0
buffer_load_dwordx4 v2, s[8:11], s37 offen lds
v_mfma_f32_16x16x32_bf16 v[32:35], v[240:243], v[64:67], v[32:35]
v_mfma_f32_16x16x32_bf16 v[36:39], v[240:243], v[68:71], v[36:39]
v_mfma_f32_16x16x32_bf16 v[40:43], a[56:59], v[64:67], v[40:43]
v_mfma_f32_16x16x32_bf16 v[44:47], a[56:59], v[68:71], v[44:47]
v_mfma_f32_16x16x32_bf16 v[48:51], v[64:67], a[128:131], v[48:51]
v_mfma_f32_16x16x32_bf16 v[52:55], v[68:71], a[128:131], v[52:55]
v_mfma_f32_16x16x32_bf16 v[56:59], v[64:67], a[200:203], v[56:59]
v_mfma_f32_16x16x32_bf16 v[60:63], v[68:71], a[200:203], v[60:63]
ds_read_b128 v[64:67], v3 offset:12288
ds_read_b128 v[68:71], v3 offset:13312
s_waitcnt lgkmcnt(2)
v_mfma_f32_16x16x32_bf16 v[16:19], v[100:103], v[72:75], v[16:19]
v_mfma_f32_16x16x32_bf16 v[20:23], v[100:103], v[76:79], v[20:23]
v_mfma_f32_16x16x32_bf16 v[24:27], v[172:175], v[72:75], v[24:27]
v_mfma_f32_16x16x32_bf16 v[28:31], v[172:175], v[76:79], v[28:31]
s_add_u32 s37, s43, 640
s_add_u32 m0, s44, 20480
s_nop 0
buffer_load_dwordx4 v2, s[8:11], s37 offen lds
v_mfma_f32_16x16x32_bf16 v[32:35], v[244:247], v[72:75], v[32:35]
v_mfma_f32_16x16x32_bf16 v[36:39], v[244:247], v[76:79], v[36:39]
v_mfma_f32_16x16x32_bf16 v[40:43], a[60:63], v[72:75], v[40:43]
v_mfma_f32_16x16x32_bf16 v[44:47], a[60:63], v[76:79], v[44:47]
v_mfma_f32_16x16x32_bf16 v[48:51], v[72:75], a[132:135], v[48:51]
v_mfma_f32_16x16x32_bf16 v[52:55], v[76:79], a[132:135], v[52:55]
v_mfma_f32_16x16x32_bf16 v[56:59], v[72:75], a[204:207], v[56:59]
v_mfma_f32_16x16x32_bf16 v[60:63], v[76:79], a[204:207], v[60:63]
ds_read_b128 v[72:75], v3 offset:14336
ds_read_b128 v[76:79], v3 offset:15360
s_waitcnt lgkmcnt(2)
v_mfma_f32_16x16x32_bf16 v[16:19], v[104:107], v[64:67], v[16:19]
v_mfma_f32_16x16x32_bf16 v[20:23], v[104:107], v[68:71], v[20:23]
v_mfma_f32_16x16x32_bf16 v[24:27], v[176:179], v[64:67], v[24:27]
v_mfma_f32_16x16x32_bf16 v[28:31], v[176:179], v[68:71], v[28:31]
s_add_u32 s37, s43, 768
s_add_u32 m0, s44, 24576
s_nop 0
buffer_load_dwordx4 v2, s[8:11], s37 offen lds
v_mfma_f32_16x16x32_bf16 v[32:35], v[248:251], v[64:67], v[32:35]
v_mfma_f32_16x16x32_bf16 v[36:39], v[248:251], v[68:71], v[36:39]
v_mfma_f32_16x16x32_bf16 v[40:43], a[64:67], v[64:67], v[40:43]
v_mfma_f32_16x16x32_bf16 v[44:47], a[64:67], v[68:71], v[44:47]
v_mfma_f32_16x16x32_bf16 v[48:51], v[64:67], a[136:139], v[48:51]
v_mfma_f32_16x16x32_bf16 v[52:55], v[68:71], a[136:139], v[52:55]
v_mfma_f32_16x16x32_bf16 v[56:59], v[64:67], a[208:211], v[56:59]
v_mfma_f32_16x16x32_bf16 v[60:63], v[68:71], a[208:211], v[60:63]
ds_read_b128 v[64:67], v3 offset:16384
ds_read_b128 v[68:71], v3 offset:17408
s_waitcnt lgkmcnt(2)
v_mfma_f32_16x16x32_bf16 v[16:19], v[108:111], v[72:75], v[16:19]
v_mfma_f32_16x16x32_bf16 v[20:23], v[108:111], v[76:79], v[20:23]
v_mfma_f32_16x16x32_bf16 v[24:27], v[180:183], v[72:75], v[24:27]
v_mfma_f32_16x16x32_bf16 v[28:31], v[180:183], v[76:79], v[28:31]
s_add_u32 s37, s43, 896
s_add_u32 m0, s44, 28672
s_nop 0
buffer_load_dwordx4 v2, s[8:11], s37 offen lds
v_mfma_f32_16x16x32_bf16 v[32:35], v[252:255], v[72:75], v[32:35]
v_mfma_f32_16x16x32_bf16 v[36:39], v[252:255], v[76:79], v[36:39]
v_mfma_f32_16x16x32_bf16 v[40:43], a[68:71], v[72:75], v[40:43]
v_mfma_f32_16x16x32_bf16 v[44:47], a[68:71], v[76:79], v[44:47]
v_mfma_f32_16x16x32_bf16 v[48:51], v[72:75], a[140:143], v[48:51]
v_mfma_f32_16x16x32_bf16 v[52:55], v[76:79], a[140:143], v[52:55]
v_mfma_f32_16x16x32_bf16 v[56:59], v[72:75], a[212:215], v[56:59]
v_mfma_f32_16x16x32_bf16 v[60:63], v[76:79], a[212:215], v[60:63]
ds_read_b128 v[72:75], v3 offset:18432
ds_read_b128 v[76:79], v3 offset:19456
s_waitcnt lgkmcnt(2)
v_mfma_f32_16x16x32_bf16 v[16:19], v[112:115], v[64:67], v[16:19]
v_mfma_f32_16x16x32_bf16 v[20:23], v[112:115], v[68:71], v[20:23]
v_mfma_f32_16x16x32_bf16 v[24:27], v[184:187], v[64:67], v[24:27]
v_mfma_f32_16x16x32_bf16 v[28:31], v[184:187], v[68:71], v[28:31]
s_add_u32 s37, s43, 1024
s_add_u32 m0, s44, 32768
s_nop 0
buffer_load_dwordx4 v2, s[8:11], s37 offen lds
v_mfma_f32_16x16x32_bf16 v[32:35], a[0:3], v[64:67], v[32:35]
v_mfma_f32_16x16x32_bf16 v[36:39], a[0:3], v[68:71], v[36:39]
v_mfma_f32_16x16x32_bf16 v[40:43], a[72:75], v[64:67], v[40:43]
v_mfma_f32_16x16x32_bf16 v[44:47], a[72:75], v[68:71], v[44:47]
v_mfma_f32_16x16x32_bf16 v[48:51], v[64:67], a[144:147], v[48:51]
v_mfma_f32_16x16x32_bf16 v[52:55], v[68:71], a[144:147], v[52:55]
v_mfma_f32_16x16x32_bf16 v[56:59], v[64:67], a[216:219], v[56:59]
v_mfma_f32_16x16x32_bf16 v[60:63], v[68:71], a[216:219], v[60:63]
ds_read_b128 v[64:67], v3 offset:20480
ds_read_b128 v[68:71], v3 offset:21504
s_waitcnt lgkmcnt(2)
v_mfma_f32_16x16x32_bf16 v[16:19], v[116:119], v[72:75], v[16:19]
v_mfma_f32_16x16x32_bf16 v[20:23], v[116:119], v[76:79], v[20:23]
v_mfma_f32_16x16x32_bf16 v[24:27], v[188:191], v[72:75], v[24:27]
v_mfma_f32_16x16x32_bf16 v[28:31], v[188:191], v[76:79], v[28:31]
v_mfma_f32_16x16x32_bf16 v[32:35], a[4:7], v[72:75], v[32:35]
v_mfma_f32_16x16x32_bf16 v[36:39], a[4:7], v[76:79], v[36:39]
v_mfma_f32_16x16x32_bf16 v[40:43], a[76:79], v[72:75], v[40:43]
v_mfma_f32_16x16x32_bf16 v[44:47], a[76:79], v[76:79], v[44:47]
v_mfma_f32_16x16x32_bf16 v[48:51], v[72:75], a[148:151], v[48:51]
v_mfma_f32_16x16x32_bf16 v[52:55], v[76:79], a[148:151], v[52:55]
v_mfma_f32_16x16x32_bf16 v[56:59], v[72:75], a[220:223], v[56:59]
v_mfma_f32_16x16x32_bf16 v[60:63], v[76:79], a[220:223], v[60:63]
ds_read_b128 v[72:75], v3 offset:22528
ds_read_b128 v[76:79], v3 offset:23552
s_waitcnt lgkmcnt(2)
v_mfma_f32_16x16x32_bf16 v[16:19], v[120:123], v[64:67], v[16:19]
v_mfma_f32_16x16x32_bf16 v[20:23], v[120:123], v[68:71], v[20:23]
v_mfma_f32_16x16x32_bf16 v[24:27], v[192:195], v[64:67], v[24:27]
v_mfma_f32_16x16x32_bf16 v[28:31], v[192:195], v[68:71], v[28:31]
s_waitcnt vmcnt(9)
v_mov_b32 v12, s35
s_mov_b64 exec, 1
buffer_store_dword v12, v8, s[4:7], s49 offen sc0 sc1
s_mov_b64 exec, -1
v_mfma_f32_16x16x32_bf16 v[32:35], a[8:11], v[64:67], v[32:35]
v_mfma_f32_16x16x32_bf16 v[36:39], a[8:11], v[68:71], v[36:39]
v_mfma_f32_16x16x32_bf16 v[40:43], a[80:83], v[64:67], v[40:43]
v_mfma_f32_16x16x32_bf16 v[44:47], a[80:83], v[68:71], v[44:47]
v_mfma_f32_16x16x32_bf16 v[48:51], v[64:67], a[152:155], v[48:51]
v_mfma_f32_16x16x32_bf16 v[52:55], v[68:71], a[152:155], v[52:55]
v_mfma_f32_16x16x32_bf16 v[56:59], v[64:67], a[224:227], v[56:59]
v_mfma_f32_16x16x32_bf16 v[60:63], v[68:71], a[224:227], v[60:63]
ds_read_b128 v[64:67], v3 offset:24576
ds_read_b128 v[68:71], v3 offset:25600
s_waitcnt lgkmcnt(2)
v_mfma_f32_16x16x32_bf16 v[16:19], v[124:127], v[72:75], v[16:19]
v_mfma_f32_16x16x32_bf16 v[20:23], v[124:127], v[76:79], v[20:23]
v_mfma_f32_16x16x32_bf16 v[24:27], v[196:199], v[72:75], v[24:27]
v_mfma_f32_16x16x32_bf16 v[28:31], v[196:199], v[76:79], v[28:31]
v_mfma_f32_16x16x32_bf16 v[32:35], a[12:15], v[72:75], v[32:35]
v_mfma_f32_16x16x32_bf16 v[36:39], a[12:15], v[76:79], v[36:39]
v_mfma_f32_16x16x32_bf16 v[40:43], a[84:87], v[72:75], v[40:43]
v_mfma_f32_16x16x32_bf16 v[44:47], a[84:87], v[76:79], v[44:47]
v_mfma_f32_16x16x32_bf16 v[48:51], v[72:75], a[156:159], v[48:51]
v_mfma_f32_16x16x32_bf16 v[52:55], v[76:79], a[156:159], v[52:55]
v_mfma_f32_16x16x32_bf16 v[56:59], v[72:75], a[228:231], v[56:59]
v_mfma_f32_16x16x32_bf16 v[60:63], v[76:79], a[228:231], v[60:63]
ds_read_b128 v[72:75], v3 offset:26624
ds_read_b128 v[76:79], v3 offset:27648
s_waitcnt lgkmcnt(2)
v_mfma_f32_16x16x32_bf16 v[16:19], v[128:131], v[64:67], v[16:19]
v_mfma_f32_16x16x32_bf16 v[20:23], v[128:131], v[68:71], v[20:23]
v_mfma_f32_16x16x32_bf16 v[24:27], v[200:203], v[64:67], v[24:27]
v_mfma_f32_16x16x32_bf16 v[28:31], v[200:203], v[68:71], v[28:31]
v_mfma_f32_16x16x32_bf16 v[32:35], a[16:19], v[64:67], v[32:35]
v_mfma_f32_16x16x32_bf16 v[36:39], a[16:19], v[68:71], v[36:39]
v_mfma_f32_16x16x32_bf16 v[40:43], a[88:91], v[64:67], v[40:43]
v_mfma_f32_16x16x32_bf16 v[44:47], a[88:91], v[68:71], v[44:47]
v_mfma_f32_16x16x32_bf16 v[48:51], v[64:67], a[160:163], v[48:51]
v_mfma_f32_16x16x32_bf16 v[52:55], v[68:71], a[160:163], v[52:55]
v_mfma_f32_16x16x32_bf16 v[56:59], v[64:67], a[232:235], v[56:59]
v_mfma_f32_16x16x32_bf16 v[60:63], v[68:71], a[232:235], v[60:63]
ds_read_b128 v[64:67], v3 offset:28672
ds_read_b128 v[68:71], v3 offset:29696
s_waitcnt lgkmcnt(2)
v_mfma_f32_16x16x32_bf16 v[16:19], v[132:135], v[72:75], v[16:19]
v_mfma_f32_16x16x32_bf16 v[20:23], v[132:135], v[76:79], v[20:23]
v_mfma_f32_16x16x32_bf16 v[24:27], v[204:207], v[72:75], v[24:27]
v_mfma_f32_16x16x32_bf16 v[28:31], v[204:207], v[76:79], v[28:31]
v_mfma_f32_16x16x32_bf16 v[32:35], a[20:23], v[72:75], v[32:35]
v_mfma_f32_16x16x32_bf16 v[36:39], a[20:23], v[76:79], v[36:39]
v_mfma_f32_16x16x32_bf16 v[40:43], a[92:95], v[72:75], v[40:43]
v_mfma_f32_16x16x32_bf16 v[44:47], a[92:95], v[76:79], v[44:47]
v_mfma_f32_16x16x32_bf16 v[48:51], v[72:75], a[164:167], v[48:51]
v_mfma_f32_16x16x32_bf16 v[52:55], v[76:79], a[164:167], v[52:55]
v_mfma_f32_16x16x32_bf16 v[56:59], v[72:75], a[236:239], v[56:59]
v_mfma_f32_16x16x32_bf16 v[60:63], v[76:79], a[236:239], v[60:63]
ds_read_b128 v[72:75], v3 offset:30720
ds_read_b128 v[76:79], v3 offset:31744
s_waitcnt lgkmcnt(2)
v_mfma_f32_16x16x32_bf16 v[16:19], v[136:139], v[64:67], v[16:19]
v_mfma_f32_16x16x32_bf16 v[20:23], v[136:139], v[68:71], v[20:23]
v_mfma_f32_16x16x32_bf16 v[24:27], v[208:211], v[64:67], v[24:27]
v_mfma_f32_16x16x32_bf16 v[28:31], v[208:211], v[68:71], v[28:31]
v_mfma_f32_16x16x32_bf16 v[32:35], a[24:27], v[64:67], v[32:35]
v_mfma_f32_16x16x32_bf16 v[36:39], a[24:27], v[68:71], v[36:39]
v_mfma_f32_16x16x32_bf16 v[40:43], a[96:99], v[64:67], v[40:43]
v_mfma_f32_16x16x32_bf16 v[44:47], a[96:99], v[68:71], v[44:47]
v_mfma_f32_16x16x32_bf16 v[48:51], v[64:67], a[168:171], v[48:51]
v_mfma_f32_16x16x32_bf16 v[52:55], v[68:71], a[168:171], v[52:55]
v_mfma_f32_16x16x32_bf16 v[56:59], v[64:67], a[240:243], v[56:59]
v_mfma_f32_16x16x32_bf16 v[60:63], v[68:71], a[240:243], v[60:63]
ds_read_b128 v[64:67], v3 offset:32768
ds_read_b128 v[68:71], v3 offset:33792
s_waitcnt lgkmcnt(2)
v_mfma_f32_16x16x32_bf16 v[16:19], v[140:143], v[72:75], v[16:19]
v_mfma_f32_16x16x32_bf16 v[20:23], v[140:143], v[76:79], v[20:23]
v_mfma_f32_16x16x32_bf16 v[24:27], v[212:215], v[72:75], v[24:27]
v_mfma_f32_16x16x32_bf16 v[28:31], v[212:215], v[76:79], v[28:31]
v_mfma_f32_16x16x32_bf16 v[32:35], a[28:31], v[72:75], v[32:35]
v_mfma_f32_16x16x32_bf16 v[36:39], a[28:31], v[76:79], v[36:39]
v_mfma_f32_16x16x32_bf16 v[40:43], a[100:103], v[72:75], v[40:43]
v_mfma_f32_16x16x32_bf16 v[44:47], a[100:103], v[76:79], v[44:47]
v_mfma_f32_16x16x32_bf16 v[48:51], v[72:75], a[172:175], v[48:51]
v_mfma_f32_16x16x32_bf16 v[52:55], v[76:79], a[172:175], v[52:55]
v_mfma_f32_16x16x32_bf16 v[56:59], v[72:75], a[244:247], v[56:59]
v_mfma_f32_16x16x32_bf16 v[60:63], v[76:79], a[244:247], v[60:63]
ds_read_b128 v[72:75], v3 offset:34816
ds_read_b128 v[76:79], v3 offset:35840
s_waitcnt lgkmcnt(2)
v_mfma_f32_16x16x32_bf16 v[16:19], v[144:147], v[64:67], v[16:19]
v_mfma_f32_16x16x32_bf16 v[20:23], v[144:147], v[68:71], v[20:23]
v_mfma_f32_16x16x32_bf16 v[24:27], v[216:219], v[64:67], v[24:27]
v_mfma_f32_16x16x32_bf16 v[28:31], v[216:219], v[68:71], v[28:31]
v_mfma_f32_16x16x32_bf16 v[32:35], a[32:35], v[64:67], v[32:35]
v_mfma_f32_16x16x32_bf16 v[36:39], a[32:35], v[68:71], v[36:39]
v_mfma_f32_16x16x32_bf16 v[40:43], a[104:107], v[64:67], v[40:43]
v_mfma_f32_16x16x32_bf16 v[44:47], a[104:107], v[68:71], v[44:47]
v_mfma_f32_16x16x32_bf16 v[48:51], v[64:67], a[176:179], v[48:51]
v_mfma_f32_16x16x32_bf16 v[52:55], v[68:71], a[176:179], v[52:55]
v_mfma_f32_16x16x32_bf16 v[56:59], v[64:67], a[248:251], v[56:59]
v_mfma_f32_16x16x32_bf16 v[60:63], v[68:71], a[248:251], v[60:63]
s_waitcnt lgkmcnt(0)
v_mfma_f32_16x16x32_bf16 v[16:19], v[148:151], v[72:75], v[16:19]
v_mfma_f32_16x16x32_bf16 v[20:23], v[148:151], v[76:79], v[20:23]
v_mfma_f32_16x16x32_bf16 v[24:27], v[220:223], v[72:75], v[24:27]
v_mfma_f32_16x16x32_bf16 v[28:31], v[220:223], v[76:79], v[28:31]
v_mfma_f32_16x16x32_bf16 v[32:35], a[36:39], v[72:75], v[32:35]
v_mfma_f32_16x16x32_bf16 v[36:39], a[36:39], v[76:79], v[36:39]
v_mfma_f32_16x16x32_bf16 v[40:43], a[108:111], v[72:75], v[40:43]
v_mfma_f32_16x16x32_bf16 v[44:47], a[108:111], v[76:79], v[44:47]
v_mfma_f32_16x16x32_bf16 v[48:51], v[72:75], a[180:183], v[48:51]
v_mfma_f32_16x16x32_bf16 v[52:55], v[76:79], a[180:183], v[52:55]
v_mfma_f32_16x16x32_bf16 v[56:59], v[72:75], a[252:255], v[56:59]
v_mfma_f32_16x16x32_bf16 v[60:63], v[76:79], a[252:255], v[60:63]
v_add_u32 v3, s48, v3
s_sub_u32 s48, 0, s48
v_cvt_pk_bf16_f32 v64, v16, v17
v_cvt_pk_bf16_f32 v65, v18, v19
v_cvt_pk_bf16_f32 v66, v24, v25
v_cvt_pk_bf16_f32 v67, v26, v27
buffer_store_dwordx4 v[64:67], v1, s[4:7], s39 offen offset:0
v_cvt_pk_bf16_f32 v68, v20, v21
v_cvt_pk_bf16_f32 v69, v22, v23
v_cvt_pk_bf16_f32 v70, v28, v29
v_cvt_pk_bf16_f32 v71, v30, v31
buffer_store_dwordx4 v[68:71], v1, s[4:7], s39 offen offset:1024
v_pk_mul_f32 v[32:33], v[32:33], s[46:47]
v_pk_mul_f32 v[34:35], v[34:35], s[46:47]
v_pk_mul_f32 v[36:37], v[36:37], s[46:47]
v_pk_mul_f32 v[38:39], v[38:39], s[46:47]
v_pk_mul_f32 v[40:41], v[40:41], s[46:47]
v_pk_mul_f32 v[42:43], v[42:43], s[46:47]
v_pk_mul_f32 v[44:45], v[44:45], s[46:47]
v_pk_mul_f32 v[46:47], v[46:47], s[46:47]
v_cvt_pk_bf16_f32 v72, v32, v33
v_cvt_pk_bf16_f32 v73, v34, v35
v_cvt_pk_bf16_f32 v74, v40, v41
v_cvt_pk_bf16_f32 v75, v42, v43
buffer_store_dwordx4 v[72:75], v4, s[4:7], s40 offen offset:0 sc0 sc1
v_cvt_pk_bf16_f32 v76, v36, v37
v_cvt_pk_bf16_f32 v77, v38, v39
v_cvt_pk_bf16_f32 v78, v44, v45
v_cvt_pk_bf16_f32 v79, v46, v47
buffer_store_dwordx4 v[76:79], v4, s[4:7], s40 offen offset:128 sc0 sc1
v_cvt_pk_bf16_f32 v16, v48, v49
v_cvt_pk_bf16_f32 v17, v50, v51
v_cvt_pk_bf16_f32 v18, v52, v53
v_cvt_pk_bf16_f32 v19, v54, v55
buffer_store_dwordx4 v[16:19], v1, s[4:7], s41 offen offset:2048 sc0 sc1
v_cvt_pk_bf16_f32 v20, v56, v57
v_cvt_pk_bf16_f32 v21, v58, v59
v_cvt_pk_bf16_f32 v22, v60, v61
v_cvt_pk_bf16_f32 v23, v62, v63
buffer_store_dwordx4 v[20:23], v1, s[4:7], s41 offen offset:3072 sc0 sc1
s_add_u32 s39, s39, 1048576
s_add_u32 s40, s40, 2097152
s_add_u32 s41, s41, 2097152
s_add_u32 s35, s35, 1
s_cmp_lg_u32 s35, 1
s_cbranch_scc1 L_q_n1
s_branch L_q_init_in
L_q_init:
s_sleep 4
L_q_init_in:
buffer_load_dword v12, v8, s[24:27], 0 offen offset:0 sc0 sc1
s_sub_u32 s36, s36, 1
s_cbranch_scc1 L_exit_w
s_waitcnt vmcnt(0)
v_readfirstlane_b32 s37, v12
s_nop 0
s_and_b32 s37, s37, 0xff
s_cmp_eq_u32 s37, 32
s_cbranch_scc0 L_q_init
v_mov_b32 v12, s35
s_mov_b64 exec, 1
buffer_store_dword v12, v8, s[4:7], s49 offen sc0 sc1
s_mov_b64 exec, -1
s_waitcnt vmcnt(0)
L_q_n1:
s_cmp_lt_u32 s35, 16
s_cbranch_scc1 L_q_loop
s_waitcnt vmcnt(0)
v_mov_b32 v12, s35
s_mov_b64 exec, 1
buffer_store_dword v12, v8, s[4:7], s49 offen sc0 sc1
s_mov_b64 exec, -1
s_barrier
s_lshr_b32 s37, s34, 1
s_and_b32 s38, s34, 1
s_lshl_b32 s50, s42, 13
s_lshl_b32 s39, s37, 10
s_add_u32 s50, s50, s39
s_add_u32 s50, s50, 50331648
s_lshl_b32 s52, s42, 14
s_add_u32 s52, s52, 16777216
s_lshl_b32 s39, s38, 13
s_add_u32 s53, s52, s39
s_mul_i32 s55, s33, 10240
s_add_u32 s55, s55, 8388608
s_and_b32 s59, s33, 1
s_sub_u32 s59, s59, 1
s_lshl_b32 s39, s33, 1
s_add_u32 s39, s39, s37
s_lshl_b32 s56, s39, 6
s_lshl_b32 s40, s32, 1
s_add_u32 s40, s40, s38
s_add_u32 s56, s56, s40
s_lshl_b32 s58, s56, 2
s_add_u32 s58, s58, 331776
s_lshl_b32 s56, s56, 11
s_add_u32 s56, s56, 67108864
s_mov_b32 s35, 0
s_lshl_b32 s37, s37, 4
v_add_u32 v12, s37, v10
v_lshlrev_b32 v13, 2, v11
v_sub_u32 v12, v12, v13
v_mov_b32 v13, 0xf149f2ca
v_cmp_le_i32 vcc, 0, v12
s_nop 1
v_cndmask_b32 v80, v13, v8, vcc
v_cmp_le_i32 vcc, 1, v12
s_nop 1
v_cndmask_b32 v81, v13, v8, vcc
v_cmp_le_i32 vcc, 2, v12
s_nop 1
v_cndmask_b32 v82, v13, v8, vcc
v_cmp_le_i32 vcc, 3, v12
s_nop 1
v_cndmask_b32 v83, v13, v8, vcc
v_cmp_le_i32 vcc, 16, v12
s_nop 1
v_cndmask_b32 v84, v13, v8, vcc
v_cmp_le_i32 vcc, 17, v12
s_nop 1
v_cndmask_b32 v85, v13, v8, vcc
v_cmp_le_i32 vcc, 18, v12
s_nop 1
v_cndmask_b32 v86, v13, v8, vcc
v_cmp_le_i32 vcc, 19, v12
s_nop 1
v_cndmask_b32 v87, v13, v8, vcc
v_cmp_gt_u32 vcc, 2, v11
s_nop 1
v_cndmask_b32 v88, v13, v8, vcc
v_cndmask_b32 v89, v13, v8, vcc
v_cndmask_b32 v90, v13, v8, vcc
v_cndmask_b32 v91, v13, v8, vcc
v_mov_b32 v92, 0x3f803f80
v_mov_b32 v93, 0x3f803f80
v_mov_b32 v94, 0x3f803f80
v_mov_b32 v95, 0x3f803f80
v_lshrrev_b32 v12, 1, v11
v_lshlrev_b32 v14, 8, v12
v_and_b32 v12, 1, v11
v_lshl_add_u32 v14, v12, 5, v14
v_bfe_u32 v12, v10, 1, 2
v_lshl_add_u32 v14, v12, 6, v14
v_and_b32 v12, 1, v10
v_lshl_add_u32 v14, v12, 4, v14
s_lshl_b32 s37, s34, 8
v_lshl_add_u32 v15, v9, 2, s37
s_lshl_b32 s37, s34, 10
v_add_u32 v6, s37, v1
s_lshl_b32 s38, s38, 11
v_add_u32 v3, s38, v1
v_and_b32 v12, 3, v10
v_cmp_eq_u32 vcc, 0, v12
s_nop 1
v_cndmask_b32 v5, 0, 1, vcc
L_at_loop:
s_add_u32 s51, s50, 4096
s_add_u32 s54, s53, 4096
s_add_u32 s60, s55, 4096
s_add_u32 s57, s55, 8192
buffer_load_dwordx4 v[16:19], v1, s[4:7], s50 offen offset:0
buffer_load_dwordx4 v[32:35], v4, s[4:7], s52 offen offset:0 sc1
buffer_load_dwordx4 v[48:51], v4, s[4:7], s52 offen offset:128 sc1
buffer_load_dwordx4 v[20:23], v1, s[4:7], s50 offen offset:2048
buffer_load_dwordx4 v[36:39], v4, s[4:7], s52 offen offset:64 sc1
buffer_load_dwordx4 v[52:55], v4, s[4:7], s52 offen offset:192 sc1
buffer_load_dwordx4 v[24:27], v1, s[4:7], s51 offen offset:0
buffer_load_dwordx4 v[40:43], v4, s[4:7], s52 offen offset:1024 sc1
buffer_load_dwordx4 v[56:59], v4, s[4:7], s52 offen offset:1152 sc1
buffer_load_dwordx4 v[28:31], v1, s[4:7], s51 offen offset:2048
buffer_load_dwordx4 v[44:47], v4, s[4:7], s52 offen offset:1088 sc1
buffer_load_dwordx4 v[60:63], v4, s[4:7], s52 offen offset:1216 sc1
buffer_load_dwordx4 v[64:67], v1, s[4:7], s53 offen offset:2048 sc1
buffer_load_dwordx4 v[68:71], v1, s[4:7], s53 offen offset:3072 sc1
buffer_load_dwordx4 v[72:75], v1, s[4:7], s54 offen offset:2048 sc1
buffer_load_dwordx4 v[76:79], v1, s[4:7], s54 offen offset:3072 sc1
s_waitcnt vmcnt(13)
v_mfma_f32_16x16x32_bf16 v[96:99], v[32:35], v[16:19], v[80:83]
v_mfma_f32_16x16x32_bf16 v[100:103], v[48:51], v[16:19], v[84:87]
s_waitcnt vmcnt(10)
v_mfma_f32_16x16x32_bf16 v[96:99], v[36:39], v[20:23], v[96:99]
v_mfma_f32_16x16x32_bf16 v[100:103], v[52:55], v[20:23], v[100:103]
s_waitcnt vmcnt(7)
v_mfma_f32_16x16x32_bf16 v[96:99], v[40:43], v[24:27], v[96:99]
v_mfma_f32_16x16x32_bf16 v[100:103], v[56:59], v[24:27], v[100:103]
s_waitcnt vmcnt(4)
v_mfma_f32_16x16x32_bf16 v[96:99], v[44:47], v[28:31], v[96:99]
v_mfma_f32_16x16x32_bf16 v[100:103], v[60:63], v[28:31], v[100:103]
s_nop 3
v_max3_f32 v160, v96, v97, v98
s_nop 2
v_max3_f32 v160, v160, v99, v100
v_max3_f32 v160, v160, v101, v102
v_max_f32 v160, v160, v103
s_branch L_at_in
L_at_poll:
s_sleep 2
L_at_in:
buffer_load_dwordx4 v[164:167], v6, s[4:7], s55 offen sc0 sc1
buffer_load_dwordx4 v[168:171], v6, s[4:7], s60 offen sc0 sc1
buffer_load_dword v172, v15, s[4:7], s57 offen sc0 sc1
s_sub_u32 s36, s36, 1
s_cbranch_scc1 L_exit_w
s_waitcnt vmcnt(0)
v_bitop3_b32 v12, v164, v168, s59 bitop3:0x7e
v_bitop3_b32 v13, v172, s59, v5 bitop3:0x28
v_and_or_b32 v12, v12, 1, v13
v_cmp_ne_u32 vcc, 0, v12
s_cbranch_vccnz L_at_poll
ds_write_b128 v6, v[164:167]
ds_write_b128 v6, v[168:171] offset:4096
ds_write_b32 v15, v172 offset:8192
s_waitcnt lgkmcnt(0)
s_barrier
ds_read_b128 v[176:179], v14 offset:0
ds_read_b128 v[180:183], v14 offset:512
ds_read_b128 v[184:187], v14 offset:1024
ds_read_b128 v[188:191], v14 offset:1536
s_waitcnt lgkmcnt(3)
v_mfma_f32_16x16x32_bf16 v[192:195], v[224:227], v[176:179], 0
v_mfma_f32_16x16x32_bf16 v[196:199], a[40:43], v[176:179], 0
v_mfma_f32_16x16x32_bf16 v[200:203], v[176:179], a[112:115], 0
v_mfma_f32_16x16x32_bf16 v[204:207], v[176:179], a[184:187], 0
ds_read_b128 v[176:179], v14 offset:2048
s_waitcnt lgkmcnt(3)
v_mfma_f32_16x16x32_bf16 v[192:195], v[228:231], v[180:183], v[192:195]
v_mfma_f32_16x16x32_bf16 v[196:199], a[44:47], v[180:183], v[196:199]
v_mfma_f32_16x16x32_bf16 v[200:203], v[180:183], a[116:119], v[200:203]
v_mfma_f32_16x16x32_bf16 v[204:207], v[180:183], a[188:191], v[204:207]
ds_read_b128 v[180:183], v14 offset:2560
s_waitcnt lgkmcnt(3)
v_mfma_f32_16x16x32_bf16 v[192:195], v[232:235], v[184:187], v[192:195]
v_mfma_f32_16x16x32_bf16 v[196:199], a[48:51], v[184:187], v[196:199]
v_mfma_f32_16x16x32_bf16 v[200:203], v[184:187], a[120:123], v[200:203]
v_mfma_f32_16x16x32_bf16 v[204:207], v[184:187], a[192:195], v[204:207]
ds_read_b128 v[184:187], v14 offset:3072
s_waitcnt lgkmcnt(3)
v_mfma_f32_16x16x32_bf16 v[192:195], v[236:239], v[188:191], v[192:195]
v_mfma_f32_16x16x32_bf16 v[196:199], a[52:55], v[188:191], v[196:199]
v_mfma_f32_16x16x32_bf16 v[200:203], v[188:191], a[124:127], v[200:203]
v_mfma_f32_16x16x32_bf16 v[204:207], v[188:191], a[196:199], v[204:207]
ds_read_b128 v[188:191], v14 offset:3584
s_waitcnt lgkmcnt(3)
v_mfma_f32_16x16x32_bf16 v[192:195], v[240:243], v[176:179], v[192:195]
v_mfma_f32_16x16x32_bf16 v[196:199], a[56:59], v[176:179], v[196:199]
v_mfma_f32_16x16x32_bf16 v[200:203], v[176:179], a[128:131], v[200:203]
v_mfma_f32_16x16x32_bf16 v[204:207], v[176:179], a[200:203], v[204:207]
ds_read_b128 v[176:179], v14 offset:4096
s_waitcnt lgkmcnt(3)
v_mfma_f32_16x16x32_bf16 v[192:195], v[244:247], v[180:183], v[192:195]
v_mfma_f32_16x16x32_bf16 v[196:199], a[60:63], v[180:183], v[196:199]
v_mfma_f32_16x16x32_bf16 v[200:203], v[180:183], a[132:135], v[200:203]
v_mfma_f32_16x16x32_bf16 v[204:207], v[180:183], a[204:207], v[204:207]
ds_read_b128 v[180:183], v14 offset:4608
s_waitcnt lgkmcnt(3)
v_mfma_f32_16x16x32_bf16 v[192:195], v[248:251], v[184:187], v[192:195]
v_mfma_f32_16x16x32_bf16 v[196:199], a[64:67], v[184:187], v[196:199]
v_mfma_f32_16x16x32_bf16 v[200:203], v[184:187], a[136:139], v[200:203]
v_mfma_f32_16x16x32_bf16 v[204:207], v[184:187], a[208:211], v[204:207]
ds_read_b128 v[184:187], v14 offset:5120
s_waitcnt lgkmcnt(3)
v_mfma_f32_16x16x32_bf16 v[192:195], v[252:255], v[188:191], v[192:195]
v_mfma_f32_16x16x32_bf16 v[196:199], a[68:71], v[188:191], v[196:199]
v_mfma_f32_16x16x32_bf16 v[200:203], v[188:191], a[140:143], v[200:203]
v_mfma_f32_16x16x32_bf16 v[204:207], v[188:191], a[212:215], v[204:207]
ds_read_b128 v[188:191], v14 offset:5632
s_waitcnt lgkmcnt(3)
v_mfma_f32_16x16x32_bf16 v[192:195], a[0:3], v[176:179], v[192:195]
v_mfma_f32_16x16x32_bf16 v[196:199], a[72:75], v[176:179], v[196:199]
v_mfma_f32_16x16x32_bf16 v[200:203], v[176:179], a[144:147], v[200:203]
v_mfma_f32_16x16x32_bf16 v[204:207], v[176:179], a[216:219], v[204:207]
ds_read_b128 v[176:179], v14 offset:6144
s_waitcnt lgkmcnt(3)
v_mfma_f32_16x16x32_bf16 v[192:195], a[4:7], v[180:183], v[192:195]
v_mfma_f32_16x16x32_bf16 v[196:199], a[76:79], v[180:183], v[196:199]
v_mfma_f32_16x16x32_bf16 v[200:203], v[180:183], a[148:151], v[200:203]
v_mfma_f32_16x16x32_bf16 v[204:207], v[180:183], a[220:223], v[204:207]
ds_read_b128 v[180:183], v14 offset:6656
s_waitcnt lgkmcnt(3)
v_mfma_f32_16x16x32_bf16 v[192:195], a[8:11], v[184:187], v[192:195]
v_mfma_f32_16x16x32_bf16 v[196:199], a[80:83], v[184:187], v[196:199]
v_mfma_f32_16x16x32_bf16 v[200:203], v[184:187], a[152:155], v[200:203]
v_mfma_f32_16x16x32_bf16 v[204:207], v[184:187], a[224:227], v[204:207]
ds_read_b128 v[184:187], v14 offset:7168
s_waitcnt lgkmcnt(3)
v_mfma_f32_16x16x32_bf16 v[192:195], a[12:15], v[188:191], v[192:195]
v_mfma_f32_16x16x32_bf16 v[196:199], a[84:87], v[188:191], v[196:199]
v_mfma_f32_16x16x32_bf16 v[200:203], v[188:191], a[156:159], v[200:203]
v_mfma_f32_16x16x32_bf16 v[204:207], v[188:191], a[228:231], v[204:207]
ds_read_b128 v[188:191], v14 offset:7680
s_waitcnt lgkmcnt(3)
v_mfma_f32_16x16x32_bf16 v[192:195], a[16:19], v[176:179], v[192:195]
v_mfma_f32_16x16x32_bf16 v[196:199], a[88:91], v[176:179], v[196:199]
v_mfma_f32_16x16x32_bf16 v[200:203], v[176:179], a[160:163], v[200:203]
v_mfma_f32_16x16x32_bf16 v[204:207], v[176:179], a[232:235], v[204:207]
ds_read_b128 v[176:179], v14 offset:8192
s_waitcnt lgkmcnt(3)
v_mfma_f32_16x16x32_bf16 v[192:195], a[20:23], v[180:183], v[192:195]
v_mfma_f32_16x16x32_bf16 v[196:199], a[92:95], v[180:183], v[196:199]
v_mfma_f32_16x16x32_bf16 v[200:203], v[180:183], a[164:167], v[200:203]
v_mfma_f32_16x16x32_bf16 v[204:207], v[180:183], a[236:239], v[204:207]
ds_read_b128 v[180:183], v14 offset:8704
s_waitcnt lgkmcnt(3)
v_mfma_f32_16x16x32_bf16 v[192:195], a[24:27], v[184:187], v[192:195]
v_mfma_f32_16x16x32_bf16 v[196:199], a[96:99], v[184:187], v[196:199]
v_mfma_f32_16x16x32_bf16 v[200:203], v[184:187], a[168:171], v[200:203]
v_mfma_f32_16x16x32_bf16 v[204:207], v[184:187], a[240:243], v[204:207]
s_waitcnt lgkmcnt(2)
v_mfma_f32_16x16x32_bf16 v[192:195], a[28:31], v[188:191], v[192:195]
v_mfma_f32_16x16x32_bf16 v[196:199], a[100:103], v[188:191], v[196:199]
v_mfma_f32_16x16x32_bf16 v[200:203], v[188:191], a[172:175], v[200:203]
v_mfma_f32_16x16x32_bf16 v[204:207], v[188:191], a[244:247], v[204:207]
s_waitcnt lgkmcnt(1)
v_mfma_f32_16x16x32_bf16 v[192:195], a[32:35], v[176:179], v[192:195]
v_mfma_f32_16x16x32_bf16 v[196:199], a[104:107], v[176:179], v[196:199]
v_mfma_f32_16x16x32_bf16 v[200:203], v[176:179], a[176:179], v[200:203]
v_mfma_f32_16x16x32_bf16 v[204:207], v[176:179], a[248:251], v[204:207]
s_waitcnt lgkmcnt(0)
v_mfma_f32_16x16x32_bf16 v[192:195], a[36:39], v[180:183], v[192:195]
v_mfma_f32_16x16x32_bf16 v[196:199], a[108:111], v[180:183], v[196:199]
v_mfma_f32_16x16x32_bf16 v[200:203], v[180:183], a[180:183], v[200:203]
v_mfma_f32_16x16x32_bf16 v[204:207], v[180:183], a[252:255], v[204:207]
v_mul_f32 v192, s46, v192
v_mul_f32 v193, s46, v193
v_mul_f32 v194, s46, v194
v_mul_f32 v195, s46, v195
v_mul_f32 v196, s46, v196
v_mul_f32 v197, s46, v197
v_mul_f32 v198, s46, v198
v_mul_f32 v199, s46, v199
v_cvt_pk_bf16_f32 v208, v192, v193
v_cvt_pk_bf16_f32 v209, v194, v195
v_cvt_pk_bf16_f32 v210, v196, v197
v_cvt_pk_bf16_f32 v211, v198, v199
ds_write_b128 v6, v[208:211] offset:9216
v_cvt_pk_bf16_f32 v212, v200, v201
v_cvt_pk_bf16_f32 v213, v202, v203
v_cvt_pk_bf16_f32 v214, v204, v205
v_cvt_pk_bf16_f32 v215, v206, v207
ds_write_b128 v6, v[212:215] offset:13312
s_waitcnt lgkmcnt(0)
s_barrier
ds_read_b128 v[108:111], v1 offset:9216
ds_read_b128 v[112:115], v1 offset:10240
ds_read_b128 v[116:119], v1 offset:11264
ds_read_b128 v[120:123], v1 offset:12288
ds_read_b128 v[124:127], v3 offset:13312
ds_read_b128 v[128:131], v3 offset:14336
s_waitcnt lgkmcnt(5)
v_mfma_f32_16x16x32_bf16 v[104:107], v[108:111], v[16:19], v[88:91]
s_waitcnt lgkmcnt(4)
v_mfma_f32_16x16x32_bf16 v[104:107], v[112:115], v[20:23], v[104:107]
s_waitcnt lgkmcnt(3)
v_mfma_f32_16x16x32_bf16 v[104:107], v[116:119], v[24:27], v[104:107]
s_waitcnt lgkmcnt(2)
v_mfma_f32_16x16x32_bf16 v[104:107], v[120:123], v[28:31], v[104:107]
s_nop 7
v_max3_f32 v160, v160, v104, v105
v_max3_f32 v161, v160, v106, v107
v_max3_f32 v160, v160, v106, v107
s_nop 1
v_permlane16_swap_b32 v160, v161
v_max_f32 v162, v160, v161
v_max_f32 v163, v160, v161
s_nop 1
v_permlane32_swap_b32 v162, v163
v_max_f32 v160, v162, v163
v_pk_add_f32 v[96:97], v[96:97], v[160:161] op_sel_hi:[1,0] neg_lo:[0,1] neg_hi:[0,1]
v_pk_add_f32 v[98:99], v[98:99], v[160:161] op_sel_hi:[1,0] neg_lo:[0,1] neg_hi:[0,1]
v_pk_add_f32 v[100:101], v[100:101], v[160:161] op_sel_hi:[1,0] neg_lo:[0,1] neg_hi:[0,1]
v_pk_add_f32 v[102:103], v[102:103], v[160:161] op_sel_hi:[1,0] neg_lo:[0,1] neg_hi:[0,1]
v_pk_add_f32 v[104:105], v[104:105], v[160:161] op_sel_hi:[1,0] neg_lo:[0,1] neg_hi:[0,1]
v_pk_add_f32 v[106:107], v[106:107], v[160:161] op_sel_hi:[1,0] neg_lo:[0,1] neg_hi:[0,1]
v_exp_f32 v96, v96
v_exp_f32 v97, v97
v_exp_f32 v98, v98
v_exp_f32 v99, v99
v_exp_f32 v100, v100
v_exp_f32 v101, v101
v_exp_f32 v102, v102
v_exp_f32 v103, v103
v_exp_f32 v104, v104
v_exp_f32 v105, v105
v_exp_f32 v106, v106
v_exp_f32 v107, v107
v_cvt_pk_bf16_f32 v132, v96, v97
v_cvt_pk_bf16_f32 v133, v98, v99
v_cvt_pk_bf16_f32 v134, v100, v101
v_cvt_pk_bf16_f32 v135, v102, v103
v_cvt_pk_bf16_f32 v136, v104, v105
v_cvt_pk_bf16_f32 v137, v106, v107
v_mfma_f32_16x16x32_bf16 v[156:159], v[92:95], v[132:135], 0
v_mfma_f32_16x16x32_bf16 v[140:143], v[64:67], v[132:135], 0
v_mfma_f32_16x16x32_bf16 v[144:147], v[68:71], v[132:135], 0
v_mfma_f32_16x16x32_bf16 v[148:151], v[72:75], v[132:135], 0
v_mfma_f32_16x16x32_bf16 v[152:155], v[76:79], v[132:135], 0
s_waitcnt lgkmcnt(0)
v_mfma_f32_16x16x16_bf16 v[156:159], v[92:93], v[136:137], v[156:159]
v_mfma_f32_16x16x16_bf16 v[140:143], v[124:125], v[136:137], v[140:143]
v_mfma_f32_16x16x16_bf16 v[144:147], v[126:127], v[136:137], v[144:147]
v_mfma_f32_16x16x16_bf16 v[148:151], v[128:129], v[136:137], v[148:151]
v_mfma_f32_16x16x16_bf16 v[152:155], v[130:131], v[136:137], v[152:155]
v_rcp_f32 v156, v156
s_nop 0
v_mul_f32 v140, v140, v156
v_mul_f32 v141, v141, v156
v_mul_f32 v142, v142, v156
v_mul_f32 v143, v143, v156
v_mul_f32 v144, v144, v156
v_mul_f32 v145, v145, v156
v_mul_f32 v146, v146, v156
v_mul_f32 v147, v147, v156
v_cvt_pk_bf16_f32 v140, v140, v141
v_cvt_pk_bf16_f32 v141, v142, v143
v_cvt_pk_bf16_f32 v142, v144, v145
v_cvt_pk_bf16_f32 v143, v146, v147
buffer_store_dwordx4 v[140:143], v1, s[4:7], s56 offen offset:0 sc0 sc1
v_mul_f32 v148, v148, v156
v_mul_f32 v149, v149, v156
v_mul_f32 v150, v150, v156
v_mul_f32 v151, v151, v156
v_mul_f32 v152, v152, v156
v_mul_f32 v153, v153, v156
v_mul_f32 v154, v154, v156
v_mul_f32 v155, v155, v156
v_cvt_pk_bf16_f32 v148, v148, v149
v_cvt_pk_bf16_f32 v149, v150, v151
v_cvt_pk_bf16_f32 v150, v152, v153
v_cvt_pk_bf16_f32 v151, v154, v155
buffer_store_dwordx4 v[148:151], v1, s[4:7], s56 offen offset:1024 sc0 sc1
s_add_u32 s35, s35, 1
v_mov_b32 v13, s35
s_add_u32 s50, s50, 1048576
s_add_u32 s52, s52, 2097152
s_add_u32 s53, s53, 2097152
s_add_u32 s55, s55, 40960
s_add_u32 s56, s56, 1048576
s_waitcnt vmcnt(0)
s_mov_b64 exec, 1
buffer_store_dword v13, v8, s[4:7], s58 offen sc0 sc1
s_mov_b64 exec, -1
s_cmp_lt_u32 s35, 16
s_cbranch_scc1 L_at_loop
s_waitcnt vmcnt(0)
s_endpgm
L_role_aw:
s_load_dwordx2 s[4:5], s[0:1], 104
s_mov_b32 s6, 268435456
s_mov_b32 s7, 0x20000
s_load_dwordx2 s[8:9], s[0:1], 0
s_mov_b32 s10, 2359296
s_mov_b32 s11, 0x20000
s_load_dwordx2 s[12:13], s[0:1], 8
s_mov_b32 s14, 1990656
s_mov_b32 s15, 0x20000
s_load_dwordx2 s[16:17], s[0:1], 16
s_mov_b32 s18, 663552
s_mov_b32 s19, 0x20000
s_load_dwordx2 s[20:21], s[0:1], 64
s_mov_b32 s22, 4718592
s_mov_b32 s23, 0x20000
s_load_dwordx2 s[24:25], s[0:1], 96
s_mov_b32 s26, 256
s_mov_b32 s27, 0x20000
s_load_dwordx2 s[28:29], s[0:1], 88
s_mov_b32 s30, 2359296
s_mov_b32 s31, 0x20000
s_load_dwordx2 s[64:65], s[0:1], 80
s_mov_b32 s66, 1152
s_mov_b32 s67, 0x20000
v_and_b32 v9, 63, v0
v_and_b32 v10, 15, v0
v_bfe_u32 v11, v0, 4, 2
v_lshrrev_b32 v1, 6, v0
s_nop 0
v_readfirstlane_b32 s34, v1
v_lshrrev_b32 v12, 2, v9
v_mul_u32_u24 v2, 1152, v12
v_lshrrev_b32 v12, 5, v9
v_lshlrev_b32 v12, 1, v12
v_and_b32 v13, 3, v9
v_xor_b32 v12, v12, v13
v_lshl_add_u32 v2, v12, 4, v2
v_lshrrev_b32 v12, 3, v10
v_lshlrev_b32 v12, 1, v12
v_xor_b32 v12, v12, v11
v_lshlrev_b32 v12, 4, v12
v_lshl_add_u32 v3, v10, 6, v12
v_lshrrev_b32 v12, 2, v10
v_lshl_add_u32 v12, v11, 3, v12
v_mul_u32_u24 v7, 64, v12
v_and_b32 v12, 3, v10
v_lshl_add_u32 v7, v12, 3, v7
v_lshlrev_b32 v1, 4, v9
s_mul_i32 s38, s34, 20480
s_add_u32 s38, s38, 73728
v_add_u32 v7, s38, v7
v_mov_b32 v8, 0
s_lshl_b32 s37, s34, 3
s_add_u32 s37, s37, 0
v_and_b32 v12, 3, v9
v_add_u32 v12, s37, v12
v_min_u32 v12, 26, v12
v_mul_u32_u24 v13, 57, v12
v_lshrrev_b32 v13, 9, v13
v_mul_u32_u24 v13, 1008, v13
v_lshl_add_u32 v13, v12, 4, v13
v_lshrrev_b32 v12, 2, v9
v_mul_u32_u24 v12, 3456, v12
v_add_u32 v5, v12, v13
s_lshl_b32 s37, s34, 3
s_add_u32 s37, s37, 4
v_and_b32 v12, 3, v9
v_add_u32 v12, s37, v12
v_min_u32 v12, 26, v12
v_mul_u32_u24 v13, 57, v12
v_lshrrev_b32 v13, 9, v13
v_mul_u32_u24 v13, 1008, v13
v_lshl_add_u32 v13, v12, 4, v13
v_lshrrev_b32 v12, 2, v9
v_mul_u32_u24 v12, 3456, v12
v_add_u32 v6, v12, v13
s_mul_i32 s39, s32, 144
s_mul_i32 s40, s33, 11
s_and_b32 s41, s34, 1
s_add_u32 s40, s40, s41
s_sub_u32 s40, s40, 1
s_max_i32 s41, s40, 0
s_lshr_b32 s42, s34, 1
s_lshl_b32 s42, s42, 6
s_mul_i32 s43, s41, 18432
s_add_u32 s43, s43, s42
s_mul_i32 s40, s40, 18432
s_add_u32 s40, s40, s42
s_lshl_b32 s44, s34, 10
s_mov_b32 s36, 400000
v_mul_u32_u24 v4, 456, v10
v_lshl_add_u32 v4, v11, 3, v4
s_lshl_b32 s37, s34, 7
s_add_u32 s37, s37, 73728
v_add_u32 v4, s37, v4
v_lshlrev_b32 v14, 2, v10
v_add_u32 v14, 161280, v14
s_waitcnt lgkmcnt(0)
s_add_u32 s37, s39, 0
s_add_u32 m0, s38, 0
s_nop 0
buffer_load_dwordx4 v5, s[12:15], s37 offen lds
s_add_u32 s37, s39, 55296
s_add_u32 m0, s38, 1024
s_nop 0
buffer_load_dwordx4 v5, s[12:15], s37 offen lds
s_add_u32 s37, s39, 110592
s_add_u32 m0, s38, 2048
s_nop 0
buffer_load_dwordx4 v5, s[12:15], s37 offen lds
s_add_u32 s37, s39, 165888
s_add_u32 m0, s38, 3072
s_nop 0
buffer_load_dwordx4 v5, s[12:15], s37 offen lds
s_add_u32 s37, s39, 221184
s_add_u32 m0, s38, 4096
s_nop 0
buffer_load_dwordx4 v5, s[12:15], s37 offen lds
s_add_u32 s37, s39, 276480
s_add_u32 m0, s38, 5120
s_nop 0
buffer_load_dwordx4 v5, s[12:15], s37 offen lds
s_add_u32 s37, s39, 331776
s_add_u32 m0, s38, 6144
s_nop 0
buffer_load_dwordx4 v5, s[12:15], s37 offen lds
s_add_u32 s37, s39, 387072
s_add_u32 m0, s38, 7168
s_nop 0
buffer_load_dwordx4 v5, s[12:15], s37 offen lds
s_add_u32 s37, s39, 442368
s_add_u32 m0, s38, 8192
s_nop 0
buffer_load_dwordx4 v5, s[12:15], s37 offen lds
s_add_u32 s37, s39, 497664
s_add_u32 m0, s38, 9216
s_nop 0
buffer_load_dwordx4 v5, s[12:15], s37 offen lds
s_add_u32 s37, s39, 552960
s_add_u32 m0, s38, 10240
s_nop 0
buffer_load_dwordx4 v5, s[12:15], s37 offen lds
s_add_u32 s37, s39, 608256
s_add_u32 m0, s38, 11264
s_nop 0
buffer_load_dwordx4 v5, s[12:15], s37 offen lds
s_add_u32 s37, s39, 663552
s_add_u32 m0, s38, 12288
s_nop 0
buffer_load_dwordx4 v5, s[12:15], s37 offen lds
s_add_u32 s37, s39, 718848
s_add_u32 m0, s38, 13312
s_nop 0
buffer_load_dwordx4 v5, s[12:15], s37 offen lds
s_add_u32 s37, s39, 774144
s_add_u32 m0, s38, 14336
s_nop 0
buffer_load_dwordx4 v5, s[12:15], s37 offen lds
s_add_u32 s37, s39, 829440
s_add_u32 m0, s38, 15360
s_nop 0
buffer_load_dwordx4 v5, s[12:15], s37 offen lds
s_add_u32 s37, s43, 0
s_add_u32 m0, s44, 0
s_nop 0
buffer_load_dwordx4 v2, s[8:11], s37 offen lds
s_add_u32 s37, s43, 128
s_add_u32 m0, s44, 4096
s_nop 0
buffer_load_dwordx4 v2, s[8:11], s37 offen lds
s_add_u32 s37, s43, 256
s_add_u32 m0, s44, 8192
s_nop 0
buffer_load_dwordx4 v2, s[8:11], s37 offen lds
s_add_u32 s37, s43, 384
s_add_u32 m0, s44, 12288
s_nop 0
buffer_load_dwordx4 v2, s[8:11], s37 offen lds
s_add_u32 s37, s43, 512
s_add_u32 m0, s44, 16384
s_nop 0
buffer_load_dwordx4 v2, s[8:11], s37 offen lds
s_add_u32 s37, s43, 640
s_add_u32 m0, s44, 20480
s_nop 0
buffer_load_dwordx4 v2, s[8:11], s37 offen lds
s_add_u32 s37, s43, 768
s_add_u32 m0, s44, 24576
s_nop 0
buffer_load_dwordx4 v2, s[8:11], s37 offen lds
s_add_u32 s37, s43, 896
s_add_u32 m0, s44, 28672
s_nop 0
buffer_load_dwordx4 v2, s[8:11], s37 offen lds
s_add_u32 s37, s43, 1024
s_add_u32 m0, s44, 32768
s_nop 0
buffer_load_dwordx4 v2, s[8:11], s37 offen lds
s_waitcnt vmcnt(21)
ds_read_b64_tr_b16 v[80:81], v7 offset:0
ds_read_b64_tr_b16 v[82:83], v7 offset:256
ds_read_b64_tr_b16 v[84:85], v7 offset:2048
ds_read_b64_tr_b16 v[86:87], v7 offset:2304
ds_read_b64_tr_b16 v[152:153], v7 offset:32
ds_read_b64_tr_b16 v[154:155], v7 offset:288
ds_read_b64_tr_b16 v[156:157], v7 offset:2080
ds_read_b64_tr_b16 v[158:159], v7 offset:2336
s_waitcnt lgkmcnt(0)
s_add_u32 s37, s39, 884736
s_add_u32 m0, s38, 16384
s_nop 0
buffer_load_dwordx4 v5, s[12:15], s37 offen lds
s_add_u32 s37, s39, 940032
s_add_u32 m0, s38, 17408
s_nop 0
buffer_load_dwordx4 v5, s[12:15], s37 offen lds
s_add_u32 s37, s39, 995328
s_add_u32 m0, s38, 18432
s_nop 0
buffer_load_dwordx4 v5, s[12:15], s37 offen lds
s_add_u32 s37, s39, 1050624
s_add_u32 m0, s38, 19456
s_nop 0
buffer_load_dwordx4 v5, s[12:15], s37 offen lds
s_waitcnt vmcnt(21)
ds_read_b64_tr_b16 v[88:89], v7 offset:4096
ds_read_b64_tr_b16 v[90:91], v7 offset:4352
ds_read_b64_tr_b16 v[92:93], v7 offset:6144
ds_read_b64_tr_b16 v[94:95], v7 offset:6400
ds_read_b64_tr_b16 v[160:161], v7 offset:4128
ds_read_b64_tr_b16 v[162:163], v7 offset:4384
ds_read_b64_tr_b16 v[164:165], v7 offset:6176
ds_read_b64_tr_b16 v[166:167], v7 offset:6432
s_waitcnt lgkmcnt(0)
s_add_u32 s37, s39, 1105920
s_add_u32 m0, s38, 0
s_nop 0
buffer_load_dwordx4 v5, s[12:15], s37 offen lds
s_add_u32 s37, s39, 1161216
s_add_u32 m0, s38, 1024
s_nop 0
buffer_load_dwordx4 v5, s[12:15], s37 offen lds
s_add_u32 s37, s39, 1216512
s_add_u32 m0, s38, 2048
s_nop 0
buffer_load_dwordx4 v5, s[12:15], s37 offen lds
s_add_u32 s37, s39, 1271808
s_add_u32 m0, s38, 3072
s_nop 0
buffer_load_dwordx4 v5, s[12:15], s37 offen lds
s_waitcnt vmcnt(21)
ds_read_b64_tr_b16 v[96:97], v7 offset:8192
ds_read_b64_tr_b16 v[98:99], v7 offset:8448
ds_read_b64_tr_b16 v[100:101], v7 offset:10240
ds_read_b64_tr_b16 v[102:103], v7 offset:10496
ds_read_b64_tr_b16 v[168:169], v7 offset:8224
ds_read_b64_tr_b16 v[170:171], v7 offset:8480
ds_read_b64_tr_b16 v[172:173], v7 offset:10272
ds_read_b64_tr_b16 v[174:175], v7 offset:10528
s_waitcnt lgkmcnt(0)
s_add_u32 s37, s39, 1327104
s_add_u32 m0, s38, 4096
s_nop 0
buffer_load_dwordx4 v5, s[12:15], s37 offen lds
s_add_u32 s37, s39, 1382400
s_add_u32 m0, s38, 5120
s_nop 0
buffer_load_dwordx4 v5, s[12:15], s37 offen lds
s_add_u32 s37, s39, 1437696
s_add_u32 m0, s38, 6144
s_nop 0
buffer_load_dwordx4 v5, s[12:15], s37 offen lds
s_add_u32 s37, s39, 1492992
s_add_u32 m0, s38, 7168
s_nop 0
buffer_load_dwordx4 v5, s[12:15], s37 offen lds
s_waitcnt vmcnt(21)
ds_read_b64_tr_b16 v[104:105], v7 offset:12288
ds_read_b64_tr_b16 v[106:107], v7 offset:12544
ds_read_b64_tr_b16 v[108:109], v7 offset:14336
ds_read_b64_tr_b16 v[110:111], v7 offset:14592
ds_read_b64_tr_b16 v[176:177], v7 offset:12320
ds_read_b64_tr_b16 v[178:179], v7 offset:12576
ds_read_b64_tr_b16 v[180:181], v7 offset:14368
ds_read_b64_tr_b16 v[182:183], v7 offset:14624
s_waitcnt lgkmcnt(0)
s_add_u32 s37, s39, 1548288
s_add_u32 m0, s38, 8192
s_nop 0
buffer_load_dwordx4 v5, s[12:15], s37 offen lds
s_add_u32 s37, s39, 1603584
s_add_u32 m0, s38, 9216
s_nop 0
buffer_load_dwordx4 v5, s[12:15], s37 offen lds
s_add_u32 s37, s39, 1658880
s_add_u32 m0, s38, 10240
s_nop 0
buffer_load_dwordx4 v5, s[12:15], s37 offen lds
s_add_u32 s37, s39, 1714176
s_add_u32 m0, s38, 11264
s_nop 0
buffer_load_dwordx4 v5, s[12:15], s37 offen lds
s_waitcnt vmcnt(12)
ds_read_b64_tr_b16 v[112:113], v7 offset:16384
ds_read_b64_tr_b16 v[114:115], v7 offset:16640
ds_read_b64_tr_b16 v[116:117], v7 offset:18432
ds_read_b64_tr_b16 v[118:119], v7 offset:18688
ds_read_b64_tr_b16 v[184:185], v7 offset:16416
ds_read_b64_tr_b16 v[186:187], v7 offset:16672
ds_read_b64_tr_b16 v[188:189], v7 offset:18464
ds_read_b64_tr_b16 v[190:191], v7 offset:18720
s_waitcnt lgkmcnt(0)
s_add_u32 s37, s39, 1769472
s_add_u32 m0, s38, 12288
s_nop 0
buffer_load_dwordx4 v5, s[12:15], s37 offen lds
s_add_u32 s37, s39, 1824768
s_add_u32 m0, s38, 13312
s_nop 0
buffer_load_dwordx4 v5, s[12:15], s37 offen lds
s_add_u32 s37, s39, 1880064
s_add_u32 m0, s38, 14336
s_nop 0
buffer_load_dwordx4 v5, s[12:15], s37 offen lds
s_add_u32 s37, s39, 1935360
s_add_u32 m0, s38, 15360
s_nop 0
buffer_load_dwordx4 v5, s[12:15], s37 offen lds
s_waitcnt vmcnt(12)
ds_read_b64_tr_b16 v[120:121], v7 offset:0
ds_read_b64_tr_b16 v[122:123], v7 offset:256
ds_read_b64_tr_b16 v[124:125], v7 offset:2048
ds_read_b64_tr_b16 v[126:127], v7 offset:2304
ds_read_b64_tr_b16 v[192:193], v7 offset:32
ds_read_b64_tr_b16 v[194:195], v7 offset:288
ds_read_b64_tr_b16 v[196:197], v7 offset:2080
ds_read_b64_tr_b16 v[198:199], v7 offset:2336
s_waitcnt lgkmcnt(0)
s_add_u32 s37, s39, 0
s_add_u32 m0, s38, 16384
s_nop 0
buffer_load_dwordx4 v6, s[12:15], s37 offen lds
s_add_u32 s37, s39, 55296
s_add_u32 m0, s38, 17408
s_nop 0
buffer_load_dwordx4 v6, s[12:15], s37 offen lds
s_add_u32 s37, s39, 110592
s_add_u32 m0, s38, 18432
s_nop 0
buffer_load_dwordx4 v6, s[12:15], s37 offen lds
s_add_u32 s37, s39, 165888
s_add_u32 m0, s38, 19456
s_nop 0
buffer_load_dwordx4 v6, s[12:15], s37 offen lds
s_waitcnt vmcnt(12)
ds_read_b64_tr_b16 v[128:129], v7 offset:4096
ds_read_b64_tr_b16 v[130:131], v7 offset:4352
ds_read_b64_tr_b16 v[132:133], v7 offset:6144
ds_read_b64_tr_b16 v[134:135], v7 offset:6400
ds_read_b64_tr_b16 v[200:201], v7 offset:4128
ds_read_b64_tr_b16 v[202:203], v7 offset:4384
ds_read_b64_tr_b16 v[204:205], v7 offset:6176
ds_read_b64_tr_b16 v[206:207], v7 offset:6432
s_waitcnt lgkmcnt(0)
s_add_u32 s37, s39, 221184
s_add_u32 m0, s38, 0
s_nop 0
buffer_load_dwordx4 v6, s[12:15], s37 offen lds
s_add_u32 s37, s39, 276480
s_add_u32 m0, s38, 1024
s_nop 0
buffer_load_dwordx4 v6, s[12:15], s37 offen lds
s_add_u32 s37, s39, 331776
s_add_u32 m0, s38, 2048
s_nop 0
buffer_load_dwordx4 v6, s[12:15], s37 offen lds
s_add_u32 s37, s39, 387072
s_add_u32 m0, s38, 3072
s_nop 0
buffer_load_dwordx4 v6, s[12:15], s37 offen lds
s_waitcnt vmcnt(12)
ds_read_b64_tr_b16 v[136:137], v7 offset:8192
ds_read_b64_tr_b16 v[138:139], v7 offset:8448
ds_read_b64_tr_b16 v[140:141], v7 offset:10240
ds_read_b64_tr_b16 v[142:143], v7 offset:10496
ds_read_b64_tr_b16 v[208:209], v7 offset:8224
ds_read_b64_tr_b16 v[210:211], v7 offset:8480
ds_read_b64_tr_b16 v[212:213], v7 offset:10272
ds_read_b64_tr_b16 v[214:215], v7 offset:10528
s_waitcnt lgkmcnt(0)
s_add_u32 s37, s39, 442368
s_add_u32 m0, s38, 4096
s_nop 0
buffer_load_dwordx4 v6, s[12:15], s37 offen lds
s_add_u32 s37, s39, 497664
s_add_u32 m0, s38, 5120
s_nop 0
buffer_load_dwordx4 v6, s[12:15], s37 offen lds
s_add_u32 s37, s39, 552960
s_add_u32 m0, s38, 6144
s_nop 0
buffer_load_dwordx4 v6, s[12:15], s37 offen lds
s_add_u32 s37, s39, 608256
s_add_u32 m0, s38, 7168
s_nop 0
buffer_load_dwordx4 v6, s[12:15], s37 offen lds
s_waitcnt vmcnt(12)
ds_read_b64_tr_b16 v[144:145], v7 offset:12288
ds_read_b64_tr_b16 v[146:147], v7 offset:12544
ds_read_b64_tr_b16 v[148:149], v7 offset:14336
ds_read_b64_tr_b16 v[150:151], v7 offset:14592
ds_read_b64_tr_b16 v[216:217], v7 offset:12320
ds_read_b64_tr_b16 v[218:219], v7 offset:12576
ds_read_b64_tr_b16 v[220:221], v7 offset:14368
ds_read_b64_tr_b16 v[222:223], v7 offset:14624
s_waitcnt lgkmcnt(0)
s_add_u32 s37, s39, 663552
s_add_u32 m0, s38, 8192
s_nop 0
buffer_load_dwordx4 v6, s[12:15], s37 offen lds
s_add_u32 s37, s39, 718848
s_add_u32 m0, s38, 9216
s_nop 0
buffer_load_dwordx4 v6, s[12:15], s37 offen lds
s_add_u32 s37, s39, 774144
s_add_u32 m0, s38, 10240
s_nop 0
buffer_load_dwordx4 v6, s[12:15], s37 offen lds
s_add_u32 s37, s39, 829440
s_add_u32 m0, s38, 11264
s_nop 0
buffer_load_dwordx4 v6, s[12:15], s37 offen lds
s_waitcnt vmcnt(12)
ds_read_b64_tr_b16 v[224:225], v7 offset:16384
ds_read_b64_tr_b16 v[226:227], v7 offset:16640
ds_read_b64_tr_b16 v[228:229], v7 offset:18432
ds_read_b64_tr_b16 v[230:231], v7 offset:18688
ds_read_b64_tr_b16 a[40:41], v7 offset:16416
ds_read_b64_tr_b16 a[42:43], v7 offset:16672
ds_read_b64_tr_b16 a[44:45], v7 offset:18464
ds_read_b64_tr_b16 a[46:47], v7 offset:18720
s_waitcnt lgkmcnt(0)
s_add_u32 s37, s39, 884736
s_add_u32 m0, s38, 12288
s_nop 0
buffer_load_dwordx4 v6, s[12:15], s37 offen lds
s_add_u32 s37, s39, 940032
s_add_u32 m0, s38, 13312
s_nop 0
buffer_load_dwordx4 v6, s[12:15], s37 offen lds
s_add_u32 s37, s39, 995328
s_add_u32 m0, s38, 14336
s_nop 0
buffer_load_dwordx4 v6, s[12:15], s37 offen lds
s_add_u32 s37, s39, 1050624
s_add_u32 m0, s38, 15360
s_nop 0
buffer_load_dwordx4 v6, s[12:15], s37 offen lds
s_waitcnt vmcnt(12)
ds_read_b64_tr_b16 v[232:233], v7 offset:0
ds_read_b64_tr_b16 v[234:235], v7 offset:256
ds_read_b64_tr_b16 v[236:237], v7 offset:2048
ds_read_b64_tr_b16 v[238:239], v7 offset:2304
ds_read_b64_tr_b16 a[48:49], v7 offset:32
ds_read_b64_tr_b16 a[50:51], v7 offset:288
ds_read_b64_tr_b16 a[52:53], v7 offset:2080
ds_read_b64_tr_b16 a[54:55], v7 offset:2336
s_waitcnt lgkmcnt(0)
s_add_u32 s37, s39, 1105920
s_add_u32 m0, s38, 16384
s_nop 0
buffer_load_dwordx4 v6, s[12:15], s37 offen lds
s_add_u32 s37, s39, 1161216
s_add_u32 m0, s38, 17408
s_nop 0
buffer_load_dwordx4 v6, s[12:15], s37 offen lds
s_add_u32 s37, s39, 1216512
s_add_u32 m0, s38, 18432
s_nop 0
buffer_load_dwordx4 v6, s[12:15], s37 offen lds
s_add_u32 s37, s39, 1271808
s_add_u32 m0, s38, 19456
s_nop 0
buffer_load_dwordx4 v6, s[12:15], s37 offen lds
s_waitcnt vmcnt(12)
ds_read_b64_tr_b16 v[240:241], v7 offset:4096
ds_read_b64_tr_b16 v[242:243], v7 offset:4352
ds_read_b64_tr_b16 v[244:245], v7 offset:6144
ds_read_b64_tr_b16 v[246:247], v7 offset:6400
ds_read_b64_tr_b16 a[56:57], v7 offset:4128
ds_read_b64_tr_b16 a[58:59], v7 offset:4384
ds_read_b64_tr_b16 a[60:61], v7 offset:6176
ds_read_b64_tr_b16 a[62:63], v7 offset:6432
s_waitcnt lgkmcnt(0)
s_add_u32 s37, s39, 1327104
s_add_u32 m0, s38, 0
s_nop 0
buffer_load_dwordx4 v6, s[12:15], s37 offen lds
s_add_u32 s37, s39, 1382400
s_add_u32 m0, s38, 1024
s_nop 0
buffer_load_dwordx4 v6, s[12:15], s37 offen lds
s_add_u32 s37, s39, 1437696
s_add_u32 m0, s38, 2048
s_nop 0
buffer_load_dwordx4 v6, s[12:15], s37 offen lds
s_add_u32 s37, s39, 1492992
s_add_u32 m0, s38, 3072
s_nop 0
buffer_load_dwordx4 v6, s[12:15], s37 offen lds
s_waitcnt vmcnt(12)
ds_read_b64_tr_b16 v[248:249], v7 offset:8192
ds_read_b64_tr_b16 v[250:251], v7 offset:8448
ds_read_b64_tr_b16 v[252:253], v7 offset:10240
ds_read_b64_tr_b16 v[254:255], v7 offset:10496
ds_read_b64_tr_b16 a[64:65], v7 offset:8224
ds_read_b64_tr_b16 a[66:67], v7 offset:8480
ds_read_b64_tr_b16 a[68:69], v7 offset:10272
ds_read_b64_tr_b16 a[70:71], v7 offset:10528
s_waitcnt lgkmcnt(0)
s_add_u32 s37, s39, 1548288
s_add_u32 m0, s38, 4096
s_nop 0
buffer_load_dwordx4 v6, s[12:15], s37 offen lds
s_add_u32 s37, s39, 1603584
s_add_u32 m0, s38, 5120
s_nop 0
buffer_load_dwordx4 v6, s[12:15], s37 offen lds
s_add_u32 s37, s39, 1658880
s_add_u32 m0, s38, 6144
s_nop 0
buffer_load_dwordx4 v6, s[12:15], s37 offen lds
s_add_u32 s37, s39, 1714176
s_add_u32 m0, s38, 7168
s_nop 0
buffer_load_dwordx4 v6, s[12:15], s37 offen lds
s_waitcnt vmcnt(12)
ds_read_b64_tr_b16 a[0:1], v7 offset:12288
ds_read_b64_tr_b16 a[2:3], v7 offset:12544
ds_read_b64_tr_b16 a[4:5], v7 offset:14336
ds_read_b64_tr_b16 a[6:7], v7 offset:14592
ds_read_b64_tr_b16 a[72:73], v7 offset:12320
ds_read_b64_tr_b16 a[74:75], v7 offset:12576
ds_read_b64_tr_b16 a[76:77], v7 offset:14368
ds_read_b64_tr_b16 a[78:79], v7 offset:14624
s_waitcnt lgkmcnt(0)
s_add_u32 s37, s39, 1769472
s_add_u32 m0, s38, 8192
s_nop 0
buffer_load_dwordx4 v6, s[12:15], s37 offen lds
s_add_u32 s37, s39, 1824768
s_add_u32 m0, s38, 9216
s_nop 0
buffer_load_dwordx4 v6, s[12:15], s37 offen lds
s_add_u32 s37, s39, 1880064
s_add_u32 m0, s38, 10240
s_nop 0
buffer_load_dwordx4 v6, s[12:15], s37 offen lds
s_add_u32 s37, s39, 1935360
s_add_u32 m0, s38, 11264
s_nop 0
buffer_load_dwordx4 v6, s[12:15], s37 offen lds
s_waitcnt vmcnt(12)
ds_read_b64_tr_b16 a[8:9], v7 offset:16384
ds_read_b64_tr_b16 a[10:11], v7 offset:16640
ds_read_b64_tr_b16 a[12:13], v7 offset:18432
ds_read_b64_tr_b16 a[14:15], v7 offset:18688
ds_read_b64_tr_b16 a[80:81], v7 offset:16416
ds_read_b64_tr_b16 a[82:83], v7 offset:16672
ds_read_b64_tr_b16 a[84:85], v7 offset:18464
ds_read_b64_tr_b16 a[86:87], v7 offset:18720
s_waitcnt lgkmcnt(0)
s_waitcnt vmcnt(8)
ds_read_b64_tr_b16 a[16:17], v7 offset:0
ds_read_b64_tr_b16 a[18:19], v7 offset:256
ds_read_b64_tr_b16 a[20:21], v7 offset:2048
ds_read_b64_tr_b16 a[22:23], v7 offset:2304
ds_read_b64_tr_b16 a[88:89], v7 offset:32
ds_read_b64_tr_b16 a[90:91], v7 offset:288
ds_read_b64_tr_b16 a[92:93], v7 offset:2080
ds_read_b64_tr_b16 a[94:95], v7 offset:2336
s_waitcnt lgkmcnt(0)
s_waitcnt vmcnt(4)
ds_read_b64_tr_b16 a[24:25], v7 offset:4096
ds_read_b64_tr_b16 a[26:27], v7 offset:4352
ds_read_b64_tr_b16 a[28:29], v7 offset:6144
ds_read_b64_tr_b16 a[30:31], v7 offset:6400
ds_read_b64_tr_b16 a[96:97], v7 offset:4128
ds_read_b64_tr_b16 a[98:99], v7 offset:4384
ds_read_b64_tr_b16 a[100:101], v7 offset:6176
ds_read_b64_tr_b16 a[102:103], v7 offset:6432
s_waitcnt lgkmcnt(0)
s_waitcnt vmcnt(0)
ds_read_b64_tr_b16 a[32:33], v7 offset:8192
ds_read_b64_tr_b16 a[34:35], v7 offset:8448
ds_read_b64_tr_b16 a[36:37], v7 offset:10240
ds_read_b64_tr_b16 a[38:39], v7 offset:10496
ds_read_b64_tr_b16 a[104:105], v7 offset:8224
ds_read_b64_tr_b16 a[106:107], v7 offset:8480
ds_read_b64_tr_b16 a[108:109], v7 offset:10272
ds_read_b64_tr_b16 a[110:111], v7 offset:10528
s_waitcnt lgkmcnt(0)
s_cmp_lg_u32 s34, 3
s_cbranch_scc1 L_a_nogate
v_lshlrev_b32 v12, 4, v11
buffer_load_dwordx4 v[224:227], v12, s[64:67], 0 offen offset:0
buffer_load_dwordx4 v[228:231], v12, s[64:67], 0 offen offset:64
buffer_load_dwordx4 v[232:235], v12, s[64:67], 0 offen offset:128
buffer_load_dwordx4 v[236:239], v12, s[64:67], 0 offen offset:192
buffer_load_dwordx4 v[240:243], v12, s[64:67], 0 offen offset:256
buffer_load_dwordx4 v[244:247], v12, s[64:67], 0 offen offset:320
buffer_load_dwordx4 v[248:251], v12, s[64:67], 0 offen offset:384
buffer_load_dwordx4 v[252:255], v12, s[64:67], 0 offen offset:448
buffer_load_dwordx4 a[0:3], v12, s[64:67], 0 offen offset:512
buffer_load_dwordx4 a[4:7], v12, s[64:67], 0 offen offset:576
buffer_load_dwordx4 a[8:11], v12, s[64:67], 0 offen offset:640
buffer_load_dwordx4 a[12:15], v12, s[64:67], 0 offen offset:704
buffer_load_dwordx4 a[16:19], v12, s[64:67], 0 offen offset:768
buffer_load_dwordx4 a[20:23], v12, s[64:67], 0 offen offset:832
buffer_load_dwordx4 a[24:27], v12, s[64:67], 0 offen offset:896
buffer_load_dwordx4 a[28:31], v12, s[64:67], 0 offen offset:960
buffer_load_dwordx4 a[32:35], v12, s[64:67], 0 offen offset:1024
buffer_load_dwordx4 a[36:39], v12, s[64:67], 0 offen offset:1088
L_a_nogate:
s_mov_b32 s43, s40
s_mov_b32 s35, 0
s_mov_b32 s50, 36864
.p2align 6
L_a_loop:
s_waitcnt vmcnt(0)
s_barrier
s_add_u32 s43, s43, 36864
s_add_u32 s44, s44, s50
ds_read_b128 v[64:67], v3 offset:0
ds_read_b128 v[68:71], v3 offset:1024
ds_read_b128 v[72:75], v3 offset:2048
ds_read_b128 v[76:79], v3 offset:3072
s_waitcnt lgkmcnt(2)
v_mfma_f32_16x16x32_bf16 v[16:19], v[80:83], v[64:67], 0
v_mfma_f32_16x16x32_bf16 v[20:23], v[80:83], v[68:71], 0
v_mfma_f32_16x16x32_bf16 v[24:27], v[152:155], v[64:67], 0
v_mfma_f32_16x16x32_bf16 v[28:31], v[152:155], v[68:71], 0
s_add_u32 s37, s43, 0
s_add_u32 m0, s44, 0
s_nop 0
buffer_load_dwordx4 v2, s[8:11], s37 offen lds
v_mfma_f32_16x16x32_bf16 v[32:35], v[224:227], v[64:67], 0
v_mfma_f32_16x16x32_bf16 v[36:39], v[224:227], v[68:71], 0
v_mfma_f32_16x16x32_bf16 v[40:43], a[40:43], v[64:67], 0
v_mfma_f32_16x16x32_bf16 v[44:47], a[40:43], v[68:71], 0
ds_read_b128 v[64:67], v3 offset:4096
ds_read_b128 v[68:71], v3 offset:5120
s_waitcnt lgkmcnt(2)
v_mfma_f32_16x16x32_bf16 v[16:19], v[84:87], v[72:75], v[16:19]
v_mfma_f32_16x16x32_bf16 v[20:23], v[84:87], v[76:79], v[20:23]
v_mfma_f32_16x16x32_bf16 v[24:27], v[156:159], v[72:75], v[24:27]
v_mfma_f32_16x16x32_bf16 v[28:31], v[156:159], v[76:79], v[28:31]
s_add_u32 s37, s43, 128
s_add_u32 m0, s44, 4096
s_nop 0
buffer_load_dwordx4 v2, s[8:11], s37 offen lds
v_mfma_f32_16x16x32_bf16 v[32:35], v[228:231], v[72:75], v[32:35]
v_mfma_f32_16x16x32_bf16 v[36:39], v[228:231], v[76:79], v[36:39]
v_mfma_f32_16x16x32_bf16 v[40:43], a[44:47], v[72:75], v[40:43]
v_mfma_f32_16x16x32_bf16 v[44:47], a[44:47], v[76:79], v[44:47]
ds_read_b128 v[72:75], v3 offset:6144
ds_read_b128 v[76:79], v3 offset:7168
s_waitcnt lgkmcnt(2)
v_mfma_f32_16x16x32_bf16 v[16:19], v[88:91], v[64:67], v[16:19]
v_mfma_f32_16x16x32_bf16 v[20:23], v[88:91], v[68:71], v[20:23]
v_mfma_f32_16x16x32_bf16 v[24:27], v[160:163], v[64:67], v[24:27]
v_mfma_f32_16x16x32_bf16 v[28:31], v[160:163], v[68:71], v[28:31]
s_add_u32 s37, s43, 256
s_add_u32 m0, s44, 8192
s_nop 0
buffer_load_dwordx4 v2, s[8:11], s37 offen lds
v_mfma_f32_16x16x32_bf16 v[32:35], v[232:235], v[64:67], v[32:35]
v_mfma_f32_16x16x32_bf16 v[36:39], v[232:235], v[68:71], v[36:39]
v_mfma_f32_16x16x32_bf16 v[40:43], a[48:51], v[64:67], v[40:43]
v_mfma_f32_16x16x32_bf16 v[44:47], a[48:51], v[68:71], v[44:47]
ds_read_b128 v[64:67], v3 offset:8192
ds_read_b128 v[68:71], v3 offset:9216
s_waitcnt lgkmcnt(2)
v_mfma_f32_16x16x32_bf16 v[16:19], v[92:95], v[72:75], v[16:19]
v_mfma_f32_16x16x32_bf16 v[20:23], v[92:95], v[76:79], v[20:23]
v_mfma_f32_16x16x32_bf16 v[24:27], v[164:167], v[72:75], v[24:27]
v_mfma_f32_16x16x32_bf16 v[28:31], v[164:167], v[76:79], v[28:31]
s_add_u32 s37, s43, 384
s_add_u32 m0, s44, 12288
s_nop 0
buffer_load_dwordx4 v2, s[8:11], s37 offen lds
v_mfma_f32_16x16x32_bf16 v[32:35], v[236:239], v[72:75], v[32:35]
v_mfma_f32_16x16x32_bf16 v[36:39], v[236:239], v[76:79], v[36:39]
v_mfma_f32_16x16x32_bf16 v[40:43], a[52:55], v[72:75], v[40:43]
v_mfma_f32_16x16x32_bf16 v[44:47], a[52:55], v[76:79], v[44:47]
ds_read_b128 v[72:75], v3 offset:10240
ds_read_b128 v[76:79], v3 offset:11264
s_waitcnt lgkmcnt(2)
v_mfma_f32_16x16x32_bf16 v[16:19], v[96:99], v[64:67], v[16:19]
v_mfma_f32_16x16x32_bf16 v[20:23], v[96:99], v[68:71], v[20:23]
v_mfma_f32_16x16x32_bf16 v[24:27], v[168:171], v[64:67], v[24:27]
v_mfma_f32_16x16x32_bf16 v[28:31], v[168:171], v[68:71], v[28:31]
s_add_u32 s37, s43, 512
s_add_u32 m0, s44, 16384
s_nop 0
buffer_load_dwordx4 v2, s[8:11], s37 offen lds
v_mfma_f32_16x16x32_bf16 v[32:35], v[240:243], v[64:67], v[32:35]
v_mfma_f32_16x16x32_bf16 v[36:39], v[240:243], v[68:71], v[36:39]
v_mfma_f32_16x16x32_bf16 v[40:43], a[56:59], v[64:67], v[40:43]
v_mfma_f32_16x16x32_bf16 v[44:47], a[56:59], v[68:71], v[44:47]
ds_read_b128 v[64:67], v3 offset:12288
ds_read_b128 v[68:71], v3 offset:13312
s_waitcnt lgkmcnt(2)
v_mfma_f32_16x16x32_bf16 v[16:19], v[100:103], v[72:75], v[16:19]
v_mfma_f32_16x16x32_bf16 v[20:23], v[100:103], v[76:79], v[20:23]
v_mfma_f32_16x16x32_bf16 v[24:27], v[172:175], v[72:75], v[24:27]
v_mfma_f32_16x16x32_bf16 v[28:31], v[172:175], v[76:79], v[28:31]
s_add_u32 s37, s43, 640
s_add_u32 m0, s44, 20480
s_nop 0
buffer_load_dwordx4 v2, s[8:11], s37 offen lds
v_mfma_f32_16x16x32_bf16 v[32:35], v[244:247], v[72:75], v[32:35]
v_mfma_f32_16x16x32_bf16 v[36:39], v[244:247], v[76:79], v[36:39]
v_mfma_f32_16x16x32_bf16 v[40:43], a[60:63], v[72:75], v[40:43]
v_mfma_f32_16x16x32_bf16 v[44:47], a[60:63], v[76:79], v[44:47]
ds_read_b128 v[72:75], v3 offset:14336
ds_read_b128 v[76:79], v3 offset:15360
s_waitcnt lgkmcnt(2)
v_mfma_f32_16x16x32_bf16 v[16:19], v[104:107], v[64:67], v[16:19]
v_mfma_f32_16x16x32_bf16 v[20:23], v[104:107], v[68:71], v[20:23]
v_mfma_f32_16x16x32_bf16 v[24:27], v[176:179], v[64:67], v[24:27]
v_mfma_f32_16x16x32_bf16 v[28:31], v[176:179], v[68:71], v[28:31]
s_add_u32 s37, s43, 768
s_add_u32 m0, s44, 24576
s_nop 0
buffer_load_dwordx4 v2, s[8:11], s37 offen lds
v_mfma_f32_16x16x32_bf16 v[32:35], v[248:251], v[64:67], v[32:35]
v_mfma_f32_16x16x32_bf16 v[36:39], v[248:251], v[68:71], v[36:39]
v_mfma_f32_16x16x32_bf16 v[40:43], a[64:67], v[64:67], v[40:43]
v_mfma_f32_16x16x32_bf16 v[44:47], a[64:67], v[68:71], v[44:47]
ds_read_b128 v[64:67], v3 offset:16384
ds_read_b128 v[68:71], v3 offset:17408
s_waitcnt lgkmcnt(2)
v_mfma_f32_16x16x32_bf16 v[16:19], v[108:111], v[72:75], v[16:19]
v_mfma_f32_16x16x32_bf16 v[20:23], v[108:111], v[76:79], v[20:23]
v_mfma_f32_16x16x32_bf16 v[24:27], v[180:183], v[72:75], v[24:27]
v_mfma_f32_16x16x32_bf16 v[28:31], v[180:183], v[76:79], v[28:31]
s_add_u32 s37, s43, 896
s_add_u32 m0, s44, 28672
s_nop 0
buffer_load_dwordx4 v2, s[8:11], s37 offen lds
v_mfma_f32_16x16x32_bf16 v[32:35], v[252:255], v[72:75], v[32:35]
v_mfma_f32_16x16x32_bf16 v[36:39], v[252:255], v[76:79], v[36:39]
v_mfma_f32_16x16x32_bf16 v[40:43], a[68:71], v[72:75], v[40:43]
v_mfma_f32_16x16x32_bf16 v[44:47], a[68:71], v[76:79], v[44:47]
ds_read_b128 v[72:75], v3 offset:18432
ds_read_b128 v[76:79], v3 offset:19456
s_waitcnt lgkmcnt(2)
v_mfma_f32_16x16x32_bf16 v[16:19], v[112:115], v[64:67], v[16:19]
v_mfma_f32_16x16x32_bf16 v[20:23], v[112:115], v[68:71], v[20:23]
v_mfma_f32_16x16x32_bf16 v[24:27], v[184:187], v[64:67], v[24:27]
v_mfma_f32_16x16x32_bf16 v[28:31], v[184:187], v[68:71], v[28:31]
s_add_u32 s37, s43, 1024
s_add_u32 m0, s44, 32768
s_nop 0
buffer_load_dwordx4 v2, s[8:11], s37 offen lds
v_mfma_f32_16x16x32_bf16 v[32:35], a[0:3], v[64:67], v[32:35]
v_mfma_f32_16x16x32_bf16 v[36:39], a[0:3], v[68:71], v[36:39]
v_mfma_f32_16x16x32_bf16 v[40:43], a[72:75], v[64:67], v[40:43]
v_mfma_f32_16x16x32_bf16 v[44:47], a[72:75], v[68:71], v[44:47]
ds_read_b128 v[64:67], v3 offset:20480
ds_read_b128 v[68:71], v3 offset:21504
s_waitcnt lgkmcnt(2)
v_mfma_f32_16x16x32_bf16 v[16:19], v[116:119], v[72:75], v[16:19]
v_mfma_f32_16x16x32_bf16 v[20:23], v[116:119], v[76:79], v[20:23]
v_mfma_f32_16x16x32_bf16 v[24:27], v[188:191], v[72:75], v[24:27]
v_mfma_f32_16x16x32_bf16 v[28:31], v[188:191], v[76:79], v[28:31]
v_mfma_f32_16x16x32_bf16 v[32:35], a[4:7], v[72:75], v[32:35]
v_mfma_f32_16x16x32_bf16 v[36:39], a[4:7], v[76:79], v[36:39]
v_mfma_f32_16x16x32_bf16 v[40:43], a[76:79], v[72:75], v[40:43]
v_mfma_f32_16x16x32_bf16 v[44:47], a[76:79], v[76:79], v[44:47]
ds_read_b128 v[72:75], v3 offset:22528
ds_read_b128 v[76:79], v3 offset:23552
s_waitcnt lgkmcnt(2)
v_mfma_f32_16x16x32_bf16 v[16:19], v[120:123], v[64:67], v[16:19]
v_mfma_f32_16x16x32_bf16 v[20:23], v[120:123], v[68:71], v[20:23]
v_mfma_f32_16x16x32_bf16 v[24:27], v[192:195], v[64:67], v[24:27]
v_mfma_f32_16x16x32_bf16 v[28:31], v[192:195], v[68:71], v[28:31]
v_mfma_f32_16x16x32_bf16 v[32:35], a[8:11], v[64:67], v[32:35]
v_mfma_f32_16x16x32_bf16 v[36:39], a[8:11], v[68:71], v[36:39]
v_mfma_f32_16x16x32_bf16 v[40:43], a[80:83], v[64:67], v[40:43]
v_mfma_f32_16x16x32_bf16 v[44:47], a[80:83], v[68:71], v[44:47]
ds_read_b128 v[64:67], v3 offset:24576
ds_read_b128 v[68:71], v3 offset:25600
s_waitcnt lgkmcnt(2)
v_mfma_f32_16x16x32_bf16 v[16:19], v[124:127], v[72:75], v[16:19]
v_mfma_f32_16x16x32_bf16 v[20:23], v[124:127], v[76:79], v[20:23]
v_mfma_f32_16x16x32_bf16 v[24:27], v[196:199], v[72:75], v[24:27]
v_mfma_f32_16x16x32_bf16 v[28:31], v[196:199], v[76:79], v[28:31]
v_mfma_f32_16x16x32_bf16 v[32:35], a[12:15], v[72:75], v[32:35]
v_mfma_f32_16x16x32_bf16 v[36:39], a[12:15], v[76:79], v[36:39]
v_mfma_f32_16x16x32_bf16 v[40:43], a[84:87], v[72:75], v[40:43]
v_mfma_f32_16x16x32_bf16 v[44:47], a[84:87], v[76:79], v[44:47]
ds_read_b128 v[72:75], v3 offset:26624
ds_read_b128 v[76:79], v3 offset:27648
s_waitcnt lgkmcnt(2)
v_mfma_f32_16x16x32_bf16 v[16:19], v[128:131], v[64:67], v[16:19]
v_mfma_f32_16x16x32_bf16 v[20:23], v[128:131], v[68:71], v[20:23]
v_mfma_f32_16x16x32_bf16 v[24:27], v[200:203], v[64:67], v[24:27]
v_mfma_f32_16x16x32_bf16 v[28:31], v[200:203], v[68:71], v[28:31]
v_mfma_f32_16x16x32_bf16 v[32:35], a[16:19], v[64:67], v[32:35]
v_mfma_f32_16x16x32_bf16 v[36:39], a[16:19], v[68:71], v[36:39]
v_mfma_f32_16x16x32_bf16 v[40:43], a[88:91], v[64:67], v[40:43]
v_mfma_f32_16x16x32_bf16 v[44:47], a[88:91], v[68:71], v[44:47]
ds_read_b128 v[64:67], v3 offset:28672
ds_read_b128 v[68:71], v3 offset:29696
s_waitcnt lgkmcnt(2)
v_mfma_f32_16x16x32_bf16 v[16:19], v[132:135], v[72:75], v[16:19]
v_mfma_f32_16x16x32_bf16 v[20:23], v[132:135], v[76:79], v[20:23]
v_mfma_f32_16x16x32_bf16 v[24:27], v[204:207], v[72:75], v[24:27]
v_mfma_f32_16x16x32_bf16 v[28:31], v[204:207], v[76:79], v[28:31]
v_mfma_f32_16x16x32_bf16 v[32:35], a[20:23], v[72:75], v[32:35]
v_mfma_f32_16x16x32_bf16 v[36:39], a[20:23], v[76:79], v[36:39]
v_mfma_f32_16x16x32_bf16 v[40:43], a[92:95], v[72:75], v[40:43]
v_mfma_f32_16x16x32_bf16 v[44:47], a[92:95], v[76:79], v[44:47]
ds_read_b128 v[72:75], v3 offset:30720
ds_read_b128 v[76:79], v3 offset:31744
s_waitcnt lgkmcnt(2)
v_mfma_f32_16x16x32_bf16 v[16:19], v[136:139], v[64:67], v[16:19]
v_mfma_f32_16x16x32_bf16 v[20:23], v[136:139], v[68:71], v[20:23]
v_mfma_f32_16x16x32_bf16 v[24:27], v[208:211], v[64:67], v[24:27]
v_mfma_f32_16x16x32_bf16 v[28:31], v[208:211], v[68:71], v[28:31]
v_mfma_f32_16x16x32_bf16 v[32:35], a[24:27], v[64:67], v[32:35]
v_mfma_f32_16x16x32_bf16 v[36:39], a[24:27], v[68:71], v[36:39]
v_mfma_f32_16x16x32_bf16 v[40:43], a[96:99], v[64:67], v[40:43]
v_mfma_f32_16x16x32_bf16 v[44:47], a[96:99], v[68:71], v[44:47]
ds_read_b128 v[64:67], v3 offset:32768
ds_read_b128 v[68:71], v3 offset:33792
s_waitcnt lgkmcnt(2)
v_mfma_f32_16x16x32_bf16 v[16:19], v[140:143], v[72:75], v[16:19]
v_mfma_f32_16x16x32_bf16 v[20:23], v[140:143], v[76:79], v[20:23]
v_mfma_f32_16x16x32_bf16 v[24:27], v[212:215], v[72:75], v[24:27]
v_mfma_f32_16x16x32_bf16 v[28:31], v[212:215], v[76:79], v[28:31]
v_mfma_f32_16x16x32_bf16 v[32:35], a[28:31], v[72:75], v[32:35]
v_mfma_f32_16x16x32_bf16 v[36:39], a[28:31], v[76:79], v[36:39]
v_mfma_f32_16x16x32_bf16 v[40:43], a[100:103], v[72:75], v[40:43]
v_mfma_f32_16x16x32_bf16 v[44:47], a[100:103], v[76:79], v[44:47]
ds_read_b128 v[72:75], v3 offset:34816
ds_read_b128 v[76:79], v3 offset:35840
s_waitcnt lgkmcnt(2)
v_mfma_f32_16x16x32_bf16 v[16:19], v[144:147], v[64:67], v[16:19]
v_mfma_f32_16x16x32_bf16 v[20:23], v[144:147], v[68:71], v[20:23]
v_mfma_f32_16x16x32_bf16 v[24:27], v[216:219], v[64:67], v[24:27]
v_mfma_f32_16x16x32_bf16 v[28:31], v[216:219], v[68:71], v[28:31]
v_mfma_f32_16x16x32_bf16 v[32:35], a[32:35], v[64:67], v[32:35]
v_mfma_f32_16x16x32_bf16 v[36:39], a[32:35], v[68:71], v[36:39]
v_mfma_f32_16x16x32_bf16 v[40:43], a[104:107], v[64:67], v[40:43]
v_mfma_f32_16x16x32_bf16 v[44:47], a[104:107], v[68:71], v[44:47]
s_waitcnt lgkmcnt(0)
v_mfma_f32_16x16x32_bf16 v[16:19], v[148:151], v[72:75], v[16:19]
v_mfma_f32_16x16x32_bf16 v[20:23], v[148:151], v[76:79], v[20:23]
v_mfma_f32_16x16x32_bf16 v[24:27], v[220:223], v[72:75], v[24:27]
v_mfma_f32_16x16x32_bf16 v[28:31], v[220:223], v[76:79], v[28:31]
v_mfma_f32_16x16x32_bf16 v[32:35], a[36:39], v[72:75], v[32:35]
v_mfma_f32_16x16x32_bf16 v[36:39], a[36:39], v[76:79], v[36:39]
v_mfma_f32_16x16x32_bf16 v[40:43], a[108:111], v[72:75], v[40:43]
v_mfma_f32_16x16x32_bf16 v[44:47], a[108:111], v[76:79], v[44:47]
v_add_u32 v3, s50, v3
s_sub_u32 s50, 0, s50
v_cvt_pk_bf16_f32 v16, v16, v17
v_cvt_pk_bf16_f32 v17, v18, v19
ds_write_b64 v4, v[16:17] offset:0
v_cvt_pk_bf16_f32 v20, v20, v21
v_cvt_pk_bf16_f32 v21, v22, v23
ds_write_b64 v4, v[20:21] offset:7296
v_cvt_pk_bf16_f32 v24, v24, v25
v_cvt_pk_bf16_f32 v25, v26, v27
ds_write_b64 v4, v[24:25] offset:32
v_cvt_pk_bf16_f32 v28, v28, v29
v_cvt_pk_bf16_f32 v29, v30, v31
ds_write_b64 v4, v[28:29] offset:7328
s_cmp_eq_u32 s34, 3
s_cbranch_scc1 L_a_gate
v_cvt_pk_bf16_f32 v32, v32, v33
v_cvt_pk_bf16_f32 v33, v34, v35
ds_write_b64 v4, v[32:33] offset:64
v_cvt_pk_bf16_f32 v36, v36, v37
v_cvt_pk_bf16_f32 v37, v38, v39
ds_write_b64 v4, v[36:37] offset:7360
v_cvt_pk_bf16_f32 v40, v40, v41
v_cvt_pk_bf16_f32 v41, v42, v43
ds_write_b64 v4, v[40:41] offset:96
v_cvt_pk_bf16_f32 v44, v44, v45
v_cvt_pk_bf16_f32 v45, v46, v47
ds_write_b64 v4, v[44:45] offset:7392
s_branch L_a_nog2
L_a_gate:
ds_write_b32 v14, v32
ds_write_b32 v14, v36 offset:64
L_a_nog2:
v_add_u32 v4, 14592, v4
v_add_u32 v14, 128, v14
s_add_u32 s35, s35, 1
s_cmp_lt_u32 s35, 6
s_cbranch_scc1 L_a_loop
s_waitcnt vmcnt(0) lgkmcnt(0)
s_barrier
s_mov_b32 s35, 0
s_mul_i32 s39, s34, 36
s_add_u32 s39, s39, 73728
s_mul_i32 s40, s33, 176
s_mov_b32 s41, 0x3eae1a93
s_mov_b32 s42, 0xbfb8aa3b
L_la_loop:
v_add_u32 v12, s35, v9
v_min_u32 v12, 175, v12
v_add_u32 v2, s40, v12
v_add_u32 v12, 16, v12
v_mul_u32_u24 v14, 456, v12
v_add_u32 v14, s39, v14
v_lshlrev_b32 v12, 2, v12
v_add_u32 v12, 161280, v12
ds_read_b32 v3, v12
ds_read2_b32 v[16:17], v14 offset0:0 offset1:1
ds_read2_b32 v[18:19], v14 offset0:2 offset1:3
ds_read2_b32 v[20:21], v14 offset0:4 offset1:5
ds_read2_b32 v[22:23], v14 offset0:6 offset1:7
ds_read_b32 v24, v14 offset:32
v_subrev_u32 v15, 0, v14
ds_read2_b32 v[26:27], v15 offset0:36 offset1:37
ds_read2_b32 v[28:29], v15 offset0:38 offset1:39
ds_read2_b32 v[30:31], v15 offset0:40 offset1:41
ds_read2_b32 v[32:33], v15 offset0:42 offset1:43
ds_read_b32 v34, v15 offset:176
v_subrev_u32 v15, 912, v14
ds_read2_b32 v[36:37], v15 offset0:36 offset1:37
ds_read2_b32 v[38:39], v15 offset0:38 offset1:39
ds_read2_b32 v[40:41], v15 offset0:40 offset1:41
ds_read2_b32 v[42:43], v15 offset0:42 offset1:43
ds_read_b32 v44, v15 offset:176
s_waitcnt lgkmcnt(5)
v_dot2_f32_bf16 v176, v16, v26, 0
v_dot2_f32_bf16 v176, v17, v27, v176
v_dot2_f32_bf16 v176, v18, v28, v176
v_dot2_f32_bf16 v176, v19, v29, v176
v_dot2_f32_bf16 v176, v20, v30, v176
v_dot2_f32_bf16 v176, v21, v31, v176
v_dot2_f32_bf16 v176, v22, v32, v176
v_dot2_f32_bf16 v176, v23, v33, v176
v_dot2_f32_bf16 v176, v24, v34, v176
v_subrev_u32 v15, 1824, v14
ds_read2_b32 v[46:47], v15 offset0:36 offset1:37
ds_read2_b32 v[48:49], v15 offset0:38 offset1:39
ds_read2_b32 v[50:51], v15 offset0:40 offset1:41
ds_read2_b32 v[52:53], v15 offset0:42 offset1:43
ds_read_b32 v54, v15 offset:176
s_waitcnt lgkmcnt(5)
v_dot2_f32_bf16 v177, v16, v36, 0
v_dot2_f32_bf16 v177, v17, v37, v177
v_dot2_f32_bf16 v177, v18, v38, v177
v_dot2_f32_bf16 v177, v19, v39, v177
v_dot2_f32_bf16 v177, v20, v40, v177
v_dot2_f32_bf16 v177, v21, v41, v177
v_dot2_f32_bf16 v177, v22, v42, v177
v_dot2_f32_bf16 v177, v23, v43, v177
v_dot2_f32_bf16 v177, v24, v44, v177
v_subrev_u32 v15, 2736, v14
ds_read2_b32 v[56:57], v15 offset0:36 offset1:37
ds_read2_b32 v[58:59], v15 offset0:38 offset1:39
ds_read2_b32 v[60:61], v15 offset0:40 offset1:41
ds_read2_b32 v[62:63], v15 offset0:42 offset1:43
ds_read_b32 v64, v15 offset:176
s_waitcnt lgkmcnt(5)
v_dot2_f32_bf16 v178, v16, v46, 0
v_dot2_f32_bf16 v178, v17, v47, v178
v_dot2_f32_bf16 v178, v18, v48, v178
v_dot2_f32_bf16 v178, v19, v49, v178
v_dot2_f32_bf16 v178, v20, v50, v178
v_dot2_f32_bf16 v178, v21, v51, v178
v_dot2_f32_bf16 v178, v22, v52, v178
v_dot2_f32_bf16 v178, v23, v53, v178
v_dot2_f32_bf16 v178, v24, v54, v178
v_subrev_u32 v15, 3648, v14
ds_read2_b32 v[26:27], v15 offset0:36 offset1:37
ds_read2_b32 v[28:29], v15 offset0:38 offset1:39
ds_read2_b32 v[30:31], v15 offset0:40 offset1:41
ds_read2_b32 v[32:33], v15 offset0:42 offset1:43
ds_read_b32 v34, v15 offset:176
s_waitcnt lgkmcnt(5)
v_dot2_f32_bf16 v179, v16, v56, 0
v_dot2_f32_bf16 v179, v17, v57, v179
v_dot2_f32_bf16 v179, v18, v58, v179
v_dot2_f32_bf16 v179, v19, v59, v179
v_dot2_f32_bf16 v179, v20, v60, v179
v_dot2_f32_bf16 v179, v21, v61, v179
v_dot2_f32_bf16 v179, v22, v62, v179
v_dot2_f32_bf16 v179, v23, v63, v179
v_dot2_f32_bf16 v179, v24, v64, v179
v_subrev_u32 v15, 4560, v14
ds_read2_b32 v[36:37], v15 offset0:36 offset1:37
ds_read2_b32 v[38:39], v15 offset0:38 offset1:39
ds_read2_b32 v[40:41], v15 offset0:40 offset1:41
ds_read2_b32 v[42:43], v15 offset0:42 offset1:43
ds_read_b32 v44, v15 offset:176
s_waitcnt lgkmcnt(5)
v_dot2_f32_bf16 v180, v16, v26, 0
v_dot2_f32_bf16 v180, v17, v27, v180
v_dot2_f32_bf16 v180, v18, v28, v180
v_dot2_f32_bf16 v180, v19, v29, v180
v_dot2_f32_bf16 v180, v20, v30, v180
v_dot2_f32_bf16 v180, v21, v31, v180
v_dot2_f32_bf16 v180, v22, v32, v180
v_dot2_f32_bf16 v180, v23, v33, v180
v_dot2_f32_bf16 v180, v24, v34, v180
v_subrev_u32 v15, 5472, v14
ds_read2_b32 v[46:47], v15 offset0:36 offset1:37
ds_read2_b32 v[48:49], v15 offset0:38 offset1:39
ds_read2_b32 v[50:51], v15 offset0:40 offset1:41
ds_read2_b32 v[52:53], v15 offset0:42 offset1:43
ds_read_b32 v54, v15 offset:176
s_waitcnt lgkmcnt(5)
v_dot2_f32_bf16 v181, v16, v36, 0
v_dot2_f32_bf16 v181, v17, v37, v181
v_dot2_f32_bf16 v181, v18, v38, v181
v_dot2_f32_bf16 v181, v19, v39, v181
v_dot2_f32_bf16 v181, v20, v40, v181
v_dot2_f32_bf16 v181, v21, v41, v181
v_dot2_f32_bf16 v181, v22, v42, v181
v_dot2_f32_bf16 v181, v23, v43, v181
v_dot2_f32_bf16 v181, v24, v44, v181
v_subrev_u32 v15, 6384, v14
ds_read2_b32 v[56:57], v15 offset0:36 offset1:37
ds_read2_b32 v[58:59], v15 offset0:38 offset1:39
ds_read2_b32 v[60:61], v15 offset0:40 offset1:41
ds_read2_b32 v[62:63], v15 offset0:42 offset1:43
ds_read_b32 v64, v15 offset:176
s_waitcnt lgkmcnt(5)
v_dot2_f32_bf16 v182, v16, v46, 0
v_dot2_f32_bf16 v182, v17, v47, v182
v_dot2_f32_bf16 v182, v18, v48, v182
v_dot2_f32_bf16 v182, v19, v49, v182
v_dot2_f32_bf16 v182, v20, v50, v182
v_dot2_f32_bf16 v182, v21, v51, v182
v_dot2_f32_bf16 v182, v22, v52, v182
v_dot2_f32_bf16 v182, v23, v53, v182
v_dot2_f32_bf16 v182, v24, v54, v182
s_waitcnt lgkmcnt(0)
v_dot2_f32_bf16 v183, v16, v56, 0
v_dot2_f32_bf16 v183, v17, v57, v183
v_dot2_f32_bf16 v183, v18, v58, v183
v_dot2_f32_bf16 v183, v19, v59, v183
v_dot2_f32_bf16 v183, v20, v60, v183
v_dot2_f32_bf16 v183, v21, v61, v183
v_dot2_f32_bf16 v183, v22, v62, v183
v_dot2_f32_bf16 v183, v23, v63, v183
v_dot2_f32_bf16 v183, v24, v64, v183
v_subrev_u32 v15, 0, v14
ds_read2_b32 v[100:101], v15 offset0:72 offset1:73
ds_read2_b32 v[102:103], v15 offset0:74 offset1:75
ds_read2_b32 v[104:105], v15 offset0:76 offset1:77
ds_read2_b32 v[106:107], v15 offset0:78 offset1:79
ds_read_b32 v108, v15 offset:320
v_subrev_u32 v15, 912, v14
ds_read2_b32 v[110:111], v15 offset0:72 offset1:73
ds_read2_b32 v[112:113], v15 offset0:74 offset1:75
ds_read2_b32 v[114:115], v15 offset0:76 offset1:77
ds_read2_b32 v[116:117], v15 offset0:78 offset1:79
ds_read_b32 v118, v15 offset:320
v_mov_b32 v13, 0xf149f2ca
v_mul_f32 v176, s41, v176
v_mul_f32 v177, s41, v177
v_mul_f32 v178, s41, v178
v_mul_f32 v179, s41, v179
v_mul_f32 v180, s41, v180
v_mul_f32 v181, s41, v181
v_mul_f32 v182, s41, v182
v_mul_f32 v183, s41, v183
v_cmp_le_u32 vcc, 2, v2
s_nop 1
v_cndmask_b32 v177, v13, v177, vcc
v_cmp_le_u32 vcc, 4, v2
s_nop 1
v_cndmask_b32 v178, v13, v178, vcc
v_cmp_le_u32 vcc, 6, v2
s_nop 1
v_cndmask_b32 v179, v13, v179, vcc
v_cmp_le_u32 vcc, 8, v2
s_nop 1
v_cndmask_b32 v180, v13, v180, vcc
v_cmp_le_u32 vcc, 10, v2
s_nop 1
v_cndmask_b32 v181, v13, v181, vcc
v_cmp_le_u32 vcc, 12, v2
s_nop 1
v_cndmask_b32 v182, v13, v182, vcc
v_cmp_le_u32 vcc, 14, v2
s_nop 1
v_cndmask_b32 v183, v13, v183, vcc
v_max3_f32 v12, v176, v177, v178
v_max3_f32 v12, v12, v179, v180
v_max3_f32 v12, v12, v181, v182
v_max_f32 v12, v12, v183
v_sub_f32 v176, v176, v12
v_sub_f32 v177, v177, v12
v_sub_f32 v178, v178, v12
v_sub_f32 v179, v179, v12
v_sub_f32 v180, v180, v12
v_sub_f32 v181, v181, v12
v_sub_f32 v182, v182, v12
v_sub_f32 v183, v183, v12
v_exp_f32 v176, v176
v_exp_f32 v177, v177
v_exp_f32 v178, v178
v_exp_f32 v179, v179
v_exp_f32 v180, v180
v_exp_f32 v181, v181
v_exp_f32 v182, v182
v_exp_f32 v183, v183
v_cvt_pk_bf16_f32 v204, v176, v8
v_cvt_pk_bf16_f32 v205, v177, v8
v_cvt_pk_bf16_f32 v206, v178, v8
v_cvt_pk_bf16_f32 v207, v179, v8
v_cvt_pk_bf16_f32 v208, v180, v8
v_cvt_pk_bf16_f32 v209, v181, v8
v_cvt_pk_bf16_f32 v210, v182, v8
v_cvt_pk_bf16_f32 v211, v183, v8
v_lshlrev_b32 v212, 16, v204
v_lshlrev_b32 v213, 16, v205
v_lshlrev_b32 v214, 16, v206
v_lshlrev_b32 v215, 16, v207
v_lshlrev_b32 v216, 16, v208
v_lshlrev_b32 v217, 16, v209
v_lshlrev_b32 v218, 16, v210
v_lshlrev_b32 v219, 16, v211
v_add_f32 v12, v212, v213
v_add_f32 v13, v214, v215
v_add_f32 v12, v12, v216
v_add_f32 v13, v13, v217
v_add_f32 v12, v12, v218
v_add_f32 v13, v13, v219
v_add_f32 v12, v12, v13
v_mul_f32 v13, s42, v3
v_exp_f32 v3, v13
v_exp_f32 v13, -v13
v_add_f32 v3, 1.0, v3
v_add_f32 v13, 1.0, v13
v_mul_f32 v12, v12, v3
v_rcp_f32 v12, v12
v_rcp_f32 v13, v13
v_subrev_u32 v15, 1824, v14
ds_read2_b32 v[120:121], v15 offset0:72 offset1:73
ds_read2_b32 v[122:123], v15 offset0:74 offset1:75
ds_read2_b32 v[124:125], v15 offset0:76 offset1:77
ds_read2_b32 v[126:127], v15 offset0:78 offset1:79
ds_read_b32 v128, v15 offset:320
s_waitcnt lgkmcnt(10)
v_dot2_f32_bf16 v184, v100, v204, 0
v_dot2_f32_bf16 v185, v100, v212, 0
v_dot2_f32_bf16 v186, v101, v204, 0
v_dot2_f32_bf16 v187, v101, v212, 0
v_dot2_f32_bf16 v188, v102, v204, 0
v_dot2_f32_bf16 v189, v102, v212, 0
v_dot2_f32_bf16 v190, v103, v204, 0
v_dot2_f32_bf16 v191, v103, v212, 0
v_dot2_f32_bf16 v192, v104, v204, 0
v_dot2_f32_bf16 v193, v104, v212, 0
v_dot2_f32_bf16 v194, v105, v204, 0
v_dot2_f32_bf16 v195, v105, v212, 0
v_dot2_f32_bf16 v196, v106, v204, 0
v_dot2_f32_bf16 v197, v106, v212, 0
v_dot2_f32_bf16 v198, v107, v204, 0
v_dot2_f32_bf16 v199, v107, v212, 0
v_dot2_f32_bf16 v200, v108, v204, 0
v_dot2_f32_bf16 v201, v108, v212, 0
v_subrev_u32 v15, 2736, v14
ds_read2_b32 v[130:131], v15 offset0:72 offset1:73
ds_read2_b32 v[132:133], v15 offset0:74 offset1:75
ds_read2_b32 v[134:135], v15 offset0:76 offset1:77
ds_read2_b32 v[136:137], v15 offset0:78 offset1:79
ds_read_b32 v138, v15 offset:320
s_waitcnt lgkmcnt(10)
v_dot2_f32_bf16 v184, v110, v205, v184
v_dot2_f32_bf16 v185, v110, v213, v185
v_dot2_f32_bf16 v186, v111, v205, v186
v_dot2_f32_bf16 v187, v111, v213, v187
v_dot2_f32_bf16 v188, v112, v205, v188
v_dot2_f32_bf16 v189, v112, v213, v189
v_dot2_f32_bf16 v190, v113, v205, v190
v_dot2_f32_bf16 v191, v113, v213, v191
v_dot2_f32_bf16 v192, v114, v205, v192
v_dot2_f32_bf16 v193, v114, v213, v193
v_dot2_f32_bf16 v194, v115, v205, v194
v_dot2_f32_bf16 v195, v115, v213, v195
v_dot2_f32_bf16 v196, v116, v205, v196
v_dot2_f32_bf16 v197, v116, v213, v197
v_dot2_f32_bf16 v198, v117, v205, v198
v_dot2_f32_bf16 v199, v117, v213, v199
v_dot2_f32_bf16 v200, v118, v205, v200
v_dot2_f32_bf16 v201, v118, v213, v201
v_subrev_u32 v15, 3648, v14
ds_read2_b32 v[100:101], v15 offset0:72 offset1:73
ds_read2_b32 v[102:103], v15 offset0:74 offset1:75
ds_read2_b32 v[104:105], v15 offset0:76 offset1:77
ds_read2_b32 v[106:107], v15 offset0:78 offset1:79
ds_read_b32 v108, v15 offset:320
s_waitcnt lgkmcnt(10)
v_dot2_f32_bf16 v184, v120, v206, v184
v_dot2_f32_bf16 v185, v120, v214, v185
v_dot2_f32_bf16 v186, v121, v206, v186
v_dot2_f32_bf16 v187, v121, v214, v187
v_dot2_f32_bf16 v188, v122, v206, v188
v_dot2_f32_bf16 v189, v122, v214, v189
v_dot2_f32_bf16 v190, v123, v206, v190
v_dot2_f32_bf16 v191, v123, v214, v191
v_dot2_f32_bf16 v192, v124, v206, v192
v_dot2_f32_bf16 v193, v124, v214, v193
v_dot2_f32_bf16 v194, v125, v206, v194
v_dot2_f32_bf16 v195, v125, v214, v195
v_dot2_f32_bf16 v196, v126, v206, v196
v_dot2_f32_bf16 v197, v126, v214, v197
v_dot2_f32_bf16 v198, v127, v206, v198
v_dot2_f32_bf16 v199, v127, v214, v199
v_dot2_f32_bf16 v200, v128, v206, v200
v_dot2_f32_bf16 v201, v128, v214, v201
v_subrev_u32 v15, 4560, v14
ds_read2_b32 v[110:111], v15 offset0:72 offset1:73
ds_read2_b32 v[112:113], v15 offset0:74 offset1:75
ds_read2_b32 v[114:115], v15 offset0:76 offset1:77
ds_read2_b32 v[116:117], v15 offset0:78 offset1:79
ds_read_b32 v118, v15 offset:320
s_waitcnt lgkmcnt(10)
v_dot2_f32_bf16 v184, v130, v207, v184
v_dot2_f32_bf16 v185, v130, v215, v185
v_dot2_f32_bf16 v186, v131, v207, v186
v_dot2_f32_bf16 v187, v131, v215, v187
v_dot2_f32_bf16 v188, v132, v207, v188
v_dot2_f32_bf16 v189, v132, v215, v189
v_dot2_f32_bf16 v190, v133, v207, v190
v_dot2_f32_bf16 v191, v133, v215, v191
v_dot2_f32_bf16 v192, v134, v207, v192
v_dot2_f32_bf16 v193, v134, v215, v193
v_dot2_f32_bf16 v194, v135, v207, v194
v_dot2_f32_bf16 v195, v135, v215, v195
v_dot2_f32_bf16 v196, v136, v207, v196
v_dot2_f32_bf16 v197, v136, v215, v197
v_dot2_f32_bf16 v198, v137, v207, v198
v_dot2_f32_bf16 v199, v137, v215, v199
v_dot2_f32_bf16 v200, v138, v207, v200
v_dot2_f32_bf16 v201, v138, v215, v201
v_subrev_u32 v15, 5472, v14
ds_read2_b32 v[120:121], v15 offset0:72 offset1:73
ds_read2_b32 v[122:123], v15 offset0:74 offset1:75
ds_read2_b32 v[124:125], v15 offset0:76 offset1:77
ds_read2_b32 v[126:127], v15 offset0:78 offset1:79
ds_read_b32 v128, v15 offset:320
s_waitcnt lgkmcnt(10)
v_dot2_f32_bf16 v184, v100, v208, v184
v_dot2_f32_bf16 v185, v100, v216, v185
v_dot2_f32_bf16 v186, v101, v208, v186
v_dot2_f32_bf16 v187, v101, v216, v187
v_dot2_f32_bf16 v188, v102, v208, v188
v_dot2_f32_bf16 v189, v102, v216, v189
v_dot2_f32_bf16 v190, v103, v208, v190
v_dot2_f32_bf16 v191, v103, v216, v191
v_dot2_f32_bf16 v192, v104, v208, v192
v_dot2_f32_bf16 v193, v104, v216, v193
v_dot2_f32_bf16 v194, v105, v208, v194
v_dot2_f32_bf16 v195, v105, v216, v195
v_dot2_f32_bf16 v196, v106, v208, v196
v_dot2_f32_bf16 v197, v106, v216, v197
v_dot2_f32_bf16 v198, v107, v208, v198
v_dot2_f32_bf16 v199, v107, v216, v199
v_dot2_f32_bf16 v200, v108, v208, v200
v_dot2_f32_bf16 v201, v108, v216, v201
v_subrev_u32 v15, 6384, v14
ds_read2_b32 v[130:131], v15 offset0:72 offset1:73
ds_read2_b32 v[132:133], v15 offset0:74 offset1:75
ds_read2_b32 v[134:135], v15 offset0:76 offset1:77
ds_read2_b32 v[136:137], v15 offset0:78 offset1:79
ds_read_b32 v138, v15 offset:320
s_waitcnt lgkmcnt(10)
v_dot2_f32_bf16 v184, v110, v209, v184
v_dot2_f32_bf16 v185, v110, v217, v185
v_dot2_f32_bf16 v186, v111, v209, v186
v_dot2_f32_bf16 v187, v111, v217, v187
v_dot2_f32_bf16 v188, v112, v209, v188
v_dot2_f32_bf16 v189, v112, v217, v189
v_dot2_f32_bf16 v190, v113, v209, v190
v_dot2_f32_bf16 v191, v113, v217, v191
v_dot2_f32_bf16 v192, v114, v209, v192
v_dot2_f32_bf16 v193, v114, v217, v193
v_dot2_f32_bf16 v194, v115, v209, v194
v_dot2_f32_bf16 v195, v115, v217, v195
v_dot2_f32_bf16 v196, v116, v209, v196
v_dot2_f32_bf16 v197, v116, v217, v197
v_dot2_f32_bf16 v198, v117, v209, v198
v_dot2_f32_bf16 v199, v117, v217, v199
v_dot2_f32_bf16 v200, v118, v209, v200
v_dot2_f32_bf16 v201, v118, v217, v201
s_waitcnt lgkmcnt(5)
v_dot2_f32_bf16 v184, v120, v210, v184
v_dot2_f32_bf16 v185, v120, v218, v185
v_dot2_f32_bf16 v186, v121, v210, v186
v_dot2_f32_bf16 v187, v121, v218, v187
v_dot2_f32_bf16 v188, v122, v210, v188
v_dot2_f32_bf16 v189, v122, v218, v189
v_dot2_f32_bf16 v190, v123, v210, v190
v_dot2_f32_bf16 v191, v123, v218, v191
v_dot2_f32_bf16 v192, v124, v210, v192
v_dot2_f32_bf16 v193, v124, v218, v193
v_dot2_f32_bf16 v194, v125, v210, v194
v_dot2_f32_bf16 v195, v125, v218, v195
v_dot2_f32_bf16 v196, v126, v210, v196
v_dot2_f32_bf16 v197, v126, v218, v197
v_dot2_f32_bf16 v198, v127, v210, v198
v_dot2_f32_bf16 v199, v127, v218, v199
v_dot2_f32_bf16 v200, v128, v210, v200
v_dot2_f32_bf16 v201, v128, v218, v201
s_waitcnt lgkmcnt(0)
v_dot2_f32_bf16 v184, v130, v211, v184
v_dot2_f32_bf16 v185, v130, v219, v185
v_dot2_f32_bf16 v186, v131, v211, v186
v_dot2_f32_bf16 v187, v131, v219, v187
v_dot2_f32_bf16 v188, v132, v211, v188
v_dot2_f32_bf16 v189, v132, v219, v189
v_dot2_f32_bf16 v190, v133, v211, v190
v_dot2_f32_bf16 v191, v133, v219, v191
v_dot2_f32_bf16 v192, v134, v211, v192
v_dot2_f32_bf16 v193, v134, v219, v193
v_dot2_f32_bf16 v194, v135, v211, v194
v_dot2_f32_bf16 v195, v135, v219, v195
v_dot2_f32_bf16 v196, v136, v211, v196
v_dot2_f32_bf16 v197, v136, v219, v197
v_dot2_f32_bf16 v198, v137, v211, v198
v_dot2_f32_bf16 v199, v137, v219, v199
v_dot2_f32_bf16 v200, v138, v211, v200
v_dot2_f32_bf16 v201, v138, v219, v201
s_or_b32 s37, s32, s34
s_cmp_lg_u32 s37, 0
s_cbranch_scc1 L_la_noomg
v_lshlrev_b32 v15, 2, v2
v_min_u32 v15, 8192, v15
s_mov_b32 s37, 87031808
buffer_store_dword v13, v15, s[4:7], s37 offen sc0 sc1
L_la_noomg:
v_mul_f32 v184, v184, v12
v_mul_f32 v185, v185, v12
v_mul_f32 v186, v186, v12
v_mul_f32 v187, v187, v12
v_mul_f32 v188, v188, v12
v_mul_f32 v189, v189, v12
v_mul_f32 v190, v190, v12
v_mul_f32 v191, v191, v12
v_mul_f32 v192, v192, v12
v_mul_f32 v193, v193, v12
v_mul_f32 v194, v194, v12
v_mul_f32 v195, v195, v12
v_mul_f32 v196, v196, v12
v_mul_f32 v197, v197, v12
v_mul_f32 v198, v198, v12
v_mul_f32 v199, v199, v12
v_mul_f32 v200, v200, v12
v_mul_f32 v201, v201, v12
v_cvt_pk_bf16_f32 v184, v184, v185
v_cvt_pk_bf16_f32 v185, v186, v187
v_cvt_pk_bf16_f32 v186, v188, v189
v_cvt_pk_bf16_f32 v187, v190, v191
v_cvt_pk_bf16_f32 v188, v192, v193
v_cvt_pk_bf16_f32 v189, v194, v195
v_cvt_pk_bf16_f32 v190, v196, v197
v_cvt_pk_bf16_f32 v191, v198, v199
v_cvt_pk_bf16_f32 v192, v200, v201
ds_write2_b32 v14, v184, v185 offset0:0 offset1:1
ds_write2_b32 v14, v186, v187 offset0:2 offset1:3
ds_write2_b32 v14, v188, v189 offset0:4 offset1:5
ds_write2_b32 v14, v190, v191 offset0:6 offset1:7
ds_write_b32 v14, v192 offset:32
s_add_u32 s35, s35, 64
s_cmp_lt_u32 s35, 192
s_cbranch_scc1 L_la_loop
s_waitcnt lgkmcnt(0)
s_barrier
v_mul_u32_u24 v14, 456, v10
v_lshl_add_u32 v14, v11, 4, v14
s_add_u32 s37, s34, 1
s_mul_i32 s37, s37, 7296
s_add_u32 s37, s37, 73728
v_add_u32 v14, s37, v14
s_mul_i32 s40, s33, 11
s_add_u32 s40, s40, s34
s_mov_b32 s35, s34
s_mul_i32 s41, s32, 2304
s_add_u32 s41, s41, 83886080
L_oa_loop:
s_cmp_ge_u32 s40, 128
s_cbranch_scc1 L_oa_done
ds_read2_b64 v[16:19], v14 offset0:0 offset1:1
ds_read2_b64 v[20:23], v14 offset0:8 offset1:9
ds_read2_b64 v[24:27], v14 offset0:16 offset1:17
s_mul_i32 s37, s40, 18432
s_add_u32 s37, s37, s41
s_waitcnt lgkmcnt(2)
buffer_store_dwordx4 v[16:19], v1, s[4:7], s37 offen offset:0 sc0 sc1
s_waitcnt lgkmcnt(1)
buffer_store_dwordx4 v[20:23], v1, s[4:7], s37 offen offset:1024 sc0 sc1
s_waitcnt lgkmcnt(0)
s_mov_b64 exec, 0xffff
buffer_store_dwordx4 v[24:27], v1, s[4:7], s37 offen offset:2048 sc0 sc1
s_mov_b64 exec, -1
v_add_u32 v14, 29184, v14
s_add_u32 s40, s40, 4
s_add_u32 s35, s35, 4
s_cmp_lt_u32 s35, 11
s_cbranch_scc1 L_oa_loop
L_oa_done:
s_waitcnt vmcnt(0)
s_barrier
s_cmp_lg_u32 s34, 0
s_cbranch_scc1 L_a_sig
v_mov_b32 v12, 1
s_mov_b64 exec, 1
buffer_atomic_add v12, v8, s[24:27], 0 offen offset:4 sc1
s_mov_b64 exec, -1
L_a_sig:
s_cmp_ge_u32 s48, 5
s_cbranch_scc1 L_exit_w
v_add_u32 v12, 0, v9
v_mul_u32_u24 v13, 171, v12
v_lshrrev_b32 v13, 10, v13
v_mul_u32_u24 v13, 1056, v13
v_lshl_add_u32 v2, v12, 4, v13
v_add_u32 v12, 64, v9
v_mul_u32_u24 v13, 171, v12
v_lshrrev_b32 v13, 10, v13
v_mul_u32_u24 v13, 1056, v13
v_lshl_add_u32 v3, v12, 4, v13
v_add_u32 v12, 128, v9
v_mul_u32_u24 v13, 171, v12
v_lshrrev_b32 v13, 10, v13
v_mul_u32_u24 v13, 1056, v13
v_lshl_add_u32 v4, v12, 4, v13
v_lshrrev_b32 v12, 2, v10
v_lshl_add_u32 v12, v11, 2, v12
v_mul_u32_u24 v5, 96, v12
v_and_b32 v12, 3, v10
v_lshl_add_u32 v5, v12, 3, v5
v_lshrrev_b32 v12, 2, v10
v_lshl_add_u32 v12, v11, 3, v12
v_mul_u32_u24 v6, 96, v12
v_and_b32 v12, 3, v10
v_lshl_add_u32 v6, v12, 3, v6
s_lshl_b32 s50, s34, 15
v_add_u32 v5, s50, v5
v_add_u32 v6, s50, v6
v_add_u32 v7, s50, v1
s_mul_i32 s37, s49, 96
s_mul_i32 s51, s34, 1179648
s_add_u32 s51, s51, s37
s_mul_i32 s52, s34, 184320
s_add_u32 s52, s52, s37
v_mul_u32_u24 v15, 1152, v10
v_lshl_add_u32 v15, v11, 3, v15
s_lshl_b32 s38, s34, 5
s_add_u32 s37, s37, s38
s_mul_i32 s55, s48, 18432
s_add_u32 s54, s55, 83886080
s_add_u32 s55, s55, s37
s_lshl_b32 s53, s48, 17
s_add_u32 s53, s53, s50
s_add_u32 s53, s53, 67108864
s_lshl_b32 s56, s48, 6
s_add_u32 s56, s56, 87031808
v_lshlrev_b32 v9, 2, v9
v_lshlrev_b32 v10, 2, v10
v_add_u32 v14, 131072, v1
s_add_u32 s37, s52, 0
s_add_u32 m0, s50, 0
s_nop 0
buffer_load_dwordx4 v2, s[16:19], s37 offen lds
s_add_u32 m0, s50, 1024
s_nop 0
buffer_load_dwordx4 v3, s[16:19], s37 offen lds
s_add_u32 m0, s50, 2048
s_nop 0
buffer_load_dwordx4 v4, s[16:19], s37 offen lds
s_add_u32 s37, s52, 36864
s_add_u32 m0, s50, 3072
s_nop 0
buffer_load_dwordx4 v2, s[16:19], s37 offen lds
s_add_u32 m0, s50, 4096
s_nop 0
buffer_load_dwordx4 v3, s[16:19], s37 offen lds
s_add_u32 m0, s50, 5120
s_nop 0
buffer_load_dwordx4 v4, s[16:19], s37 offen lds
s_add_u32 s37, s52, 73728
s_add_u32 m0, s50, 6144
s_nop 0
buffer_load_dwordx4 v2, s[16:19], s37 offen lds
s_add_u32 m0, s50, 7168
s_nop 0
buffer_load_dwordx4 v3, s[16:19], s37 offen lds
s_add_u32 m0, s50, 8192
s_nop 0
buffer_load_dwordx4 v4, s[16:19], s37 offen lds
s_add_u32 s37, s52, 110592
s_add_u32 m0, s50, 9216
s_nop 0
buffer_load_dwordx4 v2, s[16:19], s37 offen lds
s_add_u32 m0, s50, 10240
s_nop 0
buffer_load_dwordx4 v3, s[16:19], s37 offen lds
s_add_u32 m0, s50, 11264
s_nop 0
buffer_load_dwordx4 v4, s[16:19], s37 offen lds
s_add_u32 s37, s52, 147456
s_add_u32 m0, s50, 12288
s_nop 0
buffer_load_dwordx4 v2, s[16:19], s37 offen lds
s_add_u32 m0, s50, 13312
s_nop 0
buffer_load_dwordx4 v3, s[16:19], s37 offen lds
s_add_u32 m0, s50, 14336
s_nop 0
buffer_load_dwordx4 v4, s[16:19], s37 offen lds
s_add_u32 s37, s51, 0
s_add_u32 m0, s50, 15360
s_nop 0
buffer_load_dwordx4 v2, s[20:23], s37 offen lds
s_add_u32 m0, s50, 16384
s_nop 0
buffer_load_dwordx4 v3, s[20:23], s37 offen lds
s_add_u32 m0, s50, 17408
s_nop 0
buffer_load_dwordx4 v4, s[20:23], s37 offen lds
s_add_u32 s37, s51, 36864
s_add_u32 m0, s50, 18432
s_nop 0
buffer_load_dwordx4 v2, s[20:23], s37 offen lds
s_add_u32 m0, s50, 19456
s_nop 0
buffer_load_dwordx4 v3, s[20:23], s37 offen lds
s_add_u32 m0, s50, 20480
s_nop 0
buffer_load_dwordx4 v4, s[20:23], s37 offen lds
s_add_u32 s37, s51, 73728
s_add_u32 m0, s50, 21504
s_nop 0
buffer_load_dwordx4 v2, s[20:23], s37 offen lds
s_add_u32 m0, s50, 22528
s_nop 0
buffer_load_dwordx4 v3, s[20:23], s37 offen lds
s_add_u32 m0, s50, 23552
s_nop 0
buffer_load_dwordx4 v4, s[20:23], s37 offen lds
s_add_u32 s37, s51, 110592
s_add_u32 m0, s50, 24576
s_nop 0
buffer_load_dwordx4 v2, s[20:23], s37 offen lds
s_add_u32 m0, s50, 25600
s_nop 0
buffer_load_dwordx4 v3, s[20:23], s37 offen lds
s_add_u32 m0, s50, 26624
s_nop 0
buffer_load_dwordx4 v4, s[20:23], s37 offen lds
s_waitcnt vmcnt(24)
ds_read_b64_tr_b16 v[68:69], v6 offset:0
ds_read_b64_tr_b16 v[70:71], v6 offset:384
ds_read_b64_tr_b16 v[72:73], v6 offset:32
ds_read_b64_tr_b16 v[74:75], v6 offset:416
ds_read_b64_tr_b16 v[76:77], v6 offset:64
ds_read_b64_tr_b16 v[78:79], v6 offset:448
s_waitcnt lgkmcnt(0)
s_add_u32 s37, s51, 147456
s_add_u32 m0, s50, 27648
s_nop 0
buffer_load_dwordx4 v2, s[20:23], s37 offen lds
s_add_u32 m0, s50, 28672
s_nop 0
buffer_load_dwordx4 v3, s[20:23], s37 offen lds
s_add_u32 m0, s50, 29696
s_nop 0
buffer_load_dwordx4 v4, s[20:23], s37 offen lds
s_waitcnt vmcnt(24)
ds_read_b64_tr_b16 v[80:81], v6 offset:3072
ds_read_b64_tr_b16 v[82:83], v6 offset:3456
ds_read_b64_tr_b16 v[84:85], v6 offset:3104
ds_read_b64_tr_b16 v[86:87], v6 offset:3488
ds_read_b64_tr_b16 v[88:89], v6 offset:3136
ds_read_b64_tr_b16 v[90:91], v6 offset:3520
s_waitcnt lgkmcnt(0)
s_add_u32 s37, s51, 184320
s_add_u32 m0, s50, 0
s_nop 0
buffer_load_dwordx4 v2, s[20:23], s37 offen lds
s_add_u32 m0, s50, 1024
s_nop 0
buffer_load_dwordx4 v3, s[20:23], s37 offen lds
s_add_u32 m0, s50, 2048
s_nop 0
buffer_load_dwordx4 v4, s[20:23], s37 offen lds
s_waitcnt vmcnt(24)
ds_read_b64_tr_b16 v[92:93], v6 offset:6144
ds_read_b64_tr_b16 v[94:95], v6 offset:6528
ds_read_b64_tr_b16 v[96:97], v6 offset:6176
ds_read_b64_tr_b16 v[98:99], v6 offset:6560
ds_read_b64_tr_b16 v[100:101], v6 offset:6208
ds_read_b64_tr_b16 v[102:103], v6 offset:6592
s_waitcnt lgkmcnt(0)
s_add_u32 s37, s51, 221184
s_add_u32 m0, s50, 3072
s_nop 0
buffer_load_dwordx4 v2, s[20:23], s37 offen lds
s_add_u32 m0, s50, 4096
s_nop 0
buffer_load_dwordx4 v3, s[20:23], s37 offen lds
s_add_u32 m0, s50, 5120
s_nop 0
buffer_load_dwordx4 v4, s[20:23], s37 offen lds
s_waitcnt vmcnt(24)
ds_read_b64_tr_b16 v[104:105], v6 offset:9216
ds_read_b64_tr_b16 v[106:107], v6 offset:9600
ds_read_b64_tr_b16 v[108:109], v6 offset:9248
ds_read_b64_tr_b16 v[110:111], v6 offset:9632
ds_read_b64_tr_b16 v[112:113], v6 offset:9280
ds_read_b64_tr_b16 v[114:115], v6 offset:9664
s_waitcnt lgkmcnt(0)
s_add_u32 s37, s51, 258048
s_add_u32 m0, s50, 6144
s_nop 0
buffer_load_dwordx4 v2, s[20:23], s37 offen lds
s_add_u32 m0, s50, 7168
s_nop 0
buffer_load_dwordx4 v3, s[20:23], s37 offen lds
s_add_u32 m0, s50, 8192
s_nop 0
buffer_load_dwordx4 v4, s[20:23], s37 offen lds
s_waitcnt vmcnt(24)
ds_read_b64_tr_b16 v[116:117], v6 offset:12288
ds_read_b64_tr_b16 v[118:119], v6 offset:12672
ds_read_b64_tr_b16 v[120:121], v6 offset:12320
ds_read_b64_tr_b16 v[122:123], v6 offset:12704
ds_read_b64_tr_b16 v[124:125], v6 offset:12352
ds_read_b64_tr_b16 v[126:127], v6 offset:12736
s_waitcnt lgkmcnt(0)
s_add_u32 s37, s51, 294912
s_add_u32 m0, s50, 9216
s_nop 0
buffer_load_dwordx4 v2, s[20:23], s37 offen lds
s_add_u32 m0, s50, 10240
s_nop 0
buffer_load_dwordx4 v3, s[20:23], s37 offen lds
s_add_u32 m0, s50, 11264
s_nop 0
buffer_load_dwordx4 v4, s[20:23], s37 offen lds
s_waitcnt vmcnt(24)
ds_read_b64_tr_b16 v[128:129], v5 offset:15360
ds_read_b64_tr_b16 v[130:131], v5 offset:16896
ds_read_b64_tr_b16 v[132:133], v5 offset:15392
ds_read_b64_tr_b16 v[134:135], v5 offset:16928
ds_read_b64_tr_b16 v[136:137], v5 offset:15424
ds_read_b64_tr_b16 v[138:139], v5 offset:16960
s_waitcnt lgkmcnt(0)
s_add_u32 s37, s51, 331776
s_add_u32 m0, s50, 12288
s_nop 0
buffer_load_dwordx4 v2, s[20:23], s37 offen lds
s_add_u32 m0, s50, 13312
s_nop 0
buffer_load_dwordx4 v3, s[20:23], s37 offen lds
s_add_u32 m0, s50, 14336
s_nop 0
buffer_load_dwordx4 v4, s[20:23], s37 offen lds
s_waitcnt vmcnt(24)
ds_read_b64_tr_b16 v[140:141], v5 offset:18432
ds_read_b64_tr_b16 v[142:143], v5 offset:19968
ds_read_b64_tr_b16 v[144:145], v5 offset:18464
ds_read_b64_tr_b16 v[146:147], v5 offset:20000
ds_read_b64_tr_b16 v[148:149], v5 offset:18496
ds_read_b64_tr_b16 v[150:151], v5 offset:20032
s_waitcnt lgkmcnt(0)
s_add_u32 s37, s51, 368640
s_add_u32 m0, s50, 15360
s_nop 0
buffer_load_dwordx4 v2, s[20:23], s37 offen lds
s_add_u32 m0, s50, 16384
s_nop 0
buffer_load_dwordx4 v3, s[20:23], s37 offen lds
s_add_u32 m0, s50, 17408
s_nop 0
buffer_load_dwordx4 v4, s[20:23], s37 offen lds
s_waitcnt vmcnt(24)
ds_read_b64_tr_b16 v[152:153], v5 offset:21504
ds_read_b64_tr_b16 v[154:155], v5 offset:23040
ds_read_b64_tr_b16 v[156:157], v5 offset:21536
ds_read_b64_tr_b16 v[158:159], v5 offset:23072
ds_read_b64_tr_b16 v[160:161], v5 offset:21568
ds_read_b64_tr_b16 v[162:163], v5 offset:23104
s_waitcnt lgkmcnt(0)
s_add_u32 s37, s51, 405504
s_add_u32 m0, s50, 18432
s_nop 0
buffer_load_dwordx4 v2, s[20:23], s37 offen lds
s_add_u32 m0, s50, 19456
s_nop 0
buffer_load_dwordx4 v3, s[20:23], s37 offen lds
s_add_u32 m0, s50, 20480
s_nop 0
buffer_load_dwordx4 v4, s[20:23], s37 offen lds
s_waitcnt vmcnt(24)
ds_read_b64_tr_b16 v[164:165], v5 offset:24576
ds_read_b64_tr_b16 v[166:167], v5 offset:26112
ds_read_b64_tr_b16 v[168:169], v5 offset:24608
ds_read_b64_tr_b16 v[170:171], v5 offset:26144
ds_read_b64_tr_b16 v[172:173], v5 offset:24640
ds_read_b64_tr_b16 v[174:175], v5 offset:26176
s_waitcnt lgkmcnt(0)
s_add_u32 s37, s51, 442368
s_add_u32 m0, s50, 21504
s_nop 0
buffer_load_dwordx4 v2, s[20:23], s37 offen lds
s_add_u32 m0, s50, 22528
s_nop 0
buffer_load_dwordx4 v3, s[20:23], s37 offen lds
s_add_u32 m0, s50, 23552
s_nop 0
buffer_load_dwordx4 v4, s[20:23], s37 offen lds
s_waitcnt vmcnt(24)
ds_read_b64_tr_b16 v[176:177], v5 offset:27648
ds_read_b64_tr_b16 v[178:179], v5 offset:29184
ds_read_b64_tr_b16 v[180:181], v5 offset:27680
ds_read_b64_tr_b16 v[182:183], v5 offset:29216
ds_read_b64_tr_b16 v[184:185], v5 offset:27712
ds_read_b64_tr_b16 v[186:187], v5 offset:29248
s_waitcnt lgkmcnt(0)
s_add_u32 s37, s51, 479232
s_add_u32 m0, s50, 24576
s_nop 0
buffer_load_dwordx4 v2, s[20:23], s37 offen lds
s_add_u32 m0, s50, 25600
s_nop 0
buffer_load_dwordx4 v3, s[20:23], s37 offen lds
s_add_u32 m0, s50, 26624
s_nop 0
buffer_load_dwordx4 v4, s[20:23], s37 offen lds
s_waitcnt vmcnt(24)
ds_read_b64_tr_b16 v[188:189], v5 offset:0
ds_read_b64_tr_b16 v[190:191], v5 offset:1536
ds_read_b64_tr_b16 v[192:193], v5 offset:32
ds_read_b64_tr_b16 v[194:195], v5 offset:1568
ds_read_b64_tr_b16 v[196:197], v5 offset:64
ds_read_b64_tr_b16 v[198:199], v5 offset:1600
s_waitcnt lgkmcnt(0)
s_add_u32 s37, s51, 516096
s_add_u32 m0, s50, 27648
s_nop 0
buffer_load_dwordx4 v2, s[20:23], s37 offen lds
s_add_u32 m0, s50, 28672
s_nop 0
buffer_load_dwordx4 v3, s[20:23], s37 offen lds
s_add_u32 m0, s50, 29696
s_nop 0
buffer_load_dwordx4 v4, s[20:23], s37 offen lds
s_waitcnt vmcnt(24)
ds_read_b64_tr_b16 v[200:201], v5 offset:3072
ds_read_b64_tr_b16 v[202:203], v5 offset:4608
ds_read_b64_tr_b16 v[204:205], v5 offset:3104
ds_read_b64_tr_b16 v[206:207], v5 offset:4640
ds_read_b64_tr_b16 v[208:209], v5 offset:3136
ds_read_b64_tr_b16 v[210:211], v5 offset:4672
s_waitcnt lgkmcnt(0)
s_add_u32 s37, s51, 552960
s_add_u32 m0, s50, 0
s_nop 0
buffer_load_dwordx4 v2, s[20:23], s37 offen lds
s_add_u32 m0, s50, 1024
s_nop 0
buffer_load_dwordx4 v3, s[20:23], s37 offen lds
s_add_u32 m0, s50, 2048
s_nop 0
buffer_load_dwordx4 v4, s[20:23], s37 offen lds
s_waitcnt vmcnt(24)
ds_read_b64_tr_b16 v[212:213], v5 offset:6144
ds_read_b64_tr_b16 v[214:215], v5 offset:7680
ds_read_b64_tr_b16 v[216:217], v5 offset:6176
ds_read_b64_tr_b16 v[218:219], v5 offset:7712
ds_read_b64_tr_b16 v[220:221], v5 offset:6208
ds_read_b64_tr_b16 v[222:223], v5 offset:7744
s_waitcnt lgkmcnt(0)
s_add_u32 s37, s51, 589824
s_add_u32 m0, s50, 3072
s_nop 0
buffer_load_dwordx4 v2, s[20:23], s37 offen lds
s_add_u32 m0, s50, 4096
s_nop 0
buffer_load_dwordx4 v3, s[20:23], s37 offen lds
s_add_u32 m0, s50, 5120
s_nop 0
buffer_load_dwordx4 v4, s[20:23], s37 offen lds
s_waitcnt vmcnt(24)
ds_read_b64_tr_b16 v[224:225], v5 offset:9216
ds_read_b64_tr_b16 v[226:227], v5 offset:10752
ds_read_b64_tr_b16 v[228:229], v5 offset:9248
ds_read_b64_tr_b16 v[230:231], v5 offset:10784
ds_read_b64_tr_b16 v[232:233], v5 offset:9280
ds_read_b64_tr_b16 v[234:235], v5 offset:10816
s_waitcnt lgkmcnt(0)
s_add_u32 s37, s51, 626688
s_add_u32 m0, s50, 6144
s_nop 0
buffer_load_dwordx4 v2, s[20:23], s37 offen lds
s_add_u32 m0, s50, 7168
s_nop 0
buffer_load_dwordx4 v3, s[20:23], s37 offen lds
s_add_u32 m0, s50, 8192
s_nop 0
buffer_load_dwordx4 v4, s[20:23], s37 offen lds
s_waitcnt vmcnt(24)
ds_read_b64_tr_b16 v[236:237], v5 offset:12288
ds_read_b64_tr_b16 v[238:239], v5 offset:13824
ds_read_b64_tr_b16 v[240:241], v5 offset:12320
ds_read_b64_tr_b16 v[242:243], v5 offset:13856
ds_read_b64_tr_b16 v[244:245], v5 offset:12352
ds_read_b64_tr_b16 v[246:247], v5 offset:13888
s_waitcnt lgkmcnt(0)
s_add_u32 s37, s51, 663552
s_add_u32 m0, s50, 9216
s_nop 0
buffer_load_dwordx4 v2, s[20:23], s37 offen lds
s_add_u32 m0, s50, 10240
s_nop 0
buffer_load_dwordx4 v3, s[20:23], s37 offen lds
s_add_u32 m0, s50, 11264
s_nop 0
buffer_load_dwordx4 v4, s[20:23], s37 offen lds
s_waitcnt vmcnt(24)
ds_read_b64_tr_b16 v[248:249], v5 offset:15360
ds_read_b64_tr_b16 v[250:251], v5 offset:16896
ds_read_b64_tr_b16 v[252:253], v5 offset:15392
ds_read_b64_tr_b16 v[254:255], v5 offset:16928
ds_read_b64_tr_b16 a[0:1], v5 offset:15424
ds_read_b64_tr_b16 a[2:3], v5 offset:16960
s_waitcnt lgkmcnt(0)
s_add_u32 s37, s51, 700416
s_add_u32 m0, s50, 12288
s_nop 0
buffer_load_dwordx4 v2, s[20:23], s37 offen lds
s_add_u32 m0, s50, 13312
s_nop 0
buffer_load_dwordx4 v3, s[20:23], s37 offen lds
s_add_u32 m0, s50, 14336
s_nop 0
buffer_load_dwordx4 v4, s[20:23], s37 offen lds
s_waitcnt vmcnt(24)
ds_read_b64_tr_b16 a[4:5], v5 offset:18432
ds_read_b64_tr_b16 a[6:7], v5 offset:19968
ds_read_b64_tr_b16 a[8:9], v5 offset:18464
ds_read_b64_tr_b16 a[10:11], v5 offset:20000
ds_read_b64_tr_b16 a[12:13], v5 offset:18496
ds_read_b64_tr_b16 a[14:15], v5 offset:20032
s_waitcnt lgkmcnt(0)
s_add_u32 s37, s51, 737280
s_add_u32 m0, s50, 15360
s_nop 0
buffer_load_dwordx4 v2, s[20:23], s37 offen lds
s_add_u32 m0, s50, 16384
s_nop 0
buffer_load_dwordx4 v3, s[20:23], s37 offen lds
s_add_u32 m0, s50, 17408
s_nop 0
buffer_load_dwordx4 v4, s[20:23], s37 offen lds
s_waitcnt vmcnt(24)
ds_read_b64_tr_b16 a[16:17], v5 offset:21504
ds_read_b64_tr_b16 a[18:19], v5 offset:23040
ds_read_b64_tr_b16 a[20:21], v5 offset:21536
ds_read_b64_tr_b16 a[22:23], v5 offset:23072
ds_read_b64_tr_b16 a[24:25], v5 offset:21568
ds_read_b64_tr_b16 a[26:27], v5 offset:23104
s_waitcnt lgkmcnt(0)
s_add_u32 s37, s51, 774144
s_add_u32 m0, s50, 18432
s_nop 0
buffer_load_dwordx4 v2, s[20:23], s37 offen lds
s_add_u32 m0, s50, 19456
s_nop 0
buffer_load_dwordx4 v3, s[20:23], s37 offen lds
s_add_u32 m0, s50, 20480
s_nop 0
buffer_load_dwordx4 v4, s[20:23], s37 offen lds
s_waitcnt vmcnt(24)
ds_read_b64_tr_b16 a[28:29], v5 offset:24576
ds_read_b64_tr_b16 a[30:31], v5 offset:26112
ds_read_b64_tr_b16 a[32:33], v5 offset:24608
ds_read_b64_tr_b16 a[34:35], v5 offset:26144
ds_read_b64_tr_b16 a[36:37], v5 offset:24640
ds_read_b64_tr_b16 a[38:39], v5 offset:26176
s_waitcnt lgkmcnt(0)
s_add_u32 s37, s51, 811008
s_add_u32 m0, s50, 21504
s_nop 0
buffer_load_dwordx4 v2, s[20:23], s37 offen lds
s_add_u32 m0, s50, 22528
s_nop 0
buffer_load_dwordx4 v3, s[20:23], s37 offen lds
s_add_u32 m0, s50, 23552
s_nop 0
buffer_load_dwordx4 v4, s[20:23], s37 offen lds
s_waitcnt vmcnt(24)
ds_read_b64_tr_b16 a[40:41], v5 offset:27648
ds_read_b64_tr_b16 a[42:43], v5 offset:29184
ds_read_b64_tr_b16 a[44:45], v5 offset:27680
ds_read_b64_tr_b16 a[46:47], v5 offset:29216
ds_read_b64_tr_b16 a[48:49], v5 offset:27712
ds_read_b64_tr_b16 a[50:51], v5 offset:29248
s_waitcnt lgkmcnt(0)
s_add_u32 s37, s51, 847872
s_add_u32 m0, s50, 24576
s_nop 0
buffer_load_dwordx4 v2, s[20:23], s37 offen lds
s_add_u32 m0, s50, 25600
s_nop 0
buffer_load_dwordx4 v3, s[20:23], s37 offen lds
s_add_u32 m0, s50, 26624
s_nop 0
buffer_load_dwordx4 v4, s[20:23], s37 offen lds
s_waitcnt vmcnt(24)
ds_read_b64_tr_b16 a[52:53], v5 offset:0
ds_read_b64_tr_b16 a[54:55], v5 offset:1536
ds_read_b64_tr_b16 a[56:57], v5 offset:32
ds_read_b64_tr_b16 a[58:59], v5 offset:1568
ds_read_b64_tr_b16 a[60:61], v5 offset:64
ds_read_b64_tr_b16 a[62:63], v5 offset:1600
s_waitcnt lgkmcnt(0)
s_add_u32 s37, s51, 884736
s_add_u32 m0, s50, 27648
s_nop 0
buffer_load_dwordx4 v2, s[20:23], s37 offen lds
s_add_u32 m0, s50, 28672
s_nop 0
buffer_load_dwordx4 v3, s[20:23], s37 offen lds
s_add_u32 m0, s50, 29696
s_nop 0
buffer_load_dwordx4 v4, s[20:23], s37 offen lds
s_waitcnt vmcnt(24)
ds_read_b64_tr_b16 a[64:65], v5 offset:3072
ds_read_b64_tr_b16 a[66:67], v5 offset:4608
ds_read_b64_tr_b16 a[68:69], v5 offset:3104
ds_read_b64_tr_b16 a[70:71], v5 offset:4640
ds_read_b64_tr_b16 a[72:73], v5 offset:3136
ds_read_b64_tr_b16 a[74:75], v5 offset:4672
s_waitcnt lgkmcnt(0)
s_add_u32 s37, s51, 921600
s_add_u32 m0, s50, 0
s_nop 0
buffer_load_dwordx4 v2, s[20:23], s37 offen lds
s_add_u32 m0, s50, 1024
s_nop 0
buffer_load_dwordx4 v3, s[20:23], s37 offen lds
s_add_u32 m0, s50, 2048
s_nop 0
buffer_load_dwordx4 v4, s[20:23], s37 offen lds
s_waitcnt vmcnt(24)
ds_read_b64_tr_b16 a[76:77], v5 offset:6144
ds_read_b64_tr_b16 a[78:79], v5 offset:7680
ds_read_b64_tr_b16 a[80:81], v5 offset:6176
ds_read_b64_tr_b16 a[82:83], v5 offset:7712
ds_read_b64_tr_b16 a[84:85], v5 offset:6208
ds_read_b64_tr_b16 a[86:87], v5 offset:7744
s_waitcnt lgkmcnt(0)
s_add_u32 s37, s51, 958464
s_add_u32 m0, s50, 3072
s_nop 0
buffer_load_dwordx4 v2, s[20:23], s37 offen lds
s_add_u32 m0, s50, 4096
s_nop 0
buffer_load_dwordx4 v3, s[20:23], s37 offen lds
s_add_u32 m0, s50, 5120
s_nop 0
buffer_load_dwordx4 v4, s[20:23], s37 offen lds
s_waitcnt vmcnt(24)
ds_read_b64_tr_b16 a[88:89], v5 offset:9216
ds_read_b64_tr_b16 a[90:91], v5 offset:10752
ds_read_b64_tr_b16 a[92:93], v5 offset:9248
ds_read_b64_tr_b16 a[94:95], v5 offset:10784
ds_read_b64_tr_b16 a[96:97], v5 offset:9280
ds_read_b64_tr_b16 a[98:99], v5 offset:10816
s_waitcnt lgkmcnt(0)
s_add_u32 s37, s51, 995328
s_add_u32 m0, s50, 6144
s_nop 0
buffer_load_dwordx4 v2, s[20:23], s37 offen lds
s_add_u32 m0, s50, 7168
s_nop 0
buffer_load_dwordx4 v3, s[20:23], s37 offen lds
s_add_u32 m0, s50, 8192
s_nop 0
buffer_load_dwordx4 v4, s[20:23], s37 offen lds
s_waitcnt vmcnt(24)
ds_read_b64_tr_b16 a[100:101], v5 offset:12288
ds_read_b64_tr_b16 a[102:103], v5 offset:13824
ds_read_b64_tr_b16 a[104:105], v5 offset:12320
ds_read_b64_tr_b16 a[106:107], v5 offset:13856
ds_read_b64_tr_b16 a[108:109], v5 offset:12352
ds_read_b64_tr_b16 a[110:111], v5 offset:13888
s_waitcnt lgkmcnt(0)
s_add_u32 s37, s51, 1032192
s_add_u32 m0, s50, 9216
s_nop 0
buffer_load_dwordx4 v2, s[20:23], s37 offen lds
s_add_u32 m0, s50, 10240
s_nop 0
buffer_load_dwordx4 v3, s[20:23], s37 offen lds
s_add_u32 m0, s50, 11264
s_nop 0
buffer_load_dwordx4 v4, s[20:23], s37 offen lds
s_waitcnt vmcnt(24)
ds_read_b64_tr_b16 a[112:113], v5 offset:15360
ds_read_b64_tr_b16 a[114:115], v5 offset:16896
ds_read_b64_tr_b16 a[116:117], v5 offset:15392
ds_read_b64_tr_b16 a[118:119], v5 offset:16928
ds_read_b64_tr_b16 a[120:121], v5 offset:15424
ds_read_b64_tr_b16 a[122:123], v5 offset:16960
s_waitcnt lgkmcnt(0)
s_add_u32 s37, s51, 1069056
s_add_u32 m0, s50, 12288
s_nop 0
buffer_load_dwordx4 v2, s[20:23], s37 offen lds
s_add_u32 m0, s50, 13312
s_nop 0
buffer_load_dwordx4 v3, s[20:23], s37 offen lds
s_add_u32 m0, s50, 14336
s_nop 0
buffer_load_dwordx4 v4, s[20:23], s37 offen lds
s_waitcnt vmcnt(24)
ds_read_b64_tr_b16 a[124:125], v5 offset:18432
ds_read_b64_tr_b16 a[126:127], v5 offset:19968
ds_read_b64_tr_b16 a[128:129], v5 offset:18464
ds_read_b64_tr_b16 a[130:131], v5 offset:20000
ds_read_b64_tr_b16 a[132:133], v5 offset:18496
ds_read_b64_tr_b16 a[134:135], v5 offset:20032
s_waitcnt lgkmcnt(0)
s_add_u32 s37, s51, 1105920
s_add_u32 m0, s50, 15360
s_nop 0
buffer_load_dwordx4 v2, s[20:23], s37 offen lds
s_add_u32 m0, s50, 16384
s_nop 0
buffer_load_dwordx4 v3, s[20:23], s37 offen lds
s_add_u32 m0, s50, 17408
s_nop 0
buffer_load_dwordx4 v4, s[20:23], s37 offen lds
s_waitcnt vmcnt(24)
ds_read_b64_tr_b16 a[136:137], v5 offset:21504
ds_read_b64_tr_b16 a[138:139], v5 offset:23040
ds_read_b64_tr_b16 a[140:141], v5 offset:21536
ds_read_b64_tr_b16 a[142:143], v5 offset:23072
ds_read_b64_tr_b16 a[144:145], v5 offset:21568
ds_read_b64_tr_b16 a[146:147], v5 offset:23104
s_waitcnt lgkmcnt(0)
s_add_u32 s37, s51, 1142784
s_add_u32 m0, s50, 18432
s_nop 0
buffer_load_dwordx4 v2, s[20:23], s37 offen lds
s_add_u32 m0, s50, 19456
s_nop 0
buffer_load_dwordx4 v3, s[20:23], s37 offen lds
s_add_u32 m0, s50, 20480
s_nop 0
buffer_load_dwordx4 v4, s[20:23], s37 offen lds
s_waitcnt vmcnt(24)
ds_read_b64_tr_b16 a[148:149], v5 offset:24576
ds_read_b64_tr_b16 a[150:151], v5 offset:26112
ds_read_b64_tr_b16 a[152:153], v5 offset:24608
ds_read_b64_tr_b16 a[154:155], v5 offset:26144
ds_read_b64_tr_b16 a[156:157], v5 offset:24640
ds_read_b64_tr_b16 a[158:159], v5 offset:26176
s_waitcnt lgkmcnt(0)
s_waitcnt vmcnt(21)
ds_read_b64_tr_b16 a[160:161], v5 offset:27648
ds_read_b64_tr_b16 a[162:163], v5 offset:29184
ds_read_b64_tr_b16 a[164:165], v5 offset:27680
ds_read_b64_tr_b16 a[166:167], v5 offset:29216
ds_read_b64_tr_b16 a[168:169], v5 offset:27712
ds_read_b64_tr_b16 a[170:171], v5 offset:29248
s_waitcnt lgkmcnt(0)
s_waitcnt vmcnt(18)
ds_read_b64_tr_b16 a[172:173], v5 offset:0
ds_read_b64_tr_b16 a[174:175], v5 offset:1536
ds_read_b64_tr_b16 a[176:177], v5 offset:32
ds_read_b64_tr_b16 a[178:179], v5 offset:1568
ds_read_b64_tr_b16 a[180:181], v5 offset:64
ds_read_b64_tr_b16 a[182:183], v5 offset:1600
s_waitcnt lgkmcnt(0)
s_waitcnt vmcnt(15)
ds_read_b64_tr_b16 a[184:185], v5 offset:3072
ds_read_b64_tr_b16 a[186:187], v5 offset:4608
ds_read_b64_tr_b16 a[188:189], v5 offset:3104
ds_read_b64_tr_b16 a[190:191], v5 offset:4640
ds_read_b64_tr_b16 a[192:193], v5 offset:3136
ds_read_b64_tr_b16 a[194:195], v5 offset:4672
s_waitcnt lgkmcnt(0)
s_waitcnt vmcnt(12)
ds_read_b64_tr_b16 a[196:197], v5 offset:6144
ds_read_b64_tr_b16 a[198:199], v5 offset:7680
ds_read_b64_tr_b16 a[200:201], v5 offset:6176
ds_read_b64_tr_b16 a[202:203], v5 offset:7712
ds_read_b64_tr_b16 a[204:205], v5 offset:6208
ds_read_b64_tr_b16 a[206:207], v5 offset:7744
s_waitcnt lgkmcnt(0)
s_waitcnt vmcnt(9)
ds_read_b64_tr_b16 a[208:209], v5 offset:9216
ds_read_b64_tr_b16 a[210:211], v5 offset:10752
ds_read_b64_tr_b16 a[212:213], v5 offset:9248
ds_read_b64_tr_b16 a[214:215], v5 offset:10784
ds_read_b64_tr_b16 a[216:217], v5 offset:9280
ds_read_b64_tr_b16 a[218:219], v5 offset:10816
s_waitcnt lgkmcnt(0)
s_waitcnt vmcnt(6)
ds_read_b64_tr_b16 a[220:221], v5 offset:12288
ds_read_b64_tr_b16 a[222:223], v5 offset:13824
ds_read_b64_tr_b16 a[224:225], v5 offset:12320
ds_read_b64_tr_b16 a[226:227], v5 offset:13856
ds_read_b64_tr_b16 a[228:229], v5 offset:12352
ds_read_b64_tr_b16 a[230:231], v5 offset:13888
s_waitcnt lgkmcnt(0)
s_waitcnt vmcnt(3)
ds_read_b64_tr_b16 a[232:233], v5 offset:15360
ds_read_b64_tr_b16 a[234:235], v5 offset:16896
ds_read_b64_tr_b16 a[236:237], v5 offset:15392
ds_read_b64_tr_b16 a[238:239], v5 offset:16928
ds_read_b64_tr_b16 a[240:241], v5 offset:15424
ds_read_b64_tr_b16 a[242:243], v5 offset:16960
s_waitcnt lgkmcnt(0)
s_waitcnt vmcnt(0)
ds_read_b64_tr_b16 a[244:245], v5 offset:18432
ds_read_b64_tr_b16 a[246:247], v5 offset:19968
ds_read_b64_tr_b16 a[248:249], v5 offset:18464
ds_read_b64_tr_b16 a[250:251], v5 offset:20000
ds_read_b64_tr_b16 a[252:253], v5 offset:18496
ds_read_b64_tr_b16 a[254:255], v5 offset:20032
s_waitcnt lgkmcnt(0)
s_branch L_w_init_in
L_w_init:
s_sleep 4
L_w_init_in:
buffer_load_dword v12, v8, s[24:27], 0 offen offset:0 sc0 sc1
s_sub_u32 s36, s36, 1
s_cbranch_scc1 L_exit_w
s_waitcnt vmcnt(0)
v_readfirstlane_b32 s37, v12
s_nop 0
s_and_b32 s37, s37, 0xff
s_cmp_eq_u32 s37, 32
s_cbranch_scc0 L_w_init
s_branch L_w_adone_in
L_w_adone:
s_sleep 4
L_w_adone_in:
buffer_load_dword v12, v8, s[24:27], 0 offen offset:4 sc0 sc1
s_sub_u32 s36, s36, 1
s_cbranch_scc1 L_exit_w
s_waitcnt vmcnt(0)
v_readfirstlane_b32 s37, v12
s_nop 0
s_cmp_eq_u32 s37, 96
s_cbranch_scc0 L_w_adone
s_mov_b32 s35, 0
s_mul_i32 s52, s34, 5
s_mul_i32 s58, s34, 3072
v_add_u32 v2, s58, v14
s_lshl_b32 s37, s34, 10
v_add_u32 v14, s37, v14
s_cmp_eq_u32 s34, 3
s_cselect_b32 s37, 0x400000, 0
v_add_u32 v15, s37, v15
L_w_wait:
s_and_b32 s57, s48, 7
s_lshl_b32 s57, s57, 8
s_add_u32 s57, s57, 331776
s_lshr_b32 s35, s48, 3
s_add_u32 s37, s52, 0
s_min_u32 s37, s37, 17
s_lshl_b32 s37, s37, 10
s_add_u32 s37, s37, s54
buffer_load_dwordx4 v[40:43], v1, s[4:7], s37 offen sc1
s_add_u32 s37, s52, 1
s_min_u32 s37, s37, 17
s_lshl_b32 s37, s37, 10
s_add_u32 s37, s37, s54
buffer_load_dwordx4 v[44:47], v1, s[4:7], s37 offen sc1
s_add_u32 s37, s52, 2
s_min_u32 s37, s37, 17
s_lshl_b32 s37, s37, 10
s_add_u32 s37, s37, s54
buffer_load_dwordx4 v[48:51], v1, s[4:7], s37 offen sc1
s_add_u32 s37, s52, 3
s_min_u32 s37, s37, 17
s_lshl_b32 s37, s37, 10
s_add_u32 s37, s37, s54
buffer_load_dwordx4 v[52:55], v1, s[4:7], s37 offen sc1
s_add_u32 s37, s52, 4
s_min_u32 s37, s37, 17
s_lshl_b32 s37, s37, 10
s_add_u32 s37, s37, s54
buffer_load_dwordx4 v[56:59], v1, s[4:7], s37 offen sc1
buffer_load_dword v4, v10, s[4:7], s56 offen sc1
s_waitcnt vmcnt(5)
v_mfma_f32_16x16x32_bf16 v[28:31], v[68:71], v[40:43], 0
v_mfma_f32_16x16x32_bf16 v[32:35], v[72:75], v[40:43], 0
v_mfma_f32_16x16x32_bf16 v[36:39], v[76:79], v[40:43], 0
s_waitcnt vmcnt(4)
v_mfma_f32_16x16x32_bf16 v[28:31], v[80:83], v[44:47], v[28:31]
v_mfma_f32_16x16x32_bf16 v[32:35], v[84:87], v[44:47], v[32:35]
v_mfma_f32_16x16x32_bf16 v[36:39], v[88:91], v[44:47], v[36:39]
s_waitcnt vmcnt(3)
v_mfma_f32_16x16x32_bf16 v[28:31], v[92:95], v[48:51], v[28:31]
v_mfma_f32_16x16x32_bf16 v[32:35], v[96:99], v[48:51], v[32:35]
v_mfma_f32_16x16x32_bf16 v[36:39], v[100:103], v[48:51], v[36:39]
s_waitcnt vmcnt(2)
v_mfma_f32_16x16x32_bf16 v[28:31], v[104:107], v[52:55], v[28:31]
v_mfma_f32_16x16x32_bf16 v[32:35], v[108:111], v[52:55], v[32:35]
v_mfma_f32_16x16x32_bf16 v[36:39], v[112:115], v[52:55], v[36:39]
s_waitcnt vmcnt(1)
v_mfma_f32_16x16x32_bf16 v[28:31], v[116:119], v[56:59], v[28:31]
v_mfma_f32_16x16x32_bf16 v[32:35], v[120:123], v[56:59], v[32:35]
v_mfma_f32_16x16x32_bf16 v[36:39], v[124:127], v[56:59], v[36:39]
s_branch L_w_poll_in
L_w_poll:
s_sleep 2
L_w_poll_in:
buffer_load_dword v12, v9, s[4:7], s57 offen offset:0 sc0 sc1
s_sub_u32 s36, s36, 1
s_cbranch_scc1 L_exit_w
s_waitcnt vmcnt(0)
v_cmp_ge_u32 vcc, s35, v12
s_nop 1
s_cmp_eq_u64 vcc, 0
s_cbranch_scc0 L_w_poll
s_add_u32 s37, s53, 0
s_add_u32 m0, s50, 0
s_nop 0
buffer_load_dwordx4 v1, s[4:7], s37 offen offset:0 sc1 lds
buffer_load_dwordx4 v1, s[4:7], s37 offen offset:1024 sc1 lds
buffer_load_dwordx4 v1, s[4:7], s37 offen offset:2048 sc1 lds
buffer_load_dwordx4 v1, s[4:7], s37 offen offset:3072 sc1 lds
s_add_u32 s37, s53, 4096
s_add_u32 m0, s50, 4096
s_nop 0
buffer_load_dwordx4 v1, s[4:7], s37 offen offset:0 sc1 lds
buffer_load_dwordx4 v1, s[4:7], s37 offen offset:1024 sc1 lds
buffer_load_dwordx4 v1, s[4:7], s37 offen offset:2048 sc1 lds
buffer_load_dwordx4 v1, s[4:7], s37 offen offset:3072 sc1 lds
s_add_u32 s37, s53, 8192
s_add_u32 m0, s50, 8192
s_nop 0
buffer_load_dwordx4 v1, s[4:7], s37 offen offset:0 sc1 lds
buffer_load_dwordx4 v1, s[4:7], s37 offen offset:1024 sc1 lds
buffer_load_dwordx4 v1, s[4:7], s37 offen offset:2048 sc1 lds
buffer_load_dwordx4 v1, s[4:7], s37 offen offset:3072 sc1 lds
s_add_u32 s37, s53, 12288
s_add_u32 m0, s50, 12288
s_nop 0
buffer_load_dwordx4 v1, s[4:7], s37 offen offset:0 sc1 lds
buffer_load_dwordx4 v1, s[4:7], s37 offen offset:1024 sc1 lds
buffer_load_dwordx4 v1, s[4:7], s37 offen offset:2048 sc1 lds
buffer_load_dwordx4 v1, s[4:7], s37 offen offset:3072 sc1 lds
s_branch L_w_b
L_w_ready:
s_add_u32 s37, s52, 0
s_min_u32 s37, s37, 17
s_lshl_b32 s37, s37, 10
s_add_u32 s37, s37, s54
buffer_load_dwordx4 v[40:43], v1, s[4:7], s37 offen sc1
s_add_u32 s37, s52, 1
s_min_u32 s37, s37, 17
s_lshl_b32 s37, s37, 10
s_add_u32 s37, s37, s54
buffer_load_dwordx4 v[44:47], v1, s[4:7], s37 offen sc1
s_add_u32 s37, s52, 2
s_min_u32 s37, s37, 17
s_lshl_b32 s37, s37, 10
s_add_u32 s37, s37, s54
buffer_load_dwordx4 v[48:51], v1, s[4:7], s37 offen sc1
s_add_u32 s37, s52, 3
s_min_u32 s37, s37, 17
s_lshl_b32 s37, s37, 10
s_add_u32 s37, s37, s54
buffer_load_dwordx4 v[52:55], v1, s[4:7], s37 offen sc1
s_add_u32 s37, s52, 4
s_min_u32 s37, s37, 17
s_lshl_b32 s37, s37, 10
s_add_u32 s37, s37, s54
buffer_load_dwordx4 v[56:59], v1, s[4:7], s37 offen sc1
buffer_load_dword v4, v10, s[4:7], s56 offen sc1
s_add_u32 s37, s53, 0
s_add_u32 m0, s50, 0
s_nop 0
buffer_load_dwordx4 v1, s[4:7], s37 offen offset:0 sc1 lds
buffer_load_dwordx4 v1, s[4:7], s37 offen offset:1024 sc1 lds
buffer_load_dwordx4 v1, s[4:7], s37 offen offset:2048 sc1 lds
buffer_load_dwordx4 v1, s[4:7], s37 offen offset:3072 sc1 lds
s_add_u32 s37, s53, 4096
s_add_u32 m0, s50, 4096
s_nop 0
buffer_load_dwordx4 v1, s[4:7], s37 offen offset:0 sc1 lds
buffer_load_dwordx4 v1, s[4:7], s37 offen offset:1024 sc1 lds
buffer_load_dwordx4 v1, s[4:7], s37 offen offset:2048 sc1 lds
buffer_load_dwordx4 v1, s[4:7], s37 offen offset:3072 sc1 lds
s_add_u32 s37, s53, 8192
s_add_u32 m0, s50, 8192
s_nop 0
buffer_load_dwordx4 v1, s[4:7], s37 offen offset:0 sc1 lds
buffer_load_dwordx4 v1, s[4:7], s37 offen offset:1024 sc1 lds
buffer_load_dwordx4 v1, s[4:7], s37 offen offset:2048 sc1 lds
buffer_load_dwordx4 v1, s[4:7], s37 offen offset:3072 sc1 lds
s_add_u32 s37, s53, 12288
s_add_u32 m0, s50, 12288
s_nop 0
buffer_load_dwordx4 v1, s[4:7], s37 offen offset:0 sc1 lds
buffer_load_dwordx4 v1, s[4:7], s37 offen offset:1024 sc1 lds
buffer_load_dwordx4 v1, s[4:7], s37 offen offset:2048 sc1 lds
buffer_load_dwordx4 v1, s[4:7], s37 offen offset:3072 sc1 lds
s_waitcnt lgkmcnt(0)
s_barrier
ds_read_b128 v[16:19], v14 offset:0
ds_read_b128 v[20:23], v14 offset:3072
ds_read_b128 v[24:27], v14 offset:6144
ds_read_b128 v[28:31], v14 offset:9216
s_waitcnt lgkmcnt(0)
v_pk_add_f32 v[16:17], v[16:17], v[20:21]
v_pk_add_f32 v[18:19], v[18:19], v[22:23]
v_pk_add_f32 v[24:25], v[24:25], v[28:29]
v_pk_add_f32 v[26:27], v[26:27], v[30:31]
v_pk_add_f32 v[16:17], v[16:17], v[24:25]
v_pk_add_f32 v[18:19], v[18:19], v[26:27]
v_cvt_pk_bf16_f32 v60, v16, v17
v_cvt_pk_bf16_f32 v61, v18, v19
v_xor_b32 v14, 16384, v14
buffer_store_dwordx2 v[60:61], v15, s[28:31], s59 offen
s_waitcnt vmcnt(22)
v_mfma_f32_16x16x32_bf16 v[28:31], v[68:71], v[40:43], 0
v_mfma_f32_16x16x32_bf16 v[32:35], v[72:75], v[40:43], 0
v_mfma_f32_16x16x32_bf16 v[36:39], v[76:79], v[40:43], 0
s_waitcnt vmcnt(21)
v_mfma_f32_16x16x32_bf16 v[28:31], v[80:83], v[44:47], v[28:31]
v_mfma_f32_16x16x32_bf16 v[32:35], v[84:87], v[44:47], v[32:35]
v_mfma_f32_16x16x32_bf16 v[36:39], v[88:91], v[44:47], v[36:39]
s_waitcnt vmcnt(20)
v_mfma_f32_16x16x32_bf16 v[28:31], v[92:95], v[48:51], v[28:31]
v_mfma_f32_16x16x32_bf16 v[32:35], v[96:99], v[48:51], v[32:35]
v_mfma_f32_16x16x32_bf16 v[36:39], v[100:103], v[48:51], v[36:39]
s_waitcnt vmcnt(19)
v_mfma_f32_16x16x32_bf16 v[28:31], v[104:107], v[52:55], v[28:31]
v_mfma_f32_16x16x32_bf16 v[32:35], v[108:111], v[52:55], v[32:35]
v_mfma_f32_16x16x32_bf16 v[36:39], v[112:115], v[52:55], v[36:39]
s_waitcnt vmcnt(18)
v_mfma_f32_16x16x32_bf16 v[28:31], v[116:119], v[56:59], v[28:31]
v_mfma_f32_16x16x32_bf16 v[32:35], v[120:123], v[56:59], v[32:35]
v_mfma_f32_16x16x32_bf16 v[36:39], v[124:127], v[56:59], v[36:39]
L_w_b:
s_waitcnt vmcnt(15)
ds_read_b128 v[40:43], v7 offset:0
s_waitcnt vmcnt(14)
ds_read_b128 v[44:47], v7 offset:1024
s_add_u32 s37, s53, 16384
s_add_u32 m0, s50, 16384
s_nop 0
buffer_load_dwordx4 v1, s[4:7], s37 offen offset:0 sc1 lds
s_waitcnt vmcnt(14)
ds_read_b128 v[48:51], v7 offset:2048
s_waitcnt lgkmcnt(2)
v_mfma_f32_16x16x32_bf16 v[16:19], v[128:131], v[40:43], 0
v_mfma_f32_16x16x32_bf16 v[20:23], v[132:135], v[40:43], 0
v_mfma_f32_16x16x32_bf16 v[24:27], v[136:139], v[40:43], 0
buffer_load_dwordx4 v1, s[4:7], s37 offen offset:1024 sc1 lds
s_waitcnt vmcnt(14)
ds_read_b128 v[52:55], v7 offset:3072
s_waitcnt lgkmcnt(2)
v_mfma_f32_16x16x32_bf16 v[16:19], v[140:143], v[44:47], v[16:19]
v_mfma_f32_16x16x32_bf16 v[20:23], v[144:147], v[44:47], v[20:23]
v_mfma_f32_16x16x32_bf16 v[24:27], v[148:151], v[44:47], v[24:27]
buffer_load_dwordx4 v1, s[4:7], s37 offen offset:2048 sc1 lds
s_waitcnt vmcnt(14)
ds_read_b128 v[40:43], v7 offset:4096
s_waitcnt lgkmcnt(2)
v_mfma_f32_16x16x32_bf16 v[16:19], v[152:155], v[48:51], v[16:19]
v_mfma_f32_16x16x32_bf16 v[20:23], v[156:159], v[48:51], v[20:23]
v_mfma_f32_16x16x32_bf16 v[24:27], v[160:163], v[48:51], v[24:27]
buffer_load_dwordx4 v1, s[4:7], s37 offen offset:3072 sc1 lds
s_waitcnt vmcnt(14)
ds_read_b128 v[44:47], v7 offset:5120
s_waitcnt lgkmcnt(2)
v_mfma_f32_16x16x32_bf16 v[16:19], v[164:167], v[52:55], v[16:19]
v_mfma_f32_16x16x32_bf16 v[20:23], v[168:171], v[52:55], v[20:23]
v_mfma_f32_16x16x32_bf16 v[24:27], v[172:175], v[52:55], v[24:27]
s_add_u32 s37, s53, 20480
s_add_u32 m0, s50, 20480
s_nop 0
buffer_load_dwordx4 v1, s[4:7], s37 offen offset:0 sc1 lds
s_waitcnt vmcnt(14)
ds_read_b128 v[48:51], v7 offset:6144
s_waitcnt lgkmcnt(2)
v_mfma_f32_16x16x32_bf16 v[16:19], v[176:179], v[40:43], v[16:19]
v_mfma_f32_16x16x32_bf16 v[20:23], v[180:183], v[40:43], v[20:23]
v_mfma_f32_16x16x32_bf16 v[24:27], v[184:187], v[40:43], v[24:27]
buffer_load_dwordx4 v1, s[4:7], s37 offen offset:1024 sc1 lds
s_waitcnt vmcnt(14)
ds_read_b128 v[52:55], v7 offset:7168
s_waitcnt lgkmcnt(2)
v_mfma_f32_16x16x32_bf16 v[16:19], v[188:191], v[44:47], v[16:19]
v_mfma_f32_16x16x32_bf16 v[20:23], v[192:195], v[44:47], v[20:23]
v_mfma_f32_16x16x32_bf16 v[24:27], v[196:199], v[44:47], v[24:27]
buffer_load_dwordx4 v1, s[4:7], s37 offen offset:2048 sc1 lds
s_waitcnt vmcnt(14)
ds_read_b128 v[40:43], v7 offset:8192
s_waitcnt lgkmcnt(2)
v_mfma_f32_16x16x32_bf16 v[16:19], v[200:203], v[48:51], v[16:19]
v_mfma_f32_16x16x32_bf16 v[20:23], v[204:207], v[48:51], v[20:23]
v_mfma_f32_16x16x32_bf16 v[24:27], v[208:211], v[48:51], v[24:27]
buffer_load_dwordx4 v1, s[4:7], s37 offen offset:3072 sc1 lds
s_waitcnt vmcnt(14)
ds_read_b128 v[44:47], v7 offset:9216
s_waitcnt lgkmcnt(2)
v_mfma_f32_16x16x32_bf16 v[16:19], v[212:215], v[52:55], v[16:19]
v_mfma_f32_16x16x32_bf16 v[20:23], v[216:219], v[52:55], v[20:23]
v_mfma_f32_16x16x32_bf16 v[24:27], v[220:223], v[52:55], v[24:27]
s_add_u32 s37, s53, 24576
s_add_u32 m0, s50, 24576
s_nop 0
buffer_load_dwordx4 v1, s[4:7], s37 offen offset:0 sc1 lds
s_waitcnt vmcnt(14)
ds_read_b128 v[48:51], v7 offset:10240
s_waitcnt lgkmcnt(2)
v_mfma_f32_16x16x32_bf16 v[16:19], v[224:227], v[40:43], v[16:19]
v_mfma_f32_16x16x32_bf16 v[20:23], v[228:231], v[40:43], v[20:23]
v_mfma_f32_16x16x32_bf16 v[24:27], v[232:235], v[40:43], v[24:27]
buffer_load_dwordx4 v1, s[4:7], s37 offen offset:1024 sc1 lds
s_waitcnt vmcnt(14)
ds_read_b128 v[52:55], v7 offset:11264
s_waitcnt lgkmcnt(2)
v_mfma_f32_16x16x32_bf16 v[16:19], v[236:239], v[44:47], v[16:19]
v_mfma_f32_16x16x32_bf16 v[20:23], v[240:243], v[44:47], v[20:23]
v_mfma_f32_16x16x32_bf16 v[24:27], v[244:247], v[44:47], v[24:27]
buffer_load_dwordx4 v1, s[4:7], s37 offen offset:2048 sc1 lds
s_waitcnt vmcnt(14)
ds_read_b128 v[40:43], v7 offset:12288
s_waitcnt lgkmcnt(2)
v_mfma_f32_16x16x32_bf16 v[16:19], v[248:251], v[48:51], v[16:19]
v_mfma_f32_16x16x32_bf16 v[20:23], v[252:255], v[48:51], v[20:23]
v_mfma_f32_16x16x32_bf16 v[24:27], a[0:3], v[48:51], v[24:27]
buffer_load_dwordx4 v1, s[4:7], s37 offen offset:3072 sc1 lds
s_waitcnt vmcnt(14)
ds_read_b128 v[44:47], v7 offset:13312
s_waitcnt lgkmcnt(2)
v_mfma_f32_16x16x32_bf16 v[16:19], a[4:7], v[52:55], v[16:19]
v_mfma_f32_16x16x32_bf16 v[20:23], a[8:11], v[52:55], v[20:23]
v_mfma_f32_16x16x32_bf16 v[24:27], a[12:15], v[52:55], v[24:27]
s_add_u32 s37, s53, 28672
s_add_u32 m0, s50, 28672
s_nop 0
buffer_load_dwordx4 v1, s[4:7], s37 offen offset:0 sc1 lds
s_waitcnt vmcnt(14)
ds_read_b128 v[48:51], v7 offset:14336
s_waitcnt lgkmcnt(2)
v_mfma_f32_16x16x32_bf16 v[16:19], a[16:19], v[40:43], v[16:19]
v_mfma_f32_16x16x32_bf16 v[20:23], a[20:23], v[40:43], v[20:23]
v_mfma_f32_16x16x32_bf16 v[24:27], a[24:27], v[40:43], v[24:27]
buffer_load_dwordx4 v1, s[4:7], s37 offen offset:1024 sc1 lds
s_waitcnt vmcnt(14)
ds_read_b128 v[52:55], v7 offset:15360
s_waitcnt lgkmcnt(2)
v_mfma_f32_16x16x32_bf16 v[16:19], a[28:31], v[44:47], v[16:19]
v_mfma_f32_16x16x32_bf16 v[20:23], a[32:35], v[44:47], v[20:23]
v_mfma_f32_16x16x32_bf16 v[24:27], a[36:39], v[44:47], v[24:27]
buffer_load_dwordx4 v1, s[4:7], s37 offen offset:2048 sc1 lds
s_waitcnt vmcnt(14)
ds_read_b128 v[40:43], v7 offset:16384
s_waitcnt lgkmcnt(2)
v_mfma_f32_16x16x32_bf16 v[16:19], a[40:43], v[48:51], v[16:19]
v_mfma_f32_16x16x32_bf16 v[20:23], a[44:47], v[48:51], v[20:23]
v_mfma_f32_16x16x32_bf16 v[24:27], a[48:51], v[48:51], v[24:27]
buffer_load_dwordx4 v1, s[4:7], s37 offen offset:3072 sc1 lds
s_add_u32 s38, s48, 5
s_and_b32 s57, s38, 7
s_lshl_b32 s57, s57, 8
s_add_u32 s57, s57, 331776
s_lshr_b32 s35, s38, 3
buffer_load_dword v3, v9, s[4:7], s57 offen sc0 sc1
s_waitcnt vmcnt(15)
ds_read_b128 v[44:47], v7 offset:17408
s_waitcnt lgkmcnt(2)
v_mfma_f32_16x16x32_bf16 v[16:19], a[52:55], v[52:55], v[16:19]
v_mfma_f32_16x16x32_bf16 v[20:23], a[56:59], v[52:55], v[20:23]
v_mfma_f32_16x16x32_bf16 v[24:27], a[60:63], v[52:55], v[24:27]
s_waitcnt vmcnt(14)
ds_read_b128 v[48:51], v7 offset:18432
s_waitcnt lgkmcnt(2)
v_mfma_f32_16x16x32_bf16 v[16:19], a[64:67], v[40:43], v[16:19]
v_mfma_f32_16x16x32_bf16 v[20:23], a[68:71], v[40:43], v[20:23]
v_mfma_f32_16x16x32_bf16 v[24:27], a[72:75], v[40:43], v[24:27]
s_waitcnt vmcnt(13)
ds_read_b128 v[52:55], v7 offset:19456
s_waitcnt lgkmcnt(2)
v_mfma_f32_16x16x32_bf16 v[16:19], a[76:79], v[44:47], v[16:19]
v_mfma_f32_16x16x32_bf16 v[20:23], a[80:83], v[44:47], v[20:23]
v_mfma_f32_16x16x32_bf16 v[24:27], a[84:87], v[44:47], v[24:27]
s_waitcnt vmcnt(12)
ds_read_b128 v[40:43], v7 offset:20480
s_waitcnt lgkmcnt(2)
v_mfma_f32_16x16x32_bf16 v[16:19], a[88:91], v[48:51], v[16:19]
v_mfma_f32_16x16x32_bf16 v[20:23], a[92:95], v[48:51], v[20:23]
v_mfma_f32_16x16x32_bf16 v[24:27], a[96:99], v[48:51], v[24:27]
s_waitcnt vmcnt(11)
ds_read_b128 v[44:47], v7 offset:21504
s_waitcnt lgkmcnt(2)
v_mfma_f32_16x16x32_bf16 v[16:19], a[100:103], v[52:55], v[16:19]
v_mfma_f32_16x16x32_bf16 v[20:23], a[104:107], v[52:55], v[20:23]
v_mfma_f32_16x16x32_bf16 v[24:27], a[108:111], v[52:55], v[24:27]
s_waitcnt vmcnt(10)
ds_read_b128 v[48:51], v7 offset:22528
s_waitcnt lgkmcnt(2)
v_mfma_f32_16x16x32_bf16 v[16:19], a[112:115], v[40:43], v[16:19]
v_mfma_f32_16x16x32_bf16 v[20:23], a[116:119], v[40:43], v[20:23]
v_mfma_f32_16x16x32_bf16 v[24:27], a[120:123], v[40:43], v[24:27]
s_waitcnt vmcnt(9)
ds_read_b128 v[52:55], v7 offset:23552
s_waitcnt lgkmcnt(2)
v_mfma_f32_16x16x32_bf16 v[16:19], a[124:127], v[44:47], v[16:19]
v_mfma_f32_16x16x32_bf16 v[20:23], a[128:131], v[44:47], v[20:23]
v_mfma_f32_16x16x32_bf16 v[24:27], a[132:135], v[44:47], v[24:27]
s_waitcnt vmcnt(8)
ds_read_b128 v[40:43], v7 offset:24576
s_waitcnt lgkmcnt(2)
v_mfma_f32_16x16x32_bf16 v[16:19], a[136:139], v[48:51], v[16:19]
v_mfma_f32_16x16x32_bf16 v[20:23], a[140:143], v[48:51], v[20:23]
v_mfma_f32_16x16x32_bf16 v[24:27], a[144:147], v[48:51], v[24:27]
s_waitcnt vmcnt(7)
ds_read_b128 v[44:47], v7 offset:25600
s_waitcnt lgkmcnt(2)
v_mfma_f32_16x16x32_bf16 v[16:19], a[148:151], v[52:55], v[16:19]
v_mfma_f32_16x16x32_bf16 v[20:23], a[152:155], v[52:55], v[20:23]
v_mfma_f32_16x16x32_bf16 v[24:27], a[156:159], v[52:55], v[24:27]
s_waitcnt vmcnt(6)
ds_read_b128 v[48:51], v7 offset:26624
s_waitcnt lgkmcnt(2)
v_mfma_f32_16x16x32_bf16 v[16:19], a[160:163], v[40:43], v[16:19]
v_mfma_f32_16x16x32_bf16 v[20:23], a[164:167], v[40:43], v[20:23]
v_mfma_f32_16x16x32_bf16 v[24:27], a[168:171], v[40:43], v[24:27]
s_waitcnt vmcnt(5)
ds_read_b128 v[52:55], v7 offset:27648
s_waitcnt lgkmcnt(2)
v_mfma_f32_16x16x32_bf16 v[16:19], a[172:175], v[44:47], v[16:19]
v_mfma_f32_16x16x32_bf16 v[20:23], a[176:179], v[44:47], v[20:23]
v_mfma_f32_16x16x32_bf16 v[24:27], a[180:183], v[44:47], v[24:27]
s_waitcnt vmcnt(4)
ds_read_b128 v[40:43], v7 offset:28672
s_waitcnt lgkmcnt(2)
v_mfma_f32_16x16x32_bf16 v[16:19], a[184:187], v[48:51], v[16:19]
v_mfma_f32_16x16x32_bf16 v[20:23], a[188:191], v[48:51], v[20:23]
v_mfma_f32_16x16x32_bf16 v[24:27], a[192:195], v[48:51], v[24:27]
s_waitcnt vmcnt(3)
ds_read_b128 v[44:47], v7 offset:29696
s_waitcnt lgkmcnt(2)
v_mfma_f32_16x16x32_bf16 v[16:19], a[196:199], v[52:55], v[16:19]
v_mfma_f32_16x16x32_bf16 v[20:23], a[200:203], v[52:55], v[20:23]
v_mfma_f32_16x16x32_bf16 v[24:27], a[204:207], v[52:55], v[24:27]
s_waitcnt vmcnt(2)
ds_read_b128 v[48:51], v7 offset:30720
s_waitcnt lgkmcnt(2)
v_mfma_f32_16x16x32_bf16 v[16:19], a[208:211], v[40:43], v[16:19]
v_mfma_f32_16x16x32_bf16 v[20:23], a[212:215], v[40:43], v[20:23]
v_mfma_f32_16x16x32_bf16 v[24:27], a[216:219], v[40:43], v[24:27]
s_waitcnt vmcnt(1)
ds_read_b128 v[52:55], v7 offset:31744
s_waitcnt lgkmcnt(2)
v_mfma_f32_16x16x32_bf16 v[16:19], a[220:223], v[44:47], v[16:19]
v_mfma_f32_16x16x32_bf16 v[20:23], a[224:227], v[44:47], v[20:23]
v_mfma_f32_16x16x32_bf16 v[24:27], a[228:231], v[44:47], v[24:27]
s_waitcnt lgkmcnt(1)
v_mfma_f32_16x16x32_bf16 v[16:19], a[232:235], v[48:51], v[16:19]
v_mfma_f32_16x16x32_bf16 v[20:23], a[236:239], v[48:51], v[20:23]
v_mfma_f32_16x16x32_bf16 v[24:27], a[240:243], v[48:51], v[24:27]
s_waitcnt lgkmcnt(0)
v_mfma_f32_16x16x32_bf16 v[16:19], a[244:247], v[52:55], v[16:19]
v_mfma_f32_16x16x32_bf16 v[20:23], a[248:251], v[52:55], v[20:23]
v_mfma_f32_16x16x32_bf16 v[24:27], a[252:255], v[52:55], v[24:27]
s_mov_b32 s59, s55
s_add_u32 s55, s55, 92160
s_add_u32 s54, s54, 92160
s_add_u32 s53, s53, 655360
s_add_u32 s56, s56, 320
s_add_u32 s48, s48, 5
v_fma_f32 v16, v16, v4, v28
v_fma_f32 v17, v17, v4, v29
v_fma_f32 v18, v18, v4, v30
v_fma_f32 v19, v19, v4, v31
ds_write_b128 v2, v[16:19] offset:0
v_fma_f32 v20, v20, v4, v32
v_fma_f32 v21, v21, v4, v33
v_fma_f32 v22, v22, v4, v34
v_fma_f32 v23, v23, v4, v35
ds_write_b128 v2, v[20:23] offset:1024
v_fma_f32 v24, v24, v4, v36
v_fma_f32 v25, v25, v4, v37
v_fma_f32 v26, v26, v4, v38
v_fma_f32 v27, v27, v4, v39
ds_write_b128 v2, v[24:27] offset:2048
v_xor_b32 v2, 16384, v2
s_cmp_ge_u32 s48, 128
s_cbranch_scc1 L_w_now
s_waitcnt vmcnt(0)
v_cmp_ge_u32 vcc, s35, v3
s_cbranch_vccz L_w_ready
L_w_now:
s_waitcnt lgkmcnt(0)
s_barrier
ds_read_b128 v[16:19], v14 offset:0
ds_read_b128 v[20:23], v14 offset:3072
ds_read_b128 v[24:27], v14 offset:6144
ds_read_b128 v[28:31], v14 offset:9216
s_waitcnt lgkmcnt(0)
v_pk_add_f32 v[16:17], v[16:17], v[20:21]
v_pk_add_f32 v[18:19], v[18:19], v[22:23]
v_pk_add_f32 v[24:25], v[24:25], v[28:29]
v_pk_add_f32 v[26:27], v[26:27], v[30:31]
v_pk_add_f32 v[16:17], v[16:17], v[24:25]
v_pk_add_f32 v[18:19], v[18:19], v[26:27]
v_cvt_pk_bf16_f32 v60, v16, v17
v_cvt_pk_bf16_f32 v61, v18, v19
v_xor_b32 v14, 16384, v14
buffer_store_dwordx2 v[60:61], v15, s[28:31], s59 offen
s_cmp_lt_u32 s48, 128
s_cbranch_scc1 L_w_wait
s_waitcnt vmcnt(0)
s_endpgm
L_pro_w0:
v_and_b32 v20, 63, v0
v_lshlrev_b32 v1, 4, v20
v_add_u32 v2, 16384, v1
v_and_b32 v23, 1, v22
v_lshl_add_u32 v23, v24, 4, v23
v_mul_u32_u24 v23, 1152, v23
v_lshlrev_b32 v28, 2, v22
v_xor_b32 v28, v28, v21
v_lshl_add_u32 v28, v28, 4, v23
s_mul_i32 s55, s32, 147456
v_lshrrev_b32 v23, 2, v21
v_and_b32 v24, 1, v21
v_lshl_add_u32 v23, v23, 1, v24
v_mul_u32_u24 v23, 1152, v23
v_lshl_add_u32 v23, v22, 5, v23
v_bfe_u32 v24, v21, 1, 1
v_lshl_add_u32 v23, v24, 4, v23
s_lshl_b32 s56, s32, 7
s_waitcnt lgkmcnt(0)
buffer_load_dwordx4 v[12:15], v23, s[24:27], s56 offen
v_and_b32 v23, 1, v22
v_lshrrev_b32 v24, 2, v21
v_lshl_add_u32 v23, v23, 2, v24
v_lshlrev_b32 v23, 1, v23
v_bfe_u32 v44, v21, 1, 1
v_add_u32 v44, 0, v44
v_xor_b32 v44, v44, v23
v_lshlrev_b32 v44, 4, v44
v_lshl_add_u32 v44, v24, 8, v44
v_and_b32 v23, 1, v22
v_lshl_add_u32 v44, v23, 11, v44
v_and_b32 v23, 1, v21
v_lshl_add_u32 v44, v23, 3, v44
v_lshrrev_b32 v23, 1, v22
v_mul_u32_u24 v23, 40960, v23
v_add_u32 v23, 16384, v23
v_add_u32 v44, v44, v23
v_and_b32 v23, 1, v22
v_lshrrev_b32 v24, 2, v21
v_lshl_add_u32 v23, v23, 2, v24
v_lshlrev_b32 v23, 1, v23
v_bfe_u32 v45, v21, 1, 1
v_add_u32 v45, 2, v45
v_xor_b32 v45, v45, v23
v_lshlrev_b32 v45, 4, v45
v_lshl_add_u32 v45, v24, 8, v45
v_and_b32 v23, 1, v22
v_lshl_add_u32 v45, v23, 11, v45
v_and_b32 v23, 1, v21
v_lshl_add_u32 v45, v23, 3, v45
v_lshrrev_b32 v23, 1, v22
v_mul_u32_u24 v23, 40960, v23
v_add_u32 v23, 16384, v23
v_add_u32 v45, v45, v23
v_and_b32 v23, 1, v22
v_lshrrev_b32 v24, 2, v21
v_lshl_add_u32 v23, v23, 2, v24
v_lshlrev_b32 v23, 1, v23
v_bfe_u32 v46, v21, 1, 1
v_add_u32 v46, 0, v46
v_xor_b32 v46, v46, v23
v_lshlrev_b32 v46, 4, v46
v_lshl_add_u32 v46, v24, 8, v46
v_and_b32 v23, 1, v22
v_lshl_add_u32 v46, v23, 11, v46
v_and_b32 v23, 1, v21
v_lshl_add_u32 v46, v23, 3, v46
v_lshrrev_b32 v23, 1, v22
v_mul_u32_u24 v23, 32768, v23
v_add_u32 v23, 98304, v23
v_add_u32 v46, v46, v23
v_and_b32 v23, 1, v22
v_lshrrev_b32 v24, 2, v21
v_lshl_add_u32 v23, v23, 2, v24
v_lshlrev_b32 v23, 1, v23
v_bfe_u32 v47, v21, 1, 1
v_add_u32 v47, 2, v47
v_xor_b32 v47, v47, v23
v_lshlrev_b32 v47, 4, v47
v_lshl_add_u32 v47, v24, 8, v47
v_and_b32 v23, 1, v22
v_lshl_add_u32 v47, v23, 11, v47
v_and_b32 v23, 1, v21
v_lshl_add_u32 v47, v23, 3, v47
v_lshrrev_b32 v23, 1, v22
v_mul_u32_u24 v23, 32768, v23
v_add_u32 v23, 98304, v23
v_add_u32 v47, v47, v23
v_and_b32 v23, 1, v22
v_bfe_u32 v24, v21, 2, 1
v_lshl_add_u32 v23, v23, 1, v24
v_xor_b32 v24, 0, v23
v_lshlrev_b32 v24, 6, v24
v_lshl_add_u32 v48, v23, 8, v24
v_and_b32 v23, 3, v21
v_lshl_add_u32 v48, v23, 4, v48
v_and_b32 v23, 8, v21
v_add_u32 v48, v48, v23
v_lshrrev_b32 v23, 1, v22
v_mul_u32_u24 v23, 40960, v23
v_add_u32 v23, 16384, v23
v_add_u32 v48, v48, v23
v_and_b32 v23, 1, v22
v_bfe_u32 v24, v21, 2, 1
v_lshl_add_u32 v23, v23, 1, v24
v_xor_b32 v24, 0, v23
v_lshlrev_b32 v24, 6, v24
v_lshl_add_u32 v49, v23, 8, v24
v_and_b32 v23, 3, v21
v_lshl_add_u32 v49, v23, 4, v49
v_and_b32 v23, 8, v21
v_add_u32 v49, v49, v23
v_lshrrev_b32 v23, 1, v22
v_mul_u32_u24 v23, 32768, v23
v_add_u32 v23, 98304, v23
v_add_u32 v49, v49, v23
v_bfe_u32 v23, v21, 1, 1
v_mul_u32_u24 v23, 0xaaaa, v23
v_add_u32 v0, 0x4444, v23
v_lshlrev_b32 v3, 3, v20
v_lshrrev_b32 v25, 5, v20
v_lshlrev_b32 v25, 6, v25
v_xor_b32 v3, v3, v25
v_lshrrev_b32 v25, 2, v20
v_and_b32 v4, 3, v21
v_lshl_add_u32 v4, v4, 4, v25
v_lshlrev_b32 v4, 3, v4
v_bfe_u32 v25, v21, 1, 1
v_lshlrev_b32 v23, 6, v25
v_xor_b32 v4, v4, v23
v_lshlrev_b32 v5, 4, v21
v_lshl_add_u32 v5, v22, 2, v5
v_mul_u32_u24 v23, 1024, v25
v_add_u32 v5, v5, v23
v_lshlrev_b32 v9, 8, v22
v_lshl_add_u32 v9, v25, 6, v9
v_bfe_u32 v23, v21, 3, 1
v_lshl_add_u32 v9, v23, 7, v9
v_bfe_u32 v23, v21, 2, 1
v_lshl_add_u32 v9, v23, 5, v9
v_and_b32 v23, 1, v21
v_lshl_add_u32 v9, v23, 4, v9
v_lshrrev_b32 v23, 1, v22
v_and_b32 v24, 1, v22
v_and_b32 v25, 7, v21
v_lshrrev_b32 v7, 3, v21
v_lshl_add_u32 v8, v7, 1, v23
v_lshlrev_b32 v8, 12, v8
v_lshl_add_u32 v8, v24, 7, v8
v_and_b32 v25, 4, v21
v_lshl_add_u32 v8, v25, 3, v8
v_and_b32 v25, 1, v21
v_lshl_add_u32 v8, v25, 4, v8
v_bfe_u32 v25, v21, 1, 1
v_lshl_add_u32 v8, v25, 3, v8
s_lshr_b32 s56, s32, 1
s_lshl_b32 s56, s56, 8
s_and_b32 s57, s32, 1
s_lshl_b32 s57, s57, 6
s_add_u32 s56, s56, s57
s_add_u32 s56, s56, 0
v_add_u32 v8, s56, v8
v_and_b32 v7, 0x3d0, v1
s_mov_b32 s42, 0
s_mov_b32 s43, 65536
s_mov_b32 s44, 131072
s_mov_b32 s45, 196608
s_mov_b32 s46, 262144
s_mov_b32 s47, 294912
s_mov_b32 s48, 299008
s_mov_b32 s49, 303104
s_mov_b32 s50, 0x3e0293ee
s_mov_b32 s51, 0x3e0293ee
s_mov_b32 s52, 0x3f803f80
s_mov_b32 s53, 0x3f803f80
v_and_b32 v11, 3, v21
v_cmp_eq_u32 vcc, 0, v11
s_nop 1
v_cndmask_b32 v11, 0, 1, vcc
s_mov_b32 s34, 0
s_mov_b32 s35, -1
s_mov_b32 s36, 0
s_mov_b32 s41, 300000
s_lshl_b32 s37, s32, 14
s_add_u32 s39, s37, 17301504
s_add_u32 s37, s37, 16777216
s_mov_b32 s40, 8749056
v_mov_b64 v[36:37], 0
v_mov_b64 v[38:39], 0
ds_write_b128 v1, v[36:39] offset:14336
s_lshl_b32 s56, s32, 1
s_add_u32 s56, s56, 0
s_cmp_eq_u32 s56, 0
s_cselect_b32 s56, 64, s56
s_mul_i32 s56, s56, 10240
s_add_u32 s56, s56, 8388608
s_add_u32 s57, s56, 4096
v_mov_b32 v40, 0
v_mov_b32 v41, 0
v_mov_b32 v42, 0
v_mov_b32 v43, 0
buffer_store_dwordx4 v[40:43], v1, s[4:7], s56 offen offset:0 sc0 sc1
buffer_store_dwordx4 v[40:43], v1, s[4:7], s56 offen offset:1024 sc0 sc1
buffer_store_dwordx4 v[40:43], v1, s[4:7], s56 offen offset:2048 sc0 sc1
buffer_store_dwordx4 v[40:43], v1, s[4:7], s56 offen offset:3072 sc0 sc1
v_lshlrev_b32 v23, 2, v20
s_lshl_b32 s56, s32, 8
s_add_u32 s56, s56, 327680
buffer_store_dword v36, v23, s[4:7], s56 offen sc0 sc1
s_lshl_b32 s56, s32, 10
s_cmp_ge_u32 s32, 9
s_cselect_b32 s56, 268435456, s56
s_add_u32 s57, s56, 8388608
s_add_u32 s56, s56, 294912
s_waitcnt vmcnt(5)
v_or_b32 v12, 1, v12
buffer_store_dwordx4 v[12:15], v1, s[4:7], s56 offen sc0 sc1
buffer_store_dwordx4 v[12:15], v1, s[4:7], s57 offen sc0 sc1
s_getreg_b32 s56, hwreg(HW_REG_XCC_ID)
s_and_b32 s56, s56, 15
s_mul_i32 s57, s56, s56
s_lshl_b32 s57, s57, 18
s_lshl_b32 s56, s56, 8
s_add_u32 s57, s57, s56
s_add_u32 s58, s57, 1
s_lshl_b32 s101, s32, 7
s_add_u32 s101, s101, 327680
v_mov_b32 v24, 0
s_add_u32 s56, s54, 0
s_mov_b32 m0, 28672
s_nop 0
buffer_load_dwordx4 v26, s[12:15], s56 offen lds
s_add_u32 s56, s54, 16384
s_mov_b32 m0, 29696
s_nop 0
buffer_load_dwordx4 v26, s[12:15], s56 offen lds
s_add_u32 s56, s54, 32768
s_mov_b32 m0, 30720
s_nop 0
buffer_load_dwordx4 v27, s[12:15], s56 offen lds
s_add_u32 s56, s54, 49152
s_mov_b32 m0, 31744
s_nop 0
buffer_load_dwordx4 v27, s[12:15], s56 offen lds
s_add_u32 s56, s54, 524288
s_mov_b32 m0, 32768
s_nop 0
buffer_load_dwordx4 v26, s[12:15], s56 offen lds
s_add_u32 s56, s54, 540672
s_mov_b32 m0, 33792
s_nop 0
buffer_load_dwordx4 v26, s[12:15], s56 offen lds
s_add_u32 s56, s54, 557056
s_mov_b32 m0, 34816
s_nop 0
buffer_load_dwordx4 v27, s[12:15], s56 offen lds
s_add_u32 s56, s54, 573440
s_mov_b32 m0, 35840
s_nop 0
buffer_load_dwordx4 v27, s[12:15], s56 offen lds
v_and_b32 v23, 3, v20
v_lshrrev_b32 v24, 2, v20
v_mul_u32_u24 v29, 1152, v24
v_lshl_add_u32 v29, v23, 4, v29
v_lshrrev_b32 v24, 2, v21
v_and_b32 v25, 1, v22
v_lshlrev_b32 v31, 10, v25
v_lshrrev_b32 v25, 1, v22
v_lshl_add_u32 v31, v25, 8, v31
v_and_b32 v25, 1, v24
v_lshl_add_u32 v31, v25, 6, v31
v_lshrrev_b32 v25, 1, v24
v_lshl_add_u32 v31, v25, 3, v31
v_lshl_add_u32 v31, v23, 4, v31
v_add_u32 v31, 16384, v31
s_add_u32 s56, s55, 1024
s_mov_b32 m0, 49152
s_nop 0
buffer_load_dwordx4 v29, s[20:23], s56 offen lds
s_add_u32 s56, s55, 19456
s_mov_b32 m0, 50176
s_nop 0
buffer_load_dwordx4 v29, s[20:23], s56 offen lds
s_add_u32 s56, s55, 37888
s_mov_b32 m0, 51200
s_nop 0
buffer_load_dwordx4 v29, s[20:23], s56 offen lds
s_add_u32 s56, s55, 56320
s_mov_b32 m0, 52224
s_nop 0
buffer_load_dwordx4 v29, s[20:23], s56 offen lds
s_add_u32 s56, s55, 74752
s_mov_b32 m0, 53248
s_nop 0
buffer_load_dwordx4 v29, s[20:23], s56 offen lds
s_add_u32 s56, s55, 93184
s_mov_b32 m0, 54272
s_nop 0
buffer_load_dwordx4 v29, s[20:23], s56 offen lds
s_add_u32 s56, s55, 111616
s_mov_b32 m0, 55296
s_nop 0
buffer_load_dwordx4 v29, s[20:23], s56 offen lds
s_add_u32 s56, s55, 130048
s_mov_b32 m0, 56320
s_nop 0
buffer_load_dwordx4 v29, s[20:23], s56 offen lds
v_mov_b32 v24, 0
s_barrier
ds_read_b64_tr_b16 v[80:81], v44 offset:20480
ds_read_b64_tr_b16 v[82:83], v44 offset:21504
ds_read_b64_tr_b16 v[84:85], v46 offset:20480
ds_read_b64_tr_b16 v[86:87], v46 offset:21504
ds_read_b64_tr_b16 v[88:89], v45 offset:20480
ds_read_b64_tr_b16 v[90:91], v45 offset:21504
ds_read_b64_tr_b16 v[92:93], v47 offset:20480
ds_read_b64_tr_b16 v[94:95], v47 offset:21504
s_waitcnt lgkmcnt(0)
s_barrier
s_add_u32 s56, s54, 1048576
s_mov_b32 m0, 36864
s_nop 0
buffer_load_dwordx4 v26, s[12:15], s56 offen lds
s_add_u32 s56, s54, 1064960
s_mov_b32 m0, 37888
s_nop 0
buffer_load_dwordx4 v26, s[12:15], s56 offen lds
s_add_u32 s56, s54, 1081344
s_mov_b32 m0, 38912
s_nop 0
buffer_load_dwordx4 v27, s[12:15], s56 offen lds
s_add_u32 s56, s54, 1097728
s_mov_b32 m0, 39936
s_nop 0
buffer_load_dwordx4 v27, s[12:15], s56 offen lds
ds_read_b64_tr_b16 v[96:97], v44 offset:24576
ds_read_b64_tr_b16 v[98:99], v44 offset:25600
ds_read_b64_tr_b16 v[100:101], v46 offset:24576
ds_read_b64_tr_b16 v[102:103], v46 offset:25600
ds_read_b64_tr_b16 v[104:105], v45 offset:24576
ds_read_b64_tr_b16 v[106:107], v45 offset:25600
ds_read_b64_tr_b16 v[108:109], v47 offset:24576
ds_read_b64_tr_b16 v[110:111], v47 offset:25600
s_waitcnt lgkmcnt(0)
s_barrier
s_add_u32 s56, s54, 1572864
s_mov_b32 m0, 40960
s_nop 0
buffer_load_dwordx4 v26, s[12:15], s56 offen lds
s_add_u32 s56, s54, 1589248
s_mov_b32 m0, 41984
s_nop 0
buffer_load_dwordx4 v26, s[12:15], s56 offen lds
s_add_u32 s56, s54, 1605632
s_mov_b32 m0, 43008
s_nop 0
buffer_load_dwordx4 v27, s[12:15], s56 offen lds
s_add_u32 s56, s54, 1622016
s_mov_b32 m0, 44032
s_nop 0
buffer_load_dwordx4 v27, s[12:15], s56 offen lds
ds_read_b64_tr_b16 v[112:113], v44 offset:28672
ds_read_b64_tr_b16 v[114:115], v44 offset:29696
ds_read_b64_tr_b16 v[116:117], v46 offset:28672
ds_read_b64_tr_b16 v[118:119], v46 offset:29696
ds_read_b64_tr_b16 v[120:121], v45 offset:28672
ds_read_b64_tr_b16 v[122:123], v45 offset:29696
ds_read_b64_tr_b16 v[124:125], v47 offset:28672
ds_read_b64_tr_b16 v[126:127], v47 offset:29696
s_waitcnt lgkmcnt(0)
s_barrier
s_add_u32 s56, s54, 2097152
s_mov_b32 m0, 45056
s_nop 0
buffer_load_dwordx4 v26, s[12:15], s56 offen lds
s_add_u32 s56, s54, 2113536
s_mov_b32 m0, 46080
s_nop 0
buffer_load_dwordx4 v26, s[12:15], s56 offen lds
s_add_u32 s56, s54, 2129920
s_mov_b32 m0, 47104
s_nop 0
buffer_load_dwordx4 v27, s[12:15], s56 offen lds
s_add_u32 s56, s54, 2146304
s_mov_b32 m0, 48128
s_nop 0
buffer_load_dwordx4 v27, s[12:15], s56 offen lds
ds_read_b64_tr_b16 v[128:129], v44 offset:0
ds_read_b64_tr_b16 v[130:131], v44 offset:1024
ds_read_b64_tr_b16 v[132:133], v46 offset:0
ds_read_b64_tr_b16 v[134:135], v46 offset:1024
ds_read_b64_tr_b16 v[136:137], v45 offset:0
ds_read_b64_tr_b16 v[138:139], v45 offset:1024
ds_read_b64_tr_b16 v[140:141], v47 offset:0
ds_read_b64_tr_b16 v[142:143], v47 offset:1024
s_waitcnt lgkmcnt(0)
s_barrier
s_add_u32 s56, s54, 3145728
s_mov_b32 m0, 16384
s_nop 0
buffer_load_dwordx4 v26, s[12:15], s56 offen lds
s_add_u32 s56, s54, 3162112
s_mov_b32 m0, 17408
s_nop 0
buffer_load_dwordx4 v26, s[12:15], s56 offen lds
s_add_u32 s56, s54, 3178496
s_mov_b32 m0, 18432
s_nop 0
buffer_load_dwordx4 v27, s[12:15], s56 offen lds
s_add_u32 s56, s54, 3194880
s_mov_b32 m0, 19456
s_nop 0
buffer_load_dwordx4 v27, s[12:15], s56 offen lds
ds_read_b64_tr_b16 v[144:145], v44 offset:4096
ds_read_b64_tr_b16 v[146:147], v44 offset:5120
ds_read_b64_tr_b16 v[148:149], v46 offset:4096
ds_read_b64_tr_b16 v[150:151], v46 offset:5120
ds_read_b64_tr_b16 v[152:153], v45 offset:4096
ds_read_b64_tr_b16 v[154:155], v45 offset:5120
ds_read_b64_tr_b16 v[156:157], v47 offset:4096
ds_read_b64_tr_b16 v[158:159], v47 offset:5120
s_waitcnt lgkmcnt(0)
s_barrier
s_add_u32 s56, s54, 3670016
s_mov_b32 m0, 20480
s_nop 0
buffer_load_dwordx4 v26, s[12:15], s56 offen lds
s_add_u32 s56, s54, 3686400
s_mov_b32 m0, 21504
s_nop 0
buffer_load_dwordx4 v26, s[12:15], s56 offen lds
s_add_u32 s56, s54, 3702784
s_mov_b32 m0, 22528
s_nop 0
buffer_load_dwordx4 v27, s[12:15], s56 offen lds
s_add_u32 s56, s54, 3719168
s_mov_b32 m0, 23552
s_nop 0
buffer_load_dwordx4 v27, s[12:15], s56 offen lds
ds_read_b64_tr_b16 v[160:161], v44 offset:8192
ds_read_b64_tr_b16 v[162:163], v44 offset:9216
ds_read_b64_tr_b16 v[164:165], v46 offset:8192
ds_read_b64_tr_b16 v[166:167], v46 offset:9216
ds_read_b64_tr_b16 v[168:169], v45 offset:8192
ds_read_b64_tr_b16 v[170:171], v45 offset:9216
ds_read_b64_tr_b16 v[172:173], v47 offset:8192
ds_read_b64_tr_b16 v[174:175], v47 offset:9216
s_waitcnt lgkmcnt(0)
s_waitcnt vmcnt(32)
s_barrier
s_add_u32 s56, s54, 4194304
s_mov_b32 m0, 24576
s_nop 0
buffer_load_dwordx4 v26, s[12:15], s56 offen lds
s_add_u32 s56, s54, 4210688
s_mov_b32 m0, 25600
s_nop 0
buffer_load_dwordx4 v26, s[12:15], s56 offen lds
s_add_u32 s56, s54, 4227072
s_mov_b32 m0, 26624
s_nop 0
buffer_load_dwordx4 v27, s[12:15], s56 offen lds
s_add_u32 s56, s54, 4243456
s_mov_b32 m0, 27648
s_nop 0
buffer_load_dwordx4 v27, s[12:15], s56 offen lds
ds_read_b64_tr_b16 v[176:177], v44 offset:12288
ds_read_b64_tr_b16 v[178:179], v44 offset:13312
ds_read_b64_tr_b16 v[180:181], v46 offset:12288
ds_read_b64_tr_b16 v[182:183], v46 offset:13312
ds_read_b64_tr_b16 v[184:185], v45 offset:12288
ds_read_b64_tr_b16 v[186:187], v45 offset:13312
ds_read_b64_tr_b16 v[188:189], v47 offset:12288
ds_read_b64_tr_b16 v[190:191], v47 offset:13312
v_mov_b32 v23, s58
s_mov_b64 exec, 1
buffer_atomic_add v23, v24, s[28:31], 0 offen sc1
s_mov_b64 exec, -1
s_waitcnt lgkmcnt(0)
s_waitcnt vmcnt(33)
s_barrier
s_add_u32 s56, s54, 0
s_mov_b32 m0, 28672
s_nop 0
buffer_load_dwordx4 v26, s[16:19], s56 offen lds
s_add_u32 s56, s54, 16384
s_mov_b32 m0, 29696
s_nop 0
buffer_load_dwordx4 v26, s[16:19], s56 offen lds
s_add_u32 s56, s54, 32768
s_mov_b32 m0, 30720
s_nop 0
buffer_load_dwordx4 v27, s[16:19], s56 offen lds
s_add_u32 s56, s54, 49152
s_mov_b32 m0, 31744
s_nop 0
buffer_load_dwordx4 v27, s[16:19], s56 offen lds
ds_read_b64_tr_b16 v[192:193], v44 offset:16384
ds_read_b64_tr_b16 v[194:195], v44 offset:17408
ds_read_b64_tr_b16 v[196:197], v46 offset:16384
ds_read_b64_tr_b16 v[198:199], v46 offset:17408
ds_read_b64_tr_b16 v[200:201], v45 offset:16384
ds_read_b64_tr_b16 v[202:203], v45 offset:17408
ds_read_b64_tr_b16 v[204:205], v47 offset:16384
ds_read_b64_tr_b16 v[206:207], v47 offset:17408
s_waitcnt lgkmcnt(0)
s_waitcnt vmcnt(25)
s_barrier
s_add_u32 s56, s54, 524288
s_mov_b32 m0, 32768
s_nop 0
buffer_load_dwordx4 v26, s[16:19], s56 offen lds
s_add_u32 s56, s54, 540672
s_mov_b32 m0, 33792
s_nop 0
buffer_load_dwordx4 v26, s[16:19], s56 offen lds
s_add_u32 s56, s54, 557056
s_mov_b32 m0, 34816
s_nop 0
buffer_load_dwordx4 v27, s[16:19], s56 offen lds
s_add_u32 s56, s54, 573440
s_mov_b32 m0, 35840
s_nop 0
buffer_load_dwordx4 v27, s[16:19], s56 offen lds
ds_read_b64_tr_b16 v[208:209], v44 offset:20480
ds_read_b64_tr_b16 v[210:211], v44 offset:21504
ds_read_b64_tr_b16 v[212:213], v46 offset:20480
ds_read_b64_tr_b16 v[214:215], v46 offset:21504
ds_read_b64_tr_b16 v[216:217], v45 offset:20480
ds_read_b64_tr_b16 v[218:219], v45 offset:21504
ds_read_b64_tr_b16 v[220:221], v47 offset:20480
ds_read_b64_tr_b16 v[222:223], v47 offset:21504
s_waitcnt lgkmcnt(0)
s_waitcnt vmcnt(25)
s_barrier
s_add_u32 s56, s54, 1048576
s_mov_b32 m0, 36864
s_nop 0
buffer_load_dwordx4 v26, s[16:19], s56 offen lds
s_add_u32 s56, s54, 1064960
s_mov_b32 m0, 37888
s_nop 0
buffer_load_dwordx4 v26, s[16:19], s56 offen lds
s_add_u32 s56, s54, 1081344
s_mov_b32 m0, 38912
s_nop 0
buffer_load_dwordx4 v27, s[16:19], s56 offen lds
s_add_u32 s56, s54, 1097728
s_mov_b32 m0, 39936
s_nop 0
buffer_load_dwordx4 v27, s[16:19], s56 offen lds
ds_read_b64_tr_b16 v[224:225], v44 offset:24576
ds_read_b64_tr_b16 v[226:227], v44 offset:25600
ds_read_b64_tr_b16 v[228:229], v46 offset:24576
ds_read_b64_tr_b16 v[230:231], v46 offset:25600
ds_read_b64_tr_b16 v[232:233], v45 offset:24576
ds_read_b64_tr_b16 v[234:235], v45 offset:25600
ds_read_b64_tr_b16 v[236:237], v47 offset:24576
ds_read_b64_tr_b16 v[238:239], v47 offset:25600
ds_read_b64_tr_b16 v[60:61], v31 offset:32768
ds_read_b64_tr_b16 v[62:63], v31 offset:32896
ds_read_b64_tr_b16 v[64:65], v31 offset:33280
ds_read_b64_tr_b16 v[66:67], v31 offset:33408
ds_read_b64_tr_b16 v[68:69], v31 offset:34816
ds_read_b64_tr_b16 v[70:71], v31 offset:34944
ds_read_b64_tr_b16 v[72:73], v31 offset:35328
ds_read_b64_tr_b16 v[74:75], v31 offset:35456
s_waitcnt lgkmcnt(0)
ds_write_b128 v2, v[60:63] offset:32768
ds_write_b128 v2, v[64:67] offset:33792
ds_write_b128 v2, v[68:71] offset:34816
ds_write_b128 v2, v[72:75] offset:35840
s_waitcnt lgkmcnt(0)
s_waitcnt vmcnt(25)
s_barrier
s_add_u32 s56, s54, 1572864
s_mov_b32 m0, 40960
s_nop 0
buffer_load_dwordx4 v26, s[16:19], s56 offen lds
s_add_u32 s56, s54, 1589248
s_mov_b32 m0, 41984
s_nop 0
buffer_load_dwordx4 v26, s[16:19], s56 offen lds
s_add_u32 s56, s54, 1605632
s_mov_b32 m0, 43008
s_nop 0
buffer_load_dwordx4 v27, s[16:19], s56 offen lds
s_add_u32 s56, s54, 1622016
s_mov_b32 m0, 44032
s_nop 0
buffer_load_dwordx4 v27, s[16:19], s56 offen lds
ds_read_b64_tr_b16 v[240:241], v44 offset:28672
ds_read_b64_tr_b16 v[242:243], v44 offset:29696
ds_read_b64_tr_b16 v[244:245], v46 offset:28672
ds_read_b64_tr_b16 v[246:247], v46 offset:29696
ds_read_b64_tr_b16 v[248:249], v45 offset:28672
ds_read_b64_tr_b16 v[250:251], v45 offset:29696
ds_read_b64_tr_b16 v[252:253], v47 offset:28672
ds_read_b64_tr_b16 v[254:255], v47 offset:29696
ds_read_b64_tr_b16 v[60:61], v31 offset:36864
ds_read_b64_tr_b16 v[62:63], v31 offset:36992
ds_read_b64_tr_b16 v[64:65], v31 offset:37376
ds_read_b64_tr_b16 v[66:67], v31 offset:37504
ds_read_b64_tr_b16 v[68:69], v31 offset:38912
ds_read_b64_tr_b16 v[70:71], v31 offset:39040
ds_read_b64_tr_b16 v[72:73], v31 offset:39424
ds_read_b64_tr_b16 v[74:75], v31 offset:39552
s_waitcnt lgkmcnt(0)
ds_write_b128 v2, v[60:63] offset:36864
ds_write_b128 v2, v[64:67] offset:37888
ds_write_b128 v2, v[68:71] offset:38912
ds_write_b128 v2, v[72:75] offset:39936
s_waitcnt lgkmcnt(0)
s_waitcnt vmcnt(25)
s_barrier
s_add_u32 s56, s54, 2097152
s_mov_b32 m0, 45056
s_nop 0
buffer_load_dwordx4 v26, s[16:19], s56 offen lds
s_add_u32 s56, s54, 2113536
s_mov_b32 m0, 46080
s_nop 0
buffer_load_dwordx4 v26, s[16:19], s56 offen lds
s_add_u32 s56, s54, 2129920
s_mov_b32 m0, 47104
s_nop 0
buffer_load_dwordx4 v27, s[16:19], s56 offen lds
s_add_u32 s56, s54, 2146304
s_mov_b32 m0, 48128
s_nop 0
buffer_load_dwordx4 v27, s[16:19], s56 offen lds
ds_read_b64_tr_b16 a[0:1], v44 offset:0
ds_read_b64_tr_b16 a[2:3], v44 offset:1024
ds_read_b64_tr_b16 a[4:5], v46 offset:0
ds_read_b64_tr_b16 a[6:7], v46 offset:1024
ds_read_b64_tr_b16 a[8:9], v45 offset:0
ds_read_b64_tr_b16 a[10:11], v45 offset:1024
ds_read_b64_tr_b16 a[12:13], v47 offset:0
ds_read_b64_tr_b16 a[14:15], v47 offset:1024
s_waitcnt lgkmcnt(0)
s_waitcnt vmcnt(25)
s_barrier
s_add_u32 s56, s54, 2621440
s_mov_b32 m0, 16384
s_nop 0
buffer_load_dwordx4 v26, s[16:19], s56 offen lds
s_add_u32 s56, s54, 2637824
s_mov_b32 m0, 17408
s_nop 0
buffer_load_dwordx4 v26, s[16:19], s56 offen lds
s_add_u32 s56, s54, 2654208
s_mov_b32 m0, 18432
s_nop 0
buffer_load_dwordx4 v27, s[16:19], s56 offen lds
s_add_u32 s56, s54, 2670592
s_mov_b32 m0, 19456
s_nop 0
buffer_load_dwordx4 v27, s[16:19], s56 offen lds
ds_read_b64_tr_b16 a[16:17], v44 offset:4096
ds_read_b64_tr_b16 a[18:19], v44 offset:5120
ds_read_b64_tr_b16 a[20:21], v46 offset:4096
ds_read_b64_tr_b16 a[22:23], v46 offset:5120
ds_read_b64_tr_b16 a[24:25], v45 offset:4096
ds_read_b64_tr_b16 a[26:27], v45 offset:5120
ds_read_b64_tr_b16 a[28:29], v47 offset:4096
ds_read_b64_tr_b16 a[30:31], v47 offset:5120
s_waitcnt lgkmcnt(0)
s_waitcnt vmcnt(25)
s_barrier
s_add_u32 s56, s54, 3145728
s_mov_b32 m0, 20480
s_nop 0
buffer_load_dwordx4 v26, s[16:19], s56 offen lds
s_add_u32 s56, s54, 3162112
s_mov_b32 m0, 21504
s_nop 0
buffer_load_dwordx4 v26, s[16:19], s56 offen lds
s_add_u32 s56, s54, 3178496
s_mov_b32 m0, 22528
s_nop 0
buffer_load_dwordx4 v27, s[16:19], s56 offen lds
s_add_u32 s56, s54, 3194880
s_mov_b32 m0, 23552
s_nop 0
buffer_load_dwordx4 v27, s[16:19], s56 offen lds
ds_read_b64_tr_b16 a[32:33], v44 offset:8192
ds_read_b64_tr_b16 a[34:35], v44 offset:9216
ds_read_b64_tr_b16 a[36:37], v46 offset:8192
ds_read_b64_tr_b16 a[38:39], v46 offset:9216
ds_read_b64_tr_b16 a[40:41], v45 offset:8192
ds_read_b64_tr_b16 a[42:43], v45 offset:9216
ds_read_b64_tr_b16 a[44:45], v47 offset:8192
ds_read_b64_tr_b16 a[46:47], v47 offset:9216
s_waitcnt lgkmcnt(0)
s_waitcnt vmcnt(24)
s_barrier
s_add_u32 s56, s54, 3670016
s_mov_b32 m0, 24576
s_nop 0
buffer_load_dwordx4 v26, s[16:19], s56 offen lds
s_add_u32 s56, s54, 3686400
s_mov_b32 m0, 25600
s_nop 0
buffer_load_dwordx4 v26, s[16:19], s56 offen lds
s_add_u32 s56, s54, 3702784
s_mov_b32 m0, 26624
s_nop 0
buffer_load_dwordx4 v27, s[16:19], s56 offen lds
s_add_u32 s56, s54, 3719168
s_mov_b32 m0, 27648
s_nop 0
buffer_load_dwordx4 v27, s[16:19], s56 offen lds
ds_read_b64_tr_b16 a[48:49], v44 offset:12288
ds_read_b64_tr_b16 a[50:51], v44 offset:13312
ds_read_b64_tr_b16 a[52:53], v46 offset:12288
ds_read_b64_tr_b16 a[54:55], v46 offset:13312
ds_read_b64_tr_b16 a[56:57], v45 offset:12288
ds_read_b64_tr_b16 a[58:59], v45 offset:13312
ds_read_b64_tr_b16 a[60:61], v47 offset:12288
ds_read_b64_tr_b16 a[62:63], v47 offset:13312
s_waitcnt lgkmcnt(0)
s_waitcnt vmcnt(24)
s_barrier
s_add_u32 s56, s55, 73728
s_mov_b32 m0, 28672
s_nop 0
buffer_load_dwordx4 v28, s[20:23], s56 offen lds
s_add_u32 s56, s55, 76032
s_mov_b32 m0, 29696
s_nop 0
buffer_load_dwordx4 v28, s[20:23], s56 offen lds
s_add_u32 s56, s55, 82944
s_mov_b32 m0, 30720
s_nop 0
buffer_load_dwordx4 v28, s[20:23], s56 offen lds
s_add_u32 s56, s55, 85248
s_mov_b32 m0, 31744
s_nop 0
buffer_load_dwordx4 v28, s[20:23], s56 offen lds
ds_read_b64_tr_b16 a[64:65], v44 offset:16384
ds_read_b64_tr_b16 a[66:67], v44 offset:17408
ds_read_b64_tr_b16 a[68:69], v46 offset:16384
ds_read_b64_tr_b16 a[70:71], v46 offset:17408
ds_read_b64_tr_b16 a[72:73], v45 offset:16384
ds_read_b64_tr_b16 a[74:75], v45 offset:17408
ds_read_b64_tr_b16 a[76:77], v47 offset:16384
ds_read_b64_tr_b16 a[78:79], v47 offset:17408
s_waitcnt lgkmcnt(0)
s_waitcnt vmcnt(24)
s_barrier
s_add_u32 s56, s55, 73984
s_mov_b32 m0, 32768
s_nop 0
buffer_load_dwordx4 v28, s[20:23], s56 offen lds
s_add_u32 s56, s55, 76288
s_mov_b32 m0, 33792
s_nop 0
buffer_load_dwordx4 v28, s[20:23], s56 offen lds
s_add_u32 s56, s55, 83200
s_mov_b32 m0, 34816
s_nop 0
buffer_load_dwordx4 v28, s[20:23], s56 offen lds
s_add_u32 s56, s55, 85504
s_mov_b32 m0, 35840
s_nop 0
buffer_load_dwordx4 v28, s[20:23], s56 offen lds
ds_read_b64_tr_b16 a[80:81], v44 offset:20480
ds_read_b64_tr_b16 a[82:83], v44 offset:21504
ds_read_b64_tr_b16 a[84:85], v46 offset:20480
ds_read_b64_tr_b16 a[86:87], v46 offset:21504
ds_read_b64_tr_b16 a[88:89], v45 offset:20480
ds_read_b64_tr_b16 a[90:91], v45 offset:21504
ds_read_b64_tr_b16 a[92:93], v47 offset:20480
ds_read_b64_tr_b16 a[94:95], v47 offset:21504
s_waitcnt lgkmcnt(0)
s_waitcnt vmcnt(24)
s_barrier
s_add_u32 s56, s55, 74240
s_mov_b32 m0, 36864
s_nop 0
buffer_load_dwordx4 v28, s[20:23], s56 offen lds
s_add_u32 s56, s55, 76544
s_mov_b32 m0, 37888
s_nop 0
buffer_load_dwordx4 v28, s[20:23], s56 offen lds
s_add_u32 s56, s55, 83456
s_mov_b32 m0, 38912
s_nop 0
buffer_load_dwordx4 v28, s[20:23], s56 offen lds
s_add_u32 s56, s55, 85760
s_mov_b32 m0, 39936
s_nop 0
buffer_load_dwordx4 v28, s[20:23], s56 offen lds
ds_read_b64_tr_b16 a[96:97], v44 offset:24576
ds_read_b64_tr_b16 a[98:99], v44 offset:25600
ds_read_b64_tr_b16 a[100:101], v46 offset:24576
ds_read_b64_tr_b16 a[102:103], v46 offset:25600
ds_read_b64_tr_b16 a[104:105], v45 offset:24576
ds_read_b64_tr_b16 a[106:107], v45 offset:25600
ds_read_b64_tr_b16 a[108:109], v47 offset:24576
ds_read_b64_tr_b16 a[110:111], v47 offset:25600
s_waitcnt lgkmcnt(0)
s_waitcnt vmcnt(24)
s_barrier
s_add_u32 s56, s55, 74496
s_mov_b32 m0, 40960
s_nop 0
buffer_load_dwordx4 v28, s[20:23], s56 offen lds
s_add_u32 s56, s55, 76800
s_mov_b32 m0, 41984
s_nop 0
buffer_load_dwordx4 v28, s[20:23], s56 offen lds
s_add_u32 s56, s55, 83712
s_mov_b32 m0, 43008
s_nop 0
buffer_load_dwordx4 v28, s[20:23], s56 offen lds
s_add_u32 s56, s55, 86016
s_mov_b32 m0, 44032
s_nop 0
buffer_load_dwordx4 v28, s[20:23], s56 offen lds
ds_read_b64_tr_b16 a[112:113], v44 offset:28672
ds_read_b64_tr_b16 a[114:115], v44 offset:29696
ds_read_b64_tr_b16 a[116:117], v46 offset:28672
ds_read_b64_tr_b16 a[118:119], v46 offset:29696
ds_read_b64_tr_b16 a[120:121], v45 offset:28672
ds_read_b64_tr_b16 a[122:123], v45 offset:29696
ds_read_b64_tr_b16 a[124:125], v47 offset:28672
ds_read_b64_tr_b16 a[126:127], v47 offset:29696
s_waitcnt lgkmcnt(0)
s_waitcnt vmcnt(24)
s_barrier
s_add_u32 s56, s55, 0
s_mov_b32 m0, 45056
s_nop 0
buffer_load_dwordx4 v28, s[20:23], s56 offen lds
s_add_u32 s56, s55, 2304
s_mov_b32 m0, 46080
s_nop 0
buffer_load_dwordx4 v28, s[20:23], s56 offen lds
s_add_u32 s56, s55, 9216
s_mov_b32 m0, 47104
s_nop 0
buffer_load_dwordx4 v28, s[20:23], s56 offen lds
s_add_u32 s56, s55, 11520
s_mov_b32 m0, 48128
s_nop 0
buffer_load_dwordx4 v28, s[20:23], s56 offen lds
ds_read_b64_tr_b16 a[128:129], v44 offset:0
ds_read_b64_tr_b16 a[130:131], v44 offset:1024
ds_read_b64_tr_b16 a[132:133], v46 offset:0
ds_read_b64_tr_b16 a[134:135], v46 offset:1024
ds_read_b64_tr_b16 a[136:137], v45 offset:0
ds_read_b64_tr_b16 a[138:139], v45 offset:1024
ds_read_b64_tr_b16 a[140:141], v47 offset:0
ds_read_b64_tr_b16 a[142:143], v47 offset:1024
buffer_load_dword v32, v24, s[28:31], 0 offen sc0 sc1
s_waitcnt lgkmcnt(0)
s_waitcnt vmcnt(25)
s_barrier
s_add_u32 s56, s54, 0
s_mov_b32 m0, 16384
s_nop 0
buffer_load_dwordx4 v26, s[8:11], s56 offen lds
s_add_u32 s56, s54, 16384
s_mov_b32 m0, 17408
s_nop 0
buffer_load_dwordx4 v26, s[8:11], s56 offen lds
s_add_u32 s56, s54, 32768
s_mov_b32 m0, 18432
s_nop 0
buffer_load_dwordx4 v27, s[8:11], s56 offen lds
s_add_u32 s56, s54, 49152
s_mov_b32 m0, 19456
s_nop 0
buffer_load_dwordx4 v27, s[8:11], s56 offen lds
ds_read_b64_tr_b16 a[144:145], v44 offset:4096
ds_read_b64_tr_b16 a[146:147], v44 offset:5120
ds_read_b64_tr_b16 a[148:149], v46 offset:4096
ds_read_b64_tr_b16 a[150:151], v46 offset:5120
ds_read_b64_tr_b16 a[152:153], v45 offset:4096
ds_read_b64_tr_b16 a[154:155], v45 offset:5120
ds_read_b64_tr_b16 a[156:157], v47 offset:4096
ds_read_b64_tr_b16 a[158:159], v47 offset:5120
s_waitcnt lgkmcnt(0)
s_waitcnt vmcnt(25)
s_barrier
s_add_u32 s56, s54, 1572864
s_mov_b32 m0, 20480
s_nop 0
buffer_load_dwordx4 v26, s[8:11], s56 offen lds
s_add_u32 s56, s54, 1589248
s_mov_b32 m0, 21504
s_nop 0
buffer_load_dwordx4 v26, s[8:11], s56 offen lds
s_add_u32 s56, s54, 1605632
s_mov_b32 m0, 22528
s_nop 0
buffer_load_dwordx4 v27, s[8:11], s56 offen lds
s_add_u32 s56, s54, 1622016
s_mov_b32 m0, 23552
s_nop 0
buffer_load_dwordx4 v27, s[8:11], s56 offen lds
ds_read_b64_tr_b16 a[160:161], v44 offset:8192
ds_read_b64_tr_b16 a[162:163], v44 offset:9216
ds_read_b64_tr_b16 a[164:165], v46 offset:8192
ds_read_b64_tr_b16 a[166:167], v46 offset:9216
ds_read_b64_tr_b16 a[168:169], v45 offset:8192
ds_read_b64_tr_b16 a[170:171], v45 offset:9216
ds_read_b64_tr_b16 a[172:173], v47 offset:8192
ds_read_b64_tr_b16 a[174:175], v47 offset:9216
s_waitcnt lgkmcnt(0)
s_waitcnt vmcnt(25)
s_barrier
s_add_u32 s56, s54, 2097152
s_mov_b32 m0, 24576
s_nop 0
buffer_load_dwordx4 v26, s[8:11], s56 offen lds
s_add_u32 s56, s54, 2113536
s_mov_b32 m0, 25600
s_nop 0
buffer_load_dwordx4 v26, s[8:11], s56 offen lds
s_add_u32 s56, s54, 2129920
s_mov_b32 m0, 26624
s_nop 0
buffer_load_dwordx4 v27, s[8:11], s56 offen lds
s_add_u32 s56, s54, 2146304
s_mov_b32 m0, 27648
s_nop 0
buffer_load_dwordx4 v27, s[8:11], s56 offen lds
ds_read_b64_tr_b16 a[184:185], v48 offset:12288
ds_read_b64_tr_b16 a[186:187], v48 offset:13312
ds_read_b64_tr_b16 a[188:189], v48 offset:14336
ds_read_b64_tr_b16 a[190:191], v48 offset:15360
ds_read_b64_tr_b16 a[200:201], v49 offset:12288
ds_read_b64_tr_b16 a[202:203], v49 offset:13312
ds_read_b64_tr_b16 a[204:205], v49 offset:14336
ds_read_b64_tr_b16 a[206:207], v49 offset:15360
s_waitcnt lgkmcnt(0)
s_waitcnt vmcnt(25)
s_barrier
s_add_u32 s56, s54, 2621440
s_mov_b32 m0, 28672
s_nop 0
buffer_load_dwordx4 v26, s[12:15], s56 offen lds
s_add_u32 s56, s54, 2637824
s_mov_b32 m0, 29696
s_nop 0
buffer_load_dwordx4 v26, s[12:15], s56 offen lds
s_add_u32 s56, s54, 2654208
s_mov_b32 m0, 30720
s_nop 0
buffer_load_dwordx4 v27, s[12:15], s56 offen lds
s_add_u32 s56, s54, 2670592
s_mov_b32 m0, 31744
s_nop 0
buffer_load_dwordx4 v27, s[12:15], s56 offen lds
ds_read_b64_tr_b16 a[208:209], v48 offset:16384
ds_read_b64_tr_b16 a[210:211], v48 offset:17408
ds_read_b64_tr_b16 a[212:213], v48 offset:18432
ds_read_b64_tr_b16 a[214:215], v48 offset:19456
ds_read_b64_tr_b16 a[216:217], v49 offset:16384
ds_read_b64_tr_b16 a[218:219], v49 offset:17408
ds_read_b64_tr_b16 a[220:221], v49 offset:18432
ds_read_b64_tr_b16 a[222:223], v49 offset:19456
s_waitcnt lgkmcnt(0)
s_waitcnt vmcnt(25)
s_barrier
s_add_u32 s56, s54, 4194304
s_mov_b32 m0, 32768
s_nop 0
buffer_load_dwordx4 v26, s[16:19], s56 offen lds
s_add_u32 s56, s54, 4210688
s_mov_b32 m0, 33792
s_nop 0
buffer_load_dwordx4 v26, s[16:19], s56 offen lds
s_add_u32 s56, s54, 4227072
s_mov_b32 m0, 34816
s_nop 0
buffer_load_dwordx4 v27, s[16:19], s56 offen lds
s_add_u32 s56, s54, 4243456
s_mov_b32 m0, 35840
s_nop 0
buffer_load_dwordx4 v27, s[16:19], s56 offen lds
ds_read_b64_tr_b16 a[224:225], v48 offset:20480
ds_read_b64_tr_b16 a[226:227], v48 offset:21504
ds_read_b64_tr_b16 a[228:229], v48 offset:22528
ds_read_b64_tr_b16 a[230:231], v48 offset:23552
ds_read_b64_tr_b16 a[232:233], v49 offset:20480
ds_read_b64_tr_b16 a[234:235], v49 offset:21504
ds_read_b64_tr_b16 a[236:237], v49 offset:22528
ds_read_b64_tr_b16 a[238:239], v49 offset:23552
s_waitcnt lgkmcnt(0)
s_waitcnt vmcnt(25)
s_barrier
s_add_u32 s56, s55, 256
s_mov_b32 m0, 36864
s_nop 0
buffer_load_dwordx4 v28, s[20:23], s56 offen lds
s_add_u32 s56, s55, 2560
s_mov_b32 m0, 37888
s_nop 0
buffer_load_dwordx4 v28, s[20:23], s56 offen lds
s_add_u32 s56, s55, 9472
s_mov_b32 m0, 38912
s_nop 0
buffer_load_dwordx4 v28, s[20:23], s56 offen lds
s_add_u32 s56, s55, 11776
s_mov_b32 m0, 39936
s_nop 0
buffer_load_dwordx4 v28, s[20:23], s56 offen lds
ds_read_b64_tr_b16 a[240:241], v48 offset:24576
ds_read_b64_tr_b16 a[242:243], v48 offset:25600
ds_read_b64_tr_b16 a[244:245], v48 offset:26624
ds_read_b64_tr_b16 a[246:247], v48 offset:27648
ds_read_b64_tr_b16 a[248:249], v49 offset:24576
ds_read_b64_tr_b16 a[250:251], v49 offset:25600
ds_read_b64_tr_b16 a[252:253], v49 offset:26624
ds_read_b64_tr_b16 a[254:255], v49 offset:27648
s_waitcnt lgkmcnt(0)
s_waitcnt vmcnt(25)
s_barrier
s_add_u32 s56, s55, 512
s_mov_b32 m0, 40960
s_nop 0
buffer_load_dwordx4 v28, s[20:23], s56 offen lds
s_add_u32 s56, s55, 2816
s_mov_b32 m0, 41984
s_nop 0
buffer_load_dwordx4 v28, s[20:23], s56 offen lds
s_add_u32 s56, s55, 9728
s_mov_b32 m0, 43008
s_nop 0
buffer_load_dwordx4 v28, s[20:23], s56 offen lds
s_add_u32 s56, s55, 12032
s_mov_b32 m0, 44032
s_nop 0
buffer_load_dwordx4 v28, s[20:23], s56 offen lds
ds_read_b64_tr_b16 a[176:177], v48 offset:28672
ds_read_b64_tr_b16 a[178:179], v48 offset:29696
ds_read_b64_tr_b16 a[180:181], v48 offset:30720
ds_read_b64_tr_b16 a[182:183], v48 offset:31744
ds_read_b64_tr_b16 a[192:193], v49 offset:28672
ds_read_b64_tr_b16 a[194:195], v49 offset:29696
ds_read_b64_tr_b16 a[196:197], v49 offset:30720
ds_read_b64_tr_b16 a[198:199], v49 offset:31744
s_waitcnt lgkmcnt(0)
s_waitcnt vmcnt(24)
s_barrier
s_add_u32 s56, s55, 768
s_mov_b32 m0, 45056
s_nop 0
buffer_load_dwordx4 v28, s[20:23], s56 offen lds
s_add_u32 s56, s55, 3072
s_mov_b32 m0, 46080
s_nop 0
buffer_load_dwordx4 v28, s[20:23], s56 offen lds
s_add_u32 s56, s55, 9984
s_mov_b32 m0, 47104
s_nop 0
buffer_load_dwordx4 v28, s[20:23], s56 offen lds
s_add_u32 s56, s55, 12288
s_mov_b32 m0, 48128
s_nop 0
buffer_load_dwordx4 v28, s[20:23], s56 offen lds
ds_read_b64_tr_b16 v[60:61], v44 offset:0
ds_read_b64_tr_b16 v[62:63], v44 offset:1024
ds_read_b64_tr_b16 v[64:65], v46 offset:0
ds_read_b64_tr_b16 v[66:67], v46 offset:1024
ds_read_b64_tr_b16 v[68:69], v45 offset:0
ds_read_b64_tr_b16 v[70:71], v45 offset:1024
ds_read_b64_tr_b16 v[72:73], v47 offset:0
ds_read_b64_tr_b16 v[74:75], v47 offset:1024
s_waitcnt lgkmcnt(0)
s_waitcnt vmcnt(24)
s_barrier
ds_write_b128 v2, v[60:63] offset:0
ds_write_b128 v2, v[64:67] offset:1024
ds_write_b128 v2, v[68:71] offset:2048
ds_write_b128 v2, v[72:75] offset:3072
ds_read_b64_tr_b16 v[60:61], v44 offset:4096
ds_read_b64_tr_b16 v[62:63], v44 offset:5120
ds_read_b64_tr_b16 v[64:65], v46 offset:4096
ds_read_b64_tr_b16 v[66:67], v46 offset:5120
ds_read_b64_tr_b16 v[68:69], v45 offset:4096
ds_read_b64_tr_b16 v[70:71], v45 offset:5120
ds_read_b64_tr_b16 v[72:73], v47 offset:4096
ds_read_b64_tr_b16 v[74:75], v47 offset:5120
L_rdv_w0:
v_readfirstlane_b32 s38, v32
s_nop 0
s_and_b32 s57, s38, 0xff
s_cmp_lg_u32 s57, 32
s_cbranch_scc1 L_rdv2_w0
s_waitcnt lgkmcnt(0)
s_waitcnt vmcnt(20)
s_barrier
ds_write_b128 v2, v[60:63] offset:4096
ds_write_b128 v2, v[64:67] offset:5120
ds_write_b128 v2, v[68:71] offset:6144
ds_write_b128 v2, v[72:75] offset:7168
ds_read_b64_tr_b16 v[60:61], v44 offset:8192
ds_read_b64_tr_b16 v[62:63], v44 offset:9216
ds_read_b64_tr_b16 v[64:65], v46 offset:8192
ds_read_b64_tr_b16 v[66:67], v46 offset:9216
ds_read_b64_tr_b16 v[68:69], v45 offset:8192
ds_read_b64_tr_b16 v[70:71], v45 offset:9216
ds_read_b64_tr_b16 v[72:73], v47 offset:8192
ds_read_b64_tr_b16 v[74:75], v47 offset:9216
buffer_load_dwordx4 v[12:15], v9, s[4:7], s37 offen offset:0
buffer_load_dwordx4 v[16:19], v9, s[4:7], s37 offen offset:1024
buffer_load_dwordx4 v[52:55], v1, s[4:7], s37 offen offset:2048
buffer_load_dwordx4 v[56:59], v1, s[4:7], s37 offen offset:3072
s_mov_b32 m0, 1024
s_nop 0
buffer_load_dwordx4 v1, s[4:7], s47 offen offset:0 sc1 lds
s_waitcnt lgkmcnt(0)
s_waitcnt vmcnt(21)
s_barrier
ds_write_b128 v2, v[60:63] offset:8192
ds_write_b128 v2, v[64:67] offset:9216
ds_write_b128 v2, v[68:71] offset:10240
ds_write_b128 v2, v[72:75] offset:11264
ds_read_b64_tr_b16 v[60:61], v44 offset:12288
ds_read_b64_tr_b16 v[62:63], v44 offset:13312
ds_read_b64_tr_b16 v[64:65], v46 offset:12288
ds_read_b64_tr_b16 v[66:67], v46 offset:13312
ds_read_b64_tr_b16 v[68:69], v45 offset:12288
ds_read_b64_tr_b16 v[70:71], v45 offset:13312
ds_read_b64_tr_b16 v[72:73], v47 offset:12288
ds_read_b64_tr_b16 v[74:75], v47 offset:13312
s_waitcnt lgkmcnt(0)
s_waitcnt vmcnt(17)
s_barrier
ds_write_b128 v2, v[60:63] offset:12288
ds_write_b128 v2, v[64:67] offset:13312
ds_write_b128 v2, v[68:71] offset:14336
ds_write_b128 v2, v[72:75] offset:15360
ds_read_b64_tr_b16 v[60:61], v44 offset:16384
ds_read_b64_tr_b16 v[62:63], v44 offset:17408
ds_read_b64_tr_b16 v[64:65], v46 offset:16384
ds_read_b64_tr_b16 v[66:67], v46 offset:17408
ds_read_b64_tr_b16 v[68:69], v45 offset:16384
ds_read_b64_tr_b16 v[70:71], v45 offset:17408
ds_read_b64_tr_b16 v[72:73], v47 offset:16384
ds_read_b64_tr_b16 v[74:75], v47 offset:17408
s_waitcnt lgkmcnt(0)
s_waitcnt vmcnt(13)
s_barrier
ds_write_b128 v2, v[60:63] offset:16384
ds_write_b128 v2, v[64:67] offset:17408
ds_write_b128 v2, v[68:71] offset:18432
ds_write_b128 v2, v[72:75] offset:19456
ds_read_b64_tr_b16 v[60:61], v48 offset:20480
ds_read_b64_tr_b16 v[62:63], v48 offset:21504
ds_read_b64_tr_b16 v[64:65], v48 offset:22528
ds_read_b64_tr_b16 v[66:67], v48 offset:23552
ds_read_b64_tr_b16 v[68:69], v49 offset:20480
ds_read_b64_tr_b16 v[70:71], v49 offset:21504
ds_read_b64_tr_b16 v[72:73], v49 offset:22528
ds_read_b64_tr_b16 v[74:75], v49 offset:23552
s_waitcnt lgkmcnt(0)
s_waitcnt vmcnt(9)
s_barrier
ds_write_b128 v2, v[60:63] offset:20480
ds_write_b128 v2, v[64:67] offset:21504
ds_write_b128 v2, v[68:71] offset:22528
ds_write_b128 v2, v[72:75] offset:23552
ds_read_b64_tr_b16 v[60:61], v48 offset:24576
ds_read_b64_tr_b16 v[62:63], v48 offset:25600
ds_read_b64_tr_b16 v[64:65], v48 offset:26624
ds_read_b64_tr_b16 v[66:67], v48 offset:27648
ds_read_b64_tr_b16 v[68:69], v49 offset:24576
ds_read_b64_tr_b16 v[70:71], v49 offset:25600
ds_read_b64_tr_b16 v[72:73], v49 offset:26624
ds_read_b64_tr_b16 v[74:75], v49 offset:27648
s_waitcnt lgkmcnt(0)
s_waitcnt vmcnt(5)
s_barrier
ds_write_b128 v2, v[60:63] offset:24576
ds_write_b128 v2, v[64:67] offset:25600
ds_write_b128 v2, v[68:71] offset:26624
ds_write_b128 v2, v[72:75] offset:27648
ds_read_b64_tr_b16 v[60:61], v48 offset:28672
ds_read_b64_tr_b16 v[62:63], v48 offset:29696
ds_read_b64_tr_b16 v[64:65], v48 offset:30720
ds_read_b64_tr_b16 v[66:67], v48 offset:31744
ds_read_b64_tr_b16 v[68:69], v49 offset:28672
ds_read_b64_tr_b16 v[70:71], v49 offset:29696
ds_read_b64_tr_b16 v[72:73], v49 offset:30720
ds_read_b64_tr_b16 v[74:75], v49 offset:31744
s_waitcnt lgkmcnt(0)
s_barrier
ds_write_b128 v2, v[60:63] offset:28672
ds_write_b128 v2, v[64:67] offset:29696
ds_write_b128 v2, v[68:71] offset:30720
ds_write_b128 v2, v[72:75] offset:31744
s_lshl_b32 s57, s58, 5
s_mov_b32 s0, 0x3f003f00
s_mov_b32 s1, 0x3f003f00
s_mov_b32 s58, 304128
s_cmp_eq_u32 s38, s57
s_mov_b32 s56, 0x33333333
s_mov_b32 s57, 0x33333333
s_mov_b32 s2, 0x21800000
s_mov_b32 s55, -24
s_cbranch_scc0 L_slow_w0
v_mov_b64 v[20:21], 0
v_mov_b64 v[22:23], 0
v_mov_b64 v[24:25], 0
v_mov_b64 v[26:27], 0
v_mov_b64 v[28:29], 0
v_mov_b64 v[30:31], 0
v_mov_b64 v[32:33], 0
v_mov_b64 v[34:35], 0
v_mov_b64 v[36:37], 0
v_mov_b64 v[38:39], 0
v_mov_b64 v[40:41], 0
v_mov_b64 v[42:43], 0
ds_read_b128 v[44:47], v2 offset:0
ds_read_b128 v[48:51], v2 offset:1024
v_bfe_u32 v77, v1, 6, 1
v_lshl_add_u32 v77, v77, 3, v1
v_lshlrev_b32 v77, 1, v77
s_waitcnt vmcnt(0) lgkmcnt(0)
s_branch L_top_w0f
L_done_w0f:
s_waitcnt vmcnt(0) lgkmcnt(0)
s_endpgm
L_rdv2_w0:
buffer_load_dword v32, v24, s[28:31], 0 offen sc0 sc1
s_sub_u32 s41, s41, 1
s_cbranch_scc1 L_exit
s_waitcnt vmcnt(0)
s_branch L_rdv_w0
L_ra0_w0f:
s_mov_b32 m0, 1024
s_nop 0
buffer_load_dwordx4 v1, s[4:7], s47 offen offset:0 sc1 lds
buffer_load_dwordx4 v1, s[4:7], s47 offen offset:1024 sc1 lds
buffer_load_dwordx4 v1, s[4:7], s47 offen offset:2048 sc1 lds
buffer_load_dwordx4 v1, s[4:7], s47 offen offset:3072 sc1 lds
s_sub_u32 s41, s41, 1
s_cbranch_scc1 L_exit
ds_read_b128 v[44:47], v2 offset:0
ds_read_b128 v[48:51], v2 offset:1024
v_mov_b64 v[20:21], 0
v_mov_b64 v[22:23], 0
v_mov_b64 v[24:25], 0
v_mov_b64 v[26:27], 0
v_mov_b64 v[28:29], 0
v_mov_b64 v[30:31], 0
v_mov_b64 v[32:33], 0
v_mov_b64 v[34:35], 0
v_mov_b64 v[36:37], 0
v_mov_b64 v[38:39], 0
v_mov_b64 v[40:41], 0
v_mov_b64 v[42:43], 0
s_waitcnt vmcnt(0)
ds_read_b128 v[60:63], v1 offset:1024
ds_read_b128 v[64:67], v1 offset:2048
ds_read_b128 v[68:71], v1 offset:3072
ds_read_b128 v[72:75], v1 offset:4096
s_branch L_s0_w0f
L_ra1_w0f:
L_ra2_w0f:
s_waitcnt lgkmcnt(0)
s_barrier
s_mov_b32 m0, 5120
s_nop 0
buffer_load_dwordx4 v1, s[4:7], s48 offen offset:0 sc1 lds
s_mov_b32 m0, 9216
s_nop 0
buffer_load_dwordx4 v1, s[4:7], s49 offen offset:0 sc1 lds
s_sub_u32 s41, s41, 1
s_cbranch_scc1 L_exit
s_waitcnt vmcnt(0)
s_barrier
ds_read_b128 v[76:79], v1 offset:5120
ds_read_b128 v[60:63], v1 offset:6144
ds_read_b128 v[64:67], v1 offset:7168
ds_read_b128 v[68:71], v1 offset:8192
ds_read_b128 v[72:75], v1 offset:9216
s_waitcnt lgkmcnt(0)
v_bitop3_b32 v6, v76, v60, s35 bitop3:0x7e
v_bitop3_b32 v6, v6, v64, s35 bitop3:0xf6
v_bitop3_b32 v6, v6, v68, s35 bitop3:0xf6
v_bitop3_b32 v6, v6, v72, s35 bitop3:0xf6
v_and_b32 v6, 1, v6
v_cmp_ne_u32 vcc, 0, v6
s_mov_b32 m0, 0
v_lshlrev_b32 v6, 3, v1
s_cbranch_vccnz L_ra2_w0f
s_branch L_a1_w0f
L_mx_w0f:
s_waitcnt lgkmcnt(0)
v_max3_f32 v30, v12, v13, v28
v_max_f32 v30, v30, v29
v_mov_b32 v31, v30
s_nop 1
v_permlane16_swap_b32 v30, v31
v_max_f32 v30, v30, v31
v_mov_b32 v31, v30
s_nop 1
v_permlane32_swap_b32 v30, v31
v_max_f32 v30, v30, v31
ds_write_b32 v1, v30 offset:10240
s_waitcnt lgkmcnt(0)
s_barrier
ds_read_b128 v[32:35], v1 offset:10240
s_waitcnt lgkmcnt(0)
v_max3_f32 v32, v32, v33, v34
v_max_f32 v32, v32, v35
v_sub_f32 v14, v12, v32
v_sub_f32 v15, v13, v32
v_sub_f32 v30, v28, v32
v_sub_f32 v31, v29, v32
v_exp_f32 v14, v14
v_exp_f32 v15, v15
v_exp_f32 v30, v30
v_exp_f32 v31, v31
v_cvt_pk_bf16_f32 v14, v14, v15
v_cvt_pk_bf16_f32 v30, v30, v31
ds_write_b32 v5, v14 offset:14368
v_cndmask_b32_e64 v26, 0, v30, s[56:57]
v_cndmask_b32_e64 v27, 0, v30, s[56:57]
v_mov_b64 v[76:77], s[52:53]
v_mov_b64 v[78:79], s[52:53]
v_mov_b32_dpp v24, v26 quad_perm:[2,3,0,1] row_mask:0xf bank_mask:0xf
v_mov_b32_dpp v25, v26 quad_perm:[2,3,0,1] row_mask:0xf bank_mask:0xf
s_waitcnt lgkmcnt(0)
s_barrier
v_mov_b64 v[14:15], s[0:1]
ds_read_b128 v[16:19], v1 offset:14368
ds_read_b128 v[36:39], v1 offset:14336
s_waitcnt lgkmcnt(0)
v_mfma_f32_16x16x32_bf16 v[32:35], v[76:79], v[16:19], 0
v_mfma_f32_16x16x32_bf16 v[20:23], v[52:55], v[16:19], 0
v_mfma_f32_16x16x32_bf16 v[20:23], v[56:59], v[36:39], v[20:23]
v_mfma_f32_16x16x16_bf16 v[32:35], v[14:15], v[26:27], v[32:35]
v_mfma_f32_16x16x32_bf16 v[20:23], v[40:43], v[24:27], v[20:23]
s_nop 3
v_rcp_f32 v33, v32
s_nop 2
v_mul_f32_dpp v20, v33, v20 quad_perm:[0,1,0,1] row_mask:0xf bank_mask:0xf
v_mul_f32_dpp v21, v33, v21 quad_perm:[0,1,0,1] row_mask:0xf bank_mask:0xf
v_mul_f32_dpp v22, v33, v22 quad_perm:[0,1,0,1] row_mask:0xf bank_mask:0xf
v_mul_f32_dpp v23, v33, v23 quad_perm:[0,1,0,1] row_mask:0xf bank_mask:0xf
v_cvt_pk_bf16_f32 v20, v20, v21
v_cvt_pk_bf16_f32 v21, v22, v23
ds_write_b64 v6, v[20:21] offset:5120
v_mov_b32_dpp v16, v20 quad_perm:[0,1,0,1] row_mask:0xf bank_mask:0xf
v_mov_b32_dpp v17, v21 quad_perm:[0,1,0,1] row_mask:0xf bank_mask:0xf
v_mov_b32_dpp v18, v20 quad_perm:[2,3,2,3] row_mask:0xf bank_mask:0xf
v_mov_b32_dpp v19, v21 quad_perm:[2,3,2,3] row_mask:0xf bank_mask:0xf
v_mov_b64 v[76:77], 0
v_mov_b64 v[78:79], 0
v_mov_b64 v[36:37], 0
v_mov_b64 v[38:39], 0
v_mov_b64 v[24:25], 0
v_mov_b64 v[26:27], 0
v_mov_b64 v[32:33], 0
v_mov_b64 v[34:35], 0
s_waitcnt lgkmcnt(0)
s_branch L_mxb_w0f

L_slow_w0:
v_mov_b64 v[20:21], 0
v_mov_b64 v[22:23], 0
v_mov_b64 v[24:25], 0
v_mov_b64 v[26:27], 0
v_mov_b64 v[28:29], 0
v_mov_b64 v[30:31], 0
v_mov_b64 v[32:33], 0
v_mov_b64 v[34:35], 0
v_mov_b64 v[36:37], 0
v_mov_b64 v[38:39], 0
v_mov_b64 v[40:41], 0
v_mov_b64 v[42:43], 0
ds_read_b128 v[44:47], v2 offset:0
ds_read_b128 v[48:51], v2 offset:1024
v_bfe_u32 v77, v1, 6, 1
v_lshl_add_u32 v77, v77, 3, v1
v_lshlrev_b32 v77, 1, v77
s_waitcnt vmcnt(0) lgkmcnt(0)
s_branch L_top_w0s
L_done_w0s:
s_waitcnt vmcnt(0) lgkmcnt(0)
s_endpgm
L_ra0_w0s:
s_mov_b32 m0, 1024
s_nop 0
buffer_load_dwordx4 v1, s[4:7], s47 offen offset:0 sc0 sc1 lds
buffer_load_dwordx4 v1, s[4:7], s47 offen offset:1024 sc0 sc1 lds
buffer_load_dwordx4 v1, s[4:7], s47 offen offset:2048 sc0 sc1 lds
buffer_load_dwordx4 v1, s[4:7], s47 offen offset:3072 sc0 sc1 lds
s_sub_u32 s41, s41, 1
s_cbranch_scc1 L_exit
ds_read_b128 v[44:47], v2 offset:0
ds_read_b128 v[48:51], v2 offset:1024
v_mov_b64 v[20:21], 0
v_mov_b64 v[22:23], 0
v_mov_b64 v[24:25], 0
v_mov_b64 v[26:27], 0
v_mov_b64 v[28:29], 0
v_mov_b64 v[30:31], 0
v_mov_b64 v[32:33], 0
v_mov_b64 v[34:35], 0
v_mov_b64 v[36:37], 0
v_mov_b64 v[38:39], 0
v_mov_b64 v[40:41], 0
v_mov_b64 v[42:43], 0
s_waitcnt vmcnt(0)
ds_read_b128 v[60:63], v1 offset:1024
ds_read_b128 v[64:67], v1 offset:2048
ds_read_b128 v[68:71], v1 offset:3072
ds_read_b128 v[72:75], v1 offset:4096
s_branch L_s0_w0s
L_ra1_w0s:
L_ra2_w0s:
s_waitcnt lgkmcnt(0)
s_barrier
s_mov_b32 m0, 5120
s_nop 0
buffer_load_dwordx4 v1, s[4:7], s48 offen offset:0 sc0 sc1 lds
s_mov_b32 m0, 9216
s_nop 0
buffer_load_dwordx4 v1, s[4:7], s49 offen offset:0 sc0 sc1 lds
s_sub_u32 s41, s41, 1
s_cbranch_scc1 L_exit
s_waitcnt vmcnt(0)
s_barrier
ds_read_b128 v[76:79], v1 offset:5120
ds_read_b128 v[60:63], v1 offset:6144
ds_read_b128 v[64:67], v1 offset:7168
ds_read_b128 v[68:71], v1 offset:8192
ds_read_b128 v[72:75], v1 offset:9216
s_waitcnt lgkmcnt(0)
v_bitop3_b32 v6, v76, v60, s35 bitop3:0x7e
v_bitop3_b32 v6, v6, v64, s35 bitop3:0xf6
v_bitop3_b32 v6, v6, v68, s35 bitop3:0xf6
v_bitop3_b32 v6, v6, v72, s35 bitop3:0xf6
v_and_b32 v6, 1, v6
v_cmp_ne_u32 vcc, 0, v6
s_mov_b32 m0, 0
v_lshlrev_b32 v6, 3, v1
s_cbranch_vccnz L_ra2_w0s
s_branch L_a1_w0s
L_mx_w0s:
s_waitcnt lgkmcnt(0)
v_max3_f32 v30, v12, v13, v28
v_max_f32 v30, v30, v29
v_mov_b32 v31, v30
s_nop 1
v_permlane16_swap_b32 v30, v31
v_max_f32 v30, v30, v31
v_mov_b32 v31, v30
s_nop 1
v_permlane32_swap_b32 v30, v31
v_max_f32 v30, v30, v31
ds_write_b32 v1, v30 offset:10240
s_waitcnt lgkmcnt(0)
s_barrier
ds_read_b128 v[32:35], v1 offset:10240
s_waitcnt lgkmcnt(0)
v_max3_f32 v32, v32, v33, v34
v_max_f32 v32, v32, v35
v_sub_f32 v14, v12, v32
v_sub_f32 v15, v13, v32
v_sub_f32 v30, v28, v32
v_sub_f32 v31, v29, v32
v_exp_f32 v14, v14
v_exp_f32 v15, v15
v_exp_f32 v30, v30
v_exp_f32 v31, v31
v_cvt_pk_bf16_f32 v14, v14, v15
v_cvt_pk_bf16_f32 v30, v30, v31
ds_write_b32 v5, v14 offset:14368
v_cndmask_b32_e64 v26, 0, v30, s[56:57]
v_cndmask_b32_e64 v27, 0, v30, s[56:57]
v_mov_b64 v[76:77], s[52:53]
v_mov_b64 v[78:79], s[52:53]
v_mov_b32_dpp v24, v26 quad_perm:[2,3,0,1] row_mask:0xf bank_mask:0xf
v_mov_b32_dpp v25, v26 quad_perm:[2,3,0,1] row_mask:0xf bank_mask:0xf
s_waitcnt lgkmcnt(0)
s_barrier
v_mov_b64 v[14:15], s[0:1]
ds_read_b128 v[16:19], v1 offset:14368
ds_read_b128 v[36:39], v1 offset:14336
s_waitcnt lgkmcnt(0)
v_mfma_f32_16x16x32_bf16 v[32:35], v[76:79], v[16:19], 0
v_mfma_f32_16x16x32_bf16 v[20:23], v[52:55], v[16:19], 0
v_mfma_f32_16x16x32_bf16 v[20:23], v[56:59], v[36:39], v[20:23]
v_mfma_f32_16x16x16_bf16 v[32:35], v[14:15], v[26:27], v[32:35]
v_mfma_f32_16x16x32_bf16 v[20:23], v[40:43], v[24:27], v[20:23]
s_nop 3
v_rcp_f32 v33, v32
s_nop 2
v_mul_f32_dpp v20, v33, v20 quad_perm:[0,1,0,1] row_mask:0xf bank_mask:0xf
v_mul_f32_dpp v21, v33, v21 quad_perm:[0,1,0,1] row_mask:0xf bank_mask:0xf
v_mul_f32_dpp v22, v33, v22 quad_perm:[0,1,0,1] row_mask:0xf bank_mask:0xf
v_mul_f32_dpp v23, v33, v23 quad_perm:[0,1,0,1] row_mask:0xf bank_mask:0xf
v_cvt_pk_bf16_f32 v20, v20, v21
v_cvt_pk_bf16_f32 v21, v22, v23
ds_write_b64 v6, v[20:21] offset:5120
v_mov_b32_dpp v16, v20 quad_perm:[0,1,0,1] row_mask:0xf bank_mask:0xf
v_mov_b32_dpp v17, v21 quad_perm:[0,1,0,1] row_mask:0xf bank_mask:0xf
v_mov_b32_dpp v18, v20 quad_perm:[2,3,2,3] row_mask:0xf bank_mask:0xf
v_mov_b32_dpp v19, v21 quad_perm:[2,3,2,3] row_mask:0xf bank_mask:0xf
v_mov_b64 v[76:77], 0
v_mov_b64 v[78:79], 0
v_mov_b64 v[36:37], 0
v_mov_b64 v[38:39], 0
v_mov_b64 v[24:25], 0
v_mov_b64 v[26:27], 0
v_mov_b64 v[32:33], 0
v_mov_b64 v[34:35], 0
s_waitcnt lgkmcnt(0)
s_branch L_mxb_w0s

L_pro_w0r:
v_and_b32 v20, 63, v0
v_lshlrev_b32 v1, 4, v20
v_add_u32 v2, 16384, v1
v_and_b32 v23, 1, v22
v_lshl_add_u32 v23, v24, 4, v23
v_mul_u32_u24 v23, 1152, v23
v_lshlrev_b32 v28, 2, v22
v_xor_b32 v28, v28, v21
v_lshl_add_u32 v28, v28, 4, v23
s_mul_i32 s55, s32, 147456
v_lshrrev_b32 v23, 2, v21
v_and_b32 v24, 1, v21
v_lshl_add_u32 v23, v23, 1, v24
v_mul_u32_u24 v23, 1152, v23
v_lshl_add_u32 v23, v22, 5, v23
v_bfe_u32 v24, v21, 1, 1
v_lshl_add_u32 v23, v24, 4, v23
s_lshl_b32 s56, s32, 7
s_waitcnt lgkmcnt(0)
buffer_load_dwordx4 v[12:15], v23, s[24:27], s56 offen
v_and_b32 v23, 1, v22
v_lshrrev_b32 v24, 2, v21
v_lshl_add_u32 v23, v23, 2, v24
v_lshlrev_b32 v23, 1, v23
v_bfe_u32 v44, v21, 1, 1
v_add_u32 v44, 0, v44
v_xor_b32 v44, v44, v23
v_lshlrev_b32 v44, 4, v44
v_lshl_add_u32 v44, v24, 8, v44
v_and_b32 v23, 1, v22
v_lshl_add_u32 v44, v23, 11, v44
v_and_b32 v23, 1, v21
v_lshl_add_u32 v44, v23, 3, v44
v_lshrrev_b32 v23, 1, v22
v_mul_u32_u24 v23, 40960, v23
v_add_u32 v23, 16384, v23
v_add_u32 v44, v44, v23
v_and_b32 v23, 1, v22
v_lshrrev_b32 v24, 2, v21
v_lshl_add_u32 v23, v23, 2, v24
v_lshlrev_b32 v23, 1, v23
v_bfe_u32 v45, v21, 1, 1
v_add_u32 v45, 2, v45
v_xor_b32 v45, v45, v23
v_lshlrev_b32 v45, 4, v45
v_lshl_add_u32 v45, v24, 8, v45
v_and_b32 v23, 1, v22
v_lshl_add_u32 v45, v23, 11, v45
v_and_b32 v23, 1, v21
v_lshl_add_u32 v45, v23, 3, v45
v_lshrrev_b32 v23, 1, v22
v_mul_u32_u24 v23, 40960, v23
v_add_u32 v23, 16384, v23
v_add_u32 v45, v45, v23
v_and_b32 v23, 1, v22
v_lshrrev_b32 v24, 2, v21
v_lshl_add_u32 v23, v23, 2, v24
v_lshlrev_b32 v23, 1, v23
v_bfe_u32 v46, v21, 1, 1
v_add_u32 v46, 0, v46
v_xor_b32 v46, v46, v23
v_lshlrev_b32 v46, 4, v46
v_lshl_add_u32 v46, v24, 8, v46
v_and_b32 v23, 1, v22
v_lshl_add_u32 v46, v23, 11, v46
v_and_b32 v23, 1, v21
v_lshl_add_u32 v46, v23, 3, v46
v_lshrrev_b32 v23, 1, v22
v_mul_u32_u24 v23, 32768, v23
v_add_u32 v23, 98304, v23
v_add_u32 v46, v46, v23
v_and_b32 v23, 1, v22
v_lshrrev_b32 v24, 2, v21
v_lshl_add_u32 v23, v23, 2, v24
v_lshlrev_b32 v23, 1, v23
v_bfe_u32 v47, v21, 1, 1
v_add_u32 v47, 2, v47
v_xor_b32 v47, v47, v23
v_lshlrev_b32 v47, 4, v47
v_lshl_add_u32 v47, v24, 8, v47
v_and_b32 v23, 1, v22
v_lshl_add_u32 v47, v23, 11, v47
v_and_b32 v23, 1, v21
v_lshl_add_u32 v47, v23, 3, v47
v_lshrrev_b32 v23, 1, v22
v_mul_u32_u24 v23, 32768, v23
v_add_u32 v23, 98304, v23
v_add_u32 v47, v47, v23
v_and_b32 v23, 1, v22
v_bfe_u32 v24, v21, 2, 1
v_lshl_add_u32 v23, v23, 1, v24
v_xor_b32 v24, 0, v23
v_lshlrev_b32 v24, 6, v24
v_lshl_add_u32 v48, v23, 8, v24
v_and_b32 v23, 3, v21
v_lshl_add_u32 v48, v23, 4, v48
v_and_b32 v23, 8, v21
v_add_u32 v48, v48, v23
v_lshrrev_b32 v23, 1, v22
v_mul_u32_u24 v23, 40960, v23
v_add_u32 v23, 16384, v23
v_add_u32 v48, v48, v23
v_and_b32 v23, 1, v22
v_bfe_u32 v24, v21, 2, 1
v_lshl_add_u32 v23, v23, 1, v24
v_xor_b32 v24, 0, v23
v_lshlrev_b32 v24, 6, v24
v_lshl_add_u32 v49, v23, 8, v24
v_and_b32 v23, 3, v21
v_lshl_add_u32 v49, v23, 4, v49
v_and_b32 v23, 8, v21
v_add_u32 v49, v49, v23
v_lshrrev_b32 v23, 1, v22
v_mul_u32_u24 v23, 32768, v23
v_add_u32 v23, 98304, v23
v_add_u32 v49, v49, v23
v_bfe_u32 v23, v21, 1, 1
v_mul_u32_u24 v23, 0xaaaa, v23
v_add_u32 v0, 0x4444, v23
v_lshlrev_b32 v3, 3, v20
v_lshrrev_b32 v25, 5, v20
v_lshlrev_b32 v25, 6, v25
v_xor_b32 v3, v3, v25
v_lshrrev_b32 v25, 2, v20
v_and_b32 v4, 3, v21
v_lshl_add_u32 v4, v4, 4, v25
v_lshlrev_b32 v4, 3, v4
v_bfe_u32 v25, v21, 1, 1
v_lshlrev_b32 v23, 6, v25
v_xor_b32 v4, v4, v23
v_lshlrev_b32 v5, 4, v21
v_lshl_add_u32 v5, v22, 2, v5
v_mul_u32_u24 v23, 1024, v25
v_add_u32 v5, v5, v23
v_lshlrev_b32 v9, 8, v22
v_lshl_add_u32 v9, v25, 6, v9
v_bfe_u32 v23, v21, 3, 1
v_lshl_add_u32 v9, v23, 7, v9
v_bfe_u32 v23, v21, 2, 1
v_lshl_add_u32 v9, v23, 5, v9
v_and_b32 v23, 1, v21
v_lshl_add_u32 v9, v23, 4, v9
v_lshrrev_b32 v23, 1, v22
v_and_b32 v24, 1, v22
v_and_b32 v25, 7, v21
v_lshrrev_b32 v7, 3, v21
v_lshl_add_u32 v8, v7, 1, v23
v_lshlrev_b32 v8, 12, v8
v_lshl_add_u32 v8, v24, 7, v8
v_and_b32 v25, 4, v21
v_lshl_add_u32 v8, v25, 3, v8
v_and_b32 v25, 1, v21
v_lshl_add_u32 v8, v25, 4, v8
v_bfe_u32 v25, v21, 1, 1
v_lshl_add_u32 v8, v25, 3, v8
s_lshr_b32 s56, s32, 1
s_lshl_b32 s56, s56, 8
s_and_b32 s57, s32, 1
s_lshl_b32 s57, s57, 6
s_add_u32 s56, s56, s57
s_add_u32 s56, s56, 0
v_add_u32 v8, s56, v8
v_and_b32 v7, 0x3d0, v1
s_mov_b32 s42, 0
s_mov_b32 s43, 65536
s_mov_b32 s44, 131072
s_mov_b32 s45, 196608
s_mov_b32 s46, 262144
s_mov_b32 s47, 294912
s_mov_b32 s48, 299008
s_mov_b32 s49, 303104
s_mov_b32 s50, 0x3e0293ee
s_mov_b32 s51, 0x3e0293ee
s_mov_b32 s52, 0x3f803f80
s_mov_b32 s53, 0x3f803f80
v_and_b32 v11, 3, v21
v_cmp_eq_u32 vcc, 0, v11
s_nop 1
v_cndmask_b32 v11, 0, 1, vcc
s_mov_b32 s34, 0
s_mov_b32 s35, -1
s_mov_b32 s36, 0
s_mov_b32 s41, 300000
s_lshl_b32 s37, s32, 14
s_add_u32 s39, s37, 17301504
s_add_u32 s37, s37, 16777216
s_mov_b32 s40, 8749056
v_mov_b64 v[36:37], 0
v_mov_b64 v[38:39], 0
ds_write_b128 v1, v[36:39] offset:14336
s_lshl_b32 s56, s32, 1
s_add_u32 s56, s56, 0
s_cmp_eq_u32 s56, 0
s_cselect_b32 s56, 64, s56
s_mul_i32 s56, s56, 10240
s_add_u32 s56, s56, 8388608
s_add_u32 s57, s56, 4096
v_mov_b32 v40, 0
v_mov_b32 v41, 0
v_mov_b32 v42, 0
v_mov_b32 v43, 0
buffer_store_dwordx4 v[40:43], v1, s[4:7], s56 offen offset:0 sc0 sc1
buffer_store_dwordx4 v[40:43], v1, s[4:7], s56 offen offset:1024 sc0 sc1
buffer_store_dwordx4 v[40:43], v1, s[4:7], s56 offen offset:2048 sc0 sc1
buffer_store_dwordx4 v[40:43], v1, s[4:7], s56 offen offset:3072 sc0 sc1
s_add_u32 s56, s32, 64
s_lshl_b32 s3, s56, 12
v_and_b32 v23, 1, v21
v_bfe_u32 v24, v21, 2, 1
v_bfe_u32 v25, v21, 1, 1
s_lshl_b32 s57, s56, 7
s_add_u32 s57, s57, 294912
v_and_b32 v10, 7, v21
v_lshlrev_b32 v10, 2, v10
v_lshl_add_u32 v10, v22, 5, v10
v_add_u32 v10, s57, v10
s_lshl_b32 s33, s56, 2
s_add_u32 s33, s33, 304128
v_mov_b32 v30, -1
s_mov_b64 exec, 1
buffer_store_dword v30, v1, s[4:7], s33 offen sc0 sc1
s_mov_b64 exec, -1
v_lshl_add_u32 v23, v23, 1, v24
v_lshlrev_b32 v25, 4, v25
v_mov_b32 v24, 0x3f80
v_lshlrev_b32 v24, v25, v24
v_cmp_eq_u32 vcc, 0, v23
s_nop 1
v_cndmask_b32 v76, 0, v24, vcc
v_cmp_eq_u32 vcc, 1, v23
s_nop 1
v_cndmask_b32 v77, 0, v24, vcc
v_cmp_eq_u32 vcc, 2, v23
s_nop 1
v_cndmask_b32 v78, 0, v24, vcc
v_cmp_eq_u32 vcc, 3, v23
s_nop 1
v_cndmask_b32 v79, 0, v24, vcc
buffer_store_dwordx4 v[36:39], v9, s[4:7], s3 offen offset:0 sc0 sc1
buffer_store_dwordx4 v[36:39], v9, s[4:7], s3 offen offset:1024 sc0 sc1
buffer_store_dwordx4 v[36:39], v9, s[4:7], s3 offen offset:2048 sc0 sc1
buffer_store_dwordx4 v[36:39], v9, s[4:7], s3 offen offset:3072 sc0 sc1
v_lshlrev_b32 v23, 2, v20
s_lshl_b32 s56, s32, 8
s_add_u32 s56, s56, 327680
buffer_store_dword v36, v23, s[4:7], s56 offen sc0 sc1
s_lshl_b32 s56, s32, 10
s_cmp_ge_u32 s32, 9
s_cselect_b32 s56, 268435456, s56
s_add_u32 s57, s56, 8388608
s_add_u32 s56, s56, 294912
s_waitcnt vmcnt(10)
v_or_b32 v12, 1, v12
buffer_store_dwordx4 v[12:15], v1, s[4:7], s56 offen sc0 sc1
buffer_store_dwordx4 v[12:15], v1, s[4:7], s57 offen sc0 sc1
s_getreg_b32 s56, hwreg(HW_REG_XCC_ID)
s_and_b32 s56, s56, 15
s_mul_i32 s57, s56, s56
s_lshl_b32 s57, s57, 18
s_lshl_b32 s56, s56, 8
s_add_u32 s57, s57, s56
s_add_u32 s58, s57, 1
s_lshl_b32 s101, s32, 7
s_add_u32 s101, s101, 327680
v_mov_b32 v24, 0
s_add_u32 s56, s54, 0
s_mov_b32 m0, 28672
s_nop 0
buffer_load_dwordx4 v26, s[12:15], s56 offen lds
s_add_u32 s56, s54, 16384
s_mov_b32 m0, 29696
s_nop 0
buffer_load_dwordx4 v26, s[12:15], s56 offen lds
s_add_u32 s56, s54, 32768
s_mov_b32 m0, 30720
s_nop 0
buffer_load_dwordx4 v27, s[12:15], s56 offen lds
s_add_u32 s56, s54, 49152
s_mov_b32 m0, 31744
s_nop 0
buffer_load_dwordx4 v27, s[12:15], s56 offen lds
s_add_u32 s56, s54, 524288
s_mov_b32 m0, 32768
s_nop 0
buffer_load_dwordx4 v26, s[12:15], s56 offen lds
s_add_u32 s56, s54, 540672
s_mov_b32 m0, 33792
s_nop 0
buffer_load_dwordx4 v26, s[12:15], s56 offen lds
s_add_u32 s56, s54, 557056
s_mov_b32 m0, 34816
s_nop 0
buffer_load_dwordx4 v27, s[12:15], s56 offen lds
s_add_u32 s56, s54, 573440
s_mov_b32 m0, 35840
s_nop 0
buffer_load_dwordx4 v27, s[12:15], s56 offen lds
v_and_b32 v23, 3, v20
v_lshrrev_b32 v24, 2, v20
v_mul_u32_u24 v29, 1152, v24
v_lshl_add_u32 v29, v23, 4, v29
v_lshrrev_b32 v24, 2, v21
v_and_b32 v25, 1, v22
v_lshlrev_b32 v31, 10, v25
v_lshrrev_b32 v25, 1, v22
v_lshl_add_u32 v31, v25, 8, v31
v_and_b32 v25, 1, v24
v_lshl_add_u32 v31, v25, 6, v31
v_lshrrev_b32 v25, 1, v24
v_lshl_add_u32 v31, v25, 3, v31
v_lshl_add_u32 v31, v23, 4, v31
v_add_u32 v31, 16384, v31
s_add_u32 s56, s55, 1024
s_mov_b32 m0, 49152
s_nop 0
buffer_load_dwordx4 v29, s[20:23], s56 offen lds
s_add_u32 s56, s55, 19456
s_mov_b32 m0, 50176
s_nop 0
buffer_load_dwordx4 v29, s[20:23], s56 offen lds
s_add_u32 s56, s55, 37888
s_mov_b32 m0, 51200
s_nop 0
buffer_load_dwordx4 v29, s[20:23], s56 offen lds
s_add_u32 s56, s55, 56320
s_mov_b32 m0, 52224
s_nop 0
buffer_load_dwordx4 v29, s[20:23], s56 offen lds
s_add_u32 s56, s55, 74752
s_mov_b32 m0, 53248
s_nop 0
buffer_load_dwordx4 v29, s[20:23], s56 offen lds
s_add_u32 s56, s55, 93184
s_mov_b32 m0, 54272
s_nop 0
buffer_load_dwordx4 v29, s[20:23], s56 offen lds
s_add_u32 s56, s55, 111616
s_mov_b32 m0, 55296
s_nop 0
buffer_load_dwordx4 v29, s[20:23], s56 offen lds
s_add_u32 s56, s55, 130048
s_mov_b32 m0, 56320
s_nop 0
buffer_load_dwordx4 v29, s[20:23], s56 offen lds
v_mov_b32 v24, 0
s_barrier
ds_read_b64_tr_b16 v[80:81], v44 offset:20480
ds_read_b64_tr_b16 v[82:83], v44 offset:21504
ds_read_b64_tr_b16 v[84:85], v46 offset:20480
ds_read_b64_tr_b16 v[86:87], v46 offset:21504
ds_read_b64_tr_b16 v[88:89], v45 offset:20480
ds_read_b64_tr_b16 v[90:91], v45 offset:21504
ds_read_b64_tr_b16 v[92:93], v47 offset:20480
ds_read_b64_tr_b16 v[94:95], v47 offset:21504
s_waitcnt lgkmcnt(0)
s_barrier
s_add_u32 s56, s54, 1048576
s_mov_b32 m0, 36864
s_nop 0
buffer_load_dwordx4 v26, s[12:15], s56 offen lds
s_add_u32 s56, s54, 1064960
s_mov_b32 m0, 37888
s_nop 0
buffer_load_dwordx4 v26, s[12:15], s56 offen lds
s_add_u32 s56, s54, 1081344
s_mov_b32 m0, 38912
s_nop 0
buffer_load_dwordx4 v27, s[12:15], s56 offen lds
s_add_u32 s56, s54, 1097728
s_mov_b32 m0, 39936
s_nop 0
buffer_load_dwordx4 v27, s[12:15], s56 offen lds
ds_read_b64_tr_b16 v[96:97], v44 offset:24576
ds_read_b64_tr_b16 v[98:99], v44 offset:25600
ds_read_b64_tr_b16 v[100:101], v46 offset:24576
ds_read_b64_tr_b16 v[102:103], v46 offset:25600
ds_read_b64_tr_b16 v[104:105], v45 offset:24576
ds_read_b64_tr_b16 v[106:107], v45 offset:25600
ds_read_b64_tr_b16 v[108:109], v47 offset:24576
ds_read_b64_tr_b16 v[110:111], v47 offset:25600
s_waitcnt lgkmcnt(0)
s_barrier
s_add_u32 s56, s54, 1572864
s_mov_b32 m0, 40960
s_nop 0
buffer_load_dwordx4 v26, s[12:15], s56 offen lds
s_add_u32 s56, s54, 1589248
s_mov_b32 m0, 41984
s_nop 0
buffer_load_dwordx4 v26, s[12:15], s56 offen lds
s_add_u32 s56, s54, 1605632
s_mov_b32 m0, 43008
s_nop 0
buffer_load_dwordx4 v27, s[12:15], s56 offen lds
s_add_u32 s56, s54, 1622016
s_mov_b32 m0, 44032
s_nop 0
buffer_load_dwordx4 v27, s[12:15], s56 offen lds
ds_read_b64_tr_b16 v[112:113], v44 offset:28672
ds_read_b64_tr_b16 v[114:115], v44 offset:29696
ds_read_b64_tr_b16 v[116:117], v46 offset:28672
ds_read_b64_tr_b16 v[118:119], v46 offset:29696
ds_read_b64_tr_b16 v[120:121], v45 offset:28672
ds_read_b64_tr_b16 v[122:123], v45 offset:29696
ds_read_b64_tr_b16 v[124:125], v47 offset:28672
ds_read_b64_tr_b16 v[126:127], v47 offset:29696
s_waitcnt lgkmcnt(0)
s_barrier
s_add_u32 s56, s54, 2097152
s_mov_b32 m0, 45056
s_nop 0
buffer_load_dwordx4 v26, s[12:15], s56 offen lds
s_add_u32 s56, s54, 2113536
s_mov_b32 m0, 46080
s_nop 0
buffer_load_dwordx4 v26, s[12:15], s56 offen lds
s_add_u32 s56, s54, 2129920
s_mov_b32 m0, 47104
s_nop 0
buffer_load_dwordx4 v27, s[12:15], s56 offen lds
s_add_u32 s56, s54, 2146304
s_mov_b32 m0, 48128
s_nop 0
buffer_load_dwordx4 v27, s[12:15], s56 offen lds
ds_read_b64_tr_b16 v[128:129], v44 offset:0
ds_read_b64_tr_b16 v[130:131], v44 offset:1024
ds_read_b64_tr_b16 v[132:133], v46 offset:0
ds_read_b64_tr_b16 v[134:135], v46 offset:1024
ds_read_b64_tr_b16 v[136:137], v45 offset:0
ds_read_b64_tr_b16 v[138:139], v45 offset:1024
ds_read_b64_tr_b16 v[140:141], v47 offset:0
ds_read_b64_tr_b16 v[142:143], v47 offset:1024
s_waitcnt lgkmcnt(0)
s_barrier
s_add_u32 s56, s54, 3145728
s_mov_b32 m0, 16384
s_nop 0
buffer_load_dwordx4 v26, s[12:15], s56 offen lds
s_add_u32 s56, s54, 3162112
s_mov_b32 m0, 17408
s_nop 0
buffer_load_dwordx4 v26, s[12:15], s56 offen lds
s_add_u32 s56, s54, 3178496
s_mov_b32 m0, 18432
s_nop 0
buffer_load_dwordx4 v27, s[12:15], s56 offen lds
s_add_u32 s56, s54, 3194880
s_mov_b32 m0, 19456
s_nop 0
buffer_load_dwordx4 v27, s[12:15], s56 offen lds
ds_read_b64_tr_b16 v[144:145], v44 offset:4096
ds_read_b64_tr_b16 v[146:147], v44 offset:5120
ds_read_b64_tr_b16 v[148:149], v46 offset:4096
ds_read_b64_tr_b16 v[150:151], v46 offset:5120
ds_read_b64_tr_b16 v[152:153], v45 offset:4096
ds_read_b64_tr_b16 v[154:155], v45 offset:5120
ds_read_b64_tr_b16 v[156:157], v47 offset:4096
ds_read_b64_tr_b16 v[158:159], v47 offset:5120
s_waitcnt lgkmcnt(0)
s_barrier
s_add_u32 s56, s54, 3670016
s_mov_b32 m0, 20480
s_nop 0
buffer_load_dwordx4 v26, s[12:15], s56 offen lds
s_add_u32 s56, s54, 3686400
s_mov_b32 m0, 21504
s_nop 0
buffer_load_dwordx4 v26, s[12:15], s56 offen lds
s_add_u32 s56, s54, 3702784
s_mov_b32 m0, 22528
s_nop 0
buffer_load_dwordx4 v27, s[12:15], s56 offen lds
s_add_u32 s56, s54, 3719168
s_mov_b32 m0, 23552
s_nop 0
buffer_load_dwordx4 v27, s[12:15], s56 offen lds
ds_read_b64_tr_b16 v[160:161], v44 offset:8192
ds_read_b64_tr_b16 v[162:163], v44 offset:9216
ds_read_b64_tr_b16 v[164:165], v46 offset:8192
ds_read_b64_tr_b16 v[166:167], v46 offset:9216
ds_read_b64_tr_b16 v[168:169], v45 offset:8192
ds_read_b64_tr_b16 v[170:171], v45 offset:9216
ds_read_b64_tr_b16 v[172:173], v47 offset:8192
ds_read_b64_tr_b16 v[174:175], v47 offset:9216
s_waitcnt lgkmcnt(0)
s_waitcnt vmcnt(32)
s_barrier
s_add_u32 s56, s54, 4194304
s_mov_b32 m0, 24576
s_nop 0
buffer_load_dwordx4 v26, s[12:15], s56 offen lds
s_add_u32 s56, s54, 4210688
s_mov_b32 m0, 25600
s_nop 0
buffer_load_dwordx4 v26, s[12:15], s56 offen lds
s_add_u32 s56, s54, 4227072
s_mov_b32 m0, 26624
s_nop 0
buffer_load_dwordx4 v27, s[12:15], s56 offen lds
s_add_u32 s56, s54, 4243456
s_mov_b32 m0, 27648
s_nop 0
buffer_load_dwordx4 v27, s[12:15], s56 offen lds
ds_read_b64_tr_b16 v[176:177], v44 offset:12288
ds_read_b64_tr_b16 v[178:179], v44 offset:13312
ds_read_b64_tr_b16 v[180:181], v46 offset:12288
ds_read_b64_tr_b16 v[182:183], v46 offset:13312
ds_read_b64_tr_b16 v[184:185], v45 offset:12288
ds_read_b64_tr_b16 v[186:187], v45 offset:13312
ds_read_b64_tr_b16 v[188:189], v47 offset:12288
ds_read_b64_tr_b16 v[190:191], v47 offset:13312
v_mov_b32 v23, s58
s_mov_b64 exec, 1
buffer_atomic_add v23, v24, s[28:31], 0 offen sc1
s_mov_b64 exec, -1
s_waitcnt lgkmcnt(0)
s_waitcnt vmcnt(33)
s_barrier
s_add_u32 s56, s54, 0
s_mov_b32 m0, 28672
s_nop 0
buffer_load_dwordx4 v26, s[16:19], s56 offen lds
s_add_u32 s56, s54, 16384
s_mov_b32 m0, 29696
s_nop 0
buffer_load_dwordx4 v26, s[16:19], s56 offen lds
s_add_u32 s56, s54, 32768
s_mov_b32 m0, 30720
s_nop 0
buffer_load_dwordx4 v27, s[16:19], s56 offen lds
s_add_u32 s56, s54, 49152
s_mov_b32 m0, 31744
s_nop 0
buffer_load_dwordx4 v27, s[16:19], s56 offen lds
ds_read_b64_tr_b16 v[192:193], v44 offset:16384
ds_read_b64_tr_b16 v[194:195], v44 offset:17408
ds_read_b64_tr_b16 v[196:197], v46 offset:16384
ds_read_b64_tr_b16 v[198:199], v46 offset:17408
ds_read_b64_tr_b16 v[200:201], v45 offset:16384
ds_read_b64_tr_b16 v[202:203], v45 offset:17408
ds_read_b64_tr_b16 v[204:205], v47 offset:16384
ds_read_b64_tr_b16 v[206:207], v47 offset:17408
s_waitcnt lgkmcnt(0)
s_waitcnt vmcnt(25)
s_barrier
s_add_u32 s56, s54, 524288
s_mov_b32 m0, 32768
s_nop 0
buffer_load_dwordx4 v26, s[16:19], s56 offen lds
s_add_u32 s56, s54, 540672
s_mov_b32 m0, 33792
s_nop 0
buffer_load_dwordx4 v26, s[16:19], s56 offen lds
s_add_u32 s56, s54, 557056
s_mov_b32 m0, 34816
s_nop 0
buffer_load_dwordx4 v27, s[16:19], s56 offen lds
s_add_u32 s56, s54, 573440
s_mov_b32 m0, 35840
s_nop 0
buffer_load_dwordx4 v27, s[16:19], s56 offen lds
ds_read_b64_tr_b16 v[208:209], v44 offset:20480
ds_read_b64_tr_b16 v[210:211], v44 offset:21504
ds_read_b64_tr_b16 v[212:213], v46 offset:20480
ds_read_b64_tr_b16 v[214:215], v46 offset:21504
ds_read_b64_tr_b16 v[216:217], v45 offset:20480
ds_read_b64_tr_b16 v[218:219], v45 offset:21504
ds_read_b64_tr_b16 v[220:221], v47 offset:20480
ds_read_b64_tr_b16 v[222:223], v47 offset:21504
s_waitcnt lgkmcnt(0)
s_waitcnt vmcnt(25)
s_barrier
s_add_u32 s56, s54, 1048576
s_mov_b32 m0, 36864
s_nop 0
buffer_load_dwordx4 v26, s[16:19], s56 offen lds
s_add_u32 s56, s54, 1064960
s_mov_b32 m0, 37888
s_nop 0
buffer_load_dwordx4 v26, s[16:19], s56 offen lds
s_add_u32 s56, s54, 1081344
s_mov_b32 m0, 38912
s_nop 0
buffer_load_dwordx4 v27, s[16:19], s56 offen lds
s_add_u32 s56, s54, 1097728
s_mov_b32 m0, 39936
s_nop 0
buffer_load_dwordx4 v27, s[16:19], s56 offen lds
ds_read_b64_tr_b16 v[224:225], v44 offset:24576
ds_read_b64_tr_b16 v[226:227], v44 offset:25600
ds_read_b64_tr_b16 v[228:229], v46 offset:24576
ds_read_b64_tr_b16 v[230:231], v46 offset:25600
ds_read_b64_tr_b16 v[232:233], v45 offset:24576
ds_read_b64_tr_b16 v[234:235], v45 offset:25600
ds_read_b64_tr_b16 v[236:237], v47 offset:24576
ds_read_b64_tr_b16 v[238:239], v47 offset:25600
ds_read_b64_tr_b16 v[60:61], v31 offset:32768
ds_read_b64_tr_b16 v[62:63], v31 offset:32896
ds_read_b64_tr_b16 v[64:65], v31 offset:33280
ds_read_b64_tr_b16 v[66:67], v31 offset:33408
ds_read_b64_tr_b16 v[68:69], v31 offset:34816
ds_read_b64_tr_b16 v[70:71], v31 offset:34944
ds_read_b64_tr_b16 v[72:73], v31 offset:35328
ds_read_b64_tr_b16 v[74:75], v31 offset:35456
s_waitcnt lgkmcnt(0)
ds_write_b128 v2, v[60:63] offset:32768
ds_write_b128 v2, v[64:67] offset:33792
ds_write_b128 v2, v[68:71] offset:34816
ds_write_b128 v2, v[72:75] offset:35840
s_waitcnt lgkmcnt(0)
s_waitcnt vmcnt(25)
s_barrier
s_add_u32 s56, s54, 1572864
s_mov_b32 m0, 40960
s_nop 0
buffer_load_dwordx4 v26, s[16:19], s56 offen lds
s_add_u32 s56, s54, 1589248
s_mov_b32 m0, 41984
s_nop 0
buffer_load_dwordx4 v26, s[16:19], s56 offen lds
s_add_u32 s56, s54, 1605632
s_mov_b32 m0, 43008
s_nop 0
buffer_load_dwordx4 v27, s[16:19], s56 offen lds
s_add_u32 s56, s54, 1622016
s_mov_b32 m0, 44032
s_nop 0
buffer_load_dwordx4 v27, s[16:19], s56 offen lds
ds_read_b64_tr_b16 v[240:241], v44 offset:28672
ds_read_b64_tr_b16 v[242:243], v44 offset:29696
ds_read_b64_tr_b16 v[244:245], v46 offset:28672
ds_read_b64_tr_b16 v[246:247], v46 offset:29696
ds_read_b64_tr_b16 v[248:249], v45 offset:28672
ds_read_b64_tr_b16 v[250:251], v45 offset:29696
ds_read_b64_tr_b16 v[252:253], v47 offset:28672
ds_read_b64_tr_b16 v[254:255], v47 offset:29696
ds_read_b64_tr_b16 v[60:61], v31 offset:36864
ds_read_b64_tr_b16 v[62:63], v31 offset:36992
ds_read_b64_tr_b16 v[64:65], v31 offset:37376
ds_read_b64_tr_b16 v[66:67], v31 offset:37504
ds_read_b64_tr_b16 v[68:69], v31 offset:38912
ds_read_b64_tr_b16 v[70:71], v31 offset:39040
ds_read_b64_tr_b16 v[72:73], v31 offset:39424
ds_read_b64_tr_b16 v[74:75], v31 offset:39552
s_waitcnt lgkmcnt(0)
ds_write_b128 v2, v[60:63] offset:36864
ds_write_b128 v2, v[64:67] offset:37888
ds_write_b128 v2, v[68:71] offset:38912
ds_write_b128 v2, v[72:75] offset:39936
s_waitcnt lgkmcnt(0)
s_waitcnt vmcnt(25)
s_barrier
s_add_u32 s56, s54, 2097152
s_mov_b32 m0, 45056
s_nop 0
buffer_load_dwordx4 v26, s[16:19], s56 offen lds
s_add_u32 s56, s54, 2113536
s_mov_b32 m0, 46080
s_nop 0
buffer_load_dwordx4 v26, s[16:19], s56 offen lds
s_add_u32 s56, s54, 2129920
s_mov_b32 m0, 47104
s_nop 0
buffer_load_dwordx4 v27, s[16:19], s56 offen lds
s_add_u32 s56, s54, 2146304
s_mov_b32 m0, 48128
s_nop 0
buffer_load_dwordx4 v27, s[16:19], s56 offen lds
ds_read_b64_tr_b16 a[0:1], v44 offset:0
ds_read_b64_tr_b16 a[2:3], v44 offset:1024
ds_read_b64_tr_b16 a[4:5], v46 offset:0
ds_read_b64_tr_b16 a[6:7], v46 offset:1024
ds_read_b64_tr_b16 a[8:9], v45 offset:0
ds_read_b64_tr_b16 a[10:11], v45 offset:1024
ds_read_b64_tr_b16 a[12:13], v47 offset:0
ds_read_b64_tr_b16 a[14:15], v47 offset:1024
s_waitcnt lgkmcnt(0)
s_waitcnt vmcnt(25)
s_barrier
s_add_u32 s56, s54, 2621440
s_mov_b32 m0, 16384
s_nop 0
buffer_load_dwordx4 v26, s[16:19], s56 offen lds
s_add_u32 s56, s54, 2637824
s_mov_b32 m0, 17408
s_nop 0
buffer_load_dwordx4 v26, s[16:19], s56 offen lds
s_add_u32 s56, s54, 2654208
s_mov_b32 m0, 18432
s_nop 0
buffer_load_dwordx4 v27, s[16:19], s56 offen lds
s_add_u32 s56, s54, 2670592
s_mov_b32 m0, 19456
s_nop 0
buffer_load_dwordx4 v27, s[16:19], s56 offen lds
ds_read_b64_tr_b16 a[16:17], v44 offset:4096
ds_read_b64_tr_b16 a[18:19], v44 offset:5120
ds_read_b64_tr_b16 a[20:21], v46 offset:4096
ds_read_b64_tr_b16 a[22:23], v46 offset:5120
ds_read_b64_tr_b16 a[24:25], v45 offset:4096
ds_read_b64_tr_b16 a[26:27], v45 offset:5120
ds_read_b64_tr_b16 a[28:29], v47 offset:4096
ds_read_b64_tr_b16 a[30:31], v47 offset:5120
s_waitcnt lgkmcnt(0)
s_waitcnt vmcnt(25)
s_barrier
s_add_u32 s56, s54, 3145728
s_mov_b32 m0, 20480
s_nop 0
buffer_load_dwordx4 v26, s[16:19], s56 offen lds
s_add_u32 s56, s54, 3162112
s_mov_b32 m0, 21504
s_nop 0
buffer_load_dwordx4 v26, s[16:19], s56 offen lds
s_add_u32 s56, s54, 3178496
s_mov_b32 m0, 22528
s_nop 0
buffer_load_dwordx4 v27, s[16:19], s56 offen lds
s_add_u32 s56, s54, 3194880
s_mov_b32 m0, 23552
s_nop 0
buffer_load_dwordx4 v27, s[16:19], s56 offen lds
ds_read_b64_tr_b16 a[32:33], v44 offset:8192
ds_read_b64_tr_b16 a[34:35], v44 offset:9216
ds_read_b64_tr_b16 a[36:37], v46 offset:8192
ds_read_b64_tr_b16 a[38:39], v46 offset:9216
ds_read_b64_tr_b16 a[40:41], v45 offset:8192
ds_read_b64_tr_b16 a[42:43], v45 offset:9216
ds_read_b64_tr_b16 a[44:45], v47 offset:8192
ds_read_b64_tr_b16 a[46:47], v47 offset:9216
s_waitcnt lgkmcnt(0)
s_waitcnt vmcnt(24)
s_barrier
s_add_u32 s56, s54, 3670016
s_mov_b32 m0, 24576
s_nop 0
buffer_load_dwordx4 v26, s[16:19], s56 offen lds
s_add_u32 s56, s54, 3686400
s_mov_b32 m0, 25600
s_nop 0
buffer_load_dwordx4 v26, s[16:19], s56 offen lds
s_add_u32 s56, s54, 3702784
s_mov_b32 m0, 26624
s_nop 0
buffer_load_dwordx4 v27, s[16:19], s56 offen lds
s_add_u32 s56, s54, 3719168
s_mov_b32 m0, 27648
s_nop 0
buffer_load_dwordx4 v27, s[16:19], s56 offen lds
ds_read_b64_tr_b16 a[48:49], v44 offset:12288
ds_read_b64_tr_b16 a[50:51], v44 offset:13312
ds_read_b64_tr_b16 a[52:53], v46 offset:12288
ds_read_b64_tr_b16 a[54:55], v46 offset:13312
ds_read_b64_tr_b16 a[56:57], v45 offset:12288
ds_read_b64_tr_b16 a[58:59], v45 offset:13312
ds_read_b64_tr_b16 a[60:61], v47 offset:12288
ds_read_b64_tr_b16 a[62:63], v47 offset:13312
s_waitcnt lgkmcnt(0)
s_waitcnt vmcnt(24)
s_barrier
s_add_u32 s56, s55, 73728
s_mov_b32 m0, 28672
s_nop 0
buffer_load_dwordx4 v28, s[20:23], s56 offen lds
s_add_u32 s56, s55, 76032
s_mov_b32 m0, 29696
s_nop 0
buffer_load_dwordx4 v28, s[20:23], s56 offen lds
s_add_u32 s56, s55, 82944
s_mov_b32 m0, 30720
s_nop 0
buffer_load_dwordx4 v28, s[20:23], s56 offen lds
s_add_u32 s56, s55, 85248
s_mov_b32 m0, 31744
s_nop 0
buffer_load_dwordx4 v28, s[20:23], s56 offen lds
ds_read_b64_tr_b16 a[64:65], v44 offset:16384
ds_read_b64_tr_b16 a[66:67], v44 offset:17408
ds_read_b64_tr_b16 a[68:69], v46 offset:16384
ds_read_b64_tr_b16 a[70:71], v46 offset:17408
ds_read_b64_tr_b16 a[72:73], v45 offset:16384
ds_read_b64_tr_b16 a[74:75], v45 offset:17408
ds_read_b64_tr_b16 a[76:77], v47 offset:16384
ds_read_b64_tr_b16 a[78:79], v47 offset:17408
s_waitcnt lgkmcnt(0)
s_waitcnt vmcnt(24)
s_barrier
s_add_u32 s56, s55, 73984
s_mov_b32 m0, 32768
s_nop 0
buffer_load_dwordx4 v28, s[20:23], s56 offen lds
s_add_u32 s56, s55, 76288
s_mov_b32 m0, 33792
s_nop 0
buffer_load_dwordx4 v28, s[20:23], s56 offen lds
s_add_u32 s56, s55, 83200
s_mov_b32 m0, 34816
s_nop 0
buffer_load_dwordx4 v28, s[20:23], s56 offen lds
s_add_u32 s56, s55, 85504
s_mov_b32 m0, 35840
s_nop 0
buffer_load_dwordx4 v28, s[20:23], s56 offen lds
ds_read_b64_tr_b16 a[80:81], v44 offset:20480
ds_read_b64_tr_b16 a[82:83], v44 offset:21504
ds_read_b64_tr_b16 a[84:85], v46 offset:20480
ds_read_b64_tr_b16 a[86:87], v46 offset:21504
ds_read_b64_tr_b16 a[88:89], v45 offset:20480
ds_read_b64_tr_b16 a[90:91], v45 offset:21504
ds_read_b64_tr_b16 a[92:93], v47 offset:20480
ds_read_b64_tr_b16 a[94:95], v47 offset:21504
s_waitcnt lgkmcnt(0)
s_waitcnt vmcnt(24)
s_barrier
s_add_u32 s56, s55, 74240
s_mov_b32 m0, 36864
s_nop 0
buffer_load_dwordx4 v28, s[20:23], s56 offen lds
s_add_u32 s56, s55, 76544
s_mov_b32 m0, 37888
s_nop 0
buffer_load_dwordx4 v28, s[20:23], s56 offen lds
s_add_u32 s56, s55, 83456
s_mov_b32 m0, 38912
s_nop 0
buffer_load_dwordx4 v28, s[20:23], s56 offen lds
s_add_u32 s56, s55, 85760
s_mov_b32 m0, 39936
s_nop 0
buffer_load_dwordx4 v28, s[20:23], s56 offen lds
ds_read_b64_tr_b16 a[96:97], v44 offset:24576
ds_read_b64_tr_b16 a[98:99], v44 offset:25600
ds_read_b64_tr_b16 a[100:101], v46 offset:24576
ds_read_b64_tr_b16 a[102:103], v46 offset:25600
ds_read_b64_tr_b16 a[104:105], v45 offset:24576
ds_read_b64_tr_b16 a[106:107], v45 offset:25600
ds_read_b64_tr_b16 a[108:109], v47 offset:24576
ds_read_b64_tr_b16 a[110:111], v47 offset:25600
s_waitcnt lgkmcnt(0)
s_waitcnt vmcnt(24)
s_barrier
s_add_u32 s56, s55, 74496
s_mov_b32 m0, 40960
s_nop 0
buffer_load_dwordx4 v28, s[20:23], s56 offen lds
s_add_u32 s56, s55, 76800
s_mov_b32 m0, 41984
s_nop 0
buffer_load_dwordx4 v28, s[20:23], s56 offen lds
s_add_u32 s56, s55, 83712
s_mov_b32 m0, 43008
s_nop 0
buffer_load_dwordx4 v28, s[20:23], s56 offen lds
s_add_u32 s56, s55, 86016
s_mov_b32 m0, 44032
s_nop 0
buffer_load_dwordx4 v28, s[20:23], s56 offen lds
ds_read_b64_tr_b16 a[112:113], v44 offset:28672
ds_read_b64_tr_b16 a[114:115], v44 offset:29696
ds_read_b64_tr_b16 a[116:117], v46 offset:28672
ds_read_b64_tr_b16 a[118:119], v46 offset:29696
ds_read_b64_tr_b16 a[120:121], v45 offset:28672
ds_read_b64_tr_b16 a[122:123], v45 offset:29696
ds_read_b64_tr_b16 a[124:125], v47 offset:28672
ds_read_b64_tr_b16 a[126:127], v47 offset:29696
s_waitcnt lgkmcnt(0)
s_waitcnt vmcnt(24)
s_barrier
s_add_u32 s56, s55, 0
s_mov_b32 m0, 45056
s_nop 0
buffer_load_dwordx4 v28, s[20:23], s56 offen lds
s_add_u32 s56, s55, 2304
s_mov_b32 m0, 46080
s_nop 0
buffer_load_dwordx4 v28, s[20:23], s56 offen lds
s_add_u32 s56, s55, 9216
s_mov_b32 m0, 47104
s_nop 0
buffer_load_dwordx4 v28, s[20:23], s56 offen lds
s_add_u32 s56, s55, 11520
s_mov_b32 m0, 48128
s_nop 0
buffer_load_dwordx4 v28, s[20:23], s56 offen lds
ds_read_b64_tr_b16 a[128:129], v44 offset:0
ds_read_b64_tr_b16 a[130:131], v44 offset:1024
ds_read_b64_tr_b16 a[132:133], v46 offset:0
ds_read_b64_tr_b16 a[134:135], v46 offset:1024
ds_read_b64_tr_b16 a[136:137], v45 offset:0
ds_read_b64_tr_b16 a[138:139], v45 offset:1024
ds_read_b64_tr_b16 a[140:141], v47 offset:0
ds_read_b64_tr_b16 a[142:143], v47 offset:1024
buffer_load_dword v32, v24, s[28:31], 0 offen sc0 sc1
s_waitcnt lgkmcnt(0)
s_waitcnt vmcnt(25)
s_barrier
s_add_u32 s56, s54, 0
s_mov_b32 m0, 16384
s_nop 0
buffer_load_dwordx4 v26, s[8:11], s56 offen lds
s_add_u32 s56, s54, 16384
s_mov_b32 m0, 17408
s_nop 0
buffer_load_dwordx4 v26, s[8:11], s56 offen lds
s_add_u32 s56, s54, 32768
s_mov_b32 m0, 18432
s_nop 0
buffer_load_dwordx4 v27, s[8:11], s56 offen lds
s_add_u32 s56, s54, 49152
s_mov_b32 m0, 19456
s_nop 0
buffer_load_dwordx4 v27, s[8:11], s56 offen lds
ds_read_b64_tr_b16 a[144:145], v44 offset:4096
ds_read_b64_tr_b16 a[146:147], v44 offset:5120
ds_read_b64_tr_b16 a[148:149], v46 offset:4096
ds_read_b64_tr_b16 a[150:151], v46 offset:5120
ds_read_b64_tr_b16 a[152:153], v45 offset:4096
ds_read_b64_tr_b16 a[154:155], v45 offset:5120
ds_read_b64_tr_b16 a[156:157], v47 offset:4096
ds_read_b64_tr_b16 a[158:159], v47 offset:5120
s_waitcnt lgkmcnt(0)
s_waitcnt vmcnt(25)
s_barrier
s_add_u32 s56, s54, 1572864
s_mov_b32 m0, 20480
s_nop 0
buffer_load_dwordx4 v26, s[8:11], s56 offen lds
s_add_u32 s56, s54, 1589248
s_mov_b32 m0, 21504
s_nop 0
buffer_load_dwordx4 v26, s[8:11], s56 offen lds
s_add_u32 s56, s54, 1605632
s_mov_b32 m0, 22528
s_nop 0
buffer_load_dwordx4 v27, s[8:11], s56 offen lds
s_add_u32 s56, s54, 1622016
s_mov_b32 m0, 23552
s_nop 0
buffer_load_dwordx4 v27, s[8:11], s56 offen lds
ds_read_b64_tr_b16 a[160:161], v44 offset:8192
ds_read_b64_tr_b16 a[162:163], v44 offset:9216
ds_read_b64_tr_b16 a[164:165], v46 offset:8192
ds_read_b64_tr_b16 a[166:167], v46 offset:9216
ds_read_b64_tr_b16 a[168:169], v45 offset:8192
ds_read_b64_tr_b16 a[170:171], v45 offset:9216
ds_read_b64_tr_b16 a[172:173], v47 offset:8192
ds_read_b64_tr_b16 a[174:175], v47 offset:9216
s_waitcnt lgkmcnt(0)
s_waitcnt vmcnt(25)
s_barrier
s_add_u32 s56, s54, 2097152
s_mov_b32 m0, 24576
s_nop 0
buffer_load_dwordx4 v26, s[8:11], s56 offen lds
s_add_u32 s56, s54, 2113536
s_mov_b32 m0, 25600
s_nop 0
buffer_load_dwordx4 v26, s[8:11], s56 offen lds
s_add_u32 s56, s54, 2129920
s_mov_b32 m0, 26624
s_nop 0
buffer_load_dwordx4 v27, s[8:11], s56 offen lds
s_add_u32 s56, s54, 2146304
s_mov_b32 m0, 27648
s_nop 0
buffer_load_dwordx4 v27, s[8:11], s56 offen lds
ds_read_b64_tr_b16 a[184:185], v48 offset:12288
ds_read_b64_tr_b16 a[186:187], v48 offset:13312
ds_read_b64_tr_b16 a[188:189], v48 offset:14336
ds_read_b64_tr_b16 a[190:191], v48 offset:15360
ds_read_b64_tr_b16 a[200:201], v49 offset:12288
ds_read_b64_tr_b16 a[202:203], v49 offset:13312
ds_read_b64_tr_b16 a[204:205], v49 offset:14336
ds_read_b64_tr_b16 a[206:207], v49 offset:15360
s_waitcnt lgkmcnt(0)
s_waitcnt vmcnt(25)
s_barrier
s_add_u32 s56, s54, 2621440
s_mov_b32 m0, 28672
s_nop 0
buffer_load_dwordx4 v26, s[12:15], s56 offen lds
s_add_u32 s56, s54, 2637824
s_mov_b32 m0, 29696
s_nop 0
buffer_load_dwordx4 v26, s[12:15], s56 offen lds
s_add_u32 s56, s54, 2654208
s_mov_b32 m0, 30720
s_nop 0
buffer_load_dwordx4 v27, s[12:15], s56 offen lds
s_add_u32 s56, s54, 2670592
s_mov_b32 m0, 31744
s_nop 0
buffer_load_dwordx4 v27, s[12:15], s56 offen lds
ds_read_b64_tr_b16 a[208:209], v48 offset:16384
ds_read_b64_tr_b16 a[210:211], v48 offset:17408
ds_read_b64_tr_b16 a[212:213], v48 offset:18432
ds_read_b64_tr_b16 a[214:215], v48 offset:19456
ds_read_b64_tr_b16 a[216:217], v49 offset:16384
ds_read_b64_tr_b16 a[218:219], v49 offset:17408
ds_read_b64_tr_b16 a[220:221], v49 offset:18432
ds_read_b64_tr_b16 a[222:223], v49 offset:19456
s_waitcnt lgkmcnt(0)
s_waitcnt vmcnt(25)
s_barrier
s_add_u32 s56, s54, 4194304
s_mov_b32 m0, 32768
s_nop 0
buffer_load_dwordx4 v26, s[16:19], s56 offen lds
s_add_u32 s56, s54, 4210688
s_mov_b32 m0, 33792
s_nop 0
buffer_load_dwordx4 v26, s[16:19], s56 offen lds
s_add_u32 s56, s54, 4227072
s_mov_b32 m0, 34816
s_nop 0
buffer_load_dwordx4 v27, s[16:19], s56 offen lds
s_add_u32 s56, s54, 4243456
s_mov_b32 m0, 35840
s_nop 0
buffer_load_dwordx4 v27, s[16:19], s56 offen lds
ds_read_b64_tr_b16 a[224:225], v48 offset:20480
ds_read_b64_tr_b16 a[226:227], v48 offset:21504
ds_read_b64_tr_b16 a[228:229], v48 offset:22528
ds_read_b64_tr_b16 a[230:231], v48 offset:23552
ds_read_b64_tr_b16 a[232:233], v49 offset:20480
ds_read_b64_tr_b16 a[234:235], v49 offset:21504
ds_read_b64_tr_b16 a[236:237], v49 offset:22528
ds_read_b64_tr_b16 a[238:239], v49 offset:23552
s_waitcnt lgkmcnt(0)
s_waitcnt vmcnt(25)
s_barrier
s_add_u32 s56, s55, 256
s_mov_b32 m0, 36864
s_nop 0
buffer_load_dwordx4 v28, s[20:23], s56 offen lds
s_add_u32 s56, s55, 2560
s_mov_b32 m0, 37888
s_nop 0
buffer_load_dwordx4 v28, s[20:23], s56 offen lds
s_add_u32 s56, s55, 9472
s_mov_b32 m0, 38912
s_nop 0
buffer_load_dwordx4 v28, s[20:23], s56 offen lds
s_add_u32 s56, s55, 11776
s_mov_b32 m0, 39936
s_nop 0
buffer_load_dwordx4 v28, s[20:23], s56 offen lds
ds_read_b64_tr_b16 a[240:241], v48 offset:24576
ds_read_b64_tr_b16 a[242:243], v48 offset:25600
ds_read_b64_tr_b16 a[244:245], v48 offset:26624
ds_read_b64_tr_b16 a[246:247], v48 offset:27648
ds_read_b64_tr_b16 a[248:249], v49 offset:24576
ds_read_b64_tr_b16 a[250:251], v49 offset:25600
ds_read_b64_tr_b16 a[252:253], v49 offset:26624
ds_read_b64_tr_b16 a[254:255], v49 offset:27648
s_waitcnt lgkmcnt(0)
s_waitcnt vmcnt(25)
s_barrier
s_add_u32 s56, s55, 512
s_mov_b32 m0, 40960
s_nop 0
buffer_load_dwordx4 v28, s[20:23], s56 offen lds
s_add_u32 s56, s55, 2816
s_mov_b32 m0, 41984
s_nop 0
buffer_load_dwordx4 v28, s[20:23], s56 offen lds
s_add_u32 s56, s55, 9728
s_mov_b32 m0, 43008
s_nop 0
buffer_load_dwordx4 v28, s[20:23], s56 offen lds
s_add_u32 s56, s55, 12032
s_mov_b32 m0, 44032
s_nop 0
buffer_load_dwordx4 v28, s[20:23], s56 offen lds
ds_read_b64_tr_b16 a[176:177], v48 offset:28672
ds_read_b64_tr_b16 a[178:179], v48 offset:29696
ds_read_b64_tr_b16 a[180:181], v48 offset:30720
ds_read_b64_tr_b16 a[182:183], v48 offset:31744
ds_read_b64_tr_b16 a[192:193], v49 offset:28672
ds_read_b64_tr_b16 a[194:195], v49 offset:29696
ds_read_b64_tr_b16 a[196:197], v49 offset:30720
ds_read_b64_tr_b16 a[198:199], v49 offset:31744
s_waitcnt lgkmcnt(0)
s_waitcnt vmcnt(24)
s_barrier
s_add_u32 s56, s55, 768
s_mov_b32 m0, 45056
s_nop 0
buffer_load_dwordx4 v28, s[20:23], s56 offen lds
s_add_u32 s56, s55, 3072
s_mov_b32 m0, 46080
s_nop 0
buffer_load_dwordx4 v28, s[20:23], s56 offen lds
s_add_u32 s56, s55, 9984
s_mov_b32 m0, 47104
s_nop 0
buffer_load_dwordx4 v28, s[20:23], s56 offen lds
s_add_u32 s56, s55, 12288
s_mov_b32 m0, 48128
s_nop 0
buffer_load_dwordx4 v28, s[20:23], s56 offen lds
ds_read_b64_tr_b16 v[60:61], v44 offset:0
ds_read_b64_tr_b16 v[62:63], v44 offset:1024
ds_read_b64_tr_b16 v[64:65], v46 offset:0
ds_read_b64_tr_b16 v[66:67], v46 offset:1024
ds_read_b64_tr_b16 v[68:69], v45 offset:0
ds_read_b64_tr_b16 v[70:71], v45 offset:1024
ds_read_b64_tr_b16 v[72:73], v47 offset:0
ds_read_b64_tr_b16 v[74:75], v47 offset:1024
s_waitcnt lgkmcnt(0)
s_waitcnt vmcnt(24)
s_barrier
ds_write_b128 v2, v[60:63] offset:0
ds_write_b128 v2, v[64:67] offset:1024
ds_write_b128 v2, v[68:71] offset:2048
ds_write_b128 v2, v[72:75] offset:3072
ds_read_b64_tr_b16 v[60:61], v44 offset:4096
ds_read_b64_tr_b16 v[62:63], v44 offset:5120
ds_read_b64_tr_b16 v[64:65], v46 offset:4096
ds_read_b64_tr_b16 v[66:67], v46 offset:5120
ds_read_b64_tr_b16 v[68:69], v45 offset:4096
ds_read_b64_tr_b16 v[70:71], v45 offset:5120
ds_read_b64_tr_b16 v[72:73], v47 offset:4096
ds_read_b64_tr_b16 v[74:75], v47 offset:5120
L_rdv_w0r:
v_readfirstlane_b32 s38, v32
s_nop 0
s_and_b32 s57, s38, 0xff
s_cmp_lg_u32 s57, 32
s_cbranch_scc1 L_rdv2_w0r
s_waitcnt lgkmcnt(0)
s_waitcnt vmcnt(20)
s_barrier
ds_write_b128 v2, v[60:63] offset:4096
ds_write_b128 v2, v[64:67] offset:5120
ds_write_b128 v2, v[68:71] offset:6144
ds_write_b128 v2, v[72:75] offset:7168
ds_read_b64_tr_b16 v[60:61], v44 offset:8192
ds_read_b64_tr_b16 v[62:63], v44 offset:9216
ds_read_b64_tr_b16 v[64:65], v46 offset:8192
ds_read_b64_tr_b16 v[66:67], v46 offset:9216
ds_read_b64_tr_b16 v[68:69], v45 offset:8192
ds_read_b64_tr_b16 v[70:71], v45 offset:9216
ds_read_b64_tr_b16 v[72:73], v47 offset:8192
ds_read_b64_tr_b16 v[74:75], v47 offset:9216
buffer_load_dwordx4 v[12:15], v9, s[4:7], s37 offen offset:0
buffer_load_dwordx4 v[16:19], v9, s[4:7], s37 offen offset:1024
buffer_load_dwordx4 v[52:55], v1, s[4:7], s37 offen offset:2048
buffer_load_dwordx4 v[56:59], v1, s[4:7], s37 offen offset:3072
s_mov_b32 m0, 1024
s_nop 0
buffer_load_dwordx4 v1, s[4:7], s47 offen offset:0 sc1 lds
buffer_load_dword v33, v1, s[4:7], s3 offen offset:0 sc1
buffer_load_dword v33, v1, s[4:7], s3 offen offset:1024 sc1
buffer_load_dword v33, v1, s[4:7], s3 offen offset:2048 sc1
buffer_load_dword v33, v1, s[4:7], s3 offen offset:3072 sc1
s_waitcnt lgkmcnt(0)
s_waitcnt vmcnt(25)
s_barrier
ds_write_b128 v2, v[60:63] offset:8192
ds_write_b128 v2, v[64:67] offset:9216
ds_write_b128 v2, v[68:71] offset:10240
ds_write_b128 v2, v[72:75] offset:11264
ds_read_b64_tr_b16 v[60:61], v44 offset:12288
ds_read_b64_tr_b16 v[62:63], v44 offset:13312
ds_read_b64_tr_b16 v[64:65], v46 offset:12288
ds_read_b64_tr_b16 v[66:67], v46 offset:13312
ds_read_b64_tr_b16 v[68:69], v45 offset:12288
ds_read_b64_tr_b16 v[70:71], v45 offset:13312
ds_read_b64_tr_b16 v[72:73], v47 offset:12288
ds_read_b64_tr_b16 v[74:75], v47 offset:13312
s_waitcnt lgkmcnt(0)
s_waitcnt vmcnt(21)
s_barrier
ds_write_b128 v2, v[60:63] offset:12288
ds_write_b128 v2, v[64:67] offset:13312
ds_write_b128 v2, v[68:71] offset:14336
ds_write_b128 v2, v[72:75] offset:15360
ds_read_b64_tr_b16 v[60:61], v44 offset:16384
ds_read_b64_tr_b16 v[62:63], v44 offset:17408
ds_read_b64_tr_b16 v[64:65], v46 offset:16384
ds_read_b64_tr_b16 v[66:67], v46 offset:17408
ds_read_b64_tr_b16 v[68:69], v45 offset:16384
ds_read_b64_tr_b16 v[70:71], v45 offset:17408
ds_read_b64_tr_b16 v[72:73], v47 offset:16384
ds_read_b64_tr_b16 v[74:75], v47 offset:17408
s_waitcnt lgkmcnt(0)
s_waitcnt vmcnt(17)
s_barrier
ds_write_b128 v2, v[60:63] offset:16384
ds_write_b128 v2, v[64:67] offset:17408
ds_write_b128 v2, v[68:71] offset:18432
ds_write_b128 v2, v[72:75] offset:19456
ds_read_b64_tr_b16 v[60:61], v48 offset:20480
ds_read_b64_tr_b16 v[62:63], v48 offset:21504
ds_read_b64_tr_b16 v[64:65], v48 offset:22528
ds_read_b64_tr_b16 v[66:67], v48 offset:23552
ds_read_b64_tr_b16 v[68:69], v49 offset:20480
ds_read_b64_tr_b16 v[70:71], v49 offset:21504
ds_read_b64_tr_b16 v[72:73], v49 offset:22528
ds_read_b64_tr_b16 v[74:75], v49 offset:23552
s_waitcnt lgkmcnt(0)
s_waitcnt vmcnt(13)
s_barrier
ds_write_b128 v2, v[60:63] offset:20480
ds_write_b128 v2, v[64:67] offset:21504
ds_write_b128 v2, v[68:71] offset:22528
ds_write_b128 v2, v[72:75] offset:23552
ds_read_b64_tr_b16 v[60:61], v48 offset:24576
ds_read_b64_tr_b16 v[62:63], v48 offset:25600
ds_read_b64_tr_b16 v[64:65], v48 offset:26624
ds_read_b64_tr_b16 v[66:67], v48 offset:27648
ds_read_b64_tr_b16 v[68:69], v49 offset:24576
ds_read_b64_tr_b16 v[70:71], v49 offset:25600
ds_read_b64_tr_b16 v[72:73], v49 offset:26624
ds_read_b64_tr_b16 v[74:75], v49 offset:27648
s_waitcnt lgkmcnt(0)
s_waitcnt vmcnt(9)
s_barrier
ds_write_b128 v2, v[60:63] offset:24576
ds_write_b128 v2, v[64:67] offset:25600
ds_write_b128 v2, v[68:71] offset:26624
ds_write_b128 v2, v[72:75] offset:27648
ds_read_b64_tr_b16 v[60:61], v48 offset:28672
ds_read_b64_tr_b16 v[62:63], v48 offset:29696
ds_read_b64_tr_b16 v[64:65], v48 offset:30720
ds_read_b64_tr_b16 v[66:67], v48 offset:31744
ds_read_b64_tr_b16 v[68:69], v49 offset:28672
ds_read_b64_tr_b16 v[70:71], v49 offset:29696
ds_read_b64_tr_b16 v[72:73], v49 offset:30720
ds_read_b64_tr_b16 v[74:75], v49 offset:31744
s_waitcnt lgkmcnt(0)
s_barrier
ds_write_b128 v2, v[60:63] offset:28672
ds_write_b128 v2, v[64:67] offset:29696
ds_write_b128 v2, v[68:71] offset:30720
ds_write_b128 v2, v[72:75] offset:31744
s_lshl_b32 s57, s58, 5
s_mov_b32 s0, 0x3f003f00
s_mov_b32 s1, 0x3f003f00
s_mov_b32 s58, 304128
s_cmp_eq_u32 s38, s57
s_mov_b32 s56, 0x33333333
s_mov_b32 s57, 0x33333333
s_mov_b32 s2, 0x21800000
s_mov_b32 s55, -24
s_cbranch_scc0 L_slow_w0r
v_mov_b64 v[20:21], 0
v_mov_b64 v[22:23], 0
v_mov_b64 v[24:25], 0
v_mov_b64 v[26:27], 0
v_mov_b64 v[28:29], 0
v_mov_b64 v[30:31], 0
v_mov_b64 v[32:33], 0
v_mov_b64 v[34:35], 0
v_mov_b64 v[36:37], 0
v_mov_b64 v[38:39], 0
v_mov_b64 v[40:41], 0
v_mov_b64 v[42:43], 0
ds_read_b128 v[44:47], v2 offset:0
ds_read_b128 v[48:51], v2 offset:1024
v_bfe_u32 v77, v1, 6, 1
v_lshl_add_u32 v77, v77, 3, v1
v_lshlrev_b32 v77, 1, v77
s_waitcnt vmcnt(0) lgkmcnt(0)
s_branch L_top_w0rf
L_done_w0rf:
s_mul_i32 s40, s34, 10240
s_add_u32 s40, s40, 8093696
buffer_store_dword v11, v10, s[4:7], s40 offen sc0 sc1
s_waitcnt vmcnt(0) lgkmcnt(0)
s_endpgm
L_rdv2_w0r:
buffer_load_dword v32, v24, s[28:31], 0 offen sc0 sc1
s_sub_u32 s41, s41, 1
s_cbranch_scc1 L_exit
s_waitcnt vmcnt(0)
s_branch L_rdv_w0r
L_ra0_w0rf:
s_mov_b32 m0, 1024
s_nop 0
buffer_load_dwordx4 v1, s[4:7], s47 offen offset:0 sc1 lds
buffer_load_dwordx4 v1, s[4:7], s47 offen offset:1024 sc1 lds
buffer_load_dwordx4 v1, s[4:7], s47 offen offset:2048 sc1 lds
buffer_load_dwordx4 v1, s[4:7], s47 offen offset:3072 sc1 lds
s_sub_u32 s41, s41, 1
s_cbranch_scc1 L_exit
ds_read_b128 v[44:47], v2 offset:0
ds_read_b128 v[48:51], v2 offset:1024
v_mov_b64 v[20:21], 0
v_mov_b64 v[22:23], 0
v_mov_b64 v[24:25], 0
v_mov_b64 v[26:27], 0
v_mov_b64 v[28:29], 0
v_mov_b64 v[30:31], 0
v_mov_b64 v[32:33], 0
v_mov_b64 v[34:35], 0
v_mov_b64 v[36:37], 0
v_mov_b64 v[38:39], 0
v_mov_b64 v[40:41], 0
v_mov_b64 v[42:43], 0
s_waitcnt vmcnt(0)
ds_read_b128 v[60:63], v1 offset:1024
ds_read_b128 v[64:67], v1 offset:2048
ds_read_b128 v[68:71], v1 offset:3072
ds_read_b128 v[72:75], v1 offset:4096
s_branch L_s0_w0rf
L_ra1_w0rf:
L_ra2_w0rf:
s_waitcnt lgkmcnt(0)
s_barrier
s_mov_b32 m0, 5120
s_nop 0
buffer_load_dwordx4 v1, s[4:7], s48 offen offset:0 sc1 lds
s_mov_b32 m0, 9216
s_nop 0
buffer_load_dwordx4 v1, s[4:7], s49 offen offset:0 sc1 lds
s_sub_u32 s41, s41, 1
s_cbranch_scc1 L_exit
s_waitcnt vmcnt(0)
s_barrier
ds_read_b128 v[76:79], v1 offset:5120
ds_read_b128 v[60:63], v1 offset:6144
ds_read_b128 v[64:67], v1 offset:7168
ds_read_b128 v[68:71], v1 offset:8192
ds_read_b128 v[72:75], v1 offset:9216
s_waitcnt lgkmcnt(0)
v_bitop3_b32 v6, v76, v60, s35 bitop3:0x7e
v_bitop3_b32 v6, v6, v64, s35 bitop3:0xf6
v_bitop3_b32 v6, v6, v68, s35 bitop3:0xf6
v_bitop3_b32 v6, v6, v72, s35 bitop3:0xf6
v_and_b32 v6, 1, v6
v_cmp_ne_u32 vcc, 0, v6
s_mov_b32 m0, 0
v_lshlrev_b32 v6, 3, v1
s_cbranch_vccnz L_ra2_w0rf
s_branch L_a1_w0rf
L_mx_w0rf:
s_waitcnt lgkmcnt(0)
v_max3_f32 v30, v12, v13, v28
v_max_f32 v30, v30, v29
v_mov_b32 v31, v30
s_nop 1
v_permlane16_swap_b32 v30, v31
v_max_f32 v30, v30, v31
v_mov_b32 v31, v30
s_nop 1
v_permlane32_swap_b32 v30, v31
v_max_f32 v30, v30, v31
ds_write_b32 v1, v30 offset:10240
s_waitcnt lgkmcnt(0)
s_barrier
ds_read_b128 v[32:35], v1 offset:10240
s_waitcnt lgkmcnt(0)
v_max3_f32 v32, v32, v33, v34
v_max_f32 v32, v32, v35
v_sub_f32 v14, v12, v32
v_sub_f32 v15, v13, v32
v_sub_f32 v30, v28, v32
v_sub_f32 v31, v29, v32
v_exp_f32 v14, v14
v_exp_f32 v15, v15
v_exp_f32 v30, v30
v_exp_f32 v31, v31
v_cvt_pk_bf16_f32 v14, v14, v15
v_cvt_pk_bf16_f32 v30, v30, v31
ds_write_b32 v5, v14 offset:14368
v_cndmask_b32_e64 v26, 0, v30, s[56:57]
v_cndmask_b32_e64 v27, 0, v30, s[56:57]
v_mov_b64 v[76:77], s[52:53]
v_mov_b64 v[78:79], s[52:53]
v_mov_b32_dpp v24, v26 quad_perm:[2,3,0,1] row_mask:0xf bank_mask:0xf
v_mov_b32_dpp v25, v26 quad_perm:[2,3,0,1] row_mask:0xf bank_mask:0xf
s_waitcnt lgkmcnt(0)
s_barrier
v_mov_b64 v[14:15], s[0:1]
ds_read_b128 v[16:19], v1 offset:14368
ds_read_b128 v[36:39], v1 offset:14336
s_waitcnt lgkmcnt(0)
v_mfma_f32_16x16x32_bf16 v[32:35], v[76:79], v[16:19], 0
v_mfma_f32_16x16x32_bf16 v[20:23], v[52:55], v[16:19], 0
v_mfma_f32_16x16x32_bf16 v[20:23], v[56:59], v[36:39], v[20:23]
v_mfma_f32_16x16x16_bf16 v[32:35], v[14:15], v[26:27], v[32:35]
v_mfma_f32_16x16x32_bf16 v[20:23], v[40:43], v[24:27], v[20:23]
s_nop 3
v_rcp_f32 v33, v32
s_nop 2
v_mul_f32_dpp v20, v33, v20 quad_perm:[0,1,0,1] row_mask:0xf bank_mask:0xf
v_mul_f32_dpp v21, v33, v21 quad_perm:[0,1,0,1] row_mask:0xf bank_mask:0xf
v_mul_f32_dpp v22, v33, v22 quad_perm:[0,1,0,1] row_mask:0xf bank_mask:0xf
v_mul_f32_dpp v23, v33, v23 quad_perm:[0,1,0,1] row_mask:0xf bank_mask:0xf
v_cvt_pk_bf16_f32 v20, v20, v21
v_cvt_pk_bf16_f32 v21, v22, v23
ds_write_b64 v6, v[20:21] offset:5120
v_mov_b32_dpp v16, v20 quad_perm:[0,1,0,1] row_mask:0xf bank_mask:0xf
v_mov_b32_dpp v17, v21 quad_perm:[0,1,0,1] row_mask:0xf bank_mask:0xf
v_mov_b32_dpp v18, v20 quad_perm:[2,3,2,3] row_mask:0xf bank_mask:0xf
v_mov_b32_dpp v19, v21 quad_perm:[2,3,2,3] row_mask:0xf bank_mask:0xf
v_mov_b64 v[76:77], 0
v_mov_b64 v[78:79], 0
v_mov_b64 v[36:37], 0
v_mov_b64 v[38:39], 0
v_mov_b64 v[24:25], 0
v_mov_b64 v[26:27], 0
v_mov_b64 v[32:33], 0
v_mov_b64 v[34:35], 0
s_waitcnt lgkmcnt(0)
s_branch L_mxb_w0rf

L_rr_w0rf:
buffer_load_dwordx4 v[60:63], v9, s[4:7], s3 offen offset:0 sc1
buffer_load_dwordx4 v[64:67], v9, s[4:7], s3 offen offset:1024 sc1
buffer_load_dwordx4 v[68:71], v9, s[4:7], s3 offen offset:2048 sc1
buffer_load_dwordx4 v[72:75], v9, s[4:7], s3 offen offset:3072 sc1
s_sub_u32 s41, s41, 1
s_cbranch_scc1 L_exit
s_waitcnt vmcnt(0)
s_branch L_r_w0rf
L_slow_w0r:
v_mov_b64 v[20:21], 0
v_mov_b64 v[22:23], 0
v_mov_b64 v[24:25], 0
v_mov_b64 v[26:27], 0
v_mov_b64 v[28:29], 0
v_mov_b64 v[30:31], 0
v_mov_b64 v[32:33], 0
v_mov_b64 v[34:35], 0
v_mov_b64 v[36:37], 0
v_mov_b64 v[38:39], 0
v_mov_b64 v[40:41], 0
v_mov_b64 v[42:43], 0
ds_read_b128 v[44:47], v2 offset:0
ds_read_b128 v[48:51], v2 offset:1024
v_bfe_u32 v77, v1, 6, 1
v_lshl_add_u32 v77, v77, 3, v1
v_lshlrev_b32 v77, 1, v77
s_waitcnt vmcnt(0) lgkmcnt(0)
s_branch L_top_w0rs
L_done_w0rs:
s_mul_i32 s40, s34, 10240
s_add_u32 s40, s40, 8093696
buffer_store_dword v11, v10, s[4:7], s40 offen sc0 sc1
s_waitcnt vmcnt(0) lgkmcnt(0)
s_endpgm
L_ra0_w0rs:
s_mov_b32 m0, 1024
s_nop 0
buffer_load_dwordx4 v1, s[4:7], s47 offen offset:0 sc0 sc1 lds
buffer_load_dwordx4 v1, s[4:7], s47 offen offset:1024 sc0 sc1 lds
buffer_load_dwordx4 v1, s[4:7], s47 offen offset:2048 sc0 sc1 lds
buffer_load_dwordx4 v1, s[4:7], s47 offen offset:3072 sc0 sc1 lds
s_sub_u32 s41, s41, 1
s_cbranch_scc1 L_exit
ds_read_b128 v[44:47], v2 offset:0
ds_read_b128 v[48:51], v2 offset:1024
v_mov_b64 v[20:21], 0
v_mov_b64 v[22:23], 0
v_mov_b64 v[24:25], 0
v_mov_b64 v[26:27], 0
v_mov_b64 v[28:29], 0
v_mov_b64 v[30:31], 0
v_mov_b64 v[32:33], 0
v_mov_b64 v[34:35], 0
v_mov_b64 v[36:37], 0
v_mov_b64 v[38:39], 0
v_mov_b64 v[40:41], 0
v_mov_b64 v[42:43], 0
s_waitcnt vmcnt(0)
ds_read_b128 v[60:63], v1 offset:1024
ds_read_b128 v[64:67], v1 offset:2048
ds_read_b128 v[68:71], v1 offset:3072
ds_read_b128 v[72:75], v1 offset:4096
s_branch L_s0_w0rs
L_ra1_w0rs:
L_ra2_w0rs:
s_waitcnt lgkmcnt(0)
s_barrier
s_mov_b32 m0, 5120
s_nop 0
buffer_load_dwordx4 v1, s[4:7], s48 offen offset:0 sc0 sc1 lds
s_mov_b32 m0, 9216
s_nop 0
buffer_load_dwordx4 v1, s[4:7], s49 offen offset:0 sc0 sc1 lds
s_sub_u32 s41, s41, 1
s_cbranch_scc1 L_exit
s_waitcnt vmcnt(0)
s_barrier
ds_read_b128 v[76:79], v1 offset:5120
ds_read_b128 v[60:63], v1 offset:6144
ds_read_b128 v[64:67], v1 offset:7168
ds_read_b128 v[68:71], v1 offset:8192
ds_read_b128 v[72:75], v1 offset:9216
s_waitcnt lgkmcnt(0)
v_bitop3_b32 v6, v76, v60, s35 bitop3:0x7e
v_bitop3_b32 v6, v6, v64, s35 bitop3:0xf6
v_bitop3_b32 v6, v6, v68, s35 bitop3:0xf6
v_bitop3_b32 v6, v6, v72, s35 bitop3:0xf6
v_and_b32 v6, 1, v6
v_cmp_ne_u32 vcc, 0, v6
s_mov_b32 m0, 0
v_lshlrev_b32 v6, 3, v1
s_cbranch_vccnz L_ra2_w0rs
s_branch L_a1_w0rs
L_mx_w0rs:
s_waitcnt lgkmcnt(0)
v_max3_f32 v30, v12, v13, v28
v_max_f32 v30, v30, v29
v_mov_b32 v31, v30
s_nop 1
v_permlane16_swap_b32 v30, v31
v_max_f32 v30, v30, v31
v_mov_b32 v31, v30
s_nop 1
v_permlane32_swap_b32 v30, v31
v_max_f32 v30, v30, v31
ds_write_b32 v1, v30 offset:10240
s_waitcnt lgkmcnt(0)
s_barrier
ds_read_b128 v[32:35], v1 offset:10240
s_waitcnt lgkmcnt(0)
v_max3_f32 v32, v32, v33, v34
v_max_f32 v32, v32, v35
v_sub_f32 v14, v12, v32
v_sub_f32 v15, v13, v32
v_sub_f32 v30, v28, v32
v_sub_f32 v31, v29, v32
v_exp_f32 v14, v14
v_exp_f32 v15, v15
v_exp_f32 v30, v30
v_exp_f32 v31, v31
v_cvt_pk_bf16_f32 v14, v14, v15
v_cvt_pk_bf16_f32 v30, v30, v31
ds_write_b32 v5, v14 offset:14368
v_cndmask_b32_e64 v26, 0, v30, s[56:57]
v_cndmask_b32_e64 v27, 0, v30, s[56:57]
v_mov_b64 v[76:77], s[52:53]
v_mov_b64 v[78:79], s[52:53]
v_mov_b32_dpp v24, v26 quad_perm:[2,3,0,1] row_mask:0xf bank_mask:0xf
v_mov_b32_dpp v25, v26 quad_perm:[2,3,0,1] row_mask:0xf bank_mask:0xf
s_waitcnt lgkmcnt(0)
s_barrier
v_mov_b64 v[14:15], s[0:1]
ds_read_b128 v[16:19], v1 offset:14368
ds_read_b128 v[36:39], v1 offset:14336
s_waitcnt lgkmcnt(0)
v_mfma_f32_16x16x32_bf16 v[32:35], v[76:79], v[16:19], 0
v_mfma_f32_16x16x32_bf16 v[20:23], v[52:55], v[16:19], 0
v_mfma_f32_16x16x32_bf16 v[20:23], v[56:59], v[36:39], v[20:23]
v_mfma_f32_16x16x16_bf16 v[32:35], v[14:15], v[26:27], v[32:35]
v_mfma_f32_16x16x32_bf16 v[20:23], v[40:43], v[24:27], v[20:23]
s_nop 3
v_rcp_f32 v33, v32
s_nop 2
v_mul_f32_dpp v20, v33, v20 quad_perm:[0,1,0,1] row_mask:0xf bank_mask:0xf
v_mul_f32_dpp v21, v33, v21 quad_perm:[0,1,0,1] row_mask:0xf bank_mask:0xf
v_mul_f32_dpp v22, v33, v22 quad_perm:[0,1,0,1] row_mask:0xf bank_mask:0xf
v_mul_f32_dpp v23, v33, v23 quad_perm:[0,1,0,1] row_mask:0xf bank_mask:0xf
v_cvt_pk_bf16_f32 v20, v20, v21
v_cvt_pk_bf16_f32 v21, v22, v23
ds_write_b64 v6, v[20:21] offset:5120
v_mov_b32_dpp v16, v20 quad_perm:[0,1,0,1] row_mask:0xf bank_mask:0xf
v_mov_b32_dpp v17, v21 quad_perm:[0,1,0,1] row_mask:0xf bank_mask:0xf
v_mov_b32_dpp v18, v20 quad_perm:[2,3,2,3] row_mask:0xf bank_mask:0xf
v_mov_b32_dpp v19, v21 quad_perm:[2,3,2,3] row_mask:0xf bank_mask:0xf
v_mov_b64 v[76:77], 0
v_mov_b64 v[78:79], 0
v_mov_b64 v[36:37], 0
v_mov_b64 v[38:39], 0
v_mov_b64 v[24:25], 0
v_mov_b64 v[26:27], 0
v_mov_b64 v[32:33], 0
v_mov_b64 v[34:35], 0
s_waitcnt lgkmcnt(0)
s_branch L_mxb_w0rs

L_rr_w0rs:
buffer_load_dwordx4 v[60:63], v9, s[4:7], s3 offen offset:0 sc0 sc1
buffer_load_dwordx4 v[64:67], v9, s[4:7], s3 offen offset:1024 sc0 sc1
buffer_load_dwordx4 v[68:71], v9, s[4:7], s3 offen offset:2048 sc0 sc1
buffer_load_dwordx4 v[72:75], v9, s[4:7], s3 offen offset:3072 sc0 sc1
s_sub_u32 s41, s41, 1
s_cbranch_scc1 L_exit
s_waitcnt vmcnt(0)
s_branch L_r_w0rs
L_pro_w1r:
v_and_b32 v20, 63, v0
v_lshlrev_b32 v1, 4, v20
v_add_u32 v2, 57344, v1
v_and_b32 v23, 1, v22
v_lshl_add_u32 v23, v24, 4, v23
v_mul_u32_u24 v23, 1152, v23
v_lshlrev_b32 v28, 2, v22
v_xor_b32 v28, v28, v21
v_lshl_add_u32 v28, v28, 4, v23
s_mul_i32 s55, s32, 147456
s_waitcnt lgkmcnt(0)
v_and_b32 v23, 1, v22
v_lshrrev_b32 v24, 2, v21
v_lshl_add_u32 v23, v23, 2, v24
v_lshlrev_b32 v23, 1, v23
v_bfe_u32 v44, v21, 1, 1
v_add_u32 v44, 4, v44
v_xor_b32 v44, v44, v23
v_lshlrev_b32 v44, 4, v44
v_lshl_add_u32 v44, v24, 8, v44
v_and_b32 v23, 1, v22
v_lshl_add_u32 v44, v23, 11, v44
v_and_b32 v23, 1, v21
v_lshl_add_u32 v44, v23, 3, v44
v_lshrrev_b32 v23, 1, v22
v_mul_u32_u24 v23, 40960, v23
v_add_u32 v23, 16384, v23
v_add_u32 v44, v44, v23
v_and_b32 v23, 1, v22
v_lshrrev_b32 v24, 2, v21
v_lshl_add_u32 v23, v23, 2, v24
v_lshlrev_b32 v23, 1, v23
v_bfe_u32 v45, v21, 1, 1
v_add_u32 v45, 6, v45
v_xor_b32 v45, v45, v23
v_lshlrev_b32 v45, 4, v45
v_lshl_add_u32 v45, v24, 8, v45
v_and_b32 v23, 1, v22
v_lshl_add_u32 v45, v23, 11, v45
v_and_b32 v23, 1, v21
v_lshl_add_u32 v45, v23, 3, v45
v_lshrrev_b32 v23, 1, v22
v_mul_u32_u24 v23, 40960, v23
v_add_u32 v23, 16384, v23
v_add_u32 v45, v45, v23
v_and_b32 v23, 1, v22
v_lshrrev_b32 v24, 2, v21
v_lshl_add_u32 v23, v23, 2, v24
v_lshlrev_b32 v23, 1, v23
v_bfe_u32 v46, v21, 1, 1
v_add_u32 v46, 4, v46
v_xor_b32 v46, v46, v23
v_lshlrev_b32 v46, 4, v46
v_lshl_add_u32 v46, v24, 8, v46
v_and_b32 v23, 1, v22
v_lshl_add_u32 v46, v23, 11, v46
v_and_b32 v23, 1, v21
v_lshl_add_u32 v46, v23, 3, v46
v_lshrrev_b32 v23, 1, v22
v_mul_u32_u24 v23, 32768, v23
v_add_u32 v23, 98304, v23
v_add_u32 v46, v46, v23
v_and_b32 v23, 1, v22
v_lshrrev_b32 v24, 2, v21
v_lshl_add_u32 v23, v23, 2, v24
v_lshlrev_b32 v23, 1, v23
v_bfe_u32 v47, v21, 1, 1
v_add_u32 v47, 6, v47
v_xor_b32 v47, v47, v23
v_lshlrev_b32 v47, 4, v47
v_lshl_add_u32 v47, v24, 8, v47
v_and_b32 v23, 1, v22
v_lshl_add_u32 v47, v23, 11, v47
v_and_b32 v23, 1, v21
v_lshl_add_u32 v47, v23, 3, v47
v_lshrrev_b32 v23, 1, v22
v_mul_u32_u24 v23, 32768, v23
v_add_u32 v23, 98304, v23
v_add_u32 v47, v47, v23
v_and_b32 v23, 1, v22
v_bfe_u32 v24, v21, 2, 1
v_lshl_add_u32 v23, v23, 1, v24
v_xor_b32 v24, 1, v23
v_lshlrev_b32 v24, 6, v24
v_lshl_add_u32 v48, v23, 8, v24
v_and_b32 v23, 3, v21
v_lshl_add_u32 v48, v23, 4, v48
v_and_b32 v23, 8, v21
v_add_u32 v48, v48, v23
v_lshrrev_b32 v23, 1, v22
v_mul_u32_u24 v23, 40960, v23
v_add_u32 v23, 16384, v23
v_add_u32 v48, v48, v23
v_and_b32 v23, 1, v22
v_bfe_u32 v24, v21, 2, 1
v_lshl_add_u32 v23, v23, 1, v24
v_xor_b32 v24, 1, v23
v_lshlrev_b32 v24, 6, v24
v_lshl_add_u32 v49, v23, 8, v24
v_and_b32 v23, 3, v21
v_lshl_add_u32 v49, v23, 4, v49
v_and_b32 v23, 8, v21
v_add_u32 v49, v49, v23
v_lshrrev_b32 v23, 1, v22
v_mul_u32_u24 v23, 32768, v23
v_add_u32 v23, 98304, v23
v_add_u32 v49, v49, v23
v_bfe_u32 v23, v21, 1, 1
v_mul_u32_u24 v23, 0xaaaa, v23
v_add_u32 v0, 0x4444, v23
v_lshlrev_b32 v3, 3, v20
v_lshrrev_b32 v25, 5, v20
v_lshlrev_b32 v25, 6, v25
v_xor_b32 v3, v3, v25
v_lshrrev_b32 v25, 2, v20
v_and_b32 v4, 3, v21
v_lshl_add_u32 v4, v4, 4, v25
v_lshlrev_b32 v4, 3, v4
v_bfe_u32 v25, v21, 1, 1
v_lshlrev_b32 v23, 6, v25
v_xor_b32 v4, v4, v23
v_lshlrev_b32 v5, 4, v21
v_lshl_add_u32 v5, v22, 2, v5
v_mul_u32_u24 v23, 768, v25
v_add_u32 v5, v5, v23
v_lshlrev_b32 v9, 8, v22
v_lshl_add_u32 v9, v25, 6, v9
v_bfe_u32 v23, v21, 3, 1
v_lshl_add_u32 v9, v23, 7, v9
v_bfe_u32 v23, v21, 2, 1
v_lshl_add_u32 v9, v23, 5, v9
v_and_b32 v23, 1, v21
v_lshl_add_u32 v9, v23, 4, v9
v_lshrrev_b32 v23, 1, v22
v_and_b32 v24, 1, v22
v_and_b32 v25, 7, v21
v_lshrrev_b32 v7, 3, v21
v_lshl_add_u32 v8, v7, 1, v23
v_lshlrev_b32 v8, 12, v8
v_lshl_add_u32 v8, v24, 7, v8
v_and_b32 v25, 4, v21
v_lshl_add_u32 v8, v25, 3, v8
v_and_b32 v25, 1, v21
v_lshl_add_u32 v8, v25, 4, v8
v_bfe_u32 v25, v21, 1, 1
v_lshl_add_u32 v8, v25, 3, v8
s_lshr_b32 s56, s32, 1
s_lshl_b32 s56, s56, 8
s_and_b32 s57, s32, 1
s_lshl_b32 s57, s57, 6
s_add_u32 s56, s56, s57
s_add_u32 s56, s56, 16384
v_add_u32 v8, s56, v8
v_and_b32 v7, 0x3d0, v1
s_mov_b32 s42, 0
s_mov_b32 s43, 65536
s_mov_b32 s44, 131072
s_mov_b32 s45, 196608
s_mov_b32 s46, 262144
s_mov_b32 s47, 294912
s_mov_b32 s48, 299008
s_mov_b32 s49, 303104
s_mov_b32 s50, 0x3e0293ee
s_mov_b32 s51, 0x3e0293ee
s_mov_b32 s52, 0x3f803f80
s_mov_b32 s53, 0x3f803f80
v_and_b32 v11, 3, v21
v_cmp_eq_u32 vcc, 0, v11
s_nop 1
v_cndmask_b32 v11, 0, 1, vcc
s_mov_b32 s34, 0
s_mov_b32 s35, -1
s_mov_b32 s36, 0
s_mov_b32 s41, 300000
s_lshl_b32 s37, s32, 14
s_add_u32 s39, s37, 17309696
s_add_u32 s37, s37, 16781312
s_mov_b32 s40, 8749056
v_mov_b64 v[36:37], 0
v_mov_b64 v[38:39], 0
ds_write_b128 v1, v[36:39] offset:15360
s_lshl_b32 s56, s32, 1
s_add_u32 s56, s56, 0
s_cmp_eq_u32 s56, 0
s_cselect_b32 s56, 64, s56
s_mul_i32 s56, s56, 10240
s_add_u32 s56, s56, 8392704
s_add_u32 s57, s56, 4096
v_mov_b32 v40, 0
v_mov_b32 v41, 0
v_mov_b32 v42, 0
v_mov_b32 v43, 0
buffer_store_dwordx4 v[40:43], v1, s[4:7], s56 offen offset:0 sc0 sc1
buffer_store_dwordx4 v[40:43], v1, s[4:7], s56 offen offset:1024 sc0 sc1
buffer_store_dwordx4 v[40:43], v1, s[4:7], s56 offen offset:2048 sc0 sc1
buffer_store_dwordx4 v[40:43], v1, s[4:7], s56 offen offset:3072 sc0 sc1
buffer_store_dwordx4 v[40:43], v1, s[4:7], s57 offen offset:0 sc0 sc1
s_add_u32 s56, s32, 32
s_lshl_b32 s3, s56, 12
v_and_b32 v23, 1, v21
v_bfe_u32 v24, v21, 2, 1
v_bfe_u32 v25, v21, 1, 1
s_lshl_b32 s57, s56, 7
s_add_u32 s57, s57, 294912
v_and_b32 v10, 7, v21
v_lshlrev_b32 v10, 2, v10
v_lshl_add_u32 v10, v22, 5, v10
v_add_u32 v10, s57, v10
s_lshl_b32 s33, s56, 2
s_add_u32 s33, s33, 304128
v_mov_b32 v30, -1
s_mov_b64 exec, 1
buffer_store_dword v30, v1, s[4:7], s33 offen sc0 sc1
s_mov_b64 exec, -1
v_lshl_add_u32 v23, v23, 1, v24
v_lshlrev_b32 v25, 4, v25
v_mov_b32 v24, 0x3f80
v_lshlrev_b32 v24, v25, v24
v_cmp_eq_u32 vcc, 0, v23
s_nop 1
v_cndmask_b32 v76, 0, v24, vcc
v_cmp_eq_u32 vcc, 1, v23
s_nop 1
v_cndmask_b32 v77, 0, v24, vcc
v_cmp_eq_u32 vcc, 2, v23
s_nop 1
v_cndmask_b32 v78, 0, v24, vcc
v_cmp_eq_u32 vcc, 3, v23
s_nop 1
v_cndmask_b32 v79, 0, v24, vcc
buffer_store_dwordx4 v[36:39], v9, s[4:7], s3 offen offset:0 sc0 sc1
buffer_store_dwordx4 v[36:39], v9, s[4:7], s3 offen offset:1024 sc0 sc1
buffer_store_dwordx4 v[36:39], v9, s[4:7], s3 offen offset:2048 sc0 sc1
buffer_store_dwordx4 v[36:39], v9, s[4:7], s3 offen offset:3072 sc0 sc1
s_getreg_b32 s56, hwreg(HW_REG_XCC_ID)
s_and_b32 s56, s56, 15
s_mul_i32 s57, s56, s56
s_lshl_b32 s57, s57, 18
s_lshl_b32 s56, s56, 8
s_add_u32 s57, s57, s56
s_add_u32 s58, s57, 1
s_lshl_b32 s101, s32, 7
s_add_u32 s101, s101, 327680
v_mov_b32 v24, 0
s_add_u32 s56, s54, 131072
s_mov_b32 m0, 69632
s_nop 0
buffer_load_dwordx4 v26, s[12:15], s56 offen lds
s_add_u32 s56, s54, 147456
s_mov_b32 m0, 70656
s_nop 0
buffer_load_dwordx4 v26, s[12:15], s56 offen lds
s_add_u32 s56, s54, 163840
s_mov_b32 m0, 71680
s_nop 0
buffer_load_dwordx4 v27, s[12:15], s56 offen lds
s_add_u32 s56, s54, 180224
s_mov_b32 m0, 72704
s_nop 0
buffer_load_dwordx4 v27, s[12:15], s56 offen lds
s_add_u32 s56, s54, 655360
s_mov_b32 m0, 73728
s_nop 0
buffer_load_dwordx4 v26, s[12:15], s56 offen lds
s_add_u32 s56, s54, 671744
s_mov_b32 m0, 74752
s_nop 0
buffer_load_dwordx4 v26, s[12:15], s56 offen lds
s_add_u32 s56, s54, 688128
s_mov_b32 m0, 75776
s_nop 0
buffer_load_dwordx4 v27, s[12:15], s56 offen lds
s_add_u32 s56, s54, 704512
s_mov_b32 m0, 76800
s_nop 0
buffer_load_dwordx4 v27, s[12:15], s56 offen lds
v_and_b32 v23, 3, v20
v_lshrrev_b32 v24, 2, v20
v_mul_u32_u24 v29, 1152, v24
v_lshl_add_u32 v29, v23, 4, v29
v_lshrrev_b32 v24, 2, v21
v_and_b32 v25, 1, v22
v_lshlrev_b32 v31, 10, v25
v_lshrrev_b32 v25, 1, v22
v_lshl_add_u32 v31, v25, 8, v31
v_and_b32 v25, 1, v24
v_lshl_add_u32 v31, v25, 6, v31
v_lshrrev_b32 v25, 1, v24
v_lshl_add_u32 v31, v25, 3, v31
v_lshl_add_u32 v31, v23, 4, v31
v_add_u32 v31, 57344, v31
s_add_u32 s56, s55, 1088
s_mov_b32 m0, 90112
s_nop 0
buffer_load_dwordx4 v29, s[20:23], s56 offen lds
s_add_u32 s56, s55, 19520
s_mov_b32 m0, 91136
s_nop 0
buffer_load_dwordx4 v29, s[20:23], s56 offen lds
s_add_u32 s56, s55, 37952
s_mov_b32 m0, 92160
s_nop 0
buffer_load_dwordx4 v29, s[20:23], s56 offen lds
s_add_u32 s56, s55, 56384
s_mov_b32 m0, 93184
s_nop 0
buffer_load_dwordx4 v29, s[20:23], s56 offen lds
s_add_u32 s56, s55, 74816
s_mov_b32 m0, 94208
s_nop 0
buffer_load_dwordx4 v29, s[20:23], s56 offen lds
s_add_u32 s56, s55, 93248
s_mov_b32 m0, 95232
s_nop 0
buffer_load_dwordx4 v29, s[20:23], s56 offen lds
s_add_u32 s56, s55, 111680
s_mov_b32 m0, 96256
s_nop 0
buffer_load_dwordx4 v29, s[20:23], s56 offen lds
s_add_u32 s56, s55, 130112
s_mov_b32 m0, 97280
s_nop 0
buffer_load_dwordx4 v29, s[20:23], s56 offen lds
v_mov_b32 v24, 0
s_waitcnt vmcnt(46)
s_barrier
ds_read_b64_tr_b16 v[80:81], v44 offset:20480
ds_read_b64_tr_b16 v[82:83], v44 offset:21504
ds_read_b64_tr_b16 v[84:85], v46 offset:20480
ds_read_b64_tr_b16 v[86:87], v46 offset:21504
ds_read_b64_tr_b16 v[88:89], v45 offset:20480
ds_read_b64_tr_b16 v[90:91], v45 offset:21504
ds_read_b64_tr_b16 v[92:93], v47 offset:20480
ds_read_b64_tr_b16 v[94:95], v47 offset:21504
s_waitcnt lgkmcnt(0)
s_waitcnt vmcnt(42)
s_barrier
s_add_u32 s56, s54, 1179648
s_mov_b32 m0, 77824
s_nop 0
buffer_load_dwordx4 v26, s[12:15], s56 offen lds
s_add_u32 s56, s54, 1196032
s_mov_b32 m0, 78848
s_nop 0
buffer_load_dwordx4 v26, s[12:15], s56 offen lds
s_add_u32 s56, s54, 1212416
s_mov_b32 m0, 79872
s_nop 0
buffer_load_dwordx4 v27, s[12:15], s56 offen lds
s_add_u32 s56, s54, 1228800
s_mov_b32 m0, 80896
s_nop 0
buffer_load_dwordx4 v27, s[12:15], s56 offen lds
ds_read_b64_tr_b16 v[96:97], v44 offset:24576
ds_read_b64_tr_b16 v[98:99], v44 offset:25600
ds_read_b64_tr_b16 v[100:101], v46 offset:24576
ds_read_b64_tr_b16 v[102:103], v46 offset:25600
ds_read_b64_tr_b16 v[104:105], v45 offset:24576
ds_read_b64_tr_b16 v[106:107], v45 offset:25600
ds_read_b64_tr_b16 v[108:109], v47 offset:24576
ds_read_b64_tr_b16 v[110:111], v47 offset:25600
s_waitcnt lgkmcnt(0)
s_waitcnt vmcnt(42)
s_barrier
s_add_u32 s56, s54, 1703936
s_mov_b32 m0, 81920
s_nop 0
buffer_load_dwordx4 v26, s[12:15], s56 offen lds
s_add_u32 s56, s54, 1720320
s_mov_b32 m0, 82944
s_nop 0
buffer_load_dwordx4 v26, s[12:15], s56 offen lds
s_add_u32 s56, s54, 1736704
s_mov_b32 m0, 83968
s_nop 0
buffer_load_dwordx4 v27, s[12:15], s56 offen lds
s_add_u32 s56, s54, 1753088
s_mov_b32 m0, 84992
s_nop 0
buffer_load_dwordx4 v27, s[12:15], s56 offen lds
ds_read_b64_tr_b16 v[112:113], v44 offset:28672
ds_read_b64_tr_b16 v[114:115], v44 offset:29696
ds_read_b64_tr_b16 v[116:117], v46 offset:28672
ds_read_b64_tr_b16 v[118:119], v46 offset:29696
ds_read_b64_tr_b16 v[120:121], v45 offset:28672
ds_read_b64_tr_b16 v[122:123], v45 offset:29696
ds_read_b64_tr_b16 v[124:125], v47 offset:28672
ds_read_b64_tr_b16 v[126:127], v47 offset:29696
s_waitcnt lgkmcnt(0)
s_waitcnt vmcnt(42)
s_barrier
s_add_u32 s56, s54, 2228224
s_mov_b32 m0, 86016
s_nop 0
buffer_load_dwordx4 v26, s[12:15], s56 offen lds
s_add_u32 s56, s54, 2244608
s_mov_b32 m0, 87040
s_nop 0
buffer_load_dwordx4 v26, s[12:15], s56 offen lds
s_add_u32 s56, s54, 2260992
s_mov_b32 m0, 88064
s_nop 0
buffer_load_dwordx4 v27, s[12:15], s56 offen lds
s_add_u32 s56, s54, 2277376
s_mov_b32 m0, 89088
s_nop 0
buffer_load_dwordx4 v27, s[12:15], s56 offen lds
ds_read_b64_tr_b16 v[128:129], v44 offset:0
ds_read_b64_tr_b16 v[130:131], v44 offset:1024
ds_read_b64_tr_b16 v[132:133], v46 offset:0
ds_read_b64_tr_b16 v[134:135], v46 offset:1024
ds_read_b64_tr_b16 v[136:137], v45 offset:0
ds_read_b64_tr_b16 v[138:139], v45 offset:1024
ds_read_b64_tr_b16 v[140:141], v47 offset:0
ds_read_b64_tr_b16 v[142:143], v47 offset:1024
s_waitcnt lgkmcnt(0)
s_waitcnt vmcnt(42)
s_barrier
s_add_u32 s56, s54, 3276800
s_mov_b32 m0, 57344
s_nop 0
buffer_load_dwordx4 v26, s[12:15], s56 offen lds
s_add_u32 s56, s54, 3293184
s_mov_b32 m0, 58368
s_nop 0
buffer_load_dwordx4 v26, s[12:15], s56 offen lds
s_add_u32 s56, s54, 3309568
s_mov_b32 m0, 59392
s_nop 0
buffer_load_dwordx4 v27, s[12:15], s56 offen lds
s_add_u32 s56, s54, 3325952
s_mov_b32 m0, 60416
s_nop 0
buffer_load_dwordx4 v27, s[12:15], s56 offen lds
ds_read_b64_tr_b16 v[144:145], v44 offset:4096
ds_read_b64_tr_b16 v[146:147], v44 offset:5120
ds_read_b64_tr_b16 v[148:149], v46 offset:4096
ds_read_b64_tr_b16 v[150:151], v46 offset:5120
ds_read_b64_tr_b16 v[152:153], v45 offset:4096
ds_read_b64_tr_b16 v[154:155], v45 offset:5120
ds_read_b64_tr_b16 v[156:157], v47 offset:4096
ds_read_b64_tr_b16 v[158:159], v47 offset:5120
s_waitcnt lgkmcnt(0)
s_waitcnt vmcnt(42)
s_barrier
s_add_u32 s56, s54, 3801088
s_mov_b32 m0, 61440
s_nop 0
buffer_load_dwordx4 v26, s[12:15], s56 offen lds
s_add_u32 s56, s54, 3817472
s_mov_b32 m0, 62464
s_nop 0
buffer_load_dwordx4 v26, s[12:15], s56 offen lds
s_add_u32 s56, s54, 3833856
s_mov_b32 m0, 63488
s_nop 0
buffer_load_dwordx4 v27, s[12:15], s56 offen lds
s_add_u32 s56, s54, 3850240
s_mov_b32 m0, 64512
s_nop 0
buffer_load_dwordx4 v27, s[12:15], s56 offen lds
ds_read_b64_tr_b16 v[160:161], v44 offset:8192
ds_read_b64_tr_b16 v[162:163], v44 offset:9216
ds_read_b64_tr_b16 v[164:165], v46 offset:8192
ds_read_b64_tr_b16 v[166:167], v46 offset:9216
ds_read_b64_tr_b16 v[168:169], v45 offset:8192
ds_read_b64_tr_b16 v[170:171], v45 offset:9216
ds_read_b64_tr_b16 v[172:173], v47 offset:8192
ds_read_b64_tr_b16 v[174:175], v47 offset:9216
s_waitcnt lgkmcnt(0)
s_waitcnt vmcnt(32)
s_barrier
s_add_u32 s56, s54, 4325376
s_mov_b32 m0, 65536
s_nop 0
buffer_load_dwordx4 v26, s[12:15], s56 offen lds
s_add_u32 s56, s54, 4341760
s_mov_b32 m0, 66560
s_nop 0
buffer_load_dwordx4 v26, s[12:15], s56 offen lds
s_add_u32 s56, s54, 4358144
s_mov_b32 m0, 67584
s_nop 0
buffer_load_dwordx4 v27, s[12:15], s56 offen lds
s_add_u32 s56, s54, 4374528
s_mov_b32 m0, 68608
s_nop 0
buffer_load_dwordx4 v27, s[12:15], s56 offen lds
ds_read_b64_tr_b16 v[176:177], v44 offset:12288
ds_read_b64_tr_b16 v[178:179], v44 offset:13312
ds_read_b64_tr_b16 v[180:181], v46 offset:12288
ds_read_b64_tr_b16 v[182:183], v46 offset:13312
ds_read_b64_tr_b16 v[184:185], v45 offset:12288
ds_read_b64_tr_b16 v[186:187], v45 offset:13312
ds_read_b64_tr_b16 v[188:189], v47 offset:12288
ds_read_b64_tr_b16 v[190:191], v47 offset:13312
s_waitcnt lgkmcnt(0)
s_waitcnt vmcnt(32)
s_barrier
s_add_u32 s56, s54, 131072
s_mov_b32 m0, 69632
s_nop 0
buffer_load_dwordx4 v26, s[16:19], s56 offen lds
s_add_u32 s56, s54, 147456
s_mov_b32 m0, 70656
s_nop 0
buffer_load_dwordx4 v26, s[16:19], s56 offen lds
s_add_u32 s56, s54, 163840
s_mov_b32 m0, 71680
s_nop 0
buffer_load_dwordx4 v27, s[16:19], s56 offen lds
s_add_u32 s56, s54, 180224
s_mov_b32 m0, 72704
s_nop 0
buffer_load_dwordx4 v27, s[16:19], s56 offen lds
ds_read_b64_tr_b16 v[192:193], v44 offset:16384
ds_read_b64_tr_b16 v[194:195], v44 offset:17408
ds_read_b64_tr_b16 v[196:197], v46 offset:16384
ds_read_b64_tr_b16 v[198:199], v46 offset:17408
ds_read_b64_tr_b16 v[200:201], v45 offset:16384
ds_read_b64_tr_b16 v[202:203], v45 offset:17408
ds_read_b64_tr_b16 v[204:205], v47 offset:16384
ds_read_b64_tr_b16 v[206:207], v47 offset:17408
s_waitcnt lgkmcnt(0)
s_waitcnt vmcnt(24)
s_barrier
s_add_u32 s56, s54, 655360
s_mov_b32 m0, 73728
s_nop 0
buffer_load_dwordx4 v26, s[16:19], s56 offen lds
s_add_u32 s56, s54, 671744
s_mov_b32 m0, 74752
s_nop 0
buffer_load_dwordx4 v26, s[16:19], s56 offen lds
s_add_u32 s56, s54, 688128
s_mov_b32 m0, 75776
s_nop 0
buffer_load_dwordx4 v27, s[16:19], s56 offen lds
s_add_u32 s56, s54, 704512
s_mov_b32 m0, 76800
s_nop 0
buffer_load_dwordx4 v27, s[16:19], s56 offen lds
ds_read_b64_tr_b16 v[208:209], v44 offset:20480
ds_read_b64_tr_b16 v[210:211], v44 offset:21504
ds_read_b64_tr_b16 v[212:213], v46 offset:20480
ds_read_b64_tr_b16 v[214:215], v46 offset:21504
ds_read_b64_tr_b16 v[216:217], v45 offset:20480
ds_read_b64_tr_b16 v[218:219], v45 offset:21504
ds_read_b64_tr_b16 v[220:221], v47 offset:20480
ds_read_b64_tr_b16 v[222:223], v47 offset:21504
s_waitcnt lgkmcnt(0)
s_waitcnt vmcnt(24)
s_barrier
s_add_u32 s56, s54, 1179648
s_mov_b32 m0, 77824
s_nop 0
buffer_load_dwordx4 v26, s[16:19], s56 offen lds
s_add_u32 s56, s54, 1196032
s_mov_b32 m0, 78848
s_nop 0
buffer_load_dwordx4 v26, s[16:19], s56 offen lds
s_add_u32 s56, s54, 1212416
s_mov_b32 m0, 79872
s_nop 0
buffer_load_dwordx4 v27, s[16:19], s56 offen lds
s_add_u32 s56, s54, 1228800
s_mov_b32 m0, 80896
s_nop 0
buffer_load_dwordx4 v27, s[16:19], s56 offen lds
ds_read_b64_tr_b16 v[224:225], v44 offset:24576
ds_read_b64_tr_b16 v[226:227], v44 offset:25600
ds_read_b64_tr_b16 v[228:229], v46 offset:24576
ds_read_b64_tr_b16 v[230:231], v46 offset:25600
ds_read_b64_tr_b16 v[232:233], v45 offset:24576
ds_read_b64_tr_b16 v[234:235], v45 offset:25600
ds_read_b64_tr_b16 v[236:237], v47 offset:24576
ds_read_b64_tr_b16 v[238:239], v47 offset:25600
ds_read_b64_tr_b16 v[60:61], v31 offset:32768
ds_read_b64_tr_b16 v[62:63], v31 offset:32896
ds_read_b64_tr_b16 v[64:65], v31 offset:33280
ds_read_b64_tr_b16 v[66:67], v31 offset:33408
ds_read_b64_tr_b16 v[68:69], v31 offset:34816
ds_read_b64_tr_b16 v[70:71], v31 offset:34944
ds_read_b64_tr_b16 v[72:73], v31 offset:35328
ds_read_b64_tr_b16 v[74:75], v31 offset:35456
s_waitcnt lgkmcnt(0)
ds_write_b128 v2, v[60:63] offset:32768
ds_write_b128 v2, v[64:67] offset:33792
ds_write_b128 v2, v[68:71] offset:34816
ds_write_b128 v2, v[72:75] offset:35840
s_waitcnt lgkmcnt(0)
s_waitcnt vmcnt(24)
s_barrier
s_add_u32 s56, s54, 1703936
s_mov_b32 m0, 81920
s_nop 0
buffer_load_dwordx4 v26, s[16:19], s56 offen lds
s_add_u32 s56, s54, 1720320
s_mov_b32 m0, 82944
s_nop 0
buffer_load_dwordx4 v26, s[16:19], s56 offen lds
s_add_u32 s56, s54, 1736704
s_mov_b32 m0, 83968
s_nop 0
buffer_load_dwordx4 v27, s[16:19], s56 offen lds
s_add_u32 s56, s54, 1753088
s_mov_b32 m0, 84992
s_nop 0
buffer_load_dwordx4 v27, s[16:19], s56 offen lds
ds_read_b64_tr_b16 v[240:241], v44 offset:28672
ds_read_b64_tr_b16 v[242:243], v44 offset:29696
ds_read_b64_tr_b16 v[244:245], v46 offset:28672
ds_read_b64_tr_b16 v[246:247], v46 offset:29696
ds_read_b64_tr_b16 v[248:249], v45 offset:28672
ds_read_b64_tr_b16 v[250:251], v45 offset:29696
ds_read_b64_tr_b16 v[252:253], v47 offset:28672
ds_read_b64_tr_b16 v[254:255], v47 offset:29696
ds_read_b64_tr_b16 v[60:61], v31 offset:36864
ds_read_b64_tr_b16 v[62:63], v31 offset:36992
ds_read_b64_tr_b16 v[64:65], v31 offset:37376
ds_read_b64_tr_b16 v[66:67], v31 offset:37504
ds_read_b64_tr_b16 v[68:69], v31 offset:38912
ds_read_b64_tr_b16 v[70:71], v31 offset:39040
ds_read_b64_tr_b16 v[72:73], v31 offset:39424
ds_read_b64_tr_b16 v[74:75], v31 offset:39552
s_waitcnt lgkmcnt(0)
ds_write_b128 v2, v[60:63] offset:36864
ds_write_b128 v2, v[64:67] offset:37888
ds_write_b128 v2, v[68:71] offset:38912
ds_write_b128 v2, v[72:75] offset:39936
s_waitcnt lgkmcnt(0)
s_waitcnt vmcnt(24)
s_barrier
s_add_u32 s56, s54, 2228224
s_mov_b32 m0, 86016
s_nop 0
buffer_load_dwordx4 v26, s[16:19], s56 offen lds
s_add_u32 s56, s54, 2244608
s_mov_b32 m0, 87040
s_nop 0
buffer_load_dwordx4 v26, s[16:19], s56 offen lds
s_add_u32 s56, s54, 2260992
s_mov_b32 m0, 88064
s_nop 0
buffer_load_dwordx4 v27, s[16:19], s56 offen lds
s_add_u32 s56, s54, 2277376
s_mov_b32 m0, 89088
s_nop 0
buffer_load_dwordx4 v27, s[16:19], s56 offen lds
ds_read_b64_tr_b16 a[0:1], v44 offset:0
ds_read_b64_tr_b16 a[2:3], v44 offset:1024
ds_read_b64_tr_b16 a[4:5], v46 offset:0
ds_read_b64_tr_b16 a[6:7], v46 offset:1024
ds_read_b64_tr_b16 a[8:9], v45 offset:0
ds_read_b64_tr_b16 a[10:11], v45 offset:1024
ds_read_b64_tr_b16 a[12:13], v47 offset:0
ds_read_b64_tr_b16 a[14:15], v47 offset:1024
s_waitcnt lgkmcnt(0)
s_waitcnt vmcnt(24)
s_barrier
s_add_u32 s56, s54, 2752512
s_mov_b32 m0, 57344
s_nop 0
buffer_load_dwordx4 v26, s[16:19], s56 offen lds
s_add_u32 s56, s54, 2768896
s_mov_b32 m0, 58368
s_nop 0
buffer_load_dwordx4 v26, s[16:19], s56 offen lds
s_add_u32 s56, s54, 2785280
s_mov_b32 m0, 59392
s_nop 0
buffer_load_dwordx4 v27, s[16:19], s56 offen lds
s_add_u32 s56, s54, 2801664
s_mov_b32 m0, 60416
s_nop 0
buffer_load_dwordx4 v27, s[16:19], s56 offen lds
ds_read_b64_tr_b16 a[16:17], v44 offset:4096
ds_read_b64_tr_b16 a[18:19], v44 offset:5120
ds_read_b64_tr_b16 a[20:21], v46 offset:4096
ds_read_b64_tr_b16 a[22:23], v46 offset:5120
ds_read_b64_tr_b16 a[24:25], v45 offset:4096
ds_read_b64_tr_b16 a[26:27], v45 offset:5120
ds_read_b64_tr_b16 a[28:29], v47 offset:4096
ds_read_b64_tr_b16 a[30:31], v47 offset:5120
s_waitcnt lgkmcnt(0)
s_waitcnt vmcnt(24)
s_barrier
s_add_u32 s56, s54, 3276800
s_mov_b32 m0, 61440
s_nop 0
buffer_load_dwordx4 v26, s[16:19], s56 offen lds
s_add_u32 s56, s54, 3293184
s_mov_b32 m0, 62464
s_nop 0
buffer_load_dwordx4 v26, s[16:19], s56 offen lds
s_add_u32 s56, s54, 3309568
s_mov_b32 m0, 63488
s_nop 0
buffer_load_dwordx4 v27, s[16:19], s56 offen lds
s_add_u32 s56, s54, 3325952
s_mov_b32 m0, 64512
s_nop 0
buffer_load_dwordx4 v27, s[16:19], s56 offen lds
ds_read_b64_tr_b16 a[32:33], v44 offset:8192
ds_read_b64_tr_b16 a[34:35], v44 offset:9216
ds_read_b64_tr_b16 a[36:37], v46 offset:8192
ds_read_b64_tr_b16 a[38:39], v46 offset:9216
ds_read_b64_tr_b16 a[40:41], v45 offset:8192
ds_read_b64_tr_b16 a[42:43], v45 offset:9216
ds_read_b64_tr_b16 a[44:45], v47 offset:8192
ds_read_b64_tr_b16 a[46:47], v47 offset:9216
s_waitcnt lgkmcnt(0)
s_waitcnt vmcnt(24)
s_barrier
s_add_u32 s56, s54, 3801088
s_mov_b32 m0, 65536
s_nop 0
buffer_load_dwordx4 v26, s[16:19], s56 offen lds
s_add_u32 s56, s54, 3817472
s_mov_b32 m0, 66560
s_nop 0
buffer_load_dwordx4 v26, s[16:19], s56 offen lds
s_add_u32 s56, s54, 3833856
s_mov_b32 m0, 67584
s_nop 0
buffer_load_dwordx4 v27, s[16:19], s56 offen lds
s_add_u32 s56, s54, 3850240
s_mov_b32 m0, 68608
s_nop 0
buffer_load_dwordx4 v27, s[16:19], s56 offen lds
ds_read_b64_tr_b16 a[48:49], v44 offset:12288
ds_read_b64_tr_b16 a[50:51], v44 offset:13312
ds_read_b64_tr_b16 a[52:53], v46 offset:12288
ds_read_b64_tr_b16 a[54:55], v46 offset:13312
ds_read_b64_tr_b16 a[56:57], v45 offset:12288
ds_read_b64_tr_b16 a[58:59], v45 offset:13312
ds_read_b64_tr_b16 a[60:61], v47 offset:12288
ds_read_b64_tr_b16 a[62:63], v47 offset:13312
s_waitcnt lgkmcnt(0)
s_waitcnt vmcnt(24)
s_barrier
s_add_u32 s56, s55, 78336
s_mov_b32 m0, 69632
s_nop 0
buffer_load_dwordx4 v28, s[20:23], s56 offen lds
s_add_u32 s56, s55, 80640
s_mov_b32 m0, 70656
s_nop 0
buffer_load_dwordx4 v28, s[20:23], s56 offen lds
s_add_u32 s56, s55, 87552
s_mov_b32 m0, 71680
s_nop 0
buffer_load_dwordx4 v28, s[20:23], s56 offen lds
s_add_u32 s56, s55, 89856
s_mov_b32 m0, 72704
s_nop 0
buffer_load_dwordx4 v28, s[20:23], s56 offen lds
ds_read_b64_tr_b16 a[64:65], v44 offset:16384
ds_read_b64_tr_b16 a[66:67], v44 offset:17408
ds_read_b64_tr_b16 a[68:69], v46 offset:16384
ds_read_b64_tr_b16 a[70:71], v46 offset:17408
ds_read_b64_tr_b16 a[72:73], v45 offset:16384
ds_read_b64_tr_b16 a[74:75], v45 offset:17408
ds_read_b64_tr_b16 a[76:77], v47 offset:16384
ds_read_b64_tr_b16 a[78:79], v47 offset:17408
s_waitcnt lgkmcnt(0)
s_waitcnt vmcnt(24)
s_barrier
s_add_u32 s56, s55, 78592
s_mov_b32 m0, 73728
s_nop 0
buffer_load_dwordx4 v28, s[20:23], s56 offen lds
s_add_u32 s56, s55, 80896
s_mov_b32 m0, 74752
s_nop 0
buffer_load_dwordx4 v28, s[20:23], s56 offen lds
s_add_u32 s56, s55, 87808
s_mov_b32 m0, 75776
s_nop 0
buffer_load_dwordx4 v28, s[20:23], s56 offen lds
s_add_u32 s56, s55, 90112
s_mov_b32 m0, 76800
s_nop 0
buffer_load_dwordx4 v28, s[20:23], s56 offen lds
ds_read_b64_tr_b16 a[80:81], v44 offset:20480
ds_read_b64_tr_b16 a[82:83], v44 offset:21504
ds_read_b64_tr_b16 a[84:85], v46 offset:20480
ds_read_b64_tr_b16 a[86:87], v46 offset:21504
ds_read_b64_tr_b16 a[88:89], v45 offset:20480
ds_read_b64_tr_b16 a[90:91], v45 offset:21504
ds_read_b64_tr_b16 a[92:93], v47 offset:20480
ds_read_b64_tr_b16 a[94:95], v47 offset:21504
s_waitcnt lgkmcnt(0)
s_waitcnt vmcnt(24)
s_barrier
s_add_u32 s56, s55, 78848
s_mov_b32 m0, 77824
s_nop 0
buffer_load_dwordx4 v28, s[20:23], s56 offen lds
s_add_u32 s56, s55, 81152
s_mov_b32 m0, 78848
s_nop 0
buffer_load_dwordx4 v28, s[20:23], s56 offen lds
s_add_u32 s56, s55, 88064
s_mov_b32 m0, 79872
s_nop 0
buffer_load_dwordx4 v28, s[20:23], s56 offen lds
s_add_u32 s56, s55, 90368
s_mov_b32 m0, 80896
s_nop 0
buffer_load_dwordx4 v28, s[20:23], s56 offen lds
ds_read_b64_tr_b16 a[96:97], v44 offset:24576
ds_read_b64_tr_b16 a[98:99], v44 offset:25600
ds_read_b64_tr_b16 a[100:101], v46 offset:24576
ds_read_b64_tr_b16 a[102:103], v46 offset:25600
ds_read_b64_tr_b16 a[104:105], v45 offset:24576
ds_read_b64_tr_b16 a[106:107], v45 offset:25600
ds_read_b64_tr_b16 a[108:109], v47 offset:24576
ds_read_b64_tr_b16 a[110:111], v47 offset:25600
s_waitcnt lgkmcnt(0)
s_waitcnt vmcnt(24)
s_barrier
s_add_u32 s56, s55, 79104
s_mov_b32 m0, 81920
s_nop 0
buffer_load_dwordx4 v28, s[20:23], s56 offen lds
s_add_u32 s56, s55, 81408
s_mov_b32 m0, 82944
s_nop 0
buffer_load_dwordx4 v28, s[20:23], s56 offen lds
s_add_u32 s56, s55, 88320
s_mov_b32 m0, 83968
s_nop 0
buffer_load_dwordx4 v28, s[20:23], s56 offen lds
s_add_u32 s56, s55, 90624
s_mov_b32 m0, 84992
s_nop 0
buffer_load_dwordx4 v28, s[20:23], s56 offen lds
ds_read_b64_tr_b16 a[112:113], v44 offset:28672
ds_read_b64_tr_b16 a[114:115], v44 offset:29696
ds_read_b64_tr_b16 a[116:117], v46 offset:28672
ds_read_b64_tr_b16 a[118:119], v46 offset:29696
ds_read_b64_tr_b16 a[120:121], v45 offset:28672
ds_read_b64_tr_b16 a[122:123], v45 offset:29696
ds_read_b64_tr_b16 a[124:125], v47 offset:28672
ds_read_b64_tr_b16 a[126:127], v47 offset:29696
s_waitcnt lgkmcnt(0)
s_waitcnt vmcnt(24)
s_barrier
s_add_u32 s56, s55, 4608
s_mov_b32 m0, 86016
s_nop 0
buffer_load_dwordx4 v28, s[20:23], s56 offen lds
s_add_u32 s56, s55, 6912
s_mov_b32 m0, 87040
s_nop 0
buffer_load_dwordx4 v28, s[20:23], s56 offen lds
s_add_u32 s56, s55, 13824
s_mov_b32 m0, 88064
s_nop 0
buffer_load_dwordx4 v28, s[20:23], s56 offen lds
s_add_u32 s56, s55, 16128
s_mov_b32 m0, 89088
s_nop 0
buffer_load_dwordx4 v28, s[20:23], s56 offen lds
ds_read_b64_tr_b16 a[128:129], v44 offset:0
ds_read_b64_tr_b16 a[130:131], v44 offset:1024
ds_read_b64_tr_b16 a[132:133], v46 offset:0
ds_read_b64_tr_b16 a[134:135], v46 offset:1024
ds_read_b64_tr_b16 a[136:137], v45 offset:0
ds_read_b64_tr_b16 a[138:139], v45 offset:1024
ds_read_b64_tr_b16 a[140:141], v47 offset:0
ds_read_b64_tr_b16 a[142:143], v47 offset:1024
buffer_load_dword v32, v24, s[28:31], 0 offen sc0 sc1
s_waitcnt lgkmcnt(0)
s_waitcnt vmcnt(25)
s_barrier
s_add_u32 s56, s54, 131072
s_mov_b32 m0, 57344
s_nop 0
buffer_load_dwordx4 v26, s[8:11], s56 offen lds
s_add_u32 s56, s54, 147456
s_mov_b32 m0, 58368
s_nop 0
buffer_load_dwordx4 v26, s[8:11], s56 offen lds
s_add_u32 s56, s54, 163840
s_mov_b32 m0, 59392
s_nop 0
buffer_load_dwordx4 v27, s[8:11], s56 offen lds
s_add_u32 s56, s54, 180224
s_mov_b32 m0, 60416
s_nop 0
buffer_load_dwordx4 v27, s[8:11], s56 offen lds
ds_read_b64_tr_b16 a[144:145], v44 offset:4096
ds_read_b64_tr_b16 a[146:147], v44 offset:5120
ds_read_b64_tr_b16 a[148:149], v46 offset:4096
ds_read_b64_tr_b16 a[150:151], v46 offset:5120
ds_read_b64_tr_b16 a[152:153], v45 offset:4096
ds_read_b64_tr_b16 a[154:155], v45 offset:5120
ds_read_b64_tr_b16 a[156:157], v47 offset:4096
ds_read_b64_tr_b16 a[158:159], v47 offset:5120
s_waitcnt lgkmcnt(0)
s_waitcnt vmcnt(25)
s_barrier
s_add_u32 s56, s54, 1703936
s_mov_b32 m0, 61440
s_nop 0
buffer_load_dwordx4 v26, s[8:11], s56 offen lds
s_add_u32 s56, s54, 1720320
s_mov_b32 m0, 62464
s_nop 0
buffer_load_dwordx4 v26, s[8:11], s56 offen lds
s_add_u32 s56, s54, 1736704
s_mov_b32 m0, 63488
s_nop 0
buffer_load_dwordx4 v27, s[8:11], s56 offen lds
s_add_u32 s56, s54, 1753088
s_mov_b32 m0, 64512
s_nop 0
buffer_load_dwordx4 v27, s[8:11], s56 offen lds
ds_read_b64_tr_b16 a[160:161], v44 offset:8192
ds_read_b64_tr_b16 a[162:163], v44 offset:9216
ds_read_b64_tr_b16 a[164:165], v46 offset:8192
ds_read_b64_tr_b16 a[166:167], v46 offset:9216
ds_read_b64_tr_b16 a[168:169], v45 offset:8192
ds_read_b64_tr_b16 a[170:171], v45 offset:9216
ds_read_b64_tr_b16 a[172:173], v47 offset:8192
ds_read_b64_tr_b16 a[174:175], v47 offset:9216
s_waitcnt lgkmcnt(0)
s_waitcnt vmcnt(25)
s_barrier
s_add_u32 s56, s54, 2228224
s_mov_b32 m0, 65536
s_nop 0
buffer_load_dwordx4 v26, s[8:11], s56 offen lds
s_add_u32 s56, s54, 2244608
s_mov_b32 m0, 66560
s_nop 0
buffer_load_dwordx4 v26, s[8:11], s56 offen lds
s_add_u32 s56, s54, 2260992
s_mov_b32 m0, 67584
s_nop 0
buffer_load_dwordx4 v27, s[8:11], s56 offen lds
s_add_u32 s56, s54, 2277376
s_mov_b32 m0, 68608
s_nop 0
buffer_load_dwordx4 v27, s[8:11], s56 offen lds
ds_read_b64_tr_b16 a[200:201], v48 offset:12288
ds_read_b64_tr_b16 a[202:203], v48 offset:13312
ds_read_b64_tr_b16 a[204:205], v48 offset:14336
ds_read_b64_tr_b16 a[206:207], v48 offset:15360
ds_read_b64_tr_b16 a[184:185], v49 offset:12288
ds_read_b64_tr_b16 a[186:187], v49 offset:13312
ds_read_b64_tr_b16 a[188:189], v49 offset:14336
ds_read_b64_tr_b16 a[190:191], v49 offset:15360
s_waitcnt lgkmcnt(0)
s_waitcnt vmcnt(25)
s_barrier
s_add_u32 s56, s54, 2752512
s_mov_b32 m0, 69632
s_nop 0
buffer_load_dwordx4 v26, s[12:15], s56 offen lds
s_add_u32 s56, s54, 2768896
s_mov_b32 m0, 70656
s_nop 0
buffer_load_dwordx4 v26, s[12:15], s56 offen lds
s_add_u32 s56, s54, 2785280
s_mov_b32 m0, 71680
s_nop 0
buffer_load_dwordx4 v27, s[12:15], s56 offen lds
s_add_u32 s56, s54, 2801664
s_mov_b32 m0, 72704
s_nop 0
buffer_load_dwordx4 v27, s[12:15], s56 offen lds
ds_read_b64_tr_b16 a[216:217], v48 offset:16384
ds_read_b64_tr_b16 a[218:219], v48 offset:17408
ds_read_b64_tr_b16 a[220:221], v48 offset:18432
ds_read_b64_tr_b16 a[222:223], v48 offset:19456
ds_read_b64_tr_b16 a[208:209], v49 offset:16384
ds_read_b64_tr_b16 a[210:211], v49 offset:17408
ds_read_b64_tr_b16 a[212:213], v49 offset:18432
ds_read_b64_tr_b16 a[214:215], v49 offset:19456
s_waitcnt lgkmcnt(0)
s_waitcnt vmcnt(25)
s_barrier
s_add_u32 s56, s54, 4325376
s_mov_b32 m0, 73728
s_nop 0
buffer_load_dwordx4 v26, s[16:19], s56 offen lds
s_add_u32 s56, s54, 4341760
s_mov_b32 m0, 74752
s_nop 0
buffer_load_dwordx4 v26, s[16:19], s56 offen lds
s_add_u32 s56, s54, 4358144
s_mov_b32 m0, 75776
s_nop 0
buffer_load_dwordx4 v27, s[16:19], s56 offen lds
s_add_u32 s56, s54, 4374528
s_mov_b32 m0, 76800
s_nop 0
buffer_load_dwordx4 v27, s[16:19], s56 offen lds
ds_read_b64_tr_b16 a[232:233], v48 offset:20480
ds_read_b64_tr_b16 a[234:235], v48 offset:21504
ds_read_b64_tr_b16 a[236:237], v48 offset:22528
ds_read_b64_tr_b16 a[238:239], v48 offset:23552
ds_read_b64_tr_b16 a[224:225], v49 offset:20480
ds_read_b64_tr_b16 a[226:227], v49 offset:21504
ds_read_b64_tr_b16 a[228:229], v49 offset:22528
ds_read_b64_tr_b16 a[230:231], v49 offset:23552
s_waitcnt lgkmcnt(0)
s_waitcnt vmcnt(25)
s_barrier
s_add_u32 s56, s55, 4864
s_mov_b32 m0, 77824
s_nop 0
buffer_load_dwordx4 v28, s[20:23], s56 offen lds
s_add_u32 s56, s55, 7168
s_mov_b32 m0, 78848
s_nop 0
buffer_load_dwordx4 v28, s[20:23], s56 offen lds
s_add_u32 s56, s55, 14080
s_mov_b32 m0, 79872
s_nop 0
buffer_load_dwordx4 v28, s[20:23], s56 offen lds
s_add_u32 s56, s55, 16384
s_mov_b32 m0, 80896
s_nop 0
buffer_load_dwordx4 v28, s[20:23], s56 offen lds
ds_read_b64_tr_b16 a[248:249], v48 offset:24576
ds_read_b64_tr_b16 a[250:251], v48 offset:25600
ds_read_b64_tr_b16 a[252:253], v48 offset:26624
ds_read_b64_tr_b16 a[254:255], v48 offset:27648
ds_read_b64_tr_b16 a[240:241], v49 offset:24576
ds_read_b64_tr_b16 a[242:243], v49 offset:25600
ds_read_b64_tr_b16 a[244:245], v49 offset:26624
ds_read_b64_tr_b16 a[246:247], v49 offset:27648
s_waitcnt lgkmcnt(0)
s_waitcnt vmcnt(25)
s_barrier
s_add_u32 s56, s55, 5120
s_mov_b32 m0, 81920
s_nop 0
buffer_load_dwordx4 v28, s[20:23], s56 offen lds
s_add_u32 s56, s55, 7424
s_mov_b32 m0, 82944
s_nop 0
buffer_load_dwordx4 v28, s[20:23], s56 offen lds
s_add_u32 s56, s55, 14336
s_mov_b32 m0, 83968
s_nop 0
buffer_load_dwordx4 v28, s[20:23], s56 offen lds
s_add_u32 s56, s55, 16640
s_mov_b32 m0, 84992
s_nop 0
buffer_load_dwordx4 v28, s[20:23], s56 offen lds
ds_read_b64_tr_b16 a[192:193], v48 offset:28672
ds_read_b64_tr_b16 a[194:195], v48 offset:29696
ds_read_b64_tr_b16 a[196:197], v48 offset:30720
ds_read_b64_tr_b16 a[198:199], v48 offset:31744
ds_read_b64_tr_b16 a[176:177], v49 offset:28672
ds_read_b64_tr_b16 a[178:179], v49 offset:29696
ds_read_b64_tr_b16 a[180:181], v49 offset:30720
ds_read_b64_tr_b16 a[182:183], v49 offset:31744
s_waitcnt lgkmcnt(0)
s_waitcnt vmcnt(24)
s_barrier
s_add_u32 s56, s55, 5376
s_mov_b32 m0, 86016
s_nop 0
buffer_load_dwordx4 v28, s[20:23], s56 offen lds
s_add_u32 s56, s55, 7680
s_mov_b32 m0, 87040
s_nop 0
buffer_load_dwordx4 v28, s[20:23], s56 offen lds
s_add_u32 s56, s55, 14592
s_mov_b32 m0, 88064
s_nop 0
buffer_load_dwordx4 v28, s[20:23], s56 offen lds
s_add_u32 s56, s55, 16896
s_mov_b32 m0, 89088
s_nop 0
buffer_load_dwordx4 v28, s[20:23], s56 offen lds
ds_read_b64_tr_b16 v[60:61], v44 offset:0
ds_read_b64_tr_b16 v[62:63], v44 offset:1024
ds_read_b64_tr_b16 v[64:65], v46 offset:0
ds_read_b64_tr_b16 v[66:67], v46 offset:1024
ds_read_b64_tr_b16 v[68:69], v45 offset:0
ds_read_b64_tr_b16 v[70:71], v45 offset:1024
ds_read_b64_tr_b16 v[72:73], v47 offset:0
ds_read_b64_tr_b16 v[74:75], v47 offset:1024
s_waitcnt lgkmcnt(0)
s_waitcnt vmcnt(24)
s_barrier
ds_write_b128 v2, v[60:63] offset:0
ds_write_b128 v2, v[64:67] offset:1024
ds_write_b128 v2, v[68:71] offset:2048
ds_write_b128 v2, v[72:75] offset:3072
ds_read_b64_tr_b16 v[60:61], v44 offset:4096
ds_read_b64_tr_b16 v[62:63], v44 offset:5120
ds_read_b64_tr_b16 v[64:65], v46 offset:4096
ds_read_b64_tr_b16 v[66:67], v46 offset:5120
ds_read_b64_tr_b16 v[68:69], v45 offset:4096
ds_read_b64_tr_b16 v[70:71], v45 offset:5120
ds_read_b64_tr_b16 v[72:73], v47 offset:4096
ds_read_b64_tr_b16 v[74:75], v47 offset:5120
L_rdv_w1r:
v_readfirstlane_b32 s38, v32
s_nop 0
s_and_b32 s57, s38, 0xff
s_cmp_lg_u32 s57, 32
s_cbranch_scc1 L_rdv2_w1r
s_waitcnt lgkmcnt(0)
s_waitcnt vmcnt(20)
s_barrier
ds_write_b128 v2, v[60:63] offset:4096
ds_write_b128 v2, v[64:67] offset:5120
ds_write_b128 v2, v[68:71] offset:6144
ds_write_b128 v2, v[72:75] offset:7168
ds_read_b64_tr_b16 v[60:61], v44 offset:8192
ds_read_b64_tr_b16 v[62:63], v44 offset:9216
ds_read_b64_tr_b16 v[64:65], v46 offset:8192
ds_read_b64_tr_b16 v[66:67], v46 offset:9216
ds_read_b64_tr_b16 v[68:69], v45 offset:8192
ds_read_b64_tr_b16 v[70:71], v45 offset:9216
ds_read_b64_tr_b16 v[72:73], v47 offset:8192
ds_read_b64_tr_b16 v[74:75], v47 offset:9216
buffer_load_dwordx4 v[12:15], v9, s[4:7], s37 offen offset:0
buffer_load_dwordx4 v[16:19], v9, s[4:7], s37 offen offset:1024
buffer_load_dwordx4 v[52:55], v1, s[4:7], s37 offen offset:2048
buffer_load_dwordx4 v[56:59], v1, s[4:7], s37 offen offset:3072
s_mov_b32 m0, 1024
s_nop 0
buffer_load_dwordx4 v1, s[4:7], s47 offen offset:1024 sc1 lds
buffer_load_dword v33, v1, s[4:7], s3 offen offset:0 sc1
buffer_load_dword v33, v1, s[4:7], s3 offen offset:1024 sc1
buffer_load_dword v33, v1, s[4:7], s3 offen offset:2048 sc1
buffer_load_dword v33, v1, s[4:7], s3 offen offset:3072 sc1
s_waitcnt lgkmcnt(0)
s_waitcnt vmcnt(25)
s_barrier
ds_write_b128 v2, v[60:63] offset:8192
ds_write_b128 v2, v[64:67] offset:9216
ds_write_b128 v2, v[68:71] offset:10240
ds_write_b128 v2, v[72:75] offset:11264
ds_read_b64_tr_b16 v[60:61], v44 offset:12288
ds_read_b64_tr_b16 v[62:63], v44 offset:13312
ds_read_b64_tr_b16 v[64:65], v46 offset:12288
ds_read_b64_tr_b16 v[66:67], v46 offset:13312
ds_read_b64_tr_b16 v[68:69], v45 offset:12288
ds_read_b64_tr_b16 v[70:71], v45 offset:13312
ds_read_b64_tr_b16 v[72:73], v47 offset:12288
ds_read_b64_tr_b16 v[74:75], v47 offset:13312
s_waitcnt lgkmcnt(0)
s_waitcnt vmcnt(21)
s_barrier
ds_write_b128 v2, v[60:63] offset:12288
ds_write_b128 v2, v[64:67] offset:13312
ds_write_b128 v2, v[68:71] offset:14336
ds_write_b128 v2, v[72:75] offset:15360
ds_read_b64_tr_b16 v[60:61], v44 offset:16384
ds_read_b64_tr_b16 v[62:63], v44 offset:17408
ds_read_b64_tr_b16 v[64:65], v46 offset:16384
ds_read_b64_tr_b16 v[66:67], v46 offset:17408
ds_read_b64_tr_b16 v[68:69], v45 offset:16384
ds_read_b64_tr_b16 v[70:71], v45 offset:17408
ds_read_b64_tr_b16 v[72:73], v47 offset:16384
ds_read_b64_tr_b16 v[74:75], v47 offset:17408
s_waitcnt lgkmcnt(0)
s_waitcnt vmcnt(17)
s_barrier
ds_write_b128 v2, v[60:63] offset:16384
ds_write_b128 v2, v[64:67] offset:17408
ds_write_b128 v2, v[68:71] offset:18432
ds_write_b128 v2, v[72:75] offset:19456
ds_read_b64_tr_b16 v[60:61], v48 offset:20480
ds_read_b64_tr_b16 v[62:63], v48 offset:21504
ds_read_b64_tr_b16 v[64:65], v48 offset:22528
ds_read_b64_tr_b16 v[66:67], v48 offset:23552
ds_read_b64_tr_b16 v[68:69], v49 offset:20480
ds_read_b64_tr_b16 v[70:71], v49 offset:21504
ds_read_b64_tr_b16 v[72:73], v49 offset:22528
ds_read_b64_tr_b16 v[74:75], v49 offset:23552
s_waitcnt lgkmcnt(0)
s_waitcnt vmcnt(13)
s_barrier
ds_write_b128 v2, v[60:63] offset:20480
ds_write_b128 v2, v[64:67] offset:21504
ds_write_b128 v2, v[68:71] offset:22528
ds_write_b128 v2, v[72:75] offset:23552
ds_read_b64_tr_b16 v[60:61], v48 offset:24576
ds_read_b64_tr_b16 v[62:63], v48 offset:25600
ds_read_b64_tr_b16 v[64:65], v48 offset:26624
ds_read_b64_tr_b16 v[66:67], v48 offset:27648
ds_read_b64_tr_b16 v[68:69], v49 offset:24576
ds_read_b64_tr_b16 v[70:71], v49 offset:25600
ds_read_b64_tr_b16 v[72:73], v49 offset:26624
ds_read_b64_tr_b16 v[74:75], v49 offset:27648
s_waitcnt lgkmcnt(0)
s_waitcnt vmcnt(9)
s_barrier
ds_write_b128 v2, v[60:63] offset:24576
ds_write_b128 v2, v[64:67] offset:25600
ds_write_b128 v2, v[68:71] offset:26624
ds_write_b128 v2, v[72:75] offset:27648
ds_read_b64_tr_b16 v[60:61], v48 offset:28672
ds_read_b64_tr_b16 v[62:63], v48 offset:29696
ds_read_b64_tr_b16 v[64:65], v48 offset:30720
ds_read_b64_tr_b16 v[66:67], v48 offset:31744
ds_read_b64_tr_b16 v[68:69], v49 offset:28672
ds_read_b64_tr_b16 v[70:71], v49 offset:29696
ds_read_b64_tr_b16 v[72:73], v49 offset:30720
ds_read_b64_tr_b16 v[74:75], v49 offset:31744
s_waitcnt lgkmcnt(0)
s_barrier
ds_write_b128 v2, v[60:63] offset:28672
ds_write_b128 v2, v[64:67] offset:29696
ds_write_b128 v2, v[68:71] offset:30720
ds_write_b128 v2, v[72:75] offset:31744
s_lshl_b32 s57, s58, 5
s_mov_b32 s0, 0x3f003f00
s_mov_b32 s1, 0x3f003f00
s_mov_b32 s58, 304128
s_cmp_eq_u32 s38, s57
s_mov_b32 s56, 0x33333333
s_mov_b32 s57, 0x33333333
s_mov_b32 s2, 0x21800000
s_mov_b32 s55, -24
s_cbranch_scc0 L_slow_w1r
v_mov_b64 v[20:21], 0
v_mov_b64 v[22:23], 0
v_mov_b64 v[24:25], 0
v_mov_b64 v[26:27], 0
v_mov_b64 v[28:29], 0
v_mov_b64 v[30:31], 0
v_mov_b64 v[32:33], 0
v_mov_b64 v[34:35], 0
v_mov_b64 v[36:37], 0
v_mov_b64 v[38:39], 0
v_mov_b64 v[40:41], 0
v_mov_b64 v[42:43], 0
ds_read_b128 v[44:47], v2 offset:0
ds_read_b128 v[48:51], v2 offset:1024
v_bfe_u32 v77, v1, 6, 1
v_lshl_add_u32 v77, v77, 3, v1
v_lshlrev_b32 v77, 1, v77
s_waitcnt vmcnt(0) lgkmcnt(0)
s_branch L_top_w1rf
L_done_w1rf:
s_mul_i32 s40, s34, 10240
s_add_u32 s40, s40, 8093696
buffer_store_dword v11, v10, s[4:7], s40 offen sc0 sc1
s_waitcnt vmcnt(0) lgkmcnt(0)
s_endpgm
L_rdv2_w1r:
buffer_load_dword v32, v24, s[28:31], 0 offen sc0 sc1
s_sub_u32 s41, s41, 1
s_cbranch_scc1 L_exit
s_waitcnt vmcnt(0)
s_branch L_rdv_w1r
L_ra0_w1rf:
s_mov_b32 m0, 1024
s_nop 0
buffer_load_dwordx4 v1, s[4:7], s47 offen offset:0 sc1 lds
buffer_load_dwordx4 v1, s[4:7], s47 offen offset:1024 sc1 lds
buffer_load_dwordx4 v1, s[4:7], s47 offen offset:2048 sc1 lds
buffer_load_dwordx4 v1, s[4:7], s47 offen offset:3072 sc1 lds
s_sub_u32 s41, s41, 1
s_cbranch_scc1 L_exit
ds_read_b128 v[44:47], v2 offset:0
ds_read_b128 v[48:51], v2 offset:1024
v_mov_b64 v[20:21], 0
v_mov_b64 v[22:23], 0
v_mov_b64 v[24:25], 0
v_mov_b64 v[26:27], 0
v_mov_b64 v[28:29], 0
v_mov_b64 v[30:31], 0
v_mov_b64 v[32:33], 0
v_mov_b64 v[34:35], 0
v_mov_b64 v[36:37], 0
v_mov_b64 v[38:39], 0
v_mov_b64 v[40:41], 0
v_mov_b64 v[42:43], 0
s_waitcnt vmcnt(0)
ds_read_b128 v[60:63], v1 offset:1024
ds_read_b128 v[64:67], v1 offset:2048
ds_read_b128 v[68:71], v1 offset:3072
ds_read_b128 v[72:75], v1 offset:4096
s_branch L_s0_w1rf
L_ra1_w1rf:
L_ra2_w1rf:
s_waitcnt lgkmcnt(0)
s_barrier
s_mov_b32 m0, 5120
s_nop 0
buffer_load_dwordx4 v1, s[4:7], s48 offen offset:1024 sc1 lds
s_sub_u32 s41, s41, 1
s_cbranch_scc1 L_exit
s_waitcnt vmcnt(0)
s_barrier
ds_read_b128 v[76:79], v1 offset:5120
ds_read_b128 v[60:63], v1 offset:6144
ds_read_b128 v[64:67], v1 offset:7168
ds_read_b128 v[68:71], v1 offset:8192
ds_read_b128 v[72:75], v1 offset:9216
s_waitcnt lgkmcnt(0)
v_bitop3_b32 v6, v76, v60, s35 bitop3:0x7e
v_bitop3_b32 v6, v6, v64, s35 bitop3:0xf6
v_bitop3_b32 v6, v6, v68, s35 bitop3:0xf6
v_bitop3_b32 v6, v6, v72, s35 bitop3:0xf6
v_and_b32 v6, 1, v6
v_cmp_ne_u32 vcc, 0, v6
s_mov_b32 m0, 0
v_lshlrev_b32 v6, 3, v1
s_cbranch_vccnz L_ra2_w1rf
s_branch L_a1_w1rf
L_mx_w1rf:
s_waitcnt lgkmcnt(0)
v_max3_f32 v30, v12, v13, v28
v_max_f32 v30, v30, v29
v_mov_b32 v31, v30
s_nop 1
v_permlane16_swap_b32 v30, v31
v_max_f32 v30, v30, v31
v_mov_b32 v31, v30
s_nop 1
v_permlane32_swap_b32 v30, v31
v_max_f32 v30, v30, v31
ds_write_b32 v1, v30 offset:10244
s_waitcnt lgkmcnt(0)
s_barrier
ds_read_b128 v[32:35], v1 offset:10240
s_waitcnt lgkmcnt(0)
v_max3_f32 v32, v32, v33, v34
v_max_f32 v32, v32, v35
v_sub_f32 v14, v12, v32
v_sub_f32 v15, v13, v32
v_sub_f32 v30, v28, v32
v_sub_f32 v31, v29, v32
v_exp_f32 v14, v14
v_exp_f32 v15, v15
v_exp_f32 v30, v30
v_exp_f32 v31, v31
v_cvt_pk_bf16_f32 v14, v14, v15
v_cvt_pk_bf16_f32 v30, v30, v31
ds_write_b32 v5, v14 offset:14624
v_cndmask_b32_e64 v26, 0, v30, s[56:57]
v_cndmask_b32_e64 v27, 0, v30, s[56:57]
v_mov_b64 v[76:77], s[52:53]
v_mov_b64 v[78:79], s[52:53]
v_mov_b32_dpp v24, v26 quad_perm:[2,3,0,1] row_mask:0xf bank_mask:0xf
v_mov_b32_dpp v25, v26 quad_perm:[2,3,0,1] row_mask:0xf bank_mask:0xf
s_waitcnt lgkmcnt(0)
s_barrier
v_mov_b64 v[14:15], s[0:1]
ds_read_b128 v[16:19], v1 offset:14368
ds_read_b128 v[36:39], v1 offset:14336
s_waitcnt lgkmcnt(0)
v_mfma_f32_16x16x32_bf16 v[32:35], v[76:79], v[16:19], 0
v_mfma_f32_16x16x32_bf16 v[20:23], v[52:55], v[16:19], 0
v_mfma_f32_16x16x32_bf16 v[20:23], v[56:59], v[36:39], v[20:23]
v_mfma_f32_16x16x16_bf16 v[32:35], v[14:15], v[26:27], v[32:35]
v_mfma_f32_16x16x32_bf16 v[20:23], v[40:43], v[24:27], v[20:23]
s_nop 3
v_rcp_f32 v33, v32
s_nop 2
v_mul_f32_dpp v20, v33, v20 quad_perm:[0,1,0,1] row_mask:0xf bank_mask:0xf
v_mul_f32_dpp v21, v33, v21 quad_perm:[0,1,0,1] row_mask:0xf bank_mask:0xf
v_mul_f32_dpp v22, v33, v22 quad_perm:[0,1,0,1] row_mask:0xf bank_mask:0xf
v_mul_f32_dpp v23, v33, v23 quad_perm:[0,1,0,1] row_mask:0xf bank_mask:0xf
v_cvt_pk_bf16_f32 v20, v20, v21
v_cvt_pk_bf16_f32 v21, v22, v23
ds_write_b64 v6, v[20:21] offset:6144
v_mov_b32_dpp v16, v20 quad_perm:[0,1,0,1] row_mask:0xf bank_mask:0xf
v_mov_b32_dpp v17, v21 quad_perm:[0,1,0,1] row_mask:0xf bank_mask:0xf
v_mov_b32_dpp v18, v20 quad_perm:[2,3,2,3] row_mask:0xf bank_mask:0xf
v_mov_b32_dpp v19, v21 quad_perm:[2,3,2,3] row_mask:0xf bank_mask:0xf
v_mov_b64 v[76:77], 0
v_mov_b64 v[78:79], 0
v_mov_b64 v[36:37], 0
v_mov_b64 v[38:39], 0
v_mov_b64 v[24:25], 0
v_mov_b64 v[26:27], 0
v_mov_b64 v[32:33], 0
v_mov_b64 v[34:35], 0
s_waitcnt lgkmcnt(0)
s_branch L_mxb_w1rf

L_rr_w1rf:
buffer_load_dwordx4 v[60:63], v9, s[4:7], s3 offen offset:0 sc1
buffer_load_dwordx4 v[64:67], v9, s[4:7], s3 offen offset:1024 sc1
buffer_load_dwordx4 v[68:71], v9, s[4:7], s3 offen offset:2048 sc1
buffer_load_dwordx4 v[72:75], v9, s[4:7], s3 offen offset:3072 sc1
s_sub_u32 s41, s41, 1
s_cbranch_scc1 L_exit
s_waitcnt vmcnt(0)
s_branch L_r_w1rf
L_slow_w1r:
v_mov_b64 v[20:21], 0
v_mov_b64 v[22:23], 0
v_mov_b64 v[24:25], 0
v_mov_b64 v[26:27], 0
v_mov_b64 v[28:29], 0
v_mov_b64 v[30:31], 0
v_mov_b64 v[32:33], 0
v_mov_b64 v[34:35], 0
v_mov_b64 v[36:37], 0
v_mov_b64 v[38:39], 0
v_mov_b64 v[40:41], 0
v_mov_b64 v[42:43], 0
ds_read_b128 v[44:47], v2 offset:0
ds_read_b128 v[48:51], v2 offset:1024
v_bfe_u32 v77, v1, 6, 1
v_lshl_add_u32 v77, v77, 3, v1
v_lshlrev_b32 v77, 1, v77
s_waitcnt vmcnt(0) lgkmcnt(0)
s_branch L_top_w1rs
L_done_w1rs:
s_mul_i32 s40, s34, 10240
s_add_u32 s40, s40, 8093696
buffer_store_dword v11, v10, s[4:7], s40 offen sc0 sc1
s_waitcnt vmcnt(0) lgkmcnt(0)
s_endpgm
L_ra0_w1rs:
s_mov_b32 m0, 1024
s_nop 0
buffer_load_dwordx4 v1, s[4:7], s47 offen offset:0 sc0 sc1 lds
buffer_load_dwordx4 v1, s[4:7], s47 offen offset:1024 sc0 sc1 lds
buffer_load_dwordx4 v1, s[4:7], s47 offen offset:2048 sc0 sc1 lds
buffer_load_dwordx4 v1, s[4:7], s47 offen offset:3072 sc0 sc1 lds
s_sub_u32 s41, s41, 1
s_cbranch_scc1 L_exit
ds_read_b128 v[44:47], v2 offset:0
ds_read_b128 v[48:51], v2 offset:1024
v_mov_b64 v[20:21], 0
v_mov_b64 v[22:23], 0
v_mov_b64 v[24:25], 0
v_mov_b64 v[26:27], 0
v_mov_b64 v[28:29], 0
v_mov_b64 v[30:31], 0
v_mov_b64 v[32:33], 0
v_mov_b64 v[34:35], 0
v_mov_b64 v[36:37], 0
v_mov_b64 v[38:39], 0
v_mov_b64 v[40:41], 0
v_mov_b64 v[42:43], 0
s_waitcnt vmcnt(0)
ds_read_b128 v[60:63], v1 offset:1024
ds_read_b128 v[64:67], v1 offset:2048
ds_read_b128 v[68:71], v1 offset:3072
ds_read_b128 v[72:75], v1 offset:4096
s_branch L_s0_w1rs
L_ra1_w1rs:
L_ra2_w1rs:
s_waitcnt lgkmcnt(0)
s_barrier
s_mov_b32 m0, 5120
s_nop 0
buffer_load_dwordx4 v1, s[4:7], s48 offen offset:1024 sc0 sc1 lds
s_sub_u32 s41, s41, 1
s_cbranch_scc1 L_exit
s_waitcnt vmcnt(0)
s_barrier
ds_read_b128 v[76:79], v1 offset:5120
ds_read_b128 v[60:63], v1 offset:6144
ds_read_b128 v[64:67], v1 offset:7168
ds_read_b128 v[68:71], v1 offset:8192
ds_read_b128 v[72:75], v1 offset:9216
s_waitcnt lgkmcnt(0)
v_bitop3_b32 v6, v76, v60, s35 bitop3:0x7e
v_bitop3_b32 v6, v6, v64, s35 bitop3:0xf6
v_bitop3_b32 v6, v6, v68, s35 bitop3:0xf6
v_bitop3_b32 v6, v6, v72, s35 bitop3:0xf6
v_and_b32 v6, 1, v6
v_cmp_ne_u32 vcc, 0, v6
s_mov_b32 m0, 0
v_lshlrev_b32 v6, 3, v1
s_cbranch_vccnz L_ra2_w1rs
s_branch L_a1_w1rs
L_mx_w1rs:
s_waitcnt lgkmcnt(0)
v_max3_f32 v30, v12, v13, v28
v_max_f32 v30, v30, v29
v_mov_b32 v31, v30
s_nop 1
v_permlane16_swap_b32 v30, v31
v_max_f32 v30, v30, v31
v_mov_b32 v31, v30
s_nop 1
v_permlane32_swap_b32 v30, v31
v_max_f32 v30, v30, v31
ds_write_b32 v1, v30 offset:10244
s_waitcnt lgkmcnt(0)
s_barrier
ds_read_b128 v[32:35], v1 offset:10240
s_waitcnt lgkmcnt(0)
v_max3_f32 v32, v32, v33, v34
v_max_f32 v32, v32, v35
v_sub_f32 v14, v12, v32
v_sub_f32 v15, v13, v32
v_sub_f32 v30, v28, v32
v_sub_f32 v31, v29, v32
v_exp_f32 v14, v14
v_exp_f32 v15, v15
v_exp_f32 v30, v30
v_exp_f32 v31, v31
v_cvt_pk_bf16_f32 v14, v14, v15
v_cvt_pk_bf16_f32 v30, v30, v31
ds_write_b32 v5, v14 offset:14624
v_cndmask_b32_e64 v26, 0, v30, s[56:57]
v_cndmask_b32_e64 v27, 0, v30, s[56:57]
v_mov_b64 v[76:77], s[52:53]
v_mov_b64 v[78:79], s[52:53]
v_mov_b32_dpp v24, v26 quad_perm:[2,3,0,1] row_mask:0xf bank_mask:0xf
v_mov_b32_dpp v25, v26 quad_perm:[2,3,0,1] row_mask:0xf bank_mask:0xf
s_waitcnt lgkmcnt(0)
s_barrier
v_mov_b64 v[14:15], s[0:1]
ds_read_b128 v[16:19], v1 offset:14368
ds_read_b128 v[36:39], v1 offset:14336
s_waitcnt lgkmcnt(0)
v_mfma_f32_16x16x32_bf16 v[32:35], v[76:79], v[16:19], 0
v_mfma_f32_16x16x32_bf16 v[20:23], v[52:55], v[16:19], 0
v_mfma_f32_16x16x32_bf16 v[20:23], v[56:59], v[36:39], v[20:23]
v_mfma_f32_16x16x16_bf16 v[32:35], v[14:15], v[26:27], v[32:35]
v_mfma_f32_16x16x32_bf16 v[20:23], v[40:43], v[24:27], v[20:23]
s_nop 3
v_rcp_f32 v33, v32
s_nop 2
v_mul_f32_dpp v20, v33, v20 quad_perm:[0,1,0,1] row_mask:0xf bank_mask:0xf
v_mul_f32_dpp v21, v33, v21 quad_perm:[0,1,0,1] row_mask:0xf bank_mask:0xf
v_mul_f32_dpp v22, v33, v22 quad_perm:[0,1,0,1] row_mask:0xf bank_mask:0xf
v_mul_f32_dpp v23, v33, v23 quad_perm:[0,1,0,1] row_mask:0xf bank_mask:0xf
v_cvt_pk_bf16_f32 v20, v20, v21
v_cvt_pk_bf16_f32 v21, v22, v23
ds_write_b64 v6, v[20:21] offset:6144
v_mov_b32_dpp v16, v20 quad_perm:[0,1,0,1] row_mask:0xf bank_mask:0xf
v_mov_b32_dpp v17, v21 quad_perm:[0,1,0,1] row_mask:0xf bank_mask:0xf
v_mov_b32_dpp v18, v20 quad_perm:[2,3,2,3] row_mask:0xf bank_mask:0xf
v_mov_b32_dpp v19, v21 quad_perm:[2,3,2,3] row_mask:0xf bank_mask:0xf
v_mov_b64 v[76:77], 0
v_mov_b64 v[78:79], 0
v_mov_b64 v[36:37], 0
v_mov_b64 v[38:39], 0
v_mov_b64 v[24:25], 0
v_mov_b64 v[26:27], 0
v_mov_b64 v[32:33], 0
v_mov_b64 v[34:35], 0
s_waitcnt lgkmcnt(0)
s_branch L_mxb_w1rs

L_rr_w1rs:
buffer_load_dwordx4 v[60:63], v9, s[4:7], s3 offen offset:0 sc0 sc1
buffer_load_dwordx4 v[64:67], v9, s[4:7], s3 offen offset:1024 sc0 sc1
buffer_load_dwordx4 v[68:71], v9, s[4:7], s3 offen offset:2048 sc0 sc1
buffer_load_dwordx4 v[72:75], v9, s[4:7], s3 offen offset:3072 sc0 sc1
s_sub_u32 s41, s41, 1
s_cbranch_scc1 L_exit
s_waitcnt vmcnt(0)
s_branch L_r_w1rs
.p2align 6
L_ex_w0f:
s_add_u32 s34, s34, 1
s_not_b32 s35, s35
s_not_b32 s36, s36
s_add_u32 s37, s37, 524288
s_add_u32 s39, s39, 524288
v_mov_b64 v[20:21], 0
v_mov_b64 v[22:23], 0
v_mov_b64 v[24:25], 0
v_mov_b64 v[26:27], 0
v_mov_b64 v[28:29], 0
v_mov_b64 v[30:31], 0
v_mov_b64 v[32:33], 0
v_mov_b64 v[34:35], 0
v_mov_b64 v[36:37], 0
v_mov_b64 v[38:39], 0
v_mov_b64 v[40:41], 0
v_mov_b64 v[42:43], 0
ds_read_b128 v[44:47], v2 offset:0
ds_read_b128 v[48:51], v2 offset:1024
v_bfe_u32 v77, v1, 6, 1
v_lshl_add_u32 v77, v77, 3, v1
v_lshlrev_b32 v77, 1, v77
s_barrier
s_cmp_eq_u32 s34, 63
s_cbranch_scc1 L_done_w0f
L_top_w0f:
s_barrier
ds_read_b128 v[60:63], v1 offset:1024
s_mov_b32 m0, 5120
s_nop 0
buffer_load_dwordx4 v1, s[4:7], s48 offen offset:0 sc1 lds
s_barrier
ds_read_b128 v[64:67], v1 offset:2048
ds_read_b128 v[68:71], v1 offset:3072
ds_read_b128 v[72:75], v1 offset:4096
L_s0_w0f:
s_waitcnt lgkmcnt(3)
v_smfmac_f32_16x16x64_bf16 v[32:35], v[60:63], v[184:191], v0
v_smfmac_f32_16x16x64_bf16 v[36:39], v[60:63], a[48:55], v0
v_smfmac_f32_16x16x64_bf16 v[20:23], v[60:63], v[44:51], v0
buffer_load_dwordx4 v[12:15], v9, s[4:7], s37 offen offset:0
v_smfmac_f32_16x16x64_bf16 v[40:43], v[60:63], a[56:63], v0
s_waitcnt lgkmcnt(2)
v_smfmac_f32_16x16x64_bf16 v[24:27], v[64:67], v[88:95], v0
v_smfmac_f32_16x16x64_bf16 v[28:31], v[64:67], v[192:199], v0
v_smfmac_f32_16x16x64_bf16 v[20:23], v[64:67], v[80:87], v0
ds_read_b128 v[48:51], v2 offset:3072
ds_read_b128 v[44:47], v2 offset:2048
v_smfmac_f32_16x16x64_bf16 v[32:35], v[64:67], v[200:207], v0
v_bitop3_b32 v6, v60, v64, s35 bitop3:0x7e
s_waitcnt lgkmcnt(2)
v_bitop3_b32 v76, v68, v72, s35 bitop3:0x7e
v_smfmac_f32_16x16x64_bf16 v[28:31], v[60:63], v[176:183], v0
v_bitop3_b32 v6, v6, v76, 1 bitop3:0xa8
v_smfmac_f32_16x16x64_bf16 v[36:39], v[64:67], a[64:71], v0
buffer_load_dwordx4 v[16:19], v9, s[4:7], s37 offen offset:1024
s_waitcnt lgkmcnt(0)
v_smfmac_f32_16x16x64_bf16 v[24:27], v[60:63], v[44:51], v0
ds_read_b128 v[44:47], v2 offset:4096
v_cmp_ne_u32 vcc, 0, v6
v_smfmac_f32_16x16x64_bf16 v[20:23], v[68:71], v[96:103], v0
v_smfmac_f32_16x16x64_bf16 v[40:43], v[64:67], a[72:79], v0
s_cbranch_vccnz L_ra0_w0f
ds_read_b128 v[48:51], v2 offset:5120
buffer_load_dwordx4 v[52:55], v1, s[4:7], s37 offen offset:2048
v_smfmac_f32_16x16x64_bf16 v[24:27], v[68:71], v[104:111], v0
s_waitcnt vmcnt(3)
s_barrier
ds_read_b32 v6, v77 offset:8192
v_smfmac_f32_16x16x64_bf16 v[28:31], v[68:71], v[208:215], v0
ds_read_b128 v[60:63], v1 offset:6144
buffer_load_dwordx4 v[56:59], v1, s[4:7], s37 offen offset:3072
s_waitcnt lgkmcnt(2)
v_smfmac_f32_16x16x64_bf16 v[20:23], v[72:75], v[44:51], v0
ds_read_b128 v[64:67], v1 offset:7168
ds_read_b128 v[76:79], v1 offset:5120
v_smfmac_f32_16x16x64_bf16 v[32:35], v[68:71], v[216:223], v0
ds_read_b128 v[44:47], v2 offset:6144
v_smfmac_f32_16x16x64_bf16 v[36:39], v[68:71], a[80:87], v0
ds_read_b128 v[48:51], v2 offset:7168
s_mov_b32 m0, 0
v_smfmac_f32_16x16x64_bf16 v[40:43], v[68:71], a[88:95], v0
ds_read_b128 v[68:71], v1 offset:8192
s_waitcnt lgkmcnt(5)
v_bitop3_b32 v6, v6, v60, s35 bitop3:0x7e
v_smfmac_f32_16x16x64_bf16 v[28:31], v[72:75], v[224:231], v0
s_waitcnt lgkmcnt(4)
v_bitop3_b32 v6, v6, v64, s35 bitop3:0xf6
v_smfmac_f32_16x16x64_bf16 v[32:35], v[72:75], v[232:239], v0
s_waitcnt lgkmcnt(3)
v_bitop3_b32 v6, v6, v76, s35 bitop3:0xf6
v_and_b32 v6, 1, v6
s_waitcnt lgkmcnt(1)
v_smfmac_f32_16x16x64_bf16 v[24:27], v[72:75], v[44:51], v0
ds_read_b128 v[44:47], v2 offset:8192
v_cmp_ne_u32 vcc, 0, v6
v_smfmac_f32_16x16x64_bf16 v[36:39], v[72:75], a[96:103], v0
ds_read_b128 v[48:51], v2 offset:9216
v_lshlrev_b32 v6, 3, v1
v_smfmac_f32_16x16x64_bf16 v[40:43], v[72:75], a[104:111], v0
ds_read_b128 v[72:75], v1 offset:9216
s_cbranch_vccnz L_ra1_w0f
L_a1_w0f:
v_smfmac_f32_16x16x64_bf16 v[20:23], v[60:63], v[112:119], v0
v_smfmac_f32_16x16x64_bf16 v[20:23], v[64:67], v[128:135], v0
buffer_load_dword v6, s[4:7], s39 offen lds
s_waitcnt lgkmcnt(0)
v_smfmac_f32_16x16x64_bf16 v[20:23], v[72:75], v[160:167], v0
v_bfe_u32 v6, v1, 5, 1
v_smfmac_f32_16x16x64_bf16 v[20:23], v[76:79], v[44:51], v0
v_mad_i32_i24 v6, v6, s55, v1
v_smfmac_f32_16x16x64_bf16 v[20:23], v[68:71], v[144:151], v0
ds_read_b128 v[44:47], v2 offset:10240
v_smfmac_f32_16x16x64_bf16 v[24:27], v[60:63], v[120:127], v0
ds_read_b128 v[48:51], v2 offset:11264
v_smfmac_f32_16x16x64_bf16 v[24:27], v[64:67], v[136:143], v0
v_add_f32 v20, v20, v22
v_smfmac_f32_16x16x64_bf16 v[24:27], v[68:71], v[152:159], v0
v_add_f32 v21, v21, v23
v_cvt_pk_bf16_f32 v22, v20, v21
v_smfmac_f32_16x16x64_bf16 v[24:27], v[72:75], v[168:175], v0
s_waitcnt lgkmcnt(0)
v_smfmac_f32_16x16x64_bf16 v[24:27], v[76:79], v[44:51], v0
ds_read_b128 v[44:47], v2 offset:12288
v_smfmac_f32_16x16x64_bf16 v[28:31], v[76:79], v[240:247], v0
v_smfmac_f32_16x16x64_bf16 v[28:31], v[64:67], a[0:7], v0
ds_read_b128 v[48:51], v2 offset:13312
v_add_f32 v25, v25, v27
v_add_f32 v24, v24, v26
v_cvt_pk_bf16_f32 v23, v24, v25
v_smfmac_f32_16x16x64_bf16 v[28:31], v[68:71], a[16:23], v0
ds_write_b64 v3, v[22:23] offset:10240
v_smfmac_f32_16x16x64_bf16 v[28:31], v[72:75], a[32:39], v0
s_waitcnt vmcnt(1)
s_waitcnt lgkmcnt(1)
v_smfmac_f32_16x16x64_bf16 v[28:31], v[60:63], v[44:51], v0
ds_read_b128 v[48:51], v2 offset:15360
v_smfmac_f32_16x16x64_bf16 v[32:35], v[76:79], v[248:255], v0
ds_read_b128 v[44:47], v2 offset:14336
v_smfmac_f32_16x16x64_bf16 v[32:35], v[64:67], a[8:15], v0
s_waitcnt lgkmcnt(2)
s_barrier
ds_read_b64_tr_b16 v[20:21], v4 offset:10240
v_smfmac_f32_16x16x64_bf16 v[32:35], v[68:71], a[24:31], v0
ds_read_b64_tr_b16 v[22:23], v4 offset:10752
v_add_f32 v29, v29, v31
v_smfmac_f32_16x16x64_bf16 v[32:35], v[72:75], a[40:47], v0
ds_read_b64_tr_b16 v[24:25], v4 offset:11264
ds_read_b64_tr_b16 v[26:27], v4 offset:11776
s_waitcnt lgkmcnt(4)
v_smfmac_f32_16x16x64_bf16 v[32:35], v[60:63], v[44:51], v0
ds_read_b128 v[48:51], v2 offset:19456
s_waitcnt lgkmcnt(3)
v_mfma_f32_16x16x32_bf16 v[12:15], v[12:15], v[20:23], 0
ds_read_b128 v[44:47], v2 offset:18432
v_add_f32 v28, v28, v30
s_waitcnt lgkmcnt(2)
v_mfma_f32_16x16x32_bf16 v[12:15], v[16:19], v[24:27], v[12:15]
v_add_f32 v32, v32, v34
v_add_f32 v33, v33, v35
v_cvt_pk_bf16_f32 v31, v32, v33
v_cvt_pk_bf16_f32 v30, v28, v29
v_smfmac_f32_16x16x64_bf16 v[36:39], v[76:79], a[112:119], v0
ds_write_b64 v3, v[30:31] offset:12288
v_add_f32_dpp v12, v14, v12 quad_perm:[2,3,0,1] row_mask:0xf bank_mask:0xf
v_exp_f32 v14, v12
v_add_f32_dpp v13, v15, v13 quad_perm:[2,3,0,1] row_mask:0xf bank_mask:0xf
v_exp_f32 v15, v13
s_nop 0
v_cvt_pk_bf16_f32 v14, v14, v15
v_smfmac_f32_16x16x64_bf16 v[40:43], v[76:79], a[120:127], v0
ds_write_b32 v5, v14 offset:14368
s_waitcnt lgkmcnt(2)
v_smfmac_f32_16x16x64_bf16 v[40:43], v[72:75], v[44:51], v0
ds_read_b128 v[44:47], v2 offset:16384
s_waitcnt lgkmcnt(2)
s_barrier
ds_read_b64_tr_b16 v[28:29], v4 offset:12288
v_smfmac_f32_16x16x64_bf16 v[36:39], v[60:63], a[128:135], v0
ds_read_b64_tr_b16 v[30:31], v4 offset:12800
ds_read_b64_tr_b16 v[32:33], v4 offset:13312
v_smfmac_f32_16x16x64_bf16 v[40:43], v[60:63], a[136:143], v0
ds_read_b64_tr_b16 v[34:35], v4 offset:13824
v_mov_b64 v[76:77], s[52:53]
s_waitcnt lgkmcnt(2)
v_mfma_f32_16x16x32_bf16 v[28:31], v[28:31], v[20:23], 0
s_barrier
ds_read_b128 v[16:19], v1 offset:14368
s_waitcnt lgkmcnt(1)
v_mfma_f32_16x16x32_bf16 v[28:31], v[32:35], v[24:27], v[28:31]
ds_read_b128 v[60:63], v1 offset:14336
v_mov_b64 v[14:15], s[0:1]
v_smfmac_f32_16x16x64_bf16 v[40:43], v[64:67], a[152:159], v0
ds_read_b128 v[48:51], v2 offset:17408
v_mov_b64 v[78:79], s[52:53]
v_smfmac_f32_16x16x64_bf16 v[40:43], v[68:71], a[168:175], v0
v_add_f32_dpp v28, v30, v28 quad_perm:[2,3,0,1] row_mask:0xf bank_mask:0xf
v_smfmac_f32_16x16x64_bf16 v[36:39], v[64:67], a[144:151], v0
ds_read_b128 v[64:67], v2 offset:25600
v_add_f32_dpp v29, v31, v29 quad_perm:[2,3,0,1] row_mask:0xf bank_mask:0xf
s_waitcnt lgkmcnt(1)
v_smfmac_f32_16x16x64_bf16 v[36:39], v[72:75], v[44:51], v0
ds_read_b128 v[72:75], v2 offset:29696
v_mul_f32 v28, s50, v28
v_smfmac_f32_16x16x64_bf16 v[36:39], v[68:71], a[160:167], v0
ds_read_b128 v[68:71], v2 offset:28672
v_cvt_pk_bf16_f32 v40, v40, v41
v_mfma_f32_16x16x32_bf16 v[32:35], v[76:79], v[16:19], 0
v_exp_f32 v30, v28
ds_read_b128 v[44:47], v2 offset:20480
v_mfma_f32_16x16x32_bf16 v[20:23], v[52:55], v[16:19], 0
v_mul_f32 v29, s50, v29
v_cvt_pk_bf16_f32 v41, v42, v43
v_cvt_pk_bf16_f32 v43, v38, v39
v_mov_b64 v[76:77], 0
v_exp_f32 v31, v29
v_mfma_f32_16x16x32_bf16 v[20:23], v[56:59], v[60:63], v[20:23]
v_cvt_pk_bf16_f32 v30, v30, v31
v_cndmask_b32_e64 v26, 0, v30, s[56:57]
v_cndmask_b32_e64 v27, 0, v30, s[56:57]
s_nop 0
v_mov_b32_dpp v24, v26 quad_perm:[2,3,0,1] row_mask:0xf bank_mask:0xf
v_mfma_f32_16x16x16_bf16 v[32:35], v[14:15], v[26:27], v[32:35]
v_mov_b32_dpp v25, v26 quad_perm:[2,3,0,1] row_mask:0xf bank_mask:0xf
v_cvt_pk_bf16_f32 v42, v36, v37
s_nop 1
v_mfma_f32_16x16x32_bf16 v[20:23], v[40:43], v[24:27], v[20:23]
ds_read_b128 v[60:63], v2 offset:24576
ds_read_b128 v[48:51], v2 offset:21504
v_mov_b64 v[78:79], 0
v_rcp_f32 v33, v32
v_mov_b64 v[36:37], 0
v_min_f32 v32, v32, v33
v_cmp_nlt_f32 vcc, s2, v32
v_mul_f32_dpp v23, v33, v23 quad_perm:[0,1,0,1] row_mask:0xf bank_mask:0xf
v_mul_f32_dpp v21, v33, v21 quad_perm:[0,1,0,1] row_mask:0xf bank_mask:0xf
v_mul_f32_dpp v22, v33, v22 quad_perm:[0,1,0,1] row_mask:0xf bank_mask:0xf
v_mul_f32_dpp v20, v33, v20 quad_perm:[0,1,0,1] row_mask:0xf bank_mask:0xf
v_cvt_pk_bf16_f32 v20, v20, v21
v_cvt_pk_bf16_f32 v21, v22, v23
ds_write_b64 v6, v[20:21] offset:5120
s_and_b64 vcc, vcc, s[56:57]
s_cbranch_scc1 L_mx_w0f
L_mxb_w0f:
v_mov_b64 v[38:39], 0
v_mov_b32_dpp v19, v21 quad_perm:[2,3,2,3] row_mask:0xf bank_mask:0xf
v_mov_b32_dpp v16, v20 quad_perm:[0,1,0,1] row_mask:0xf bank_mask:0xf
v_mov_b32_dpp v18, v20 quad_perm:[2,3,2,3] row_mask:0xf bank_mask:0xf
v_mov_b32_dpp v17, v21 quad_perm:[0,1,0,1] row_mask:0xf bank_mask:0xf
v_mov_b64 v[24:25], 0
v_mov_b64 v[26:27], 0
v_smfmac_f32_16x16x64_bf16 v[76:79], v[16:19], a[176:183], v0
s_waitcnt lgkmcnt(0)
s_barrier
v_mov_b64 v[32:33], 0
ds_read_b128 v[12:15], v7 offset:7168
ds_read_b128 v[52:55], v7 offset:6144
v_smfmac_f32_16x16x64_bf16 v[36:39], v[16:19], v[44:51], v0
ds_read_b128 v[48:51], v2 offset:23552
ds_read_b128 v[56:59], v7 offset:8192
v_mov_b64 v[30:31], 0
v_mov_b64 v[34:35], 0
v_smfmac_f32_16x16x64_bf16 v[24:27], v[16:19], v[60:67], v0
ds_read_b128 v[44:47], v2 offset:22528
v_smfmac_f32_16x16x64_bf16 v[32:35], v[16:19], v[68:75], v0
ds_read_b128 v[68:71], v2 offset:30720
s_waitcnt lgkmcnt(5)
v_smfmac_f32_16x16x64_bf16 v[76:79], v[12:15], a[184:191], v0
ds_read_b128 v[60:63], v2 offset:26624
s_waitcnt lgkmcnt(5)
v_smfmac_f32_16x16x64_bf16 v[76:79], v[52:55], a[192:199], v0
ds_read_b128 v[64:67], v2 offset:27648
s_waitcnt lgkmcnt(4)
v_smfmac_f32_16x16x64_bf16 v[76:79], v[56:59], a[200:207], v0
v_mov_b64 v[28:29], 0
v_smfmac_f32_16x16x64_bf16 v[36:39], v[12:15], a[208:215], v0
ds_read_b128 v[72:75], v2 offset:31744
s_waitcnt lgkmcnt(4)
v_smfmac_f32_16x16x64_bf16 v[36:39], v[52:55], v[44:51], v0
ds_read_b128 v[44:47], v2 offset:32768
v_cvt_pk_bf16_f32 v77, v77, v79
v_cvt_pk_bf16_f32 v76, v76, v78
v_bfi_b32 v76, 1, s35, v76
v_smfmac_f32_16x16x64_bf16 v[36:39], v[56:59], a[216:223], v0
v_smfmac_f32_16x16x64_bf16 v[24:27], v[12:15], a[224:231], v0
buffer_store_dwordx2 v[76:77], v8, s[4:7], s42 offen
s_waitcnt lgkmcnt(2)
v_smfmac_f32_16x16x64_bf16 v[24:27], v[52:55], v[60:67], v0
ds_read_b128 v[48:51], v2 offset:33792
ds_read_b128 v[60:63], v2 offset:36864
v_cvt_pk_bf16_f32 v36, v36, v38
v_bfi_b32 v36, 1, s35, v36
v_cvt_pk_bf16_f32 v37, v37, v39
v_smfmac_f32_16x16x64_bf16 v[24:27], v[56:59], a[232:239], v0
buffer_store_dwordx2 v[36:37], v8, s[4:7], s43 offen
ds_read_b128 v[64:67], v2 offset:37888
v_smfmac_f32_16x16x64_bf16 v[32:35], v[12:15], a[240:247], v0
ds_read_b128 v[40:43], v2 offset:35840
s_waitcnt lgkmcnt(5)
v_smfmac_f32_16x16x64_bf16 v[32:35], v[52:55], v[68:75], v0
ds_read_b128 v[72:75], v2 offset:39936
ds_read_b128 v[36:39], v2 offset:34816
v_cvt_pk_bf16_f32 v25, v25, v27
v_cvt_pk_bf16_f32 v24, v24, v26
v_bfi_b32 v24, 1, s35, v24
buffer_store_dwordx2 v[24:25], v8, s[4:7], s44 offen
v_smfmac_f32_16x16x64_bf16 v[32:35], v[56:59], a[248:255], v0
ds_read_b128 v[68:71], v2 offset:38912
s_waitcnt lgkmcnt(6)
v_smfmac_f32_16x16x64_bf16 v[28:31], v[16:19], v[44:51], v0
s_nop 3
v_cvt_pk_bf16_f32 v33, v33, v35
v_cvt_pk_bf16_f32 v32, v32, v34
v_bfi_b32 v32, 1, s35, v32
buffer_store_dwordx2 v[32:33], v8, s[4:7], s45 offen
s_waitcnt lgkmcnt(1)
v_smfmac_f32_16x16x64_bf16 v[28:31], v[52:55], v[36:43], v0
v_smfmac_f32_16x16x64_bf16 v[28:31], v[12:15], v[60:67], v0
s_waitcnt lgkmcnt(0)
v_smfmac_f32_16x16x64_bf16 v[28:31], v[56:59], v[68:75], v0
s_nop 7
v_cvt_pk_bf16_f32 v28, v28, v30
v_bfi_b32 v28, 1, s35, v28
v_cvt_pk_bf16_f32 v29, v29, v31
buffer_store_dwordx2 v[28:29], v8, s[4:7], s46 offen
s_branch L_ex_w0f
.p2align 6
L_ex_w0rf:
v_and_b32 v6, 0x70, v1
ds_read_b128 v[76:79], v6 offset:256
v_bfe_u32 v11, v1, 4, 2
v_lshrrev_b32_e64 v11, v11, 1
v_mov_b64 v[20:21], 0
v_mov_b64 v[22:23], 0
v_mov_b64 v[24:25], 0
v_mov_b64 v[26:27], 0
v_mov_b64 v[28:29], 0
v_mov_b64 v[30:31], 0
v_mov_b64 v[32:33], 0
v_mov_b64 v[34:35], 0
ds_read_b128 v[44:47], v2 offset:0
ds_read_b128 v[48:51], v2 offset:1024
s_add_u32 s34, s34, 1
s_not_b32 s35, s35
s_not_b32 s36, s36
s_barrier
s_waitcnt vmcnt(0)
s_add_u32 s37, s37, 524288
s_add_u32 s39, s39, 524288
s_mul_i32 s40, s34, 10240
s_add_u32 s40, s40, 8093696
buffer_load_dwordx4 v[60:63], v9, s[4:7], s3 offen offset:0 sc1
buffer_load_dwordx4 v[64:67], v9, s[4:7], s3 offen offset:1024 sc1
buffer_load_dwordx4 v[68:71], v9, s[4:7], s3 offen offset:2048 sc1
buffer_load_dwordx4 v[72:75], v9, s[4:7], s3 offen offset:3072 sc1
s_waitcnt lgkmcnt(2)
s_waitcnt vmcnt(3)
L_r_w0rf:
v_mfma_f32_16x16x32_bf16 v[36:39], v[60:63], v[76:79], 0
s_waitcnt vmcnt(2)
v_mfma_f32_16x16x32_bf16 v[36:39], v[64:67], v[76:79], v[36:39]
v_bitop3_b32 v40, v60, v64, s36 bitop3:0x7e
s_waitcnt vmcnt(1)
v_mfma_f32_16x16x32_bf16 v[36:39], v[68:71], v[76:79], v[36:39]
s_waitcnt vmcnt(0)
v_mfma_f32_16x16x32_bf16 v[36:39], v[72:75], v[76:79], v[36:39]
v_bitop3_b32 v41, v68, v72, s36 bitop3:0x7e
v_bitop3_b32 v40, v40, v41, 1 bitop3:0xa8
v_cmp_ne_u32 vcc, 0, v40
v_nop
v_nop
v_nop
v_nop
v_nop
v_pk_add_f32 v[36:37], v[36:37], v[38:39]
v_cvt_pk_bf16_f32 v40, v36, v37
v_bfi_b32 v40, v11, s35, v40
s_cbranch_vccnz L_rr_w0rf
buffer_store_dword v40, v10, s[4:7], 0 offen
s_cmp_eq_u32 s34, 63
v_mov_b32 v11, v40
s_cbranch_scc1 L_done_w0rf
v_mov_b64 v[36:37], 0
v_mov_b64 v[38:39], 0
v_mov_b64 v[40:41], 0
v_mov_b64 v[42:43], 0
v_bfe_u32 v77, v1, 6, 1
v_lshl_add_u32 v77, v77, 3, v1
v_lshlrev_b32 v77, 1, v77
L_top_w0rf:
s_barrier
ds_read_b128 v[60:63], v1 offset:1024
s_mov_b32 m0, 5120
s_nop 0
buffer_load_dwordx4 v1, s[4:7], s48 offen offset:0 sc1 lds
s_barrier
ds_read_b128 v[64:67], v1 offset:2048
ds_read_b128 v[68:71], v1 offset:3072
ds_read_b128 v[72:75], v1 offset:4096
L_s0_w0rf:
s_waitcnt lgkmcnt(3)
v_smfmac_f32_16x16x64_bf16 v[32:35], v[60:63], v[184:191], v0
v_smfmac_f32_16x16x64_bf16 v[36:39], v[60:63], a[48:55], v0
v_smfmac_f32_16x16x64_bf16 v[20:23], v[60:63], v[44:51], v0
buffer_load_dwordx4 v[12:15], v9, s[4:7], s37 offen offset:0
v_smfmac_f32_16x16x64_bf16 v[40:43], v[60:63], a[56:63], v0
s_waitcnt lgkmcnt(2)
v_smfmac_f32_16x16x64_bf16 v[24:27], v[64:67], v[88:95], v0
v_smfmac_f32_16x16x64_bf16 v[28:31], v[64:67], v[192:199], v0
v_smfmac_f32_16x16x64_bf16 v[20:23], v[64:67], v[80:87], v0
ds_read_b128 v[48:51], v2 offset:3072
ds_read_b128 v[44:47], v2 offset:2048
v_smfmac_f32_16x16x64_bf16 v[32:35], v[64:67], v[200:207], v0
v_bitop3_b32 v6, v60, v64, s35 bitop3:0x7e
s_waitcnt lgkmcnt(2)
v_bitop3_b32 v76, v68, v72, s35 bitop3:0x7e
v_smfmac_f32_16x16x64_bf16 v[28:31], v[60:63], v[176:183], v0
v_bitop3_b32 v6, v6, v76, 1 bitop3:0xa8
v_smfmac_f32_16x16x64_bf16 v[36:39], v[64:67], a[64:71], v0
buffer_load_dwordx4 v[16:19], v9, s[4:7], s37 offen offset:1024
s_waitcnt lgkmcnt(0)
v_smfmac_f32_16x16x64_bf16 v[24:27], v[60:63], v[44:51], v0
ds_read_b128 v[44:47], v2 offset:4096
v_cmp_ne_u32 vcc, 0, v6
v_smfmac_f32_16x16x64_bf16 v[20:23], v[68:71], v[96:103], v0
v_smfmac_f32_16x16x64_bf16 v[40:43], v[64:67], a[72:79], v0
s_cbranch_vccnz L_ra0_w0rf
ds_read_b128 v[48:51], v2 offset:5120
buffer_load_dwordx4 v[52:55], v1, s[4:7], s37 offen offset:2048
v_smfmac_f32_16x16x64_bf16 v[24:27], v[68:71], v[104:111], v0
s_waitcnt vmcnt(3)
s_barrier
ds_read_b32 v6, v77 offset:8192
v_smfmac_f32_16x16x64_bf16 v[28:31], v[68:71], v[208:215], v0
ds_read_b128 v[60:63], v1 offset:6144
buffer_load_dwordx4 v[56:59], v1, s[4:7], s37 offen offset:3072
s_waitcnt lgkmcnt(2)
v_smfmac_f32_16x16x64_bf16 v[20:23], v[72:75], v[44:51], v0
ds_read_b128 v[64:67], v1 offset:7168
ds_read_b128 v[76:79], v1 offset:5120
v_smfmac_f32_16x16x64_bf16 v[32:35], v[68:71], v[216:223], v0
ds_read_b128 v[44:47], v2 offset:6144
v_smfmac_f32_16x16x64_bf16 v[36:39], v[68:71], a[80:87], v0
ds_read_b128 v[48:51], v2 offset:7168
s_mov_b32 m0, 0
v_smfmac_f32_16x16x64_bf16 v[40:43], v[68:71], a[88:95], v0
ds_read_b128 v[68:71], v1 offset:8192
s_waitcnt lgkmcnt(5)
v_bitop3_b32 v6, v6, v60, s35 bitop3:0x7e
v_smfmac_f32_16x16x64_bf16 v[28:31], v[72:75], v[224:231], v0
s_waitcnt lgkmcnt(4)
v_bitop3_b32 v6, v6, v64, s35 bitop3:0xf6
v_smfmac_f32_16x16x64_bf16 v[32:35], v[72:75], v[232:239], v0
s_waitcnt lgkmcnt(3)
v_bitop3_b32 v6, v6, v76, s35 bitop3:0xf6
v_and_b32 v6, 1, v6
s_waitcnt lgkmcnt(1)
v_smfmac_f32_16x16x64_bf16 v[24:27], v[72:75], v[44:51], v0
ds_read_b128 v[44:47], v2 offset:8192
v_cmp_ne_u32 vcc, 0, v6
v_smfmac_f32_16x16x64_bf16 v[36:39], v[72:75], a[96:103], v0
ds_read_b128 v[48:51], v2 offset:9216
v_lshlrev_b32 v6, 3, v1
v_smfmac_f32_16x16x64_bf16 v[40:43], v[72:75], a[104:111], v0
ds_read_b128 v[72:75], v1 offset:9216
s_cbranch_vccnz L_ra1_w0rf
L_a1_w0rf:
buffer_store_dword v11, v10, s[4:7], s40 offen sc0 sc1
v_smfmac_f32_16x16x64_bf16 v[20:23], v[60:63], v[112:119], v0
v_smfmac_f32_16x16x64_bf16 v[20:23], v[64:67], v[128:135], v0
buffer_load_dword v6, s[4:7], s39 offen lds
s_waitcnt lgkmcnt(0)
v_smfmac_f32_16x16x64_bf16 v[20:23], v[72:75], v[160:167], v0
v_bfe_u32 v6, v1, 5, 1
v_smfmac_f32_16x16x64_bf16 v[20:23], v[76:79], v[44:51], v0
v_mad_i32_i24 v6, v6, s55, v1
v_smfmac_f32_16x16x64_bf16 v[20:23], v[68:71], v[144:151], v0
ds_read_b128 v[44:47], v2 offset:10240
v_smfmac_f32_16x16x64_bf16 v[24:27], v[60:63], v[120:127], v0
ds_read_b128 v[48:51], v2 offset:11264
v_smfmac_f32_16x16x64_bf16 v[24:27], v[64:67], v[136:143], v0
v_add_f32 v20, v20, v22
v_smfmac_f32_16x16x64_bf16 v[24:27], v[68:71], v[152:159], v0
v_add_f32 v21, v21, v23
v_cvt_pk_bf16_f32 v22, v20, v21
v_smfmac_f32_16x16x64_bf16 v[24:27], v[72:75], v[168:175], v0
s_waitcnt lgkmcnt(0)
v_smfmac_f32_16x16x64_bf16 v[24:27], v[76:79], v[44:51], v0
ds_read_b128 v[44:47], v2 offset:12288
v_smfmac_f32_16x16x64_bf16 v[28:31], v[76:79], v[240:247], v0
v_smfmac_f32_16x16x64_bf16 v[28:31], v[64:67], a[0:7], v0
ds_read_b128 v[48:51], v2 offset:13312
v_add_f32 v25, v25, v27
v_add_f32 v24, v24, v26
v_cvt_pk_bf16_f32 v23, v24, v25
v_smfmac_f32_16x16x64_bf16 v[28:31], v[68:71], a[16:23], v0
ds_write_b64 v3, v[22:23] offset:10240
v_smfmac_f32_16x16x64_bf16 v[28:31], v[72:75], a[32:39], v0
s_waitcnt vmcnt(2)
s_waitcnt lgkmcnt(1)
v_smfmac_f32_16x16x64_bf16 v[28:31], v[60:63], v[44:51], v0
ds_read_b128 v[48:51], v2 offset:15360
v_smfmac_f32_16x16x64_bf16 v[32:35], v[76:79], v[248:255], v0
ds_read_b128 v[44:47], v2 offset:14336
v_smfmac_f32_16x16x64_bf16 v[32:35], v[64:67], a[8:15], v0
s_waitcnt lgkmcnt(2)
s_barrier
ds_read_b64_tr_b16 v[20:21], v4 offset:10240
v_smfmac_f32_16x16x64_bf16 v[32:35], v[68:71], a[24:31], v0
ds_read_b64_tr_b16 v[22:23], v4 offset:10752
v_add_f32 v29, v29, v31
v_smfmac_f32_16x16x64_bf16 v[32:35], v[72:75], a[40:47], v0
ds_read_b64_tr_b16 v[24:25], v4 offset:11264
ds_read_b64_tr_b16 v[26:27], v4 offset:11776
s_waitcnt lgkmcnt(4)
v_smfmac_f32_16x16x64_bf16 v[32:35], v[60:63], v[44:51], v0
ds_read_b128 v[48:51], v2 offset:19456
s_waitcnt lgkmcnt(3)
v_mfma_f32_16x16x32_bf16 v[12:15], v[12:15], v[20:23], 0
ds_read_b128 v[44:47], v2 offset:18432
v_add_f32 v28, v28, v30
s_waitcnt lgkmcnt(2)
v_mfma_f32_16x16x32_bf16 v[12:15], v[16:19], v[24:27], v[12:15]
v_add_f32 v32, v32, v34
v_add_f32 v33, v33, v35
v_cvt_pk_bf16_f32 v31, v32, v33
v_cvt_pk_bf16_f32 v30, v28, v29
v_smfmac_f32_16x16x64_bf16 v[36:39], v[76:79], a[112:119], v0
ds_write_b64 v3, v[30:31] offset:12288
v_add_f32_dpp v12, v14, v12 quad_perm:[2,3,0,1] row_mask:0xf bank_mask:0xf
v_exp_f32 v14, v12
v_add_f32_dpp v13, v15, v13 quad_perm:[2,3,0,1] row_mask:0xf bank_mask:0xf
v_exp_f32 v15, v13
s_nop 0
v_cvt_pk_bf16_f32 v14, v14, v15
v_smfmac_f32_16x16x64_bf16 v[40:43], v[76:79], a[120:127], v0
ds_write_b32 v5, v14 offset:14368
s_waitcnt lgkmcnt(2)
v_smfmac_f32_16x16x64_bf16 v[40:43], v[72:75], v[44:51], v0
ds_read_b128 v[44:47], v2 offset:16384
s_waitcnt lgkmcnt(2)
s_barrier
ds_read_b64_tr_b16 v[28:29], v4 offset:12288
v_smfmac_f32_16x16x64_bf16 v[36:39], v[60:63], a[128:135], v0
ds_read_b64_tr_b16 v[30:31], v4 offset:12800
ds_read_b64_tr_b16 v[32:33], v4 offset:13312
v_smfmac_f32_16x16x64_bf16 v[40:43], v[60:63], a[136:143], v0
ds_read_b64_tr_b16 v[34:35], v4 offset:13824
v_mov_b64 v[76:77], s[52:53]
s_waitcnt lgkmcnt(2)
v_mfma_f32_16x16x32_bf16 v[28:31], v[28:31], v[20:23], 0
s_barrier
ds_read_b128 v[16:19], v1 offset:14368
s_waitcnt lgkmcnt(1)
v_mfma_f32_16x16x32_bf16 v[28:31], v[32:35], v[24:27], v[28:31]
ds_read_b128 v[60:63], v1 offset:14336
v_mov_b64 v[14:15], s[0:1]
v_smfmac_f32_16x16x64_bf16 v[40:43], v[64:67], a[152:159], v0
ds_read_b128 v[48:51], v2 offset:17408
v_mov_b64 v[78:79], s[52:53]
v_smfmac_f32_16x16x64_bf16 v[40:43], v[68:71], a[168:175], v0
v_add_f32_dpp v28, v30, v28 quad_perm:[2,3,0,1] row_mask:0xf bank_mask:0xf
v_smfmac_f32_16x16x64_bf16 v[36:39], v[64:67], a[144:151], v0
ds_read_b128 v[64:67], v2 offset:25600
v_add_f32_dpp v29, v31, v29 quad_perm:[2,3,0,1] row_mask:0xf bank_mask:0xf
s_waitcnt lgkmcnt(1)
v_smfmac_f32_16x16x64_bf16 v[36:39], v[72:75], v[44:51], v0
ds_read_b128 v[72:75], v2 offset:29696
v_mul_f32 v28, s50, v28
v_smfmac_f32_16x16x64_bf16 v[36:39], v[68:71], a[160:167], v0
ds_read_b128 v[68:71], v2 offset:28672
v_cvt_pk_bf16_f32 v40, v40, v41
v_mfma_f32_16x16x32_bf16 v[32:35], v[76:79], v[16:19], 0
v_exp_f32 v30, v28
ds_read_b128 v[44:47], v2 offset:20480
v_mfma_f32_16x16x32_bf16 v[20:23], v[52:55], v[16:19], 0
v_mul_f32 v29, s50, v29
v_cvt_pk_bf16_f32 v41, v42, v43
v_cvt_pk_bf16_f32 v43, v38, v39
v_mov_b64 v[76:77], 0
v_exp_f32 v31, v29
v_mfma_f32_16x16x32_bf16 v[20:23], v[56:59], v[60:63], v[20:23]
v_cvt_pk_bf16_f32 v30, v30, v31
v_cndmask_b32_e64 v26, 0, v30, s[56:57]
v_cndmask_b32_e64 v27, 0, v30, s[56:57]
s_nop 0
v_mov_b32_dpp v24, v26 quad_perm:[2,3,0,1] row_mask:0xf bank_mask:0xf
v_mfma_f32_16x16x16_bf16 v[32:35], v[14:15], v[26:27], v[32:35]
v_mov_b32_dpp v25, v26 quad_perm:[2,3,0,1] row_mask:0xf bank_mask:0xf
v_cvt_pk_bf16_f32 v42, v36, v37
s_nop 1
v_mfma_f32_16x16x32_bf16 v[20:23], v[40:43], v[24:27], v[20:23]
ds_read_b128 v[60:63], v2 offset:24576
ds_read_b128 v[48:51], v2 offset:21504
v_mov_b64 v[78:79], 0
v_rcp_f32 v33, v32
v_mov_b64 v[36:37], 0
v_min_f32 v32, v32, v33
v_cmp_nlt_f32 vcc, s2, v32
v_mul_f32_dpp v23, v33, v23 quad_perm:[0,1,0,1] row_mask:0xf bank_mask:0xf
v_mul_f32_dpp v21, v33, v21 quad_perm:[0,1,0,1] row_mask:0xf bank_mask:0xf
v_mul_f32_dpp v22, v33, v22 quad_perm:[0,1,0,1] row_mask:0xf bank_mask:0xf
v_mul_f32_dpp v20, v33, v20 quad_perm:[0,1,0,1] row_mask:0xf bank_mask:0xf
v_cvt_pk_bf16_f32 v20, v20, v21
v_cvt_pk_bf16_f32 v21, v22, v23
ds_write_b64 v6, v[20:21] offset:5120
s_and_b64 vcc, vcc, s[56:57]
s_cbranch_scc1 L_mx_w0rf
L_mxb_w0rf:
v_mov_b64 v[38:39], 0
v_mov_b32_dpp v19, v21 quad_perm:[2,3,2,3] row_mask:0xf bank_mask:0xf
v_mov_b32_dpp v16, v20 quad_perm:[0,1,0,1] row_mask:0xf bank_mask:0xf
v_mov_b32_dpp v18, v20 quad_perm:[2,3,2,3] row_mask:0xf bank_mask:0xf
v_mov_b32_dpp v17, v21 quad_perm:[0,1,0,1] row_mask:0xf bank_mask:0xf
v_mov_b64 v[24:25], 0
v_mov_b64 v[26:27], 0
v_smfmac_f32_16x16x64_bf16 v[76:79], v[16:19], a[176:183], v0
s_waitcnt lgkmcnt(0)
s_barrier
v_mov_b64 v[32:33], 0
ds_read_b128 v[12:15], v7 offset:7168
ds_read_b128 v[52:55], v7 offset:6144
v_smfmac_f32_16x16x64_bf16 v[36:39], v[16:19], v[44:51], v0
ds_read_b128 v[48:51], v2 offset:23552
ds_read_b128 v[56:59], v7 offset:8192
v_mov_b64 v[30:31], 0
v_mov_b64 v[34:35], 0
v_smfmac_f32_16x16x64_bf16 v[24:27], v[16:19], v[60:67], v0
ds_read_b128 v[44:47], v2 offset:22528
v_smfmac_f32_16x16x64_bf16 v[32:35], v[16:19], v[68:75], v0
ds_read_b128 v[68:71], v2 offset:30720
s_waitcnt lgkmcnt(5)
v_smfmac_f32_16x16x64_bf16 v[76:79], v[12:15], a[184:191], v0
ds_read_b128 v[60:63], v2 offset:26624
s_waitcnt lgkmcnt(5)
v_smfmac_f32_16x16x64_bf16 v[76:79], v[52:55], a[192:199], v0
ds_read_b128 v[64:67], v2 offset:27648
s_waitcnt lgkmcnt(4)
v_smfmac_f32_16x16x64_bf16 v[76:79], v[56:59], a[200:207], v0
v_mov_b64 v[28:29], 0
v_smfmac_f32_16x16x64_bf16 v[36:39], v[12:15], a[208:215], v0
ds_read_b128 v[72:75], v2 offset:31744
s_waitcnt lgkmcnt(4)
v_smfmac_f32_16x16x64_bf16 v[36:39], v[52:55], v[44:51], v0
ds_read_b128 v[44:47], v2 offset:32768
v_cvt_pk_bf16_f32 v77, v77, v79
v_cvt_pk_bf16_f32 v76, v76, v78
v_bfi_b32 v76, 1, s35, v76
v_smfmac_f32_16x16x64_bf16 v[36:39], v[56:59], a[216:223], v0
v_smfmac_f32_16x16x64_bf16 v[24:27], v[12:15], a[224:231], v0
buffer_store_dwordx2 v[76:77], v8, s[4:7], s42 offen
s_waitcnt lgkmcnt(2)
v_smfmac_f32_16x16x64_bf16 v[24:27], v[52:55], v[60:67], v0
ds_read_b128 v[48:51], v2 offset:33792
ds_read_b128 v[60:63], v2 offset:36864
v_cvt_pk_bf16_f32 v36, v36, v38
v_bfi_b32 v36, 1, s35, v36
v_cvt_pk_bf16_f32 v37, v37, v39
v_smfmac_f32_16x16x64_bf16 v[24:27], v[56:59], a[232:239], v0
buffer_store_dwordx2 v[36:37], v8, s[4:7], s43 offen
ds_read_b128 v[64:67], v2 offset:37888
v_smfmac_f32_16x16x64_bf16 v[32:35], v[12:15], a[240:247], v0
ds_read_b128 v[40:43], v2 offset:35840
s_waitcnt lgkmcnt(5)
v_smfmac_f32_16x16x64_bf16 v[32:35], v[52:55], v[68:75], v0
ds_read_b128 v[72:75], v2 offset:39936
ds_read_b128 v[36:39], v2 offset:34816
v_cvt_pk_bf16_f32 v25, v25, v27
v_cvt_pk_bf16_f32 v24, v24, v26
v_bfi_b32 v24, 1, s35, v24
buffer_store_dwordx2 v[24:25], v8, s[4:7], s44 offen
v_smfmac_f32_16x16x64_bf16 v[32:35], v[56:59], a[248:255], v0
ds_read_b128 v[68:71], v2 offset:38912
s_waitcnt lgkmcnt(6)
v_smfmac_f32_16x16x64_bf16 v[28:31], v[16:19], v[44:51], v0
s_nop 3
v_cvt_pk_bf16_f32 v33, v33, v35
v_cvt_pk_bf16_f32 v32, v32, v34
v_bfi_b32 v32, 1, s35, v32
buffer_store_dwordx2 v[32:33], v8, s[4:7], s45 offen
s_waitcnt lgkmcnt(1)
v_smfmac_f32_16x16x64_bf16 v[28:31], v[52:55], v[36:43], v0
v_smfmac_f32_16x16x64_bf16 v[28:31], v[12:15], v[60:67], v0
s_waitcnt lgkmcnt(0)
v_smfmac_f32_16x16x64_bf16 v[28:31], v[56:59], v[68:75], v0
s_nop 7
v_cvt_pk_bf16_f32 v28, v28, v30
v_bfi_b32 v28, 1, s35, v28
v_cvt_pk_bf16_f32 v29, v29, v31
buffer_store_dwordx2 v[28:29], v8, s[4:7], s46 offen
s_branch L_ex_w0rf
.p2align 6
L_ex_w1rf:
v_and_b32 v6, 0x70, v1
ds_read_b128 v[76:79], v6 offset:256
v_bfe_u32 v11, v1, 4, 2
v_lshrrev_b32_e64 v11, v11, 1
v_mov_b64 v[20:21], 0
v_mov_b64 v[22:23], 0
v_mov_b64 v[24:25], 0
v_mov_b64 v[26:27], 0
v_mov_b64 v[28:29], 0
v_mov_b64 v[30:31], 0
v_mov_b64 v[32:33], 0
v_mov_b64 v[34:35], 0
ds_read_b128 v[44:47], v2 offset:0
ds_read_b128 v[48:51], v2 offset:1024
s_add_u32 s34, s34, 1
s_not_b32 s35, s35
s_not_b32 s36, s36
s_add_u32 s37, s37, 524288
s_mul_i32 s40, s34, 10240
s_add_u32 s40, s40, 8093696
s_barrier
s_waitcnt vmcnt(0)
buffer_load_dwordx4 v[60:63], v9, s[4:7], s3 offen offset:0 sc1
buffer_load_dwordx4 v[64:67], v9, s[4:7], s3 offen offset:1024 sc1
buffer_load_dwordx4 v[68:71], v9, s[4:7], s3 offen offset:2048 sc1
buffer_load_dwordx4 v[72:75], v9, s[4:7], s3 offen offset:3072 sc1
s_waitcnt lgkmcnt(2)
s_waitcnt vmcnt(3)
L_r_w1rf:
v_mfma_f32_16x16x32_bf16 v[36:39], v[60:63], v[76:79], 0
s_waitcnt vmcnt(2)
v_mfma_f32_16x16x32_bf16 v[36:39], v[64:67], v[76:79], v[36:39]
v_bitop3_b32 v40, v60, v64, s36 bitop3:0x7e
s_waitcnt vmcnt(1)
v_mfma_f32_16x16x32_bf16 v[36:39], v[68:71], v[76:79], v[36:39]
s_waitcnt vmcnt(0)
v_mfma_f32_16x16x32_bf16 v[36:39], v[72:75], v[76:79], v[36:39]
v_bitop3_b32 v41, v68, v72, s36 bitop3:0x7e
v_bitop3_b32 v40, v40, v41, 1 bitop3:0xa8
v_cmp_ne_u32 vcc, 0, v40
v_nop
v_nop
v_nop
v_nop
v_nop
v_pk_add_f32 v[36:37], v[36:37], v[38:39]
v_cvt_pk_bf16_f32 v40, v36, v37
v_bfi_b32 v40, v11, s35, v40
s_cbranch_vccnz L_rr_w1rf
buffer_store_dword v40, v10, s[4:7], 0 offen
s_cmp_eq_u32 s34, 63
v_mov_b32 v11, v40
s_cbranch_scc1 L_done_w1rf
v_mov_b64 v[36:37], 0
v_mov_b64 v[38:39], 0
v_mov_b64 v[40:41], 0
v_mov_b64 v[42:43], 0
v_bfe_u32 v77, v1, 6, 1
v_lshl_add_u32 v77, v77, 3, v1
v_lshlrev_b32 v77, 1, v77
L_top_w1rf:
s_barrier
ds_read_b128 v[60:63], v1 offset:1024
s_mov_b32 m0, 5120
s_nop 0
buffer_load_dwordx4 v1, s[4:7], s48 offen offset:1024 sc1 lds
s_barrier
ds_read_b128 v[64:67], v1 offset:2048
ds_read_b128 v[68:71], v1 offset:3072
ds_read_b128 v[72:75], v1 offset:4096
L_s0_w1rf:
s_waitcnt lgkmcnt(3)
v_smfmac_f32_16x16x64_bf16 v[20:23], v[60:63], v[44:51], v0
v_smfmac_f32_16x16x64_bf16 v[36:39], v[60:63], a[48:55], v0
v_smfmac_f32_16x16x64_bf16 v[32:35], v[60:63], v[184:191], v0
s_waitcnt lgkmcnt(2)
v_smfmac_f32_16x16x64_bf16 v[24:27], v[64:67], v[88:95], v0
buffer_load_dwordx4 v[12:15], v9, s[4:7], s37 offen offset:0
v_smfmac_f32_16x16x64_bf16 v[28:31], v[64:67], v[192:199], v0
ds_read_b128 v[44:47], v2 offset:2048
ds_read_b128 v[48:51], v2 offset:3072
v_smfmac_f32_16x16x64_bf16 v[20:23], v[64:67], v[80:87], v0
v_smfmac_f32_16x16x64_bf16 v[40:43], v[60:63], a[56:63], v0
v_smfmac_f32_16x16x64_bf16 v[32:35], v[64:67], v[200:207], v0
v_bitop3_b32 v6, v60, v64, s35 bitop3:0x7e
v_smfmac_f32_16x16x64_bf16 v[36:39], v[64:67], a[64:71], v0
s_waitcnt lgkmcnt(2)
v_bitop3_b32 v76, v68, v72, s35 bitop3:0x7e
v_smfmac_f32_16x16x64_bf16 v[28:31], v[60:63], v[176:183], v0
v_bitop3_b32 v6, v6, v76, 1 bitop3:0xa8
s_waitcnt lgkmcnt(0)
v_smfmac_f32_16x16x64_bf16 v[24:27], v[60:63], v[44:51], v0
ds_read_b128 v[44:47], v2 offset:4096
buffer_load_dwordx4 v[16:19], v9, s[4:7], s37 offen offset:1024
v_cmp_ne_u32 vcc, 0, v6
v_smfmac_f32_16x16x64_bf16 v[20:23], v[68:71], v[96:103], v0
v_smfmac_f32_16x16x64_bf16 v[40:43], v[64:67], a[72:79], v0
s_cbranch_vccnz L_ra0_w1rf
ds_read_b128 v[48:51], v2 offset:5120
v_smfmac_f32_16x16x64_bf16 v[24:27], v[68:71], v[104:111], v0
s_waitcnt vmcnt(2)
s_barrier
ds_read_b32 v6, v77 offset:8192
buffer_load_dwordx4 v[52:55], v1, s[4:7], s37 offen offset:2048
v_smfmac_f32_16x16x64_bf16 v[28:31], v[68:71], v[208:215], v0
ds_read_b128 v[60:63], v1 offset:6144
s_waitcnt lgkmcnt(2)
v_smfmac_f32_16x16x64_bf16 v[20:23], v[72:75], v[44:51], v0
buffer_load_dwordx4 v[56:59], v1, s[4:7], s37 offen offset:3072
ds_read_b128 v[64:67], v1 offset:7168
ds_read_b128 v[76:79], v1 offset:5120
v_smfmac_f32_16x16x64_bf16 v[32:35], v[68:71], v[216:223], v0
ds_read_b128 v[44:47], v2 offset:6144
v_smfmac_f32_16x16x64_bf16 v[36:39], v[68:71], a[80:87], v0
ds_read_b128 v[48:51], v2 offset:7168
s_mov_b32 m0, 0
v_smfmac_f32_16x16x64_bf16 v[40:43], v[68:71], a[88:95], v0
ds_read_b128 v[68:71], v1 offset:8192
s_waitcnt lgkmcnt(5)
v_bitop3_b32 v6, v6, v60, s35 bitop3:0x7e
v_smfmac_f32_16x16x64_bf16 v[28:31], v[72:75], v[224:231], v0
s_waitcnt lgkmcnt(4)
v_bitop3_b32 v6, v6, v64, s35 bitop3:0xf6
v_smfmac_f32_16x16x64_bf16 v[32:35], v[72:75], v[232:239], v0
s_waitcnt lgkmcnt(3)
v_bitop3_b32 v6, v6, v76, s35 bitop3:0xf6
v_and_b32 v6, 1, v6
s_waitcnt lgkmcnt(1)
v_smfmac_f32_16x16x64_bf16 v[24:27], v[72:75], v[44:51], v0
ds_read_b128 v[44:47], v2 offset:8192
v_cmp_ne_u32 vcc, 0, v6
v_smfmac_f32_16x16x64_bf16 v[36:39], v[72:75], a[96:103], v0
ds_read_b128 v[48:51], v2 offset:9216
v_lshlrev_b32 v6, 3, v1
v_smfmac_f32_16x16x64_bf16 v[40:43], v[72:75], a[104:111], v0
s_cbranch_vccnz L_ra1_w1rf
L_a1_w1rf:
ds_read_b128 v[72:75], v1 offset:9216
v_smfmac_f32_16x16x64_bf16 v[20:23], v[60:63], v[112:119], v0
buffer_store_dword v11, v10, s[4:7], s40 offen sc0 sc1
v_smfmac_f32_16x16x64_bf16 v[20:23], v[64:67], v[128:135], v0
s_waitcnt lgkmcnt(0)
v_smfmac_f32_16x16x64_bf16 v[20:23], v[72:75], v[160:167], v0
v_bfe_u32 v6, v1, 5, 1
v_smfmac_f32_16x16x64_bf16 v[20:23], v[76:79], v[44:51], v0
v_mad_i32_i24 v6, v6, s55, v1
v_smfmac_f32_16x16x64_bf16 v[20:23], v[68:71], v[144:151], v0
ds_read_b128 v[44:47], v2 offset:10240
v_smfmac_f32_16x16x64_bf16 v[24:27], v[60:63], v[120:127], v0
ds_read_b128 v[48:51], v2 offset:11264
v_smfmac_f32_16x16x64_bf16 v[24:27], v[64:67], v[136:143], v0
v_add_f32 v20, v20, v22
v_smfmac_f32_16x16x64_bf16 v[24:27], v[68:71], v[152:159], v0
v_add_f32 v21, v21, v23
v_smfmac_f32_16x16x64_bf16 v[24:27], v[72:75], v[168:175], v0
v_cvt_pk_bf16_f32 v22, v20, v21
s_waitcnt lgkmcnt(0)
v_smfmac_f32_16x16x64_bf16 v[24:27], v[76:79], v[44:51], v0
ds_read_b128 v[44:47], v2 offset:12288
v_smfmac_f32_16x16x64_bf16 v[28:31], v[76:79], v[240:247], v0
ds_read_b128 v[48:51], v2 offset:13312
v_smfmac_f32_16x16x64_bf16 v[28:31], v[64:67], a[0:7], v0
v_add_f32 v25, v25, v27
v_add_f32 v24, v24, v26
v_cvt_pk_bf16_f32 v23, v24, v25
v_smfmac_f32_16x16x64_bf16 v[28:31], v[68:71], a[16:23], v0
ds_write_b64 v3, v[22:23] offset:10752
v_smfmac_f32_16x16x64_bf16 v[28:31], v[72:75], a[32:39], v0
s_waitcnt vmcnt(1)
v_smfmac_f32_16x16x64_bf16 v[32:35], v[76:79], v[248:255], v0
s_waitcnt lgkmcnt(1)
v_smfmac_f32_16x16x64_bf16 v[28:31], v[60:63], v[44:51], v0
ds_read_b128 v[48:51], v2 offset:15360
ds_read_b128 v[44:47], v2 offset:14336
v_smfmac_f32_16x16x64_bf16 v[32:35], v[64:67], a[8:15], v0
s_waitcnt lgkmcnt(2)
s_barrier
v_smfmac_f32_16x16x64_bf16 v[32:35], v[68:71], a[24:31], v0
ds_read_b64_tr_b16 v[20:21], v4 offset:10240
ds_read_b64_tr_b16 v[22:23], v4 offset:10752
v_add_f32 v29, v29, v31
v_smfmac_f32_16x16x64_bf16 v[32:35], v[72:75], a[40:47], v0
ds_read_b64_tr_b16 v[24:25], v4 offset:11264
ds_read_b64_tr_b16 v[26:27], v4 offset:11776
s_waitcnt lgkmcnt(4)
v_smfmac_f32_16x16x64_bf16 v[32:35], v[60:63], v[44:51], v0
ds_read_b128 v[48:51], v2 offset:19456
s_waitcnt lgkmcnt(3)
v_mfma_f32_16x16x32_bf16 v[12:15], v[12:15], v[20:23], 0
ds_read_b128 v[44:47], v2 offset:18432
v_add_f32 v28, v28, v30
s_waitcnt lgkmcnt(2)
v_mfma_f32_16x16x32_bf16 v[12:15], v[16:19], v[24:27], v[12:15]
v_add_f32 v32, v32, v34
v_add_f32 v33, v33, v35
v_cvt_pk_bf16_f32 v30, v28, v29
v_cvt_pk_bf16_f32 v31, v32, v33
v_smfmac_f32_16x16x64_bf16 v[36:39], v[76:79], a[112:119], v0
ds_write_b64 v3, v[30:31] offset:12800
v_add_f32_dpp v12, v14, v12 quad_perm:[2,3,0,1] row_mask:0xf bank_mask:0xf
v_exp_f32 v14, v12
v_add_f32_dpp v13, v15, v13 quad_perm:[2,3,0,1] row_mask:0xf bank_mask:0xf
v_exp_f32 v15, v13
s_nop 0
v_cvt_pk_bf16_f32 v14, v14, v15
v_smfmac_f32_16x16x64_bf16 v[40:43], v[76:79], a[120:127], v0
ds_write_b32 v5, v14 offset:14624
s_waitcnt lgkmcnt(1)
s_barrier
ds_read_b64_tr_b16 v[28:29], v4 offset:12288
v_smfmac_f32_16x16x64_bf16 v[36:39], v[60:63], a[128:135], v0
ds_read_b64_tr_b16 v[30:31], v4 offset:12800
ds_read_b64_tr_b16 v[32:33], v4 offset:13312
v_smfmac_f32_16x16x64_bf16 v[40:43], v[60:63], a[136:143], v0
ds_read_b64_tr_b16 v[34:35], v4 offset:13824
v_mov_b64 v[76:77], s[52:53]
v_smfmac_f32_16x16x64_bf16 v[40:43], v[72:75], v[44:51], v0
ds_read_b128 v[44:47], v2 offset:16384
s_waitcnt lgkmcnt(3)
v_mfma_f32_16x16x32_bf16 v[28:31], v[28:31], v[20:23], 0
s_barrier
ds_read_b128 v[16:19], v1 offset:14368
s_waitcnt lgkmcnt(2)
v_mfma_f32_16x16x32_bf16 v[28:31], v[32:35], v[24:27], v[28:31]
ds_read_b128 v[60:63], v1 offset:14336
v_mov_b64 v[14:15], s[0:1]
v_smfmac_f32_16x16x64_bf16 v[40:43], v[64:67], a[152:159], v0
ds_read_b128 v[48:51], v2 offset:17408
v_mov_b64 v[78:79], s[52:53]
v_smfmac_f32_16x16x64_bf16 v[40:43], v[68:71], a[168:175], v0
v_add_f32_dpp v28, v30, v28 quad_perm:[2,3,0,1] row_mask:0xf bank_mask:0xf
v_smfmac_f32_16x16x64_bf16 v[36:39], v[64:67], a[144:151], v0
ds_read_b128 v[64:67], v2 offset:27648
v_mul_f32 v28, s50, v28
v_add_f32_dpp v29, v31, v29 quad_perm:[2,3,0,1] row_mask:0xf bank_mask:0xf
v_smfmac_f32_16x16x64_bf16 v[36:39], v[68:71], a[160:167], v0
ds_read_b128 v[68:71], v2 offset:30720
s_waitcnt lgkmcnt(2)
v_smfmac_f32_16x16x64_bf16 v[36:39], v[72:75], v[44:51], v0
ds_read_b128 v[72:75], v2 offset:31744
v_mul_f32 v29, s50, v29
v_cvt_pk_bf16_f32 v40, v40, v41
v_mfma_f32_16x16x32_bf16 v[32:35], v[76:79], v[16:19], 0
v_exp_f32 v30, v28
ds_read_b128 v[44:47], v2 offset:22528
v_mfma_f32_16x16x32_bf16 v[20:23], v[52:55], v[16:19], 0
v_exp_f32 v31, v29
v_mov_b64 v[76:77], 0
v_mfma_f32_16x16x32_bf16 v[20:23], v[56:59], v[60:63], v[20:23]
v_cvt_pk_bf16_f32 v41, v42, v43
v_cvt_pk_bf16_f32 v43, v38, v39
v_cvt_pk_bf16_f32 v30, v30, v31
v_cndmask_b32_e64 v26, 0, v30, s[56:57]
v_cndmask_b32_e64 v27, 0, v30, s[56:57]
s_nop 0
v_mov_b32_dpp v24, v26 quad_perm:[2,3,0,1] row_mask:0xf bank_mask:0xf
v_mfma_f32_16x16x16_bf16 v[32:35], v[14:15], v[26:27], v[32:35]
v_cvt_pk_bf16_f32 v42, v36, v37
v_mov_b32_dpp v25, v26 quad_perm:[2,3,0,1] row_mask:0xf bank_mask:0xf
s_nop 1
v_mfma_f32_16x16x32_bf16 v[20:23], v[40:43], v[24:27], v[20:23]
ds_read_b128 v[48:51], v2 offset:23552
ds_read_b128 v[60:63], v2 offset:26624
v_mov_b64 v[78:79], 0
v_rcp_f32 v33, v32
v_mov_b64 v[36:37], 0
v_min_f32 v32, v32, v33
v_cmp_nlt_f32 vcc, s2, v32
v_mul_f32_dpp v23, v33, v23 quad_perm:[0,1,0,1] row_mask:0xf bank_mask:0xf
v_mul_f32_dpp v21, v33, v21 quad_perm:[0,1,0,1] row_mask:0xf bank_mask:0xf
v_mul_f32_dpp v22, v33, v22 quad_perm:[0,1,0,1] row_mask:0xf bank_mask:0xf
v_mul_f32_dpp v20, v33, v20 quad_perm:[0,1,0,1] row_mask:0xf bank_mask:0xf
v_cvt_pk_bf16_f32 v20, v20, v21
v_cvt_pk_bf16_f32 v21, v22, v23
ds_write_b64 v6, v[20:21] offset:6144
s_and_b64 vcc, vcc, s[56:57]
v_mov_b32_dpp v19, v21 quad_perm:[2,3,2,3] row_mask:0xf bank_mask:0xf
s_cbranch_scc1 L_mx_w1rf
L_mxb_w1rf:
v_mov_b32_dpp v16, v20 quad_perm:[0,1,0,1] row_mask:0xf bank_mask:0xf
v_mov_b32_dpp v17, v21 quad_perm:[0,1,0,1] row_mask:0xf bank_mask:0xf
v_mov_b64 v[38:39], 0
v_mov_b32_dpp v18, v20 quad_perm:[2,3,2,3] row_mask:0xf bank_mask:0xf
v_mov_b64 v[26:27], 0
v_mov_b64 v[24:25], 0
v_smfmac_f32_16x16x64_bf16 v[76:79], v[16:19], a[176:183], v0
s_waitcnt lgkmcnt(0)
s_barrier
ds_read_b128 v[12:15], v7 offset:8192
v_mov_b64 v[32:33], 0
ds_read_b128 v[52:55], v7 offset:5120
v_smfmac_f32_16x16x64_bf16 v[36:39], v[16:19], v[44:51], v0
ds_read_b128 v[48:51], v2 offset:21504
ds_read_b128 v[44:47], v2 offset:20480
ds_read_b128 v[56:59], v7 offset:7168
v_mov_b64 v[30:31], 0
v_mov_b64 v[34:35], 0
v_smfmac_f32_16x16x64_bf16 v[24:27], v[16:19], v[60:67], v0
v_smfmac_f32_16x16x64_bf16 v[32:35], v[16:19], v[68:75], v0
ds_read_b128 v[68:71], v2 offset:28672
s_waitcnt lgkmcnt(5)
v_smfmac_f32_16x16x64_bf16 v[76:79], v[12:15], a[184:191], v0
ds_read_b128 v[60:63], v2 offset:24576
s_waitcnt lgkmcnt(5)
v_smfmac_f32_16x16x64_bf16 v[76:79], v[52:55], a[192:199], v0
ds_read_b128 v[64:67], v2 offset:25600
s_waitcnt lgkmcnt(3)
v_smfmac_f32_16x16x64_bf16 v[76:79], v[56:59], a[200:207], v0
v_mov_b64 v[28:29], 0
v_smfmac_f32_16x16x64_bf16 v[36:39], v[12:15], a[208:215], v0
ds_read_b128 v[72:75], v2 offset:29696
v_smfmac_f32_16x16x64_bf16 v[36:39], v[52:55], v[44:51], v0
ds_read_b128 v[44:47], v2 offset:34816
v_cvt_pk_bf16_f32 v77, v77, v79
v_cvt_pk_bf16_f32 v76, v76, v78
v_bfi_b32 v76, 1, s35, v76
v_smfmac_f32_16x16x64_bf16 v[36:39], v[56:59], a[216:223], v0
buffer_store_dwordx2 v[76:77], v8, s[4:7], s42 offen
ds_read_b128 v[48:51], v2 offset:35840
v_smfmac_f32_16x16x64_bf16 v[24:27], v[12:15], a[224:231], v0
s_waitcnt lgkmcnt(3)
v_smfmac_f32_16x16x64_bf16 v[24:27], v[52:55], v[60:67], v0
ds_read_b128 v[60:63], v2 offset:38912
v_cvt_pk_bf16_f32 v37, v37, v39
v_cvt_pk_bf16_f32 v36, v36, v38
v_bfi_b32 v36, 1, s35, v36
v_smfmac_f32_16x16x64_bf16 v[24:27], v[56:59], a[232:239], v0
buffer_store_dwordx2 v[36:37], v8, s[4:7], s43 offen
ds_read_b128 v[64:67], v2 offset:39936
ds_read_b128 v[40:43], v2 offset:33792
v_smfmac_f32_16x16x64_bf16 v[32:35], v[12:15], a[240:247], v0
s_waitcnt lgkmcnt(5)
v_smfmac_f32_16x16x64_bf16 v[32:35], v[52:55], v[68:75], v0
ds_read_b128 v[72:75], v2 offset:37888
ds_read_b128 v[36:39], v2 offset:32768
v_cvt_pk_bf16_f32 v25, v25, v27
v_cvt_pk_bf16_f32 v24, v24, v26
v_bfi_b32 v24, 1, s35, v24
buffer_store_dwordx2 v[24:25], v8, s[4:7], s44 offen
v_smfmac_f32_16x16x64_bf16 v[32:35], v[56:59], a[248:255], v0
ds_read_b128 v[68:71], v2 offset:36864
s_waitcnt lgkmcnt(6)
v_smfmac_f32_16x16x64_bf16 v[28:31], v[16:19], v[44:51], v0
s_nop 3
v_cvt_pk_bf16_f32 v33, v33, v35
v_cvt_pk_bf16_f32 v32, v32, v34
v_bfi_b32 v32, 1, s35, v32
buffer_store_dwordx2 v[32:33], v8, s[4:7], s45 offen
s_waitcnt lgkmcnt(1)
v_smfmac_f32_16x16x64_bf16 v[28:31], v[52:55], v[36:43], v0
v_smfmac_f32_16x16x64_bf16 v[28:31], v[12:15], v[60:67], v0
s_waitcnt lgkmcnt(0)
v_smfmac_f32_16x16x64_bf16 v[28:31], v[56:59], v[68:75], v0
s_nop 7
v_cvt_pk_bf16_f32 v28, v28, v30
v_bfi_b32 v28, 1, s35, v28
v_cvt_pk_bf16_f32 v29, v29, v31
buffer_store_dwordx2 v[28:29], v8, s[4:7], s46 offen
s_branch L_ex_w1rf
.p2align 6
L_ex_w2rf:
s_add_u32 s34, s34, 1
s_not_b32 s35, s35
s_not_b32 s36, s36
v_and_b32 v6, 0x70, v1
ds_read_b128 v[76:79], v6 offset:256
v_bfe_u32 v11, v1, 4, 2
v_lshrrev_b32_e64 v11, v11, 1
v_bfe_u32 v6, v1, 2, 7
s_mov_b32 m0, 1024
v_mov_b32 v42, s35
s_waitcnt vmcnt(1)
buffer_load_dwordx4 v[60:63], v9, s[4:7], s3 offen offset:0 sc1
buffer_load_dwordx4 v[64:67], v9, s[4:7], s3 offen offset:1024 sc1
buffer_load_dwordx4 v[68:71], v9, s[4:7], s3 offen offset:2048 sc1
buffer_load_dwordx4 v[72:75], v9, s[4:7], s3 offen offset:3072 sc1
s_barrier
s_waitcnt lgkmcnt(0)
s_waitcnt vmcnt(3)
L_r_w2rf:
v_mfma_f32_16x16x32_bf16 v[36:39], v[60:63], v[76:79], 0
s_waitcnt vmcnt(2)
v_mfma_f32_16x16x32_bf16 v[36:39], v[64:67], v[76:79], v[36:39]
v_bitop3_b32 v40, v60, v64, s36 bitop3:0x7e
s_waitcnt vmcnt(1)
v_mfma_f32_16x16x32_bf16 v[36:39], v[68:71], v[76:79], v[36:39]
s_waitcnt vmcnt(0)
v_mfma_f32_16x16x32_bf16 v[36:39], v[72:75], v[76:79], v[36:39]
v_bitop3_b32 v41, v68, v72, s36 bitop3:0x7e
v_bitop3_b32 v40, v40, v41, 1 bitop3:0xa8
v_cmp_ne_u32 vcc, 0, v40
v_nop
v_nop
v_nop
v_nop
v_nop
v_pk_add_f32 v[36:37], v[36:37], v[38:39]
v_cvt_pk_bf16_f32 v40, v36, v37
v_bfi_b32 v40, v11, s35, v40
s_cbranch_vccnz L_rr_w2rf
buffer_store_dword v40, v10, s[4:7], 0 offen
s_cmp_eq_u32 s34, 63
v_mov_b32 v11, v40
s_cbranch_scc1 L_done_w2rf
s_mov_b64 exec, 1
buffer_store_dword v42, v1, s[4:7], s33 offen
s_mov_b64 exec, -1
v_mov_b64 v[20:21], 0
v_mov_b64 v[22:23], 0
v_mov_b64 v[24:25], 0
v_mov_b64 v[26:27], 0
v_mov_b64 v[28:29], 0
v_mov_b64 v[30:31], 0
v_mov_b64 v[32:33], 0
v_mov_b64 v[34:35], 0
v_mov_b64 v[36:37], 0
v_mov_b64 v[38:39], 0
v_mov_b64 v[40:41], 0
v_mov_b64 v[42:43], 0
v_bfe_u32 v77, v1, 6, 1
v_lshl_add_u32 v77, v77, 3, v1
v_lshlrev_b32 v77, 1, v77
ds_read_b128 v[44:47], v2 offset:0
ds_read_b128 v[48:51], v2 offset:1024
s_add_u32 s37, s37, 524288
s_mul_i32 s40, s34, 10240
s_add_u32 s40, s40, 8093696
v_mov_b32 v79, s36
L_sp_w2rf:
buffer_load_dword v79, v6, s[4:7], s58 offen sc1
s_sub_u32 s41, s41, 1
s_cbranch_scc1 L_exit
buffer_load_dwordx4 v1, s[4:7], s47 offen offset:0 sc1 lds
buffer_load_dwordx4 v1, s[4:7], s47 offen offset:1024 sc1 lds
buffer_load_dwordx4 v1, s[4:7], s47 offen offset:2048 sc1 lds
buffer_load_dwordx4 v1, s[4:7], s47 offen offset:3072 sc1 lds
s_waitcnt vmcnt(9)
v_cmp_ne_u32 vcc, s35, v79
s_cbranch_vccnz L_sp_w2rf
L_top_w2rf:
s_waitcnt vmcnt(8)
s_barrier
ds_read_b128 v[60:63], v1 offset:1024
s_mov_b32 m0, 5120
s_nop 0
buffer_load_dwordx4 v1, s[4:7], s48 offen offset:2048 sc1 lds
s_waitcnt vmcnt(6)
s_barrier
ds_read_b128 v[64:67], v1 offset:2048
ds_read_b128 v[68:71], v1 offset:3072
ds_read_b128 v[72:75], v1 offset:4096
L_s0_w2rf:
s_waitcnt lgkmcnt(3)
v_smfmac_f32_16x16x64_bf16 v[32:35], v[60:63], v[184:191], v0
v_smfmac_f32_16x16x64_bf16 v[20:23], v[60:63], v[44:51], v0
v_smfmac_f32_16x16x64_bf16 v[36:39], v[60:63], a[48:55], v0
s_waitcnt lgkmcnt(2)
v_smfmac_f32_16x16x64_bf16 v[24:27], v[64:67], v[88:95], v0
v_smfmac_f32_16x16x64_bf16 v[40:43], v[60:63], a[56:63], v0
ds_read_b128 v[48:51], v2 offset:3072
ds_read_b128 v[44:47], v2 offset:2048
v_smfmac_f32_16x16x64_bf16 v[28:31], v[64:67], v[192:199], v0
v_smfmac_f32_16x16x64_bf16 v[20:23], v[64:67], v[80:87], v0
v_smfmac_f32_16x16x64_bf16 v[32:35], v[64:67], v[200:207], v0
buffer_load_dwordx4 v[12:15], v9, s[4:7], s37 offen offset:0
v_bitop3_b32 v6, v60, v64, s35 bitop3:0x7e
v_smfmac_f32_16x16x64_bf16 v[36:39], v[64:67], a[64:71], v0
s_waitcnt lgkmcnt(2)
v_bitop3_b32 v76, v68, v72, s35 bitop3:0x7e
v_smfmac_f32_16x16x64_bf16 v[28:31], v[60:63], v[176:183], v0
v_bitop3_b32 v6, v6, v76, 1 bitop3:0xa8
s_waitcnt lgkmcnt(0)
v_smfmac_f32_16x16x64_bf16 v[24:27], v[60:63], v[44:51], v0
ds_read_b128 v[44:47], v2 offset:4096
v_cmp_ne_u32 vcc, 0, v6
v_smfmac_f32_16x16x64_bf16 v[20:23], v[68:71], v[96:103], v0
v_smfmac_f32_16x16x64_bf16 v[40:43], v[64:67], a[72:79], v0
buffer_load_dwordx4 v[16:19], v9, s[4:7], s37 offen offset:1024
s_cbranch_vccnz L_ra0_w2rf
ds_read_b128 v[48:51], v2 offset:5120
v_smfmac_f32_16x16x64_bf16 v[24:27], v[68:71], v[104:111], v0
s_waitcnt vmcnt(2)
s_barrier
ds_read_b32 v6, v77 offset:8192
v_smfmac_f32_16x16x64_bf16 v[28:31], v[68:71], v[208:215], v0
ds_read_b128 v[60:63], v1 offset:6144
ds_read_b128 v[64:67], v1 offset:7168
buffer_load_dwordx4 v[52:55], v1, s[4:7], s37 offen offset:2048
s_waitcnt lgkmcnt(3)
v_smfmac_f32_16x16x64_bf16 v[20:23], v[72:75], v[44:51], v0
ds_read_b128 v[44:47], v2 offset:6144
v_smfmac_f32_16x16x64_bf16 v[32:35], v[68:71], v[216:223], v0
ds_read_b128 v[76:79], v1 offset:5120
buffer_load_dwordx4 v[56:59], v1, s[4:7], s37 offen offset:3072
v_smfmac_f32_16x16x64_bf16 v[36:39], v[68:71], a[80:87], v0
ds_read_b128 v[48:51], v2 offset:7168
s_mov_b32 m0, 0
v_smfmac_f32_16x16x64_bf16 v[40:43], v[68:71], a[88:95], v0
ds_read_b128 v[68:71], v1 offset:8192
s_waitcnt lgkmcnt(5)
v_bitop3_b32 v6, v6, v60, s35 bitop3:0x7e
v_smfmac_f32_16x16x64_bf16 v[28:31], v[72:75], v[224:231], v0
s_waitcnt lgkmcnt(4)
v_bitop3_b32 v6, v6, v64, s35 bitop3:0xf6
v_smfmac_f32_16x16x64_bf16 v[32:35], v[72:75], v[232:239], v0
s_waitcnt lgkmcnt(2)
v_bitop3_b32 v6, v6, v76, s35 bitop3:0xf6
v_and_b32 v6, 1, v6
s_waitcnt lgkmcnt(1)
v_smfmac_f32_16x16x64_bf16 v[24:27], v[72:75], v[44:51], v0
ds_read_b128 v[44:47], v2 offset:8192
v_cmp_ne_u32 vcc, 0, v6
v_smfmac_f32_16x16x64_bf16 v[36:39], v[72:75], a[96:103], v0
ds_read_b128 v[48:51], v2 offset:9216
v_lshlrev_b32 v6, 3, v1
v_smfmac_f32_16x16x64_bf16 v[40:43], v[72:75], a[104:111], v0
s_cbranch_vccnz L_ra1_w2rf
L_a1_w2rf:
ds_read_b128 v[72:75], v1 offset:9216
v_smfmac_f32_16x16x64_bf16 v[20:23], v[60:63], v[112:119], v0
buffer_store_dword v11, v10, s[4:7], s40 offen sc0 sc1
v_smfmac_f32_16x16x64_bf16 v[20:23], v[64:67], v[128:135], v0
s_waitcnt lgkmcnt(0)
v_smfmac_f32_16x16x64_bf16 v[20:23], v[72:75], v[160:167], v0
v_bfe_u32 v6, v1, 5, 1
v_smfmac_f32_16x16x64_bf16 v[20:23], v[76:79], v[44:51], v0
v_mad_i32_i24 v6, v6, s55, v1
v_smfmac_f32_16x16x64_bf16 v[20:23], v[68:71], v[144:151], v0
ds_read_b128 v[44:47], v2 offset:10240
v_smfmac_f32_16x16x64_bf16 v[24:27], v[60:63], v[120:127], v0
ds_read_b128 v[48:51], v2 offset:11264
v_smfmac_f32_16x16x64_bf16 v[24:27], v[64:67], v[136:143], v0
v_add_f32 v20, v20, v22
v_smfmac_f32_16x16x64_bf16 v[24:27], v[68:71], v[152:159], v0
v_add_f32 v21, v21, v23
v_cvt_pk_bf16_f32 v22, v20, v21
v_smfmac_f32_16x16x64_bf16 v[24:27], v[72:75], v[168:175], v0
s_waitcnt lgkmcnt(0)
v_smfmac_f32_16x16x64_bf16 v[24:27], v[76:79], v[44:51], v0
ds_read_b128 v[44:47], v2 offset:12288
v_smfmac_f32_16x16x64_bf16 v[28:31], v[76:79], v[240:247], v0
ds_read_b128 v[48:51], v2 offset:13312
v_smfmac_f32_16x16x64_bf16 v[28:31], v[64:67], a[0:7], v0
v_add_f32 v25, v25, v27
v_add_f32 v24, v24, v26
v_cvt_pk_bf16_f32 v23, v24, v25
v_smfmac_f32_16x16x64_bf16 v[28:31], v[68:71], a[16:23], v0
ds_write_b64 v3, v[22:23] offset:11264
v_smfmac_f32_16x16x64_bf16 v[32:35], v[76:79], v[248:255], v0
v_smfmac_f32_16x16x64_bf16 v[28:31], v[72:75], a[32:39], v0
s_waitcnt vmcnt(1)
s_waitcnt lgkmcnt(1)
v_smfmac_f32_16x16x64_bf16 v[28:31], v[60:63], v[44:51], v0
ds_read_b128 v[48:51], v2 offset:15360
ds_read_b128 v[44:47], v2 offset:14336
v_smfmac_f32_16x16x64_bf16 v[32:35], v[64:67], a[8:15], v0
s_waitcnt lgkmcnt(2)
s_barrier
ds_read_b64_tr_b16 v[20:21], v4 offset:10240
v_smfmac_f32_16x16x64_bf16 v[32:35], v[68:71], a[24:31], v0
ds_read_b64_tr_b16 v[22:23], v4 offset:10752
v_add_f32 v29, v29, v31
v_smfmac_f32_16x16x64_bf16 v[32:35], v[72:75], a[40:47], v0
ds_read_b64_tr_b16 v[24:25], v4 offset:11264
ds_read_b64_tr_b16 v[26:27], v4 offset:11776
s_waitcnt lgkmcnt(4)
v_smfmac_f32_16x16x64_bf16 v[32:35], v[60:63], v[44:51], v0
ds_read_b128 v[48:51], v2 offset:19456
s_waitcnt lgkmcnt(3)
v_mfma_f32_16x16x32_bf16 v[12:15], v[12:15], v[20:23], 0
ds_read_b128 v[44:47], v2 offset:18432
v_add_f32 v28, v28, v30
s_waitcnt lgkmcnt(2)
v_mfma_f32_16x16x32_bf16 v[12:15], v[16:19], v[24:27], v[12:15]
v_add_f32 v33, v33, v35
v_add_f32 v32, v32, v34
v_cvt_pk_bf16_f32 v30, v28, v29
v_cvt_pk_bf16_f32 v31, v32, v33
v_smfmac_f32_16x16x64_bf16 v[36:39], v[76:79], a[112:119], v0
ds_write_b64 v3, v[30:31] offset:13312
v_add_f32_dpp v12, v14, v12 quad_perm:[2,3,0,1] row_mask:0xf bank_mask:0xf
v_exp_f32 v14, v12
v_add_f32_dpp v13, v15, v13 quad_perm:[2,3,0,1] row_mask:0xf bank_mask:0xf
v_exp_f32 v15, v13
s_nop 0
v_cvt_pk_bf16_f32 v14, v14, v15
v_smfmac_f32_16x16x64_bf16 v[40:43], v[76:79], a[120:127], v0
ds_write_b32 v5, v14 offset:14880
s_waitcnt lgkmcnt(2)
v_smfmac_f32_16x16x64_bf16 v[40:43], v[72:75], v[44:51], v0
ds_read_b128 v[44:47], v2 offset:16384
s_waitcnt lgkmcnt(2)
s_barrier
ds_read_b64_tr_b16 v[28:29], v4 offset:12288
v_smfmac_f32_16x16x64_bf16 v[36:39], v[60:63], a[128:135], v0
ds_read_b64_tr_b16 v[30:31], v4 offset:12800
ds_read_b64_tr_b16 v[32:33], v4 offset:13312
v_smfmac_f32_16x16x64_bf16 v[40:43], v[60:63], a[136:143], v0
ds_read_b64_tr_b16 v[34:35], v4 offset:13824
v_mov_b64 v[76:77], s[52:53]
s_waitcnt lgkmcnt(2)
v_mfma_f32_16x16x32_bf16 v[28:31], v[28:31], v[20:23], 0
s_barrier
ds_read_b128 v[16:19], v1 offset:14368
s_waitcnt lgkmcnt(1)
v_mfma_f32_16x16x32_bf16 v[28:31], v[32:35], v[24:27], v[28:31]
ds_read_b128 v[60:63], v1 offset:14336
v_mov_b64 v[14:15], s[0:1]
v_smfmac_f32_16x16x64_bf16 v[40:43], v[64:67], a[152:159], v0
ds_read_b128 v[48:51], v2 offset:17408
v_mov_b64 v[78:79], s[52:53]
v_smfmac_f32_16x16x64_bf16 v[40:43], v[68:71], a[168:175], v0
v_add_f32_dpp v28, v30, v28 quad_perm:[2,3,0,1] row_mask:0xf bank_mask:0xf
v_mul_f32 v28, s50, v28
v_smfmac_f32_16x16x64_bf16 v[36:39], v[64:67], a[144:151], v0
ds_read_b128 v[64:67], v2 offset:23552
v_add_f32_dpp v29, v31, v29 quad_perm:[2,3,0,1] row_mask:0xf bank_mask:0xf
v_smfmac_f32_16x16x64_bf16 v[36:39], v[68:71], a[160:167], v0
ds_read_b128 v[68:71], v2 offset:24576
s_waitcnt lgkmcnt(2)
v_smfmac_f32_16x16x64_bf16 v[36:39], v[72:75], v[44:51], v0
ds_read_b128 v[72:75], v2 offset:25600
v_cvt_pk_bf16_f32 v40, v40, v41
v_mfma_f32_16x16x32_bf16 v[32:35], v[76:79], v[16:19], 0
ds_read_b128 v[44:47], v2 offset:20480
v_mul_f32 v29, s50, v29
v_exp_f32 v30, v28
v_mfma_f32_16x16x32_bf16 v[20:23], v[52:55], v[16:19], 0
v_exp_f32 v31, v29
v_cvt_pk_bf16_f32 v41, v42, v43
v_cvt_pk_bf16_f32 v43, v38, v39
v_mov_b64 v[76:77], 0
v_mfma_f32_16x16x32_bf16 v[20:23], v[56:59], v[60:63], v[20:23]
v_cvt_pk_bf16_f32 v30, v30, v31
v_cndmask_b32_e64 v26, 0, v30, s[56:57]
v_cndmask_b32_e64 v27, 0, v30, s[56:57]
s_nop 0
v_mov_b32_dpp v24, v26 quad_perm:[2,3,0,1] row_mask:0xf bank_mask:0xf
v_mfma_f32_16x16x16_bf16 v[32:35], v[14:15], v[26:27], v[32:35]
v_cvt_pk_bf16_f32 v42, v36, v37
v_mov_b32_dpp v25, v26 quad_perm:[2,3,0,1] row_mask:0xf bank_mask:0xf
s_nop 1
v_mfma_f32_16x16x32_bf16 v[20:23], v[40:43], v[24:27], v[20:23]
ds_read_b128 v[60:63], v2 offset:22528
ds_read_b128 v[48:51], v2 offset:21504
v_rcp_f32 v33, v32
v_mov_b64 v[36:37], 0
v_mov_b64 v[78:79], 0
v_min_f32 v32, v32, v33
v_cmp_nlt_f32 vcc, s2, v32
v_mul_f32_dpp v23, v33, v23 quad_perm:[0,1,0,1] row_mask:0xf bank_mask:0xf
v_mul_f32_dpp v21, v33, v21 quad_perm:[0,1,0,1] row_mask:0xf bank_mask:0xf
v_mul_f32_dpp v22, v33, v22 quad_perm:[0,1,0,1] row_mask:0xf bank_mask:0xf
v_mul_f32_dpp v20, v33, v20 quad_perm:[0,1,0,1] row_mask:0xf bank_mask:0xf
v_cvt_pk_bf16_f32 v20, v20, v21
v_cvt_pk_bf16_f32 v21, v22, v23
ds_write_b64 v6, v[20:21] offset:7168
s_and_b64 vcc, vcc, s[56:57]
v_mov_b32_dpp v16, v20 quad_perm:[0,1,0,1] row_mask:0xf bank_mask:0xf
v_mov_b32_dpp v19, v21 quad_perm:[2,3,2,3] row_mask:0xf bank_mask:0xf
s_cbranch_scc1 L_mx_w2rf
L_mxb_w2rf:
v_mov_b32_dpp v18, v20 quad_perm:[2,3,2,3] row_mask:0xf bank_mask:0xf
v_mov_b64 v[38:39], 0
v_mov_b32_dpp v17, v21 quad_perm:[0,1,0,1] row_mask:0xf bank_mask:0xf
v_mov_b64 v[26:27], 0
v_mov_b64 v[24:25], 0
v_mov_b64 v[32:33], 0
v_smfmac_f32_16x16x64_bf16 v[76:79], v[16:19], a[176:183], v0
s_waitcnt lgkmcnt(0)
s_barrier
ds_read_b128 v[12:15], v7 offset:5120
ds_read_b128 v[52:55], v7 offset:8192
v_smfmac_f32_16x16x64_bf16 v[36:39], v[16:19], a[184:191], v0
ds_read_b128 v[56:59], v7 offset:6144
v_mov_b64 v[34:35], 0
v_smfmac_f32_16x16x64_bf16 v[24:27], v[16:19], a[192:199], v0
v_smfmac_f32_16x16x64_bf16 v[32:35], v[16:19], a[200:207], v0
s_waitcnt lgkmcnt(2)
v_smfmac_f32_16x16x64_bf16 v[76:79], v[12:15], a[208:215], v0
s_waitcnt lgkmcnt(1)
v_smfmac_f32_16x16x64_bf16 v[76:79], v[52:55], a[216:223], v0
s_waitcnt lgkmcnt(0)
v_smfmac_f32_16x16x64_bf16 v[76:79], v[56:59], a[224:231], v0
v_smfmac_f32_16x16x64_bf16 v[36:39], v[12:15], v[44:51], v0
ds_read_b128 v[48:51], v2 offset:27648
ds_read_b128 v[44:47], v2 offset:26624
v_smfmac_f32_16x16x64_bf16 v[36:39], v[52:55], a[232:239], v0
v_cvt_pk_bf16_f32 v77, v77, v79
v_cvt_pk_bf16_f32 v76, v76, v78
v_bfi_b32 v76, 1, s35, v76
v_smfmac_f32_16x16x64_bf16 v[36:39], v[56:59], v[60:67], v0
buffer_store_dwordx2 v[76:77], v8, s[4:7], s42 offen
ds_read_b128 v[60:63], v2 offset:28672
v_smfmac_f32_16x16x64_bf16 v[24:27], v[12:15], v[68:75], v0
ds_read_b128 v[64:67], v2 offset:29696
v_smfmac_f32_16x16x64_bf16 v[24:27], v[52:55], a[240:247], v0
ds_read_b128 v[68:71], v2 offset:30720
v_cvt_pk_bf16_f32 v36, v36, v38
v_bfi_b32 v36, 1, s35, v36
v_cvt_pk_bf16_f32 v37, v37, v39
s_waitcnt lgkmcnt(3)
v_smfmac_f32_16x16x64_bf16 v[24:27], v[56:59], v[44:51], v0
buffer_store_dwordx2 v[36:37], v8, s[4:7], s43 offen
ds_read_b128 v[72:75], v2 offset:31744
v_smfmac_f32_16x16x64_bf16 v[32:35], v[52:55], a[248:255], v0
s_waitcnt lgkmcnt(2)
v_smfmac_f32_16x16x64_bf16 v[32:35], v[12:15], v[60:67], v0
v_cvt_pk_bf16_f32 v25, v25, v27
v_cvt_pk_bf16_f32 v24, v24, v26
v_bfi_b32 v24, 1, s35, v24
buffer_store_dwordx2 v[24:25], v8, s[4:7], s44 offen
s_waitcnt lgkmcnt(0)
v_smfmac_f32_16x16x64_bf16 v[32:35], v[56:59], v[68:75], v0
s_nop 7
v_cvt_pk_bf16_f32 v33, v33, v35
v_cvt_pk_bf16_f32 v32, v32, v34
v_bfi_b32 v32, 1, s35, v32
buffer_store_dwordx2 v[32:33], v8, s[4:7], s45 offen
s_branch L_ex_w2rf
.p2align 6
L_ex_w3f:
s_add_u32 s34, s34, 1
s_not_b32 s35, s35
s_not_b32 s36, s36
s_add_u32 s37, s37, 524288
s_add_u32 s39, s39, 524288
v_mov_b64 v[20:21], 0
v_mov_b64 v[22:23], 0
v_mov_b64 v[24:25], 0
v_mov_b64 v[26:27], 0
v_mov_b64 v[28:29], 0
v_mov_b64 v[30:31], 0
v_mov_b64 v[32:33], 0
v_mov_b64 v[34:35], 0
v_mov_b64 v[36:37], 0
v_mov_b64 v[38:39], 0
v_mov_b64 v[40:41], 0
v_mov_b64 v[42:43], 0
ds_read_b128 v[44:47], v2 offset:0
ds_read_b128 v[48:51], v2 offset:1024
v_bfe_u32 v77, v1, 6, 1
v_lshl_add_u32 v77, v77, 3, v1
v_lshlrev_b32 v77, 1, v77
s_barrier
s_cmp_eq_u32 s34, 63
s_cbranch_scc1 L_done_w3f
s_cmp_ge_u32 s34, s100
s_cbranch_scc1 L_ev_w3f
L_evb_w3f:
L_top_w3f:
s_barrier
ds_read_b128 v[60:63], v1 offset:1024
s_mov_b32 m0, 5120
s_nop 0
buffer_load_dwordx4 v1, s[4:7], s48 offen offset:3072 sc1 lds
s_barrier
ds_read_b128 v[64:67], v1 offset:2048
ds_read_b128 v[68:71], v1 offset:3072
ds_read_b128 v[72:75], v1 offset:4096
L_s0_w3f:
s_waitcnt lgkmcnt(3)
v_smfmac_f32_16x16x64_bf16 v[32:35], v[60:63], v[184:191], v0
s_mov_b32 m0, 9216
s_nop 0
buffer_load_dwordx4 v1, s[4:7], s49 offen offset:0 sc1 lds
s_waitcnt lgkmcnt(2)
v_smfmac_f32_16x16x64_bf16 v[24:27], v[64:67], v[88:95], v0
v_smfmac_f32_16x16x64_bf16 v[20:23], v[60:63], v[44:51], v0
v_smfmac_f32_16x16x64_bf16 v[36:39], v[60:63], a[48:55], v0
v_smfmac_f32_16x16x64_bf16 v[28:31], v[64:67], v[192:199], v0
ds_read_b128 v[48:51], v2 offset:3072
ds_read_b128 v[44:47], v2 offset:2048
v_smfmac_f32_16x16x64_bf16 v[40:43], v[60:63], a[56:63], v0
v_smfmac_f32_16x16x64_bf16 v[20:23], v[64:67], v[80:87], v0
v_bitop3_b32 v6, v60, v64, s35 bitop3:0x7e
v_smfmac_f32_16x16x64_bf16 v[32:35], v[64:67], v[200:207], v0
buffer_load_dwordx4 v[12:15], v9, s[4:7], s37 offen offset:0
v_smfmac_f32_16x16x64_bf16 v[36:39], v[64:67], a[64:71], v0
s_waitcnt lgkmcnt(2)
v_bitop3_b32 v76, v68, v72, s35 bitop3:0x7e
v_smfmac_f32_16x16x64_bf16 v[28:31], v[60:63], v[176:183], v0
v_bitop3_b32 v6, v6, v76, 1 bitop3:0xa8
v_cmp_ne_u32 vcc, 0, v6
s_waitcnt lgkmcnt(0)
v_smfmac_f32_16x16x64_bf16 v[24:27], v[60:63], v[44:51], v0
ds_read_b128 v[44:47], v2 offset:4096
v_smfmac_f32_16x16x64_bf16 v[20:23], v[68:71], v[96:103], v0
ds_read_b128 v[48:51], v2 offset:5120
s_cbranch_vccnz L_ra0_w3f
v_smfmac_f32_16x16x64_bf16 v[40:43], v[64:67], a[72:79], v0
s_waitcnt vmcnt(1)
s_barrier
v_smfmac_f32_16x16x64_bf16 v[24:27], v[68:71], v[104:111], v0
ds_read_b32 v6, v77 offset:8192
buffer_load_dwordx4 v[16:19], v9, s[4:7], s37 offen offset:1024
v_smfmac_f32_16x16x64_bf16 v[28:31], v[68:71], v[208:215], v0
ds_read_b128 v[60:63], v1 offset:6144
ds_read_b128 v[64:67], v1 offset:7168
s_waitcnt lgkmcnt(3)
v_smfmac_f32_16x16x64_bf16 v[20:23], v[72:75], v[44:51], v0
buffer_load_dwordx4 v[52:55], v1, s[4:7], s37 offen offset:2048
ds_read_b128 v[44:47], v2 offset:6144
v_smfmac_f32_16x16x64_bf16 v[32:35], v[68:71], v[216:223], v0
ds_read_b128 v[76:79], v1 offset:5120
v_smfmac_f32_16x16x64_bf16 v[36:39], v[68:71], a[80:87], v0
ds_read_b128 v[48:51], v2 offset:7168
v_smfmac_f32_16x16x64_bf16 v[40:43], v[68:71], a[88:95], v0
s_mov_b32 m0, 0
buffer_load_dwordx4 v[56:59], v1, s[4:7], s37 offen offset:3072
ds_read_b128 v[68:71], v1 offset:8192
s_waitcnt lgkmcnt(5)
v_bitop3_b32 v6, v6, v60, s35 bitop3:0x7e
v_smfmac_f32_16x16x64_bf16 v[28:31], v[72:75], v[224:231], v0
s_waitcnt lgkmcnt(4)
v_bitop3_b32 v6, v6, v64, s35 bitop3:0xf6
v_smfmac_f32_16x16x64_bf16 v[32:35], v[72:75], v[232:239], v0
s_waitcnt lgkmcnt(2)
v_bitop3_b32 v6, v6, v76, s35 bitop3:0xf6
v_and_b32 v6, 1, v6
s_waitcnt lgkmcnt(1)
v_smfmac_f32_16x16x64_bf16 v[24:27], v[72:75], v[44:51], v0
ds_read_b128 v[44:47], v2 offset:8192
v_cmp_ne_u32 vcc, 0, v6
v_smfmac_f32_16x16x64_bf16 v[36:39], v[72:75], a[96:103], v0
ds_read_b128 v[48:51], v2 offset:9216
v_lshlrev_b32 v6, 3, v1
v_smfmac_f32_16x16x64_bf16 v[40:43], v[72:75], a[104:111], v0
s_cbranch_vccnz L_ra1_w3f
L_a1_w3f:
ds_read_b128 v[72:75], v1 offset:9216
v_smfmac_f32_16x16x64_bf16 v[20:23], v[60:63], v[112:119], v0
v_smfmac_f32_16x16x64_bf16 v[20:23], v[64:67], v[128:135], v0
buffer_load_dword v6, s[4:7], s39 offen lds
s_waitcnt lgkmcnt(0)
v_smfmac_f32_16x16x64_bf16 v[20:23], v[72:75], v[160:167], v0
v_bfe_u32 v6, v1, 5, 1
v_smfmac_f32_16x16x64_bf16 v[20:23], v[76:79], v[44:51], v0
v_mad_i32_i24 v6, v6, s55, v1
v_smfmac_f32_16x16x64_bf16 v[20:23], v[68:71], v[144:151], v0
ds_read_b128 v[44:47], v2 offset:10240
v_smfmac_f32_16x16x64_bf16 v[24:27], v[60:63], v[120:127], v0
ds_read_b128 v[48:51], v2 offset:11264
v_smfmac_f32_16x16x64_bf16 v[24:27], v[64:67], v[136:143], v0
v_add_f32 v20, v20, v22
v_smfmac_f32_16x16x64_bf16 v[24:27], v[68:71], v[152:159], v0
v_add_f32 v21, v21, v23
v_smfmac_f32_16x16x64_bf16 v[24:27], v[72:75], v[168:175], v0
v_cvt_pk_bf16_f32 v22, v20, v21
s_waitcnt lgkmcnt(0)
v_smfmac_f32_16x16x64_bf16 v[24:27], v[76:79], v[44:51], v0
ds_read_b128 v[44:47], v2 offset:12288
v_smfmac_f32_16x16x64_bf16 v[28:31], v[76:79], v[240:247], v0
ds_read_b128 v[48:51], v2 offset:13312
v_smfmac_f32_16x16x64_bf16 v[28:31], v[64:67], a[0:7], v0
v_add_f32 v25, v25, v27
v_add_f32 v24, v24, v26
v_cvt_pk_bf16_f32 v23, v24, v25
v_smfmac_f32_16x16x64_bf16 v[28:31], v[68:71], a[16:23], v0
ds_write_b64 v3, v[22:23] offset:11776
v_smfmac_f32_16x16x64_bf16 v[32:35], v[76:79], v[248:255], v0
v_smfmac_f32_16x16x64_bf16 v[28:31], v[72:75], a[32:39], v0
s_waitcnt vmcnt(1)
s_waitcnt lgkmcnt(1)
v_smfmac_f32_16x16x64_bf16 v[28:31], v[60:63], v[44:51], v0
ds_read_b128 v[48:51], v2 offset:15360
ds_read_b128 v[44:47], v2 offset:14336
v_smfmac_f32_16x16x64_bf16 v[32:35], v[64:67], a[8:15], v0
s_waitcnt lgkmcnt(2)
s_barrier
v_smfmac_f32_16x16x64_bf16 v[32:35], v[68:71], a[24:31], v0
ds_read_b64_tr_b16 v[20:21], v4 offset:10240
ds_read_b64_tr_b16 v[22:23], v4 offset:10752
v_add_f32 v29, v29, v31
v_smfmac_f32_16x16x64_bf16 v[32:35], v[72:75], a[40:47], v0
ds_read_b64_tr_b16 v[24:25], v4 offset:11264
ds_read_b64_tr_b16 v[26:27], v4 offset:11776
s_waitcnt lgkmcnt(4)
v_smfmac_f32_16x16x64_bf16 v[32:35], v[60:63], v[44:51], v0
ds_read_b128 v[48:51], v2 offset:19456
s_waitcnt lgkmcnt(3)
v_mfma_f32_16x16x32_bf16 v[12:15], v[12:15], v[20:23], 0
ds_read_b128 v[44:47], v2 offset:18432
v_add_f32 v28, v28, v30
s_waitcnt lgkmcnt(2)
v_mfma_f32_16x16x32_bf16 v[12:15], v[16:19], v[24:27], v[12:15]
v_add_f32 v32, v32, v34
v_add_f32 v33, v33, v35
v_cvt_pk_bf16_f32 v30, v28, v29
v_cvt_pk_bf16_f32 v31, v32, v33
v_smfmac_f32_16x16x64_bf16 v[36:39], v[76:79], a[112:119], v0
ds_write_b64 v3, v[30:31] offset:13824
v_add_f32_dpp v12, v14, v12 quad_perm:[2,3,0,1] row_mask:0xf bank_mask:0xf
v_exp_f32 v14, v12
v_add_f32_dpp v13, v15, v13 quad_perm:[2,3,0,1] row_mask:0xf bank_mask:0xf
v_exp_f32 v15, v13
s_nop 0
v_cvt_pk_bf16_f32 v14, v14, v15
v_smfmac_f32_16x16x64_bf16 v[40:43], v[76:79], a[120:127], v0
ds_write_b32 v5, v14 offset:15136
s_waitcnt lgkmcnt(1)
s_barrier
ds_read_b64_tr_b16 v[28:29], v4 offset:12288
v_smfmac_f32_16x16x64_bf16 v[36:39], v[60:63], a[128:135], v0
ds_read_b64_tr_b16 v[30:31], v4 offset:12800
ds_read_b64_tr_b16 v[32:33], v4 offset:13312
v_smfmac_f32_16x16x64_bf16 v[40:43], v[60:63], a[136:143], v0
ds_read_b64_tr_b16 v[34:35], v4 offset:13824
v_mov_b64 v[76:77], s[52:53]
v_smfmac_f32_16x16x64_bf16 v[40:43], v[72:75], v[44:51], v0
ds_read_b128 v[44:47], v2 offset:16384
s_waitcnt lgkmcnt(3)
v_mfma_f32_16x16x32_bf16 v[28:31], v[28:31], v[20:23], 0
s_barrier
ds_read_b128 v[16:19], v1 offset:14368
s_waitcnt lgkmcnt(2)
v_mfma_f32_16x16x32_bf16 v[28:31], v[32:35], v[24:27], v[28:31]
ds_read_b128 v[60:63], v1 offset:14336
v_mov_b64 v[14:15], s[0:1]
v_smfmac_f32_16x16x64_bf16 v[40:43], v[64:67], a[152:159], v0
ds_read_b128 v[48:51], v2 offset:17408
v_mov_b64 v[78:79], s[52:53]
v_smfmac_f32_16x16x64_bf16 v[40:43], v[68:71], a[168:175], v0
v_add_f32_dpp v28, v30, v28 quad_perm:[2,3,0,1] row_mask:0xf bank_mask:0xf
v_mul_f32 v28, s50, v28
v_smfmac_f32_16x16x64_bf16 v[36:39], v[64:67], a[144:151], v0
ds_read_b128 v[64:67], v2 offset:21504
v_add_f32_dpp v29, v31, v29 quad_perm:[2,3,0,1] row_mask:0xf bank_mask:0xf
v_smfmac_f32_16x16x64_bf16 v[36:39], v[68:71], a[160:167], v0
ds_read_b128 v[68:71], v2 offset:26624
s_waitcnt lgkmcnt(2)
v_smfmac_f32_16x16x64_bf16 v[36:39], v[72:75], v[44:51], v0
ds_read_b128 v[72:75], v2 offset:27648
v_cvt_pk_bf16_f32 v40, v40, v41
v_exp_f32 v30, v28
v_mfma_f32_16x16x32_bf16 v[32:35], v[76:79], v[16:19], 0
ds_read_b128 v[44:47], v2 offset:22528
v_mul_f32 v29, s50, v29
v_mfma_f32_16x16x32_bf16 v[20:23], v[52:55], v[16:19], 0
v_exp_f32 v31, v29
v_mfma_f32_16x16x32_bf16 v[20:23], v[56:59], v[60:63], v[20:23]
v_cvt_pk_bf16_f32 v41, v42, v43
v_cvt_pk_bf16_f32 v30, v30, v31
v_cndmask_b32_e64 v26, 0, v30, s[56:57]
v_cvt_pk_bf16_f32 v43, v38, v39
v_cndmask_b32_e64 v27, 0, v30, s[56:57]
v_mov_b32_dpp v24, v26 quad_perm:[2,3,0,1] row_mask:0xf bank_mask:0xf
v_mov_b64 v[76:77], 0
v_mfma_f32_16x16x16_bf16 v[32:35], v[14:15], v[26:27], v[32:35]
v_cvt_pk_bf16_f32 v42, v36, v37
v_mov_b32_dpp v25, v26 quad_perm:[2,3,0,1] row_mask:0xf bank_mask:0xf
s_nop 1
v_mfma_f32_16x16x32_bf16 v[20:23], v[40:43], v[24:27], v[20:23]
ds_read_b128 v[48:51], v2 offset:23552
s_nop 0
v_rcp_f32 v33, v32
ds_read_b128 v[60:63], v2 offset:20480
v_mov_b64 v[36:37], 0
v_min_f32 v32, v32, v33
v_cmp_nlt_f32 vcc, s2, v32
v_mov_b64 v[78:79], 0
v_mul_f32_dpp v23, v33, v23 quad_perm:[0,1,0,1] row_mask:0xf bank_mask:0xf
v_mul_f32_dpp v21, v33, v21 quad_perm:[0,1,0,1] row_mask:0xf bank_mask:0xf
v_mul_f32_dpp v22, v33, v22 quad_perm:[0,1,0,1] row_mask:0xf bank_mask:0xf
v_mul_f32_dpp v20, v33, v20 quad_perm:[0,1,0,1] row_mask:0xf bank_mask:0xf
v_cvt_pk_bf16_f32 v20, v20, v21
v_cvt_pk_bf16_f32 v21, v22, v23
ds_write_b64 v6, v[20:21] offset:8192
s_and_b64 vcc, vcc, s[56:57]
v_mov_b64 v[38:39], 0
s_cbranch_scc1 L_mx_w3f
L_mxb_w3f:
v_mov_b32_dpp v16, v20 quad_perm:[0,1,0,1] row_mask:0xf bank_mask:0xf
v_mov_b32_dpp v19, v21 quad_perm:[2,3,2,3] row_mask:0xf bank_mask:0xf
v_mov_b64 v[24:25], 0
v_mov_b32_dpp v18, v20 quad_perm:[2,3,2,3] row_mask:0xf bank_mask:0xf
v_mov_b32_dpp v17, v21 quad_perm:[0,1,0,1] row_mask:0xf bank_mask:0xf
v_mov_b64 v[26:27], 0
v_mov_b64 v[32:33], 0
v_smfmac_f32_16x16x64_bf16 v[76:79], v[16:19], a[176:183], v0
s_waitcnt lgkmcnt(0)
s_barrier
ds_read_b128 v[12:15], v7 offset:6144
ds_read_b128 v[52:55], v7 offset:7168
v_smfmac_f32_16x16x64_bf16 v[36:39], v[16:19], a[184:191], v0
ds_read_b128 v[56:59], v7 offset:5120
v_mov_b64 v[34:35], 0
s_nop 1
v_smfmac_f32_16x16x64_bf16 v[32:35], v[16:19], a[200:207], v0
v_smfmac_f32_16x16x64_bf16 v[24:27], v[16:19], a[192:199], v0
s_waitcnt lgkmcnt(2)
v_smfmac_f32_16x16x64_bf16 v[76:79], v[12:15], a[208:215], v0
s_waitcnt lgkmcnt(1)
v_smfmac_f32_16x16x64_bf16 v[76:79], v[52:55], a[216:223], v0
s_waitcnt lgkmcnt(0)
v_smfmac_f32_16x16x64_bf16 v[76:79], v[56:59], a[224:231], v0
v_smfmac_f32_16x16x64_bf16 v[36:39], v[12:15], v[44:51], v0
ds_read_b128 v[48:51], v2 offset:25600
ds_read_b128 v[44:47], v2 offset:24576
v_smfmac_f32_16x16x64_bf16 v[36:39], v[52:55], a[232:239], v0
v_cvt_pk_bf16_f32 v77, v77, v79
v_cvt_pk_bf16_f32 v76, v76, v78
v_bfi_b32 v76, 1, s35, v76
v_smfmac_f32_16x16x64_bf16 v[36:39], v[56:59], v[60:67], v0
buffer_store_dwordx2 v[76:77], v8, s[4:7], s42 offen
ds_read_b128 v[60:63], v2 offset:30720
v_smfmac_f32_16x16x64_bf16 v[24:27], v[12:15], v[68:75], v0
ds_read_b128 v[64:67], v2 offset:31744
v_smfmac_f32_16x16x64_bf16 v[24:27], v[52:55], a[240:247], v0
ds_read_b128 v[68:71], v2 offset:28672
v_cvt_pk_bf16_f32 v36, v36, v38
v_bfi_b32 v36, 1, s35, v36
v_cvt_pk_bf16_f32 v37, v37, v39
s_waitcnt lgkmcnt(3)
v_smfmac_f32_16x16x64_bf16 v[24:27], v[56:59], v[44:51], v0
buffer_store_dwordx2 v[36:37], v8, s[4:7], s43 offen
ds_read_b128 v[72:75], v2 offset:29696
s_nop 5
v_cvt_pk_bf16_f32 v25, v25, v27
v_cvt_pk_bf16_f32 v24, v24, v26
v_bfi_b32 v24, 1, s35, v24
v_smfmac_f32_16x16x64_bf16 v[32:35], v[52:55], a[248:255], v0
s_waitcnt lgkmcnt(2)
v_smfmac_f32_16x16x64_bf16 v[32:35], v[12:15], v[60:67], v0
buffer_store_dwordx2 v[24:25], v8, s[4:7], s44 offen
s_waitcnt lgkmcnt(0)
v_smfmac_f32_16x16x64_bf16 v[32:35], v[56:59], v[68:75], v0
s_nop 7
v_cvt_pk_bf16_f32 v33, v33, v35
v_cvt_pk_bf16_f32 v32, v32, v34
v_bfi_b32 v32, 1, s35, v32
buffer_store_dwordx2 v[32:33], v8, s[4:7], s45 offen
s_branch L_ex_w3f
.p2align 6
L_ex_w0s:
s_add_u32 s34, s34, 1
s_not_b32 s35, s35
s_not_b32 s36, s36
s_add_u32 s37, s37, 524288
s_add_u32 s39, s39, 524288
v_mov_b64 v[20:21], 0
v_mov_b64 v[22:23], 0
v_mov_b64 v[24:25], 0
v_mov_b64 v[26:27], 0
v_mov_b64 v[28:29], 0
v_mov_b64 v[30:31], 0
v_mov_b64 v[32:33], 0
v_mov_b64 v[34:35], 0
v_mov_b64 v[36:37], 0
v_mov_b64 v[38:39], 0
v_mov_b64 v[40:41], 0
v_mov_b64 v[42:43], 0
ds_read_b128 v[44:47], v2 offset:0
ds_read_b128 v[48:51], v2 offset:1024
v_bfe_u32 v77, v1, 6, 1
v_lshl_add_u32 v77, v77, 3, v1
v_lshlrev_b32 v77, 1, v77
s_barrier
s_cmp_eq_u32 s34, 63
s_cbranch_scc1 L_done_w0s
L_top_w0s:
s_barrier
ds_read_b128 v[60:63], v1 offset:1024
s_mov_b32 m0, 5120
s_nop 0
buffer_load_dwordx4 v1, s[4:7], s48 offen offset:0 sc0 sc1 lds
s_barrier
ds_read_b128 v[64:67], v1 offset:2048
ds_read_b128 v[68:71], v1 offset:3072
ds_read_b128 v[72:75], v1 offset:4096
L_s0_w0s:
s_waitcnt lgkmcnt(3)
v_smfmac_f32_16x16x64_bf16 v[32:35], v[60:63], v[184:191], v0
v_smfmac_f32_16x16x64_bf16 v[36:39], v[60:63], a[48:55], v0
v_smfmac_f32_16x16x64_bf16 v[20:23], v[60:63], v[44:51], v0
buffer_load_dwordx4 v[12:15], v9, s[4:7], s37 offen offset:0
v_smfmac_f32_16x16x64_bf16 v[40:43], v[60:63], a[56:63], v0
s_waitcnt lgkmcnt(2)
v_smfmac_f32_16x16x64_bf16 v[24:27], v[64:67], v[88:95], v0
v_smfmac_f32_16x16x64_bf16 v[28:31], v[64:67], v[192:199], v0
v_smfmac_f32_16x16x64_bf16 v[20:23], v[64:67], v[80:87], v0
ds_read_b128 v[48:51], v2 offset:3072
ds_read_b128 v[44:47], v2 offset:2048
v_smfmac_f32_16x16x64_bf16 v[32:35], v[64:67], v[200:207], v0
v_bitop3_b32 v6, v60, v64, s35 bitop3:0x7e
s_waitcnt lgkmcnt(2)
v_bitop3_b32 v76, v68, v72, s35 bitop3:0x7e
v_smfmac_f32_16x16x64_bf16 v[28:31], v[60:63], v[176:183], v0
v_bitop3_b32 v6, v6, v76, 1 bitop3:0xa8
v_smfmac_f32_16x16x64_bf16 v[36:39], v[64:67], a[64:71], v0
buffer_load_dwordx4 v[16:19], v9, s[4:7], s37 offen offset:1024
s_waitcnt lgkmcnt(0)
v_smfmac_f32_16x16x64_bf16 v[24:27], v[60:63], v[44:51], v0
ds_read_b128 v[44:47], v2 offset:4096
v_cmp_ne_u32 vcc, 0, v6
v_smfmac_f32_16x16x64_bf16 v[20:23], v[68:71], v[96:103], v0
v_smfmac_f32_16x16x64_bf16 v[40:43], v[64:67], a[72:79], v0
s_cbranch_vccnz L_ra0_w0s
ds_read_b128 v[48:51], v2 offset:5120
buffer_load_dwordx4 v[52:55], v1, s[4:7], s37 offen offset:2048
v_smfmac_f32_16x16x64_bf16 v[24:27], v[68:71], v[104:111], v0
s_waitcnt vmcnt(3)
s_barrier
ds_read_b32 v6, v77 offset:8192
v_smfmac_f32_16x16x64_bf16 v[28:31], v[68:71], v[208:215], v0
ds_read_b128 v[60:63], v1 offset:6144
buffer_load_dwordx4 v[56:59], v1, s[4:7], s37 offen offset:3072
s_waitcnt lgkmcnt(2)
v_smfmac_f32_16x16x64_bf16 v[20:23], v[72:75], v[44:51], v0
ds_read_b128 v[64:67], v1 offset:7168
ds_read_b128 v[76:79], v1 offset:5120
v_smfmac_f32_16x16x64_bf16 v[32:35], v[68:71], v[216:223], v0
ds_read_b128 v[44:47], v2 offset:6144
v_smfmac_f32_16x16x64_bf16 v[36:39], v[68:71], a[80:87], v0
ds_read_b128 v[48:51], v2 offset:7168
s_mov_b32 m0, 0
v_smfmac_f32_16x16x64_bf16 v[40:43], v[68:71], a[88:95], v0
ds_read_b128 v[68:71], v1 offset:8192
s_waitcnt lgkmcnt(5)
v_bitop3_b32 v6, v6, v60, s35 bitop3:0x7e
v_smfmac_f32_16x16x64_bf16 v[28:31], v[72:75], v[224:231], v0
s_waitcnt lgkmcnt(4)
v_bitop3_b32 v6, v6, v64, s35 bitop3:0xf6
v_smfmac_f32_16x16x64_bf16 v[32:35], v[72:75], v[232:239], v0
s_waitcnt lgkmcnt(3)
v_bitop3_b32 v6, v6, v76, s35 bitop3:0xf6
v_and_b32 v6, 1, v6
s_waitcnt lgkmcnt(1)
v_smfmac_f32_16x16x64_bf16 v[24:27], v[72:75], v[44:51], v0
ds_read_b128 v[44:47], v2 offset:8192
v_cmp_ne_u32 vcc, 0, v6
v_smfmac_f32_16x16x64_bf16 v[36:39], v[72:75], a[96:103], v0
ds_read_b128 v[48:51], v2 offset:9216
v_lshlrev_b32 v6, 3, v1
v_smfmac_f32_16x16x64_bf16 v[40:43], v[72:75], a[104:111], v0
ds_read_b128 v[72:75], v1 offset:9216
s_cbranch_vccnz L_ra1_w0s
L_a1_w0s:
v_smfmac_f32_16x16x64_bf16 v[20:23], v[60:63], v[112:119], v0
v_smfmac_f32_16x16x64_bf16 v[20:23], v[64:67], v[128:135], v0
buffer_load_dword v6, s[4:7], s39 offen lds
s_waitcnt lgkmcnt(0)
v_smfmac_f32_16x16x64_bf16 v[20:23], v[72:75], v[160:167], v0
v_bfe_u32 v6, v1, 5, 1
v_smfmac_f32_16x16x64_bf16 v[20:23], v[76:79], v[44:51], v0
v_mad_i32_i24 v6, v6, s55, v1
v_smfmac_f32_16x16x64_bf16 v[20:23], v[68:71], v[144:151], v0
ds_read_b128 v[44:47], v2 offset:10240
v_smfmac_f32_16x16x64_bf16 v[24:27], v[60:63], v[120:127], v0
ds_read_b128 v[48:51], v2 offset:11264
v_smfmac_f32_16x16x64_bf16 v[24:27], v[64:67], v[136:143], v0
v_add_f32 v20, v20, v22
v_smfmac_f32_16x16x64_bf16 v[24:27], v[68:71], v[152:159], v0
v_add_f32 v21, v21, v23
v_cvt_pk_bf16_f32 v22, v20, v21
v_smfmac_f32_16x16x64_bf16 v[24:27], v[72:75], v[168:175], v0
s_waitcnt lgkmcnt(0)
v_smfmac_f32_16x16x64_bf16 v[24:27], v[76:79], v[44:51], v0
ds_read_b128 v[44:47], v2 offset:12288
v_smfmac_f32_16x16x64_bf16 v[28:31], v[76:79], v[240:247], v0
v_smfmac_f32_16x16x64_bf16 v[28:31], v[64:67], a[0:7], v0
ds_read_b128 v[48:51], v2 offset:13312
v_add_f32 v25, v25, v27
v_add_f32 v24, v24, v26
v_cvt_pk_bf16_f32 v23, v24, v25
v_smfmac_f32_16x16x64_bf16 v[28:31], v[68:71], a[16:23], v0
ds_write_b64 v3, v[22:23] offset:10240
v_smfmac_f32_16x16x64_bf16 v[28:31], v[72:75], a[32:39], v0
s_waitcnt vmcnt(1)
s_waitcnt lgkmcnt(1)
v_smfmac_f32_16x16x64_bf16 v[28:31], v[60:63], v[44:51], v0
ds_read_b128 v[48:51], v2 offset:15360
v_smfmac_f32_16x16x64_bf16 v[32:35], v[76:79], v[248:255], v0
ds_read_b128 v[44:47], v2 offset:14336
v_smfmac_f32_16x16x64_bf16 v[32:35], v[64:67], a[8:15], v0
s_waitcnt lgkmcnt(2)
s_barrier
ds_read_b64_tr_b16 v[20:21], v4 offset:10240
v_smfmac_f32_16x16x64_bf16 v[32:35], v[68:71], a[24:31], v0
ds_read_b64_tr_b16 v[22:23], v4 offset:10752
v_add_f32 v29, v29, v31
v_smfmac_f32_16x16x64_bf16 v[32:35], v[72:75], a[40:47], v0
ds_read_b64_tr_b16 v[24:25], v4 offset:11264
ds_read_b64_tr_b16 v[26:27], v4 offset:11776
s_waitcnt lgkmcnt(4)
v_smfmac_f32_16x16x64_bf16 v[32:35], v[60:63], v[44:51], v0
ds_read_b128 v[48:51], v2 offset:19456
s_waitcnt lgkmcnt(3)
v_mfma_f32_16x16x32_bf16 v[12:15], v[12:15], v[20:23], 0
ds_read_b128 v[44:47], v2 offset:18432
v_add_f32 v28, v28, v30
s_waitcnt lgkmcnt(2)
v_mfma_f32_16x16x32_bf16 v[12:15], v[16:19], v[24:27], v[12:15]
v_add_f32 v32, v32, v34
v_add_f32 v33, v33, v35
v_cvt_pk_bf16_f32 v31, v32, v33
v_cvt_pk_bf16_f32 v30, v28, v29
v_smfmac_f32_16x16x64_bf16 v[36:39], v[76:79], a[112:119], v0
ds_write_b64 v3, v[30:31] offset:12288
v_add_f32_dpp v12, v14, v12 quad_perm:[2,3,0,1] row_mask:0xf bank_mask:0xf
v_exp_f32 v14, v12
v_add_f32_dpp v13, v15, v13 quad_perm:[2,3,0,1] row_mask:0xf bank_mask:0xf
v_exp_f32 v15, v13
s_nop 0
v_cvt_pk_bf16_f32 v14, v14, v15
v_smfmac_f32_16x16x64_bf16 v[40:43], v[76:79], a[120:127], v0
ds_write_b32 v5, v14 offset:14368
s_waitcnt lgkmcnt(2)
v_smfmac_f32_16x16x64_bf16 v[40:43], v[72:75], v[44:51], v0
ds_read_b128 v[44:47], v2 offset:16384
s_waitcnt lgkmcnt(2)
s_barrier
ds_read_b64_tr_b16 v[28:29], v4 offset:12288
v_smfmac_f32_16x16x64_bf16 v[36:39], v[60:63], a[128:135], v0
ds_read_b64_tr_b16 v[30:31], v4 offset:12800
ds_read_b64_tr_b16 v[32:33], v4 offset:13312
v_smfmac_f32_16x16x64_bf16 v[40:43], v[60:63], a[136:143], v0
ds_read_b64_tr_b16 v[34:35], v4 offset:13824
v_mov_b64 v[76:77], s[52:53]
s_waitcnt lgkmcnt(2)
v_mfma_f32_16x16x32_bf16 v[28:31], v[28:31], v[20:23], 0
s_barrier
ds_read_b128 v[16:19], v1 offset:14368
s_waitcnt lgkmcnt(1)
v_mfma_f32_16x16x32_bf16 v[28:31], v[32:35], v[24:27], v[28:31]
ds_read_b128 v[60:63], v1 offset:14336
v_mov_b64 v[14:15], s[0:1]
v_smfmac_f32_16x16x64_bf16 v[40:43], v[64:67], a[152:159], v0
ds_read_b128 v[48:51], v2 offset:17408
v_mov_b64 v[78:79], s[52:53]
v_smfmac_f32_16x16x64_bf16 v[40:43], v[68:71], a[168:175], v0
v_add_f32_dpp v28, v30, v28 quad_perm:[2,3,0,1] row_mask:0xf bank_mask:0xf
v_smfmac_f32_16x16x64_bf16 v[36:39], v[64:67], a[144:151], v0
ds_read_b128 v[64:67], v2 offset:25600
v_add_f32_dpp v29, v31, v29 quad_perm:[2,3,0,1] row_mask:0xf bank_mask:0xf
s_waitcnt lgkmcnt(1)
v_smfmac_f32_16x16x64_bf16 v[36:39], v[72:75], v[44:51], v0
ds_read_b128 v[72:75], v2 offset:29696
v_mul_f32 v28, s50, v28
v_smfmac_f32_16x16x64_bf16 v[36:39], v[68:71], a[160:167], v0
ds_read_b128 v[68:71], v2 offset:28672
v_cvt_pk_bf16_f32 v40, v40, v41
v_mfma_f32_16x16x32_bf16 v[32:35], v[76:79], v[16:19], 0
v_exp_f32 v30, v28
ds_read_b128 v[44:47], v2 offset:20480
v_mfma_f32_16x16x32_bf16 v[20:23], v[52:55], v[16:19], 0
v_mul_f32 v29, s50, v29
v_cvt_pk_bf16_f32 v41, v42, v43
v_cvt_pk_bf16_f32 v43, v38, v39
v_mov_b64 v[76:77], 0
v_exp_f32 v31, v29
v_mfma_f32_16x16x32_bf16 v[20:23], v[56:59], v[60:63], v[20:23]
v_cvt_pk_bf16_f32 v30, v30, v31
v_cndmask_b32_e64 v26, 0, v30, s[56:57]
v_cndmask_b32_e64 v27, 0, v30, s[56:57]
s_nop 0
v_mov_b32_dpp v24, v26 quad_perm:[2,3,0,1] row_mask:0xf bank_mask:0xf
v_mfma_f32_16x16x16_bf16 v[32:35], v[14:15], v[26:27], v[32:35]
v_mov_b32_dpp v25, v26 quad_perm:[2,3,0,1] row_mask:0xf bank_mask:0xf
v_cvt_pk_bf16_f32 v42, v36, v37
s_nop 1
v_mfma_f32_16x16x32_bf16 v[20:23], v[40:43], v[24:27], v[20:23]
ds_read_b128 v[60:63], v2 offset:24576
ds_read_b128 v[48:51], v2 offset:21504
v_mov_b64 v[78:79], 0
v_rcp_f32 v33, v32
v_mov_b64 v[36:37], 0
v_min_f32 v32, v32, v33
v_cmp_nlt_f32 vcc, s2, v32
v_mul_f32_dpp v23, v33, v23 quad_perm:[0,1,0,1] row_mask:0xf bank_mask:0xf
v_mul_f32_dpp v21, v33, v21 quad_perm:[0,1,0,1] row_mask:0xf bank_mask:0xf
v_mul_f32_dpp v22, v33, v22 quad_perm:[0,1,0,1] row_mask:0xf bank_mask:0xf
v_mul_f32_dpp v20, v33, v20 quad_perm:[0,1,0,1] row_mask:0xf bank_mask:0xf
v_cvt_pk_bf16_f32 v20, v20, v21
v_cvt_pk_bf16_f32 v21, v22, v23
ds_write_b64 v6, v[20:21] offset:5120
s_and_b64 vcc, vcc, s[56:57]
s_cbranch_scc1 L_mx_w0s
L_mxb_w0s:
v_mov_b64 v[38:39], 0
v_mov_b32_dpp v19, v21 quad_perm:[2,3,2,3] row_mask:0xf bank_mask:0xf
v_mov_b32_dpp v16, v20 quad_perm:[0,1,0,1] row_mask:0xf bank_mask:0xf
v_mov_b32_dpp v18, v20 quad_perm:[2,3,2,3] row_mask:0xf bank_mask:0xf
v_mov_b32_dpp v17, v21 quad_perm:[0,1,0,1] row_mask:0xf bank_mask:0xf
v_mov_b64 v[24:25], 0
v_mov_b64 v[26:27], 0
v_smfmac_f32_16x16x64_bf16 v[76:79], v[16:19], a[176:183], v0
s_waitcnt lgkmcnt(0)
s_barrier
v_mov_b64 v[32:33], 0
ds_read_b128 v[12:15], v7 offset:7168
ds_read_b128 v[52:55], v7 offset:6144
v_smfmac_f32_16x16x64_bf16 v[36:39], v[16:19], v[44:51], v0
ds_read_b128 v[48:51], v2 offset:23552
ds_read_b128 v[56:59], v7 offset:8192
v_mov_b64 v[30:31], 0
v_mov_b64 v[34:35], 0
v_smfmac_f32_16x16x64_bf16 v[24:27], v[16:19], v[60:67], v0
ds_read_b128 v[44:47], v2 offset:22528
v_smfmac_f32_16x16x64_bf16 v[32:35], v[16:19], v[68:75], v0
ds_read_b128 v[68:71], v2 offset:30720
s_waitcnt lgkmcnt(5)
v_smfmac_f32_16x16x64_bf16 v[76:79], v[12:15], a[184:191], v0
ds_read_b128 v[60:63], v2 offset:26624
s_waitcnt lgkmcnt(5)
v_smfmac_f32_16x16x64_bf16 v[76:79], v[52:55], a[192:199], v0
ds_read_b128 v[64:67], v2 offset:27648
s_waitcnt lgkmcnt(4)
v_smfmac_f32_16x16x64_bf16 v[76:79], v[56:59], a[200:207], v0
v_mov_b64 v[28:29], 0
v_smfmac_f32_16x16x64_bf16 v[36:39], v[12:15], a[208:215], v0
ds_read_b128 v[72:75], v2 offset:31744
s_waitcnt lgkmcnt(4)
v_smfmac_f32_16x16x64_bf16 v[36:39], v[52:55], v[44:51], v0
ds_read_b128 v[44:47], v2 offset:32768
v_cvt_pk_bf16_f32 v77, v77, v79
v_cvt_pk_bf16_f32 v76, v76, v78
v_bfi_b32 v76, 1, s35, v76
v_smfmac_f32_16x16x64_bf16 v[36:39], v[56:59], a[216:223], v0
v_smfmac_f32_16x16x64_bf16 v[24:27], v[12:15], a[224:231], v0
buffer_store_dwordx2 v[76:77], v8, s[4:7], s42 offen sc0 sc1
s_waitcnt lgkmcnt(2)
v_smfmac_f32_16x16x64_bf16 v[24:27], v[52:55], v[60:67], v0
ds_read_b128 v[48:51], v2 offset:33792
ds_read_b128 v[60:63], v2 offset:36864
v_cvt_pk_bf16_f32 v36, v36, v38
v_bfi_b32 v36, 1, s35, v36
v_cvt_pk_bf16_f32 v37, v37, v39
v_smfmac_f32_16x16x64_bf16 v[24:27], v[56:59], a[232:239], v0
buffer_store_dwordx2 v[36:37], v8, s[4:7], s43 offen sc0 sc1
ds_read_b128 v[64:67], v2 offset:37888
v_smfmac_f32_16x16x64_bf16 v[32:35], v[12:15], a[240:247], v0
ds_read_b128 v[40:43], v2 offset:35840
s_waitcnt lgkmcnt(5)
v_smfmac_f32_16x16x64_bf16 v[32:35], v[52:55], v[68:75], v0
ds_read_b128 v[72:75], v2 offset:39936
ds_read_b128 v[36:39], v2 offset:34816
v_cvt_pk_bf16_f32 v25, v25, v27
v_cvt_pk_bf16_f32 v24, v24, v26
v_bfi_b32 v24, 1, s35, v24
buffer_store_dwordx2 v[24:25], v8, s[4:7], s44 offen sc0 sc1
v_smfmac_f32_16x16x64_bf16 v[32:35], v[56:59], a[248:255], v0
ds_read_b128 v[68:71], v2 offset:38912
s_waitcnt lgkmcnt(6)
v_smfmac_f32_16x16x64_bf16 v[28:31], v[16:19], v[44:51], v0
s_nop 3
v_cvt_pk_bf16_f32 v33, v33, v35
v_cvt_pk_bf16_f32 v32, v32, v34
v_bfi_b32 v32, 1, s35, v32
buffer_store_dwordx2 v[32:33], v8, s[4:7], s45 offen sc0 sc1
s_waitcnt lgkmcnt(1)
v_smfmac_f32_16x16x64_bf16 v[28:31], v[52:55], v[36:43], v0
v_smfmac_f32_16x16x64_bf16 v[28:31], v[12:15], v[60:67], v0
s_waitcnt lgkmcnt(0)
v_smfmac_f32_16x16x64_bf16 v[28:31], v[56:59], v[68:75], v0
s_nop 7
v_cvt_pk_bf16_f32 v28, v28, v30
v_bfi_b32 v28, 1, s35, v28
v_cvt_pk_bf16_f32 v29, v29, v31
buffer_store_dwordx2 v[28:29], v8, s[4:7], s46 offen sc0 sc1
s_branch L_ex_w0s
.p2align 6
L_ex_w0rs:
v_and_b32 v6, 0x70, v1
ds_read_b128 v[76:79], v6 offset:256
v_bfe_u32 v11, v1, 4, 2
v_lshrrev_b32_e64 v11, v11, 1
v_mov_b64 v[20:21], 0
v_mov_b64 v[22:23], 0
v_mov_b64 v[24:25], 0
v_mov_b64 v[26:27], 0
v_mov_b64 v[28:29], 0
v_mov_b64 v[30:31], 0
v_mov_b64 v[32:33], 0
v_mov_b64 v[34:35], 0
ds_read_b128 v[44:47], v2 offset:0
ds_read_b128 v[48:51], v2 offset:1024
s_add_u32 s34, s34, 1
s_not_b32 s35, s35
s_not_b32 s36, s36
s_barrier
s_waitcnt vmcnt(0)
s_add_u32 s37, s37, 524288
s_add_u32 s39, s39, 524288
s_mul_i32 s40, s34, 10240
s_add_u32 s40, s40, 8093696
buffer_load_dwordx4 v[60:63], v9, s[4:7], s3 offen offset:0 sc0 sc1
buffer_load_dwordx4 v[64:67], v9, s[4:7], s3 offen offset:1024 sc0 sc1
buffer_load_dwordx4 v[68:71], v9, s[4:7], s3 offen offset:2048 sc0 sc1
buffer_load_dwordx4 v[72:75], v9, s[4:7], s3 offen offset:3072 sc0 sc1
s_waitcnt lgkmcnt(2)
s_waitcnt vmcnt(3)
L_r_w0rs:
v_mfma_f32_16x16x32_bf16 v[36:39], v[60:63], v[76:79], 0
s_waitcnt vmcnt(2)
v_mfma_f32_16x16x32_bf16 v[36:39], v[64:67], v[76:79], v[36:39]
v_bitop3_b32 v40, v60, v64, s36 bitop3:0x7e
s_waitcnt vmcnt(1)
v_mfma_f32_16x16x32_bf16 v[36:39], v[68:71], v[76:79], v[36:39]
s_waitcnt vmcnt(0)
v_mfma_f32_16x16x32_bf16 v[36:39], v[72:75], v[76:79], v[36:39]
v_bitop3_b32 v41, v68, v72, s36 bitop3:0x7e
v_bitop3_b32 v40, v40, v41, 1 bitop3:0xa8
v_cmp_ne_u32 vcc, 0, v40
v_nop
v_nop
v_nop
v_nop
v_nop
v_pk_add_f32 v[36:37], v[36:37], v[38:39]
v_cvt_pk_bf16_f32 v40, v36, v37
v_bfi_b32 v40, v11, s35, v40
s_cbranch_vccnz L_rr_w0rs
buffer_store_dword v40, v10, s[4:7], 0 offen sc0 sc1
s_cmp_eq_u32 s34, 63
v_mov_b32 v11, v40
s_cbranch_scc1 L_done_w0rs
v_mov_b64 v[36:37], 0
v_mov_b64 v[38:39], 0
v_mov_b64 v[40:41], 0
v_mov_b64 v[42:43], 0
v_bfe_u32 v77, v1, 6, 1
v_lshl_add_u32 v77, v77, 3, v1
v_lshlrev_b32 v77, 1, v77
L_top_w0rs:
s_barrier
ds_read_b128 v[60:63], v1 offset:1024
s_mov_b32 m0, 5120
s_nop 0
buffer_load_dwordx4 v1, s[4:7], s48 offen offset:0 sc0 sc1 lds
s_barrier
ds_read_b128 v[64:67], v1 offset:2048
ds_read_b128 v[68:71], v1 offset:3072
ds_read_b128 v[72:75], v1 offset:4096
L_s0_w0rs:
s_waitcnt lgkmcnt(3)
v_smfmac_f32_16x16x64_bf16 v[32:35], v[60:63], v[184:191], v0
v_smfmac_f32_16x16x64_bf16 v[36:39], v[60:63], a[48:55], v0
v_smfmac_f32_16x16x64_bf16 v[20:23], v[60:63], v[44:51], v0
buffer_load_dwordx4 v[12:15], v9, s[4:7], s37 offen offset:0
v_smfmac_f32_16x16x64_bf16 v[40:43], v[60:63], a[56:63], v0
s_waitcnt lgkmcnt(2)
v_smfmac_f32_16x16x64_bf16 v[24:27], v[64:67], v[88:95], v0
v_smfmac_f32_16x16x64_bf16 v[28:31], v[64:67], v[192:199], v0
v_smfmac_f32_16x16x64_bf16 v[20:23], v[64:67], v[80:87], v0
ds_read_b128 v[48:51], v2 offset:3072
ds_read_b128 v[44:47], v2 offset:2048
v_smfmac_f32_16x16x64_bf16 v[32:35], v[64:67], v[200:207], v0
v_bitop3_b32 v6, v60, v64, s35 bitop3:0x7e
s_waitcnt lgkmcnt(2)
v_bitop3_b32 v76, v68, v72, s35 bitop3:0x7e
v_smfmac_f32_16x16x64_bf16 v[28:31], v[60:63], v[176:183], v0
v_bitop3_b32 v6, v6, v76, 1 bitop3:0xa8
v_smfmac_f32_16x16x64_bf16 v[36:39], v[64:67], a[64:71], v0
buffer_load_dwordx4 v[16:19], v9, s[4:7], s37 offen offset:1024
s_waitcnt lgkmcnt(0)
v_smfmac_f32_16x16x64_bf16 v[24:27], v[60:63], v[44:51], v0
ds_read_b128 v[44:47], v2 offset:4096
v_cmp_ne_u32 vcc, 0, v6
v_smfmac_f32_16x16x64_bf16 v[20:23], v[68:71], v[96:103], v0
v_smfmac_f32_16x16x64_bf16 v[40:43], v[64:67], a[72:79], v0
s_cbranch_vccnz L_ra0_w0rs
ds_read_b128 v[48:51], v2 offset:5120
buffer_load_dwordx4 v[52:55], v1, s[4:7], s37 offen offset:2048
v_smfmac_f32_16x16x64_bf16 v[24:27], v[68:71], v[104:111], v0
s_waitcnt vmcnt(3)
s_barrier
ds_read_b32 v6, v77 offset:8192
v_smfmac_f32_16x16x64_bf16 v[28:31], v[68:71], v[208:215], v0
ds_read_b128 v[60:63], v1 offset:6144
buffer_load_dwordx4 v[56:59], v1, s[4:7], s37 offen offset:3072
s_waitcnt lgkmcnt(2)
v_smfmac_f32_16x16x64_bf16 v[20:23], v[72:75], v[44:51], v0
ds_read_b128 v[64:67], v1 offset:7168
ds_read_b128 v[76:79], v1 offset:5120
v_smfmac_f32_16x16x64_bf16 v[32:35], v[68:71], v[216:223], v0
ds_read_b128 v[44:47], v2 offset:6144
v_smfmac_f32_16x16x64_bf16 v[36:39], v[68:71], a[80:87], v0
ds_read_b128 v[48:51], v2 offset:7168
s_mov_b32 m0, 0
v_smfmac_f32_16x16x64_bf16 v[40:43], v[68:71], a[88:95], v0
ds_read_b128 v[68:71], v1 offset:8192
s_waitcnt lgkmcnt(5)
v_bitop3_b32 v6, v6, v60, s35 bitop3:0x7e
v_smfmac_f32_16x16x64_bf16 v[28:31], v[72:75], v[224:231], v0
s_waitcnt lgkmcnt(4)
v_bitop3_b32 v6, v6, v64, s35 bitop3:0xf6
v_smfmac_f32_16x16x64_bf16 v[32:35], v[72:75], v[232:239], v0
s_waitcnt lgkmcnt(3)
v_bitop3_b32 v6, v6, v76, s35 bitop3:0xf6
v_and_b32 v6, 1, v6
s_waitcnt lgkmcnt(1)
v_smfmac_f32_16x16x64_bf16 v[24:27], v[72:75], v[44:51], v0
ds_read_b128 v[44:47], v2 offset:8192
v_cmp_ne_u32 vcc, 0, v6
v_smfmac_f32_16x16x64_bf16 v[36:39], v[72:75], a[96:103], v0
ds_read_b128 v[48:51], v2 offset:9216
v_lshlrev_b32 v6, 3, v1
v_smfmac_f32_16x16x64_bf16 v[40:43], v[72:75], a[104:111], v0
ds_read_b128 v[72:75], v1 offset:9216
s_cbranch_vccnz L_ra1_w0rs
L_a1_w0rs:
buffer_store_dword v11, v10, s[4:7], s40 offen sc0 sc1
v_smfmac_f32_16x16x64_bf16 v[20:23], v[60:63], v[112:119], v0
v_smfmac_f32_16x16x64_bf16 v[20:23], v[64:67], v[128:135], v0
buffer_load_dword v6, s[4:7], s39 offen lds
s_waitcnt lgkmcnt(0)
v_smfmac_f32_16x16x64_bf16 v[20:23], v[72:75], v[160:167], v0
v_bfe_u32 v6, v1, 5, 1
v_smfmac_f32_16x16x64_bf16 v[20:23], v[76:79], v[44:51], v0
v_mad_i32_i24 v6, v6, s55, v1
v_smfmac_f32_16x16x64_bf16 v[20:23], v[68:71], v[144:151], v0
ds_read_b128 v[44:47], v2 offset:10240
v_smfmac_f32_16x16x64_bf16 v[24:27], v[60:63], v[120:127], v0
ds_read_b128 v[48:51], v2 offset:11264
v_smfmac_f32_16x16x64_bf16 v[24:27], v[64:67], v[136:143], v0
v_add_f32 v20, v20, v22
v_smfmac_f32_16x16x64_bf16 v[24:27], v[68:71], v[152:159], v0
v_add_f32 v21, v21, v23
v_cvt_pk_bf16_f32 v22, v20, v21
v_smfmac_f32_16x16x64_bf16 v[24:27], v[72:75], v[168:175], v0
s_waitcnt lgkmcnt(0)
v_smfmac_f32_16x16x64_bf16 v[24:27], v[76:79], v[44:51], v0
ds_read_b128 v[44:47], v2 offset:12288
v_smfmac_f32_16x16x64_bf16 v[28:31], v[76:79], v[240:247], v0
v_smfmac_f32_16x16x64_bf16 v[28:31], v[64:67], a[0:7], v0
ds_read_b128 v[48:51], v2 offset:13312
v_add_f32 v25, v25, v27
v_add_f32 v24, v24, v26
v_cvt_pk_bf16_f32 v23, v24, v25
v_smfmac_f32_16x16x64_bf16 v[28:31], v[68:71], a[16:23], v0
ds_write_b64 v3, v[22:23] offset:10240
v_smfmac_f32_16x16x64_bf16 v[28:31], v[72:75], a[32:39], v0
s_waitcnt vmcnt(2)
s_waitcnt lgkmcnt(1)
v_smfmac_f32_16x16x64_bf16 v[28:31], v[60:63], v[44:51], v0
ds_read_b128 v[48:51], v2 offset:15360
v_smfmac_f32_16x16x64_bf16 v[32:35], v[76:79], v[248:255], v0
ds_read_b128 v[44:47], v2 offset:14336
v_smfmac_f32_16x16x64_bf16 v[32:35], v[64:67], a[8:15], v0
s_waitcnt lgkmcnt(2)
s_barrier
ds_read_b64_tr_b16 v[20:21], v4 offset:10240
v_smfmac_f32_16x16x64_bf16 v[32:35], v[68:71], a[24:31], v0
ds_read_b64_tr_b16 v[22:23], v4 offset:10752
v_add_f32 v29, v29, v31
v_smfmac_f32_16x16x64_bf16 v[32:35], v[72:75], a[40:47], v0
ds_read_b64_tr_b16 v[24:25], v4 offset:11264
ds_read_b64_tr_b16 v[26:27], v4 offset:11776
s_waitcnt lgkmcnt(4)
v_smfmac_f32_16x16x64_bf16 v[32:35], v[60:63], v[44:51], v0
ds_read_b128 v[48:51], v2 offset:19456
s_waitcnt lgkmcnt(3)
v_mfma_f32_16x16x32_bf16 v[12:15], v[12:15], v[20:23], 0
ds_read_b128 v[44:47], v2 offset:18432
v_add_f32 v28, v28, v30
s_waitcnt lgkmcnt(2)
v_mfma_f32_16x16x32_bf16 v[12:15], v[16:19], v[24:27], v[12:15]
v_add_f32 v32, v32, v34
v_add_f32 v33, v33, v35
v_cvt_pk_bf16_f32 v31, v32, v33
v_cvt_pk_bf16_f32 v30, v28, v29
v_smfmac_f32_16x16x64_bf16 v[36:39], v[76:79], a[112:119], v0
ds_write_b64 v3, v[30:31] offset:12288
v_add_f32_dpp v12, v14, v12 quad_perm:[2,3,0,1] row_mask:0xf bank_mask:0xf
v_exp_f32 v14, v12
v_add_f32_dpp v13, v15, v13 quad_perm:[2,3,0,1] row_mask:0xf bank_mask:0xf
v_exp_f32 v15, v13
s_nop 0
v_cvt_pk_bf16_f32 v14, v14, v15
v_smfmac_f32_16x16x64_bf16 v[40:43], v[76:79], a[120:127], v0
ds_write_b32 v5, v14 offset:14368
s_waitcnt lgkmcnt(2)
v_smfmac_f32_16x16x64_bf16 v[40:43], v[72:75], v[44:51], v0
ds_read_b128 v[44:47], v2 offset:16384
s_waitcnt lgkmcnt(2)
s_barrier
ds_read_b64_tr_b16 v[28:29], v4 offset:12288
v_smfmac_f32_16x16x64_bf16 v[36:39], v[60:63], a[128:135], v0
ds_read_b64_tr_b16 v[30:31], v4 offset:12800
ds_read_b64_tr_b16 v[32:33], v4 offset:13312
v_smfmac_f32_16x16x64_bf16 v[40:43], v[60:63], a[136:143], v0
ds_read_b64_tr_b16 v[34:35], v4 offset:13824
v_mov_b64 v[76:77], s[52:53]
s_waitcnt lgkmcnt(2)
v_mfma_f32_16x16x32_bf16 v[28:31], v[28:31], v[20:23], 0
s_barrier
ds_read_b128 v[16:19], v1 offset:14368
s_waitcnt lgkmcnt(1)
v_mfma_f32_16x16x32_bf16 v[28:31], v[32:35], v[24:27], v[28:31]
ds_read_b128 v[60:63], v1 offset:14336
v_mov_b64 v[14:15], s[0:1]
v_smfmac_f32_16x16x64_bf16 v[40:43], v[64:67], a[152:159], v0
ds_read_b128 v[48:51], v2 offset:17408
v_mov_b64 v[78:79], s[52:53]
v_smfmac_f32_16x16x64_bf16 v[40:43], v[68:71], a[168:175], v0
v_add_f32_dpp v28, v30, v28 quad_perm:[2,3,0,1] row_mask:0xf bank_mask:0xf
v_smfmac_f32_16x16x64_bf16 v[36:39], v[64:67], a[144:151], v0
ds_read_b128 v[64:67], v2 offset:25600
v_add_f32_dpp v29, v31, v29 quad_perm:[2,3,0,1] row_mask:0xf bank_mask:0xf
s_waitcnt lgkmcnt(1)
v_smfmac_f32_16x16x64_bf16 v[36:39], v[72:75], v[44:51], v0
ds_read_b128 v[72:75], v2 offset:29696
v_mul_f32 v28, s50, v28
v_smfmac_f32_16x16x64_bf16 v[36:39], v[68:71], a[160:167], v0
ds_read_b128 v[68:71], v2 offset:28672
v_cvt_pk_bf16_f32 v40, v40, v41
v_mfma_f32_16x16x32_bf16 v[32:35], v[76:79], v[16:19], 0
v_exp_f32 v30, v28
ds_read_b128 v[44:47], v2 offset:20480
v_mfma_f32_16x16x32_bf16 v[20:23], v[52:55], v[16:19], 0
v_mul_f32 v29, s50, v29
v_cvt_pk_bf16_f32 v41, v42, v43
v_cvt_pk_bf16_f32 v43, v38, v39
v_mov_b64 v[76:77], 0
v_exp_f32 v31, v29
v_mfma_f32_16x16x32_bf16 v[20:23], v[56:59], v[60:63], v[20:23]
v_cvt_pk_bf16_f32 v30, v30, v31
v_cndmask_b32_e64 v26, 0, v30, s[56:57]
v_cndmask_b32_e64 v27, 0, v30, s[56:57]
s_nop 0
v_mov_b32_dpp v24, v26 quad_perm:[2,3,0,1] row_mask:0xf bank_mask:0xf
v_mfma_f32_16x16x16_bf16 v[32:35], v[14:15], v[26:27], v[32:35]
v_mov_b32_dpp v25, v26 quad_perm:[2,3,0,1] row_mask:0xf bank_mask:0xf
v_cvt_pk_bf16_f32 v42, v36, v37
s_nop 1
v_mfma_f32_16x16x32_bf16 v[20:23], v[40:43], v[24:27], v[20:23]
ds_read_b128 v[60:63], v2 offset:24576
ds_read_b128 v[48:51], v2 offset:21504
v_mov_b64 v[78:79], 0
v_rcp_f32 v33, v32
v_mov_b64 v[36:37], 0
v_min_f32 v32, v32, v33
v_cmp_nlt_f32 vcc, s2, v32
v_mul_f32_dpp v23, v33, v23 quad_perm:[0,1,0,1] row_mask:0xf bank_mask:0xf
v_mul_f32_dpp v21, v33, v21 quad_perm:[0,1,0,1] row_mask:0xf bank_mask:0xf
v_mul_f32_dpp v22, v33, v22 quad_perm:[0,1,0,1] row_mask:0xf bank_mask:0xf
v_mul_f32_dpp v20, v33, v20 quad_perm:[0,1,0,1] row_mask:0xf bank_mask:0xf
v_cvt_pk_bf16_f32 v20, v20, v21
v_cvt_pk_bf16_f32 v21, v22, v23
ds_write_b64 v6, v[20:21] offset:5120
s_and_b64 vcc, vcc, s[56:57]
s_cbranch_scc1 L_mx_w0rs
L_mxb_w0rs:
v_mov_b64 v[38:39], 0
v_mov_b32_dpp v19, v21 quad_perm:[2,3,2,3] row_mask:0xf bank_mask:0xf
v_mov_b32_dpp v16, v20 quad_perm:[0,1,0,1] row_mask:0xf bank_mask:0xf
v_mov_b32_dpp v18, v20 quad_perm:[2,3,2,3] row_mask:0xf bank_mask:0xf
v_mov_b32_dpp v17, v21 quad_perm:[0,1,0,1] row_mask:0xf bank_mask:0xf
v_mov_b64 v[24:25], 0
v_mov_b64 v[26:27], 0
v_smfmac_f32_16x16x64_bf16 v[76:79], v[16:19], a[176:183], v0
s_waitcnt lgkmcnt(0)
s_barrier
v_mov_b64 v[32:33], 0
ds_read_b128 v[12:15], v7 offset:7168
ds_read_b128 v[52:55], v7 offset:6144
v_smfmac_f32_16x16x64_bf16 v[36:39], v[16:19], v[44:51], v0
ds_read_b128 v[48:51], v2 offset:23552
ds_read_b128 v[56:59], v7 offset:8192
v_mov_b64 v[30:31], 0
v_mov_b64 v[34:35], 0
v_smfmac_f32_16x16x64_bf16 v[24:27], v[16:19], v[60:67], v0
ds_read_b128 v[44:47], v2 offset:22528
v_smfmac_f32_16x16x64_bf16 v[32:35], v[16:19], v[68:75], v0
ds_read_b128 v[68:71], v2 offset:30720
s_waitcnt lgkmcnt(5)
v_smfmac_f32_16x16x64_bf16 v[76:79], v[12:15], a[184:191], v0
ds_read_b128 v[60:63], v2 offset:26624
s_waitcnt lgkmcnt(5)
v_smfmac_f32_16x16x64_bf16 v[76:79], v[52:55], a[192:199], v0
ds_read_b128 v[64:67], v2 offset:27648
s_waitcnt lgkmcnt(4)
v_smfmac_f32_16x16x64_bf16 v[76:79], v[56:59], a[200:207], v0
v_mov_b64 v[28:29], 0
v_smfmac_f32_16x16x64_bf16 v[36:39], v[12:15], a[208:215], v0
ds_read_b128 v[72:75], v2 offset:31744
s_waitcnt lgkmcnt(4)
v_smfmac_f32_16x16x64_bf16 v[36:39], v[52:55], v[44:51], v0
ds_read_b128 v[44:47], v2 offset:32768
v_cvt_pk_bf16_f32 v77, v77, v79
v_cvt_pk_bf16_f32 v76, v76, v78
v_bfi_b32 v76, 1, s35, v76
v_smfmac_f32_16x16x64_bf16 v[36:39], v[56:59], a[216:223], v0
v_smfmac_f32_16x16x64_bf16 v[24:27], v[12:15], a[224:231], v0
buffer_store_dwordx2 v[76:77], v8, s[4:7], s42 offen sc0 sc1
s_waitcnt lgkmcnt(2)
v_smfmac_f32_16x16x64_bf16 v[24:27], v[52:55], v[60:67], v0
ds_read_b128 v[48:51], v2 offset:33792
ds_read_b128 v[60:63], v2 offset:36864
v_cvt_pk_bf16_f32 v36, v36, v38
v_bfi_b32 v36, 1, s35, v36
v_cvt_pk_bf16_f32 v37, v37, v39
v_smfmac_f32_16x16x64_bf16 v[24:27], v[56:59], a[232:239], v0
buffer_store_dwordx2 v[36:37], v8, s[4:7], s43 offen sc0 sc1
ds_read_b128 v[64:67], v2 offset:37888
v_smfmac_f32_16x16x64_bf16 v[32:35], v[12:15], a[240:247], v0
ds_read_b128 v[40:43], v2 offset:35840
s_waitcnt lgkmcnt(5)
v_smfmac_f32_16x16x64_bf16 v[32:35], v[52:55], v[68:75], v0
ds_read_b128 v[72:75], v2 offset:39936
ds_read_b128 v[36:39], v2 offset:34816
v_cvt_pk_bf16_f32 v25, v25, v27
v_cvt_pk_bf16_f32 v24, v24, v26
v_bfi_b32 v24, 1, s35, v24
buffer_store_dwordx2 v[24:25], v8, s[4:7], s44 offen sc0 sc1
v_smfmac_f32_16x16x64_bf16 v[32:35], v[56:59], a[248:255], v0
ds_read_b128 v[68:71], v2 offset:38912
s_waitcnt lgkmcnt(6)
v_smfmac_f32_16x16x64_bf16 v[28:31], v[16:19], v[44:51], v0
s_nop 3
v_cvt_pk_bf16_f32 v33, v33, v35
v_cvt_pk_bf16_f32 v32, v32, v34
v_bfi_b32 v32, 1, s35, v32
buffer_store_dwordx2 v[32:33], v8, s[4:7], s45 offen sc0 sc1
s_waitcnt lgkmcnt(1)
v_smfmac_f32_16x16x64_bf16 v[28:31], v[52:55], v[36:43], v0
v_smfmac_f32_16x16x64_bf16 v[28:31], v[12:15], v[60:67], v0
s_waitcnt lgkmcnt(0)
v_smfmac_f32_16x16x64_bf16 v[28:31], v[56:59], v[68:75], v0
s_nop 7
v_cvt_pk_bf16_f32 v28, v28, v30
v_bfi_b32 v28, 1, s35, v28
v_cvt_pk_bf16_f32 v29, v29, v31
buffer_store_dwordx2 v[28:29], v8, s[4:7], s46 offen sc0 sc1
s_branch L_ex_w0rs
.p2align 6
L_ex_w1rs:
v_and_b32 v6, 0x70, v1
ds_read_b128 v[76:79], v6 offset:256
v_bfe_u32 v11, v1, 4, 2
v_lshrrev_b32_e64 v11, v11, 1
v_mov_b64 v[20:21], 0
v_mov_b64 v[22:23], 0
v_mov_b64 v[24:25], 0
v_mov_b64 v[26:27], 0
v_mov_b64 v[28:29], 0
v_mov_b64 v[30:31], 0
v_mov_b64 v[32:33], 0
v_mov_b64 v[34:35], 0
ds_read_b128 v[44:47], v2 offset:0
ds_read_b128 v[48:51], v2 offset:1024
s_add_u32 s34, s34, 1
s_not_b32 s35, s35
s_not_b32 s36, s36
s_add_u32 s37, s37, 524288
s_mul_i32 s40, s34, 10240
s_add_u32 s40, s40, 8093696
s_barrier
s_waitcnt vmcnt(0)
buffer_load_dwordx4 v[60:63], v9, s[4:7], s3 offen offset:0 sc0 sc1
buffer_load_dwordx4 v[64:67], v9, s[4:7], s3 offen offset:1024 sc0 sc1
buffer_load_dwordx4 v[68:71], v9, s[4:7], s3 offen offset:2048 sc0 sc1
buffer_load_dwordx4 v[72:75], v9, s[4:7], s3 offen offset:3072 sc0 sc1
s_waitcnt lgkmcnt(2)
s_waitcnt vmcnt(3)
L_r_w1rs:
v_mfma_f32_16x16x32_bf16 v[36:39], v[60:63], v[76:79], 0
s_waitcnt vmcnt(2)
v_mfma_f32_16x16x32_bf16 v[36:39], v[64:67], v[76:79], v[36:39]
v_bitop3_b32 v40, v60, v64, s36 bitop3:0x7e
s_waitcnt vmcnt(1)
v_mfma_f32_16x16x32_bf16 v[36:39], v[68:71], v[76:79], v[36:39]
s_waitcnt vmcnt(0)
v_mfma_f32_16x16x32_bf16 v[36:39], v[72:75], v[76:79], v[36:39]
v_bitop3_b32 v41, v68, v72, s36 bitop3:0x7e
v_bitop3_b32 v40, v40, v41, 1 bitop3:0xa8
v_cmp_ne_u32 vcc, 0, v40
v_nop
v_nop
v_nop
v_nop
v_nop
v_pk_add_f32 v[36:37], v[36:37], v[38:39]
v_cvt_pk_bf16_f32 v40, v36, v37
v_bfi_b32 v40, v11, s35, v40
s_cbranch_vccnz L_rr_w1rs
buffer_store_dword v40, v10, s[4:7], 0 offen sc0 sc1
s_cmp_eq_u32 s34, 63
v_mov_b32 v11, v40
s_cbranch_scc1 L_done_w1rs
v_mov_b64 v[36:37], 0
v_mov_b64 v[38:39], 0
v_mov_b64 v[40:41], 0
v_mov_b64 v[42:43], 0
v_bfe_u32 v77, v1, 6, 1
v_lshl_add_u32 v77, v77, 3, v1
v_lshlrev_b32 v77, 1, v77
L_top_w1rs:
s_barrier
ds_read_b128 v[60:63], v1 offset:1024
s_mov_b32 m0, 5120
s_nop 0
buffer_load_dwordx4 v1, s[4:7], s48 offen offset:1024 sc0 sc1 lds
s_barrier
ds_read_b128 v[64:67], v1 offset:2048
ds_read_b128 v[68:71], v1 offset:3072
ds_read_b128 v[72:75], v1 offset:4096
L_s0_w1rs:
s_waitcnt lgkmcnt(3)
v_smfmac_f32_16x16x64_bf16 v[20:23], v[60:63], v[44:51], v0
v_smfmac_f32_16x16x64_bf16 v[36:39], v[60:63], a[48:55], v0
v_smfmac_f32_16x16x64_bf16 v[32:35], v[60:63], v[184:191], v0
s_waitcnt lgkmcnt(2)
v_smfmac_f32_16x16x64_bf16 v[24:27], v[64:67], v[88:95], v0
buffer_load_dwordx4 v[12:15], v9, s[4:7], s37 offen offset:0
v_smfmac_f32_16x16x64_bf16 v[28:31], v[64:67], v[192:199], v0
ds_read_b128 v[44:47], v2 offset:2048
ds_read_b128 v[48:51], v2 offset:3072
v_smfmac_f32_16x16x64_bf16 v[20:23], v[64:67], v[80:87], v0
v_smfmac_f32_16x16x64_bf16 v[40:43], v[60:63], a[56:63], v0
v_smfmac_f32_16x16x64_bf16 v[32:35], v[64:67], v[200:207], v0
v_bitop3_b32 v6, v60, v64, s35 bitop3:0x7e
v_smfmac_f32_16x16x64_bf16 v[36:39], v[64:67], a[64:71], v0
s_waitcnt lgkmcnt(2)
v_bitop3_b32 v76, v68, v72, s35 bitop3:0x7e
v_smfmac_f32_16x16x64_bf16 v[28:31], v[60:63], v[176:183], v0
v_bitop3_b32 v6, v6, v76, 1 bitop3:0xa8
s_waitcnt lgkmcnt(0)
v_smfmac_f32_16x16x64_bf16 v[24:27], v[60:63], v[44:51], v0
ds_read_b128 v[44:47], v2 offset:4096
buffer_load_dwordx4 v[16:19], v9, s[4:7], s37 offen offset:1024
v_cmp_ne_u32 vcc, 0, v6
v_smfmac_f32_16x16x64_bf16 v[20:23], v[68:71], v[96:103], v0
v_smfmac_f32_16x16x64_bf16 v[40:43], v[64:67], a[72:79], v0
s_cbranch_vccnz L_ra0_w1rs
ds_read_b128 v[48:51], v2 offset:5120
v_smfmac_f32_16x16x64_bf16 v[24:27], v[68:71], v[104:111], v0
s_waitcnt vmcnt(2)
s_barrier
ds_read_b32 v6, v77 offset:8192
buffer_load_dwordx4 v[52:55], v1, s[4:7], s37 offen offset:2048
v_smfmac_f32_16x16x64_bf16 v[28:31], v[68:71], v[208:215], v0
ds_read_b128 v[60:63], v1 offset:6144
s_waitcnt lgkmcnt(2)
v_smfmac_f32_16x16x64_bf16 v[20:23], v[72:75], v[44:51], v0
buffer_load_dwordx4 v[56:59], v1, s[4:7], s37 offen offset:3072
ds_read_b128 v[64:67], v1 offset:7168
ds_read_b128 v[76:79], v1 offset:5120
v_smfmac_f32_16x16x64_bf16 v[32:35], v[68:71], v[216:223], v0
ds_read_b128 v[44:47], v2 offset:6144
v_smfmac_f32_16x16x64_bf16 v[36:39], v[68:71], a[80:87], v0
ds_read_b128 v[48:51], v2 offset:7168
s_mov_b32 m0, 0
v_smfmac_f32_16x16x64_bf16 v[40:43], v[68:71], a[88:95], v0
ds_read_b128 v[68:71], v1 offset:8192
s_waitcnt lgkmcnt(5)
v_bitop3_b32 v6, v6, v60, s35 bitop3:0x7e
v_smfmac_f32_16x16x64_bf16 v[28:31], v[72:75], v[224:231], v0
s_waitcnt lgkmcnt(4)
v_bitop3_b32 v6, v6, v64, s35 bitop3:0xf6
v_smfmac_f32_16x16x64_bf16 v[32:35], v[72:75], v[232:239], v0
s_waitcnt lgkmcnt(3)
v_bitop3_b32 v6, v6, v76, s35 bitop3:0xf6
v_and_b32 v6, 1, v6
s_waitcnt lgkmcnt(1)
v_smfmac_f32_16x16x64_bf16 v[24:27], v[72:75], v[44:51], v0
ds_read_b128 v[44:47], v2 offset:8192
v_cmp_ne_u32 vcc, 0, v6
v_smfmac_f32_16x16x64_bf16 v[36:39], v[72:75], a[96:103], v0
ds_read_b128 v[48:51], v2 offset:9216
v_lshlrev_b32 v6, 3, v1
v_smfmac_f32_16x16x64_bf16 v[40:43], v[72:75], a[104:111], v0
s_cbranch_vccnz L_ra1_w1rs
L_a1_w1rs:
ds_read_b128 v[72:75], v1 offset:9216
v_smfmac_f32_16x16x64_bf16 v[20:23], v[60:63], v[112:119], v0
buffer_store_dword v11, v10, s[4:7], s40 offen sc0 sc1
v_smfmac_f32_16x16x64_bf16 v[20:23], v[64:67], v[128:135], v0
s_waitcnt lgkmcnt(0)
v_smfmac_f32_16x16x64_bf16 v[20:23], v[72:75], v[160:167], v0
v_bfe_u32 v6, v1, 5, 1
v_smfmac_f32_16x16x64_bf16 v[20:23], v[76:79], v[44:51], v0
v_mad_i32_i24 v6, v6, s55, v1
v_smfmac_f32_16x16x64_bf16 v[20:23], v[68:71], v[144:151], v0
ds_read_b128 v[44:47], v2 offset:10240
v_smfmac_f32_16x16x64_bf16 v[24:27], v[60:63], v[120:127], v0
ds_read_b128 v[48:51], v2 offset:11264
v_smfmac_f32_16x16x64_bf16 v[24:27], v[64:67], v[136:143], v0
v_add_f32 v20, v20, v22
v_smfmac_f32_16x16x64_bf16 v[24:27], v[68:71], v[152:159], v0
v_add_f32 v21, v21, v23
v_smfmac_f32_16x16x64_bf16 v[24:27], v[72:75], v[168:175], v0
v_cvt_pk_bf16_f32 v22, v20, v21
s_waitcnt lgkmcnt(0)
v_smfmac_f32_16x16x64_bf16 v[24:27], v[76:79], v[44:51], v0
ds_read_b128 v[44:47], v2 offset:12288
v_smfmac_f32_16x16x64_bf16 v[28:31], v[76:79], v[240:247], v0
ds_read_b128 v[48:51], v2 offset:13312
v_smfmac_f32_16x16x64_bf16 v[28:31], v[64:67], a[0:7], v0
v_add_f32 v25, v25, v27
v_add_f32 v24, v24, v26
v_cvt_pk_bf16_f32 v23, v24, v25
v_smfmac_f32_16x16x64_bf16 v[28:31], v[68:71], a[16:23], v0
ds_write_b64 v3, v[22:23] offset:10752
v_smfmac_f32_16x16x64_bf16 v[28:31], v[72:75], a[32:39], v0
s_waitcnt vmcnt(1)
v_smfmac_f32_16x16x64_bf16 v[32:35], v[76:79], v[248:255], v0
s_waitcnt lgkmcnt(1)
v_smfmac_f32_16x16x64_bf16 v[28:31], v[60:63], v[44:51], v0
ds_read_b128 v[48:51], v2 offset:15360
ds_read_b128 v[44:47], v2 offset:14336
v_smfmac_f32_16x16x64_bf16 v[32:35], v[64:67], a[8:15], v0
s_waitcnt lgkmcnt(2)
s_barrier
v_smfmac_f32_16x16x64_bf16 v[32:35], v[68:71], a[24:31], v0
ds_read_b64_tr_b16 v[20:21], v4 offset:10240
ds_read_b64_tr_b16 v[22:23], v4 offset:10752
v_add_f32 v29, v29, v31
v_smfmac_f32_16x16x64_bf16 v[32:35], v[72:75], a[40:47], v0
ds_read_b64_tr_b16 v[24:25], v4 offset:11264
ds_read_b64_tr_b16 v[26:27], v4 offset:11776
s_waitcnt lgkmcnt(4)
v_smfmac_f32_16x16x64_bf16 v[32:35], v[60:63], v[44:51], v0
ds_read_b128 v[48:51], v2 offset:19456
s_waitcnt lgkmcnt(3)
v_mfma_f32_16x16x32_bf16 v[12:15], v[12:15], v[20:23], 0
ds_read_b128 v[44:47], v2 offset:18432
v_add_f32 v28, v28, v30
s_waitcnt lgkmcnt(2)
v_mfma_f32_16x16x32_bf16 v[12:15], v[16:19], v[24:27], v[12:15]
v_add_f32 v32, v32, v34
v_add_f32 v33, v33, v35
v_cvt_pk_bf16_f32 v30, v28, v29
v_cvt_pk_bf16_f32 v31, v32, v33
v_smfmac_f32_16x16x64_bf16 v[36:39], v[76:79], a[112:119], v0
ds_write_b64 v3, v[30:31] offset:12800
v_add_f32_dpp v12, v14, v12 quad_perm:[2,3,0,1] row_mask:0xf bank_mask:0xf
v_exp_f32 v14, v12
v_add_f32_dpp v13, v15, v13 quad_perm:[2,3,0,1] row_mask:0xf bank_mask:0xf
v_exp_f32 v15, v13
s_nop 0
v_cvt_pk_bf16_f32 v14, v14, v15
v_smfmac_f32_16x16x64_bf16 v[40:43], v[76:79], a[120:127], v0
ds_write_b32 v5, v14 offset:14624
s_waitcnt lgkmcnt(1)
s_barrier
ds_read_b64_tr_b16 v[28:29], v4 offset:12288
v_smfmac_f32_16x16x64_bf16 v[36:39], v[60:63], a[128:135], v0
ds_read_b64_tr_b16 v[30:31], v4 offset:12800
ds_read_b64_tr_b16 v[32:33], v4 offset:13312
v_smfmac_f32_16x16x64_bf16 v[40:43], v[60:63], a[136:143], v0
ds_read_b64_tr_b16 v[34:35], v4 offset:13824
v_mov_b64 v[76:77], s[52:53]
v_smfmac_f32_16x16x64_bf16 v[40:43], v[72:75], v[44:51], v0
ds_read_b128 v[44:47], v2 offset:16384
s_waitcnt lgkmcnt(3)
v_mfma_f32_16x16x32_bf16 v[28:31], v[28:31], v[20:23], 0
s_barrier
ds_read_b128 v[16:19], v1 offset:14368
s_waitcnt lgkmcnt(2)
v_mfma_f32_16x16x32_bf16 v[28:31], v[32:35], v[24:27], v[28:31]
ds_read_b128 v[60:63], v1 offset:14336
v_mov_b64 v[14:15], s[0:1]
v_smfmac_f32_16x16x64_bf16 v[40:43], v[64:67], a[152:159], v0
ds_read_b128 v[48:51], v2 offset:17408
v_mov_b64 v[78:79], s[52:53]
v_smfmac_f32_16x16x64_bf16 v[40:43], v[68:71], a[168:175], v0
v_add_f32_dpp v28, v30, v28 quad_perm:[2,3,0,1] row_mask:0xf bank_mask:0xf
v_smfmac_f32_16x16x64_bf16 v[36:39], v[64:67], a[144:151], v0
ds_read_b128 v[64:67], v2 offset:27648
v_mul_f32 v28, s50, v28
v_add_f32_dpp v29, v31, v29 quad_perm:[2,3,0,1] row_mask:0xf bank_mask:0xf
v_smfmac_f32_16x16x64_bf16 v[36:39], v[68:71], a[160:167], v0
ds_read_b128 v[68:71], v2 offset:30720
s_waitcnt lgkmcnt(2)
v_smfmac_f32_16x16x64_bf16 v[36:39], v[72:75], v[44:51], v0
ds_read_b128 v[72:75], v2 offset:31744
v_mul_f32 v29, s50, v29
v_cvt_pk_bf16_f32 v40, v40, v41
v_mfma_f32_16x16x32_bf16 v[32:35], v[76:79], v[16:19], 0
v_exp_f32 v30, v28
ds_read_b128 v[44:47], v2 offset:22528
v_mfma_f32_16x16x32_bf16 v[20:23], v[52:55], v[16:19], 0
v_exp_f32 v31, v29
v_mov_b64 v[76:77], 0
v_mfma_f32_16x16x32_bf16 v[20:23], v[56:59], v[60:63], v[20:23]
v_cvt_pk_bf16_f32 v41, v42, v43
v_cvt_pk_bf16_f32 v43, v38, v39
v_cvt_pk_bf16_f32 v30, v30, v31
v_cndmask_b32_e64 v26, 0, v30, s[56:57]
v_cndmask_b32_e64 v27, 0, v30, s[56:57]
s_nop 0
v_mov_b32_dpp v24, v26 quad_perm:[2,3,0,1] row_mask:0xf bank_mask:0xf
v_mfma_f32_16x16x16_bf16 v[32:35], v[14:15], v[26:27], v[32:35]
v_cvt_pk_bf16_f32 v42, v36, v37
v_mov_b32_dpp v25, v26 quad_perm:[2,3,0,1] row_mask:0xf bank_mask:0xf
s_nop 1
v_mfma_f32_16x16x32_bf16 v[20:23], v[40:43], v[24:27], v[20:23]
ds_read_b128 v[48:51], v2 offset:23552
ds_read_b128 v[60:63], v2 offset:26624
v_mov_b64 v[78:79], 0
v_rcp_f32 v33, v32
v_mov_b64 v[36:37], 0
v_min_f32 v32, v32, v33
v_cmp_nlt_f32 vcc, s2, v32
v_mul_f32_dpp v23, v33, v23 quad_perm:[0,1,0,1] row_mask:0xf bank_mask:0xf
v_mul_f32_dpp v21, v33, v21 quad_perm:[0,1,0,1] row_mask:0xf bank_mask:0xf
v_mul_f32_dpp v22, v33, v22 quad_perm:[0,1,0,1] row_mask:0xf bank_mask:0xf
v_mul_f32_dpp v20, v33, v20 quad_perm:[0,1,0,1] row_mask:0xf bank_mask:0xf
v_cvt_pk_bf16_f32 v20, v20, v21
v_cvt_pk_bf16_f32 v21, v22, v23
ds_write_b64 v6, v[20:21] offset:6144
s_and_b64 vcc, vcc, s[56:57]
v_mov_b32_dpp v19, v21 quad_perm:[2,3,2,3] row_mask:0xf bank_mask:0xf
s_cbranch_scc1 L_mx_w1rs
L_mxb_w1rs:
v_mov_b32_dpp v16, v20 quad_perm:[0,1,0,1] row_mask:0xf bank_mask:0xf
v_mov_b32_dpp v17, v21 quad_perm:[0,1,0,1] row_mask:0xf bank_mask:0xf
v_mov_b64 v[38:39], 0
v_mov_b32_dpp v18, v20 quad_perm:[2,3,2,3] row_mask:0xf bank_mask:0xf
v_mov_b64 v[26:27], 0
v_mov_b64 v[24:25], 0
v_smfmac_f32_16x16x64_bf16 v[76:79], v[16:19], a[176:183], v0
s_waitcnt lgkmcnt(0)
s_barrier
ds_read_b128 v[12:15], v7 offset:8192
v_mov_b64 v[32:33], 0
ds_read_b128 v[52:55], v7 offset:5120
v_smfmac_f32_16x16x64_bf16 v[36:39], v[16:19], v[44:51], v0
ds_read_b128 v[48:51], v2 offset:21504
ds_read_b128 v[44:47], v2 offset:20480
ds_read_b128 v[56:59], v7 offset:7168
v_mov_b64 v[30:31], 0
v_mov_b64 v[34:35], 0
v_smfmac_f32_16x16x64_bf16 v[24:27], v[16:19], v[60:67], v0
v_smfmac_f32_16x16x64_bf16 v[32:35], v[16:19], v[68:75], v0
ds_read_b128 v[68:71], v2 offset:28672
s_waitcnt lgkmcnt(5)
v_smfmac_f32_16x16x64_bf16 v[76:79], v[12:15], a[184:191], v0
ds_read_b128 v[60:63], v2 offset:24576
s_waitcnt lgkmcnt(5)
v_smfmac_f32_16x16x64_bf16 v[76:79], v[52:55], a[192:199], v0
ds_read_b128 v[64:67], v2 offset:25600
s_waitcnt lgkmcnt(3)
v_smfmac_f32_16x16x64_bf16 v[76:79], v[56:59], a[200:207], v0
v_mov_b64 v[28:29], 0
v_smfmac_f32_16x16x64_bf16 v[36:39], v[12:15], a[208:215], v0
ds_read_b128 v[72:75], v2 offset:29696
v_smfmac_f32_16x16x64_bf16 v[36:39], v[52:55], v[44:51], v0
ds_read_b128 v[44:47], v2 offset:34816
v_cvt_pk_bf16_f32 v77, v77, v79
v_cvt_pk_bf16_f32 v76, v76, v78
v_bfi_b32 v76, 1, s35, v76
v_smfmac_f32_16x16x64_bf16 v[36:39], v[56:59], a[216:223], v0
buffer_store_dwordx2 v[76:77], v8, s[4:7], s42 offen sc0 sc1
ds_read_b128 v[48:51], v2 offset:35840
v_smfmac_f32_16x16x64_bf16 v[24:27], v[12:15], a[224:231], v0
s_waitcnt lgkmcnt(3)
v_smfmac_f32_16x16x64_bf16 v[24:27], v[52:55], v[60:67], v0
ds_read_b128 v[60:63], v2 offset:38912
v_cvt_pk_bf16_f32 v37, v37, v39
v_cvt_pk_bf16_f32 v36, v36, v38
v_bfi_b32 v36, 1, s35, v36
v_smfmac_f32_16x16x64_bf16 v[24:27], v[56:59], a[232:239], v0
buffer_store_dwordx2 v[36:37], v8, s[4:7], s43 offen sc0 sc1
ds_read_b128 v[64:67], v2 offset:39936
ds_read_b128 v[40:43], v2 offset:33792
v_smfmac_f32_16x16x64_bf16 v[32:35], v[12:15], a[240:247], v0
s_waitcnt lgkmcnt(5)
v_smfmac_f32_16x16x64_bf16 v[32:35], v[52:55], v[68:75], v0
ds_read_b128 v[72:75], v2 offset:37888
ds_read_b128 v[36:39], v2 offset:32768
v_cvt_pk_bf16_f32 v25, v25, v27
v_cvt_pk_bf16_f32 v24, v24, v26
v_bfi_b32 v24, 1, s35, v24
buffer_store_dwordx2 v[24:25], v8, s[4:7], s44 offen sc0 sc1
v_smfmac_f32_16x16x64_bf16 v[32:35], v[56:59], a[248:255], v0
ds_read_b128 v[68:71], v2 offset:36864
s_waitcnt lgkmcnt(6)
v_smfmac_f32_16x16x64_bf16 v[28:31], v[16:19], v[44:51], v0
s_nop 3
v_cvt_pk_bf16_f32 v33, v33, v35
v_cvt_pk_bf16_f32 v32, v32, v34
v_bfi_b32 v32, 1, s35, v32
buffer_store_dwordx2 v[32:33], v8, s[4:7], s45 offen sc0 sc1
s_waitcnt lgkmcnt(1)
v_smfmac_f32_16x16x64_bf16 v[28:31], v[52:55], v[36:43], v0
v_smfmac_f32_16x16x64_bf16 v[28:31], v[12:15], v[60:67], v0
s_waitcnt lgkmcnt(0)
v_smfmac_f32_16x16x64_bf16 v[28:31], v[56:59], v[68:75], v0
s_nop 7
v_cvt_pk_bf16_f32 v28, v28, v30
v_bfi_b32 v28, 1, s35, v28
v_cvt_pk_bf16_f32 v29, v29, v31
buffer_store_dwordx2 v[28:29], v8, s[4:7], s46 offen sc0 sc1
s_branch L_ex_w1rs
.p2align 6
L_ex_w2rs:
s_add_u32 s34, s34, 1
s_not_b32 s35, s35
s_not_b32 s36, s36
v_and_b32 v6, 0x70, v1
ds_read_b128 v[76:79], v6 offset:256
v_bfe_u32 v11, v1, 4, 2
v_lshrrev_b32_e64 v11, v11, 1
v_bfe_u32 v6, v1, 2, 7
s_mov_b32 m0, 1024
v_mov_b32 v42, s35
s_waitcnt vmcnt(1)
buffer_load_dwordx4 v[60:63], v9, s[4:7], s3 offen offset:0 sc0 sc1
buffer_load_dwordx4 v[64:67], v9, s[4:7], s3 offen offset:1024 sc0 sc1
buffer_load_dwordx4 v[68:71], v9, s[4:7], s3 offen offset:2048 sc0 sc1
buffer_load_dwordx4 v[72:75], v9, s[4:7], s3 offen offset:3072 sc0 sc1
s_barrier
s_waitcnt lgkmcnt(0)
s_waitcnt vmcnt(3)
L_r_w2rs:
v_mfma_f32_16x16x32_bf16 v[36:39], v[60:63], v[76:79], 0
s_waitcnt vmcnt(2)
v_mfma_f32_16x16x32_bf16 v[36:39], v[64:67], v[76:79], v[36:39]
v_bitop3_b32 v40, v60, v64, s36 bitop3:0x7e
s_waitcnt vmcnt(1)
v_mfma_f32_16x16x32_bf16 v[36:39], v[68:71], v[76:79], v[36:39]
s_waitcnt vmcnt(0)
v_mfma_f32_16x16x32_bf16 v[36:39], v[72:75], v[76:79], v[36:39]
v_bitop3_b32 v41, v68, v72, s36 bitop3:0x7e
v_bitop3_b32 v40, v40, v41, 1 bitop3:0xa8
v_cmp_ne_u32 vcc, 0, v40
v_nop
v_nop
v_nop
v_nop
v_nop
v_pk_add_f32 v[36:37], v[36:37], v[38:39]
v_cvt_pk_bf16_f32 v40, v36, v37
v_bfi_b32 v40, v11, s35, v40
s_cbranch_vccnz L_rr_w2rs
buffer_store_dword v40, v10, s[4:7], 0 offen sc0 sc1
s_cmp_eq_u32 s34, 63
v_mov_b32 v11, v40
s_cbranch_scc1 L_done_w2rs
s_mov_b64 exec, 1
buffer_store_dword v42, v1, s[4:7], s33 offen sc0 sc1
s_mov_b64 exec, -1
v_mov_b64 v[20:21], 0
v_mov_b64 v[22:23], 0
v_mov_b64 v[24:25], 0
v_mov_b64 v[26:27], 0
v_mov_b64 v[28:29], 0
v_mov_b64 v[30:31], 0
v_mov_b64 v[32:33], 0
v_mov_b64 v[34:35], 0
v_mov_b64 v[36:37], 0
v_mov_b64 v[38:39], 0
v_mov_b64 v[40:41], 0
v_mov_b64 v[42:43], 0
v_bfe_u32 v77, v1, 6, 1
v_lshl_add_u32 v77, v77, 3, v1
v_lshlrev_b32 v77, 1, v77
ds_read_b128 v[44:47], v2 offset:0
ds_read_b128 v[48:51], v2 offset:1024
s_add_u32 s37, s37, 524288
s_mul_i32 s40, s34, 10240
s_add_u32 s40, s40, 8093696
v_mov_b32 v79, s36
L_sp_w2rs:
buffer_load_dword v79, v6, s[4:7], s58 offen sc0 sc1
s_sub_u32 s41, s41, 1
s_cbranch_scc1 L_exit
buffer_load_dwordx4 v1, s[4:7], s47 offen offset:0 sc0 sc1 lds
buffer_load_dwordx4 v1, s[4:7], s47 offen offset:1024 sc0 sc1 lds
buffer_load_dwordx4 v1, s[4:7], s47 offen offset:2048 sc0 sc1 lds
buffer_load_dwordx4 v1, s[4:7], s47 offen offset:3072 sc0 sc1 lds
s_waitcnt vmcnt(4)
v_cmp_ne_u32 vcc, s35, v79
s_cbranch_vccnz L_sp_w2rs
L_top_w2rs:
s_waitcnt vmcnt(3)
s_barrier
ds_read_b128 v[60:63], v1 offset:1024
s_mov_b32 m0, 5120
s_nop 0
buffer_load_dwordx4 v1, s[4:7], s48 offen offset:2048 sc0 sc1 lds
s_waitcnt vmcnt(1)
s_barrier
ds_read_b128 v[64:67], v1 offset:2048
ds_read_b128 v[68:71], v1 offset:3072
ds_read_b128 v[72:75], v1 offset:4096
L_s0_w2rs:
s_waitcnt lgkmcnt(3)
v_smfmac_f32_16x16x64_bf16 v[32:35], v[60:63], v[184:191], v0
v_smfmac_f32_16x16x64_bf16 v[20:23], v[60:63], v[44:51], v0
v_smfmac_f32_16x16x64_bf16 v[36:39], v[60:63], a[48:55], v0
s_waitcnt lgkmcnt(2)
v_smfmac_f32_16x16x64_bf16 v[24:27], v[64:67], v[88:95], v0
v_smfmac_f32_16x16x64_bf16 v[40:43], v[60:63], a[56:63], v0
ds_read_b128 v[48:51], v2 offset:3072
ds_read_b128 v[44:47], v2 offset:2048
v_smfmac_f32_16x16x64_bf16 v[28:31], v[64:67], v[192:199], v0
v_smfmac_f32_16x16x64_bf16 v[20:23], v[64:67], v[80:87], v0
v_smfmac_f32_16x16x64_bf16 v[32:35], v[64:67], v[200:207], v0
buffer_load_dwordx4 v[12:15], v9, s[4:7], s37 offen offset:0
v_bitop3_b32 v6, v60, v64, s35 bitop3:0x7e
v_smfmac_f32_16x16x64_bf16 v[36:39], v[64:67], a[64:71], v0
s_waitcnt lgkmcnt(2)
v_bitop3_b32 v76, v68, v72, s35 bitop3:0x7e
v_smfmac_f32_16x16x64_bf16 v[28:31], v[60:63], v[176:183], v0
v_bitop3_b32 v6, v6, v76, 1 bitop3:0xa8
s_waitcnt lgkmcnt(0)
v_smfmac_f32_16x16x64_bf16 v[24:27], v[60:63], v[44:51], v0
ds_read_b128 v[44:47], v2 offset:4096
v_cmp_ne_u32 vcc, 0, v6
v_smfmac_f32_16x16x64_bf16 v[20:23], v[68:71], v[96:103], v0
v_smfmac_f32_16x16x64_bf16 v[40:43], v[64:67], a[72:79], v0
buffer_load_dwordx4 v[16:19], v9, s[4:7], s37 offen offset:1024
s_cbranch_vccnz L_ra0_w2rs
ds_read_b128 v[48:51], v2 offset:5120
v_smfmac_f32_16x16x64_bf16 v[24:27], v[68:71], v[104:111], v0
s_waitcnt vmcnt(2)
s_barrier
ds_read_b32 v6, v77 offset:8192
v_smfmac_f32_16x16x64_bf16 v[28:31], v[68:71], v[208:215], v0
ds_read_b128 v[60:63], v1 offset:6144
ds_read_b128 v[64:67], v1 offset:7168
buffer_load_dwordx4 v[52:55], v1, s[4:7], s37 offen offset:2048
s_waitcnt lgkmcnt(3)
v_smfmac_f32_16x16x64_bf16 v[20:23], v[72:75], v[44:51], v0
ds_read_b128 v[44:47], v2 offset:6144
v_smfmac_f32_16x16x64_bf16 v[32:35], v[68:71], v[216:223], v0
ds_read_b128 v[76:79], v1 offset:5120
buffer_load_dwordx4 v[56:59], v1, s[4:7], s37 offen offset:3072
v_smfmac_f32_16x16x64_bf16 v[36:39], v[68:71], a[80:87], v0
ds_read_b128 v[48:51], v2 offset:7168
s_mov_b32 m0, 0
v_smfmac_f32_16x16x64_bf16 v[40:43], v[68:71], a[88:95], v0
ds_read_b128 v[68:71], v1 offset:8192
s_waitcnt lgkmcnt(5)
v_bitop3_b32 v6, v6, v60, s35 bitop3:0x7e
v_smfmac_f32_16x16x64_bf16 v[28:31], v[72:75], v[224:231], v0
s_waitcnt lgkmcnt(4)
v_bitop3_b32 v6, v6, v64, s35 bitop3:0xf6
v_smfmac_f32_16x16x64_bf16 v[32:35], v[72:75], v[232:239], v0
s_waitcnt lgkmcnt(2)
v_bitop3_b32 v6, v6, v76, s35 bitop3:0xf6
v_and_b32 v6, 1, v6
s_waitcnt lgkmcnt(1)
v_smfmac_f32_16x16x64_bf16 v[24:27], v[72:75], v[44:51], v0
ds_read_b128 v[44:47], v2 offset:8192
v_cmp_ne_u32 vcc, 0, v6
v_smfmac_f32_16x16x64_bf16 v[36:39], v[72:75], a[96:103], v0
ds_read_b128 v[48:51], v2 offset:9216
v_lshlrev_b32 v6, 3, v1
v_smfmac_f32_16x16x64_bf16 v[40:43], v[72:75], a[104:111], v0
s_cbranch_vccnz L_ra1_w2rs
L_a1_w2rs:
ds_read_b128 v[72:75], v1 offset:9216
v_smfmac_f32_16x16x64_bf16 v[20:23], v[60:63], v[112:119], v0
buffer_store_dword v11, v10, s[4:7], s40 offen sc0 sc1
v_smfmac_f32_16x16x64_bf16 v[20:23], v[64:67], v[128:135], v0
s_waitcnt lgkmcnt(0)
v_smfmac_f32_16x16x64_bf16 v[20:23], v[72:75], v[160:167], v0
v_bfe_u32 v6, v1, 5, 1
v_smfmac_f32_16x16x64_bf16 v[20:23], v[76:79], v[44:51], v0
v_mad_i32_i24 v6, v6, s55, v1
v_smfmac_f32_16x16x64_bf16 v[20:23], v[68:71], v[144:151], v0
ds_read_b128 v[44:47], v2 offset:10240
v_smfmac_f32_16x16x64_bf16 v[24:27], v[60:63], v[120:127], v0
ds_read_b128 v[48:51], v2 offset:11264
v_smfmac_f32_16x16x64_bf16 v[24:27], v[64:67], v[136:143], v0
v_add_f32 v20, v20, v22
v_smfmac_f32_16x16x64_bf16 v[24:27], v[68:71], v[152:159], v0
v_add_f32 v21, v21, v23
v_cvt_pk_bf16_f32 v22, v20, v21
v_smfmac_f32_16x16x64_bf16 v[24:27], v[72:75], v[168:175], v0
s_waitcnt lgkmcnt(0)
v_smfmac_f32_16x16x64_bf16 v[24:27], v[76:79], v[44:51], v0
ds_read_b128 v[44:47], v2 offset:12288
v_smfmac_f32_16x16x64_bf16 v[28:31], v[76:79], v[240:247], v0
ds_read_b128 v[48:51], v2 offset:13312
v_smfmac_f32_16x16x64_bf16 v[28:31], v[64:67], a[0:7], v0
v_add_f32 v25, v25, v27
v_add_f32 v24, v24, v26
v_cvt_pk_bf16_f32 v23, v24, v25
v_smfmac_f32_16x16x64_bf16 v[28:31], v[68:71], a[16:23], v0
ds_write_b64 v3, v[22:23] offset:11264
v_smfmac_f32_16x16x64_bf16 v[32:35], v[76:79], v[248:255], v0
v_smfmac_f32_16x16x64_bf16 v[28:31], v[72:75], a[32:39], v0
s_waitcnt vmcnt(1)
s_waitcnt lgkmcnt(1)
v_smfmac_f32_16x16x64_bf16 v[28:31], v[60:63], v[44:51], v0
ds_read_b128 v[48:51], v2 offset:15360
ds_read_b128 v[44:47], v2 offset:14336
v_smfmac_f32_16x16x64_bf16 v[32:35], v[64:67], a[8:15], v0
s_waitcnt lgkmcnt(2)
s_barrier
ds_read_b64_tr_b16 v[20:21], v4 offset:10240
v_smfmac_f32_16x16x64_bf16 v[32:35], v[68:71], a[24:31], v0
ds_read_b64_tr_b16 v[22:23], v4 offset:10752
v_add_f32 v29, v29, v31
v_smfmac_f32_16x16x64_bf16 v[32:35], v[72:75], a[40:47], v0
ds_read_b64_tr_b16 v[24:25], v4 offset:11264
ds_read_b64_tr_b16 v[26:27], v4 offset:11776
s_waitcnt lgkmcnt(4)
v_smfmac_f32_16x16x64_bf16 v[32:35], v[60:63], v[44:51], v0
ds_read_b128 v[48:51], v2 offset:19456
s_waitcnt lgkmcnt(3)
v_mfma_f32_16x16x32_bf16 v[12:15], v[12:15], v[20:23], 0
ds_read_b128 v[44:47], v2 offset:18432
v_add_f32 v28, v28, v30
s_waitcnt lgkmcnt(2)
v_mfma_f32_16x16x32_bf16 v[12:15], v[16:19], v[24:27], v[12:15]
v_add_f32 v33, v33, v35
v_add_f32 v32, v32, v34
v_cvt_pk_bf16_f32 v30, v28, v29
v_cvt_pk_bf16_f32 v31, v32, v33
v_smfmac_f32_16x16x64_bf16 v[36:39], v[76:79], a[112:119], v0
ds_write_b64 v3, v[30:31] offset:13312
v_add_f32_dpp v12, v14, v12 quad_perm:[2,3,0,1] row_mask:0xf bank_mask:0xf
v_exp_f32 v14, v12
v_add_f32_dpp v13, v15, v13 quad_perm:[2,3,0,1] row_mask:0xf bank_mask:0xf
v_exp_f32 v15, v13
s_nop 0
v_cvt_pk_bf16_f32 v14, v14, v15
v_smfmac_f32_16x16x64_bf16 v[40:43], v[76:79], a[120:127], v0
ds_write_b32 v5, v14 offset:14880
s_waitcnt lgkmcnt(2)
v_smfmac_f32_16x16x64_bf16 v[40:43], v[72:75], v[44:51], v0
ds_read_b128 v[44:47], v2 offset:16384
s_waitcnt lgkmcnt(2)
s_barrier
ds_read_b64_tr_b16 v[28:29], v4 offset:12288
v_smfmac_f32_16x16x64_bf16 v[36:39], v[60:63], a[128:135], v0
ds_read_b64_tr_b16 v[30:31], v4 offset:12800
ds_read_b64_tr_b16 v[32:33], v4 offset:13312
v_smfmac_f32_16x16x64_bf16 v[40:43], v[60:63], a[136:143], v0
ds_read_b64_tr_b16 v[34:35], v4 offset:13824
v_mov_b64 v[76:77], s[52:53]
s_waitcnt lgkmcnt(2)
v_mfma_f32_16x16x32_bf16 v[28:31], v[28:31], v[20:23], 0
s_barrier
ds_read_b128 v[16:19], v1 offset:14368
s_waitcnt lgkmcnt(1)
v_mfma_f32_16x16x32_bf16 v[28:31], v[32:35], v[24:27], v[28:31]
ds_read_b128 v[60:63], v1 offset:14336
v_mov_b64 v[14:15], s[0:1]
v_smfmac_f32_16x16x64_bf16 v[40:43], v[64:67], a[152:159], v0
ds_read_b128 v[48:51], v2 offset:17408
v_mov_b64 v[78:79], s[52:53]
v_smfmac_f32_16x16x64_bf16 v[40:43], v[68:71], a[168:175], v0
v_add_f32_dpp v28, v30, v28 quad_perm:[2,3,0,1] row_mask:0xf bank_mask:0xf
v_mul_f32 v28, s50, v28
v_smfmac_f32_16x16x64_bf16 v[36:39], v[64:67], a[144:151], v0
ds_read_b128 v[64:67], v2 offset:23552
v_add_f32_dpp v29, v31, v29 quad_perm:[2,3,0,1] row_mask:0xf bank_mask:0xf
v_smfmac_f32_16x16x64_bf16 v[36:39], v[68:71], a[160:167], v0
ds_read_b128 v[68:71], v2 offset:24576
s_waitcnt lgkmcnt(2)
v_smfmac_f32_16x16x64_bf16 v[36:39], v[72:75], v[44:51], v0
ds_read_b128 v[72:75], v2 offset:25600
v_cvt_pk_bf16_f32 v40, v40, v41
v_mfma_f32_16x16x32_bf16 v[32:35], v[76:79], v[16:19], 0
ds_read_b128 v[44:47], v2 offset:20480
v_mul_f32 v29, s50, v29
v_exp_f32 v30, v28
v_mfma_f32_16x16x32_bf16 v[20:23], v[52:55], v[16:19], 0
v_exp_f32 v31, v29
v_cvt_pk_bf16_f32 v41, v42, v43
v_cvt_pk_bf16_f32 v43, v38, v39
v_mov_b64 v[76:77], 0
v_mfma_f32_16x16x32_bf16 v[20:23], v[56:59], v[60:63], v[20:23]
v_cvt_pk_bf16_f32 v30, v30, v31
v_cndmask_b32_e64 v26, 0, v30, s[56:57]
v_cndmask_b32_e64 v27, 0, v30, s[56:57]
s_nop 0
v_mov_b32_dpp v24, v26 quad_perm:[2,3,0,1] row_mask:0xf bank_mask:0xf
v_mfma_f32_16x16x16_bf16 v[32:35], v[14:15], v[26:27], v[32:35]
v_cvt_pk_bf16_f32 v42, v36, v37
v_mov_b32_dpp v25, v26 quad_perm:[2,3,0,1] row_mask:0xf bank_mask:0xf
s_nop 1
v_mfma_f32_16x16x32_bf16 v[20:23], v[40:43], v[24:27], v[20:23]
ds_read_b128 v[60:63], v2 offset:22528
ds_read_b128 v[48:51], v2 offset:21504
v_rcp_f32 v33, v32
v_mov_b64 v[36:37], 0
v_mov_b64 v[78:79], 0
v_min_f32 v32, v32, v33
v_cmp_nlt_f32 vcc, s2, v32
v_mul_f32_dpp v23, v33, v23 quad_perm:[0,1,0,1] row_mask:0xf bank_mask:0xf
v_mul_f32_dpp v21, v33, v21 quad_perm:[0,1,0,1] row_mask:0xf bank_mask:0xf
v_mul_f32_dpp v22, v33, v22 quad_perm:[0,1,0,1] row_mask:0xf bank_mask:0xf
v_mul_f32_dpp v20, v33, v20 quad_perm:[0,1,0,1] row_mask:0xf bank_mask:0xf
v_cvt_pk_bf16_f32 v20, v20, v21
v_cvt_pk_bf16_f32 v21, v22, v23
ds_write_b64 v6, v[20:21] offset:7168
s_and_b64 vcc, vcc, s[56:57]
v_mov_b32_dpp v16, v20 quad_perm:[0,1,0,1] row_mask:0xf bank_mask:0xf
v_mov_b32_dpp v19, v21 quad_perm:[2,3,2,3] row_mask:0xf bank_mask:0xf
s_cbranch_scc1 L_mx_w2rs
L_mxb_w2rs:
v_mov_b32_dpp v18, v20 quad_perm:[2,3,2,3] row_mask:0xf bank_mask:0xf
v_mov_b64 v[38:39], 0
v_mov_b32_dpp v17, v21 quad_perm:[0,1,0,1] row_mask:0xf bank_mask:0xf
v_mov_b64 v[26:27], 0
v_mov_b64 v[24:25], 0
v_mov_b64 v[32:33], 0
v_smfmac_f32_16x16x64_bf16 v[76:79], v[16:19], a[176:183], v0
s_waitcnt lgkmcnt(0)
s_barrier
ds_read_b128 v[12:15], v7 offset:5120
ds_read_b128 v[52:55], v7 offset:8192
v_smfmac_f32_16x16x64_bf16 v[36:39], v[16:19], a[184:191], v0
ds_read_b128 v[56:59], v7 offset:6144
v_mov_b64 v[34:35], 0
v_smfmac_f32_16x16x64_bf16 v[24:27], v[16:19], a[192:199], v0
v_smfmac_f32_16x16x64_bf16 v[32:35], v[16:19], a[200:207], v0
s_waitcnt lgkmcnt(2)
v_smfmac_f32_16x16x64_bf16 v[76:79], v[12:15], a[208:215], v0
s_waitcnt lgkmcnt(1)
v_smfmac_f32_16x16x64_bf16 v[76:79], v[52:55], a[216:223], v0
s_waitcnt lgkmcnt(0)
v_smfmac_f32_16x16x64_bf16 v[76:79], v[56:59], a[224:231], v0
v_smfmac_f32_16x16x64_bf16 v[36:39], v[12:15], v[44:51], v0
ds_read_b128 v[48:51], v2 offset:27648
ds_read_b128 v[44:47], v2 offset:26624
v_smfmac_f32_16x16x64_bf16 v[36:39], v[52:55], a[232:239], v0
v_cvt_pk_bf16_f32 v77, v77, v79
v_cvt_pk_bf16_f32 v76, v76, v78
v_bfi_b32 v76, 1, s35, v76
v_smfmac_f32_16x16x64_bf16 v[36:39], v[56:59], v[60:67], v0
buffer_store_dwordx2 v[76:77], v8, s[4:7], s42 offen sc0 sc1
ds_read_b128 v[60:63], v2 offset:28672
v_smfmac_f32_16x16x64_bf16 v[24:27], v[12:15], v[68:75], v0
ds_read_b128 v[64:67], v2 offset:29696
v_smfmac_f32_16x16x64_bf16 v[24:27], v[52:55], a[240:247], v0
ds_read_b128 v[68:71], v2 offset:30720
v_cvt_pk_bf16_f32 v36, v36, v38
v_bfi_b32 v36, 1, s35, v36
v_cvt_pk_bf16_f32 v37, v37, v39
s_waitcnt lgkmcnt(3)
v_smfmac_f32_16x16x64_bf16 v[24:27], v[56:59], v[44:51], v0
buffer_store_dwordx2 v[36:37], v8, s[4:7], s43 offen sc0 sc1
ds_read_b128 v[72:75], v2 offset:31744
v_smfmac_f32_16x16x64_bf16 v[32:35], v[52:55], a[248:255], v0
s_waitcnt lgkmcnt(2)
v_smfmac_f32_16x16x64_bf16 v[32:35], v[12:15], v[60:67], v0
v_cvt_pk_bf16_f32 v25, v25, v27
v_cvt_pk_bf16_f32 v24, v24, v26
v_bfi_b32 v24, 1, s35, v24
buffer_store_dwordx2 v[24:25], v8, s[4:7], s44 offen sc0 sc1
s_waitcnt lgkmcnt(0)
v_smfmac_f32_16x16x64_bf16 v[32:35], v[56:59], v[68:75], v0
s_nop 7
v_cvt_pk_bf16_f32 v33, v33, v35
v_cvt_pk_bf16_f32 v32, v32, v34
v_bfi_b32 v32, 1, s35, v32
buffer_store_dwordx2 v[32:33], v8, s[4:7], s45 offen sc0 sc1
s_branch L_ex_w2rs
.p2align 6
L_ex_w3s:
s_add_u32 s34, s34, 1
s_not_b32 s35, s35
s_not_b32 s36, s36
s_add_u32 s37, s37, 524288
s_add_u32 s39, s39, 524288
v_mov_b64 v[20:21], 0
v_mov_b64 v[22:23], 0
v_mov_b64 v[24:25], 0
v_mov_b64 v[26:27], 0
v_mov_b64 v[28:29], 0
v_mov_b64 v[30:31], 0
v_mov_b64 v[32:33], 0
v_mov_b64 v[34:35], 0
v_mov_b64 v[36:37], 0
v_mov_b64 v[38:39], 0
v_mov_b64 v[40:41], 0
v_mov_b64 v[42:43], 0
ds_read_b128 v[44:47], v2 offset:0
ds_read_b128 v[48:51], v2 offset:1024
v_bfe_u32 v77, v1, 6, 1
v_lshl_add_u32 v77, v77, 3, v1
v_lshlrev_b32 v77, 1, v77
s_barrier
s_cmp_eq_u32 s34, 63
s_cbranch_scc1 L_done_w3s
s_cmp_ge_u32 s34, s100
s_cbranch_scc1 L_ev_w3s
L_evb_w3s:
L_top_w3s:
s_barrier
ds_read_b128 v[60:63], v1 offset:1024
s_mov_b32 m0, 5120
s_nop 0
buffer_load_dwordx4 v1, s[4:7], s48 offen offset:3072 sc0 sc1 lds
s_barrier
ds_read_b128 v[64:67], v1 offset:2048
ds_read_b128 v[68:71], v1 offset:3072
ds_read_b128 v[72:75], v1 offset:4096
L_s0_w3s:
s_waitcnt lgkmcnt(3)
v_smfmac_f32_16x16x64_bf16 v[32:35], v[60:63], v[184:191], v0
s_mov_b32 m0, 9216
s_nop 0
buffer_load_dwordx4 v1, s[4:7], s49 offen offset:0 sc0 sc1 lds
s_waitcnt lgkmcnt(2)
v_smfmac_f32_16x16x64_bf16 v[24:27], v[64:67], v[88:95], v0
v_smfmac_f32_16x16x64_bf16 v[20:23], v[60:63], v[44:51], v0
v_smfmac_f32_16x16x64_bf16 v[36:39], v[60:63], a[48:55], v0
v_smfmac_f32_16x16x64_bf16 v[28:31], v[64:67], v[192:199], v0
ds_read_b128 v[48:51], v2 offset:3072
ds_read_b128 v[44:47], v2 offset:2048
v_smfmac_f32_16x16x64_bf16 v[40:43], v[60:63], a[56:63], v0
v_smfmac_f32_16x16x64_bf16 v[20:23], v[64:67], v[80:87], v0
v_bitop3_b32 v6, v60, v64, s35 bitop3:0x7e
v_smfmac_f32_16x16x64_bf16 v[32:35], v[64:67], v[200:207], v0
buffer_load_dwordx4 v[12:15], v9, s[4:7], s37 offen offset:0
v_smfmac_f32_16x16x64_bf16 v[36:39], v[64:67], a[64:71], v0
s_waitcnt lgkmcnt(2)
v_bitop3_b32 v76, v68, v72, s35 bitop3:0x7e
v_smfmac_f32_16x16x64_bf16 v[28:31], v[60:63], v[176:183], v0
v_bitop3_b32 v6, v6, v76, 1 bitop3:0xa8
v_cmp_ne_u32 vcc, 0, v6
s_waitcnt lgkmcnt(0)
v_smfmac_f32_16x16x64_bf16 v[24:27], v[60:63], v[44:51], v0
ds_read_b128 v[44:47], v2 offset:4096
v_smfmac_f32_16x16x64_bf16 v[20:23], v[68:71], v[96:103], v0
ds_read_b128 v[48:51], v2 offset:5120
s_cbranch_vccnz L_ra0_w3s
v_smfmac_f32_16x16x64_bf16 v[40:43], v[64:67], a[72:79], v0
s_waitcnt vmcnt(1)
s_barrier
v_smfmac_f32_16x16x64_bf16 v[24:27], v[68:71], v[104:111], v0
ds_read_b32 v6, v77 offset:8192
buffer_load_dwordx4 v[16:19], v9, s[4:7], s37 offen offset:1024
v_smfmac_f32_16x16x64_bf16 v[28:31], v[68:71], v[208:215], v0
ds_read_b128 v[60:63], v1 offset:6144
ds_read_b128 v[64:67], v1 offset:7168
s_waitcnt lgkmcnt(3)
v_smfmac_f32_16x16x64_bf16 v[20:23], v[72:75], v[44:51], v0
buffer_load_dwordx4 v[52:55], v1, s[4:7], s37 offen offset:2048
ds_read_b128 v[44:47], v2 offset:6144
v_smfmac_f32_16x16x64_bf16 v[32:35], v[68:71], v[216:223], v0
ds_read_b128 v[76:79], v1 offset:5120
v_smfmac_f32_16x16x64_bf16 v[36:39], v[68:71], a[80:87], v0
ds_read_b128 v[48:51], v2 offset:7168
v_smfmac_f32_16x16x64_bf16 v[40:43], v[68:71], a[88:95], v0
s_mov_b32 m0, 0
buffer_load_dwordx4 v[56:59], v1, s[4:7], s37 offen offset:3072
ds_read_b128 v[68:71], v1 offset:8192
s_waitcnt lgkmcnt(5)
v_bitop3_b32 v6, v6, v60, s35 bitop3:0x7e
v_smfmac_f32_16x16x64_bf16 v[28:31], v[72:75], v[224:231], v0
s_waitcnt lgkmcnt(4)
v_bitop3_b32 v6, v6, v64, s35 bitop3:0xf6
v_smfmac_f32_16x16x64_bf16 v[32:35], v[72:75], v[232:239], v0
s_waitcnt lgkmcnt(2)
v_bitop3_b32 v6, v6, v76, s35 bitop3:0xf6
v_and_b32 v6, 1, v6
s_waitcnt lgkmcnt(1)
v_smfmac_f32_16x16x64_bf16 v[24:27], v[72:75], v[44:51], v0
ds_read_b128 v[44:47], v2 offset:8192
v_cmp_ne_u32 vcc, 0, v6
v_smfmac_f32_16x16x64_bf16 v[36:39], v[72:75], a[96:103], v0
ds_read_b128 v[48:51], v2 offset:9216
v_lshlrev_b32 v6, 3, v1
v_smfmac_f32_16x16x64_bf16 v[40:43], v[72:75], a[104:111], v0
s_cbranch_vccnz L_ra1_w3s
L_a1_w3s:
ds_read_b128 v[72:75], v1 offset:9216
v_smfmac_f32_16x16x64_bf16 v[20:23], v[60:63], v[112:119], v0
v_smfmac_f32_16x16x64_bf16 v[20:23], v[64:67], v[128:135], v0
buffer_load_dword v6, s[4:7], s39 offen lds
s_waitcnt lgkmcnt(0)
v_smfmac_f32_16x16x64_bf16 v[20:23], v[72:75], v[160:167], v0
v_bfe_u32 v6, v1, 5, 1
v_smfmac_f32_16x16x64_bf16 v[20:23], v[76:79], v[44:51], v0
v_mad_i32_i24 v6, v6, s55, v1
v_smfmac_f32_16x16x64_bf16 v[20:23], v[68:71], v[144:151], v0
ds_read_b128 v[44:47], v2 offset:10240
v_smfmac_f32_16x16x64_bf16 v[24:27], v[60:63], v[120:127], v0
ds_read_b128 v[48:51], v2 offset:11264
v_smfmac_f32_16x16x64_bf16 v[24:27], v[64:67], v[136:143], v0
v_add_f32 v20, v20, v22
v_smfmac_f32_16x16x64_bf16 v[24:27], v[68:71], v[152:159], v0
v_add_f32 v21, v21, v23
v_smfmac_f32_16x16x64_bf16 v[24:27], v[72:75], v[168:175], v0
v_cvt_pk_bf16_f32 v22, v20, v21
s_waitcnt lgkmcnt(0)
v_smfmac_f32_16x16x64_bf16 v[24:27], v[76:79], v[44:51], v0
ds_read_b128 v[44:47], v2 offset:12288
v_smfmac_f32_16x16x64_bf16 v[28:31], v[76:79], v[240:247], v0
ds_read_b128 v[48:51], v2 offset:13312
v_smfmac_f32_16x16x64_bf16 v[28:31], v[64:67], a[0:7], v0
v_add_f32 v25, v25, v27
v_add_f32 v24, v24, v26
v_cvt_pk_bf16_f32 v23, v24, v25
v_smfmac_f32_16x16x64_bf16 v[28:31], v[68:71], a[16:23], v0
ds_write_b64 v3, v[22:23] offset:11776
v_smfmac_f32_16x16x64_bf16 v[32:35], v[76:79], v[248:255], v0
v_smfmac_f32_16x16x64_bf16 v[28:31], v[72:75], a[32:39], v0
s_waitcnt vmcnt(1)
s_waitcnt lgkmcnt(1)
v_smfmac_f32_16x16x64_bf16 v[28:31], v[60:63], v[44:51], v0
ds_read_b128 v[48:51], v2 offset:15360
ds_read_b128 v[44:47], v2 offset:14336
v_smfmac_f32_16x16x64_bf16 v[32:35], v[64:67], a[8:15], v0
s_waitcnt lgkmcnt(2)
s_barrier
v_smfmac_f32_16x16x64_bf16 v[32:35], v[68:71], a[24:31], v0
ds_read_b64_tr_b16 v[20:21], v4 offset:10240
ds_read_b64_tr_b16 v[22:23], v4 offset:10752
v_add_f32 v29, v29, v31
v_smfmac_f32_16x16x64_bf16 v[32:35], v[72:75], a[40:47], v0
ds_read_b64_tr_b16 v[24:25], v4 offset:11264
ds_read_b64_tr_b16 v[26:27], v4 offset:11776
s_waitcnt lgkmcnt(4)
v_smfmac_f32_16x16x64_bf16 v[32:35], v[60:63], v[44:51], v0
ds_read_b128 v[48:51], v2 offset:19456
s_waitcnt lgkmcnt(3)
v_mfma_f32_16x16x32_bf16 v[12:15], v[12:15], v[20:23], 0
ds_read_b128 v[44:47], v2 offset:18432
v_add_f32 v28, v28, v30
s_waitcnt lgkmcnt(2)
v_mfma_f32_16x16x32_bf16 v[12:15], v[16:19], v[24:27], v[12:15]
v_add_f32 v32, v32, v34
v_add_f32 v33, v33, v35
v_cvt_pk_bf16_f32 v30, v28, v29
v_cvt_pk_bf16_f32 v31, v32, v33
v_smfmac_f32_16x16x64_bf16 v[36:39], v[76:79], a[112:119], v0
ds_write_b64 v3, v[30:31] offset:13824
v_add_f32_dpp v12, v14, v12 quad_perm:[2,3,0,1] row_mask:0xf bank_mask:0xf
v_exp_f32 v14, v12
v_add_f32_dpp v13, v15, v13 quad_perm:[2,3,0,1] row_mask:0xf bank_mask:0xf
v_exp_f32 v15, v13
s_nop 0
v_cvt_pk_bf16_f32 v14, v14, v15
v_smfmac_f32_16x16x64_bf16 v[40:43], v[76:79], a[120:127], v0
ds_write_b32 v5, v14 offset:15136
s_waitcnt lgkmcnt(1)
s_barrier
ds_read_b64_tr_b16 v[28:29], v4 offset:12288
v_smfmac_f32_16x16x64_bf16 v[36:39], v[60:63], a[128:135], v0
ds_read_b64_tr_b16 v[30:31], v4 offset:12800
ds_read_b64_tr_b16 v[32:33], v4 offset:13312
v_smfmac_f32_16x16x64_bf16 v[40:43], v[60:63], a[136:143], v0
ds_read_b64_tr_b16 v[34:35], v4 offset:13824
v_mov_b64 v[76:77], s[52:53]
v_smfmac_f32_16x16x64_bf16 v[40:43], v[72:75], v[44:51], v0
ds_read_b128 v[44:47], v2 offset:16384
s_waitcnt lgkmcnt(3)
v_mfma_f32_16x16x32_bf16 v[28:31], v[28:31], v[20:23], 0
s_barrier
ds_read_b128 v[16:19], v1 offset:14368
s_waitcnt lgkmcnt(2)
v_mfma_f32_16x16x32_bf16 v[28:31], v[32:35], v[24:27], v[28:31]
ds_read_b128 v[60:63], v1 offset:14336
v_mov_b64 v[14:15], s[0:1]
v_smfmac_f32_16x16x64_bf16 v[40:43], v[64:67], a[152:159], v0
ds_read_b128 v[48:51], v2 offset:17408
v_mov_b64 v[78:79], s[52:53]
v_smfmac_f32_16x16x64_bf16 v[40:43], v[68:71], a[168:175], v0
v_add_f32_dpp v28, v30, v28 quad_perm:[2,3,0,1] row_mask:0xf bank_mask:0xf
v_mul_f32 v28, s50, v28
v_smfmac_f32_16x16x64_bf16 v[36:39], v[64:67], a[144:151], v0
ds_read_b128 v[64:67], v2 offset:21504
v_add_f32_dpp v29, v31, v29 quad_perm:[2,3,0,1] row_mask:0xf bank_mask:0xf
v_smfmac_f32_16x16x64_bf16 v[36:39], v[68:71], a[160:167], v0
ds_read_b128 v[68:71], v2 offset:26624
s_waitcnt lgkmcnt(2)
v_smfmac_f32_16x16x64_bf16 v[36:39], v[72:75], v[44:51], v0
ds_read_b128 v[72:75], v2 offset:27648
v_cvt_pk_bf16_f32 v40, v40, v41
v_exp_f32 v30, v28
v_mfma_f32_16x16x32_bf16 v[32:35], v[76:79], v[16:19], 0
ds_read_b128 v[44:47], v2 offset:22528
v_mul_f32 v29, s50, v29
v_mfma_f32_16x16x32_bf16 v[20:23], v[52:55], v[16:19], 0
v_exp_f32 v31, v29
v_mfma_f32_16x16x32_bf16 v[20:23], v[56:59], v[60:63], v[20:23]
v_cvt_pk_bf16_f32 v41, v42, v43
v_cvt_pk_bf16_f32 v30, v30, v31
v_cndmask_b32_e64 v26, 0, v30, s[56:57]
v_cvt_pk_bf16_f32 v43, v38, v39
v_cndmask_b32_e64 v27, 0, v30, s[56:57]
v_mov_b32_dpp v24, v26 quad_perm:[2,3,0,1] row_mask:0xf bank_mask:0xf
v_mov_b64 v[76:77], 0
v_mfma_f32_16x16x16_bf16 v[32:35], v[14:15], v[26:27], v[32:35]
v_cvt_pk_bf16_f32 v42, v36, v37
v_mov_b32_dpp v25, v26 quad_perm:[2,3,0,1] row_mask:0xf bank_mask:0xf
s_nop 1
v_mfma_f32_16x16x32_bf16 v[20:23], v[40:43], v[24:27], v[20:23]
ds_read_b128 v[48:51], v2 offset:23552
s_nop 0
v_rcp_f32 v33, v32
ds_read_b128 v[60:63], v2 offset:20480
v_mov_b64 v[36:37], 0
v_min_f32 v32, v32, v33
v_cmp_nlt_f32 vcc, s2, v32
v_mov_b64 v[78:79], 0
v_mul_f32_dpp v23, v33, v23 quad_perm:[0,1,0,1] row_mask:0xf bank_mask:0xf
v_mul_f32_dpp v21, v33, v21 quad_perm:[0,1,0,1] row_mask:0xf bank_mask:0xf
v_mul_f32_dpp v22, v33, v22 quad_perm:[0,1,0,1] row_mask:0xf bank_mask:0xf
v_mul_f32_dpp v20, v33, v20 quad_perm:[0,1,0,1] row_mask:0xf bank_mask:0xf
v_cvt_pk_bf16_f32 v20, v20, v21
v_cvt_pk_bf16_f32 v21, v22, v23
ds_write_b64 v6, v[20:21] offset:8192
s_and_b64 vcc, vcc, s[56:57]
v_mov_b64 v[38:39], 0
s_cbranch_scc1 L_mx_w3s
L_mxb_w3s:
v_mov_b32_dpp v16, v20 quad_perm:[0,1,0,1] row_mask:0xf bank_mask:0xf
v_mov_b32_dpp v19, v21 quad_perm:[2,3,2,3] row_mask:0xf bank_mask:0xf
v_mov_b64 v[24:25], 0
v_mov_b32_dpp v18, v20 quad_perm:[2,3,2,3] row_mask:0xf bank_mask:0xf
v_mov_b32_dpp v17, v21 quad_perm:[0,1,0,1] row_mask:0xf bank_mask:0xf
v_mov_b64 v[26:27], 0
v_mov_b64 v[32:33], 0
v_smfmac_f32_16x16x64_bf16 v[76:79], v[16:19], a[176:183], v0
s_waitcnt lgkmcnt(0)
s_barrier
ds_read_b128 v[12:15], v7 offset:6144
ds_read_b128 v[52:55], v7 offset:7168
v_smfmac_f32_16x16x64_bf16 v[36:39], v[16:19], a[184:191], v0
ds_read_b128 v[56:59], v7 offset:5120
v_mov_b64 v[34:35], 0
s_nop 1
v_smfmac_f32_16x16x64_bf16 v[32:35], v[16:19], a[200:207], v0
v_smfmac_f32_16x16x64_bf16 v[24:27], v[16:19], a[192:199], v0
s_waitcnt lgkmcnt(2)
v_smfmac_f32_16x16x64_bf16 v[76:79], v[12:15], a[208:215], v0
s_waitcnt lgkmcnt(1)
v_smfmac_f32_16x16x64_bf16 v[76:79], v[52:55], a[216:223], v0
s_waitcnt lgkmcnt(0)
v_smfmac_f32_16x16x64_bf16 v[76:79], v[56:59], a[224:231], v0
v_smfmac_f32_16x16x64_bf16 v[36:39], v[12:15], v[44:51], v0
ds_read_b128 v[48:51], v2 offset:25600
ds_read_b128 v[44:47], v2 offset:24576
v_smfmac_f32_16x16x64_bf16 v[36:39], v[52:55], a[232:239], v0
v_cvt_pk_bf16_f32 v77, v77, v79
v_cvt_pk_bf16_f32 v76, v76, v78
v_bfi_b32 v76, 1, s35, v76
v_smfmac_f32_16x16x64_bf16 v[36:39], v[56:59], v[60:67], v0
buffer_store_dwordx2 v[76:77], v8, s[4:7], s42 offen sc0 sc1
ds_read_b128 v[60:63], v2 offset:30720
v_smfmac_f32_16x16x64_bf16 v[24:27], v[12:15], v[68:75], v0
ds_read_b128 v[64:67], v2 offset:31744
v_smfmac_f32_16x16x64_bf16 v[24:27], v[52:55], a[240:247], v0
ds_read_b128 v[68:71], v2 offset:28672
v_cvt_pk_bf16_f32 v36, v36, v38
v_bfi_b32 v36, 1, s35, v36
v_cvt_pk_bf16_f32 v37, v37, v39
s_waitcnt lgkmcnt(3)
v_smfmac_f32_16x16x64_bf16 v[24:27], v[56:59], v[44:51], v0
buffer_store_dwordx2 v[36:37], v8, s[4:7], s43 offen sc0 sc1
ds_read_b128 v[72:75], v2 offset:29696
s_nop 5
v_cvt_pk_bf16_f32 v25, v25, v27
v_cvt_pk_bf16_f32 v24, v24, v26
v_bfi_b32 v24, 1, s35, v24
v_smfmac_f32_16x16x64_bf16 v[32:35], v[52:55], a[248:255], v0
s_waitcnt lgkmcnt(2)
v_smfmac_f32_16x16x64_bf16 v[32:35], v[12:15], v[60:67], v0
buffer_store_dwordx2 v[24:25], v8, s[4:7], s44 offen sc0 sc1
s_waitcnt lgkmcnt(0)
v_smfmac_f32_16x16x64_bf16 v[32:35], v[56:59], v[68:75], v0
s_nop 7
v_cvt_pk_bf16_f32 v33, v33, v35
v_cvt_pk_bf16_f32 v32, v32, v34
v_bfi_b32 v32, 1, s35, v32
buffer_store_dwordx2 v[32:33], v8, s[4:7], s45 offen sc0 sc1
s_branch L_ex_w3s
L_pro_w2r:
v_and_b32 v20, 63, v0
v_lshlrev_b32 v1, 4, v20
v_add_u32 v2, 98304, v1
v_and_b32 v23, 1, v22
v_lshl_add_u32 v23, v24, 4, v23
v_mul_u32_u24 v23, 1152, v23
v_lshlrev_b32 v28, 2, v22
v_xor_b32 v28, v28, v21
v_lshl_add_u32 v28, v28, 4, v23
s_mul_i32 s55, s32, 147456
s_waitcnt lgkmcnt(0)
v_and_b32 v23, 1, v22
v_lshrrev_b32 v24, 2, v21
v_lshl_add_u32 v23, v23, 2, v24
v_lshlrev_b32 v23, 1, v23
v_bfe_u32 v44, v21, 1, 1
v_add_u32 v44, 8, v44
v_xor_b32 v44, v44, v23
v_lshlrev_b32 v44, 4, v44
v_lshl_add_u32 v44, v24, 8, v44
v_and_b32 v23, 1, v22
v_lshl_add_u32 v44, v23, 11, v44
v_and_b32 v23, 1, v21
v_lshl_add_u32 v44, v23, 3, v44
v_lshrrev_b32 v23, 1, v22
v_mul_u32_u24 v23, 40960, v23
v_add_u32 v23, 16384, v23
v_add_u32 v44, v44, v23
v_and_b32 v23, 1, v22
v_lshrrev_b32 v24, 2, v21
v_lshl_add_u32 v23, v23, 2, v24
v_lshlrev_b32 v23, 1, v23
v_bfe_u32 v45, v21, 1, 1
v_add_u32 v45, 10, v45
v_xor_b32 v45, v45, v23
v_lshlrev_b32 v45, 4, v45
v_lshl_add_u32 v45, v24, 8, v45
v_and_b32 v23, 1, v22
v_lshl_add_u32 v45, v23, 11, v45
v_and_b32 v23, 1, v21
v_lshl_add_u32 v45, v23, 3, v45
v_lshrrev_b32 v23, 1, v22
v_mul_u32_u24 v23, 40960, v23
v_add_u32 v23, 16384, v23
v_add_u32 v45, v45, v23
v_and_b32 v23, 1, v22
v_lshrrev_b32 v24, 2, v21
v_lshl_add_u32 v23, v23, 2, v24
v_lshlrev_b32 v23, 1, v23
v_bfe_u32 v46, v21, 1, 1
v_add_u32 v46, 8, v46
v_xor_b32 v46, v46, v23
v_lshlrev_b32 v46, 4, v46
v_lshl_add_u32 v46, v24, 8, v46
v_and_b32 v23, 1, v22
v_lshl_add_u32 v46, v23, 11, v46
v_and_b32 v23, 1, v21
v_lshl_add_u32 v46, v23, 3, v46
v_lshrrev_b32 v23, 1, v22
v_mul_u32_u24 v23, 32768, v23
v_add_u32 v23, 98304, v23
v_add_u32 v46, v46, v23
v_and_b32 v23, 1, v22
v_lshrrev_b32 v24, 2, v21
v_lshl_add_u32 v23, v23, 2, v24
v_lshlrev_b32 v23, 1, v23
v_bfe_u32 v47, v21, 1, 1
v_add_u32 v47, 10, v47
v_xor_b32 v47, v47, v23
v_lshlrev_b32 v47, 4, v47
v_lshl_add_u32 v47, v24, 8, v47
v_and_b32 v23, 1, v22
v_lshl_add_u32 v47, v23, 11, v47
v_and_b32 v23, 1, v21
v_lshl_add_u32 v47, v23, 3, v47
v_lshrrev_b32 v23, 1, v22
v_mul_u32_u24 v23, 32768, v23
v_add_u32 v23, 98304, v23
v_add_u32 v47, v47, v23
v_and_b32 v23, 1, v22
v_bfe_u32 v24, v21, 2, 1
v_lshl_add_u32 v23, v23, 1, v24
v_xor_b32 v24, 2, v23
v_lshlrev_b32 v24, 6, v24
v_lshl_add_u32 v48, v23, 8, v24
v_and_b32 v23, 3, v21
v_lshl_add_u32 v48, v23, 4, v48
v_and_b32 v23, 8, v21
v_add_u32 v48, v48, v23
v_lshrrev_b32 v23, 1, v22
v_mul_u32_u24 v23, 40960, v23
v_add_u32 v23, 16384, v23
v_add_u32 v48, v48, v23
v_and_b32 v23, 1, v22
v_bfe_u32 v24, v21, 2, 1
v_lshl_add_u32 v23, v23, 1, v24
v_xor_b32 v24, 2, v23
v_lshlrev_b32 v24, 6, v24
v_lshl_add_u32 v49, v23, 8, v24
v_and_b32 v23, 3, v21
v_lshl_add_u32 v49, v23, 4, v49
v_and_b32 v23, 8, v21
v_add_u32 v49, v49, v23
v_lshrrev_b32 v23, 1, v22
v_mul_u32_u24 v23, 32768, v23
v_add_u32 v23, 98304, v23
v_add_u32 v49, v49, v23
v_bfe_u32 v23, v21, 1, 1
v_mul_u32_u24 v23, 0xaaaa, v23
v_add_u32 v0, 0x4444, v23
v_lshlrev_b32 v3, 3, v20
v_lshrrev_b32 v25, 5, v20
v_lshlrev_b32 v25, 6, v25
v_xor_b32 v3, v3, v25
v_lshrrev_b32 v25, 2, v20
v_and_b32 v4, 3, v21
v_lshl_add_u32 v4, v4, 4, v25
v_lshlrev_b32 v4, 3, v4
v_bfe_u32 v25, v21, 1, 1
v_lshlrev_b32 v23, 6, v25
v_xor_b32 v4, v4, v23
v_lshlrev_b32 v5, 4, v21
v_lshl_add_u32 v5, v22, 2, v5
v_mul_u32_u24 v23, 512, v25
v_add_u32 v5, v5, v23
v_lshlrev_b32 v9, 8, v22
v_lshl_add_u32 v9, v25, 6, v9
v_bfe_u32 v23, v21, 3, 1
v_lshl_add_u32 v9, v23, 7, v9
v_bfe_u32 v23, v21, 2, 1
v_lshl_add_u32 v9, v23, 5, v9
v_and_b32 v23, 1, v21
v_lshl_add_u32 v9, v23, 4, v9
v_lshrrev_b32 v23, 1, v22
v_and_b32 v24, 1, v22
v_and_b32 v25, 7, v21
v_lshrrev_b32 v7, 3, v21
v_lshl_add_u32 v8, v7, 1, v23
v_lshlrev_b32 v8, 12, v8
v_lshl_add_u32 v8, v24, 7, v8
v_and_b32 v25, 4, v21
v_lshl_add_u32 v8, v25, 3, v8
v_and_b32 v25, 1, v21
v_lshl_add_u32 v8, v25, 4, v8
v_bfe_u32 v25, v21, 1, 1
v_lshl_add_u32 v8, v25, 3, v8
s_lshr_b32 s56, s32, 1
s_lshl_b32 s56, s56, 8
s_and_b32 s57, s32, 1
s_lshl_b32 s57, s57, 6
s_add_u32 s56, s56, s57
s_add_u32 s56, s56, 32768
v_add_u32 v8, s56, v8
v_and_b32 v7, 0x3d0, v1
s_mov_b32 s42, 0
s_mov_b32 s43, 65536
s_mov_b32 s44, 131072
s_mov_b32 s45, 196608
s_mov_b32 s46, 262144
s_mov_b32 s47, 294912
s_mov_b32 s48, 299008
s_mov_b32 s49, 303104
s_mov_b32 s50, 0x3e0293ee
s_mov_b32 s51, 0x3e0293ee
s_mov_b32 s52, 0x3f803f80
s_mov_b32 s53, 0x3f803f80
v_and_b32 v11, 3, v21
v_cmp_eq_u32 vcc, 0, v11
s_nop 1
v_cndmask_b32 v11, 0, 1, vcc
s_mov_b32 s34, 0
s_mov_b32 s35, -1
s_mov_b32 s36, 0
s_mov_b32 s41, 300000
s_lshl_b32 s37, s32, 14
s_add_u32 s39, s37, 17301504
s_add_u32 s37, s37, 16785408
s_mov_b32 s40, 8749056
v_mov_b64 v[36:37], 0
v_mov_b64 v[38:39], 0
s_lshl_b32 s56, s32, 1
s_add_u32 s56, s56, 1
s_cmp_eq_u32 s56, 0
s_cselect_b32 s56, 64, s56
s_mul_i32 s56, s56, 10240
s_add_u32 s56, s56, 8388608
s_add_u32 s57, s56, 4096
v_mov_b32 v40, 1
v_mov_b32 v41, 1
v_mov_b32 v42, 1
v_mov_b32 v43, 1
buffer_store_dwordx4 v[40:43], v1, s[4:7], s56 offen offset:0 sc0 sc1
buffer_store_dwordx4 v[40:43], v1, s[4:7], s56 offen offset:1024 sc0 sc1
buffer_store_dwordx4 v[40:43], v1, s[4:7], s56 offen offset:2048 sc0 sc1
buffer_store_dwordx4 v[40:43], v1, s[4:7], s56 offen offset:3072 sc0 sc1
s_add_u32 s56, s32, 0
s_lshl_b32 s3, s56, 12
v_and_b32 v23, 1, v21
v_bfe_u32 v24, v21, 2, 1
v_bfe_u32 v25, v21, 1, 1
s_lshl_b32 s57, s56, 7
s_add_u32 s57, s57, 294912
v_and_b32 v10, 7, v21
v_lshlrev_b32 v10, 2, v10
v_lshl_add_u32 v10, v22, 5, v10
v_add_u32 v10, s57, v10
s_lshl_b32 s33, s56, 2
s_add_u32 s33, s33, 304128
v_mov_b32 v30, -1
s_mov_b64 exec, 1
buffer_store_dword v30, v1, s[4:7], s33 offen sc0 sc1
s_mov_b64 exec, -1
v_lshl_add_u32 v23, v23, 1, v24
v_lshlrev_b32 v25, 4, v25
v_mov_b32 v24, 0x3f80
v_lshlrev_b32 v24, v25, v24
v_cmp_eq_u32 vcc, 0, v23
s_nop 1
v_cndmask_b32 v76, 0, v24, vcc
v_cmp_eq_u32 vcc, 1, v23
s_nop 1
v_cndmask_b32 v77, 0, v24, vcc
v_cmp_eq_u32 vcc, 2, v23
s_nop 1
v_cndmask_b32 v78, 0, v24, vcc
v_cmp_eq_u32 vcc, 3, v23
s_nop 1
v_cndmask_b32 v79, 0, v24, vcc
v_and_b32 v23, 0x70, v1
ds_write_b128 v23, v[76:79] offset:256
buffer_store_dwordx4 v[36:39], v9, s[4:7], s3 offen offset:0 sc0 sc1
buffer_store_dwordx4 v[36:39], v9, s[4:7], s3 offen offset:1024 sc0 sc1
buffer_store_dwordx4 v[36:39], v9, s[4:7], s3 offen offset:2048 sc0 sc1
buffer_store_dwordx4 v[36:39], v9, s[4:7], s3 offen offset:3072 sc0 sc1
s_getreg_b32 s56, hwreg(HW_REG_XCC_ID)
s_and_b32 s56, s56, 15
s_mul_i32 s57, s56, s56
s_lshl_b32 s57, s57, 18
s_lshl_b32 s56, s56, 8
s_add_u32 s57, s57, s56
s_add_u32 s58, s57, 1
s_lshl_b32 s101, s32, 7
s_add_u32 s101, s101, 327680
v_mov_b32 v24, 0
s_add_u32 s56, s54, 262144
s_mov_b32 m0, 110592
s_nop 0
buffer_load_dwordx4 v26, s[12:15], s56 offen lds
s_add_u32 s56, s54, 278528
s_mov_b32 m0, 111616
s_nop 0
buffer_load_dwordx4 v26, s[12:15], s56 offen lds
s_add_u32 s56, s54, 294912
s_mov_b32 m0, 112640
s_nop 0
buffer_load_dwordx4 v27, s[12:15], s56 offen lds
s_add_u32 s56, s54, 311296
s_mov_b32 m0, 113664
s_nop 0
buffer_load_dwordx4 v27, s[12:15], s56 offen lds
s_add_u32 s56, s54, 786432
s_mov_b32 m0, 114688
s_nop 0
buffer_load_dwordx4 v26, s[12:15], s56 offen lds
s_add_u32 s56, s54, 802816
s_mov_b32 m0, 115712
s_nop 0
buffer_load_dwordx4 v26, s[12:15], s56 offen lds
s_add_u32 s56, s54, 819200
s_mov_b32 m0, 116736
s_nop 0
buffer_load_dwordx4 v27, s[12:15], s56 offen lds
s_add_u32 s56, s54, 835584
s_mov_b32 m0, 117760
s_nop 0
buffer_load_dwordx4 v27, s[12:15], s56 offen lds
v_mov_b32 v24, 0
s_waitcnt vmcnt(37)
s_barrier
ds_read_b64_tr_b16 v[80:81], v44 offset:20480
ds_read_b64_tr_b16 v[82:83], v44 offset:21504
ds_read_b64_tr_b16 v[84:85], v46 offset:20480
ds_read_b64_tr_b16 v[86:87], v46 offset:21504
ds_read_b64_tr_b16 v[88:89], v45 offset:20480
ds_read_b64_tr_b16 v[90:91], v45 offset:21504
ds_read_b64_tr_b16 v[92:93], v47 offset:20480
ds_read_b64_tr_b16 v[94:95], v47 offset:21504
s_waitcnt lgkmcnt(0)
s_waitcnt vmcnt(33)
s_barrier
s_add_u32 s56, s54, 1310720
s_mov_b32 m0, 118784
s_nop 0
buffer_load_dwordx4 v26, s[12:15], s56 offen lds
s_add_u32 s56, s54, 1327104
s_mov_b32 m0, 119808
s_nop 0
buffer_load_dwordx4 v26, s[12:15], s56 offen lds
s_add_u32 s56, s54, 1343488
s_mov_b32 m0, 120832
s_nop 0
buffer_load_dwordx4 v27, s[12:15], s56 offen lds
s_add_u32 s56, s54, 1359872
s_mov_b32 m0, 121856
s_nop 0
buffer_load_dwordx4 v27, s[12:15], s56 offen lds
ds_read_b64_tr_b16 v[96:97], v44 offset:24576
ds_read_b64_tr_b16 v[98:99], v44 offset:25600
ds_read_b64_tr_b16 v[100:101], v46 offset:24576
ds_read_b64_tr_b16 v[102:103], v46 offset:25600
ds_read_b64_tr_b16 v[104:105], v45 offset:24576
ds_read_b64_tr_b16 v[106:107], v45 offset:25600
ds_read_b64_tr_b16 v[108:109], v47 offset:24576
ds_read_b64_tr_b16 v[110:111], v47 offset:25600
s_waitcnt lgkmcnt(0)
s_waitcnt vmcnt(33)
s_barrier
s_add_u32 s56, s54, 1835008
s_mov_b32 m0, 122880
s_nop 0
buffer_load_dwordx4 v26, s[12:15], s56 offen lds
s_add_u32 s56, s54, 1851392
s_mov_b32 m0, 123904
s_nop 0
buffer_load_dwordx4 v26, s[12:15], s56 offen lds
s_add_u32 s56, s54, 1867776
s_mov_b32 m0, 124928
s_nop 0
buffer_load_dwordx4 v27, s[12:15], s56 offen lds
s_add_u32 s56, s54, 1884160
s_mov_b32 m0, 125952
s_nop 0
buffer_load_dwordx4 v27, s[12:15], s56 offen lds
ds_read_b64_tr_b16 v[112:113], v44 offset:28672
ds_read_b64_tr_b16 v[114:115], v44 offset:29696
ds_read_b64_tr_b16 v[116:117], v46 offset:28672
ds_read_b64_tr_b16 v[118:119], v46 offset:29696
ds_read_b64_tr_b16 v[120:121], v45 offset:28672
ds_read_b64_tr_b16 v[122:123], v45 offset:29696
ds_read_b64_tr_b16 v[124:125], v47 offset:28672
ds_read_b64_tr_b16 v[126:127], v47 offset:29696
s_waitcnt lgkmcnt(0)
s_waitcnt vmcnt(33)
s_barrier
s_add_u32 s56, s54, 2359296
s_mov_b32 m0, 126976
s_nop 0
buffer_load_dwordx4 v26, s[12:15], s56 offen lds
s_add_u32 s56, s54, 2375680
s_mov_b32 m0, 128000
s_nop 0
buffer_load_dwordx4 v26, s[12:15], s56 offen lds
s_add_u32 s56, s54, 2392064
s_mov_b32 m0, 129024
s_nop 0
buffer_load_dwordx4 v27, s[12:15], s56 offen lds
s_add_u32 s56, s54, 2408448
s_mov_b32 m0, 130048
s_nop 0
buffer_load_dwordx4 v27, s[12:15], s56 offen lds
ds_read_b64_tr_b16 v[128:129], v44 offset:0
ds_read_b64_tr_b16 v[130:131], v44 offset:1024
ds_read_b64_tr_b16 v[132:133], v46 offset:0
ds_read_b64_tr_b16 v[134:135], v46 offset:1024
ds_read_b64_tr_b16 v[136:137], v45 offset:0
ds_read_b64_tr_b16 v[138:139], v45 offset:1024
ds_read_b64_tr_b16 v[140:141], v47 offset:0
ds_read_b64_tr_b16 v[142:143], v47 offset:1024
s_waitcnt lgkmcnt(0)
s_waitcnt vmcnt(33)
s_barrier
s_add_u32 s56, s54, 3407872
s_mov_b32 m0, 98304
s_nop 0
buffer_load_dwordx4 v26, s[12:15], s56 offen lds
s_add_u32 s56, s54, 3424256
s_mov_b32 m0, 99328
s_nop 0
buffer_load_dwordx4 v26, s[12:15], s56 offen lds
s_add_u32 s56, s54, 3440640
s_mov_b32 m0, 100352
s_nop 0
buffer_load_dwordx4 v27, s[12:15], s56 offen lds
s_add_u32 s56, s54, 3457024
s_mov_b32 m0, 101376
s_nop 0
buffer_load_dwordx4 v27, s[12:15], s56 offen lds
ds_read_b64_tr_b16 v[144:145], v44 offset:4096
ds_read_b64_tr_b16 v[146:147], v44 offset:5120
ds_read_b64_tr_b16 v[148:149], v46 offset:4096
ds_read_b64_tr_b16 v[150:151], v46 offset:5120
ds_read_b64_tr_b16 v[152:153], v45 offset:4096
ds_read_b64_tr_b16 v[154:155], v45 offset:5120
ds_read_b64_tr_b16 v[156:157], v47 offset:4096
ds_read_b64_tr_b16 v[158:159], v47 offset:5120
s_waitcnt lgkmcnt(0)
s_waitcnt vmcnt(33)
s_barrier
s_add_u32 s56, s54, 3932160
s_mov_b32 m0, 102400
s_nop 0
buffer_load_dwordx4 v26, s[12:15], s56 offen lds
s_add_u32 s56, s54, 3948544
s_mov_b32 m0, 103424
s_nop 0
buffer_load_dwordx4 v26, s[12:15], s56 offen lds
s_add_u32 s56, s54, 3964928
s_mov_b32 m0, 104448
s_nop 0
buffer_load_dwordx4 v27, s[12:15], s56 offen lds
s_add_u32 s56, s54, 3981312
s_mov_b32 m0, 105472
s_nop 0
buffer_load_dwordx4 v27, s[12:15], s56 offen lds
ds_read_b64_tr_b16 v[160:161], v44 offset:8192
ds_read_b64_tr_b16 v[162:163], v44 offset:9216
ds_read_b64_tr_b16 v[164:165], v46 offset:8192
ds_read_b64_tr_b16 v[166:167], v46 offset:9216
ds_read_b64_tr_b16 v[168:169], v45 offset:8192
ds_read_b64_tr_b16 v[170:171], v45 offset:9216
ds_read_b64_tr_b16 v[172:173], v47 offset:8192
ds_read_b64_tr_b16 v[174:175], v47 offset:9216
s_waitcnt lgkmcnt(0)
s_waitcnt vmcnt(24)
s_barrier
s_add_u32 s56, s54, 4456448
s_mov_b32 m0, 106496
s_nop 0
buffer_load_dwordx4 v26, s[12:15], s56 offen lds
s_add_u32 s56, s54, 4472832
s_mov_b32 m0, 107520
s_nop 0
buffer_load_dwordx4 v26, s[12:15], s56 offen lds
s_add_u32 s56, s54, 4489216
s_mov_b32 m0, 108544
s_nop 0
buffer_load_dwordx4 v27, s[12:15], s56 offen lds
s_add_u32 s56, s54, 4505600
s_mov_b32 m0, 109568
s_nop 0
buffer_load_dwordx4 v27, s[12:15], s56 offen lds
ds_read_b64_tr_b16 v[176:177], v44 offset:12288
ds_read_b64_tr_b16 v[178:179], v44 offset:13312
ds_read_b64_tr_b16 v[180:181], v46 offset:12288
ds_read_b64_tr_b16 v[182:183], v46 offset:13312
ds_read_b64_tr_b16 v[184:185], v45 offset:12288
ds_read_b64_tr_b16 v[186:187], v45 offset:13312
ds_read_b64_tr_b16 v[188:189], v47 offset:12288
ds_read_b64_tr_b16 v[190:191], v47 offset:13312
s_waitcnt lgkmcnt(0)
s_waitcnt vmcnt(24)
s_barrier
s_add_u32 s56, s54, 262144
s_mov_b32 m0, 110592
s_nop 0
buffer_load_dwordx4 v26, s[16:19], s56 offen lds
s_add_u32 s56, s54, 278528
s_mov_b32 m0, 111616
s_nop 0
buffer_load_dwordx4 v26, s[16:19], s56 offen lds
s_add_u32 s56, s54, 294912
s_mov_b32 m0, 112640
s_nop 0
buffer_load_dwordx4 v27, s[16:19], s56 offen lds
s_add_u32 s56, s54, 311296
s_mov_b32 m0, 113664
s_nop 0
buffer_load_dwordx4 v27, s[16:19], s56 offen lds
ds_read_b64_tr_b16 v[192:193], v44 offset:16384
ds_read_b64_tr_b16 v[194:195], v44 offset:17408
ds_read_b64_tr_b16 v[196:197], v46 offset:16384
ds_read_b64_tr_b16 v[198:199], v46 offset:17408
ds_read_b64_tr_b16 v[200:201], v45 offset:16384
ds_read_b64_tr_b16 v[202:203], v45 offset:17408
ds_read_b64_tr_b16 v[204:205], v47 offset:16384
ds_read_b64_tr_b16 v[206:207], v47 offset:17408
s_waitcnt lgkmcnt(0)
s_waitcnt vmcnt(24)
s_barrier
s_add_u32 s56, s54, 786432
s_mov_b32 m0, 114688
s_nop 0
buffer_load_dwordx4 v26, s[16:19], s56 offen lds
s_add_u32 s56, s54, 802816
s_mov_b32 m0, 115712
s_nop 0
buffer_load_dwordx4 v26, s[16:19], s56 offen lds
s_add_u32 s56, s54, 819200
s_mov_b32 m0, 116736
s_nop 0
buffer_load_dwordx4 v27, s[16:19], s56 offen lds
s_add_u32 s56, s54, 835584
s_mov_b32 m0, 117760
s_nop 0
buffer_load_dwordx4 v27, s[16:19], s56 offen lds
ds_read_b64_tr_b16 v[208:209], v44 offset:20480
ds_read_b64_tr_b16 v[210:211], v44 offset:21504
ds_read_b64_tr_b16 v[212:213], v46 offset:20480
ds_read_b64_tr_b16 v[214:215], v46 offset:21504
ds_read_b64_tr_b16 v[216:217], v45 offset:20480
ds_read_b64_tr_b16 v[218:219], v45 offset:21504
ds_read_b64_tr_b16 v[220:221], v47 offset:20480
ds_read_b64_tr_b16 v[222:223], v47 offset:21504
s_waitcnt lgkmcnt(0)
s_waitcnt vmcnt(24)
s_barrier
s_add_u32 s56, s54, 1310720
s_mov_b32 m0, 118784
s_nop 0
buffer_load_dwordx4 v26, s[16:19], s56 offen lds
s_add_u32 s56, s54, 1327104
s_mov_b32 m0, 119808
s_nop 0
buffer_load_dwordx4 v26, s[16:19], s56 offen lds
s_add_u32 s56, s54, 1343488
s_mov_b32 m0, 120832
s_nop 0
buffer_load_dwordx4 v27, s[16:19], s56 offen lds
s_add_u32 s56, s54, 1359872
s_mov_b32 m0, 121856
s_nop 0
buffer_load_dwordx4 v27, s[16:19], s56 offen lds
ds_read_b64_tr_b16 v[224:225], v44 offset:24576
ds_read_b64_tr_b16 v[226:227], v44 offset:25600
ds_read_b64_tr_b16 v[228:229], v46 offset:24576
ds_read_b64_tr_b16 v[230:231], v46 offset:25600
ds_read_b64_tr_b16 v[232:233], v45 offset:24576
ds_read_b64_tr_b16 v[234:235], v45 offset:25600
ds_read_b64_tr_b16 v[236:237], v47 offset:24576
ds_read_b64_tr_b16 v[238:239], v47 offset:25600
s_waitcnt lgkmcnt(0)
s_waitcnt vmcnt(24)
s_barrier
s_add_u32 s56, s54, 1835008
s_mov_b32 m0, 122880
s_nop 0
buffer_load_dwordx4 v26, s[16:19], s56 offen lds
s_add_u32 s56, s54, 1851392
s_mov_b32 m0, 123904
s_nop 0
buffer_load_dwordx4 v26, s[16:19], s56 offen lds
s_add_u32 s56, s54, 1867776
s_mov_b32 m0, 124928
s_nop 0
buffer_load_dwordx4 v27, s[16:19], s56 offen lds
s_add_u32 s56, s54, 1884160
s_mov_b32 m0, 125952
s_nop 0
buffer_load_dwordx4 v27, s[16:19], s56 offen lds
ds_read_b64_tr_b16 v[240:241], v44 offset:28672
ds_read_b64_tr_b16 v[242:243], v44 offset:29696
ds_read_b64_tr_b16 v[244:245], v46 offset:28672
ds_read_b64_tr_b16 v[246:247], v46 offset:29696
ds_read_b64_tr_b16 v[248:249], v45 offset:28672
ds_read_b64_tr_b16 v[250:251], v45 offset:29696
ds_read_b64_tr_b16 v[252:253], v47 offset:28672
ds_read_b64_tr_b16 v[254:255], v47 offset:29696
s_waitcnt lgkmcnt(0)
s_waitcnt vmcnt(24)
s_barrier
s_add_u32 s56, s54, 2359296
s_mov_b32 m0, 126976
s_nop 0
buffer_load_dwordx4 v26, s[16:19], s56 offen lds
s_add_u32 s56, s54, 2375680
s_mov_b32 m0, 128000
s_nop 0
buffer_load_dwordx4 v26, s[16:19], s56 offen lds
s_add_u32 s56, s54, 2392064
s_mov_b32 m0, 129024
s_nop 0
buffer_load_dwordx4 v27, s[16:19], s56 offen lds
s_add_u32 s56, s54, 2408448
s_mov_b32 m0, 130048
s_nop 0
buffer_load_dwordx4 v27, s[16:19], s56 offen lds
ds_read_b64_tr_b16 a[0:1], v44 offset:0
ds_read_b64_tr_b16 a[2:3], v44 offset:1024
ds_read_b64_tr_b16 a[4:5], v46 offset:0
ds_read_b64_tr_b16 a[6:7], v46 offset:1024
ds_read_b64_tr_b16 a[8:9], v45 offset:0
ds_read_b64_tr_b16 a[10:11], v45 offset:1024
ds_read_b64_tr_b16 a[12:13], v47 offset:0
ds_read_b64_tr_b16 a[14:15], v47 offset:1024
s_waitcnt lgkmcnt(0)
s_waitcnt vmcnt(24)
s_barrier
s_add_u32 s56, s54, 2883584
s_mov_b32 m0, 98304
s_nop 0
buffer_load_dwordx4 v26, s[16:19], s56 offen lds
s_add_u32 s56, s54, 2899968
s_mov_b32 m0, 99328
s_nop 0
buffer_load_dwordx4 v26, s[16:19], s56 offen lds
s_add_u32 s56, s54, 2916352
s_mov_b32 m0, 100352
s_nop 0
buffer_load_dwordx4 v27, s[16:19], s56 offen lds
s_add_u32 s56, s54, 2932736
s_mov_b32 m0, 101376
s_nop 0
buffer_load_dwordx4 v27, s[16:19], s56 offen lds
ds_read_b64_tr_b16 a[16:17], v44 offset:4096
ds_read_b64_tr_b16 a[18:19], v44 offset:5120
ds_read_b64_tr_b16 a[20:21], v46 offset:4096
ds_read_b64_tr_b16 a[22:23], v46 offset:5120
ds_read_b64_tr_b16 a[24:25], v45 offset:4096
ds_read_b64_tr_b16 a[26:27], v45 offset:5120
ds_read_b64_tr_b16 a[28:29], v47 offset:4096
ds_read_b64_tr_b16 a[30:31], v47 offset:5120
s_waitcnt lgkmcnt(0)
s_waitcnt vmcnt(24)
s_barrier
s_add_u32 s56, s54, 3407872
s_mov_b32 m0, 102400
s_nop 0
buffer_load_dwordx4 v26, s[16:19], s56 offen lds
s_add_u32 s56, s54, 3424256
s_mov_b32 m0, 103424
s_nop 0
buffer_load_dwordx4 v26, s[16:19], s56 offen lds
s_add_u32 s56, s54, 3440640
s_mov_b32 m0, 104448
s_nop 0
buffer_load_dwordx4 v27, s[16:19], s56 offen lds
s_add_u32 s56, s54, 3457024
s_mov_b32 m0, 105472
s_nop 0
buffer_load_dwordx4 v27, s[16:19], s56 offen lds
ds_read_b64_tr_b16 a[32:33], v44 offset:8192
ds_read_b64_tr_b16 a[34:35], v44 offset:9216
ds_read_b64_tr_b16 a[36:37], v46 offset:8192
ds_read_b64_tr_b16 a[38:39], v46 offset:9216
ds_read_b64_tr_b16 a[40:41], v45 offset:8192
ds_read_b64_tr_b16 a[42:43], v45 offset:9216
ds_read_b64_tr_b16 a[44:45], v47 offset:8192
ds_read_b64_tr_b16 a[46:47], v47 offset:9216
s_waitcnt lgkmcnt(0)
s_waitcnt vmcnt(24)
s_barrier
s_add_u32 s56, s54, 3932160
s_mov_b32 m0, 106496
s_nop 0
buffer_load_dwordx4 v26, s[16:19], s56 offen lds
s_add_u32 s56, s54, 3948544
s_mov_b32 m0, 107520
s_nop 0
buffer_load_dwordx4 v26, s[16:19], s56 offen lds
s_add_u32 s56, s54, 3964928
s_mov_b32 m0, 108544
s_nop 0
buffer_load_dwordx4 v27, s[16:19], s56 offen lds
s_add_u32 s56, s54, 3981312
s_mov_b32 m0, 109568
s_nop 0
buffer_load_dwordx4 v27, s[16:19], s56 offen lds
ds_read_b64_tr_b16 a[48:49], v44 offset:12288
ds_read_b64_tr_b16 a[50:51], v44 offset:13312
ds_read_b64_tr_b16 a[52:53], v46 offset:12288
ds_read_b64_tr_b16 a[54:55], v46 offset:13312
ds_read_b64_tr_b16 a[56:57], v45 offset:12288
ds_read_b64_tr_b16 a[58:59], v45 offset:13312
ds_read_b64_tr_b16 a[60:61], v47 offset:12288
ds_read_b64_tr_b16 a[62:63], v47 offset:13312
s_waitcnt lgkmcnt(0)
s_waitcnt vmcnt(24)
s_barrier
s_add_u32 s56, s55, 110592
s_mov_b32 m0, 110592
s_nop 0
buffer_load_dwordx4 v28, s[20:23], s56 offen lds
s_add_u32 s56, s55, 112896
s_mov_b32 m0, 111616
s_nop 0
buffer_load_dwordx4 v28, s[20:23], s56 offen lds
s_add_u32 s56, s55, 119808
s_mov_b32 m0, 112640
s_nop 0
buffer_load_dwordx4 v28, s[20:23], s56 offen lds
s_add_u32 s56, s55, 122112
s_mov_b32 m0, 113664
s_nop 0
buffer_load_dwordx4 v28, s[20:23], s56 offen lds
ds_read_b64_tr_b16 a[64:65], v44 offset:16384
ds_read_b64_tr_b16 a[66:67], v44 offset:17408
ds_read_b64_tr_b16 a[68:69], v46 offset:16384
ds_read_b64_tr_b16 a[70:71], v46 offset:17408
ds_read_b64_tr_b16 a[72:73], v45 offset:16384
ds_read_b64_tr_b16 a[74:75], v45 offset:17408
ds_read_b64_tr_b16 a[76:77], v47 offset:16384
ds_read_b64_tr_b16 a[78:79], v47 offset:17408
s_waitcnt lgkmcnt(0)
s_waitcnt vmcnt(24)
s_barrier
s_add_u32 s56, s55, 110848
s_mov_b32 m0, 114688
s_nop 0
buffer_load_dwordx4 v28, s[20:23], s56 offen lds
s_add_u32 s56, s55, 113152
s_mov_b32 m0, 115712
s_nop 0
buffer_load_dwordx4 v28, s[20:23], s56 offen lds
s_add_u32 s56, s55, 120064
s_mov_b32 m0, 116736
s_nop 0
buffer_load_dwordx4 v28, s[20:23], s56 offen lds
s_add_u32 s56, s55, 122368
s_mov_b32 m0, 117760
s_nop 0
buffer_load_dwordx4 v28, s[20:23], s56 offen lds
ds_read_b64_tr_b16 a[80:81], v44 offset:20480
ds_read_b64_tr_b16 a[82:83], v44 offset:21504
ds_read_b64_tr_b16 a[84:85], v46 offset:20480
ds_read_b64_tr_b16 a[86:87], v46 offset:21504
ds_read_b64_tr_b16 a[88:89], v45 offset:20480
ds_read_b64_tr_b16 a[90:91], v45 offset:21504
ds_read_b64_tr_b16 a[92:93], v47 offset:20480
ds_read_b64_tr_b16 a[94:95], v47 offset:21504
s_waitcnt lgkmcnt(0)
s_waitcnt vmcnt(24)
s_barrier
s_add_u32 s56, s55, 111104
s_mov_b32 m0, 118784
s_nop 0
buffer_load_dwordx4 v28, s[20:23], s56 offen lds
s_add_u32 s56, s55, 113408
s_mov_b32 m0, 119808
s_nop 0
buffer_load_dwordx4 v28, s[20:23], s56 offen lds
s_add_u32 s56, s55, 120320
s_mov_b32 m0, 120832
s_nop 0
buffer_load_dwordx4 v28, s[20:23], s56 offen lds
s_add_u32 s56, s55, 122624
s_mov_b32 m0, 121856
s_nop 0
buffer_load_dwordx4 v28, s[20:23], s56 offen lds
ds_read_b64_tr_b16 a[96:97], v44 offset:24576
ds_read_b64_tr_b16 a[98:99], v44 offset:25600
ds_read_b64_tr_b16 a[100:101], v46 offset:24576
ds_read_b64_tr_b16 a[102:103], v46 offset:25600
ds_read_b64_tr_b16 a[104:105], v45 offset:24576
ds_read_b64_tr_b16 a[106:107], v45 offset:25600
ds_read_b64_tr_b16 a[108:109], v47 offset:24576
ds_read_b64_tr_b16 a[110:111], v47 offset:25600
s_waitcnt lgkmcnt(0)
s_waitcnt vmcnt(24)
s_barrier
s_add_u32 s56, s55, 111360
s_mov_b32 m0, 122880
s_nop 0
buffer_load_dwordx4 v28, s[20:23], s56 offen lds
s_add_u32 s56, s55, 113664
s_mov_b32 m0, 123904
s_nop 0
buffer_load_dwordx4 v28, s[20:23], s56 offen lds
s_add_u32 s56, s55, 120576
s_mov_b32 m0, 124928
s_nop 0
buffer_load_dwordx4 v28, s[20:23], s56 offen lds
s_add_u32 s56, s55, 122880
s_mov_b32 m0, 125952
s_nop 0
buffer_load_dwordx4 v28, s[20:23], s56 offen lds
ds_read_b64_tr_b16 a[112:113], v44 offset:28672
ds_read_b64_tr_b16 a[114:115], v44 offset:29696
ds_read_b64_tr_b16 a[116:117], v46 offset:28672
ds_read_b64_tr_b16 a[118:119], v46 offset:29696
ds_read_b64_tr_b16 a[120:121], v45 offset:28672
ds_read_b64_tr_b16 a[122:123], v45 offset:29696
ds_read_b64_tr_b16 a[124:125], v47 offset:28672
ds_read_b64_tr_b16 a[126:127], v47 offset:29696
s_waitcnt lgkmcnt(0)
s_waitcnt vmcnt(24)
s_barrier
s_add_u32 s56, s55, 36864
s_mov_b32 m0, 126976
s_nop 0
buffer_load_dwordx4 v28, s[20:23], s56 offen lds
s_add_u32 s56, s55, 39168
s_mov_b32 m0, 128000
s_nop 0
buffer_load_dwordx4 v28, s[20:23], s56 offen lds
s_add_u32 s56, s55, 46080
s_mov_b32 m0, 129024
s_nop 0
buffer_load_dwordx4 v28, s[20:23], s56 offen lds
s_add_u32 s56, s55, 48384
s_mov_b32 m0, 130048
s_nop 0
buffer_load_dwordx4 v28, s[20:23], s56 offen lds
ds_read_b64_tr_b16 a[128:129], v44 offset:0
ds_read_b64_tr_b16 a[130:131], v44 offset:1024
ds_read_b64_tr_b16 a[132:133], v46 offset:0
ds_read_b64_tr_b16 a[134:135], v46 offset:1024
ds_read_b64_tr_b16 a[136:137], v45 offset:0
ds_read_b64_tr_b16 a[138:139], v45 offset:1024
ds_read_b64_tr_b16 a[140:141], v47 offset:0
ds_read_b64_tr_b16 a[142:143], v47 offset:1024
buffer_load_dword v32, v24, s[28:31], 0 offen sc0 sc1
s_waitcnt lgkmcnt(0)
s_waitcnt vmcnt(25)
s_barrier
s_add_u32 s56, s54, 262144
s_mov_b32 m0, 98304
s_nop 0
buffer_load_dwordx4 v26, s[8:11], s56 offen lds
s_add_u32 s56, s54, 278528
s_mov_b32 m0, 99328
s_nop 0
buffer_load_dwordx4 v26, s[8:11], s56 offen lds
s_add_u32 s56, s54, 294912
s_mov_b32 m0, 100352
s_nop 0
buffer_load_dwordx4 v27, s[8:11], s56 offen lds
s_add_u32 s56, s54, 311296
s_mov_b32 m0, 101376
s_nop 0
buffer_load_dwordx4 v27, s[8:11], s56 offen lds
ds_read_b64_tr_b16 a[144:145], v44 offset:4096
ds_read_b64_tr_b16 a[146:147], v44 offset:5120
ds_read_b64_tr_b16 a[148:149], v46 offset:4096
ds_read_b64_tr_b16 a[150:151], v46 offset:5120
ds_read_b64_tr_b16 a[152:153], v45 offset:4096
ds_read_b64_tr_b16 a[154:155], v45 offset:5120
ds_read_b64_tr_b16 a[156:157], v47 offset:4096
ds_read_b64_tr_b16 a[158:159], v47 offset:5120
s_waitcnt lgkmcnt(0)
s_waitcnt vmcnt(25)
s_barrier
s_add_u32 s56, s54, 1835008
s_mov_b32 m0, 102400
s_nop 0
buffer_load_dwordx4 v26, s[8:11], s56 offen lds
s_add_u32 s56, s54, 1851392
s_mov_b32 m0, 103424
s_nop 0
buffer_load_dwordx4 v26, s[8:11], s56 offen lds
s_add_u32 s56, s54, 1867776
s_mov_b32 m0, 104448
s_nop 0
buffer_load_dwordx4 v27, s[8:11], s56 offen lds
s_add_u32 s56, s54, 1884160
s_mov_b32 m0, 105472
s_nop 0
buffer_load_dwordx4 v27, s[8:11], s56 offen lds
ds_read_b64_tr_b16 a[160:161], v44 offset:8192
ds_read_b64_tr_b16 a[162:163], v44 offset:9216
ds_read_b64_tr_b16 a[164:165], v46 offset:8192
ds_read_b64_tr_b16 a[166:167], v46 offset:9216
ds_read_b64_tr_b16 a[168:169], v45 offset:8192
ds_read_b64_tr_b16 a[170:171], v45 offset:9216
ds_read_b64_tr_b16 a[172:173], v47 offset:8192
ds_read_b64_tr_b16 a[174:175], v47 offset:9216
s_waitcnt lgkmcnt(0)
s_waitcnt vmcnt(25)
s_barrier
s_add_u32 s56, s54, 2359296
s_mov_b32 m0, 106496
s_nop 0
buffer_load_dwordx4 v26, s[8:11], s56 offen lds
s_add_u32 s56, s54, 2375680
s_mov_b32 m0, 107520
s_nop 0
buffer_load_dwordx4 v26, s[8:11], s56 offen lds
s_add_u32 s56, s54, 2392064
s_mov_b32 m0, 108544
s_nop 0
buffer_load_dwordx4 v27, s[8:11], s56 offen lds
s_add_u32 s56, s54, 2408448
s_mov_b32 m0, 109568
s_nop 0
buffer_load_dwordx4 v27, s[8:11], s56 offen lds
ds_read_b64_tr_b16 a[176:177], v48 offset:12288
ds_read_b64_tr_b16 a[178:179], v48 offset:13312
ds_read_b64_tr_b16 a[180:181], v48 offset:14336
ds_read_b64_tr_b16 a[182:183], v48 offset:15360
ds_read_b64_tr_b16 a[216:217], v49 offset:12288
ds_read_b64_tr_b16 a[218:219], v49 offset:13312
ds_read_b64_tr_b16 a[220:221], v49 offset:14336
ds_read_b64_tr_b16 a[222:223], v49 offset:15360
s_waitcnt lgkmcnt(0)
s_waitcnt vmcnt(25)
s_barrier
s_add_u32 s56, s54, 2883584
s_mov_b32 m0, 110592
s_nop 0
buffer_load_dwordx4 v26, s[12:15], s56 offen lds
s_add_u32 s56, s54, 2899968
s_mov_b32 m0, 111616
s_nop 0
buffer_load_dwordx4 v26, s[12:15], s56 offen lds
s_add_u32 s56, s54, 2916352
s_mov_b32 m0, 112640
s_nop 0
buffer_load_dwordx4 v27, s[12:15], s56 offen lds
s_add_u32 s56, s54, 2932736
s_mov_b32 m0, 113664
s_nop 0
buffer_load_dwordx4 v27, s[12:15], s56 offen lds
ds_read_b64_tr_b16 a[184:185], v48 offset:16384
ds_read_b64_tr_b16 a[186:187], v48 offset:17408
ds_read_b64_tr_b16 a[188:189], v48 offset:18432
ds_read_b64_tr_b16 a[190:191], v48 offset:19456
ds_read_b64_tr_b16 a[232:233], v49 offset:16384
ds_read_b64_tr_b16 a[234:235], v49 offset:17408
ds_read_b64_tr_b16 a[236:237], v49 offset:18432
ds_read_b64_tr_b16 a[238:239], v49 offset:19456
s_waitcnt lgkmcnt(0)
s_waitcnt vmcnt(25)
s_barrier
s_add_u32 s56, s54, 4456448
s_mov_b32 m0, 114688
s_nop 0
buffer_load_dwordx4 v26, s[16:19], s56 offen lds
s_add_u32 s56, s54, 4472832
s_mov_b32 m0, 115712
s_nop 0
buffer_load_dwordx4 v26, s[16:19], s56 offen lds
s_add_u32 s56, s54, 4489216
s_mov_b32 m0, 116736
s_nop 0
buffer_load_dwordx4 v27, s[16:19], s56 offen lds
s_add_u32 s56, s54, 4505600
s_mov_b32 m0, 117760
s_nop 0
buffer_load_dwordx4 v27, s[16:19], s56 offen lds
ds_read_b64_tr_b16 a[192:193], v48 offset:20480
ds_read_b64_tr_b16 a[194:195], v48 offset:21504
ds_read_b64_tr_b16 a[196:197], v48 offset:22528
ds_read_b64_tr_b16 a[198:199], v48 offset:23552
ds_read_b64_tr_b16 a[240:241], v49 offset:20480
ds_read_b64_tr_b16 a[242:243], v49 offset:21504
ds_read_b64_tr_b16 a[244:245], v49 offset:22528
ds_read_b64_tr_b16 a[246:247], v49 offset:23552
s_waitcnt lgkmcnt(0)
s_waitcnt vmcnt(25)
s_barrier
s_add_u32 s56, s55, 37120
s_mov_b32 m0, 118784
s_nop 0
buffer_load_dwordx4 v28, s[20:23], s56 offen lds
s_add_u32 s56, s55, 39424
s_mov_b32 m0, 119808
s_nop 0
buffer_load_dwordx4 v28, s[20:23], s56 offen lds
s_add_u32 s56, s55, 46336
s_mov_b32 m0, 120832
s_nop 0
buffer_load_dwordx4 v28, s[20:23], s56 offen lds
s_add_u32 s56, s55, 48640
s_mov_b32 m0, 121856
s_nop 0
buffer_load_dwordx4 v28, s[20:23], s56 offen lds
ds_read_b64_tr_b16 a[200:201], v48 offset:24576
ds_read_b64_tr_b16 a[202:203], v48 offset:25600
ds_read_b64_tr_b16 a[204:205], v48 offset:26624
ds_read_b64_tr_b16 a[206:207], v48 offset:27648
ds_read_b64_tr_b16 a[248:249], v49 offset:24576
ds_read_b64_tr_b16 a[250:251], v49 offset:25600
ds_read_b64_tr_b16 a[252:253], v49 offset:26624
ds_read_b64_tr_b16 a[254:255], v49 offset:27648
s_waitcnt lgkmcnt(0)
s_waitcnt vmcnt(25)
s_barrier
s_add_u32 s56, s55, 37376
s_mov_b32 m0, 122880
s_nop 0
buffer_load_dwordx4 v28, s[20:23], s56 offen lds
s_add_u32 s56, s55, 39680
s_mov_b32 m0, 123904
s_nop 0
buffer_load_dwordx4 v28, s[20:23], s56 offen lds
s_add_u32 s56, s55, 46592
s_mov_b32 m0, 124928
s_nop 0
buffer_load_dwordx4 v28, s[20:23], s56 offen lds
s_add_u32 s56, s55, 48896
s_mov_b32 m0, 125952
s_nop 0
buffer_load_dwordx4 v28, s[20:23], s56 offen lds
ds_read_b64_tr_b16 a[208:209], v48 offset:28672
ds_read_b64_tr_b16 a[210:211], v48 offset:29696
ds_read_b64_tr_b16 a[212:213], v48 offset:30720
ds_read_b64_tr_b16 a[214:215], v48 offset:31744
ds_read_b64_tr_b16 a[224:225], v49 offset:28672
ds_read_b64_tr_b16 a[226:227], v49 offset:29696
ds_read_b64_tr_b16 a[228:229], v49 offset:30720
ds_read_b64_tr_b16 a[230:231], v49 offset:31744
s_waitcnt lgkmcnt(0)
s_waitcnt vmcnt(24)
s_barrier
s_add_u32 s56, s55, 37632
s_mov_b32 m0, 126976
s_nop 0
buffer_load_dwordx4 v28, s[20:23], s56 offen lds
s_add_u32 s56, s55, 39936
s_mov_b32 m0, 128000
s_nop 0
buffer_load_dwordx4 v28, s[20:23], s56 offen lds
s_add_u32 s56, s55, 46848
s_mov_b32 m0, 129024
s_nop 0
buffer_load_dwordx4 v28, s[20:23], s56 offen lds
s_add_u32 s56, s55, 49152
s_mov_b32 m0, 130048
s_nop 0
buffer_load_dwordx4 v28, s[20:23], s56 offen lds
ds_read_b64_tr_b16 v[60:61], v44 offset:0
ds_read_b64_tr_b16 v[62:63], v44 offset:1024
ds_read_b64_tr_b16 v[64:65], v46 offset:0
ds_read_b64_tr_b16 v[66:67], v46 offset:1024
ds_read_b64_tr_b16 v[68:69], v45 offset:0
ds_read_b64_tr_b16 v[70:71], v45 offset:1024
ds_read_b64_tr_b16 v[72:73], v47 offset:0
ds_read_b64_tr_b16 v[74:75], v47 offset:1024
s_waitcnt lgkmcnt(0)
s_waitcnt vmcnt(24)
s_barrier
ds_write_b128 v2, v[60:63] offset:0
ds_write_b128 v2, v[64:67] offset:1024
ds_write_b128 v2, v[68:71] offset:2048
ds_write_b128 v2, v[72:75] offset:3072
ds_read_b64_tr_b16 v[60:61], v44 offset:4096
ds_read_b64_tr_b16 v[62:63], v44 offset:5120
ds_read_b64_tr_b16 v[64:65], v46 offset:4096
ds_read_b64_tr_b16 v[66:67], v46 offset:5120
ds_read_b64_tr_b16 v[68:69], v45 offset:4096
ds_read_b64_tr_b16 v[70:71], v45 offset:5120
ds_read_b64_tr_b16 v[72:73], v47 offset:4096
ds_read_b64_tr_b16 v[74:75], v47 offset:5120
L_rdv_w2r:
v_readfirstlane_b32 s38, v32
s_nop 0
s_and_b32 s57, s38, 0xff
s_cmp_lg_u32 s57, 32
s_cbranch_scc1 L_rdv2_w2r
s_waitcnt lgkmcnt(0)
s_waitcnt vmcnt(20)
s_barrier
ds_write_b128 v2, v[60:63] offset:4096
ds_write_b128 v2, v[64:67] offset:5120
ds_write_b128 v2, v[68:71] offset:6144
ds_write_b128 v2, v[72:75] offset:7168
ds_read_b64_tr_b16 v[60:61], v44 offset:8192
ds_read_b64_tr_b16 v[62:63], v44 offset:9216
ds_read_b64_tr_b16 v[64:65], v46 offset:8192
ds_read_b64_tr_b16 v[66:67], v46 offset:9216
ds_read_b64_tr_b16 v[68:69], v45 offset:8192
ds_read_b64_tr_b16 v[70:71], v45 offset:9216
ds_read_b64_tr_b16 v[72:73], v47 offset:8192
ds_read_b64_tr_b16 v[74:75], v47 offset:9216
buffer_load_dwordx4 v[12:15], v9, s[4:7], s37 offen offset:0
buffer_load_dwordx4 v[16:19], v9, s[4:7], s37 offen offset:1024
buffer_load_dwordx4 v[52:55], v1, s[4:7], s37 offen offset:2048
buffer_load_dwordx4 v[56:59], v1, s[4:7], s37 offen offset:3072
s_mov_b32 m0, 1024
s_nop 0
buffer_load_dwordx4 v1, s[4:7], s47 offen offset:2048 sc1 lds
s_mov_b32 s56, 304128
buffer_load_dword v33, v24, s[4:7], s56 offen sc1
buffer_load_dword v33, v1, s[4:7], s3 offen offset:0 sc1
buffer_load_dword v33, v1, s[4:7], s3 offen offset:1024 sc1
buffer_load_dword v33, v1, s[4:7], s3 offen offset:2048 sc1
buffer_load_dword v33, v1, s[4:7], s3 offen offset:3072 sc1
s_waitcnt lgkmcnt(0)
s_waitcnt vmcnt(26)
s_barrier
ds_write_b128 v2, v[60:63] offset:8192
ds_write_b128 v2, v[64:67] offset:9216
ds_write_b128 v2, v[68:71] offset:10240
ds_write_b128 v2, v[72:75] offset:11264
ds_read_b64_tr_b16 v[60:61], v44 offset:12288
ds_read_b64_tr_b16 v[62:63], v44 offset:13312
ds_read_b64_tr_b16 v[64:65], v46 offset:12288
ds_read_b64_tr_b16 v[66:67], v46 offset:13312
ds_read_b64_tr_b16 v[68:69], v45 offset:12288
ds_read_b64_tr_b16 v[70:71], v45 offset:13312
ds_read_b64_tr_b16 v[72:73], v47 offset:12288
ds_read_b64_tr_b16 v[74:75], v47 offset:13312
s_waitcnt lgkmcnt(0)
s_waitcnt vmcnt(22)
s_barrier
ds_write_b128 v2, v[60:63] offset:12288
ds_write_b128 v2, v[64:67] offset:13312
ds_write_b128 v2, v[68:71] offset:14336
ds_write_b128 v2, v[72:75] offset:15360
ds_read_b64_tr_b16 v[60:61], v44 offset:16384
ds_read_b64_tr_b16 v[62:63], v44 offset:17408
ds_read_b64_tr_b16 v[64:65], v46 offset:16384
ds_read_b64_tr_b16 v[66:67], v46 offset:17408
ds_read_b64_tr_b16 v[68:69], v45 offset:16384
ds_read_b64_tr_b16 v[70:71], v45 offset:17408
ds_read_b64_tr_b16 v[72:73], v47 offset:16384
ds_read_b64_tr_b16 v[74:75], v47 offset:17408
s_waitcnt lgkmcnt(0)
s_waitcnt vmcnt(18)
s_barrier
ds_write_b128 v2, v[60:63] offset:16384
ds_write_b128 v2, v[64:67] offset:17408
ds_write_b128 v2, v[68:71] offset:18432
ds_write_b128 v2, v[72:75] offset:19456
ds_read_b64_tr_b16 v[60:61], v48 offset:20480
ds_read_b64_tr_b16 v[62:63], v48 offset:21504
ds_read_b64_tr_b16 v[64:65], v48 offset:22528
ds_read_b64_tr_b16 v[66:67], v48 offset:23552
ds_read_b64_tr_b16 v[68:69], v49 offset:20480
ds_read_b64_tr_b16 v[70:71], v49 offset:21504
ds_read_b64_tr_b16 v[72:73], v49 offset:22528
ds_read_b64_tr_b16 v[74:75], v49 offset:23552
s_waitcnt lgkmcnt(0)
s_waitcnt vmcnt(14)
s_barrier
ds_write_b128 v2, v[60:63] offset:20480
ds_write_b128 v2, v[64:67] offset:21504
ds_write_b128 v2, v[68:71] offset:22528
ds_write_b128 v2, v[72:75] offset:23552
ds_read_b64_tr_b16 v[60:61], v48 offset:24576
ds_read_b64_tr_b16 v[62:63], v48 offset:25600
ds_read_b64_tr_b16 v[64:65], v48 offset:26624
ds_read_b64_tr_b16 v[66:67], v48 offset:27648
ds_read_b64_tr_b16 v[68:69], v49 offset:24576
ds_read_b64_tr_b16 v[70:71], v49 offset:25600
ds_read_b64_tr_b16 v[72:73], v49 offset:26624
ds_read_b64_tr_b16 v[74:75], v49 offset:27648
s_waitcnt lgkmcnt(0)
s_waitcnt vmcnt(10)
s_barrier
ds_write_b128 v2, v[60:63] offset:24576
ds_write_b128 v2, v[64:67] offset:25600
ds_write_b128 v2, v[68:71] offset:26624
ds_write_b128 v2, v[72:75] offset:27648
ds_read_b64_tr_b16 v[60:61], v48 offset:28672
ds_read_b64_tr_b16 v[62:63], v48 offset:29696
ds_read_b64_tr_b16 v[64:65], v48 offset:30720
ds_read_b64_tr_b16 v[66:67], v48 offset:31744
ds_read_b64_tr_b16 v[68:69], v49 offset:28672
ds_read_b64_tr_b16 v[70:71], v49 offset:29696
ds_read_b64_tr_b16 v[72:73], v49 offset:30720
ds_read_b64_tr_b16 v[74:75], v49 offset:31744
s_waitcnt lgkmcnt(0)
s_barrier
ds_write_b128 v2, v[60:63] offset:28672
ds_write_b128 v2, v[64:67] offset:29696
ds_write_b128 v2, v[68:71] offset:30720
ds_write_b128 v2, v[72:75] offset:31744
s_lshl_b32 s57, s58, 5
s_mov_b32 s0, 0x3f003f00
s_mov_b32 s1, 0x3f003f00
s_mov_b32 s58, 304128
s_cmp_eq_u32 s38, s57
s_mov_b32 s56, 0x33333333
s_mov_b32 s57, 0x33333333
s_mov_b32 s2, 0x21800000
s_mov_b32 s55, -24
s_cbranch_scc0 L_slow_w2r
v_mov_b64 v[20:21], 0
v_mov_b64 v[22:23], 0
v_mov_b64 v[24:25], 0
v_mov_b64 v[26:27], 0
v_mov_b64 v[28:29], 0
v_mov_b64 v[30:31], 0
v_mov_b64 v[32:33], 0
v_mov_b64 v[34:35], 0
v_mov_b64 v[36:37], 0
v_mov_b64 v[38:39], 0
v_mov_b64 v[40:41], 0
v_mov_b64 v[42:43], 0
ds_read_b128 v[44:47], v2 offset:0
ds_read_b128 v[48:51], v2 offset:1024
v_bfe_u32 v77, v1, 6, 1
v_lshl_add_u32 v77, v77, 3, v1
v_lshlrev_b32 v77, 1, v77
s_waitcnt vmcnt(0) lgkmcnt(0)
s_branch L_top_w2rf
L_done_w2rf:
s_mul_i32 s40, s34, 10240
s_add_u32 s40, s40, 8093696
buffer_store_dword v11, v10, s[4:7], s40 offen sc0 sc1
s_waitcnt vmcnt(0) lgkmcnt(0)
s_endpgm
L_rdv2_w2r:
buffer_load_dword v32, v24, s[28:31], 0 offen sc0 sc1
s_sub_u32 s41, s41, 1
s_cbranch_scc1 L_exit
s_waitcnt vmcnt(0)
s_branch L_rdv_w2r
L_ra0_w2rf:
s_mov_b32 m0, 1024
s_nop 0
buffer_load_dwordx4 v1, s[4:7], s47 offen offset:0 sc1 lds
buffer_load_dwordx4 v1, s[4:7], s47 offen offset:1024 sc1 lds
buffer_load_dwordx4 v1, s[4:7], s47 offen offset:2048 sc1 lds
buffer_load_dwordx4 v1, s[4:7], s47 offen offset:3072 sc1 lds
s_sub_u32 s41, s41, 1
s_cbranch_scc1 L_exit
ds_read_b128 v[44:47], v2 offset:0
ds_read_b128 v[48:51], v2 offset:1024
v_mov_b64 v[20:21], 0
v_mov_b64 v[22:23], 0
v_mov_b64 v[24:25], 0
v_mov_b64 v[26:27], 0
v_mov_b64 v[28:29], 0
v_mov_b64 v[30:31], 0
v_mov_b64 v[32:33], 0
v_mov_b64 v[34:35], 0
v_mov_b64 v[36:37], 0
v_mov_b64 v[38:39], 0
v_mov_b64 v[40:41], 0
v_mov_b64 v[42:43], 0
s_waitcnt vmcnt(0)
ds_read_b128 v[60:63], v1 offset:1024
ds_read_b128 v[64:67], v1 offset:2048
ds_read_b128 v[68:71], v1 offset:3072
ds_read_b128 v[72:75], v1 offset:4096
s_branch L_s0_w2rf
L_ra1_w2rf:
L_ra2_w2rf:
s_waitcnt lgkmcnt(0)
s_barrier
s_mov_b32 m0, 5120
s_nop 0
buffer_load_dwordx4 v1, s[4:7], s48 offen offset:2048 sc1 lds
s_sub_u32 s41, s41, 1
s_cbranch_scc1 L_exit
s_waitcnt vmcnt(0)
s_barrier
ds_read_b128 v[76:79], v1 offset:5120
ds_read_b128 v[60:63], v1 offset:6144
ds_read_b128 v[64:67], v1 offset:7168
ds_read_b128 v[68:71], v1 offset:8192
ds_read_b128 v[72:75], v1 offset:9216
s_waitcnt lgkmcnt(0)
v_bitop3_b32 v6, v76, v60, s35 bitop3:0x7e
v_bitop3_b32 v6, v6, v64, s35 bitop3:0xf6
v_bitop3_b32 v6, v6, v68, s35 bitop3:0xf6
v_bitop3_b32 v6, v6, v72, s35 bitop3:0xf6
v_and_b32 v6, 1, v6
v_cmp_ne_u32 vcc, 0, v6
s_mov_b32 m0, 0
v_lshlrev_b32 v6, 3, v1
s_cbranch_vccnz L_ra2_w2rf
s_branch L_a1_w2rf
L_mx_w2rf:
s_waitcnt lgkmcnt(0)
v_max3_f32 v30, v12, v13, v28
v_max_f32 v30, v30, v29
v_mov_b32 v31, v30
s_nop 1
v_permlane16_swap_b32 v30, v31
v_max_f32 v30, v30, v31
v_mov_b32 v31, v30
s_nop 1
v_permlane32_swap_b32 v30, v31
v_max_f32 v30, v30, v31
ds_write_b32 v1, v30 offset:10248
s_waitcnt lgkmcnt(0)
s_barrier
ds_read_b128 v[32:35], v1 offset:10240
s_waitcnt lgkmcnt(0)
v_max3_f32 v32, v32, v33, v34
v_max_f32 v32, v32, v35
v_sub_f32 v14, v12, v32
v_sub_f32 v15, v13, v32
v_sub_f32 v30, v28, v32
v_sub_f32 v31, v29, v32
v_exp_f32 v14, v14
v_exp_f32 v15, v15
v_exp_f32 v30, v30
v_exp_f32 v31, v31
v_cvt_pk_bf16_f32 v14, v14, v15
v_cvt_pk_bf16_f32 v30, v30, v31
ds_write_b32 v5, v14 offset:14880
v_cndmask_b32_e64 v26, 0, v30, s[56:57]
v_cndmask_b32_e64 v27, 0, v30, s[56:57]
v_mov_b64 v[76:77], s[52:53]
v_mov_b64 v[78:79], s[52:53]
v_mov_b32_dpp v24, v26 quad_perm:[2,3,0,1] row_mask:0xf bank_mask:0xf
v_mov_b32_dpp v25, v26 quad_perm:[2,3,0,1] row_mask:0xf bank_mask:0xf
s_waitcnt lgkmcnt(0)
s_barrier
v_mov_b64 v[14:15], s[0:1]
ds_read_b128 v[16:19], v1 offset:14368
ds_read_b128 v[36:39], v1 offset:14336
s_waitcnt lgkmcnt(0)
v_mfma_f32_16x16x32_bf16 v[32:35], v[76:79], v[16:19], 0
v_mfma_f32_16x16x32_bf16 v[20:23], v[52:55], v[16:19], 0
v_mfma_f32_16x16x32_bf16 v[20:23], v[56:59], v[36:39], v[20:23]
v_mfma_f32_16x16x16_bf16 v[32:35], v[14:15], v[26:27], v[32:35]
v_mfma_f32_16x16x32_bf16 v[20:23], v[40:43], v[24:27], v[20:23]
s_nop 3
v_rcp_f32 v33, v32
s_nop 2
v_mul_f32_dpp v20, v33, v20 quad_perm:[0,1,0,1] row_mask:0xf bank_mask:0xf
v_mul_f32_dpp v21, v33, v21 quad_perm:[0,1,0,1] row_mask:0xf bank_mask:0xf
v_mul_f32_dpp v22, v33, v22 quad_perm:[0,1,0,1] row_mask:0xf bank_mask:0xf
v_mul_f32_dpp v23, v33, v23 quad_perm:[0,1,0,1] row_mask:0xf bank_mask:0xf
v_cvt_pk_bf16_f32 v20, v20, v21
v_cvt_pk_bf16_f32 v21, v22, v23
ds_write_b64 v6, v[20:21] offset:7168
v_mov_b32_dpp v16, v20 quad_perm:[0,1,0,1] row_mask:0xf bank_mask:0xf
v_mov_b32_dpp v17, v21 quad_perm:[0,1,0,1] row_mask:0xf bank_mask:0xf
v_mov_b32_dpp v18, v20 quad_perm:[2,3,2,3] row_mask:0xf bank_mask:0xf
v_mov_b32_dpp v19, v21 quad_perm:[2,3,2,3] row_mask:0xf bank_mask:0xf
v_mov_b64 v[76:77], 0
v_mov_b64 v[78:79], 0
v_mov_b64 v[36:37], 0
v_mov_b64 v[38:39], 0
v_mov_b64 v[24:25], 0
v_mov_b64 v[26:27], 0
v_mov_b64 v[32:33], 0
v_mov_b64 v[34:35], 0
s_waitcnt lgkmcnt(0)
s_branch L_mxb_w2rf

L_rr_w2rf:
buffer_load_dwordx4 v[60:63], v9, s[4:7], s3 offen offset:0 sc1
buffer_load_dwordx4 v[64:67], v9, s[4:7], s3 offen offset:1024 sc1
buffer_load_dwordx4 v[68:71], v9, s[4:7], s3 offen offset:2048 sc1
buffer_load_dwordx4 v[72:75], v9, s[4:7], s3 offen offset:3072 sc1
s_sub_u32 s41, s41, 1
s_cbranch_scc1 L_exit
s_waitcnt vmcnt(0)
s_branch L_r_w2rf
L_slow_w2r:
v_mov_b64 v[20:21], 0
v_mov_b64 v[22:23], 0
v_mov_b64 v[24:25], 0
v_mov_b64 v[26:27], 0
v_mov_b64 v[28:29], 0
v_mov_b64 v[30:31], 0
v_mov_b64 v[32:33], 0
v_mov_b64 v[34:35], 0
v_mov_b64 v[36:37], 0
v_mov_b64 v[38:39], 0
v_mov_b64 v[40:41], 0
v_mov_b64 v[42:43], 0
ds_read_b128 v[44:47], v2 offset:0
ds_read_b128 v[48:51], v2 offset:1024
v_bfe_u32 v77, v1, 6, 1
v_lshl_add_u32 v77, v77, 3, v1
v_lshlrev_b32 v77, 1, v77
s_waitcnt vmcnt(0) lgkmcnt(0)
s_branch L_top_w2rs
L_done_w2rs:
s_mul_i32 s40, s34, 10240
s_add_u32 s40, s40, 8093696
buffer_store_dword v11, v10, s[4:7], s40 offen sc0 sc1
s_waitcnt vmcnt(0) lgkmcnt(0)
s_endpgm
L_ra0_w2rs:
s_mov_b32 m0, 1024
s_nop 0
buffer_load_dwordx4 v1, s[4:7], s47 offen offset:0 sc0 sc1 lds
buffer_load_dwordx4 v1, s[4:7], s47 offen offset:1024 sc0 sc1 lds
buffer_load_dwordx4 v1, s[4:7], s47 offen offset:2048 sc0 sc1 lds
buffer_load_dwordx4 v1, s[4:7], s47 offen offset:3072 sc0 sc1 lds
s_sub_u32 s41, s41, 1
s_cbranch_scc1 L_exit
ds_read_b128 v[44:47], v2 offset:0
ds_read_b128 v[48:51], v2 offset:1024
v_mov_b64 v[20:21], 0
v_mov_b64 v[22:23], 0
v_mov_b64 v[24:25], 0
v_mov_b64 v[26:27], 0
v_mov_b64 v[28:29], 0
v_mov_b64 v[30:31], 0
v_mov_b64 v[32:33], 0
v_mov_b64 v[34:35], 0
v_mov_b64 v[36:37], 0
v_mov_b64 v[38:39], 0
v_mov_b64 v[40:41], 0
v_mov_b64 v[42:43], 0
s_waitcnt vmcnt(0)
ds_read_b128 v[60:63], v1 offset:1024
ds_read_b128 v[64:67], v1 offset:2048
ds_read_b128 v[68:71], v1 offset:3072
ds_read_b128 v[72:75], v1 offset:4096
s_branch L_s0_w2rs
L_ra1_w2rs:
L_ra2_w2rs:
s_waitcnt lgkmcnt(0)
s_barrier
s_mov_b32 m0, 5120
s_nop 0
buffer_load_dwordx4 v1, s[4:7], s48 offen offset:2048 sc0 sc1 lds
s_sub_u32 s41, s41, 1
s_cbranch_scc1 L_exit
s_waitcnt vmcnt(0)
s_barrier
ds_read_b128 v[76:79], v1 offset:5120
ds_read_b128 v[60:63], v1 offset:6144
ds_read_b128 v[64:67], v1 offset:7168
ds_read_b128 v[68:71], v1 offset:8192
ds_read_b128 v[72:75], v1 offset:9216
s_waitcnt lgkmcnt(0)
v_bitop3_b32 v6, v76, v60, s35 bitop3:0x7e
v_bitop3_b32 v6, v6, v64, s35 bitop3:0xf6
v_bitop3_b32 v6, v6, v68, s35 bitop3:0xf6
v_bitop3_b32 v6, v6, v72, s35 bitop3:0xf6
v_and_b32 v6, 1, v6
v_cmp_ne_u32 vcc, 0, v6
s_mov_b32 m0, 0
v_lshlrev_b32 v6, 3, v1
s_cbranch_vccnz L_ra2_w2rs
s_branch L_a1_w2rs
L_mx_w2rs:
s_waitcnt lgkmcnt(0)
v_max3_f32 v30, v12, v13, v28
v_max_f32 v30, v30, v29
v_mov_b32 v31, v30
s_nop 1
v_permlane16_swap_b32 v30, v31
v_max_f32 v30, v30, v31
v_mov_b32 v31, v30
s_nop 1
v_permlane32_swap_b32 v30, v31
v_max_f32 v30, v30, v31
ds_write_b32 v1, v30 offset:10248
s_waitcnt lgkmcnt(0)
s_barrier
ds_read_b128 v[32:35], v1 offset:10240
s_waitcnt lgkmcnt(0)
v_max3_f32 v32, v32, v33, v34
v_max_f32 v32, v32, v35
v_sub_f32 v14, v12, v32
v_sub_f32 v15, v13, v32
v_sub_f32 v30, v28, v32
v_sub_f32 v31, v29, v32
v_exp_f32 v14, v14
v_exp_f32 v15, v15
v_exp_f32 v30, v30
v_exp_f32 v31, v31
v_cvt_pk_bf16_f32 v14, v14, v15
v_cvt_pk_bf16_f32 v30, v30, v31
ds_write_b32 v5, v14 offset:14880
v_cndmask_b32_e64 v26, 0, v30, s[56:57]
v_cndmask_b32_e64 v27, 0, v30, s[56:57]
v_mov_b64 v[76:77], s[52:53]
v_mov_b64 v[78:79], s[52:53]
v_mov_b32_dpp v24, v26 quad_perm:[2,3,0,1] row_mask:0xf bank_mask:0xf
v_mov_b32_dpp v25, v26 quad_perm:[2,3,0,1] row_mask:0xf bank_mask:0xf
s_waitcnt lgkmcnt(0)
s_barrier
v_mov_b64 v[14:15], s[0:1]
ds_read_b128 v[16:19], v1 offset:14368
ds_read_b128 v[36:39], v1 offset:14336
s_waitcnt lgkmcnt(0)
v_mfma_f32_16x16x32_bf16 v[32:35], v[76:79], v[16:19], 0
v_mfma_f32_16x16x32_bf16 v[20:23], v[52:55], v[16:19], 0
v_mfma_f32_16x16x32_bf16 v[20:23], v[56:59], v[36:39], v[20:23]
v_mfma_f32_16x16x16_bf16 v[32:35], v[14:15], v[26:27], v[32:35]
v_mfma_f32_16x16x32_bf16 v[20:23], v[40:43], v[24:27], v[20:23]
s_nop 3
v_rcp_f32 v33, v32
s_nop 2
v_mul_f32_dpp v20, v33, v20 quad_perm:[0,1,0,1] row_mask:0xf bank_mask:0xf
v_mul_f32_dpp v21, v33, v21 quad_perm:[0,1,0,1] row_mask:0xf bank_mask:0xf
v_mul_f32_dpp v22, v33, v22 quad_perm:[0,1,0,1] row_mask:0xf bank_mask:0xf
v_mul_f32_dpp v23, v33, v23 quad_perm:[0,1,0,1] row_mask:0xf bank_mask:0xf
v_cvt_pk_bf16_f32 v20, v20, v21
v_cvt_pk_bf16_f32 v21, v22, v23
ds_write_b64 v6, v[20:21] offset:7168
v_mov_b32_dpp v16, v20 quad_perm:[0,1,0,1] row_mask:0xf bank_mask:0xf
v_mov_b32_dpp v17, v21 quad_perm:[0,1,0,1] row_mask:0xf bank_mask:0xf
v_mov_b32_dpp v18, v20 quad_perm:[2,3,2,3] row_mask:0xf bank_mask:0xf
v_mov_b32_dpp v19, v21 quad_perm:[2,3,2,3] row_mask:0xf bank_mask:0xf
v_mov_b64 v[76:77], 0
v_mov_b64 v[78:79], 0
v_mov_b64 v[36:37], 0
v_mov_b64 v[38:39], 0
v_mov_b64 v[24:25], 0
v_mov_b64 v[26:27], 0
v_mov_b64 v[32:33], 0
v_mov_b64 v[34:35], 0
s_waitcnt lgkmcnt(0)
s_branch L_mxb_w2rs

L_rr_w2rs:
buffer_load_dwordx4 v[60:63], v9, s[4:7], s3 offen offset:0 sc0 sc1
buffer_load_dwordx4 v[64:67], v9, s[4:7], s3 offen offset:1024 sc0 sc1
buffer_load_dwordx4 v[68:71], v9, s[4:7], s3 offen offset:2048 sc0 sc1
buffer_load_dwordx4 v[72:75], v9, s[4:7], s3 offen offset:3072 sc0 sc1
s_sub_u32 s41, s41, 1
s_cbranch_scc1 L_exit
s_waitcnt vmcnt(0)
s_branch L_r_w2rs
L_pro_w3:
v_and_b32 v20, 63, v0
v_lshlrev_b32 v1, 4, v20
v_add_u32 v2, 131072, v1
v_and_b32 v23, 1, v22
v_lshl_add_u32 v23, v24, 4, v23
v_mul_u32_u24 v23, 1152, v23
v_lshlrev_b32 v28, 2, v22
v_xor_b32 v28, v28, v21
v_lshl_add_u32 v28, v28, 4, v23
s_mul_i32 s55, s32, 147456
s_waitcnt lgkmcnt(0)
v_and_b32 v23, 1, v22
v_lshrrev_b32 v24, 2, v21
v_lshl_add_u32 v23, v23, 2, v24
v_lshlrev_b32 v23, 1, v23
v_bfe_u32 v44, v21, 1, 1
v_add_u32 v44, 12, v44
v_xor_b32 v44, v44, v23
v_lshlrev_b32 v44, 4, v44
v_lshl_add_u32 v44, v24, 8, v44
v_and_b32 v23, 1, v22
v_lshl_add_u32 v44, v23, 11, v44
v_and_b32 v23, 1, v21
v_lshl_add_u32 v44, v23, 3, v44
v_lshrrev_b32 v23, 1, v22
v_mul_u32_u24 v23, 40960, v23
v_add_u32 v23, 16384, v23
v_add_u32 v44, v44, v23
v_and_b32 v23, 1, v22
v_lshrrev_b32 v24, 2, v21
v_lshl_add_u32 v23, v23, 2, v24
v_lshlrev_b32 v23, 1, v23
v_bfe_u32 v45, v21, 1, 1
v_add_u32 v45, 14, v45
v_xor_b32 v45, v45, v23
v_lshlrev_b32 v45, 4, v45
v_lshl_add_u32 v45, v24, 8, v45
v_and_b32 v23, 1, v22
v_lshl_add_u32 v45, v23, 11, v45
v_and_b32 v23, 1, v21
v_lshl_add_u32 v45, v23, 3, v45
v_lshrrev_b32 v23, 1, v22
v_mul_u32_u24 v23, 40960, v23
v_add_u32 v23, 16384, v23
v_add_u32 v45, v45, v23
v_and_b32 v23, 1, v22
v_lshrrev_b32 v24, 2, v21
v_lshl_add_u32 v23, v23, 2, v24
v_lshlrev_b32 v23, 1, v23
v_bfe_u32 v46, v21, 1, 1
v_add_u32 v46, 12, v46
v_xor_b32 v46, v46, v23
v_lshlrev_b32 v46, 4, v46
v_lshl_add_u32 v46, v24, 8, v46
v_and_b32 v23, 1, v22
v_lshl_add_u32 v46, v23, 11, v46
v_and_b32 v23, 1, v21
v_lshl_add_u32 v46, v23, 3, v46
v_lshrrev_b32 v23, 1, v22
v_mul_u32_u24 v23, 32768, v23
v_add_u32 v23, 98304, v23
v_add_u32 v46, v46, v23
v_and_b32 v23, 1, v22
v_lshrrev_b32 v24, 2, v21
v_lshl_add_u32 v23, v23, 2, v24
v_lshlrev_b32 v23, 1, v23
v_bfe_u32 v47, v21, 1, 1
v_add_u32 v47, 14, v47
v_xor_b32 v47, v47, v23
v_lshlrev_b32 v47, 4, v47
v_lshl_add_u32 v47, v24, 8, v47
v_and_b32 v23, 1, v22
v_lshl_add_u32 v47, v23, 11, v47
v_and_b32 v23, 1, v21
v_lshl_add_u32 v47, v23, 3, v47
v_lshrrev_b32 v23, 1, v22
v_mul_u32_u24 v23, 32768, v23
v_add_u32 v23, 98304, v23
v_add_u32 v47, v47, v23
v_and_b32 v23, 1, v22
v_bfe_u32 v24, v21, 2, 1
v_lshl_add_u32 v23, v23, 1, v24
v_xor_b32 v24, 3, v23
v_lshlrev_b32 v24, 6, v24
v_lshl_add_u32 v48, v23, 8, v24
v_and_b32 v23, 3, v21
v_lshl_add_u32 v48, v23, 4, v48
v_and_b32 v23, 8, v21
v_add_u32 v48, v48, v23
v_lshrrev_b32 v23, 1, v22
v_mul_u32_u24 v23, 40960, v23
v_add_u32 v23, 16384, v23
v_add_u32 v48, v48, v23
v_and_b32 v23, 1, v22
v_bfe_u32 v24, v21, 2, 1
v_lshl_add_u32 v23, v23, 1, v24
v_xor_b32 v24, 3, v23
v_lshlrev_b32 v24, 6, v24
v_lshl_add_u32 v49, v23, 8, v24
v_and_b32 v23, 3, v21
v_lshl_add_u32 v49, v23, 4, v49
v_and_b32 v23, 8, v21
v_add_u32 v49, v49, v23
v_lshrrev_b32 v23, 1, v22
v_mul_u32_u24 v23, 32768, v23
v_add_u32 v23, 98304, v23
v_add_u32 v49, v49, v23
v_bfe_u32 v23, v21, 1, 1
v_mul_u32_u24 v23, 0xaaaa, v23
v_add_u32 v0, 0x4444, v23
v_lshlrev_b32 v3, 3, v20
v_lshrrev_b32 v25, 5, v20
v_lshlrev_b32 v25, 6, v25
v_xor_b32 v3, v3, v25
v_lshrrev_b32 v25, 2, v20
v_and_b32 v4, 3, v21
v_lshl_add_u32 v4, v4, 4, v25
v_lshlrev_b32 v4, 3, v4
v_bfe_u32 v25, v21, 1, 1
v_lshlrev_b32 v23, 6, v25
v_xor_b32 v4, v4, v23
v_lshlrev_b32 v5, 4, v21
v_lshl_add_u32 v5, v22, 2, v5
v_mul_u32_u24 v23, 256, v25
v_add_u32 v5, v5, v23
v_lshlrev_b32 v9, 8, v22
v_lshl_add_u32 v9, v25, 6, v9
v_bfe_u32 v23, v21, 3, 1
v_lshl_add_u32 v9, v23, 7, v9
v_bfe_u32 v23, v21, 2, 1
v_lshl_add_u32 v9, v23, 5, v9
v_and_b32 v23, 1, v21
v_lshl_add_u32 v9, v23, 4, v9
v_lshrrev_b32 v23, 1, v22
v_and_b32 v24, 1, v22
v_and_b32 v25, 7, v21
v_lshrrev_b32 v7, 3, v21
v_lshl_add_u32 v8, v7, 1, v23
v_lshlrev_b32 v8, 12, v8
v_lshl_add_u32 v8, v24, 7, v8
v_and_b32 v25, 4, v21
v_lshl_add_u32 v8, v25, 3, v8
v_and_b32 v25, 1, v21
v_lshl_add_u32 v8, v25, 4, v8
v_bfe_u32 v25, v21, 1, 1
v_lshl_add_u32 v8, v25, 3, v8
s_lshr_b32 s56, s32, 1
s_lshl_b32 s56, s56, 8
s_and_b32 s57, s32, 1
s_lshl_b32 s57, s57, 6
s_add_u32 s56, s56, s57
s_add_u32 s56, s56, 49152
v_add_u32 v8, s56, v8
v_and_b32 v7, 0x3d0, v1
s_mov_b32 s42, 0
s_mov_b32 s43, 65536
s_mov_b32 s44, 131072
s_mov_b32 s45, 196608
s_mov_b32 s46, 262144
s_mov_b32 s47, 294912
s_mov_b32 s48, 299008
s_mov_b32 s49, 303104
s_mov_b32 s50, 0x3e0293ee
s_mov_b32 s51, 0x3e0293ee
s_mov_b32 s52, 0x3f803f80
s_mov_b32 s53, 0x3f803f80
v_and_b32 v11, 3, v21
v_cmp_eq_u32 vcc, 0, v11
s_nop 1
v_cndmask_b32 v11, 0, 1, vcc
s_mov_b32 s34, 0
s_mov_b32 s35, -1
s_mov_b32 s36, 0
s_mov_b32 s41, 300000
s_lshl_b32 s37, s32, 14
s_add_u32 s39, s37, 17309696
s_add_u32 s37, s37, 16789504
s_mov_b32 s40, 8749056
v_mov_b64 v[36:37], 0
v_mov_b64 v[38:39], 0
s_lshl_b32 s56, s32, 1
s_add_u32 s56, s56, 1
s_cmp_eq_u32 s56, 0
s_cselect_b32 s56, 64, s56
s_mul_i32 s56, s56, 10240
s_add_u32 s56, s56, 8392704
s_add_u32 s57, s56, 4096
v_mov_b32 v40, 1
v_mov_b32 v41, 1
v_mov_b32 v42, 1
v_mov_b32 v43, 1
buffer_store_dwordx4 v[40:43], v1, s[4:7], s56 offen offset:0 sc0 sc1
buffer_store_dwordx4 v[40:43], v1, s[4:7], s56 offen offset:1024 sc0 sc1
buffer_store_dwordx4 v[40:43], v1, s[4:7], s56 offen offset:2048 sc0 sc1
buffer_store_dwordx4 v[40:43], v1, s[4:7], s56 offen offset:3072 sc0 sc1
buffer_store_dwordx4 v[40:43], v1, s[4:7], s57 offen offset:0 sc0 sc1
s_getreg_b32 s56, hwreg(HW_REG_XCC_ID)
s_and_b32 s56, s56, 15
s_mul_i32 s57, s56, s56
s_lshl_b32 s57, s57, 18
s_lshl_b32 s56, s56, 8
s_add_u32 s57, s57, s56
s_add_u32 s58, s57, 1
s_lshl_b32 s101, s32, 7
s_add_u32 s101, s101, 327680
v_mov_b32 v24, 0
s_add_u32 s56, s54, 393216
s_mov_b32 m0, 143360
s_nop 0
buffer_load_dwordx4 v26, s[12:15], s56 offen lds
s_add_u32 s56, s54, 409600
s_mov_b32 m0, 144384
s_nop 0
buffer_load_dwordx4 v26, s[12:15], s56 offen lds
s_add_u32 s56, s54, 425984
s_mov_b32 m0, 145408
s_nop 0
buffer_load_dwordx4 v27, s[12:15], s56 offen lds
s_add_u32 s56, s54, 442368
s_mov_b32 m0, 146432
s_nop 0
buffer_load_dwordx4 v27, s[12:15], s56 offen lds
s_add_u32 s56, s54, 917504
s_mov_b32 m0, 147456
s_nop 0
buffer_load_dwordx4 v26, s[12:15], s56 offen lds
s_add_u32 s56, s54, 933888
s_mov_b32 m0, 148480
s_nop 0
buffer_load_dwordx4 v26, s[12:15], s56 offen lds
s_add_u32 s56, s54, 950272
s_mov_b32 m0, 149504
s_nop 0
buffer_load_dwordx4 v27, s[12:15], s56 offen lds
s_add_u32 s56, s54, 966656
s_mov_b32 m0, 150528
s_nop 0
buffer_load_dwordx4 v27, s[12:15], s56 offen lds
v_mov_b32 v24, 0
s_waitcnt vmcnt(33)
s_barrier
ds_read_b64_tr_b16 v[80:81], v44 offset:20480
ds_read_b64_tr_b16 v[82:83], v44 offset:21504
ds_read_b64_tr_b16 v[84:85], v46 offset:20480
ds_read_b64_tr_b16 v[86:87], v46 offset:21504
ds_read_b64_tr_b16 v[88:89], v45 offset:20480
ds_read_b64_tr_b16 v[90:91], v45 offset:21504
ds_read_b64_tr_b16 v[92:93], v47 offset:20480
ds_read_b64_tr_b16 v[94:95], v47 offset:21504
s_waitcnt lgkmcnt(0)
s_waitcnt vmcnt(29)
s_barrier
s_add_u32 s56, s54, 1441792
s_mov_b32 m0, 151552
s_nop 0
buffer_load_dwordx4 v26, s[12:15], s56 offen lds
s_add_u32 s56, s54, 1458176
s_mov_b32 m0, 152576
s_nop 0
buffer_load_dwordx4 v26, s[12:15], s56 offen lds
s_add_u32 s56, s54, 1474560
s_mov_b32 m0, 153600
s_nop 0
buffer_load_dwordx4 v27, s[12:15], s56 offen lds
s_add_u32 s56, s54, 1490944
s_mov_b32 m0, 154624
s_nop 0
buffer_load_dwordx4 v27, s[12:15], s56 offen lds
ds_read_b64_tr_b16 v[96:97], v44 offset:24576
ds_read_b64_tr_b16 v[98:99], v44 offset:25600
ds_read_b64_tr_b16 v[100:101], v46 offset:24576
ds_read_b64_tr_b16 v[102:103], v46 offset:25600
ds_read_b64_tr_b16 v[104:105], v45 offset:24576
ds_read_b64_tr_b16 v[106:107], v45 offset:25600
ds_read_b64_tr_b16 v[108:109], v47 offset:24576
ds_read_b64_tr_b16 v[110:111], v47 offset:25600
s_waitcnt lgkmcnt(0)
s_waitcnt vmcnt(29)
s_barrier
s_add_u32 s56, s54, 1966080
s_mov_b32 m0, 155648
s_nop 0
buffer_load_dwordx4 v26, s[12:15], s56 offen lds
s_add_u32 s56, s54, 1982464
s_mov_b32 m0, 156672
s_nop 0
buffer_load_dwordx4 v26, s[12:15], s56 offen lds
s_add_u32 s56, s54, 1998848
s_mov_b32 m0, 157696
s_nop 0
buffer_load_dwordx4 v27, s[12:15], s56 offen lds
s_add_u32 s56, s54, 2015232
s_mov_b32 m0, 158720
s_nop 0
buffer_load_dwordx4 v27, s[12:15], s56 offen lds
ds_read_b64_tr_b16 v[112:113], v44 offset:28672
ds_read_b64_tr_b16 v[114:115], v44 offset:29696
ds_read_b64_tr_b16 v[116:117], v46 offset:28672
ds_read_b64_tr_b16 v[118:119], v46 offset:29696
ds_read_b64_tr_b16 v[120:121], v45 offset:28672
ds_read_b64_tr_b16 v[122:123], v45 offset:29696
ds_read_b64_tr_b16 v[124:125], v47 offset:28672
ds_read_b64_tr_b16 v[126:127], v47 offset:29696
s_waitcnt lgkmcnt(0)
s_waitcnt vmcnt(29)
s_barrier
s_add_u32 s56, s54, 2490368
s_mov_b32 m0, 159744
s_nop 0
buffer_load_dwordx4 v26, s[12:15], s56 offen lds
s_add_u32 s56, s54, 2506752
s_mov_b32 m0, 160768
s_nop 0
buffer_load_dwordx4 v26, s[12:15], s56 offen lds
s_add_u32 s56, s54, 2523136
s_mov_b32 m0, 161792
s_nop 0
buffer_load_dwordx4 v27, s[12:15], s56 offen lds
s_add_u32 s56, s54, 2539520
s_mov_b32 m0, 162816
s_nop 0
buffer_load_dwordx4 v27, s[12:15], s56 offen lds
ds_read_b64_tr_b16 v[128:129], v44 offset:0
ds_read_b64_tr_b16 v[130:131], v44 offset:1024
ds_read_b64_tr_b16 v[132:133], v46 offset:0
ds_read_b64_tr_b16 v[134:135], v46 offset:1024
ds_read_b64_tr_b16 v[136:137], v45 offset:0
ds_read_b64_tr_b16 v[138:139], v45 offset:1024
ds_read_b64_tr_b16 v[140:141], v47 offset:0
ds_read_b64_tr_b16 v[142:143], v47 offset:1024
s_waitcnt lgkmcnt(0)
s_waitcnt vmcnt(29)
s_barrier
s_add_u32 s56, s54, 3538944
s_mov_b32 m0, 131072
s_nop 0
buffer_load_dwordx4 v26, s[12:15], s56 offen lds
s_add_u32 s56, s54, 3555328
s_mov_b32 m0, 132096
s_nop 0
buffer_load_dwordx4 v26, s[12:15], s56 offen lds
s_add_u32 s56, s54, 3571712
s_mov_b32 m0, 133120
s_nop 0
buffer_load_dwordx4 v27, s[12:15], s56 offen lds
s_add_u32 s56, s54, 3588096
s_mov_b32 m0, 134144
s_nop 0
buffer_load_dwordx4 v27, s[12:15], s56 offen lds
ds_read_b64_tr_b16 v[144:145], v44 offset:4096
ds_read_b64_tr_b16 v[146:147], v44 offset:5120
ds_read_b64_tr_b16 v[148:149], v46 offset:4096
ds_read_b64_tr_b16 v[150:151], v46 offset:5120
ds_read_b64_tr_b16 v[152:153], v45 offset:4096
ds_read_b64_tr_b16 v[154:155], v45 offset:5120
ds_read_b64_tr_b16 v[156:157], v47 offset:4096
ds_read_b64_tr_b16 v[158:159], v47 offset:5120
s_waitcnt lgkmcnt(0)
s_waitcnt vmcnt(29)
s_barrier
s_add_u32 s56, s54, 4063232
s_mov_b32 m0, 135168
s_nop 0
buffer_load_dwordx4 v26, s[12:15], s56 offen lds
s_add_u32 s56, s54, 4079616
s_mov_b32 m0, 136192
s_nop 0
buffer_load_dwordx4 v26, s[12:15], s56 offen lds
s_add_u32 s56, s54, 4096000
s_mov_b32 m0, 137216
s_nop 0
buffer_load_dwordx4 v27, s[12:15], s56 offen lds
s_add_u32 s56, s54, 4112384
s_mov_b32 m0, 138240
s_nop 0
buffer_load_dwordx4 v27, s[12:15], s56 offen lds
ds_read_b64_tr_b16 v[160:161], v44 offset:8192
ds_read_b64_tr_b16 v[162:163], v44 offset:9216
ds_read_b64_tr_b16 v[164:165], v46 offset:8192
ds_read_b64_tr_b16 v[166:167], v46 offset:9216
ds_read_b64_tr_b16 v[168:169], v45 offset:8192
ds_read_b64_tr_b16 v[170:171], v45 offset:9216
ds_read_b64_tr_b16 v[172:173], v47 offset:8192
ds_read_b64_tr_b16 v[174:175], v47 offset:9216
s_waitcnt lgkmcnt(0)
s_waitcnt vmcnt(24)
s_barrier
s_add_u32 s56, s54, 4587520
s_mov_b32 m0, 139264
s_nop 0
buffer_load_dwordx4 v26, s[12:15], s56 offen lds
s_add_u32 s56, s54, 4603904
s_mov_b32 m0, 140288
s_nop 0
buffer_load_dwordx4 v26, s[12:15], s56 offen lds
s_add_u32 s56, s54, 4620288
s_mov_b32 m0, 141312
s_nop 0
buffer_load_dwordx4 v27, s[12:15], s56 offen lds
s_add_u32 s56, s54, 4636672
s_mov_b32 m0, 142336
s_nop 0
buffer_load_dwordx4 v27, s[12:15], s56 offen lds
ds_read_b64_tr_b16 v[176:177], v44 offset:12288
ds_read_b64_tr_b16 v[178:179], v44 offset:13312
ds_read_b64_tr_b16 v[180:181], v46 offset:12288
ds_read_b64_tr_b16 v[182:183], v46 offset:13312
ds_read_b64_tr_b16 v[184:185], v45 offset:12288
ds_read_b64_tr_b16 v[186:187], v45 offset:13312
ds_read_b64_tr_b16 v[188:189], v47 offset:12288
ds_read_b64_tr_b16 v[190:191], v47 offset:13312
s_waitcnt lgkmcnt(0)
s_waitcnt vmcnt(24)
s_barrier
s_add_u32 s56, s54, 393216
s_mov_b32 m0, 143360
s_nop 0
buffer_load_dwordx4 v26, s[16:19], s56 offen lds
s_add_u32 s56, s54, 409600
s_mov_b32 m0, 144384
s_nop 0
buffer_load_dwordx4 v26, s[16:19], s56 offen lds
s_add_u32 s56, s54, 425984
s_mov_b32 m0, 145408
s_nop 0
buffer_load_dwordx4 v27, s[16:19], s56 offen lds
s_add_u32 s56, s54, 442368
s_mov_b32 m0, 146432
s_nop 0
buffer_load_dwordx4 v27, s[16:19], s56 offen lds
ds_read_b64_tr_b16 v[192:193], v44 offset:16384
ds_read_b64_tr_b16 v[194:195], v44 offset:17408
ds_read_b64_tr_b16 v[196:197], v46 offset:16384
ds_read_b64_tr_b16 v[198:199], v46 offset:17408
ds_read_b64_tr_b16 v[200:201], v45 offset:16384
ds_read_b64_tr_b16 v[202:203], v45 offset:17408
ds_read_b64_tr_b16 v[204:205], v47 offset:16384
ds_read_b64_tr_b16 v[206:207], v47 offset:17408
s_waitcnt lgkmcnt(0)
s_waitcnt vmcnt(24)
s_barrier
s_add_u32 s56, s54, 917504
s_mov_b32 m0, 147456
s_nop 0
buffer_load_dwordx4 v26, s[16:19], s56 offen lds
s_add_u32 s56, s54, 933888
s_mov_b32 m0, 148480
s_nop 0
buffer_load_dwordx4 v26, s[16:19], s56 offen lds
s_add_u32 s56, s54, 950272
s_mov_b32 m0, 149504
s_nop 0
buffer_load_dwordx4 v27, s[16:19], s56 offen lds
s_add_u32 s56, s54, 966656
s_mov_b32 m0, 150528
s_nop 0
buffer_load_dwordx4 v27, s[16:19], s56 offen lds
ds_read_b64_tr_b16 v[208:209], v44 offset:20480
ds_read_b64_tr_b16 v[210:211], v44 offset:21504
ds_read_b64_tr_b16 v[212:213], v46 offset:20480
ds_read_b64_tr_b16 v[214:215], v46 offset:21504
ds_read_b64_tr_b16 v[216:217], v45 offset:20480
ds_read_b64_tr_b16 v[218:219], v45 offset:21504
ds_read_b64_tr_b16 v[220:221], v47 offset:20480
ds_read_b64_tr_b16 v[222:223], v47 offset:21504
s_waitcnt lgkmcnt(0)
s_waitcnt vmcnt(24)
s_barrier
s_add_u32 s56, s54, 1441792
s_mov_b32 m0, 151552
s_nop 0
buffer_load_dwordx4 v26, s[16:19], s56 offen lds
s_add_u32 s56, s54, 1458176
s_mov_b32 m0, 152576
s_nop 0
buffer_load_dwordx4 v26, s[16:19], s56 offen lds
s_add_u32 s56, s54, 1474560
s_mov_b32 m0, 153600
s_nop 0
buffer_load_dwordx4 v27, s[16:19], s56 offen lds
s_add_u32 s56, s54, 1490944
s_mov_b32 m0, 154624
s_nop 0
buffer_load_dwordx4 v27, s[16:19], s56 offen lds
ds_read_b64_tr_b16 v[224:225], v44 offset:24576
ds_read_b64_tr_b16 v[226:227], v44 offset:25600
ds_read_b64_tr_b16 v[228:229], v46 offset:24576
ds_read_b64_tr_b16 v[230:231], v46 offset:25600
ds_read_b64_tr_b16 v[232:233], v45 offset:24576
ds_read_b64_tr_b16 v[234:235], v45 offset:25600
ds_read_b64_tr_b16 v[236:237], v47 offset:24576
ds_read_b64_tr_b16 v[238:239], v47 offset:25600
s_waitcnt lgkmcnt(0)
s_waitcnt vmcnt(24)
s_barrier
s_add_u32 s56, s54, 1966080
s_mov_b32 m0, 155648
s_nop 0
buffer_load_dwordx4 v26, s[16:19], s56 offen lds
s_add_u32 s56, s54, 1982464
s_mov_b32 m0, 156672
s_nop 0
buffer_load_dwordx4 v26, s[16:19], s56 offen lds
s_add_u32 s56, s54, 1998848
s_mov_b32 m0, 157696
s_nop 0
buffer_load_dwordx4 v27, s[16:19], s56 offen lds
s_add_u32 s56, s54, 2015232
s_mov_b32 m0, 158720
s_nop 0
buffer_load_dwordx4 v27, s[16:19], s56 offen lds
ds_read_b64_tr_b16 v[240:241], v44 offset:28672
ds_read_b64_tr_b16 v[242:243], v44 offset:29696
ds_read_b64_tr_b16 v[244:245], v46 offset:28672
ds_read_b64_tr_b16 v[246:247], v46 offset:29696
ds_read_b64_tr_b16 v[248:249], v45 offset:28672
ds_read_b64_tr_b16 v[250:251], v45 offset:29696
ds_read_b64_tr_b16 v[252:253], v47 offset:28672
ds_read_b64_tr_b16 v[254:255], v47 offset:29696
s_waitcnt lgkmcnt(0)
s_waitcnt vmcnt(24)
s_barrier
s_add_u32 s56, s54, 2490368
s_mov_b32 m0, 159744
s_nop 0
buffer_load_dwordx4 v26, s[16:19], s56 offen lds
s_add_u32 s56, s54, 2506752
s_mov_b32 m0, 160768
s_nop 0
buffer_load_dwordx4 v26, s[16:19], s56 offen lds
s_add_u32 s56, s54, 2523136
s_mov_b32 m0, 161792
s_nop 0
buffer_load_dwordx4 v27, s[16:19], s56 offen lds
s_add_u32 s56, s54, 2539520
s_mov_b32 m0, 162816
s_nop 0
buffer_load_dwordx4 v27, s[16:19], s56 offen lds
ds_read_b64_tr_b16 a[0:1], v44 offset:0
ds_read_b64_tr_b16 a[2:3], v44 offset:1024
ds_read_b64_tr_b16 a[4:5], v46 offset:0
ds_read_b64_tr_b16 a[6:7], v46 offset:1024
ds_read_b64_tr_b16 a[8:9], v45 offset:0
ds_read_b64_tr_b16 a[10:11], v45 offset:1024
ds_read_b64_tr_b16 a[12:13], v47 offset:0
ds_read_b64_tr_b16 a[14:15], v47 offset:1024
s_waitcnt lgkmcnt(0)
s_waitcnt vmcnt(24)
s_barrier
s_add_u32 s56, s54, 3014656
s_mov_b32 m0, 131072
s_nop 0
buffer_load_dwordx4 v26, s[16:19], s56 offen lds
s_add_u32 s56, s54, 3031040
s_mov_b32 m0, 132096
s_nop 0
buffer_load_dwordx4 v26, s[16:19], s56 offen lds
s_add_u32 s56, s54, 3047424
s_mov_b32 m0, 133120
s_nop 0
buffer_load_dwordx4 v27, s[16:19], s56 offen lds
s_add_u32 s56, s54, 3063808
s_mov_b32 m0, 134144
s_nop 0
buffer_load_dwordx4 v27, s[16:19], s56 offen lds
ds_read_b64_tr_b16 a[16:17], v44 offset:4096
ds_read_b64_tr_b16 a[18:19], v44 offset:5120
ds_read_b64_tr_b16 a[20:21], v46 offset:4096
ds_read_b64_tr_b16 a[22:23], v46 offset:5120
ds_read_b64_tr_b16 a[24:25], v45 offset:4096
ds_read_b64_tr_b16 a[26:27], v45 offset:5120
ds_read_b64_tr_b16 a[28:29], v47 offset:4096
ds_read_b64_tr_b16 a[30:31], v47 offset:5120
s_waitcnt lgkmcnt(0)
s_waitcnt vmcnt(24)
s_barrier
s_add_u32 s56, s54, 3538944
s_mov_b32 m0, 135168
s_nop 0
buffer_load_dwordx4 v26, s[16:19], s56 offen lds
s_add_u32 s56, s54, 3555328
s_mov_b32 m0, 136192
s_nop 0
buffer_load_dwordx4 v26, s[16:19], s56 offen lds
s_add_u32 s56, s54, 3571712
s_mov_b32 m0, 137216
s_nop 0
buffer_load_dwordx4 v27, s[16:19], s56 offen lds
s_add_u32 s56, s54, 3588096
s_mov_b32 m0, 138240
s_nop 0
buffer_load_dwordx4 v27, s[16:19], s56 offen lds
ds_read_b64_tr_b16 a[32:33], v44 offset:8192
ds_read_b64_tr_b16 a[34:35], v44 offset:9216
ds_read_b64_tr_b16 a[36:37], v46 offset:8192
ds_read_b64_tr_b16 a[38:39], v46 offset:9216
ds_read_b64_tr_b16 a[40:41], v45 offset:8192
ds_read_b64_tr_b16 a[42:43], v45 offset:9216
ds_read_b64_tr_b16 a[44:45], v47 offset:8192
ds_read_b64_tr_b16 a[46:47], v47 offset:9216
s_waitcnt lgkmcnt(0)
s_waitcnt vmcnt(24)
s_barrier
s_add_u32 s56, s54, 4063232
s_mov_b32 m0, 139264
s_nop 0
buffer_load_dwordx4 v26, s[16:19], s56 offen lds
s_add_u32 s56, s54, 4079616
s_mov_b32 m0, 140288
s_nop 0
buffer_load_dwordx4 v26, s[16:19], s56 offen lds
s_add_u32 s56, s54, 4096000
s_mov_b32 m0, 141312
s_nop 0
buffer_load_dwordx4 v27, s[16:19], s56 offen lds
s_add_u32 s56, s54, 4112384
s_mov_b32 m0, 142336
s_nop 0
buffer_load_dwordx4 v27, s[16:19], s56 offen lds
ds_read_b64_tr_b16 a[48:49], v44 offset:12288
ds_read_b64_tr_b16 a[50:51], v44 offset:13312
ds_read_b64_tr_b16 a[52:53], v46 offset:12288
ds_read_b64_tr_b16 a[54:55], v46 offset:13312
ds_read_b64_tr_b16 a[56:57], v45 offset:12288
ds_read_b64_tr_b16 a[58:59], v45 offset:13312
ds_read_b64_tr_b16 a[60:61], v47 offset:12288
ds_read_b64_tr_b16 a[62:63], v47 offset:13312
s_waitcnt lgkmcnt(0)
s_waitcnt vmcnt(24)
s_barrier
s_add_u32 s56, s55, 115200
s_mov_b32 m0, 143360
s_nop 0
buffer_load_dwordx4 v28, s[20:23], s56 offen lds
s_add_u32 s56, s55, 117504
s_mov_b32 m0, 144384
s_nop 0
buffer_load_dwordx4 v28, s[20:23], s56 offen lds
s_add_u32 s56, s55, 124416
s_mov_b32 m0, 145408
s_nop 0
buffer_load_dwordx4 v28, s[20:23], s56 offen lds
s_add_u32 s56, s55, 126720
s_mov_b32 m0, 146432
s_nop 0
buffer_load_dwordx4 v28, s[20:23], s56 offen lds
ds_read_b64_tr_b16 a[64:65], v44 offset:16384
ds_read_b64_tr_b16 a[66:67], v44 offset:17408
ds_read_b64_tr_b16 a[68:69], v46 offset:16384
ds_read_b64_tr_b16 a[70:71], v46 offset:17408
ds_read_b64_tr_b16 a[72:73], v45 offset:16384
ds_read_b64_tr_b16 a[74:75], v45 offset:17408
ds_read_b64_tr_b16 a[76:77], v47 offset:16384
ds_read_b64_tr_b16 a[78:79], v47 offset:17408
s_waitcnt lgkmcnt(0)
s_waitcnt vmcnt(24)
s_barrier
s_add_u32 s56, s55, 115456
s_mov_b32 m0, 147456
s_nop 0
buffer_load_dwordx4 v28, s[20:23], s56 offen lds
s_add_u32 s56, s55, 117760
s_mov_b32 m0, 148480
s_nop 0
buffer_load_dwordx4 v28, s[20:23], s56 offen lds
s_add_u32 s56, s55, 124672
s_mov_b32 m0, 149504
s_nop 0
buffer_load_dwordx4 v28, s[20:23], s56 offen lds
s_add_u32 s56, s55, 126976
s_mov_b32 m0, 150528
s_nop 0
buffer_load_dwordx4 v28, s[20:23], s56 offen lds
ds_read_b64_tr_b16 a[80:81], v44 offset:20480
ds_read_b64_tr_b16 a[82:83], v44 offset:21504
ds_read_b64_tr_b16 a[84:85], v46 offset:20480
ds_read_b64_tr_b16 a[86:87], v46 offset:21504
ds_read_b64_tr_b16 a[88:89], v45 offset:20480
ds_read_b64_tr_b16 a[90:91], v45 offset:21504
ds_read_b64_tr_b16 a[92:93], v47 offset:20480
ds_read_b64_tr_b16 a[94:95], v47 offset:21504
s_waitcnt lgkmcnt(0)
s_waitcnt vmcnt(24)
s_barrier
s_add_u32 s56, s55, 115712
s_mov_b32 m0, 151552
s_nop 0
buffer_load_dwordx4 v28, s[20:23], s56 offen lds
s_add_u32 s56, s55, 118016
s_mov_b32 m0, 152576
s_nop 0
buffer_load_dwordx4 v28, s[20:23], s56 offen lds
s_add_u32 s56, s55, 124928
s_mov_b32 m0, 153600
s_nop 0
buffer_load_dwordx4 v28, s[20:23], s56 offen lds
s_add_u32 s56, s55, 127232
s_mov_b32 m0, 154624
s_nop 0
buffer_load_dwordx4 v28, s[20:23], s56 offen lds
ds_read_b64_tr_b16 a[96:97], v44 offset:24576
ds_read_b64_tr_b16 a[98:99], v44 offset:25600
ds_read_b64_tr_b16 a[100:101], v46 offset:24576
ds_read_b64_tr_b16 a[102:103], v46 offset:25600
ds_read_b64_tr_b16 a[104:105], v45 offset:24576
ds_read_b64_tr_b16 a[106:107], v45 offset:25600
ds_read_b64_tr_b16 a[108:109], v47 offset:24576
ds_read_b64_tr_b16 a[110:111], v47 offset:25600
s_waitcnt lgkmcnt(0)
s_waitcnt vmcnt(24)
s_barrier
s_add_u32 s56, s55, 115968
s_mov_b32 m0, 155648
s_nop 0
buffer_load_dwordx4 v28, s[20:23], s56 offen lds
s_add_u32 s56, s55, 118272
s_mov_b32 m0, 156672
s_nop 0
buffer_load_dwordx4 v28, s[20:23], s56 offen lds
s_add_u32 s56, s55, 125184
s_mov_b32 m0, 157696
s_nop 0
buffer_load_dwordx4 v28, s[20:23], s56 offen lds
s_add_u32 s56, s55, 127488
s_mov_b32 m0, 158720
s_nop 0
buffer_load_dwordx4 v28, s[20:23], s56 offen lds
ds_read_b64_tr_b16 a[112:113], v44 offset:28672
ds_read_b64_tr_b16 a[114:115], v44 offset:29696
ds_read_b64_tr_b16 a[116:117], v46 offset:28672
ds_read_b64_tr_b16 a[118:119], v46 offset:29696
ds_read_b64_tr_b16 a[120:121], v45 offset:28672
ds_read_b64_tr_b16 a[122:123], v45 offset:29696
ds_read_b64_tr_b16 a[124:125], v47 offset:28672
ds_read_b64_tr_b16 a[126:127], v47 offset:29696
s_waitcnt lgkmcnt(0)
s_waitcnt vmcnt(24)
s_barrier
s_add_u32 s56, s55, 41472
s_mov_b32 m0, 159744
s_nop 0
buffer_load_dwordx4 v28, s[20:23], s56 offen lds
s_add_u32 s56, s55, 43776
s_mov_b32 m0, 160768
s_nop 0
buffer_load_dwordx4 v28, s[20:23], s56 offen lds
s_add_u32 s56, s55, 50688
s_mov_b32 m0, 161792
s_nop 0
buffer_load_dwordx4 v28, s[20:23], s56 offen lds
s_add_u32 s56, s55, 52992
s_mov_b32 m0, 162816
s_nop 0
buffer_load_dwordx4 v28, s[20:23], s56 offen lds
ds_read_b64_tr_b16 a[128:129], v44 offset:0
ds_read_b64_tr_b16 a[130:131], v44 offset:1024
ds_read_b64_tr_b16 a[132:133], v46 offset:0
ds_read_b64_tr_b16 a[134:135], v46 offset:1024
ds_read_b64_tr_b16 a[136:137], v45 offset:0
ds_read_b64_tr_b16 a[138:139], v45 offset:1024
ds_read_b64_tr_b16 a[140:141], v47 offset:0
ds_read_b64_tr_b16 a[142:143], v47 offset:1024
buffer_load_dword v32, v24, s[28:31], 0 offen sc0 sc1
s_waitcnt lgkmcnt(0)
s_waitcnt vmcnt(25)
s_barrier
s_add_u32 s56, s54, 393216
s_mov_b32 m0, 131072
s_nop 0
buffer_load_dwordx4 v26, s[8:11], s56 offen lds
s_add_u32 s56, s54, 409600
s_mov_b32 m0, 132096
s_nop 0
buffer_load_dwordx4 v26, s[8:11], s56 offen lds
s_add_u32 s56, s54, 425984
s_mov_b32 m0, 133120
s_nop 0
buffer_load_dwordx4 v27, s[8:11], s56 offen lds
s_add_u32 s56, s54, 442368
s_mov_b32 m0, 134144
s_nop 0
buffer_load_dwordx4 v27, s[8:11], s56 offen lds
ds_read_b64_tr_b16 a[144:145], v44 offset:4096
ds_read_b64_tr_b16 a[146:147], v44 offset:5120
ds_read_b64_tr_b16 a[148:149], v46 offset:4096
ds_read_b64_tr_b16 a[150:151], v46 offset:5120
ds_read_b64_tr_b16 a[152:153], v45 offset:4096
ds_read_b64_tr_b16 a[154:155], v45 offset:5120
ds_read_b64_tr_b16 a[156:157], v47 offset:4096
ds_read_b64_tr_b16 a[158:159], v47 offset:5120
s_waitcnt lgkmcnt(0)
s_waitcnt vmcnt(25)
s_barrier
s_add_u32 s56, s54, 1966080
s_mov_b32 m0, 135168
s_nop 0
buffer_load_dwordx4 v26, s[8:11], s56 offen lds
s_add_u32 s56, s54, 1982464
s_mov_b32 m0, 136192
s_nop 0
buffer_load_dwordx4 v26, s[8:11], s56 offen lds
s_add_u32 s56, s54, 1998848
s_mov_b32 m0, 137216
s_nop 0
buffer_load_dwordx4 v27, s[8:11], s56 offen lds
s_add_u32 s56, s54, 2015232
s_mov_b32 m0, 138240
s_nop 0
buffer_load_dwordx4 v27, s[8:11], s56 offen lds
ds_read_b64_tr_b16 a[160:161], v44 offset:8192
ds_read_b64_tr_b16 a[162:163], v44 offset:9216
ds_read_b64_tr_b16 a[164:165], v46 offset:8192
ds_read_b64_tr_b16 a[166:167], v46 offset:9216
ds_read_b64_tr_b16 a[168:169], v45 offset:8192
ds_read_b64_tr_b16 a[170:171], v45 offset:9216
ds_read_b64_tr_b16 a[172:173], v47 offset:8192
ds_read_b64_tr_b16 a[174:175], v47 offset:9216
s_waitcnt lgkmcnt(0)
s_waitcnt vmcnt(25)
s_barrier
s_add_u32 s56, s54, 2490368
s_mov_b32 m0, 139264
s_nop 0
buffer_load_dwordx4 v26, s[8:11], s56 offen lds
s_add_u32 s56, s54, 2506752
s_mov_b32 m0, 140288
s_nop 0
buffer_load_dwordx4 v26, s[8:11], s56 offen lds
s_add_u32 s56, s54, 2523136
s_mov_b32 m0, 141312
s_nop 0
buffer_load_dwordx4 v27, s[8:11], s56 offen lds
s_add_u32 s56, s54, 2539520
s_mov_b32 m0, 142336
s_nop 0
buffer_load_dwordx4 v27, s[8:11], s56 offen lds
ds_read_b64_tr_b16 a[216:217], v48 offset:12288
ds_read_b64_tr_b16 a[218:219], v48 offset:13312
ds_read_b64_tr_b16 a[220:221], v48 offset:14336
ds_read_b64_tr_b16 a[222:223], v48 offset:15360
ds_read_b64_tr_b16 a[176:177], v49 offset:12288
ds_read_b64_tr_b16 a[178:179], v49 offset:13312
ds_read_b64_tr_b16 a[180:181], v49 offset:14336
ds_read_b64_tr_b16 a[182:183], v49 offset:15360
s_waitcnt lgkmcnt(0)
s_waitcnt vmcnt(25)
s_barrier
s_add_u32 s56, s54, 3014656
s_mov_b32 m0, 143360
s_nop 0
buffer_load_dwordx4 v26, s[12:15], s56 offen lds
s_add_u32 s56, s54, 3031040
s_mov_b32 m0, 144384
s_nop 0
buffer_load_dwordx4 v26, s[12:15], s56 offen lds
s_add_u32 s56, s54, 3047424
s_mov_b32 m0, 145408
s_nop 0
buffer_load_dwordx4 v27, s[12:15], s56 offen lds
s_add_u32 s56, s54, 3063808
s_mov_b32 m0, 146432
s_nop 0
buffer_load_dwordx4 v27, s[12:15], s56 offen lds
ds_read_b64_tr_b16 a[232:233], v48 offset:16384
ds_read_b64_tr_b16 a[234:235], v48 offset:17408
ds_read_b64_tr_b16 a[236:237], v48 offset:18432
ds_read_b64_tr_b16 a[238:239], v48 offset:19456
ds_read_b64_tr_b16 a[184:185], v49 offset:16384
ds_read_b64_tr_b16 a[186:187], v49 offset:17408
ds_read_b64_tr_b16 a[188:189], v49 offset:18432
ds_read_b64_tr_b16 a[190:191], v49 offset:19456
s_waitcnt lgkmcnt(0)
s_waitcnt vmcnt(25)
s_barrier
s_add_u32 s56, s54, 4587520
s_mov_b32 m0, 147456
s_nop 0
buffer_load_dwordx4 v26, s[16:19], s56 offen lds
s_add_u32 s56, s54, 4603904
s_mov_b32 m0, 148480
s_nop 0
buffer_load_dwordx4 v26, s[16:19], s56 offen lds
s_add_u32 s56, s54, 4620288
s_mov_b32 m0, 149504
s_nop 0
buffer_load_dwordx4 v27, s[16:19], s56 offen lds
s_add_u32 s56, s54, 4636672
s_mov_b32 m0, 150528
s_nop 0
buffer_load_dwordx4 v27, s[16:19], s56 offen lds
ds_read_b64_tr_b16 a[240:241], v48 offset:20480
ds_read_b64_tr_b16 a[242:243], v48 offset:21504
ds_read_b64_tr_b16 a[244:245], v48 offset:22528
ds_read_b64_tr_b16 a[246:247], v48 offset:23552
ds_read_b64_tr_b16 a[192:193], v49 offset:20480
ds_read_b64_tr_b16 a[194:195], v49 offset:21504
ds_read_b64_tr_b16 a[196:197], v49 offset:22528
ds_read_b64_tr_b16 a[198:199], v49 offset:23552
s_waitcnt lgkmcnt(0)
s_waitcnt vmcnt(25)
s_barrier
s_add_u32 s56, s55, 41728
s_mov_b32 m0, 151552
s_nop 0
buffer_load_dwordx4 v28, s[20:23], s56 offen lds
s_add_u32 s56, s55, 44032
s_mov_b32 m0, 152576
s_nop 0
buffer_load_dwordx4 v28, s[20:23], s56 offen lds
s_add_u32 s56, s55, 50944
s_mov_b32 m0, 153600
s_nop 0
buffer_load_dwordx4 v28, s[20:23], s56 offen lds
s_add_u32 s56, s55, 53248
s_mov_b32 m0, 154624
s_nop 0
buffer_load_dwordx4 v28, s[20:23], s56 offen lds
ds_read_b64_tr_b16 a[248:249], v48 offset:24576
ds_read_b64_tr_b16 a[250:251], v48 offset:25600
ds_read_b64_tr_b16 a[252:253], v48 offset:26624
ds_read_b64_tr_b16 a[254:255], v48 offset:27648
ds_read_b64_tr_b16 a[200:201], v49 offset:24576
ds_read_b64_tr_b16 a[202:203], v49 offset:25600
ds_read_b64_tr_b16 a[204:205], v49 offset:26624
ds_read_b64_tr_b16 a[206:207], v49 offset:27648
s_waitcnt lgkmcnt(0)
s_waitcnt vmcnt(25)
s_barrier
s_add_u32 s56, s55, 41984
s_mov_b32 m0, 155648
s_nop 0
buffer_load_dwordx4 v28, s[20:23], s56 offen lds
s_add_u32 s56, s55, 44288
s_mov_b32 m0, 156672
s_nop 0
buffer_load_dwordx4 v28, s[20:23], s56 offen lds
s_add_u32 s56, s55, 51200
s_mov_b32 m0, 157696
s_nop 0
buffer_load_dwordx4 v28, s[20:23], s56 offen lds
s_add_u32 s56, s55, 53504
s_mov_b32 m0, 158720
s_nop 0
buffer_load_dwordx4 v28, s[20:23], s56 offen lds
ds_read_b64_tr_b16 a[224:225], v48 offset:28672
ds_read_b64_tr_b16 a[226:227], v48 offset:29696
ds_read_b64_tr_b16 a[228:229], v48 offset:30720
ds_read_b64_tr_b16 a[230:231], v48 offset:31744
ds_read_b64_tr_b16 a[208:209], v49 offset:28672
ds_read_b64_tr_b16 a[210:211], v49 offset:29696
ds_read_b64_tr_b16 a[212:213], v49 offset:30720
ds_read_b64_tr_b16 a[214:215], v49 offset:31744
s_waitcnt lgkmcnt(0)
s_waitcnt vmcnt(24)
s_barrier
s_add_u32 s56, s55, 42240
s_mov_b32 m0, 159744
s_nop 0
buffer_load_dwordx4 v28, s[20:23], s56 offen lds
s_add_u32 s56, s55, 44544
s_mov_b32 m0, 160768
s_nop 0
buffer_load_dwordx4 v28, s[20:23], s56 offen lds
s_add_u32 s56, s55, 51456
s_mov_b32 m0, 161792
s_nop 0
buffer_load_dwordx4 v28, s[20:23], s56 offen lds
s_add_u32 s56, s55, 53760
s_mov_b32 m0, 162816
s_nop 0
buffer_load_dwordx4 v28, s[20:23], s56 offen lds
ds_read_b64_tr_b16 v[60:61], v44 offset:0
ds_read_b64_tr_b16 v[62:63], v44 offset:1024
ds_read_b64_tr_b16 v[64:65], v46 offset:0
ds_read_b64_tr_b16 v[66:67], v46 offset:1024
ds_read_b64_tr_b16 v[68:69], v45 offset:0
ds_read_b64_tr_b16 v[70:71], v45 offset:1024
ds_read_b64_tr_b16 v[72:73], v47 offset:0
ds_read_b64_tr_b16 v[74:75], v47 offset:1024
s_waitcnt lgkmcnt(0)
s_waitcnt vmcnt(24)
s_barrier
ds_write_b128 v2, v[60:63] offset:0
ds_write_b128 v2, v[64:67] offset:1024
ds_write_b128 v2, v[68:71] offset:2048
ds_write_b128 v2, v[72:75] offset:3072
ds_read_b64_tr_b16 v[60:61], v44 offset:4096
ds_read_b64_tr_b16 v[62:63], v44 offset:5120
ds_read_b64_tr_b16 v[64:65], v46 offset:4096
ds_read_b64_tr_b16 v[66:67], v46 offset:5120
ds_read_b64_tr_b16 v[68:69], v45 offset:4096
ds_read_b64_tr_b16 v[70:71], v45 offset:5120
ds_read_b64_tr_b16 v[72:73], v47 offset:4096
ds_read_b64_tr_b16 v[74:75], v47 offset:5120
L_rdv_w3:
v_readfirstlane_b32 s38, v32
s_nop 0
s_and_b32 s57, s38, 0xff
s_cmp_lg_u32 s57, 32
s_cbranch_scc1 L_rdv2_w3
L_kvw_w3p:
s_load_dwordx16 s[64:79], s[4:5], s101 glc
s_sub_u32 s41, s41, 1
s_cbranch_scc1 L_exit
s_waitcnt lgkmcnt(0)
s_min_u32 s64, s64, s65
s_min_u32 s64, s64, s66
s_min_u32 s64, s64, s67
s_min_u32 s64, s64, s68
s_min_u32 s64, s64, s69
s_min_u32 s64, s64, s70
s_min_u32 s64, s64, s71
s_min_u32 s64, s64, s72
s_min_u32 s64, s64, s73
s_min_u32 s64, s64, s74
s_min_u32 s64, s64, s75
s_min_u32 s64, s64, s76
s_min_u32 s64, s64, s77
s_min_u32 s64, s64, s78
s_min_u32 s64, s64, s79
s_lshl_b32 s100, s64, 2
s_sub_u32 s100, s100, 1
s_cmp_ge_i32 s34, s100
s_cbranch_scc1 L_kvw_w3p
s_waitcnt lgkmcnt(0)
s_waitcnt vmcnt(20)
s_barrier
ds_write_b128 v2, v[60:63] offset:4096
ds_write_b128 v2, v[64:67] offset:5120
ds_write_b128 v2, v[68:71] offset:6144
ds_write_b128 v2, v[72:75] offset:7168
ds_read_b64_tr_b16 v[60:61], v44 offset:8192
ds_read_b64_tr_b16 v[62:63], v44 offset:9216
ds_read_b64_tr_b16 v[64:65], v46 offset:8192
ds_read_b64_tr_b16 v[66:67], v46 offset:9216
ds_read_b64_tr_b16 v[68:69], v45 offset:8192
ds_read_b64_tr_b16 v[70:71], v45 offset:9216
ds_read_b64_tr_b16 v[72:73], v47 offset:8192
ds_read_b64_tr_b16 v[74:75], v47 offset:9216
buffer_load_dwordx4 v[12:15], v9, s[4:7], s37 offen offset:0
buffer_load_dwordx4 v[16:19], v9, s[4:7], s37 offen offset:1024
buffer_load_dwordx4 v[52:55], v1, s[4:7], s37 offen offset:2048
buffer_load_dwordx4 v[56:59], v1, s[4:7], s37 offen offset:3072
s_mov_b32 m0, 1024
s_nop 0
buffer_load_dwordx4 v1, s[4:7], s47 offen offset:3072 sc1 lds
s_waitcnt lgkmcnt(0)
s_waitcnt vmcnt(21)
s_barrier
ds_write_b128 v2, v[60:63] offset:8192
ds_write_b128 v2, v[64:67] offset:9216
ds_write_b128 v2, v[68:71] offset:10240
ds_write_b128 v2, v[72:75] offset:11264
ds_read_b64_tr_b16 v[60:61], v44 offset:12288
ds_read_b64_tr_b16 v[62:63], v44 offset:13312
ds_read_b64_tr_b16 v[64:65], v46 offset:12288
ds_read_b64_tr_b16 v[66:67], v46 offset:13312
ds_read_b64_tr_b16 v[68:69], v45 offset:12288
ds_read_b64_tr_b16 v[70:71], v45 offset:13312
ds_read_b64_tr_b16 v[72:73], v47 offset:12288
ds_read_b64_tr_b16 v[74:75], v47 offset:13312
s_waitcnt lgkmcnt(0)
s_waitcnt vmcnt(17)
s_barrier
ds_write_b128 v2, v[60:63] offset:12288
ds_write_b128 v2, v[64:67] offset:13312
ds_write_b128 v2, v[68:71] offset:14336
ds_write_b128 v2, v[72:75] offset:15360
ds_read_b64_tr_b16 v[60:61], v44 offset:16384
ds_read_b64_tr_b16 v[62:63], v44 offset:17408
ds_read_b64_tr_b16 v[64:65], v46 offset:16384
ds_read_b64_tr_b16 v[66:67], v46 offset:17408
ds_read_b64_tr_b16 v[68:69], v45 offset:16384
ds_read_b64_tr_b16 v[70:71], v45 offset:17408
ds_read_b64_tr_b16 v[72:73], v47 offset:16384
ds_read_b64_tr_b16 v[74:75], v47 offset:17408
s_waitcnt lgkmcnt(0)
s_waitcnt vmcnt(13)
s_barrier
ds_write_b128 v2, v[60:63] offset:16384
ds_write_b128 v2, v[64:67] offset:17408
ds_write_b128 v2, v[68:71] offset:18432
ds_write_b128 v2, v[72:75] offset:19456
ds_read_b64_tr_b16 v[60:61], v48 offset:20480
ds_read_b64_tr_b16 v[62:63], v48 offset:21504
ds_read_b64_tr_b16 v[64:65], v48 offset:22528
ds_read_b64_tr_b16 v[66:67], v48 offset:23552
ds_read_b64_tr_b16 v[68:69], v49 offset:20480
ds_read_b64_tr_b16 v[70:71], v49 offset:21504
ds_read_b64_tr_b16 v[72:73], v49 offset:22528
ds_read_b64_tr_b16 v[74:75], v49 offset:23552
s_waitcnt lgkmcnt(0)
s_waitcnt vmcnt(9)
s_barrier
ds_write_b128 v2, v[60:63] offset:20480
ds_write_b128 v2, v[64:67] offset:21504
ds_write_b128 v2, v[68:71] offset:22528
ds_write_b128 v2, v[72:75] offset:23552
ds_read_b64_tr_b16 v[60:61], v48 offset:24576
ds_read_b64_tr_b16 v[62:63], v48 offset:25600
ds_read_b64_tr_b16 v[64:65], v48 offset:26624
ds_read_b64_tr_b16 v[66:67], v48 offset:27648
ds_read_b64_tr_b16 v[68:69], v49 offset:24576
ds_read_b64_tr_b16 v[70:71], v49 offset:25600
ds_read_b64_tr_b16 v[72:73], v49 offset:26624
ds_read_b64_tr_b16 v[74:75], v49 offset:27648
s_waitcnt lgkmcnt(0)
s_waitcnt vmcnt(5)
s_barrier
ds_write_b128 v2, v[60:63] offset:24576
ds_write_b128 v2, v[64:67] offset:25600
ds_write_b128 v2, v[68:71] offset:26624
ds_write_b128 v2, v[72:75] offset:27648
ds_read_b64_tr_b16 v[60:61], v48 offset:28672
ds_read_b64_tr_b16 v[62:63], v48 offset:29696
ds_read_b64_tr_b16 v[64:65], v48 offset:30720
ds_read_b64_tr_b16 v[66:67], v48 offset:31744
ds_read_b64_tr_b16 v[68:69], v49 offset:28672
ds_read_b64_tr_b16 v[70:71], v49 offset:29696
ds_read_b64_tr_b16 v[72:73], v49 offset:30720
ds_read_b64_tr_b16 v[74:75], v49 offset:31744
s_waitcnt lgkmcnt(0)
s_barrier
ds_write_b128 v2, v[60:63] offset:28672
ds_write_b128 v2, v[64:67] offset:29696
ds_write_b128 v2, v[68:71] offset:30720
ds_write_b128 v2, v[72:75] offset:31744
s_lshl_b32 s57, s58, 5
s_mov_b32 s0, 0x3f003f00
s_mov_b32 s1, 0x3f003f00
s_mov_b32 s58, 304128
s_cmp_eq_u32 s38, s57
s_mov_b32 s56, 0x33333333
s_mov_b32 s57, 0x33333333
s_mov_b32 s2, 0x21800000
s_mov_b32 s55, -24
s_cbranch_scc0 L_slow_w3
v_mov_b64 v[20:21], 0
v_mov_b64 v[22:23], 0
v_mov_b64 v[24:25], 0
v_mov_b64 v[26:27], 0
v_mov_b64 v[28:29], 0
v_mov_b64 v[30:31], 0
v_mov_b64 v[32:33], 0
v_mov_b64 v[34:35], 0
v_mov_b64 v[36:37], 0
v_mov_b64 v[38:39], 0
v_mov_b64 v[40:41], 0
v_mov_b64 v[42:43], 0
ds_read_b128 v[44:47], v2 offset:0
ds_read_b128 v[48:51], v2 offset:1024
v_bfe_u32 v77, v1, 6, 1
v_lshl_add_u32 v77, v77, 3, v1
v_lshlrev_b32 v77, 1, v77
s_waitcnt vmcnt(0) lgkmcnt(0)
s_branch L_top_w3f
L_done_w3f:
s_waitcnt vmcnt(0) lgkmcnt(0)
s_endpgm
L_rdv2_w3:
buffer_load_dword v32, v24, s[28:31], 0 offen sc0 sc1
s_sub_u32 s41, s41, 1
s_cbranch_scc1 L_exit
s_waitcnt vmcnt(0)
s_branch L_rdv_w3
L_ra0_w3f:
s_mov_b32 m0, 1024
s_nop 0
buffer_load_dwordx4 v1, s[4:7], s47 offen offset:0 sc1 lds
buffer_load_dwordx4 v1, s[4:7], s47 offen offset:1024 sc1 lds
buffer_load_dwordx4 v1, s[4:7], s47 offen offset:2048 sc1 lds
buffer_load_dwordx4 v1, s[4:7], s47 offen offset:3072 sc1 lds
s_sub_u32 s41, s41, 1
s_cbranch_scc1 L_exit
ds_read_b128 v[44:47], v2 offset:0
ds_read_b128 v[48:51], v2 offset:1024
v_mov_b64 v[20:21], 0
v_mov_b64 v[22:23], 0
v_mov_b64 v[24:25], 0
v_mov_b64 v[26:27], 0
v_mov_b64 v[28:29], 0
v_mov_b64 v[30:31], 0
v_mov_b64 v[32:33], 0
v_mov_b64 v[34:35], 0
v_mov_b64 v[36:37], 0
v_mov_b64 v[38:39], 0
v_mov_b64 v[40:41], 0
v_mov_b64 v[42:43], 0
s_waitcnt vmcnt(0)
ds_read_b128 v[60:63], v1 offset:1024
ds_read_b128 v[64:67], v1 offset:2048
ds_read_b128 v[68:71], v1 offset:3072
ds_read_b128 v[72:75], v1 offset:4096
s_branch L_s0_w3f
L_ra1_w3f:
L_ra2_w3f:
s_waitcnt lgkmcnt(0)
s_barrier
s_mov_b32 m0, 5120
s_nop 0
buffer_load_dwordx4 v1, s[4:7], s48 offen offset:3072 sc1 lds
s_sub_u32 s41, s41, 1
s_cbranch_scc1 L_exit
s_waitcnt vmcnt(0)
s_barrier
ds_read_b128 v[76:79], v1 offset:5120
ds_read_b128 v[60:63], v1 offset:6144
ds_read_b128 v[64:67], v1 offset:7168
ds_read_b128 v[68:71], v1 offset:8192
ds_read_b128 v[72:75], v1 offset:9216
s_waitcnt lgkmcnt(0)
v_bitop3_b32 v6, v76, v60, s35 bitop3:0x7e
v_bitop3_b32 v6, v6, v64, s35 bitop3:0xf6
v_bitop3_b32 v6, v6, v68, s35 bitop3:0xf6
v_bitop3_b32 v6, v6, v72, s35 bitop3:0xf6
v_and_b32 v6, 1, v6
v_cmp_ne_u32 vcc, 0, v6
s_mov_b32 m0, 0
v_lshlrev_b32 v6, 3, v1
s_cbranch_vccnz L_ra2_w3f
s_branch L_a1_w3f
L_mx_w3f:
s_waitcnt lgkmcnt(0)
v_max3_f32 v30, v12, v13, v28
v_max_f32 v30, v30, v29
v_mov_b32 v31, v30
s_nop 1
v_permlane16_swap_b32 v30, v31
v_max_f32 v30, v30, v31
v_mov_b32 v31, v30
s_nop 1
v_permlane32_swap_b32 v30, v31
v_max_f32 v30, v30, v31
ds_write_b32 v1, v30 offset:10252
s_waitcnt lgkmcnt(0)
s_barrier
ds_read_b128 v[32:35], v1 offset:10240
s_waitcnt lgkmcnt(0)
v_max3_f32 v32, v32, v33, v34
v_max_f32 v32, v32, v35
v_sub_f32 v14, v12, v32
v_sub_f32 v15, v13, v32
v_sub_f32 v30, v28, v32
v_sub_f32 v31, v29, v32
v_exp_f32 v14, v14
v_exp_f32 v15, v15
v_exp_f32 v30, v30
v_exp_f32 v31, v31
v_cvt_pk_bf16_f32 v14, v14, v15
v_cvt_pk_bf16_f32 v30, v30, v31
ds_write_b32 v5, v14 offset:15136
v_cndmask_b32_e64 v26, 0, v30, s[56:57]
v_cndmask_b32_e64 v27, 0, v30, s[56:57]
v_mov_b64 v[76:77], s[52:53]
v_mov_b64 v[78:79], s[52:53]
v_mov_b32_dpp v24, v26 quad_perm:[2,3,0,1] row_mask:0xf bank_mask:0xf
v_mov_b32_dpp v25, v26 quad_perm:[2,3,0,1] row_mask:0xf bank_mask:0xf
s_waitcnt lgkmcnt(0)
s_barrier
v_mov_b64 v[14:15], s[0:1]
ds_read_b128 v[16:19], v1 offset:14368
ds_read_b128 v[36:39], v1 offset:14336
s_waitcnt lgkmcnt(0)
v_mfma_f32_16x16x32_bf16 v[32:35], v[76:79], v[16:19], 0
v_mfma_f32_16x16x32_bf16 v[20:23], v[52:55], v[16:19], 0
v_mfma_f32_16x16x32_bf16 v[20:23], v[56:59], v[36:39], v[20:23]
v_mfma_f32_16x16x16_bf16 v[32:35], v[14:15], v[26:27], v[32:35]
v_mfma_f32_16x16x32_bf16 v[20:23], v[40:43], v[24:27], v[20:23]
s_nop 3
v_rcp_f32 v33, v32
s_nop 2
v_mul_f32_dpp v20, v33, v20 quad_perm:[0,1,0,1] row_mask:0xf bank_mask:0xf
v_mul_f32_dpp v21, v33, v21 quad_perm:[0,1,0,1] row_mask:0xf bank_mask:0xf
v_mul_f32_dpp v22, v33, v22 quad_perm:[0,1,0,1] row_mask:0xf bank_mask:0xf
v_mul_f32_dpp v23, v33, v23 quad_perm:[0,1,0,1] row_mask:0xf bank_mask:0xf
v_cvt_pk_bf16_f32 v20, v20, v21
v_cvt_pk_bf16_f32 v21, v22, v23
ds_write_b64 v6, v[20:21] offset:8192
v_mov_b32_dpp v16, v20 quad_perm:[0,1,0,1] row_mask:0xf bank_mask:0xf
v_mov_b32_dpp v17, v21 quad_perm:[0,1,0,1] row_mask:0xf bank_mask:0xf
v_mov_b32_dpp v18, v20 quad_perm:[2,3,2,3] row_mask:0xf bank_mask:0xf
v_mov_b32_dpp v19, v21 quad_perm:[2,3,2,3] row_mask:0xf bank_mask:0xf
v_mov_b64 v[76:77], 0
v_mov_b64 v[78:79], 0
v_mov_b64 v[36:37], 0
v_mov_b64 v[38:39], 0
v_mov_b64 v[24:25], 0
v_mov_b64 v[26:27], 0
v_mov_b64 v[32:33], 0
v_mov_b64 v[34:35], 0
s_waitcnt lgkmcnt(0)
s_branch L_mxb_w3f

L_ev_w3f:

L_kvw_w3f:
s_load_dwordx16 s[64:79], s[4:5], s101 glc
s_sub_u32 s41, s41, 1
s_cbranch_scc1 L_exit
s_waitcnt lgkmcnt(0)
s_min_u32 s64, s64, s65
s_min_u32 s64, s64, s66
s_min_u32 s64, s64, s67
s_min_u32 s64, s64, s68
s_min_u32 s64, s64, s69
s_min_u32 s64, s64, s70
s_min_u32 s64, s64, s71
s_min_u32 s64, s64, s72
s_min_u32 s64, s64, s73
s_min_u32 s64, s64, s74
s_min_u32 s64, s64, s75
s_min_u32 s64, s64, s76
s_min_u32 s64, s64, s77
s_min_u32 s64, s64, s78
s_min_u32 s64, s64, s79
s_lshl_b32 s100, s64, 2
s_sub_u32 s100, s100, 1
s_cmp_ge_i32 s34, s100
s_cbranch_scc1 L_kvw_w3f
s_branch L_evb_w3f
L_slow_w3:
v_mov_b64 v[20:21], 0
v_mov_b64 v[22:23], 0
v_mov_b64 v[24:25], 0
v_mov_b64 v[26:27], 0
v_mov_b64 v[28:29], 0
v_mov_b64 v[30:31], 0
v_mov_b64 v[32:33], 0
v_mov_b64 v[34:35], 0
v_mov_b64 v[36:37], 0
v_mov_b64 v[38:39], 0
v_mov_b64 v[40:41], 0
v_mov_b64 v[42:43], 0
ds_read_b128 v[44:47], v2 offset:0
ds_read_b128 v[48:51], v2 offset:1024
v_bfe_u32 v77, v1, 6, 1
v_lshl_add_u32 v77, v77, 3, v1
v_lshlrev_b32 v77, 1, v77
s_waitcnt vmcnt(0) lgkmcnt(0)
s_branch L_top_w3s
L_done_w3s:
s_waitcnt vmcnt(0) lgkmcnt(0)
s_endpgm
L_ra0_w3s:
s_mov_b32 m0, 1024
s_nop 0
buffer_load_dwordx4 v1, s[4:7], s47 offen offset:0 sc0 sc1 lds
buffer_load_dwordx4 v1, s[4:7], s47 offen offset:1024 sc0 sc1 lds
buffer_load_dwordx4 v1, s[4:7], s47 offen offset:2048 sc0 sc1 lds
buffer_load_dwordx4 v1, s[4:7], s47 offen offset:3072 sc0 sc1 lds
s_sub_u32 s41, s41, 1
s_cbranch_scc1 L_exit
ds_read_b128 v[44:47], v2 offset:0
ds_read_b128 v[48:51], v2 offset:1024
v_mov_b64 v[20:21], 0
v_mov_b64 v[22:23], 0
v_mov_b64 v[24:25], 0
v_mov_b64 v[26:27], 0
v_mov_b64 v[28:29], 0
v_mov_b64 v[30:31], 0
v_mov_b64 v[32:33], 0
v_mov_b64 v[34:35], 0
v_mov_b64 v[36:37], 0
v_mov_b64 v[38:39], 0
v_mov_b64 v[40:41], 0
v_mov_b64 v[42:43], 0
s_waitcnt vmcnt(0)
ds_read_b128 v[60:63], v1 offset:1024
ds_read_b128 v[64:67], v1 offset:2048
ds_read_b128 v[68:71], v1 offset:3072
ds_read_b128 v[72:75], v1 offset:4096
s_branch L_s0_w3s
L_ra1_w3s:
L_ra2_w3s:
s_waitcnt lgkmcnt(0)
s_barrier
s_mov_b32 m0, 5120
s_nop 0
buffer_load_dwordx4 v1, s[4:7], s48 offen offset:3072 sc0 sc1 lds
s_sub_u32 s41, s41, 1
s_cbranch_scc1 L_exit
s_waitcnt vmcnt(0)
s_barrier
ds_read_b128 v[76:79], v1 offset:5120
ds_read_b128 v[60:63], v1 offset:6144
ds_read_b128 v[64:67], v1 offset:7168
ds_read_b128 v[68:71], v1 offset:8192
ds_read_b128 v[72:75], v1 offset:9216
s_waitcnt lgkmcnt(0)
v_bitop3_b32 v6, v76, v60, s35 bitop3:0x7e
v_bitop3_b32 v6, v6, v64, s35 bitop3:0xf6
v_bitop3_b32 v6, v6, v68, s35 bitop3:0xf6
v_bitop3_b32 v6, v6, v72, s35 bitop3:0xf6
v_and_b32 v6, 1, v6
v_cmp_ne_u32 vcc, 0, v6
s_mov_b32 m0, 0
v_lshlrev_b32 v6, 3, v1
s_cbranch_vccnz L_ra2_w3s
s_branch L_a1_w3s
L_mx_w3s:
s_waitcnt lgkmcnt(0)
v_max3_f32 v30, v12, v13, v28
v_max_f32 v30, v30, v29
v_mov_b32 v31, v30
s_nop 1
v_permlane16_swap_b32 v30, v31
v_max_f32 v30, v30, v31
v_mov_b32 v31, v30
s_nop 1
v_permlane32_swap_b32 v30, v31
v_max_f32 v30, v30, v31
ds_write_b32 v1, v30 offset:10252
s_waitcnt lgkmcnt(0)
s_barrier
ds_read_b128 v[32:35], v1 offset:10240
s_waitcnt lgkmcnt(0)
v_max3_f32 v32, v32, v33, v34
v_max_f32 v32, v32, v35
v_sub_f32 v14, v12, v32
v_sub_f32 v15, v13, v32
v_sub_f32 v30, v28, v32
v_sub_f32 v31, v29, v32
v_exp_f32 v14, v14
v_exp_f32 v15, v15
v_exp_f32 v30, v30
v_exp_f32 v31, v31
v_cvt_pk_bf16_f32 v14, v14, v15
v_cvt_pk_bf16_f32 v30, v30, v31
ds_write_b32 v5, v14 offset:15136
v_cndmask_b32_e64 v26, 0, v30, s[56:57]
v_cndmask_b32_e64 v27, 0, v30, s[56:57]
v_mov_b64 v[76:77], s[52:53]
v_mov_b64 v[78:79], s[52:53]
v_mov_b32_dpp v24, v26 quad_perm:[2,3,0,1] row_mask:0xf bank_mask:0xf
v_mov_b32_dpp v25, v26 quad_perm:[2,3,0,1] row_mask:0xf bank_mask:0xf
s_waitcnt lgkmcnt(0)
s_barrier
v_mov_b64 v[14:15], s[0:1]
ds_read_b128 v[16:19], v1 offset:14368
ds_read_b128 v[36:39], v1 offset:14336
s_waitcnt lgkmcnt(0)
v_mfma_f32_16x16x32_bf16 v[32:35], v[76:79], v[16:19], 0
v_mfma_f32_16x16x32_bf16 v[20:23], v[52:55], v[16:19], 0
v_mfma_f32_16x16x32_bf16 v[20:23], v[56:59], v[36:39], v[20:23]
v_mfma_f32_16x16x16_bf16 v[32:35], v[14:15], v[26:27], v[32:35]
v_mfma_f32_16x16x32_bf16 v[20:23], v[40:43], v[24:27], v[20:23]
s_nop 3
v_rcp_f32 v33, v32
s_nop 2
v_mul_f32_dpp v20, v33, v20 quad_perm:[0,1,0,1] row_mask:0xf bank_mask:0xf
v_mul_f32_dpp v21, v33, v21 quad_perm:[0,1,0,1] row_mask:0xf bank_mask:0xf
v_mul_f32_dpp v22, v33, v22 quad_perm:[0,1,0,1] row_mask:0xf bank_mask:0xf
v_mul_f32_dpp v23, v33, v23 quad_perm:[0,1,0,1] row_mask:0xf bank_mask:0xf
v_cvt_pk_bf16_f32 v20, v20, v21
v_cvt_pk_bf16_f32 v21, v22, v23
ds_write_b64 v6, v[20:21] offset:8192
v_mov_b32_dpp v16, v20 quad_perm:[0,1,0,1] row_mask:0xf bank_mask:0xf
v_mov_b32_dpp v17, v21 quad_perm:[0,1,0,1] row_mask:0xf bank_mask:0xf
v_mov_b32_dpp v18, v20 quad_perm:[2,3,2,3] row_mask:0xf bank_mask:0xf
v_mov_b32_dpp v19, v21 quad_perm:[2,3,2,3] row_mask:0xf bank_mask:0xf
v_mov_b64 v[76:77], 0
v_mov_b64 v[78:79], 0
v_mov_b64 v[36:37], 0
v_mov_b64 v[38:39], 0
v_mov_b64 v[24:25], 0
v_mov_b64 v[26:27], 0
v_mov_b64 v[32:33], 0
v_mov_b64 v[34:35], 0
s_waitcnt lgkmcnt(0)
s_branch L_mxb_w3s

L_ev_w3s:

L_kvw_w3s:
s_load_dwordx16 s[64:79], s[4:5], s101 glc
s_sub_u32 s41, s41, 1
s_cbranch_scc1 L_exit
s_waitcnt lgkmcnt(0)
s_min_u32 s64, s64, s65
s_min_u32 s64, s64, s66
s_min_u32 s64, s64, s67
s_min_u32 s64, s64, s68
s_min_u32 s64, s64, s69
s_min_u32 s64, s64, s70
s_min_u32 s64, s64, s71
s_min_u32 s64, s64, s72
s_min_u32 s64, s64, s73
s_min_u32 s64, s64, s74
s_min_u32 s64, s64, s75
s_min_u32 s64, s64, s76
s_min_u32 s64, s64, s77
s_min_u32 s64, s64, s78
s_min_u32 s64, s64, s79
s_lshl_b32 s100, s64, 2
s_sub_u32 s100, s100, 1
s_cmp_ge_i32 s34, s100
s_cbranch_scc1 L_kvw_w3s
s_branch L_evb_w3s
s_endpgm

.section .rodata,"a"
.p2align 6
.amdhsa_kernel gated_mix__sliding_local_dilated__memory_aug_recurrent_mem_tr__prompt_kernel
  .amdhsa_next_free_vgpr 512
  .amdhsa_next_free_sgpr 102
  .amdhsa_accum_offset 256
  .amdhsa_group_segment_fixed_size 0
  .amdhsa_kernarg_size 112
  .amdhsa_user_sgpr_count 2
  .amdhsa_user_sgpr_kernarg_segment_ptr 1
  .amdhsa_system_sgpr_workgroup_id_x 1
  .amdhsa_float_denorm_mode_32 3
.end_amdhsa_kernel
```

```asm
; @launch grid=(256,1,1) block=(256,1,1) lds=163840
.amdgcn_target "amdgcn-amd-amdhsa--gfx950"
.text
.globl gated_mix__sliding_local_dilated__memory_aug_recurrent_mem_tr__prompt_kernel
.p2align 8
.type gated_mix__sliding_local_dilated__memory_aug_recurrent_mem_tr__prompt_kernel,@function
gated_mix__sliding_local_dilated__memory_aug_recurrent_mem_tr__prompt_kernel:

s_cmp_ge_u32 s2, 256
s_cbranch_scc1 L_exit_w
s_and_b32 s3, s2, 7
s_lshr_b32 s32, s2, 3
s_cmp_lg_u32 s3, 0
s_cbranch_scc1 L_other
s_load_dwordx2 s[24:25], s[0:1], 32
s_load_dwordx2 s[8:9], s[0:1], 40
s_load_dwordx2 s[12:13], s[0:1], 48
s_load_dwordx2 s[16:17], s[0:1], 56
s_load_dwordx2 s[20:21], s[0:1], 64
s_load_dwordx2 s[28:29], s[0:1], 96
s_load_dwordx2 s[4:5], s[0:1], 104
s_mov_b32 s26, 9216
s_mov_b32 s27, 0x20000
s_mov_b32 s10, 4718592
s_mov_b32 s11, 0x20000
s_mov_b32 s14, 4718592
s_mov_b32 s15, 0x20000
s_mov_b32 s18, 4718592
s_mov_b32 s19, 0x20000
s_mov_b32 s22, 4718592
s_mov_b32 s23, 0x20000
s_mov_b32 s30, 256
s_mov_b32 s31, 0x20000
s_mov_b32 s6, 268435456
s_mov_b32 s7, 0x20000
v_lshrrev_b32 v1, 6, v0
v_and_b32 v21, 15, v0
v_readfirstlane_b32 s33, v1
v_bfe_u32 v22, v0, 4, 2
v_lshrrev_b32 v24, 1, v22
v_and_b32 v23, 1, v22
v_lshl_add_u32 v23, v24, 3, v23
v_lshlrev_b32 v23, 13, v23
v_lshlrev_b32 v26, 1, v22
v_xor_b32 v26, v26, v21
v_lshl_add_u32 v26, v26, 4, v23
v_xor_b32 v27, 128, v26
s_lshl_b32 s54, s32, 8
s_lshl_b32 s55, s33, 17
s_add_u32 s55, s55, s54
s_mul_i32 s57, s33, 40960
s_min_u32 s57, s57, 114688
s_waitcnt lgkmcnt(0)
s_add_u32 s56, s55, 524288
s_add_u32 m0, s57, 36864
s_nop 0
buffer_load_dwordx4 v26, s[8:11], s56 offen lds
s_add_u32 s56, s55, 540672
s_add_u32 m0, s57, 37888
s_nop 0
buffer_load_dwordx4 v26, s[8:11], s56 offen lds
s_add_u32 s56, s55, 557056
s_add_u32 m0, s57, 38912
s_nop 0
buffer_load_dwordx4 v27, s[8:11], s56 offen lds
s_add_u32 s56, s55, 573440
s_add_u32 m0, s57, 39936
s_nop 0
buffer_load_dwordx4 v27, s[8:11], s56 offen lds
s_add_u32 s56, s55, 1048576
s_add_u32 m0, s57, 40960
s_nop 0
buffer_load_dwordx4 v26, s[8:11], s56 offen lds
s_add_u32 s56, s55, 1064960
s_add_u32 m0, s57, 41984
s_nop 0
buffer_load_dwordx4 v26, s[8:11], s56 offen lds
s_add_u32 s56, s55, 1081344
s_add_u32 m0, s57, 43008
s_nop 0
buffer_load_dwordx4 v27, s[8:11], s56 offen lds
s_add_u32 s56, s55, 1097728
s_add_u32 m0, s57, 44032
s_nop 0
buffer_load_dwordx4 v27, s[8:11], s56 offen lds
s_add_u32 s56, s55, 2621440
s_add_u32 m0, s57, 45056
s_nop 0
buffer_load_dwordx4 v26, s[8:11], s56 offen lds
s_add_u32 s56, s55, 2637824
s_add_u32 m0, s57, 46080
s_nop 0
buffer_load_dwordx4 v26, s[8:11], s56 offen lds
s_add_u32 s56, s55, 2654208
s_add_u32 m0, s57, 47104
s_nop 0
buffer_load_dwordx4 v27, s[8:11], s56 offen lds
s_add_u32 s56, s55, 2670592
s_add_u32 m0, s57, 48128
s_nop 0
buffer_load_dwordx4 v27, s[8:11], s56 offen lds
s_add_u32 s56, s55, 3145728
s_add_u32 m0, s57, 16384
s_nop 0
buffer_load_dwordx4 v26, s[8:11], s56 offen lds
s_add_u32 s56, s55, 3162112
s_add_u32 m0, s57, 17408
s_nop 0
buffer_load_dwordx4 v26, s[8:11], s56 offen lds
s_add_u32 s56, s55, 3178496
s_add_u32 m0, s57, 18432
s_nop 0
buffer_load_dwordx4 v27, s[8:11], s56 offen lds
s_add_u32 s56, s55, 3194880
s_add_u32 m0, s57, 19456
s_nop 0
buffer_load_dwordx4 v27, s[8:11], s56 offen lds
s_add_u32 s56, s55, 3670016
s_add_u32 m0, s57, 20480
s_nop 0
buffer_load_dwordx4 v26, s[8:11], s56 offen lds
s_add_u32 s56, s55, 3686400
s_add_u32 m0, s57, 21504
s_nop 0
buffer_load_dwordx4 v26, s[8:11], s56 offen lds
s_add_u32 s56, s55, 3702784
s_add_u32 m0, s57, 22528
s_nop 0
buffer_load_dwordx4 v27, s[8:11], s56 offen lds
s_add_u32 s56, s55, 3719168
s_add_u32 m0, s57, 23552
s_nop 0
buffer_load_dwordx4 v27, s[8:11], s56 offen lds
s_add_u32 s56, s55, 4194304
s_add_u32 m0, s57, 24576
s_nop 0
buffer_load_dwordx4 v26, s[8:11], s56 offen lds
s_add_u32 s56, s55, 4210688
s_add_u32 m0, s57, 25600
s_nop 0
buffer_load_dwordx4 v26, s[8:11], s56 offen lds
s_add_u32 s56, s55, 4227072
s_add_u32 m0, s57, 26624
s_nop 0
buffer_load_dwordx4 v27, s[8:11], s56 offen lds
s_add_u32 s56, s55, 4243456
s_add_u32 m0, s57, 27648
s_nop 0
buffer_load_dwordx4 v27, s[8:11], s56 offen lds
s_cmp_eq_u32 s33, 1
s_cbranch_scc1 L_pro_w1r
s_cmp_eq_u32 s33, 2
s_cbranch_scc1 L_pro_w2r
s_cmp_eq_u32 s33, 3
s_cbranch_scc1 L_pro_w3
s_cmp_lt_u32 s32, 8
s_cbranch_scc1 L_pro_w0r
s_branch L_pro_w0
L_exit:
s_endpgm

L_other:
s_lshl_b32 s3, s3, 2
s_lshr_b32 s3, 0x43652170, s3
s_and_b32 s3, s3, 7
s_cmp_ge_u32 s3, 5
s_cbranch_scc1 L_pre_aw
s_lshr_b32 s33, s32, 3
s_and_b32 s32, s32, 7
s_sub_u32 s3, s3, 1
s_lshl_b32 s3, s3, 3
s_add_u32 s32, s32, s3
s_branch L_role_q
L_pre_aw:
s_sub_u32 s3, s3, 5
s_lshl_b32 s49, s3, 5
s_add_u32 s49, s49, s32
s_lshr_b32 s33, s49, 3
s_and_b32 s32, s32, 7
s_mul_i32 s48, s49, 43
s_lshr_b32 s48, s48, 9
s_mul_i32 s3, s48, 12
s_sub_u32 s49, s49, s3
s_branch L_role_aw
L_exit_w:
s_endpgm
L_role_q:
s_load_dwordx2 s[4:5], s[0:1], 104
s_mov_b32 s6, 268435456
s_mov_b32 s7, 0x20000
s_load_dwordx2 s[8:9], s[0:1], 0
s_mov_b32 s10, 2359296
s_mov_b32 s11, 0x20000
s_load_dwordx2 s[12:13], s[0:1], 40
s_mov_b32 s14, 4718592
s_mov_b32 s15, 0x20000
s_load_dwordx2 s[16:17], s[0:1], 48
s_mov_b32 s18, 4718592
s_mov_b32 s19, 0x20000
s_load_dwordx2 s[20:21], s[0:1], 56
s_mov_b32 s22, 4718592
s_mov_b32 s23, 0x20000
s_load_dwordx2 s[24:25], s[0:1], 96
s_mov_b32 s26, 256
s_mov_b32 s27, 0x20000
v_and_b32 v9, 63, v0
v_and_b32 v10, 15, v0
v_bfe_u32 v11, v0, 4, 2
v_lshrrev_b32 v1, 6, v0
s_nop 0
v_readfirstlane_b32 s34, v1
v_lshrrev_b32 v12, 2, v9
v_mul_u32_u24 v2, 1152, v12
v_lshrrev_b32 v12, 5, v9
v_lshlrev_b32 v12, 1, v12
v_and_b32 v13, 3, v9
v_xor_b32 v12, v12, v13
v_lshl_add_u32 v2, v12, 4, v2
v_lshrrev_b32 v12, 3, v10
v_lshlrev_b32 v12, 1, v12
v_xor_b32 v12, v12, v11
v_lshlrev_b32 v12, 4, v12
v_lshl_add_u32 v3, v10, 6, v12
v_lshlrev_b32 v12, 13, v11
v_lshlrev_b32 v5, 1, v11
v_xor_b32 v5, v5, v10
v_lshl_add_u32 v5, v5, 4, v12
v_xor_b32 v6, 128, v5
v_lshlrev_b32 v1, 4, v9
s_mul_i32 s38, s34, 20480
s_add_u32 s38, s38, 73728
s_lshl_b32 s39, s32, 8
s_lshl_b32 s40, s34, 17
s_add_u32 s39, s39, s40
s_lshl_b32 s43, s33, 1
s_and_b32 s41, s34, 1
s_add_u32 s43, s43, s41
s_mul_i32 s43, s43, 18432
s_lshr_b32 s41, s34, 1
s_lshl_b32 s41, s41, 6
s_add_u32 s43, s43, s41
s_lshl_b32 s44, s34, 10
s_mov_b32 s36, 400000
s_mov_b32 s46, 0x3e0293ee
s_mov_b32 s47, 0x3e0293ee
v_mov_b32 v8, 0
v_lshrrev_b32 v12, 2, v10
v_lshlrev_b32 v4, 12, v12
v_lshl_add_u32 v4, v11, 8, v4
v_and_b32 v12, 3, v10
v_lshl_add_u32 v4, v12, 4, v4
s_waitcnt lgkmcnt(0)
s_add_u32 s37, s39, 0
s_add_u32 m0, s38, 0
s_nop 0
buffer_load_dwordx4 v5, s[12:15], s37 offen lds
s_add_u32 s37, s39, 32768
s_add_u32 m0, s38, 1024
s_nop 0
buffer_load_dwordx4 v5, s[12:15], s37 offen lds
s_add_u32 s37, s39, 65536
s_add_u32 m0, s38, 2048
s_nop 0
buffer_load_dwordx4 v6, s[12:15], s37 offen lds
s_add_u32 s37, s39, 98304
s_add_u32 m0, s38, 3072
s_nop 0
buffer_load_dwordx4 v6, s[12:15], s37 offen lds
s_add_u32 s37, s39, 524288
s_add_u32 m0, s38, 4096
s_nop 0
buffer_load_dwordx4 v5, s[12:15], s37 offen lds
s_add_u32 s37, s39, 557056
s_add_u32 m0, s38, 5120
s_nop 0
buffer_load_dwordx4 v5, s[12:15], s37 offen lds
s_add_u32 s37, s39, 589824
s_add_u32 m0, s38, 6144
s_nop 0
buffer_load_dwordx4 v6, s[12:15], s37 offen lds
s_add_u32 s37, s39, 622592
s_add_u32 m0, s38, 7168
s_nop 0
buffer_load_dwordx4 v6, s[12:15], s37 offen lds
s_add_u32 s37, s39, 1048576
s_add_u32 m0, s38, 8192
s_nop 0
buffer_load_dwordx4 v5, s[12:15], s37 offen lds
s_add_u32 s37, s39, 1081344
s_add_u32 m0, s38, 9216
s_nop 0
buffer_load_dwordx4 v5, s[12:15], s37 offen lds
s_add_u32 s37, s39, 1114112
s_add_u32 m0, s38, 10240
s_nop 0
buffer_load_dwordx4 v6, s[12:15], s37 offen lds
s_add_u32 s37, s39, 1146880
s_add_u32 m0, s38, 11264
s_nop 0
buffer_load_dwordx4 v6, s[12:15], s37 offen lds
s_add_u32 s37, s39, 1572864
s_add_u32 m0, s38, 12288
s_nop 0
buffer_load_dwordx4 v5, s[12:15], s37 offen lds
s_add_u32 s37, s39, 1605632
s_add_u32 m0, s38, 13312
s_nop 0
buffer_load_dwordx4 v5, s[12:15], s37 offen lds
s_add_u32 s37, s39, 1638400
s_add_u32 m0, s38, 14336
s_nop 0
buffer_load_dwordx4 v6, s[12:15], s37 offen lds
s_add_u32 s37, s39, 1671168
s_add_u32 m0, s38, 15360
s_nop 0
buffer_load_dwordx4 v6, s[12:15], s37 offen lds
s_add_u32 s37, s39, 2097152
s_add_u32 m0, s38, 16384
s_nop 0
buffer_load_dwordx4 v5, s[12:15], s37 offen lds
s_add_u32 s37, s39, 2129920
s_add_u32 m0, s38, 17408
s_nop 0
buffer_load_dwordx4 v5, s[12:15], s37 offen lds
s_add_u32 s37, s39, 2162688
s_add_u32 m0, s38, 18432
s_nop 0
buffer_load_dwordx4 v6, s[12:15], s37 offen lds
s_add_u32 s37, s39, 2195456
s_add_u32 m0, s38, 19456
s_nop 0
buffer_load_dwordx4 v6, s[12:15], s37 offen lds
s_add_u32 s37, s43, 0
s_add_u32 m0, s44, 0
s_nop 0
buffer_load_dwordx4 v2, s[8:11], s37 offen lds
s_add_u32 s37, s43, 128
s_add_u32 m0, s44, 4096
s_nop 0
buffer_load_dwordx4 v2, s[8:11], s37 offen lds
s_add_u32 s37, s43, 256
s_add_u32 m0, s44, 8192
s_nop 0
buffer_load_dwordx4 v2, s[8:11], s37 offen lds
s_add_u32 s37, s43, 384
s_add_u32 m0, s44, 12288
s_nop 0
buffer_load_dwordx4 v2, s[8:11], s37 offen lds
s_add_u32 s37, s43, 512
s_add_u32 m0, s44, 16384
s_nop 0
buffer_load_dwordx4 v2, s[8:11], s37 offen lds
s_add_u32 s37, s43, 640
s_add_u32 m0, s44, 20480
s_nop 0
buffer_load_dwordx4 v2, s[8:11], s37 offen lds
s_add_u32 s37, s43, 768
s_add_u32 m0, s44, 24576
s_nop 0
buffer_load_dwordx4 v2, s[8:11], s37 offen lds
s_add_u32 s37, s43, 896
s_add_u32 m0, s44, 28672
s_nop 0
buffer_load_dwordx4 v2, s[8:11], s37 offen lds
s_add_u32 s37, s43, 1024
s_add_u32 m0, s44, 32768
s_nop 0
buffer_load_dwordx4 v2, s[8:11], s37 offen lds
s_lshr_b32 s40, s34, 1
s_lshl_b32 s40, s40, 3
s_and_b32 s41, s34, 1
s_lshl_b32 s41, s41, 1
s_add_u32 s40, s40, s41
s_add_u32 s40, s40, 0
s_lshl_b32 s41, s34, 2
s_add_u32 s41, s41, 0
v_and_b32 v12, 1, v11
v_lshrrev_b32 v13, 2, v10
v_lshl_add_u32 v12, v12, 2, v13
v_lshlrev_b32 v12, 1, v12
v_bfe_u32 v16, v10, 1, 1
v_add_u32 v16, s40, v16
v_xor_b32 v16, v16, v12
v_lshlrev_b32 v16, 4, v16
v_lshl_add_u32 v16, v13, 8, v16
v_and_b32 v12, 1, v11
v_lshl_add_u32 v16, v12, 11, v16
v_and_b32 v12, 1, v10
v_lshl_add_u32 v16, v12, 3, v16
v_lshrrev_b32 v12, 1, v11
v_mul_u32_u24 v12, 20480, v12
v_add_u32 v12, 73728, v12
v_add_u32 v16, v16, v12
v_and_b32 v12, 1, v11
v_lshrrev_b32 v13, 2, v10
v_lshl_add_u32 v12, v12, 2, v13
v_lshlrev_b32 v12, 1, v12
v_bfe_u32 v20, v10, 1, 1
v_add_u32 v20, s41, v20
v_xor_b32 v20, v20, v12
v_lshlrev_b32 v20, 4, v20
v_lshl_add_u32 v20, v13, 8, v20
v_and_b32 v12, 1, v11
v_lshl_add_u32 v20, v12, 11, v20
v_and_b32 v12, 1, v10
v_lshl_add_u32 v20, v12, 3, v20
v_lshrrev_b32 v12, 1, v11
v_mul_u32_u24 v12, 20480, v12
v_add_u32 v12, 73728, v12
v_add_u32 v20, v20, v12
v_and_b32 v12, 1, v11
v_lshrrev_b32 v13, 2, v10
v_lshl_add_u32 v12, v12, 2, v13
v_lshlrev_b32 v12, 1, v12
v_bfe_u32 v18, v10, 1, 1
v_add_u32 v18, s40, v18
v_xor_b32 v18, v18, v12
v_lshlrev_b32 v18, 4, v18
v_lshl_add_u32 v18, v13, 8, v18
v_and_b32 v12, 1, v11
v_lshl_add_u32 v18, v12, 11, v18
v_and_b32 v12, 1, v10
v_lshl_add_u32 v18, v12, 3, v18
v_lshrrev_b32 v12, 1, v11
v_mul_u32_u24 v12, 20480, v12
v_add_u32 v12, 114688, v12
v_add_u32 v18, v18, v12
v_and_b32 v12, 1, v11
v_lshrrev_b32 v13, 2, v10
v_lshl_add_u32 v12, v12, 2, v13
v_lshlrev_b32 v12, 1, v12
v_bfe_u32 v22, v10, 1, 1
v_add_u32 v22, s41, v22
v_xor_b32 v22, v22, v12
v_lshlrev_b32 v22, 4, v22
v_lshl_add_u32 v22, v13, 8, v22
v_and_b32 v12, 1, v11
v_lshl_add_u32 v22, v12, 11, v22
v_and_b32 v12, 1, v10
v_lshl_add_u32 v22, v12, 3, v22
v_lshrrev_b32 v12, 1, v11
v_mul_u32_u24 v12, 20480, v12
v_add_u32 v12, 114688, v12
v_add_u32 v22, v22, v12
s_lshr_b32 s40, s34, 1
s_lshl_b32 s40, s40, 3
s_and_b32 s41, s34, 1
s_lshl_b32 s41, s41, 1
s_add_u32 s40, s40, s41
s_add_u32 s40, s40, 4
s_lshl_b32 s41, s34, 2
s_add_u32 s41, s41, 2
v_and_b32 v12, 1, v11
v_lshrrev_b32 v13, 2, v10
v_lshl_add_u32 v12, v12, 2, v13
v_lshlrev_b32 v12, 1, v12
v_bfe_u32 v17, v10, 1, 1
v_add_u32 v17, s40, v17
v_xor_b32 v17, v17, v12
v_lshlrev_b32 v17, 4, v17
v_lshl_add_u32 v17, v13, 8, v17
v_and_b32 v12, 1, v11
v_lshl_add_u32 v17, v12, 11, v17
v_and_b32 v12, 1, v10
v_lshl_add_u32 v17, v12, 3, v17
v_lshrrev_b32 v12, 1, v11
v_mul_u32_u24 v12, 20480, v12
v_add_u32 v12, 73728, v12
v_add_u32 v17, v17, v12
v_and_b32 v12, 1, v11
v_lshrrev_b32 v13, 2, v10
v_lshl_add_u32 v12, v12, 2, v13
v_lshlrev_b32 v12, 1, v12
v_bfe_u32 v21, v10, 1, 1
v_add_u32 v21, s41, v21
v_xor_b32 v21, v21, v12
v_lshlrev_b32 v21, 4, v21
v_lshl_add_u32 v21, v13, 8, v21
v_and_b32 v12, 1, v11
v_lshl_add_u32 v21, v12, 11, v21
v_and_b32 v12, 1, v10
v_lshl_add_u32 v21, v12, 3, v21
v_lshrrev_b32 v12, 1, v11
v_mul_u32_u24 v12, 20480, v12
v_add_u32 v12, 73728, v12
v_add_u32 v21, v21, v12
v_and_b32 v12, 1, v11
v_lshrrev_b32 v13, 2, v10
v_lshl_add_u32 v12, v12, 2, v13
v_lshlrev_b32 v12, 1, v12
v_bfe_u32 v19, v10, 1, 1
v_add_u32 v19, s40, v19
v_xor_b32 v19, v19, v12
v_lshlrev_b32 v19, 4, v19
v_lshl_add_u32 v19, v13, 8, v19
v_and_b32 v12, 1, v11
v_lshl_add_u32 v19, v12, 11, v19
v_and_b32 v12, 1, v10
v_lshl_add_u32 v19, v12, 3, v19
v_lshrrev_b32 v12, 1, v11
v_mul_u32_u24 v12, 20480, v12
v_add_u32 v12, 114688, v12
v_add_u32 v19, v19, v12
v_and_b32 v12, 1, v11
v_lshrrev_b32 v13, 2, v10
v_lshl_add_u32 v12, v12, 2, v13
v_lshlrev_b32 v12, 1, v12
v_bfe_u32 v23, v10, 1, 1
v_add_u32 v23, s41, v23
v_xor_b32 v23, v23, v12
v_lshlrev_b32 v23, 4, v23
v_lshl_add_u32 v23, v13, 8, v23
v_and_b32 v12, 1, v11
v_lshl_add_u32 v23, v12, 11, v23
v_and_b32 v12, 1, v10
v_lshl_add_u32 v23, v12, 3, v23
v_lshrrev_b32 v12, 1, v11
v_mul_u32_u24 v12, 20480, v12
v_add_u32 v12, 114688, v12
v_add_u32 v23, v23, v12
s_waitcnt vmcnt(25)
s_barrier
ds_read_b64_tr_b16 v[80:81], v16 offset:0
ds_read_b64_tr_b16 v[82:83], v16 offset:1024
ds_read_b64_tr_b16 v[84:85], v18 offset:0
ds_read_b64_tr_b16 v[86:87], v18 offset:1024
ds_read_b64_tr_b16 v[152:153], v17 offset:0
ds_read_b64_tr_b16 v[154:155], v17 offset:1024
ds_read_b64_tr_b16 v[156:157], v19 offset:0
ds_read_b64_tr_b16 v[158:159], v19 offset:1024
s_waitcnt lgkmcnt(0)
s_waitcnt vmcnt(21)
s_barrier
s_add_u32 s37, s39, 2621440
s_add_u32 m0, s38, 0
s_nop 0
buffer_load_dwordx4 v5, s[12:15], s37 offen lds
s_add_u32 s37, s39, 2654208
s_add_u32 m0, s38, 1024
s_nop 0
buffer_load_dwordx4 v5, s[12:15], s37 offen lds
s_add_u32 s37, s39, 2686976
s_add_u32 m0, s38, 2048
s_nop 0
buffer_load_dwordx4 v6, s[12:15], s37 offen lds
s_add_u32 s37, s39, 2719744
s_add_u32 m0, s38, 3072
s_nop 0
buffer_load_dwordx4 v6, s[12:15], s37 offen lds
ds_read_b64_tr_b16 v[88:89], v16 offset:4096
ds_read_b64_tr_b16 v[90:91], v16 offset:5120
ds_read_b64_tr_b16 v[92:93], v18 offset:4096
ds_read_b64_tr_b16 v[94:95], v18 offset:5120
ds_read_b64_tr_b16 v[160:161], v17 offset:4096
ds_read_b64_tr_b16 v[162:163], v17 offset:5120
ds_read_b64_tr_b16 v[164:165], v19 offset:4096
ds_read_b64_tr_b16 v[166:167], v19 offset:5120
s_waitcnt lgkmcnt(0)
s_waitcnt vmcnt(21)
s_barrier
s_add_u32 s37, s39, 3145728
s_add_u32 m0, s38, 4096
s_nop 0
buffer_load_dwordx4 v5, s[12:15], s37 offen lds
s_add_u32 s37, s39, 3178496
s_add_u32 m0, s38, 5120
s_nop 0
buffer_load_dwordx4 v5, s[12:15], s37 offen lds
s_add_u32 s37, s39, 3211264
s_add_u32 m0, s38, 6144
s_nop 0
buffer_load_dwordx4 v6, s[12:15], s37 offen lds
s_add_u32 s37, s39, 3244032
s_add_u32 m0, s38, 7168
s_nop 0
buffer_load_dwordx4 v6, s[12:15], s37 offen lds
ds_read_b64_tr_b16 v[96:97], v16 offset:8192
ds_read_b64_tr_b16 v[98:99], v16 offset:9216
ds_read_b64_tr_b16 v[100:101], v18 offset:8192
ds_read_b64_tr_b16 v[102:103], v18 offset:9216
ds_read_b64_tr_b16 v[168:169], v17 offset:8192
ds_read_b64_tr_b16 v[170:171], v17 offset:9216
ds_read_b64_tr_b16 v[172:173], v19 offset:8192
ds_read_b64_tr_b16 v[174:175], v19 offset:9216
s_waitcnt lgkmcnt(0)
s_waitcnt vmcnt(21)
s_barrier
s_add_u32 s37, s39, 3670016
s_add_u32 m0, s38, 8192
s_nop 0
buffer_load_dwordx4 v5, s[12:15], s37 offen lds
s_add_u32 s37, s39, 3702784
s_add_u32 m0, s38, 9216
s_nop 0
buffer_load_dwordx4 v5, s[12:15], s37 offen lds
s_add_u32 s37, s39, 3735552
s_add_u32 m0, s38, 10240
s_nop 0
buffer_load_dwordx4 v6, s[12:15], s37 offen lds
s_add_u32 s37, s39, 3768320
s_add_u32 m0, s38, 11264
s_nop 0
buffer_load_dwordx4 v6, s[12:15], s37 offen lds
ds_read_b64_tr_b16 v[104:105], v16 offset:12288
ds_read_b64_tr_b16 v[106:107], v16 offset:13312
ds_read_b64_tr_b16 v[108:109], v18 offset:12288
ds_read_b64_tr_b16 v[110:111], v18 offset:13312
ds_read_b64_tr_b16 v[176:177], v17 offset:12288
ds_read_b64_tr_b16 v[178:179], v17 offset:13312
ds_read_b64_tr_b16 v[180:181], v19 offset:12288
ds_read_b64_tr_b16 v[182:183], v19 offset:13312
s_waitcnt lgkmcnt(0)
s_waitcnt vmcnt(21)
s_barrier
s_add_u32 s37, s39, 4194304
s_add_u32 m0, s38, 12288
s_nop 0
buffer_load_dwordx4 v5, s[12:15], s37 offen lds
s_add_u32 s37, s39, 4227072
s_add_u32 m0, s38, 13312
s_nop 0
buffer_load_dwordx4 v5, s[12:15], s37 offen lds
s_add_u32 s37, s39, 4259840
s_add_u32 m0, s38, 14336
s_nop 0
buffer_load_dwordx4 v6, s[12:15], s37 offen lds
s_add_u32 s37, s39, 4292608
s_add_u32 m0, s38, 15360
s_nop 0
buffer_load_dwordx4 v6, s[12:15], s37 offen lds
ds_read_b64_tr_b16 v[112:113], v16 offset:16384
ds_read_b64_tr_b16 v[114:115], v16 offset:17408
ds_read_b64_tr_b16 v[116:117], v18 offset:16384
ds_read_b64_tr_b16 v[118:119], v18 offset:17408
ds_read_b64_tr_b16 v[184:185], v17 offset:16384
ds_read_b64_tr_b16 v[186:187], v17 offset:17408
ds_read_b64_tr_b16 v[188:189], v19 offset:16384
ds_read_b64_tr_b16 v[190:191], v19 offset:17408
s_waitcnt lgkmcnt(0)
s_waitcnt vmcnt(12)
s_barrier
s_add_u32 s37, s39, 0
s_add_u32 m0, s38, 16384
s_nop 0
buffer_load_dwordx4 v5, s[16:19], s37 offen lds
s_add_u32 s37, s39, 32768
s_add_u32 m0, s38, 17408
s_nop 0
buffer_load_dwordx4 v5, s[16:19], s37 offen lds
s_add_u32 s37, s39, 65536
s_add_u32 m0, s38, 18432
s_nop 0
buffer_load_dwordx4 v6, s[16:19], s37 offen lds
s_add_u32 s37, s39, 98304
s_add_u32 m0, s38, 19456
s_nop 0
buffer_load_dwordx4 v6, s[16:19], s37 offen lds
ds_read_b64_tr_b16 v[120:121], v16 offset:0
ds_read_b64_tr_b16 v[122:123], v16 offset:1024
ds_read_b64_tr_b16 v[124:125], v18 offset:0
ds_read_b64_tr_b16 v[126:127], v18 offset:1024
ds_read_b64_tr_b16 v[192:193], v17 offset:0
ds_read_b64_tr_b16 v[194:195], v17 offset:1024
ds_read_b64_tr_b16 v[196:197], v19 offset:0
ds_read_b64_tr_b16 v[198:199], v19 offset:1024
s_waitcnt lgkmcnt(0)
s_waitcnt vmcnt(12)
s_barrier
s_add_u32 s37, s39, 524288
s_add_u32 m0, s38, 0
s_nop 0
buffer_load_dwordx4 v5, s[16:19], s37 offen lds
s_add_u32 s37, s39, 557056
s_add_u32 m0, s38, 1024
s_nop 0
buffer_load_dwordx4 v5, s[16:19], s37 offen lds
s_add_u32 s37, s39, 589824
s_add_u32 m0, s38, 2048
s_nop 0
buffer_load_dwordx4 v6, s[16:19], s37 offen lds
s_add_u32 s37, s39, 622592
s_add_u32 m0, s38, 3072
s_nop 0
buffer_load_dwordx4 v6, s[16:19], s37 offen lds
ds_read_b64_tr_b16 v[128:129], v16 offset:4096
ds_read_b64_tr_b16 v[130:131], v16 offset:5120
ds_read_b64_tr_b16 v[132:133], v18 offset:4096
ds_read_b64_tr_b16 v[134:135], v18 offset:5120
ds_read_b64_tr_b16 v[200:201], v17 offset:4096
ds_read_b64_tr_b16 v[202:203], v17 offset:5120
ds_read_b64_tr_b16 v[204:205], v19 offset:4096
ds_read_b64_tr_b16 v[206:207], v19 offset:5120
s_waitcnt lgkmcnt(0)
s_waitcnt vmcnt(12)
s_barrier
s_add_u32 s37, s39, 1048576
s_add_u32 m0, s38, 4096
s_nop 0
buffer_load_dwordx4 v5, s[16:19], s37 offen lds
s_add_u32 s37, s39, 1081344
s_add_u32 m0, s38, 5120
s_nop 0
buffer_load_dwordx4 v5, s[16:19], s37 offen lds
s_add_u32 s37, s39, 1114112
s_add_u32 m0, s38, 6144
s_nop 0
buffer_load_dwordx4 v6, s[16:19], s37 offen lds
s_add_u32 s37, s39, 1146880
s_add_u32 m0, s38, 7168
s_nop 0
buffer_load_dwordx4 v6, s[16:19], s37 offen lds
ds_read_b64_tr_b16 v[136:137], v16 offset:8192
ds_read_b64_tr_b16 v[138:139], v16 offset:9216
ds_read_b64_tr_b16 v[140:141], v18 offset:8192
ds_read_b64_tr_b16 v[142:143], v18 offset:9216
ds_read_b64_tr_b16 v[208:209], v17 offset:8192
ds_read_b64_tr_b16 v[210:211], v17 offset:9216
ds_read_b64_tr_b16 v[212:213], v19 offset:8192
ds_read_b64_tr_b16 v[214:215], v19 offset:9216
s_waitcnt lgkmcnt(0)
s_waitcnt vmcnt(12)
s_barrier
s_add_u32 s37, s39, 1572864
s_add_u32 m0, s38, 8192
s_nop 0
buffer_load_dwordx4 v5, s[16:19], s37 offen lds
s_add_u32 s37, s39, 1605632
s_add_u32 m0, s38, 9216
s_nop 0
buffer_load_dwordx4 v5, s[16:19], s37 offen lds
s_add_u32 s37, s39, 1638400
s_add_u32 m0, s38, 10240
s_nop 0
buffer_load_dwordx4 v6, s[16:19], s37 offen lds
s_add_u32 s37, s39, 1671168
s_add_u32 m0, s38, 11264
s_nop 0
buffer_load_dwordx4 v6, s[16:19], s37 offen lds
ds_read_b64_tr_b16 v[144:145], v16 offset:12288
ds_read_b64_tr_b16 v[146:147], v16 offset:13312
ds_read_b64_tr_b16 v[148:149], v18 offset:12288
ds_read_b64_tr_b16 v[150:151], v18 offset:13312
ds_read_b64_tr_b16 v[216:217], v17 offset:12288
ds_read_b64_tr_b16 v[218:219], v17 offset:13312
ds_read_b64_tr_b16 v[220:221], v19 offset:12288
ds_read_b64_tr_b16 v[222:223], v19 offset:13312
s_waitcnt lgkmcnt(0)
s_waitcnt vmcnt(12)
s_barrier
s_add_u32 s37, s39, 2097152
s_add_u32 m0, s38, 12288
s_nop 0
buffer_load_dwordx4 v5, s[16:19], s37 offen lds
s_add_u32 s37, s39, 2129920
s_add_u32 m0, s38, 13312
s_nop 0
buffer_load_dwordx4 v5, s[16:19], s37 offen lds
s_add_u32 s37, s39, 2162688
s_add_u32 m0, s38, 14336
s_nop 0
buffer_load_dwordx4 v6, s[16:19], s37 offen lds
s_add_u32 s37, s39, 2195456
s_add_u32 m0, s38, 15360
s_nop 0
buffer_load_dwordx4 v6, s[16:19], s37 offen lds
ds_read_b64_tr_b16 v[224:225], v16 offset:16384
ds_read_b64_tr_b16 v[226:227], v16 offset:17408
ds_read_b64_tr_b16 v[228:229], v18 offset:16384
ds_read_b64_tr_b16 v[230:231], v18 offset:17408
ds_read_b64_tr_b16 a[40:41], v17 offset:16384
ds_read_b64_tr_b16 a[42:43], v17 offset:17408
ds_read_b64_tr_b16 a[44:45], v19 offset:16384
ds_read_b64_tr_b16 a[46:47], v19 offset:17408
s_waitcnt lgkmcnt(0)
s_waitcnt vmcnt(12)
s_barrier
s_add_u32 s37, s39, 2621440
s_add_u32 m0, s38, 16384
s_nop 0
buffer_load_dwordx4 v5, s[16:19], s37 offen lds
s_add_u32 s37, s39, 2654208
s_add_u32 m0, s38, 17408
s_nop 0
buffer_load_dwordx4 v5, s[16:19], s37 offen lds
s_add_u32 s37, s39, 2686976
s_add_u32 m0, s38, 18432
s_nop 0
buffer_load_dwordx4 v6, s[16:19], s37 offen lds
s_add_u32 s37, s39, 2719744
s_add_u32 m0, s38, 19456
s_nop 0
buffer_load_dwordx4 v6, s[16:19], s37 offen lds
ds_read_b64_tr_b16 v[232:233], v16 offset:0
ds_read_b64_tr_b16 v[234:235], v16 offset:1024
ds_read_b64_tr_b16 v[236:237], v18 offset:0
ds_read_b64_tr_b16 v[238:239], v18 offset:1024
ds_read_b64_tr_b16 a[48:49], v17 offset:0
ds_read_b64_tr_b16 a[50:51], v17 offset:1024
ds_read_b64_tr_b16 a[52:53], v19 offset:0
ds_read_b64_tr_b16 a[54:55], v19 offset:1024
s_waitcnt lgkmcnt(0)
s_waitcnt vmcnt(12)
s_barrier
s_add_u32 s37, s39, 3145728
s_add_u32 m0, s38, 0
s_nop 0
buffer_load_dwordx4 v5, s[16:19], s37 offen lds
s_add_u32 s37, s39, 3178496
s_add_u32 m0, s38, 1024
s_nop 0
buffer_load_dwordx4 v5, s[16:19], s37 offen lds
s_add_u32 s37, s39, 3211264
s_add_u32 m0, s38, 2048
s_nop 0
buffer_load_dwordx4 v6, s[16:19], s37 offen lds
s_add_u32 s37, s39, 3244032
s_add_u32 m0, s38, 3072
s_nop 0
buffer_load_dwordx4 v6, s[16:19], s37 offen lds
ds_read_b64_tr_b16 v[240:241], v16 offset:4096
ds_read_b64_tr_b16 v[242:243], v16 offset:5120
ds_read_b64_tr_b16 v[244:245], v18 offset:4096
ds_read_b64_tr_b16 v[246:247], v18 offset:5120
ds_read_b64_tr_b16 a[56:57], v17 offset:4096
ds_read_b64_tr_b16 a[58:59], v17 offset:5120
ds_read_b64_tr_b16 a[60:61], v19 offset:4096
ds_read_b64_tr_b16 a[62:63], v19 offset:5120
s_waitcnt lgkmcnt(0)
s_waitcnt vmcnt(12)
s_barrier
s_add_u32 s37, s39, 3670016
s_add_u32 m0, s38, 4096
s_nop 0
buffer_load_dwordx4 v5, s[16:19], s37 offen lds
s_add_u32 s37, s39, 3702784
s_add_u32 m0, s38, 5120
s_nop 0
buffer_load_dwordx4 v5, s[16:19], s37 offen lds
s_add_u32 s37, s39, 3735552
s_add_u32 m0, s38, 6144
s_nop 0
buffer_load_dwordx4 v6, s[16:19], s37 offen lds
s_add_u32 s37, s39, 3768320
s_add_u32 m0, s38, 7168
s_nop 0
buffer_load_dwordx4 v6, s[16:19], s37 offen lds
ds_read_b64_tr_b16 v[248:249], v16 offset:8192
ds_read_b64_tr_b16 v[250:251], v16 offset:9216
ds_read_b64_tr_b16 v[252:253], v18 offset:8192
ds_read_b64_tr_b16 v[254:255], v18 offset:9216
ds_read_b64_tr_b16 a[64:65], v17 offset:8192
ds_read_b64_tr_b16 a[66:67], v17 offset:9216
ds_read_b64_tr_b16 a[68:69], v19 offset:8192
ds_read_b64_tr_b16 a[70:71], v19 offset:9216
s_waitcnt lgkmcnt(0)
s_waitcnt vmcnt(12)
s_barrier
s_add_u32 s37, s39, 4194304
s_add_u32 m0, s38, 8192
s_nop 0
buffer_load_dwordx4 v5, s[16:19], s37 offen lds
s_add_u32 s37, s39, 4227072
s_add_u32 m0, s38, 9216
s_nop 0
buffer_load_dwordx4 v5, s[16:19], s37 offen lds
s_add_u32 s37, s39, 4259840
s_add_u32 m0, s38, 10240
s_nop 0
buffer_load_dwordx4 v6, s[16:19], s37 offen lds
s_add_u32 s37, s39, 4292608
s_add_u32 m0, s38, 11264
s_nop 0
buffer_load_dwordx4 v6, s[16:19], s37 offen lds
ds_read_b64_tr_b16 a[0:1], v16 offset:12288
ds_read_b64_tr_b16 a[2:3], v16 offset:13312
ds_read_b64_tr_b16 a[4:5], v18 offset:12288
ds_read_b64_tr_b16 a[6:7], v18 offset:13312
ds_read_b64_tr_b16 a[72:73], v17 offset:12288
ds_read_b64_tr_b16 a[74:75], v17 offset:13312
ds_read_b64_tr_b16 a[76:77], v19 offset:12288
ds_read_b64_tr_b16 a[78:79], v19 offset:13312
s_waitcnt lgkmcnt(0)
s_waitcnt vmcnt(12)
s_barrier
s_add_u32 s37, s39, 0
s_add_u32 m0, s38, 12288
s_nop 0
buffer_load_dwordx4 v5, s[20:23], s37 offen lds
s_add_u32 s37, s39, 32768
s_add_u32 m0, s38, 13312
s_nop 0
buffer_load_dwordx4 v5, s[20:23], s37 offen lds
s_add_u32 s37, s39, 65536
s_add_u32 m0, s38, 14336
s_nop 0
buffer_load_dwordx4 v6, s[20:23], s37 offen lds
s_add_u32 s37, s39, 98304
s_add_u32 m0, s38, 15360
s_nop 0
buffer_load_dwordx4 v6, s[20:23], s37 offen lds
ds_read_b64_tr_b16 a[8:9], v16 offset:16384
ds_read_b64_tr_b16 a[10:11], v16 offset:17408
ds_read_b64_tr_b16 a[12:13], v18 offset:16384
ds_read_b64_tr_b16 a[14:15], v18 offset:17408
ds_read_b64_tr_b16 a[80:81], v17 offset:16384
ds_read_b64_tr_b16 a[82:83], v17 offset:17408
ds_read_b64_tr_b16 a[84:85], v19 offset:16384
ds_read_b64_tr_b16 a[86:87], v19 offset:17408
s_waitcnt lgkmcnt(0)
s_waitcnt vmcnt(12)
s_barrier
s_add_u32 s37, s39, 524288
s_add_u32 m0, s38, 16384
s_nop 0
buffer_load_dwordx4 v5, s[20:23], s37 offen lds
s_add_u32 s37, s39, 557056
s_add_u32 m0, s38, 17408
s_nop 0
buffer_load_dwordx4 v5, s[20:23], s37 offen lds
s_add_u32 s37, s39, 589824
s_add_u32 m0, s38, 18432
s_nop 0
buffer_load_dwordx4 v6, s[20:23], s37 offen lds
s_add_u32 s37, s39, 622592
s_add_u32 m0, s38, 19456
s_nop 0
buffer_load_dwordx4 v6, s[20:23], s37 offen lds
ds_read_b64_tr_b16 a[16:17], v16 offset:0
ds_read_b64_tr_b16 a[18:19], v16 offset:1024
ds_read_b64_tr_b16 a[20:21], v18 offset:0
ds_read_b64_tr_b16 a[22:23], v18 offset:1024
ds_read_b64_tr_b16 a[88:89], v17 offset:0
ds_read_b64_tr_b16 a[90:91], v17 offset:1024
ds_read_b64_tr_b16 a[92:93], v19 offset:0
ds_read_b64_tr_b16 a[94:95], v19 offset:1024
s_waitcnt lgkmcnt(0)
s_waitcnt vmcnt(12)
s_barrier
s_add_u32 s37, s39, 1048576
s_add_u32 m0, s38, 0
s_nop 0
buffer_load_dwordx4 v5, s[20:23], s37 offen lds
s_add_u32 s37, s39, 1081344
s_add_u32 m0, s38, 1024
s_nop 0
buffer_load_dwordx4 v5, s[20:23], s37 offen lds
s_add_u32 s37, s39, 1114112
s_add_u32 m0, s38, 2048
s_nop 0
buffer_load_dwordx4 v6, s[20:23], s37 offen lds
s_add_u32 s37, s39, 1146880
s_add_u32 m0, s38, 3072
s_nop 0
buffer_load_dwordx4 v6, s[20:23], s37 offen lds
ds_read_b64_tr_b16 a[24:25], v16 offset:4096
ds_read_b64_tr_b16 a[26:27], v16 offset:5120
ds_read_b64_tr_b16 a[28:29], v18 offset:4096
ds_read_b64_tr_b16 a[30:31], v18 offset:5120
ds_read_b64_tr_b16 a[96:97], v17 offset:4096
ds_read_b64_tr_b16 a[98:99], v17 offset:5120
ds_read_b64_tr_b16 a[100:101], v19 offset:4096
ds_read_b64_tr_b16 a[102:103], v19 offset:5120
s_waitcnt lgkmcnt(0)
s_waitcnt vmcnt(12)
s_barrier
s_add_u32 s37, s39, 1572864
s_add_u32 m0, s38, 4096
s_nop 0
buffer_load_dwordx4 v5, s[20:23], s37 offen lds
s_add_u32 s37, s39, 1605632
s_add_u32 m0, s38, 5120
s_nop 0
buffer_load_dwordx4 v5, s[20:23], s37 offen lds
s_add_u32 s37, s39, 1638400
s_add_u32 m0, s38, 6144
s_nop 0
buffer_load_dwordx4 v6, s[20:23], s37 offen lds
s_add_u32 s37, s39, 1671168
s_add_u32 m0, s38, 7168
s_nop 0
buffer_load_dwordx4 v6, s[20:23], s37 offen lds
ds_read_b64_tr_b16 a[32:33], v16 offset:8192
ds_read_b64_tr_b16 a[34:35], v16 offset:9216
ds_read_b64_tr_b16 a[36:37], v18 offset:8192
ds_read_b64_tr_b16 a[38:39], v18 offset:9216
ds_read_b64_tr_b16 a[104:105], v17 offset:8192
ds_read_b64_tr_b16 a[106:107], v17 offset:9216
ds_read_b64_tr_b16 a[108:109], v19 offset:8192
ds_read_b64_tr_b16 a[110:111], v19 offset:9216
s_waitcnt lgkmcnt(0)
s_waitcnt vmcnt(12)
s_barrier
s_add_u32 s37, s39, 2097152
s_add_u32 m0, s38, 8192
s_nop 0
buffer_load_dwordx4 v5, s[20:23], s37 offen lds
s_add_u32 s37, s39, 2129920
s_add_u32 m0, s38, 9216
s_nop 0
buffer_load_dwordx4 v5, s[20:23], s37 offen lds
s_add_u32 s37, s39, 2162688
s_add_u32 m0, s38, 10240
s_nop 0
buffer_load_dwordx4 v6, s[20:23], s37 offen lds
s_add_u32 s37, s39, 2195456
s_add_u32 m0, s38, 11264
s_nop 0
buffer_load_dwordx4 v6, s[20:23], s37 offen lds
ds_read_b64_tr_b16 a[112:113], v20 offset:12288
ds_read_b64_tr_b16 a[114:115], v20 offset:13312
ds_read_b64_tr_b16 a[116:117], v22 offset:12288
ds_read_b64_tr_b16 a[118:119], v22 offset:13312
ds_read_b64_tr_b16 a[184:185], v21 offset:12288
ds_read_b64_tr_b16 a[186:187], v21 offset:13312
ds_read_b64_tr_b16 a[188:189], v23 offset:12288
ds_read_b64_tr_b16 a[190:191], v23 offset:13312
s_waitcnt lgkmcnt(0)
s_waitcnt vmcnt(12)
s_barrier
s_add_u32 s37, s39, 2621440
s_add_u32 m0, s38, 12288
s_nop 0
buffer_load_dwordx4 v5, s[20:23], s37 offen lds
s_add_u32 s37, s39, 2654208
s_add_u32 m0, s38, 13312
s_nop 0
buffer_load_dwordx4 v5, s[20:23], s37 offen lds
s_add_u32 s37, s39, 2686976
s_add_u32 m0, s38, 14336
s_nop 0
buffer_load_dwordx4 v6, s[20:23], s37 offen lds
s_add_u32 s37, s39, 2719744
s_add_u32 m0, s38, 15360
s_nop 0
buffer_load_dwordx4 v6, s[20:23], s37 offen lds
ds_read_b64_tr_b16 a[120:121], v20 offset:16384
ds_read_b64_tr_b16 a[122:123], v20 offset:17408
ds_read_b64_tr_b16 a[124:125], v22 offset:16384
ds_read_b64_tr_b16 a[126:127], v22 offset:17408
ds_read_b64_tr_b16 a[192:193], v21 offset:16384
ds_read_b64_tr_b16 a[194:195], v21 offset:17408
ds_read_b64_tr_b16 a[196:197], v23 offset:16384
ds_read_b64_tr_b16 a[198:199], v23 offset:17408
s_waitcnt lgkmcnt(0)
s_waitcnt vmcnt(12)
s_barrier
s_add_u32 s37, s39, 3145728
s_add_u32 m0, s38, 16384
s_nop 0
buffer_load_dwordx4 v5, s[20:23], s37 offen lds
s_add_u32 s37, s39, 3178496
s_add_u32 m0, s38, 17408
s_nop 0
buffer_load_dwordx4 v5, s[20:23], s37 offen lds
s_add_u32 s37, s39, 3211264
s_add_u32 m0, s38, 18432
s_nop 0
buffer_load_dwordx4 v6, s[20:23], s37 offen lds
s_add_u32 s37, s39, 3244032
s_add_u32 m0, s38, 19456
s_nop 0
buffer_load_dwordx4 v6, s[20:23], s37 offen lds
ds_read_b64_tr_b16 a[128:129], v20 offset:0
ds_read_b64_tr_b16 a[130:131], v20 offset:1024
ds_read_b64_tr_b16 a[132:133], v22 offset:0
ds_read_b64_tr_b16 a[134:135], v22 offset:1024
ds_read_b64_tr_b16 a[200:201], v21 offset:0
ds_read_b64_tr_b16 a[202:203], v21 offset:1024
ds_read_b64_tr_b16 a[204:205], v23 offset:0
ds_read_b64_tr_b16 a[206:207], v23 offset:1024
s_waitcnt lgkmcnt(0)
s_waitcnt vmcnt(12)
s_barrier
s_add_u32 s37, s39, 3670016
s_add_u32 m0, s38, 0
s_nop 0
buffer_load_dwordx4 v5, s[20:23], s37 offen lds
s_add_u32 s37, s39, 3702784
s_add_u32 m0, s38, 1024
s_nop 0
buffer_load_dwordx4 v5, s[20:23], s37 offen lds
s_add_u32 s37, s39, 3735552
s_add_u32 m0, s38, 2048
s_nop 0
buffer_load_dwordx4 v6, s[20:23], s37 offen lds
s_add_u32 s37, s39, 3768320
s_add_u32 m0, s38, 3072
s_nop 0
buffer_load_dwordx4 v6, s[20:23], s37 offen lds
ds_read_b64_tr_b16 a[136:137], v20 offset:4096
ds_read_b64_tr_b16 a[138:139], v20 offset:5120
ds_read_b64_tr_b16 a[140:141], v22 offset:4096
ds_read_b64_tr_b16 a[142:143], v22 offset:5120
ds_read_b64_tr_b16 a[208:209], v21 offset:4096
ds_read_b64_tr_b16 a[210:211], v21 offset:5120
ds_read_b64_tr_b16 a[212:213], v23 offset:4096
ds_read_b64_tr_b16 a[214:215], v23 offset:5120
s_waitcnt lgkmcnt(0)
s_waitcnt vmcnt(12)
s_barrier
s_add_u32 s37, s39, 4194304
s_add_u32 m0, s38, 4096
s_nop 0
buffer_load_dwordx4 v5, s[20:23], s37 offen lds
s_add_u32 s37, s39, 4227072
s_add_u32 m0, s38, 5120
s_nop 0
buffer_load_dwordx4 v5, s[20:23], s37 offen lds
s_add_u32 s37, s39, 4259840
s_add_u32 m0, s38, 6144
s_nop 0
buffer_load_dwordx4 v6, s[20:23], s37 offen lds
s_add_u32 s37, s39, 4292608
s_add_u32 m0, s38, 7168
s_nop 0
buffer_load_dwordx4 v6, s[20:23], s37 offen lds
ds_read_b64_tr_b16 a[144:145], v20 offset:8192
ds_read_b64_tr_b16 a[146:147], v20 offset:9216
ds_read_b64_tr_b16 a[148:149], v22 offset:8192
ds_read_b64_tr_b16 a[150:151], v22 offset:9216
ds_read_b64_tr_b16 a[216:217], v21 offset:8192
ds_read_b64_tr_b16 a[218:219], v21 offset:9216
ds_read_b64_tr_b16 a[220:221], v23 offset:8192
ds_read_b64_tr_b16 a[222:223], v23 offset:9216
s_waitcnt lgkmcnt(0)
s_waitcnt vmcnt(12)
s_barrier
ds_read_b64_tr_b16 a[152:153], v20 offset:12288
ds_read_b64_tr_b16 a[154:155], v20 offset:13312
ds_read_b64_tr_b16 a[156:157], v22 offset:12288
ds_read_b64_tr_b16 a[158:159], v22 offset:13312
ds_read_b64_tr_b16 a[224:225], v21 offset:12288
ds_read_b64_tr_b16 a[226:227], v21 offset:13312
ds_read_b64_tr_b16 a[228:229], v23 offset:12288
ds_read_b64_tr_b16 a[230:231], v23 offset:13312
s_waitcnt lgkmcnt(0)
s_waitcnt vmcnt(8)
s_barrier
ds_read_b64_tr_b16 a[160:161], v20 offset:16384
ds_read_b64_tr_b16 a[162:163], v20 offset:17408
ds_read_b64_tr_b16 a[164:165], v22 offset:16384
ds_read_b64_tr_b16 a[166:167], v22 offset:17408
ds_read_b64_tr_b16 a[232:233], v21 offset:16384
ds_read_b64_tr_b16 a[234:235], v21 offset:17408
ds_read_b64_tr_b16 a[236:237], v23 offset:16384
ds_read_b64_tr_b16 a[238:239], v23 offset:17408
s_waitcnt lgkmcnt(0)
s_waitcnt vmcnt(4)
s_barrier
ds_read_b64_tr_b16 a[168:169], v20 offset:0
ds_read_b64_tr_b16 a[170:171], v20 offset:1024
ds_read_b64_tr_b16 a[172:173], v22 offset:0
ds_read_b64_tr_b16 a[174:175], v22 offset:1024
ds_read_b64_tr_b16 a[240:241], v21 offset:0
ds_read_b64_tr_b16 a[242:243], v21 offset:1024
ds_read_b64_tr_b16 a[244:245], v23 offset:0
ds_read_b64_tr_b16 a[246:247], v23 offset:1024
s_waitcnt lgkmcnt(0)
s_waitcnt vmcnt(0)
s_barrier
ds_read_b64_tr_b16 a[176:177], v20 offset:4096
ds_read_b64_tr_b16 a[178:179], v20 offset:5120
ds_read_b64_tr_b16 a[180:181], v22 offset:4096
ds_read_b64_tr_b16 a[182:183], v22 offset:5120
ds_read_b64_tr_b16 a[248:249], v21 offset:4096
ds_read_b64_tr_b16 a[250:251], v21 offset:5120
ds_read_b64_tr_b16 a[252:253], v23 offset:4096
ds_read_b64_tr_b16 a[254:255], v23 offset:5120
s_waitcnt lgkmcnt(0)
s_lshl_b32 s42, s33, 5
s_add_u32 s42, s42, s32
s_lshl_b32 s39, s42, 13
s_lshl_b32 s37, s34, 11
s_add_u32 s39, s39, s37
s_add_u32 s39, s39, 50331648
s_lshl_b32 s40, s42, 14
s_add_u32 s40, s40, 16777216
s_lshl_b32 s37, s34, 12
s_add_u32 s41, s40, s37
s_lshr_b32 s37, s34, 1
s_lshl_b32 s37, s37, 10
s_add_u32 s40, s40, s37
s_and_b32 s37, s34, 1
s_lshl_b32 s37, s37, 6
s_add_u32 s40, s40, s37
s_mov_b32 s35, 0
s_mov_b32 s48, 36864
s_lshl_b32 s49, s32, 5
s_lshl_b32 s37, s33, 2
s_add_u32 s49, s49, s37
s_add_u32 s49, s49, s34
s_lshl_b32 s49, s49, 2
s_add_u32 s49, s49, 327680
s_waitcnt vmcnt(0)
.p2align 6
L_q_loop:
s_waitcnt vmcnt(7)
s_barrier
s_add_u32 s43, s43, 147456
s_add_u32 s44, s44, s48
ds_read_b128 v[64:67], v3 offset:0
ds_read_b128 v[68:71], v3 offset:1024
ds_read_b128 v[72:75], v3 offset:2048
ds_read_b128 v[76:79], v3 offset:3072
s_waitcnt lgkmcnt(2)
v_mfma_f32_16x16x32_bf16 v[16:19], v[80:83], v[64:67], 0
v_mfma_f32_16x16x32_bf16 v[20:23], v[80:83], v[68:71], 0
v_mfma_f32_16x16x32_bf16 v[24:27], v[152:155], v[64:67], 0
v_mfma_f32_16x16x32_bf16 v[28:31], v[152:155], v[68:71], 0
s_add_u32 s37, s43, 0
s_add_u32 m0, s44, 0
s_nop 0
buffer_load_dwordx4 v2, s[8:11], s37 offen lds
v_mfma_f32_16x16x32_bf16 v[32:35], v[224:227], v[64:67], 0
v_mfma_f32_16x16x32_bf16 v[36:39], v[224:227], v[68:71], 0
v_mfma_f32_16x16x32_bf16 v[40:43], a[40:43], v[64:67], 0
v_mfma_f32_16x16x32_bf16 v[44:47], a[40:43], v[68:71], 0
v_mfma_f32_16x16x32_bf16 v[48:51], v[64:67], a[112:115], 0
v_mfma_f32_16x16x32_bf16 v[52:55], v[68:71], a[112:115], 0
v_mfma_f32_16x16x32_bf16 v[56:59], v[64:67], a[184:187], 0
v_mfma_f32_16x16x32_bf16 v[60:63], v[68:71], a[184:187], 0
ds_read_b128 v[64:67], v3 offset:4096
ds_read_b128 v[68:71], v3 offset:5120
s_waitcnt lgkmcnt(2)
v_mfma_f32_16x16x32_bf16 v[16:19], v[84:87], v[72:75], v[16:19]
v_mfma_f32_16x16x32_bf16 v[20:23], v[84:87], v[76:79], v[20:23]
v_mfma_f32_16x16x32_bf16 v[24:27], v[156:159], v[72:75], v[24:27]
v_mfma_f32_16x16x32_bf16 v[28:31], v[156:159], v[76:79], v[28:31]
s_add_u32 s37, s43, 128
s_add_u32 m0, s44, 4096
s_nop 0
buffer_load_dwordx4 v2, s[8:11], s37 offen lds
v_mfma_f32_16x16x32_bf16 v[32:35], v[228:231], v[72:75], v[32:35]
v_mfma_f32_16x16x32_bf16 v[36:39], v[228:231], v[76:79], v[36:39]
v_mfma_f32_16x16x32_bf16 v[40:43], a[44:47], v[72:75], v[40:43]
v_mfma_f32_16x16x32_bf16 v[44:47], a[44:47], v[76:79], v[44:47]
v_mfma_f32_16x16x32_bf16 v[48:51], v[72:75], a[116:119], v[48:51]
v_mfma_f32_16x16x32_bf16 v[52:55], v[76:79], a[116:119], v[52:55]
v_mfma_f32_16x16x32_bf16 v[56:59], v[72:75], a[188:191], v[56:59]
v_mfma_f32_16x16x32_bf16 v[60:63], v[76:79], a[188:191], v[60:63]
ds_read_b128 v[72:75], v3 offset:6144
ds_read_b128 v[76:79], v3 offset:7168
s_waitcnt lgkmcnt(2)
v_mfma_f32_16x16x32_bf16 v[16:19], v[88:91], v[64:67], v[16:19]
v_mfma_f32_16x16x32_bf16 v[20:23], v[88:91], v[68:71], v[20:23]
v_mfma_f32_16x16x32_bf16 v[24:27], v[160:163], v[64:67], v[24:27]
v_mfma_f32_16x16x32_bf16 v[28:31], v[160:163], v[68:71], v[28:31]
s_add_u32 s37, s43, 256
s_add_u32 m0, s44, 8192
s_nop 0
buffer_load_dwordx4 v2, s[8:11], s37 offen lds
v_mfma_f32_16x16x32_bf16 v[32:35], v[232:235], v[64:67], v[32:35]
v_mfma_f32_16x16x32_bf16 v[36:39], v[232:235], v[68:71], v[36:39]
v_mfma_f32_16x16x32_bf16 v[40:43], a[48:51], v[64:67], v[40:43]
v_mfma_f32_16x16x32_bf16 v[44:47], a[48:51], v[68:71], v[44:47]
v_mfma_f32_16x16x32_bf16 v[48:51], v[64:67], a[120:123], v[48:51]
v_mfma_f32_16x16x32_bf16 v[52:55], v[68:71], a[120:123], v[52:55]
v_mfma_f32_16x16x32_bf16 v[56:59], v[64:67], a[192:195], v[56:59]
v_mfma_f32_16x16x32_bf16 v[60:63], v[68:71], a[192:195], v[60:63]
ds_read_b128 v[64:67], v3 offset:8192
ds_read_b128 v[68:71], v3 offset:9216
s_waitcnt lgkmcnt(2)
v_mfma_f32_16x16x32_bf16 v[16:19], v[92:95], v[72:75], v[16:19]
v_mfma_f32_16x16x32_bf16 v[20:23], v[92:95], v[76:79], v[20:23]
v_mfma_f32_16x16x32_bf16 v[24:27], v[164:167], v[72:75], v[24:27]
v_mfma_f32_16x16x32_bf16 v[28:31], v[164:167], v[76:79], v[28:31]
s_add_u32 s37, s43, 384
s_add_u32 m0, s44, 12288
s_nop 0
buffer_load_dwordx4 v2, s[8:11], s37 offen lds
v_mfma_f32_16x16x32_bf16 v[32:35], v[236:239], v[72:75], v[32:35]
v_mfma_f32_16x16x32_bf16 v[36:39], v[236:239], v[76:79], v[36:39]
v_mfma_f32_16x16x32_bf16 v[40:43], a[52:55], v[72:75], v[40:43]
v_mfma_f32_16x16x32_bf16 v[44:47], a[52:55], v[76:79], v[44:47]
v_mfma_f32_16x16x32_bf16 v[48:51], v[72:75], a[124:127], v[48:51]
v_mfma_f32_16x16x32_bf16 v[52:55], v[76:79], a[124:127], v[52:55]
v_mfma_f32_16x16x32_bf16 v[56:59], v[72:75], a[196:199], v[56:59]
v_mfma_f32_16x16x32_bf16 v[60:63], v[76:79], a[196:199], v[60:63]
ds_read_b128 v[72:75], v3 offset:10240
ds_read_b128 v[76:79], v3 offset:11264
s_waitcnt lgkmcnt(2)
v_mfma_f32_16x16x32_bf16 v[16:19], v[96:99], v[64:67], v[16:19]
v_mfma_f32_16x16x32_bf16 v[20:23], v[96:99], v[68:71], v[20:23]
v_mfma_f32_16x16x32_bf16 v[24:27], v[168:171], v[64:67], v[24:27]
v_mfma_f32_16x16x32_bf16 v[28:31], v[168:171], v[68:71], v[28:31]
s_add_u32 s37, s43, 512
s_add_u32 m0, s44, 16384
s_nop 0
buffer_load_dwordx4 v2, s[8:11], s37 offen lds
v_mfma_f32_16x16x32_bf16 v[32:35], v[240:243], v[64:67], v[32:35]
v_mfma_f32_16x16x32_bf16 v[36:39], v[240:243], v[68:71], v[36:39]
v_mfma_f32_16x16x32_bf16 v[40:43], a[56:59], v[64:67], v[40:43]
v_mfma_f32_16x16x32_bf16 v[44:47], a[56:59], v[68:71], v[44:47]
v_mfma_f32_16x16x32_bf16 v[48:51], v[64:67], a[128:131], v[48:51]
v_mfma_f32_16x16x32_bf16 v[52:55], v[68:71], a[128:131], v[52:55]
v_mfma_f32_16x16x32_bf16 v[56:59], v[64:67], a[200:203], v[56:59]
v_mfma_f32_16x16x32_bf16 v[60:63], v[68:71], a[200:203], v[60:63]
ds_read_b128 v[64:67], v3 offset:12288
ds_read_b128 v[68:71], v3 offset:13312
s_waitcnt lgkmcnt(2)
v_mfma_f32_16x16x32_bf16 v[16:19], v[100:103], v[72:75], v[16:19]
v_mfma_f32_16x16x32_bf16 v[20:23], v[100:103], v[76:79], v[20:23]
v_mfma_f32_16x16x32_bf16 v[24:27], v[172:175], v[72:75], v[24:27]
v_mfma_f32_16x16x32_bf16 v[28:31], v[172:175], v[76:79], v[28:31]
s_add_u32 s37, s43, 640
s_add_u32 m0, s44, 20480
s_nop 0
buffer_load_dwordx4 v2, s[8:11], s37 offen lds
v_mfma_f32_16x16x32_bf16 v[32:35], v[244:247], v[72:75], v[32:35]
v_mfma_f32_16x16x32_bf16 v[36:39], v[244:247], v[76:79], v[36:39]
v_mfma_f32_16x16x32_bf16 v[40:43], a[60:63], v[72:75], v[40:43]
v_mfma_f32_16x16x32_bf16 v[44:47], a[60:63], v[76:79], v[44:47]
v_mfma_f32_16x16x32_bf16 v[48:51], v[72:75], a[132:135], v[48:51]
v_mfma_f32_16x16x32_bf16 v[52:55], v[76:79], a[132:135], v[52:55]
v_mfma_f32_16x16x32_bf16 v[56:59], v[72:75], a[204:207], v[56:59]
v_mfma_f32_16x16x32_bf16 v[60:63], v[76:79], a[204:207], v[60:63]
ds_read_b128 v[72:75], v3 offset:14336
ds_read_b128 v[76:79], v3 offset:15360
s_waitcnt lgkmcnt(2)
v_mfma_f32_16x16x32_bf16 v[16:19], v[104:107], v[64:67], v[16:19]
v_mfma_f32_16x16x32_bf16 v[20:23], v[104:107], v[68:71], v[20:23]
v_mfma_f32_16x16x32_bf16 v[24:27], v[176:179], v[64:67], v[24:27]
v_mfma_f32_16x16x32_bf16 v[28:31], v[176:179], v[68:71], v[28:31]
s_add_u32 s37, s43, 768
s_add_u32 m0, s44, 24576
s_nop 0
buffer_load_dwordx4 v2, s[8:11], s37 offen lds
v_mfma_f32_16x16x32_bf16 v[32:35], v[248:251], v[64:67], v[32:35]
v_mfma_f32_16x16x32_bf16 v[36:39], v[248:251], v[68:71], v[36:39]
v_mfma_f32_16x16x32_bf16 v[40:43], a[64:67], v[64:67], v[40:43]
v_mfma_f32_16x16x32_bf16 v[44:47], a[64:67], v[68:71], v[44:47]
v_mfma_f32_16x16x32_bf16 v[48:51], v[64:67], a[136:139], v[48:51]
v_mfma_f32_16x16x32_bf16 v[52:55], v[68:71], a[136:139], v[52:55]
v_mfma_f32_16x16x32_bf16 v[56:59], v[64:67], a[208:211], v[56:59]
v_mfma_f32_16x16x32_bf16 v[60:63], v[68:71], a[208:211], v[60:63]
ds_read_b128 v[64:67], v3 offset:16384
ds_read_b128 v[68:71], v3 offset:17408
s_waitcnt lgkmcnt(2)
v_mfma_f32_16x16x32_bf16 v[16:19], v[108:111], v[72:75], v[16:19]
v_mfma_f32_16x16x32_bf16 v[20:23], v[108:111], v[76:79], v[20:23]
v_mfma_f32_16x16x32_bf16 v[24:27], v[180:183], v[72:75], v[24:27]
v_mfma_f32_16x16x32_bf16 v[28:31], v[180:183], v[76:79], v[28:31]
s_add_u32 s37, s43, 896
s_add_u32 m0, s44, 28672
s_nop 0
buffer_load_dwordx4 v2, s[8:11], s37 offen lds
v_mfma_f32_16x16x32_bf16 v[32:35], v[252:255], v[72:75], v[32:35]
v_mfma_f32_16x16x32_bf16 v[36:39], v[252:255], v[76:79], v[36:39]
v_mfma_f32_16x16x32_bf16 v[40:43], a[68:71], v[72:75], v[40:43]
v_mfma_f32_16x16x32_bf16 v[44:47], a[68:71], v[76:79], v[44:47]
v_mfma_f32_16x16x32_bf16 v[48:51], v[72:75], a[140:143], v[48:51]
v_mfma_f32_16x16x32_bf16 v[52:55], v[76:79], a[140:143], v[52:55]
v_mfma_f32_16x16x32_bf16 v[56:59], v[72:75], a[212:215], v[56:59]
v_mfma_f32_16x16x32_bf16 v[60:63], v[76:79], a[212:215], v[60:63]
ds_read_b128 v[72:75], v3 offset:18432
ds_read_b128 v[76:79], v3 offset:19456
s_waitcnt lgkmcnt(2)
v_mfma_f32_16x16x32_bf16 v[16:19], v[112:115], v[64:67], v[16:19]
v_mfma_f32_16x16x32_bf16 v[20:23], v[112:115], v[68:71], v[20:23]
v_mfma_f32_16x16x32_bf16 v[24:27], v[184:187], v[64:67], v[24:27]
v_mfma_f32_16x16x32_bf16 v[28:31], v[184:187], v[68:71], v[28:31]
s_add_u32 s37, s43, 1024
s_add_u32 m0, s44, 32768
s_nop 0
buffer_load_dwordx4 v2, s[8:11], s37 offen lds
v_mfma_f32_16x16x32_bf16 v[32:35], a[0:3], v[64:67], v[32:35]
v_mfma_f32_16x16x32_bf16 v[36:39], a[0:3], v[68:71], v[36:39]
v_mfma_f32_16x16x32_bf16 v[40:43], a[72:75], v[64:67], v[40:43]
v_mfma_f32_16x16x32_bf16 v[44:47], a[72:75], v[68:71], v[44:47]
v_mfma_f32_16x16x32_bf16 v[48:51], v[64:67], a[144:147], v[48:51]
v_mfma_f32_16x16x32_bf16 v[52:55], v[68:71], a[144:147], v[52:55]
v_mfma_f32_16x16x32_bf16 v[56:59], v[64:67], a[216:219], v[56:59]
v_mfma_f32_16x16x32_bf16 v[60:63], v[68:71], a[216:219], v[60:63]
ds_read_b128 v[64:67], v3 offset:20480
ds_read_b128 v[68:71], v3 offset:21504
s_waitcnt lgkmcnt(2)
v_mfma_f32_16x16x32_bf16 v[16:19], v[116:119], v[72:75], v[16:19]
v_mfma_f32_16x16x32_bf16 v[20:23], v[116:119], v[76:79], v[20:23]
v_mfma_f32_16x16x32_bf16 v[24:27], v[188:191], v[72:75], v[24:27]
v_mfma_f32_16x16x32_bf16 v[28:31], v[188:191], v[76:79], v[28:31]
v_mfma_f32_16x16x32_bf16 v[32:35], a[4:7], v[72:75], v[32:35]
v_mfma_f32_16x16x32_bf16 v[36:39], a[4:7], v[76:79], v[36:39]
v_mfma_f32_16x16x32_bf16 v[40:43], a[76:79], v[72:75], v[40:43]
v_mfma_f32_16x16x32_bf16 v[44:47], a[76:79], v[76:79], v[44:47]
v_mfma_f32_16x16x32_bf16 v[48:51], v[72:75], a[148:151], v[48:51]
v_mfma_f32_16x16x32_bf16 v[52:55], v[76:79], a[148:151], v[52:55]
v_mfma_f32_16x16x32_bf16 v[56:59], v[72:75], a[220:223], v[56:59]
v_mfma_f32_16x16x32_bf16 v[60:63], v[76:79], a[220:223], v[60:63]
ds_read_b128 v[72:75], v3 offset:22528
ds_read_b128 v[76:79], v3 offset:23552
s_waitcnt lgkmcnt(2)
v_mfma_f32_16x16x32_bf16 v[16:19], v[120:123], v[64:67], v[16:19]
v_mfma_f32_16x16x32_bf16 v[20:23], v[120:123], v[68:71], v[20:23]
v_mfma_f32_16x16x32_bf16 v[24:27], v[192:195], v[64:67], v[24:27]
v_mfma_f32_16x16x32_bf16 v[28:31], v[192:195], v[68:71], v[28:31]
s_waitcnt vmcnt(9)
v_mov_b32 v12, s35
s_mov_b64 exec, 1
buffer_store_dword v12, v8, s[4:7], s49 offen sc0 sc1
s_mov_b64 exec, -1
v_mfma_f32_16x16x32_bf16 v[32:35], a[8:11], v[64:67], v[32:35]
v_mfma_f32_16x16x32_bf16 v[36:39], a[8:11], v[68:71], v[36:39]
v_mfma_f32_16x16x32_bf16 v[40:43], a[80:83], v[64:67], v[40:43]
v_mfma_f32_16x16x32_bf16 v[44:47], a[80:83], v[68:71], v[44:47]
v_mfma_f32_16x16x32_bf16 v[48:51], v[64:67], a[152:155], v[48:51]
v_mfma_f32_16x16x32_bf16 v[52:55], v[68:71], a[152:155], v[52:55]
v_mfma_f32_16x16x32_bf16 v[56:59], v[64:67], a[224:227], v[56:59]
v_mfma_f32_16x16x32_bf16 v[60:63], v[68:71], a[224:227], v[60:63]
ds_read_b128 v[64:67], v3 offset:24576
ds_read_b128 v[68:71], v3 offset:25600
s_waitcnt lgkmcnt(2)
v_mfma_f32_16x16x32_bf16 v[16:19], v[124:127], v[72:75], v[16:19]
v_mfma_f32_16x16x32_bf16 v[20:23], v[124:127], v[76:79], v[20:23]
v_mfma_f32_16x16x32_bf16 v[24:27], v[196:199], v[72:75], v[24:27]
v_mfma_f32_16x16x32_bf16 v[28:31], v[196:199], v[76:79], v[28:31]
v_mfma_f32_16x16x32_bf16 v[32:35], a[12:15], v[72:75], v[32:35]
v_mfma_f32_16x16x32_bf16 v[36:39], a[12:15], v[76:79], v[36:39]
v_mfma_f32_16x16x32_bf16 v[40:43], a[84:87], v[72:75], v[40:43]
v_mfma_f32_16x16x32_bf16 v[44:47], a[84:87], v[76:79], v[44:47]
v_mfma_f32_16x16x32_bf16 v[48:51], v[72:75], a[156:159], v[48:51]
v_mfma_f32_16x16x32_bf16 v[52:55], v[76:79], a[156:159], v[52:55]
v_mfma_f32_16x16x32_bf16 v[56:59], v[72:75], a[228:231], v[56:59]
v_mfma_f32_16x16x32_bf16 v[60:63], v[76:79], a[228:231], v[60:63]
ds_read_b128 v[72:75], v3 offset:26624
ds_read_b128 v[76:79], v3 offset:27648
s_waitcnt lgkmcnt(2)
v_mfma_f32_16x16x32_bf16 v[16:19], v[128:131], v[64:67], v[16:19]
v_mfma_f32_16x16x32_bf16 v[20:23], v[128:131], v[68:71], v[20:23]
v_mfma_f32_16x16x32_bf16 v[24:27], v[200:203], v[64:67], v[24:27]
v_mfma_f32_16x16x32_bf16 v[28:31], v[200:203], v[68:71], v[28:31]
v_mfma_f32_16x16x32_bf16 v[32:35], a[16:19], v[64:67], v[32:35]
v_mfma_f32_16x16x32_bf16 v[36:39], a[16:19], v[68:71], v[36:39]
v_mfma_f32_16x16x32_bf16 v[40:43], a[88:91], v[64:67], v[40:43]
v_mfma_f32_16x16x32_bf16 v[44:47], a[88:91], v[68:71], v[44:47]
v_mfma_f32_16x16x32_bf16 v[48:51], v[64:67], a[160:163], v[48:51]
v_mfma_f32_16x16x32_bf16 v[52:55], v[68:71], a[160:163], v[52:55]
v_mfma_f32_16x16x32_bf16 v[56:59], v[64:67], a[232:235], v[56:59]
v_mfma_f32_16x16x32_bf16 v[60:63], v[68:71], a[232:235], v[60:63]
ds_read_b128 v[64:67], v3 offset:28672
ds_read_b128 v[68:71], v3 offset:29696
s_waitcnt lgkmcnt(2)
v_mfma_f32_16x16x32_bf16 v[16:19], v[132:135], v[72:75], v[16:19]
v_mfma_f32_16x16x32_bf16 v[20:23], v[132:135], v[76:79], v[20:23]
v_mfma_f32_16x16x32_bf16 v[24:27], v[204:207], v[72:75], v[24:27]
v_mfma_f32_16x16x32_bf16 v[28:31], v[204:207], v[76:79], v[28:31]
v_mfma_f32_16x16x32_bf16 v[32:35], a[20:23], v[72:75], v[32:35]
v_mfma_f32_16x16x32_bf16 v[36:39], a[20:23], v[76:79], v[36:39]
v_mfma_f32_16x16x32_bf16 v[40:43], a[92:95], v[72:75], v[40:43]
v_mfma_f32_16x16x32_bf16 v[44:47], a[92:95], v[76:79], v[44:47]
v_mfma_f32_16x16x32_bf16 v[48:51], v[72:75], a[164:167], v[48:51]
v_mfma_f32_16x16x32_bf16 v[52:55], v[76:79], a[164:167], v[52:55]
v_mfma_f32_16x16x32_bf16 v[56:59], v[72:75], a[236:239], v[56:59]
v_mfma_f32_16x16x32_bf16 v[60:63], v[76:79], a[236:239], v[60:63]
ds_read_b128 v[72:75], v3 offset:30720
ds_read_b128 v[76:79], v3 offset:31744
s_waitcnt lgkmcnt(2)
v_mfma_f32_16x16x32_bf16 v[16:19], v[136:139], v[64:67], v[16:19]
v_mfma_f32_16x16x32_bf16 v[20:23], v[136:139], v[68:71], v[20:23]
v_mfma_f32_16x16x32_bf16 v[24:27], v[208:211], v[64:67], v[24:27]
v_mfma_f32_16x16x32_bf16 v[28:31], v[208:211], v[68:71], v[28:31]
v_mfma_f32_16x16x32_bf16 v[32:35], a[24:27], v[64:67], v[32:35]
v_mfma_f32_16x16x32_bf16 v[36:39], a[24:27], v[68:71], v[36:39]
v_mfma_f32_16x16x32_bf16 v[40:43], a[96:99], v[64:67], v[40:43]
v_mfma_f32_16x16x32_bf16 v[44:47], a[96:99], v[68:71], v[44:47]
v_mfma_f32_16x16x32_bf16 v[48:51], v[64:67], a[168:171], v[48:51]
v_mfma_f32_16x16x32_bf16 v[52:55], v[68:71], a[168:171], v[52:55]
v_mfma_f32_16x16x32_bf16 v[56:59], v[64:67], a[240:243], v[56:59]
v_mfma_f32_16x16x32_bf16 v[60:63], v[68:71], a[240:243], v[60:63]
ds_read_b128 v[64:67], v3 offset:32768
ds_read_b128 v[68:71], v3 offset:33792
s_waitcnt lgkmcnt(2)
v_mfma_f32_16x16x32_bf16 v[16:19], v[140:143], v[72:75], v[16:19]
v_mfma_f32_16x16x32_bf16 v[20:23], v[140:143], v[76:79], v[20:23]
v_mfma_f32_16x16x32_bf16 v[24:27], v[212:215], v[72:75], v[24:27]
v_mfma_f32_16x16x32_bf16 v[28:31], v[212:215], v[76:79], v[28:31]
v_mfma_f32_16x16x32_bf16 v[32:35], a[28:31], v[72:75], v[32:35]
v_mfma_f32_16x16x32_bf16 v[36:39], a[28:31], v[76:79], v[36:39]
v_mfma_f32_16x16x32_bf16 v[40:43], a[100:103], v[72:75], v[40:43]
v_mfma_f32_16x16x32_bf16 v[44:47], a[100:103], v[76:79], v[44:47]
v_mfma_f32_16x16x32_bf16 v[48:51], v[72:75], a[172:175], v[48:51]
v_mfma_f32_16x16x32_bf16 v[52:55], v[76:79], a[172:175], v[52:55]
v_mfma_f32_16x16x32_bf16 v[56:59], v[72:75], a[244:247], v[56:59]
v_mfma_f32_16x16x32_bf16 v[60:63], v[76:79], a[244:247], v[60:63]
ds_read_b128 v[72:75], v3 offset:34816
ds_read_b128 v[76:79], v3 offset:35840
s_waitcnt lgkmcnt(2)
v_mfma_f32_16x16x32_bf16 v[16:19], v[144:147], v[64:67], v[16:19]
v_mfma_f32_16x16x32_bf16 v[20:23], v[144:147], v[68:71], v[20:23]
v_mfma_f32_16x16x32_bf16 v[24:27], v[216:219], v[64:67], v[24:27]
v_mfma_f32_16x16x32_bf16 v[28:31], v[216:219], v[68:71], v[28:31]
v_mfma_f32_16x16x32_bf16 v[32:35], a[32:35], v[64:67], v[32:35]
v_mfma_f32_16x16x32_bf16 v[36:39], a[32:35], v[68:71], v[36:39]
v_mfma_f32_16x16x32_bf16 v[40:43], a[104:107], v[64:67], v[40:43]
v_mfma_f32_16x16x32_bf16 v[44:47], a[104:107], v[68:71], v[44:47]
v_mfma_f32_16x16x32_bf16 v[48:51], v[64:67], a[176:179], v[48:51]
v_mfma_f32_16x16x32_bf16 v[52:55], v[68:71], a[176:179], v[52:55]
v_mfma_f32_16x16x32_bf16 v[56:59], v[64:67], a[248:251], v[56:59]
v_mfma_f32_16x16x32_bf16 v[60:63], v[68:71], a[248:251], v[60:63]
s_waitcnt lgkmcnt(0)
v_mfma_f32_16x16x32_bf16 v[16:19], v[148:151], v[72:75], v[16:19]
v_mfma_f32_16x16x32_bf16 v[20:23], v[148:151], v[76:79], v[20:23]
v_mfma_f32_16x16x32_bf16 v[24:27], v[220:223], v[72:75], v[24:27]
v_mfma_f32_16x16x32_bf16 v[28:31], v[220:223], v[76:79], v[28:31]
v_mfma_f32_16x16x32_bf16 v[32:35], a[36:39], v[72:75], v[32:35]
v_mfma_f32_16x16x32_bf16 v[36:39], a[36:39], v[76:79], v[36:39]
v_mfma_f32_16x16x32_bf16 v[40:43], a[108:111], v[72:75], v[40:43]
v_mfma_f32_16x16x32_bf16 v[44:47], a[108:111], v[76:79], v[44:47]
v_mfma_f32_16x16x32_bf16 v[48:51], v[72:75], a[180:183], v[48:51]
v_mfma_f32_16x16x32_bf16 v[52:55], v[76:79], a[180:183], v[52:55]
v_mfma_f32_16x16x32_bf16 v[56:59], v[72:75], a[252:255], v[56:59]
v_mfma_f32_16x16x32_bf16 v[60:63], v[76:79], a[252:255], v[60:63]
v_add_u32 v3, s48, v3
s_sub_u32 s48, 0, s48
v_cvt_pk_bf16_f32 v64, v16, v17
v_cvt_pk_bf16_f32 v65, v18, v19
v_cvt_pk_bf16_f32 v66, v24, v25
v_cvt_pk_bf16_f32 v67, v26, v27
buffer_store_dwordx4 v[64:67], v1, s[4:7], s39 offen offset:0
v_cvt_pk_bf16_f32 v68, v20, v21
v_cvt_pk_bf16_f32 v69, v22, v23
v_cvt_pk_bf16_f32 v70, v28, v29
v_cvt_pk_bf16_f32 v71, v30, v31
buffer_store_dwordx4 v[68:71], v1, s[4:7], s39 offen offset:1024
v_pk_mul_f32 v[32:33], v[32:33], s[46:47]
v_pk_mul_f32 v[34:35], v[34:35], s[46:47]
v_pk_mul_f32 v[36:37], v[36:37], s[46:47]
v_pk_mul_f32 v[38:39], v[38:39], s[46:47]
v_pk_mul_f32 v[40:41], v[40:41], s[46:47]
v_pk_mul_f32 v[42:43], v[42:43], s[46:47]
v_pk_mul_f32 v[44:45], v[44:45], s[46:47]
v_pk_mul_f32 v[46:47], v[46:47], s[46:47]
v_cvt_pk_bf16_f32 v72, v32, v33
v_cvt_pk_bf16_f32 v73, v34, v35
v_cvt_pk_bf16_f32 v74, v40, v41
v_cvt_pk_bf16_f32 v75, v42, v43
buffer_store_dwordx4 v[72:75], v4, s[4:7], s40 offen offset:0 sc0 sc1
v_cvt_pk_bf16_f32 v76, v36, v37
v_cvt_pk_bf16_f32 v77, v38, v39
v_cvt_pk_bf16_f32 v78, v44, v45
v_cvt_pk_bf16_f32 v79, v46, v47
buffer_store_dwordx4 v[76:79], v4, s[4:7], s40 offen offset:128 sc0 sc1
v_cvt_pk_bf16_f32 v16, v48, v49
v_cvt_pk_bf16_f32 v17, v50, v51
v_cvt_pk_bf16_f32 v18, v52, v53
v_cvt_pk_bf16_f32 v19, v54, v55
buffer_store_dwordx4 v[16:19], v1, s[4:7], s41 offen offset:2048 sc0 sc1
v_cvt_pk_bf16_f32 v20, v56, v57
v_cvt_pk_bf16_f32 v21, v58, v59
v_cvt_pk_bf16_f32 v22, v60, v61
v_cvt_pk_bf16_f32 v23, v62, v63
buffer_store_dwordx4 v[20:23], v1, s[4:7], s41 offen offset:3072 sc0 sc1
s_add_u32 s39, s39, 1048576
s_add_u32 s40, s40, 2097152
s_add_u32 s41, s41, 2097152
s_add_u32 s35, s35, 1
s_cmp_lg_u32 s35, 1
s_cbranch_scc1 L_q_n1
s_branch L_q_init_in
L_q_init:
s_sleep 4
L_q_init_in:
buffer_load_dword v12, v8, s[24:27], 0 offen offset:0 sc0 sc1
s_sub_u32 s36, s36, 1
s_cbranch_scc1 L_exit_w
s_waitcnt vmcnt(0)
v_readfirstlane_b32 s37, v12
s_nop 0
s_and_b32 s37, s37, 0xff
s_cmp_eq_u32 s37, 32
s_cbranch_scc0 L_q_init
v_mov_b32 v12, s35
s_mov_b64 exec, 1
buffer_store_dword v12, v8, s[4:7], s49 offen sc0 sc1
s_mov_b64 exec, -1
s_waitcnt vmcnt(0)
L_q_n1:
s_cmp_lt_u32 s35, 16
s_cbranch_scc1 L_q_loop
s_waitcnt vmcnt(0)
v_mov_b32 v12, s35
s_mov_b64 exec, 1
buffer_store_dword v12, v8, s[4:7], s49 offen sc0 sc1
s_mov_b64 exec, -1
s_barrier
s_lshr_b32 s37, s34, 1
s_and_b32 s38, s34, 1
s_lshl_b32 s50, s42, 13
s_lshl_b32 s39, s37, 10
s_add_u32 s50, s50, s39
s_add_u32 s50, s50, 50331648
s_lshl_b32 s52, s42, 14
s_add_u32 s52, s52, 16777216
s_lshl_b32 s39, s38, 13
s_add_u32 s53, s52, s39
s_mul_i32 s55, s33, 10240
s_add_u32 s55, s55, 8388608
s_and_b32 s59, s33, 1
s_sub_u32 s59, s59, 1
s_lshl_b32 s39, s33, 1
s_add_u32 s39, s39, s37
s_lshl_b32 s56, s39, 6
s_lshl_b32 s40, s32, 1
s_add_u32 s40, s40, s38
s_add_u32 s56, s56, s40
s_lshl_b32 s58, s56, 4
s_add_u32 s58, s58, 331776
s_lshl_b32 s56, s56, 11
s_add_u32 s56, s56, 67108864
s_mov_b32 s35, 0
s_lshl_b32 s37, s37, 4
v_add_u32 v12, s37, v10
v_lshlrev_b32 v13, 2, v11
v_sub_u32 v12, v12, v13
v_mov_b32 v13, 0xf149f2ca
v_cmp_le_i32 vcc, 0, v12
s_nop 1
v_cndmask_b32 v80, v13, v8, vcc
v_cmp_le_i32 vcc, 1, v12
s_nop 1
v_cndmask_b32 v81, v13, v8, vcc
v_cmp_le_i32 vcc, 2, v12
s_nop 1
v_cndmask_b32 v82, v13, v8, vcc
v_cmp_le_i32 vcc, 3, v12
s_nop 1
v_cndmask_b32 v83, v13, v8, vcc
v_cmp_le_i32 vcc, 16, v12
s_nop 1
v_cndmask_b32 v84, v13, v8, vcc
v_cmp_le_i32 vcc, 17, v12
s_nop 1
v_cndmask_b32 v85, v13, v8, vcc
v_cmp_le_i32 vcc, 18, v12
s_nop 1
v_cndmask_b32 v86, v13, v8, vcc
v_cmp_le_i32 vcc, 19, v12
s_nop 1
v_cndmask_b32 v87, v13, v8, vcc
v_cmp_gt_u32 vcc, 2, v11
s_nop 1
v_cndmask_b32 v88, v13, v8, vcc
v_cndmask_b32 v89, v13, v8, vcc
v_cndmask_b32 v90, v13, v8, vcc
v_cndmask_b32 v91, v13, v8, vcc
v_mov_b32 v92, 0x3f803f80
v_mov_b32 v93, 0x3f803f80
v_mov_b32 v94, 0x3f803f80
v_mov_b32 v95, 0x3f803f80
v_lshrrev_b32 v12, 1, v11
v_lshlrev_b32 v14, 8, v12
v_and_b32 v12, 1, v11
v_lshl_add_u32 v14, v12, 5, v14
v_bfe_u32 v12, v10, 1, 2
v_lshl_add_u32 v14, v12, 6, v14
v_and_b32 v12, 1, v10
v_lshl_add_u32 v14, v12, 4, v14
s_lshl_b32 s37, s34, 8
v_lshl_add_u32 v15, v9, 2, s37
s_lshl_b32 s37, s34, 10
v_add_u32 v6, s37, v1
s_lshl_b32 s38, s38, 11
v_add_u32 v3, s38, v1
v_and_b32 v12, 3, v10
v_cmp_eq_u32 vcc, 0, v12
s_nop 1
v_cndmask_b32 v5, 0, 1, vcc
L_at_loop:
s_add_u32 s51, s50, 4096
s_add_u32 s54, s53, 4096
s_add_u32 s60, s55, 4096
s_add_u32 s57, s55, 8192
buffer_load_dwordx4 v[16:19], v1, s[4:7], s50 offen offset:0
buffer_load_dwordx4 v[32:35], v4, s[4:7], s52 offen offset:0 sc1
buffer_load_dwordx4 v[48:51], v4, s[4:7], s52 offen offset:128 sc1
buffer_load_dwordx4 v[20:23], v1, s[4:7], s50 offen offset:2048
buffer_load_dwordx4 v[36:39], v4, s[4:7], s52 offen offset:64 sc1
buffer_load_dwordx4 v[52:55], v4, s[4:7], s52 offen offset:192 sc1
buffer_load_dwordx4 v[24:27], v1, s[4:7], s51 offen offset:0
buffer_load_dwordx4 v[40:43], v4, s[4:7], s52 offen offset:1024 sc1
buffer_load_dwordx4 v[56:59], v4, s[4:7], s52 offen offset:1152 sc1
buffer_load_dwordx4 v[28:31], v1, s[4:7], s51 offen offset:2048
buffer_load_dwordx4 v[44:47], v4, s[4:7], s52 offen offset:1088 sc1
buffer_load_dwordx4 v[60:63], v4, s[4:7], s52 offen offset:1216 sc1
buffer_load_dwordx4 v[64:67], v1, s[4:7], s53 offen offset:2048 sc1
buffer_load_dwordx4 v[68:71], v1, s[4:7], s53 offen offset:3072 sc1
buffer_load_dwordx4 v[72:75], v1, s[4:7], s54 offen offset:2048 sc1
buffer_load_dwordx4 v[76:79], v1, s[4:7], s54 offen offset:3072 sc1
s_waitcnt vmcnt(13)
v_mfma_f32_16x16x32_bf16 v[96:99], v[32:35], v[16:19], v[80:83]
v_mfma_f32_16x16x32_bf16 v[100:103], v[48:51], v[16:19], v[84:87]
s_waitcnt vmcnt(10)
v_mfma_f32_16x16x32_bf16 v[96:99], v[36:39], v[20:23], v[96:99]
v_mfma_f32_16x16x32_bf16 v[100:103], v[52:55], v[20:23], v[100:103]
s_waitcnt vmcnt(7)
v_mfma_f32_16x16x32_bf16 v[96:99], v[40:43], v[24:27], v[96:99]
v_mfma_f32_16x16x32_bf16 v[100:103], v[56:59], v[24:27], v[100:103]
s_waitcnt vmcnt(4)
v_mfma_f32_16x16x32_bf16 v[96:99], v[44:47], v[28:31], v[96:99]
v_mfma_f32_16x16x32_bf16 v[100:103], v[60:63], v[28:31], v[100:103]
s_nop 3
v_max3_f32 v160, v96, v97, v98
s_nop 2
v_max3_f32 v160, v160, v99, v100
v_max3_f32 v160, v160, v101, v102
v_max_f32 v160, v160, v103
s_branch L_at_in
L_at_poll:
s_sleep 2
L_at_in:
buffer_load_dwordx4 v[164:167], v6, s[4:7], s55 offen sc0 sc1
buffer_load_dwordx4 v[168:171], v6, s[4:7], s60 offen sc0 sc1
buffer_load_dword v172, v15, s[4:7], s57 offen sc0 sc1
s_sub_u32 s36, s36, 1
s_cbranch_scc1 L_exit_w
s_waitcnt vmcnt(0)
v_bitop3_b32 v12, v164, v168, s59 bitop3:0x7e
v_bitop3_b32 v13, v172, s59, v5 bitop3:0x28
v_and_or_b32 v12, v12, 1, v13
v_cmp_ne_u32 vcc, 0, v12
s_cbranch_vccnz L_at_poll
ds_write_b128 v6, v[164:167]
ds_write_b128 v6, v[168:171] offset:4096
ds_write_b32 v15, v172 offset:8192
s_waitcnt lgkmcnt(0)
s_barrier
ds_read_b128 v[176:179], v14 offset:0
ds_read_b128 v[180:183], v14 offset:512
ds_read_b128 v[184:187], v14 offset:1024
ds_read_b128 v[188:191], v14 offset:1536
s_waitcnt lgkmcnt(3)
v_mfma_f32_16x16x32_bf16 v[192:195], v[224:227], v[176:179], 0
v_mfma_f32_16x16x32_bf16 v[196:199], a[40:43], v[176:179], 0
v_mfma_f32_16x16x32_bf16 v[200:203], v[176:179], a[112:115], 0
v_mfma_f32_16x16x32_bf16 v[204:207], v[176:179], a[184:187], 0
ds_read_b128 v[176:179], v14 offset:2048
s_waitcnt lgkmcnt(3)
v_mfma_f32_16x16x32_bf16 v[192:195], v[228:231], v[180:183], v[192:195]
v_mfma_f32_16x16x32_bf16 v[196:199], a[44:47], v[180:183], v[196:199]
v_mfma_f32_16x16x32_bf16 v[200:203], v[180:183], a[116:119], v[200:203]
v_mfma_f32_16x16x32_bf16 v[204:207], v[180:183], a[188:191], v[204:207]
ds_read_b128 v[180:183], v14 offset:2560
s_waitcnt lgkmcnt(3)
v_mfma_f32_16x16x32_bf16 v[192:195], v[232:235], v[184:187], v[192:195]
v_mfma_f32_16x16x32_bf16 v[196:199], a[48:51], v[184:187], v[196:199]
v_mfma_f32_16x16x32_bf16 v[200:203], v[184:187], a[120:123], v[200:203]
v_mfma_f32_16x16x32_bf16 v[204:207], v[184:187], a[192:195], v[204:207]
ds_read_b128 v[184:187], v14 offset:3072
s_waitcnt lgkmcnt(3)
v_mfma_f32_16x16x32_bf16 v[192:195], v[236:239], v[188:191], v[192:195]
v_mfma_f32_16x16x32_bf16 v[196:199], a[52:55], v[188:191], v[196:199]
v_mfma_f32_16x16x32_bf16 v[200:203], v[188:191], a[124:127], v[200:203]
v_mfma_f32_16x16x32_bf16 v[204:207], v[188:191], a[196:199], v[204:207]
ds_read_b128 v[188:191], v14 offset:3584
s_waitcnt lgkmcnt(3)
v_mfma_f32_16x16x32_bf16 v[192:195], v[240:243], v[176:179], v[192:195]
v_mfma_f32_16x16x32_bf16 v[196:199], a[56:59], v[176:179], v[196:199]
v_mfma_f32_16x16x32_bf16 v[200:203], v[176:179], a[128:131], v[200:203]
v_mfma_f32_16x16x32_bf16 v[204:207], v[176:179], a[200:203], v[204:207]
ds_read_b128 v[176:179], v14 offset:4096
s_waitcnt lgkmcnt(3)
v_mfma_f32_16x16x32_bf16 v[192:195], v[244:247], v[180:183], v[192:195]
v_mfma_f32_16x16x32_bf16 v[196:199], a[60:63], v[180:183], v[196:199]
v_mfma_f32_16x16x32_bf16 v[200:203], v[180:183], a[132:135], v[200:203]
v_mfma_f32_16x16x32_bf16 v[204:207], v[180:183], a[204:207], v[204:207]
ds_read_b128 v[180:183], v14 offset:4608
s_waitcnt lgkmcnt(3)
v_mfma_f32_16x16x32_bf16 v[192:195], v[248:251], v[184:187], v[192:195]
v_mfma_f32_16x16x32_bf16 v[196:199], a[64:67], v[184:187], v[196:199]
v_mfma_f32_16x16x32_bf16 v[200:203], v[184:187], a[136:139], v[200:203]
v_mfma_f32_16x16x32_bf16 v[204:207], v[184:187], a[208:211], v[204:207]
ds_read_b128 v[184:187], v14 offset:5120
s_waitcnt lgkmcnt(3)
v_mfma_f32_16x16x32_bf16 v[192:195], v[252:255], v[188:191], v[192:195]
v_mfma_f32_16x16x32_bf16 v[196:199], a[68:71], v[188:191], v[196:199]
v_mfma_f32_16x16x32_bf16 v[200:203], v[188:191], a[140:143], v[200:203]
v_mfma_f32_16x16x32_bf16 v[204:207], v[188:191], a[212:215], v[204:207]
ds_read_b128 v[188:191], v14 offset:5632
s_waitcnt lgkmcnt(3)
v_mfma_f32_16x16x32_bf16 v[192:195], a[0:3], v[176:179], v[192:195]
v_mfma_f32_16x16x32_bf16 v[196:199], a[72:75], v[176:179], v[196:199]
v_mfma_f32_16x16x32_bf16 v[200:203], v[176:179], a[144:147], v[200:203]
v_mfma_f32_16x16x32_bf16 v[204:207], v[176:179], a[216:219], v[204:207]
ds_read_b128 v[176:179], v14 offset:6144
s_waitcnt lgkmcnt(3)
v_mfma_f32_16x16x32_bf16 v[192:195], a[4:7], v[180:183], v[192:195]
v_mfma_f32_16x16x32_bf16 v[196:199], a[76:79], v[180:183], v[196:199]
v_mfma_f32_16x16x32_bf16 v[200:203], v[180:183], a[148:151], v[200:203]
v_mfma_f32_16x16x32_bf16 v[204:207], v[180:183], a[220:223], v[204:207]
ds_read_b128 v[180:183], v14 offset:6656
s_waitcnt lgkmcnt(3)
v_mfma_f32_16x16x32_bf16 v[192:195], a[8:11], v[184:187], v[192:195]
v_mfma_f32_16x16x32_bf16 v[196:199], a[80:83], v[184:187], v[196:199]
v_mfma_f32_16x16x32_bf16 v[200:203], v[184:187], a[152:155], v[200:203]
v_mfma_f32_16x16x32_bf16 v[204:207], v[184:187], a[224:227], v[204:207]
ds_read_b128 v[184:187], v14 offset:7168
s_waitcnt lgkmcnt(3)
v_mfma_f32_16x16x32_bf16 v[192:195], a[12:15], v[188:191], v[192:195]
v_mfma_f32_16x16x32_bf16 v[196:199], a[84:87], v[188:191], v[196:199]
v_mfma_f32_16x16x32_bf16 v[200:203], v[188:191], a[156:159], v[200:203]
v_mfma_f32_16x16x32_bf16 v[204:207], v[188:191], a[228:231], v[204:207]
ds_read_b128 v[188:191], v14 offset:7680
s_waitcnt lgkmcnt(3)
v_mfma_f32_16x16x32_bf16 v[192:195], a[16:19], v[176:179], v[192:195]
v_mfma_f32_16x16x32_bf16 v[196:199], a[88:91], v[176:179], v[196:199]
v_mfma_f32_16x16x32_bf16 v[200:203], v[176:179], a[160:163], v[200:203]
v_mfma_f32_16x16x32_bf16 v[204:207], v[176:179], a[232:235], v[204:207]
ds_read_b128 v[176:179], v14 offset:8192
s_waitcnt lgkmcnt(3)
v_mfma_f32_16x16x32_bf16 v[192:195], a[20:23], v[180:183], v[192:195]
v_mfma_f32_16x16x32_bf16 v[196:199], a[92:95], v[180:183], v[196:199]
v_mfma_f32_16x16x32_bf16 v[200:203], v[180:183], a[164:167], v[200:203]
v_mfma_f32_16x16x32_bf16 v[204:207], v[180:183], a[236:239], v[204:207]
ds_read_b128 v[180:183], v14 offset:8704
s_waitcnt lgkmcnt(3)
v_mfma_f32_16x16x32_bf16 v[192:195], a[24:27], v[184:187], v[192:195]
v_mfma_f32_16x16x32_bf16 v[196:199], a[96:99], v[184:187], v[196:199]
v_mfma_f32_16x16x32_bf16 v[200:203], v[184:187], a[168:171], v[200:203]
v_mfma_f32_16x16x32_bf16 v[204:207], v[184:187], a[240:243], v[204:207]
s_waitcnt lgkmcnt(2)
v_mfma_f32_16x16x32_bf16 v[192:195], a[28:31], v[188:191], v[192:195]
v_mfma_f32_16x16x32_bf16 v[196:199], a[100:103], v[188:191], v[196:199]
v_mfma_f32_16x16x32_bf16 v[200:203], v[188:191], a[172:175], v[200:203]
v_mfma_f32_16x16x32_bf16 v[204:207], v[188:191], a[244:247], v[204:207]
s_waitcnt lgkmcnt(1)
v_mfma_f32_16x16x32_bf16 v[192:195], a[32:35], v[176:179], v[192:195]
v_mfma_f32_16x16x32_bf16 v[196:199], a[104:107], v[176:179], v[196:199]
v_mfma_f32_16x16x32_bf16 v[200:203], v[176:179], a[176:179], v[200:203]
v_mfma_f32_16x16x32_bf16 v[204:207], v[176:179], a[248:251], v[204:207]
s_waitcnt lgkmcnt(0)
v_mfma_f32_16x16x32_bf16 v[192:195], a[36:39], v[180:183], v[192:195]
v_mfma_f32_16x16x32_bf16 v[196:199], a[108:111], v[180:183], v[196:199]
v_mfma_f32_16x16x32_bf16 v[200:203], v[180:183], a[180:183], v[200:203]
v_mfma_f32_16x16x32_bf16 v[204:207], v[180:183], a[252:255], v[204:207]
v_mul_f32 v192, s46, v192
v_mul_f32 v193, s46, v193
v_mul_f32 v194, s46, v194
v_mul_f32 v195, s46, v195
v_mul_f32 v196, s46, v196
v_mul_f32 v197, s46, v197
v_mul_f32 v198, s46, v198
v_mul_f32 v199, s46, v199
v_cvt_pk_bf16_f32 v208, v192, v193
v_cvt_pk_bf16_f32 v209, v194, v195
v_cvt_pk_bf16_f32 v210, v196, v197
v_cvt_pk_bf16_f32 v211, v198, v199
ds_write_b128 v6, v[208:211] offset:9216
v_cvt_pk_bf16_f32 v212, v200, v201
v_cvt_pk_bf16_f32 v213, v202, v203
v_cvt_pk_bf16_f32 v214, v204, v205
v_cvt_pk_bf16_f32 v215, v206, v207
ds_write_b128 v6, v[212:215] offset:13312
s_waitcnt lgkmcnt(0)
s_barrier
ds_read_b128 v[108:111], v1 offset:9216
ds_read_b128 v[112:115], v1 offset:10240
ds_read_b128 v[116:119], v1 offset:11264
ds_read_b128 v[120:123], v1 offset:12288
ds_read_b128 v[124:127], v3 offset:13312
ds_read_b128 v[128:131], v3 offset:14336
s_waitcnt lgkmcnt(5)
v_mfma_f32_16x16x32_bf16 v[104:107], v[108:111], v[16:19], v[88:91]
s_waitcnt lgkmcnt(4)
v_mfma_f32_16x16x32_bf16 v[104:107], v[112:115], v[20:23], v[104:107]
s_waitcnt lgkmcnt(3)
v_mfma_f32_16x16x32_bf16 v[104:107], v[116:119], v[24:27], v[104:107]
s_waitcnt lgkmcnt(2)
v_mfma_f32_16x16x32_bf16 v[104:107], v[120:123], v[28:31], v[104:107]
s_nop 7
v_max3_f32 v160, v160, v104, v105
v_max3_f32 v161, v160, v106, v107
v_max3_f32 v160, v160, v106, v107
s_nop 1
v_permlane16_swap_b32 v160, v161
v_max_f32 v162, v160, v161
v_max_f32 v163, v160, v161
s_nop 1
v_permlane32_swap_b32 v162, v163
v_max_f32 v160, v162, v163
v_pk_add_f32 v[96:97], v[96:97], v[160:161] op_sel_hi:[1,0] neg_lo:[0,1] neg_hi:[0,1]
v_pk_add_f32 v[98:99], v[98:99], v[160:161] op_sel_hi:[1,0] neg_lo:[0,1] neg_hi:[0,1]
v_pk_add_f32 v[100:101], v[100:101], v[160:161] op_sel_hi:[1,0] neg_lo:[0,1] neg_hi:[0,1]
v_pk_add_f32 v[102:103], v[102:103], v[160:161] op_sel_hi:[1,0] neg_lo:[0,1] neg_hi:[0,1]
v_pk_add_f32 v[104:105], v[104:105], v[160:161] op_sel_hi:[1,0] neg_lo:[0,1] neg_hi:[0,1]
v_pk_add_f32 v[106:107], v[106:107], v[160:161] op_sel_hi:[1,0] neg_lo:[0,1] neg_hi:[0,1]
v_exp_f32 v96, v96
v_exp_f32 v97, v97
v_exp_f32 v98, v98
v_exp_f32 v99, v99
v_exp_f32 v100, v100
v_exp_f32 v101, v101
v_exp_f32 v102, v102
v_exp_f32 v103, v103
v_exp_f32 v104, v104
v_exp_f32 v105, v105
v_exp_f32 v106, v106
v_exp_f32 v107, v107
v_cvt_pk_bf16_f32 v132, v96, v97
v_cvt_pk_bf16_f32 v133, v98, v99
v_cvt_pk_bf16_f32 v134, v100, v101
v_cvt_pk_bf16_f32 v135, v102, v103
v_cvt_pk_bf16_f32 v136, v104, v105
v_cvt_pk_bf16_f32 v137, v106, v107
v_mfma_f32_16x16x32_bf16 v[156:159], v[92:95], v[132:135], 0
v_mfma_f32_16x16x32_bf16 v[140:143], v[64:67], v[132:135], 0
v_mfma_f32_16x16x32_bf16 v[144:147], v[68:71], v[132:135], 0
v_mfma_f32_16x16x32_bf16 v[148:151], v[72:75], v[132:135], 0
v_mfma_f32_16x16x32_bf16 v[152:155], v[76:79], v[132:135], 0
s_waitcnt lgkmcnt(0)
v_mfma_f32_16x16x16_bf16 v[156:159], v[92:93], v[136:137], v[156:159]
v_mfma_f32_16x16x16_bf16 v[140:143], v[124:125], v[136:137], v[140:143]
v_mfma_f32_16x16x16_bf16 v[144:147], v[126:127], v[136:137], v[144:147]
v_mfma_f32_16x16x16_bf16 v[148:151], v[128:129], v[136:137], v[148:151]
v_mfma_f32_16x16x16_bf16 v[152:155], v[130:131], v[136:137], v[152:155]
v_rcp_f32 v156, v156
s_nop 0
v_mul_f32 v140, v140, v156
v_mul_f32 v141, v141, v156
v_mul_f32 v142, v142, v156
v_mul_f32 v143, v143, v156
v_mul_f32 v144, v144, v156
v_mul_f32 v145, v145, v156
v_mul_f32 v146, v146, v156
v_mul_f32 v147, v147, v156
v_cvt_pk_bf16_f32 v140, v140, v141
v_cvt_pk_bf16_f32 v141, v142, v143
v_cvt_pk_bf16_f32 v142, v144, v145
v_cvt_pk_bf16_f32 v143, v146, v147
buffer_store_dwordx4 v[140:143], v1, s[4:7], s56 offen offset:0 sc0 sc1
v_mul_f32 v148, v148, v156
v_mul_f32 v149, v149, v156
v_mul_f32 v150, v150, v156
v_mul_f32 v151, v151, v156
v_mul_f32 v152, v152, v156
v_mul_f32 v153, v153, v156
v_mul_f32 v154, v154, v156
v_mul_f32 v155, v155, v156
v_cvt_pk_bf16_f32 v148, v148, v149
v_cvt_pk_bf16_f32 v149, v150, v151
v_cvt_pk_bf16_f32 v150, v152, v153
v_cvt_pk_bf16_f32 v151, v154, v155
buffer_store_dwordx4 v[148:151], v1, s[4:7], s56 offen offset:1024 sc0 sc1
s_add_u32 s35, s35, 1
v_mov_b32 v13, s35
s_add_u32 s50, s50, 1048576
s_add_u32 s52, s52, 2097152
s_add_u32 s53, s53, 2097152
s_add_u32 s55, s55, 40960
s_add_u32 s56, s56, 1048576
s_waitcnt vmcnt(0)
s_mov_b64 exec, 1
buffer_store_dword v13, v8, s[4:7], s58 offen sc0 sc1
s_mov_b64 exec, -1
s_cmp_lt_u32 s35, 16
s_cbranch_scc1 L_at_loop
s_waitcnt vmcnt(0)
s_endpgm
L_role_aw:
s_load_dwordx2 s[4:5], s[0:1], 104
s_mov_b32 s6, 268435456
s_mov_b32 s7, 0x20000
s_load_dwordx2 s[8:9], s[0:1], 0
s_mov_b32 s10, 2359296
s_mov_b32 s11, 0x20000
s_load_dwordx2 s[12:13], s[0:1], 8
s_mov_b32 s14, 1990656
s_mov_b32 s15, 0x20000
s_load_dwordx2 s[16:17], s[0:1], 16
s_mov_b32 s18, 663552
s_mov_b32 s19, 0x20000
s_load_dwordx2 s[20:21], s[0:1], 64
s_mov_b32 s22, 4718592
s_mov_b32 s23, 0x20000
s_load_dwordx2 s[24:25], s[0:1], 96
s_mov_b32 s26, 256
s_mov_b32 s27, 0x20000
s_load_dwordx2 s[28:29], s[0:1], 88
s_mov_b32 s30, 2359296
s_mov_b32 s31, 0x20000
s_load_dwordx2 s[64:65], s[0:1], 80
s_mov_b32 s66, 1152
s_mov_b32 s67, 0x20000
v_and_b32 v9, 63, v0
v_and_b32 v10, 15, v0
v_bfe_u32 v11, v0, 4, 2
v_lshrrev_b32 v1, 6, v0
s_nop 0
v_readfirstlane_b32 s34, v1
v_lshrrev_b32 v12, 2, v9
v_mul_u32_u24 v2, 1152, v12
v_lshrrev_b32 v12, 5, v9
v_lshlrev_b32 v12, 1, v12
v_and_b32 v13, 3, v9
v_xor_b32 v12, v12, v13
v_lshl_add_u32 v2, v12, 4, v2
v_lshrrev_b32 v12, 3, v10
v_lshlrev_b32 v12, 1, v12
v_xor_b32 v12, v12, v11
v_lshlrev_b32 v12, 4, v12
v_lshl_add_u32 v3, v10, 6, v12
v_lshrrev_b32 v12, 2, v10
v_lshl_add_u32 v12, v11, 3, v12
v_mul_u32_u24 v7, 64, v12
v_and_b32 v12, 3, v10
v_lshl_add_u32 v7, v12, 3, v7
v_lshlrev_b32 v1, 4, v9
s_mul_i32 s38, s34, 20480
s_add_u32 s38, s38, 73728
v_add_u32 v7, s38, v7
v_mov_b32 v8, 0
s_lshl_b32 s37, s34, 3
s_add_u32 s37, s37, 0
v_and_b32 v12, 3, v9
v_add_u32 v12, s37, v12
v_min_u32 v12, 26, v12
v_mul_u32_u24 v13, 57, v12
v_lshrrev_b32 v13, 9, v13
v_mul_u32_u24 v13, 1008, v13
v_lshl_add_u32 v13, v12, 4, v13
v_lshrrev_b32 v12, 2, v9
v_mul_u32_u24 v12, 3456, v12
v_add_u32 v5, v12, v13
s_lshl_b32 s37, s34, 3
s_add_u32 s37, s37, 4
v_and_b32 v12, 3, v9
v_add_u32 v12, s37, v12
v_min_u32 v12, 26, v12
v_mul_u32_u24 v13, 57, v12
v_lshrrev_b32 v13, 9, v13
v_mul_u32_u24 v13, 1008, v13
v_lshl_add_u32 v13, v12, 4, v13
v_lshrrev_b32 v12, 2, v9
v_mul_u32_u24 v12, 3456, v12
v_add_u32 v6, v12, v13
s_mul_i32 s39, s32, 144
s_mul_i32 s40, s33, 11
s_and_b32 s41, s34, 1
s_add_u32 s40, s40, s41
s_sub_u32 s40, s40, 1
s_max_i32 s41, s40, 0
s_lshr_b32 s42, s34, 1
s_lshl_b32 s42, s42, 6
s_mul_i32 s43, s41, 18432
s_add_u32 s43, s43, s42
s_mul_i32 s40, s40, 18432
s_add_u32 s40, s40, s42
s_lshl_b32 s44, s34, 10
s_mov_b32 s36, 400000
v_mul_u32_u24 v4, 456, v10
v_lshl_add_u32 v4, v11, 3, v4
s_lshl_b32 s37, s34, 7
s_add_u32 s37, s37, 73728
v_add_u32 v4, s37, v4
v_lshlrev_b32 v14, 2, v10
v_add_u32 v14, 161280, v14
s_waitcnt lgkmcnt(0)
s_add_u32 s37, s39, 0
s_add_u32 m0, s38, 0
s_nop 0
buffer_load_dwordx4 v5, s[12:15], s37 offen lds
s_add_u32 s37, s39, 55296
s_add_u32 m0, s38, 1024
s_nop 0
buffer_load_dwordx4 v5, s[12:15], s37 offen lds
s_add_u32 s37, s39, 110592
s_add_u32 m0, s38, 2048
s_nop 0
buffer_load_dwordx4 v5, s[12:15], s37 offen lds
s_add_u32 s37, s39, 165888
s_add_u32 m0, s38, 3072
s_nop 0
buffer_load_dwordx4 v5, s[12:15], s37 offen lds
s_add_u32 s37, s39, 221184
s_add_u32 m0, s38, 4096
s_nop 0
buffer_load_dwordx4 v5, s[12:15], s37 offen lds
s_add_u32 s37, s39, 276480
s_add_u32 m0, s38, 5120
s_nop 0
buffer_load_dwordx4 v5, s[12:15], s37 offen lds
s_add_u32 s37, s39, 331776
s_add_u32 m0, s38, 6144
s_nop 0
buffer_load_dwordx4 v5, s[12:15], s37 offen lds
s_add_u32 s37, s39, 387072
s_add_u32 m0, s38, 7168
s_nop 0
buffer_load_dwordx4 v5, s[12:15], s37 offen lds
s_add_u32 s37, s39, 442368
s_add_u32 m0, s38, 8192
s_nop 0
buffer_load_dwordx4 v5, s[12:15], s37 offen lds
s_add_u32 s37, s39, 497664
s_add_u32 m0, s38, 9216
s_nop 0
buffer_load_dwordx4 v5, s[12:15], s37 offen lds
s_add_u32 s37, s39, 552960
s_add_u32 m0, s38, 10240
s_nop 0
buffer_load_dwordx4 v5, s[12:15], s37 offen lds
s_add_u32 s37, s39, 608256
s_add_u32 m0, s38, 11264
s_nop 0
buffer_load_dwordx4 v5, s[12:15], s37 offen lds
s_add_u32 s37, s39, 663552
s_add_u32 m0, s38, 12288
s_nop 0
buffer_load_dwordx4 v5, s[12:15], s37 offen lds
s_add_u32 s37, s39, 718848
s_add_u32 m0, s38, 13312
s_nop 0
buffer_load_dwordx4 v5, s[12:15], s37 offen lds
s_add_u32 s37, s39, 774144
s_add_u32 m0, s38, 14336
s_nop 0
buffer_load_dwordx4 v5, s[12:15], s37 offen lds
s_add_u32 s37, s39, 829440
s_add_u32 m0, s38, 15360
s_nop 0
buffer_load_dwordx4 v5, s[12:15], s37 offen lds
s_add_u32 s37, s43, 0
s_add_u32 m0, s44, 0
s_nop 0
buffer_load_dwordx4 v2, s[8:11], s37 offen lds
s_add_u32 s37, s43, 128
s_add_u32 m0, s44, 4096
s_nop 0
buffer_load_dwordx4 v2, s[8:11], s37 offen lds
s_add_u32 s37, s43, 256
s_add_u32 m0, s44, 8192
s_nop 0
buffer_load_dwordx4 v2, s[8:11], s37 offen lds
s_add_u32 s37, s43, 384
s_add_u32 m0, s44, 12288
s_nop 0
buffer_load_dwordx4 v2, s[8:11], s37 offen lds
s_add_u32 s37, s43, 512
s_add_u32 m0, s44, 16384
s_nop 0
buffer_load_dwordx4 v2, s[8:11], s37 offen lds
s_add_u32 s37, s43, 640
s_add_u32 m0, s44, 20480
s_nop 0
buffer_load_dwordx4 v2, s[8:11], s37 offen lds
s_add_u32 s37, s43, 768
s_add_u32 m0, s44, 24576
s_nop 0
buffer_load_dwordx4 v2, s[8:11], s37 offen lds
s_add_u32 s37, s43, 896
s_add_u32 m0, s44, 28672
s_nop 0
buffer_load_dwordx4 v2, s[8:11], s37 offen lds
s_add_u32 s37, s43, 1024
s_add_u32 m0, s44, 32768
s_nop 0
buffer_load_dwordx4 v2, s[8:11], s37 offen lds
s_waitcnt vmcnt(21)
ds_read_b64_tr_b16 v[80:81], v7 offset:0
ds_read_b64_tr_b16 v[82:83], v7 offset:256
ds_read_b64_tr_b16 v[84:85], v7 offset:2048
ds_read_b64_tr_b16 v[86:87], v7 offset:2304
ds_read_b64_tr_b16 v[152:153], v7 offset:32
ds_read_b64_tr_b16 v[154:155], v7 offset:288
ds_read_b64_tr_b16 v[156:157], v7 offset:2080
ds_read_b64_tr_b16 v[158:159], v7 offset:2336
s_waitcnt lgkmcnt(0)
s_add_u32 s37, s39, 884736
s_add_u32 m0, s38, 16384
s_nop 0
buffer_load_dwordx4 v5, s[12:15], s37 offen lds
s_add_u32 s37, s39, 940032
s_add_u32 m0, s38, 17408
s_nop 0
buffer_load_dwordx4 v5, s[12:15], s37 offen lds
s_add_u32 s37, s39, 995328
s_add_u32 m0, s38, 18432
s_nop 0
buffer_load_dwordx4 v5, s[12:15], s37 offen lds
s_add_u32 s37, s39, 1050624
s_add_u32 m0, s38, 19456
s_nop 0
buffer_load_dwordx4 v5, s[12:15], s37 offen lds
s_waitcnt vmcnt(21)
ds_read_b64_tr_b16 v[88:89], v7 offset:4096
ds_read_b64_tr_b16 v[90:91], v7 offset:4352
ds_read_b64_tr_b16 v[92:93], v7 offset:6144
ds_read_b64_tr_b16 v[94:95], v7 offset:6400
ds_read_b64_tr_b16 v[160:161], v7 offset:4128
ds_read_b64_tr_b16 v[162:163], v7 offset:4384
ds_read_b64_tr_b16 v[164:165], v7 offset:6176
ds_read_b64_tr_b16 v[166:167], v7 offset:6432
s_waitcnt lgkmcnt(0)
s_add_u32 s37, s39, 1105920
s_add_u32 m0, s38, 0
s_nop 0
buffer_load_dwordx4 v5, s[12:15], s37 offen lds
s_add_u32 s37, s39, 1161216
s_add_u32 m0, s38, 1024
s_nop 0
buffer_load_dwordx4 v5, s[12:15], s37 offen lds
s_add_u32 s37, s39, 1216512
s_add_u32 m0, s38, 2048
s_nop 0
buffer_load_dwordx4 v5, s[12:15], s37 offen lds
s_add_u32 s37, s39, 1271808
s_add_u32 m0, s38, 3072
s_nop 0
buffer_load_dwordx4 v5, s[12:15], s37 offen lds
s_waitcnt vmcnt(21)
ds_read_b64_tr_b16 v[96:97], v7 offset:8192
ds_read_b64_tr_b16 v[98:99], v7 offset:8448
ds_read_b64_tr_b16 v[100:101], v7 offset:10240
ds_read_b64_tr_b16 v[102:103], v7 offset:10496
ds_read_b64_tr_b16 v[168:169], v7 offset:8224
ds_read_b64_tr_b16 v[170:171], v7 offset:8480
ds_read_b64_tr_b16 v[172:173], v7 offset:10272
ds_read_b64_tr_b16 v[174:175], v7 offset:10528
s_waitcnt lgkmcnt(0)
s_add_u32 s37, s39, 1327104
s_add_u32 m0, s38, 4096
s_nop 0
buffer_load_dwordx4 v5, s[12:15], s37 offen lds
s_add_u32 s37, s39, 1382400
s_add_u32 m0, s38, 5120
s_nop 0
buffer_load_dwordx4 v5, s[12:15], s37 offen lds
s_add_u32 s37, s39, 1437696
s_add_u32 m0, s38, 6144
s_nop 0
buffer_load_dwordx4 v5, s[12:15], s37 offen lds
s_add_u32 s37, s39, 1492992
s_add_u32 m0, s38, 7168
s_nop 0
buffer_load_dwordx4 v5, s[12:15], s37 offen lds
s_waitcnt vmcnt(21)
ds_read_b64_tr_b16 v[104:105], v7 offset:12288
ds_read_b64_tr_b16 v[106:107], v7 offset:12544
ds_read_b64_tr_b16 v[108:109], v7 offset:14336
ds_read_b64_tr_b16 v[110:111], v7 offset:14592
ds_read_b64_tr_b16 v[176:177], v7 offset:12320
ds_read_b64_tr_b16 v[178:179], v7 offset:12576
ds_read_b64_tr_b16 v[180:181], v7 offset:14368
ds_read_b64_tr_b16 v[182:183], v7 offset:14624
s_waitcnt lgkmcnt(0)
s_add_u32 s37, s39, 1548288
s_add_u32 m0, s38, 8192
s_nop 0
buffer_load_dwordx4 v5, s[12:15], s37 offen lds
s_add_u32 s37, s39, 1603584
s_add_u32 m0, s38, 9216
s_nop 0
buffer_load_dwordx4 v5, s[12:15], s37 offen lds
s_add_u32 s37, s39, 1658880
s_add_u32 m0, s38, 10240
s_nop 0
buffer_load_dwordx4 v5, s[12:15], s37 offen lds
s_add_u32 s37, s39, 1714176
s_add_u32 m0, s38, 11264
s_nop 0
buffer_load_dwordx4 v5, s[12:15], s37 offen lds
s_waitcnt vmcnt(12)
ds_read_b64_tr_b16 v[112:113], v7 offset:16384
ds_read_b64_tr_b16 v[114:115], v7 offset:16640
ds_read_b64_tr_b16 v[116:117], v7 offset:18432
ds_read_b64_tr_b16 v[118:119], v7 offset:18688
ds_read_b64_tr_b16 v[184:185], v7 offset:16416
ds_read_b64_tr_b16 v[186:187], v7 offset:16672
ds_read_b64_tr_b16 v[188:189], v7 offset:18464
ds_read_b64_tr_b16 v[190:191], v7 offset:18720
s_waitcnt lgkmcnt(0)
s_add_u32 s37, s39, 1769472
s_add_u32 m0, s38, 12288
s_nop 0
buffer_load_dwordx4 v5, s[12:15], s37 offen lds
s_add_u32 s37, s39, 1824768
s_add_u32 m0, s38, 13312
s_nop 0
buffer_load_dwordx4 v5, s[12:15], s37 offen lds
s_add_u32 s37, s39, 1880064
s_add_u32 m0, s38, 14336
s_nop 0
buffer_load_dwordx4 v5, s[12:15], s37 offen lds
s_add_u32 s37, s39, 1935360
s_add_u32 m0, s38, 15360
s_nop 0
buffer_load_dwordx4 v5, s[12:15], s37 offen lds
s_waitcnt vmcnt(12)
ds_read_b64_tr_b16 v[120:121], v7 offset:0
ds_read_b64_tr_b16 v[122:123], v7 offset:256
ds_read_b64_tr_b16 v[124:125], v7 offset:2048
ds_read_b64_tr_b16 v[126:127], v7 offset:2304
ds_read_b64_tr_b16 v[192:193], v7 offset:32
ds_read_b64_tr_b16 v[194:195], v7 offset:288
ds_read_b64_tr_b16 v[196:197], v7 offset:2080
ds_read_b64_tr_b16 v[198:199], v7 offset:2336
s_waitcnt lgkmcnt(0)
s_add_u32 s37, s39, 0
s_add_u32 m0, s38, 16384
s_nop 0
buffer_load_dwordx4 v6, s[12:15], s37 offen lds
s_add_u32 s37, s39, 55296
s_add_u32 m0, s38, 17408
s_nop 0
buffer_load_dwordx4 v6, s[12:15], s37 offen lds
s_add_u32 s37, s39, 110592
s_add_u32 m0, s38, 18432
s_nop 0
buffer_load_dwordx4 v6, s[12:15], s37 offen lds
s_add_u32 s37, s39, 165888
s_add_u32 m0, s38, 19456
s_nop 0
buffer_load_dwordx4 v6, s[12:15], s37 offen lds
s_waitcnt vmcnt(12)
ds_read_b64_tr_b16 v[128:129], v7 offset:4096
ds_read_b64_tr_b16 v[130:131], v7 offset:4352
ds_read_b64_tr_b16 v[132:133], v7 offset:6144
ds_read_b64_tr_b16 v[134:135], v7 offset:6400
ds_read_b64_tr_b16 v[200:201], v7 offset:4128
ds_read_b64_tr_b16 v[202:203], v7 offset:4384
ds_read_b64_tr_b16 v[204:205], v7 offset:6176
ds_read_b64_tr_b16 v[206:207], v7 offset:6432
s_waitcnt lgkmcnt(0)
s_add_u32 s37, s39, 221184
s_add_u32 m0, s38, 0
s_nop 0
buffer_load_dwordx4 v6, s[12:15], s37 offen lds
s_add_u32 s37, s39, 276480
s_add_u32 m0, s38, 1024
s_nop 0
buffer_load_dwordx4 v6, s[12:15], s37 offen lds
s_add_u32 s37, s39, 331776
s_add_u32 m0, s38, 2048
s_nop 0
buffer_load_dwordx4 v6, s[12:15], s37 offen lds
s_add_u32 s37, s39, 387072
s_add_u32 m0, s38, 3072
s_nop 0
buffer_load_dwordx4 v6, s[12:15], s37 offen lds
s_waitcnt vmcnt(12)
ds_read_b64_tr_b16 v[136:137], v7 offset:8192
ds_read_b64_tr_b16 v[138:139], v7 offset:8448
ds_read_b64_tr_b16 v[140:141], v7 offset:10240
ds_read_b64_tr_b16 v[142:143], v7 offset:10496
ds_read_b64_tr_b16 v[208:209], v7 offset:8224
ds_read_b64_tr_b16 v[210:211], v7 offset:8480
ds_read_b64_tr_b16 v[212:213], v7 offset:10272
ds_read_b64_tr_b16 v[214:215], v7 offset:10528
s_waitcnt lgkmcnt(0)
s_add_u32 s37, s39, 442368
s_add_u32 m0, s38, 4096
s_nop 0
buffer_load_dwordx4 v6, s[12:15], s37 offen lds
s_add_u32 s37, s39, 497664
s_add_u32 m0, s38, 5120
s_nop 0
buffer_load_dwordx4 v6, s[12:15], s37 offen lds
s_add_u32 s37, s39, 552960
s_add_u32 m0, s38, 6144
s_nop 0
buffer_load_dwordx4 v6, s[12:15], s37 offen lds
s_add_u32 s37, s39, 608256
s_add_u32 m0, s38, 7168
s_nop 0
buffer_load_dwordx4 v6, s[12:15], s37 offen lds
s_waitcnt vmcnt(12)
ds_read_b64_tr_b16 v[144:145], v7 offset:12288
ds_read_b64_tr_b16 v[146:147], v7 offset:12544
ds_read_b64_tr_b16 v[148:149], v7 offset:14336
ds_read_b64_tr_b16 v[150:151], v7 offset:14592
ds_read_b64_tr_b16 v[216:217], v7 offset:12320
ds_read_b64_tr_b16 v[218:219], v7 offset:12576
ds_read_b64_tr_b16 v[220:221], v7 offset:14368
ds_read_b64_tr_b16 v[222:223], v7 offset:14624
s_waitcnt lgkmcnt(0)
s_add_u32 s37, s39, 663552
s_add_u32 m0, s38, 8192
s_nop 0
buffer_load_dwordx4 v6, s[12:15], s37 offen lds
s_add_u32 s37, s39, 718848
s_add_u32 m0, s38, 9216
s_nop 0
buffer_load_dwordx4 v6, s[12:15], s37 offen lds
s_add_u32 s37, s39, 774144
s_add_u32 m0, s38, 10240
s_nop 0
buffer_load_dwordx4 v6, s[12:15], s37 offen lds
s_add_u32 s37, s39, 829440
s_add_u32 m0, s38, 11264
s_nop 0
buffer_load_dwordx4 v6, s[12:15], s37 offen lds
s_waitcnt vmcnt(12)
ds_read_b64_tr_b16 v[224:225], v7 offset:16384
ds_read_b64_tr_b16 v[226:227], v7 offset:16640
ds_read_b64_tr_b16 v[228:229], v7 offset:18432
ds_read_b64_tr_b16 v[230:231], v7 offset:18688
ds_read_b64_tr_b16 a[40:41], v7 offset:16416
ds_read_b64_tr_b16 a[42:43], v7 offset:16672
ds_read_b64_tr_b16 a[44:45], v7 offset:18464
ds_read_b64_tr_b16 a[46:47], v7 offset:18720
s_waitcnt lgkmcnt(0)
s_add_u32 s37, s39, 884736
s_add_u32 m0, s38, 12288
s_nop 0
buffer_load_dwordx4 v6, s[12:15], s37 offen lds
s_add_u32 s37, s39, 940032
s_add_u32 m0, s38, 13312
s_nop 0
buffer_load_dwordx4 v6, s[12:15], s37 offen lds
s_add_u32 s37, s39, 995328
s_add_u32 m0, s38, 14336
s_nop 0
buffer_load_dwordx4 v6, s[12:15], s37 offen lds
s_add_u32 s37, s39, 1050624
s_add_u32 m0, s38, 15360
s_nop 0
buffer_load_dwordx4 v6, s[12:15], s37 offen lds
s_waitcnt vmcnt(12)
ds_read_b64_tr_b16 v[232:233], v7 offset:0
ds_read_b64_tr_b16 v[234:235], v7 offset:256
ds_read_b64_tr_b16 v[236:237], v7 offset:2048
ds_read_b64_tr_b16 v[238:239], v7 offset:2304
ds_read_b64_tr_b16 a[48:49], v7 offset:32
ds_read_b64_tr_b16 a[50:51], v7 offset:288
ds_read_b64_tr_b16 a[52:53], v7 offset:2080
ds_read_b64_tr_b16 a[54:55], v7 offset:2336
s_waitcnt lgkmcnt(0)
s_add_u32 s37, s39, 1105920
s_add_u32 m0, s38, 16384
s_nop 0
buffer_load_dwordx4 v6, s[12:15], s37 offen lds
s_add_u32 s37, s39, 1161216
s_add_u32 m0, s38, 17408
s_nop 0
buffer_load_dwordx4 v6, s[12:15], s37 offen lds
s_add_u32 s37, s39, 1216512
s_add_u32 m0, s38, 18432
s_nop 0
buffer_load_dwordx4 v6, s[12:15], s37 offen lds
s_add_u32 s37, s39, 1271808
s_add_u32 m0, s38, 19456
s_nop 0
buffer_load_dwordx4 v6, s[12:15], s37 offen lds
s_waitcnt vmcnt(12)
ds_read_b64_tr_b16 v[240:241], v7 offset:4096
ds_read_b64_tr_b16 v[242:243], v7 offset:4352
ds_read_b64_tr_b16 v[244:245], v7 offset:6144
ds_read_b64_tr_b16 v[246:247], v7 offset:6400
ds_read_b64_tr_b16 a[56:57], v7 offset:4128
ds_read_b64_tr_b16 a[58:59], v7 offset:4384
ds_read_b64_tr_b16 a[60:61], v7 offset:6176
ds_read_b64_tr_b16 a[62:63], v7 offset:6432
s_waitcnt lgkmcnt(0)
s_add_u32 s37, s39, 1327104
s_add_u32 m0, s38, 0
s_nop 0
buffer_load_dwordx4 v6, s[12:15], s37 offen lds
s_add_u32 s37, s39, 1382400
s_add_u32 m0, s38, 1024
s_nop 0
buffer_load_dwordx4 v6, s[12:15], s37 offen lds
s_add_u32 s37, s39, 1437696
s_add_u32 m0, s38, 2048
s_nop 0
buffer_load_dwordx4 v6, s[12:15], s37 offen lds
s_add_u32 s37, s39, 1492992
s_add_u32 m0, s38, 3072
s_nop 0
buffer_load_dwordx4 v6, s[12:15], s37 offen lds
s_waitcnt vmcnt(12)
ds_read_b64_tr_b16 v[248:249], v7 offset:8192
ds_read_b64_tr_b16 v[250:251], v7 offset:8448
ds_read_b64_tr_b16 v[252:253], v7 offset:10240
ds_read_b64_tr_b16 v[254:255], v7 offset:10496
ds_read_b64_tr_b16 a[64:65], v7 offset:8224
ds_read_b64_tr_b16 a[66:67], v7 offset:8480
ds_read_b64_tr_b16 a[68:69], v7 offset:10272
ds_read_b64_tr_b16 a[70:71], v7 offset:10528
s_waitcnt lgkmcnt(0)
s_add_u32 s37, s39, 1548288
s_add_u32 m0, s38, 4096
s_nop 0
buffer_load_dwordx4 v6, s[12:15], s37 offen lds
s_add_u32 s37, s39, 1603584
s_add_u32 m0, s38, 5120
s_nop 0
buffer_load_dwordx4 v6, s[12:15], s37 offen lds
s_add_u32 s37, s39, 1658880
s_add_u32 m0, s38, 6144
s_nop 0
buffer_load_dwordx4 v6, s[12:15], s37 offen lds
s_add_u32 s37, s39, 1714176
s_add_u32 m0, s38, 7168
s_nop 0
buffer_load_dwordx4 v6, s[12:15], s37 offen lds
s_waitcnt vmcnt(12)
ds_read_b64_tr_b16 a[0:1], v7 offset:12288
ds_read_b64_tr_b16 a[2:3], v7 offset:12544
ds_read_b64_tr_b16 a[4:5], v7 offset:14336
ds_read_b64_tr_b16 a[6:7], v7 offset:14592
ds_read_b64_tr_b16 a[72:73], v7 offset:12320
ds_read_b64_tr_b16 a[74:75], v7 offset:12576
ds_read_b64_tr_b16 a[76:77], v7 offset:14368
ds_read_b64_tr_b16 a[78:79], v7 offset:14624
s_waitcnt lgkmcnt(0)
s_add_u32 s37, s39, 1769472
s_add_u32 m0, s38, 8192
s_nop 0
buffer_load_dwordx4 v6, s[12:15], s37 offen lds
s_add_u32 s37, s39, 1824768
s_add_u32 m0, s38, 9216
s_nop 0
buffer_load_dwordx4 v6, s[12:15], s37 offen lds
s_add_u32 s37, s39, 1880064
s_add_u32 m0, s38, 10240
s_nop 0
buffer_load_dwordx4 v6, s[12:15], s37 offen lds
s_add_u32 s37, s39, 1935360
s_add_u32 m0, s38, 11264
s_nop 0
buffer_load_dwordx4 v6, s[12:15], s37 offen lds
s_waitcnt vmcnt(12)
ds_read_b64_tr_b16 a[8:9], v7 offset:16384
ds_read_b64_tr_b16 a[10:11], v7 offset:16640
ds_read_b64_tr_b16 a[12:13], v7 offset:18432
ds_read_b64_tr_b16 a[14:15], v7 offset:18688
ds_read_b64_tr_b16 a[80:81], v7 offset:16416
ds_read_b64_tr_b16 a[82:83], v7 offset:16672
ds_read_b64_tr_b16 a[84:85], v7 offset:18464
ds_read_b64_tr_b16 a[86:87], v7 offset:18720
s_waitcnt lgkmcnt(0)
s_waitcnt vmcnt(8)
ds_read_b64_tr_b16 a[16:17], v7 offset:0
ds_read_b64_tr_b16 a[18:19], v7 offset:256
ds_read_b64_tr_b16 a[20:21], v7 offset:2048
ds_read_b64_tr_b16 a[22:23], v7 offset:2304
ds_read_b64_tr_b16 a[88:89], v7 offset:32
ds_read_b64_tr_b16 a[90:91], v7 offset:288
ds_read_b64_tr_b16 a[92:93], v7 offset:2080
ds_read_b64_tr_b16 a[94:95], v7 offset:2336
s_waitcnt lgkmcnt(0)
s_waitcnt vmcnt(4)
ds_read_b64_tr_b16 a[24:25], v7 offset:4096
ds_read_b64_tr_b16 a[26:27], v7 offset:4352
ds_read_b64_tr_b16 a[28:29], v7 offset:6144
ds_read_b64_tr_b16 a[30:31], v7 offset:6400
ds_read_b64_tr_b16 a[96:97], v7 offset:4128
ds_read_b64_tr_b16 a[98:99], v7 offset:4384
ds_read_b64_tr_b16 a[100:101], v7 offset:6176
ds_read_b64_tr_b16 a[102:103], v7 offset:6432
s_waitcnt lgkmcnt(0)
s_waitcnt vmcnt(0)
ds_read_b64_tr_b16 a[32:33], v7 offset:8192
ds_read_b64_tr_b16 a[34:35], v7 offset:8448
ds_read_b64_tr_b16 a[36:37], v7 offset:10240
ds_read_b64_tr_b16 a[38:39], v7 offset:10496
ds_read_b64_tr_b16 a[104:105], v7 offset:8224
ds_read_b64_tr_b16 a[106:107], v7 offset:8480
ds_read_b64_tr_b16 a[108:109], v7 offset:10272
ds_read_b64_tr_b16 a[110:111], v7 offset:10528
s_waitcnt lgkmcnt(0)
s_cmp_lg_u32 s34, 3
s_cbranch_scc1 L_a_nogate
v_lshlrev_b32 v12, 4, v11
buffer_load_dwordx4 v[224:227], v12, s[64:67], 0 offen offset:0
buffer_load_dwordx4 v[228:231], v12, s[64:67], 0 offen offset:64
buffer_load_dwordx4 v[232:235], v12, s[64:67], 0 offen offset:128
buffer_load_dwordx4 v[236:239], v12, s[64:67], 0 offen offset:192
buffer_load_dwordx4 v[240:243], v12, s[64:67], 0 offen offset:256
buffer_load_dwordx4 v[244:247], v12, s[64:67], 0 offen offset:320
buffer_load_dwordx4 v[248:251], v12, s[64:67], 0 offen offset:384
buffer_load_dwordx4 v[252:255], v12, s[64:67], 0 offen offset:448
buffer_load_dwordx4 a[0:3], v12, s[64:67], 0 offen offset:512
buffer_load_dwordx4 a[4:7], v12, s[64:67], 0 offen offset:576
buffer_load_dwordx4 a[8:11], v12, s[64:67], 0 offen offset:640
buffer_load_dwordx4 a[12:15], v12, s[64:67], 0 offen offset:704
buffer_load_dwordx4 a[16:19], v12, s[64:67], 0 offen offset:768
buffer_load_dwordx4 a[20:23], v12, s[64:67], 0 offen offset:832
buffer_load_dwordx4 a[24:27], v12, s[64:67], 0 offen offset:896
buffer_load_dwordx4 a[28:31], v12, s[64:67], 0 offen offset:960
buffer_load_dwordx4 a[32:35], v12, s[64:67], 0 offen offset:1024
buffer_load_dwordx4 a[36:39], v12, s[64:67], 0 offen offset:1088
L_a_nogate:
s_mov_b32 s43, s40
s_mov_b32 s35, 0
s_mov_b32 s50, 36864
.p2align 6
L_a_loop:
s_waitcnt vmcnt(0)
s_barrier
s_add_u32 s43, s43, 36864
s_add_u32 s44, s44, s50
ds_read_b128 v[64:67], v3 offset:0
ds_read_b128 v[68:71], v3 offset:1024
ds_read_b128 v[72:75], v3 offset:2048
ds_read_b128 v[76:79], v3 offset:3072
s_waitcnt lgkmcnt(2)
v_mfma_f32_16x16x32_bf16 v[16:19], v[80:83], v[64:67], 0
v_mfma_f32_16x16x32_bf16 v[20:23], v[80:83], v[68:71], 0
v_mfma_f32_16x16x32_bf16 v[24:27], v[152:155], v[64:67], 0
v_mfma_f32_16x16x32_bf16 v[28:31], v[152:155], v[68:71], 0
s_add_u32 s37, s43, 0
s_add_u32 m0, s44, 0
s_nop 0
buffer_load_dwordx4 v2, s[8:11], s37 offen lds
v_mfma_f32_16x16x32_bf16 v[32:35], v[224:227], v[64:67], 0
v_mfma_f32_16x16x32_bf16 v[36:39], v[224:227], v[68:71], 0
v_mfma_f32_16x16x32_bf16 v[40:43], a[40:43], v[64:67], 0
v_mfma_f32_16x16x32_bf16 v[44:47], a[40:43], v[68:71], 0
ds_read_b128 v[64:67], v3 offset:4096
ds_read_b128 v[68:71], v3 offset:5120
s_waitcnt lgkmcnt(2)
v_mfma_f32_16x16x32_bf16 v[16:19], v[84:87], v[72:75], v[16:19]
v_mfma_f32_16x16x32_bf16 v[20:23], v[84:87], v[76:79], v[20:23]
v_mfma_f32_16x16x32_bf16 v[24:27], v[156:159], v[72:75], v[24:27]
v_mfma_f32_16x16x32_bf16 v[28:31], v[156:159], v[76:79], v[28:31]
s_add_u32 s37, s43, 128
s_add_u32 m0, s44, 4096
s_nop 0
buffer_load_dwordx4 v2, s[8:11], s37 offen lds
v_mfma_f32_16x16x32_bf16 v[32:35], v[228:231], v[72:75], v[32:35]
v_mfma_f32_16x16x32_bf16 v[36:39], v[228:231], v[76:79], v[36:39]
v_mfma_f32_16x16x32_bf16 v[40:43], a[44:47], v[72:75], v[40:43]
v_mfma_f32_16x16x32_bf16 v[44:47], a[44:47], v[76:79], v[44:47]
ds_read_b128 v[72:75], v3 offset:6144
ds_read_b128 v[76:79], v3 offset:7168
s_waitcnt lgkmcnt(2)
v_mfma_f32_16x16x32_bf16 v[16:19], v[88:91], v[64:67], v[16:19]
v_mfma_f32_16x16x32_bf16 v[20:23], v[88:91], v[68:71], v[20:23]
v_mfma_f32_16x16x32_bf16 v[24:27], v[160:163], v[64:67], v[24:27]
v_mfma_f32_16x16x32_bf16 v[28:31], v[160:163], v[68:71], v[28:31]
s_add_u32 s37, s43, 256
s_add_u32 m0, s44, 8192
s_nop 0
buffer_load_dwordx4 v2, s[8:11], s37 offen lds
v_mfma_f32_16x16x32_bf16 v[32:35], v[232:235], v[64:67], v[32:35]
v_mfma_f32_16x16x32_bf16 v[36:39], v[232:235], v[68:71], v[36:39]
v_mfma_f32_16x16x32_bf16 v[40:43], a[48:51], v[64:67], v[40:43]
v_mfma_f32_16x16x32_bf16 v[44:47], a[48:51], v[68:71], v[44:47]
ds_read_b128 v[64:67], v3 offset:8192
ds_read_b128 v[68:71], v3 offset:9216
s_waitcnt lgkmcnt(2)
v_mfma_f32_16x16x32_bf16 v[16:19], v[92:95], v[72:75], v[16:19]
v_mfma_f32_16x16x32_bf16 v[20:23], v[92:95], v[76:79], v[20:23]
v_mfma_f32_16x16x32_bf16 v[24:27], v[164:167], v[72:75], v[24:27]
v_mfma_f32_16x16x32_bf16 v[28:31], v[164:167], v[76:79], v[28:31]
s_add_u32 s37, s43, 384
s_add_u32 m0, s44, 12288
s_nop 0
buffer_load_dwordx4 v2, s[8:11], s37 offen lds
v_mfma_f32_16x16x32_bf16 v[32:35], v[236:239], v[72:75], v[32:35]
v_mfma_f32_16x16x32_bf16 v[36:39], v[236:239], v[76:79], v[36:39]
v_mfma_f32_16x16x32_bf16 v[40:43], a[52:55], v[72:75], v[40:43]
v_mfma_f32_16x16x32_bf16 v[44:47], a[52:55], v[76:79], v[44:47]
ds_read_b128 v[72:75], v3 offset:10240
ds_read_b128 v[76:79], v3 offset:11264
s_waitcnt lgkmcnt(2)
v_mfma_f32_16x16x32_bf16 v[16:19], v[96:99], v[64:67], v[16:19]
v_mfma_f32_16x16x32_bf16 v[20:23], v[96:99], v[68:71], v[20:23]
v_mfma_f32_16x16x32_bf16 v[24:27], v[168:171], v[64:67], v[24:27]
v_mfma_f32_16x16x32_bf16 v[28:31], v[168:171], v[68:71], v[28:31]
s_add_u32 s37, s43, 512
s_add_u32 m0, s44, 16384
s_nop 0
buffer_load_dwordx4 v2, s[8:11], s37 offen lds
v_mfma_f32_16x16x32_bf16 v[32:35], v[240:243], v[64:67], v[32:35]
v_mfma_f32_16x16x32_bf16 v[36:39], v[240:243], v[68:71], v[36:39]
v_mfma_f32_16x16x32_bf16 v[40:43], a[56:59], v[64:67], v[40:43]
v_mfma_f32_16x16x32_bf16 v[44:47], a[56:59], v[68:71], v[44:47]
ds_read_b128 v[64:67], v3 offset:12288
ds_read_b128 v[68:71], v3 offset:13312
s_waitcnt lgkmcnt(2)
v_mfma_f32_16x16x32_bf16 v[16:19], v[100:103], v[72:75], v[16:19]
v_mfma_f32_16x16x32_bf16 v[20:23], v[100:103], v[76:79], v[20:23]
v_mfma_f32_16x16x32_bf16 v[24:27], v[172:175], v[72:75], v[24:27]
v_mfma_f32_16x16x32_bf16 v[28:31], v[172:175], v[76:79], v[28:31]
s_add_u32 s37, s43, 640
s_add_u32 m0, s44, 20480
s_nop 0
buffer_load_dwordx4 v2, s[8:11], s37 offen lds
v_mfma_f32_16x16x32_bf16 v[32:35], v[244:247], v[72:75], v[32:35]
v_mfma_f32_16x16x32_bf16 v[36:39], v[244:247], v[76:79], v[36:39]
v_mfma_f32_16x16x32_bf16 v[40:43], a[60:63], v[72:75], v[40:43]
v_mfma_f32_16x16x32_bf16 v[44:47], a[60:63], v[76:79], v[44:47]
ds_read_b128 v[72:75], v3 offset:14336
ds_read_b128 v[76:79], v3 offset:15360
s_waitcnt lgkmcnt(2)
v_mfma_f32_16x16x32_bf16 v[16:19], v[104:107], v[64:67], v[16:19]
v_mfma_f32_16x16x32_bf16 v[20:23], v[104:107], v[68:71], v[20:23]
v_mfma_f32_16x16x32_bf16 v[24:27], v[176:179], v[64:67], v[24:27]
v_mfma_f32_16x16x32_bf16 v[28:31], v[176:179], v[68:71], v[28:31]
s_add_u32 s37, s43, 768
s_add_u32 m0, s44, 24576
s_nop 0
buffer_load_dwordx4 v2, s[8:11], s37 offen lds
v_mfma_f32_16x16x32_bf16 v[32:35], v[248:251], v[64:67], v[32:35]
v_mfma_f32_16x16x32_bf16 v[36:39], v[248:251], v[68:71], v[36:39]
v_mfma_f32_16x16x32_bf16 v[40:43], a[64:67], v[64:67], v[40:43]
v_mfma_f32_16x16x32_bf16 v[44:47], a[64:67], v[68:71], v[44:47]
ds_read_b128 v[64:67], v3 offset:16384
ds_read_b128 v[68:71], v3 offset:17408
s_waitcnt lgkmcnt(2)
v_mfma_f32_16x16x32_bf16 v[16:19], v[108:111], v[72:75], v[16:19]
v_mfma_f32_16x16x32_bf16 v[20:23], v[108:111], v[76:79], v[20:23]
v_mfma_f32_16x16x32_bf16 v[24:27], v[180:183], v[72:75], v[24:27]
v_mfma_f32_16x16x32_bf16 v[28:31], v[180:183], v[76:79], v[28:31]
s_add_u32 s37, s43, 896
s_add_u32 m0, s44, 28672
s_nop 0
buffer_load_dwordx4 v2, s[8:11], s37 offen lds
v_mfma_f32_16x16x32_bf16 v[32:35], v[252:255], v[72:75], v[32:35]
v_mfma_f32_16x16x32_bf16 v[36:39], v[252:255], v[76:79], v[36:39]
v_mfma_f32_16x16x32_bf16 v[40:43], a[68:71], v[72:75], v[40:43]
v_mfma_f32_16x16x32_bf16 v[44:47], a[68:71], v[76:79], v[44:47]
ds_read_b128 v[72:75], v3 offset:18432
ds_read_b128 v[76:79], v3 offset:19456
s_waitcnt lgkmcnt(2)
v_mfma_f32_16x16x32_bf16 v[16:19], v[112:115], v[64:67], v[16:19]
v_mfma_f32_16x16x32_bf16 v[20:23], v[112:115], v[68:71], v[20:23]
v_mfma_f32_16x16x32_bf16 v[24:27], v[184:187], v[64:67], v[24:27]
v_mfma_f32_16x16x32_bf16 v[28:31], v[184:187], v[68:71], v[28:31]
s_add_u32 s37, s43, 1024
s_add_u32 m0, s44, 32768
s_nop 0
buffer_load_dwordx4 v2, s[8:11], s37 offen lds
v_mfma_f32_16x16x32_bf16 v[32:35], a[0:3], v[64:67], v[32:35]
v_mfma_f32_16x16x32_bf16 v[36:39], a[0:3], v[68:71], v[36:39]
v_mfma_f32_16x16x32_bf16 v[40:43], a[72:75], v[64:67], v[40:43]
v_mfma_f32_16x16x32_bf16 v[44:47], a[72:75], v[68:71], v[44:47]
ds_read_b128 v[64:67], v3 offset:20480
ds_read_b128 v[68:71], v3 offset:21504
s_waitcnt lgkmcnt(2)
v_mfma_f32_16x16x32_bf16 v[16:19], v[116:119], v[72:75], v[16:19]
v_mfma_f32_16x16x32_bf16 v[20:23], v[116:119], v[76:79], v[20:23]
v_mfma_f32_16x16x32_bf16 v[24:27], v[188:191], v[72:75], v[24:27]
v_mfma_f32_16x16x32_bf16 v[28:31], v[188:191], v[76:79], v[28:31]
v_mfma_f32_16x16x32_bf16 v[32:35], a[4:7], v[72:75], v[32:35]
v_mfma_f32_16x16x32_bf16 v[36:39], a[4:7], v[76:79], v[36:39]
v_mfma_f32_16x16x32_bf16 v[40:43], a[76:79], v[72:75], v[40:43]
v_mfma_f32_16x16x32_bf16 v[44:47], a[76:79], v[76:79], v[44:47]
ds_read_b128 v[72:75], v3 offset:22528
ds_read_b128 v[76:79], v3 offset:23552
s_waitcnt lgkmcnt(2)
v_mfma_f32_16x16x32_bf16 v[16:19], v[120:123], v[64:67], v[16:19]
v_mfma_f32_16x16x32_bf16 v[20:23], v[120:123], v[68:71], v[20:23]
v_mfma_f32_16x16x32_bf16 v[24:27], v[192:195], v[64:67], v[24:27]
v_mfma_f32_16x16x32_bf16 v[28:31], v[192:195], v[68:71], v[28:31]
v_mfma_f32_16x16x32_bf16 v[32:35], a[8:11], v[64:67], v[32:35]
v_mfma_f32_16x16x32_bf16 v[36:39], a[8:11], v[68:71], v[36:39]
v_mfma_f32_16x16x32_bf16 v[40:43], a[80:83], v[64:67], v[40:43]
v_mfma_f32_16x16x32_bf16 v[44:47], a[80:83], v[68:71], v[44:47]
ds_read_b128 v[64:67], v3 offset:24576
ds_read_b128 v[68:71], v3 offset:25600
s_waitcnt lgkmcnt(2)
v_mfma_f32_16x16x32_bf16 v[16:19], v[124:127], v[72:75], v[16:19]
v_mfma_f32_16x16x32_bf16 v[20:23], v[124:127], v[76:79], v[20:23]
v_mfma_f32_16x16x32_bf16 v[24:27], v[196:199], v[72:75], v[24:27]
v_mfma_f32_16x16x32_bf16 v[28:31], v[196:199], v[76:79], v[28:31]
v_mfma_f32_16x16x32_bf16 v[32:35], a[12:15], v[72:75], v[32:35]
v_mfma_f32_16x16x32_bf16 v[36:39], a[12:15], v[76:79], v[36:39]
v_mfma_f32_16x16x32_bf16 v[40:43], a[84:87], v[72:75], v[40:43]
v_mfma_f32_16x16x32_bf16 v[44:47], a[84:87], v[76:79], v[44:47]
ds_read_b128 v[72:75], v3 offset:26624
ds_read_b128 v[76:79], v3 offset:27648
s_waitcnt lgkmcnt(2)
v_mfma_f32_16x16x32_bf16 v[16:19], v[128:131], v[64:67], v[16:19]
v_mfma_f32_16x16x32_bf16 v[20:23], v[128:131], v[68:71], v[20:23]
v_mfma_f32_16x16x32_bf16 v[24:27], v[200:203], v[64:67], v[24:27]
v_mfma_f32_16x16x32_bf16 v[28:31], v[200:203], v[68:71], v[28:31]
v_mfma_f32_16x16x32_bf16 v[32:35], a[16:19], v[64:67], v[32:35]
v_mfma_f32_16x16x32_bf16 v[36:39], a[16:19], v[68:71], v[36:39]
v_mfma_f32_16x16x32_bf16 v[40:43], a[88:91], v[64:67], v[40:43]
v_mfma_f32_16x16x32_bf16 v[44:47], a[88:91], v[68:71], v[44:47]
ds_read_b128 v[64:67], v3 offset:28672
ds_read_b128 v[68:71], v3 offset:29696
s_waitcnt lgkmcnt(2)
v_mfma_f32_16x16x32_bf16 v[16:19], v[132:135], v[72:75], v[16:19]
v_mfma_f32_16x16x32_bf16 v[20:23], v[132:135], v[76:79], v[20:23]
v_mfma_f32_16x16x32_bf16 v[24:27], v[204:207], v[72:75], v[24:27]
v_mfma_f32_16x16x32_bf16 v[28:31], v[204:207], v[76:79], v[28:31]
v_mfma_f32_16x16x32_bf16 v[32:35], a[20:23], v[72:75], v[32:35]
v_mfma_f32_16x16x32_bf16 v[36:39], a[20:23], v[76:79], v[36:39]
v_mfma_f32_16x16x32_bf16 v[40:43], a[92:95], v[72:75], v[40:43]
v_mfma_f32_16x16x32_bf16 v[44:47], a[92:95], v[76:79], v[44:47]
ds_read_b128 v[72:75], v3 offset:30720
ds_read_b128 v[76:79], v3 offset:31744
s_waitcnt lgkmcnt(2)
v_mfma_f32_16x16x32_bf16 v[16:19], v[136:139], v[64:67], v[16:19]
v_mfma_f32_16x16x32_bf16 v[20:23], v[136:139], v[68:71], v[20:23]
v_mfma_f32_16x16x32_bf16 v[24:27], v[208:211], v[64:67], v[24:27]
v_mfma_f32_16x16x32_bf16 v[28:31], v[208:211], v[68:71], v[28:31]
v_mfma_f32_16x16x32_bf16 v[32:35], a[24:27], v[64:67], v[32:35]
v_mfma_f32_16x16x32_bf16 v[36:39], a[24:27], v[68:71], v[36:39]
v_mfma_f32_16x16x32_bf16 v[40:43], a[96:99], v[64:67], v[40:43]
v_mfma_f32_16x16x32_bf16 v[44:47], a[96:99], v[68:71], v[44:47]
ds_read_b128 v[64:67], v3 offset:32768
ds_read_b128 v[68:71], v3 offset:33792
s_waitcnt lgkmcnt(2)
v_mfma_f32_16x16x32_bf16 v[16:19], v[140:143], v[72:75], v[16:19]
v_mfma_f32_16x16x32_bf16 v[20:23], v[140:143], v[76:79], v[20:23]
v_mfma_f32_16x16x32_bf16 v[24:27], v[212:215], v[72:75], v[24:27]
v_mfma_f32_16x16x32_bf16 v[28:31], v[212:215], v[76:79], v[28:31]
v_mfma_f32_16x16x32_bf16 v[32:35], a[28:31], v[72:75], v[32:35]
v_mfma_f32_16x16x32_bf16 v[36:39], a[28:31], v[76:79], v[36:39]
v_mfma_f32_16x16x32_bf16 v[40:43], a[100:103], v[72:75], v[40:43]
v_mfma_f32_16x16x32_bf16 v[44:47], a[100:103], v[76:79], v[44:47]
ds_read_b128 v[72:75], v3 offset:34816
ds_read_b128 v[76:79], v3 offset:35840
s_waitcnt lgkmcnt(2)
v_mfma_f32_16x16x32_bf16 v[16:19], v[144:147], v[64:67], v[16:19]
v_mfma_f32_16x16x32_bf16 v[20:23], v[144:147], v[68:71], v[20:23]
v_mfma_f32_16x16x32_bf16 v[24:27], v[216:219], v[64:67], v[24:27]
v_mfma_f32_16x16x32_bf16 v[28:31], v[216:219], v[68:71], v[28:31]
v_mfma_f32_16x16x32_bf16 v[32:35], a[32:35], v[64:67], v[32:35]
v_mfma_f32_16x16x32_bf16 v[36:39], a[32:35], v[68:71], v[36:39]
v_mfma_f32_16x16x32_bf16 v[40:43], a[104:107], v[64:67], v[40:43]
v_mfma_f32_16x16x32_bf16 v[44:47], a[104:107], v[68:71], v[44:47]
s_waitcnt lgkmcnt(0)
v_mfma_f32_16x16x32_bf16 v[16:19], v[148:151], v[72:75], v[16:19]
v_mfma_f32_16x16x32_bf16 v[20:23], v[148:151], v[76:79], v[20:23]
v_mfma_f32_16x16x32_bf16 v[24:27], v[220:223], v[72:75], v[24:27]
v_mfma_f32_16x16x32_bf16 v[28:31], v[220:223], v[76:79], v[28:31]
v_mfma_f32_16x16x32_bf16 v[32:35], a[36:39], v[72:75], v[32:35]
v_mfma_f32_16x16x32_bf16 v[36:39], a[36:39], v[76:79], v[36:39]
v_mfma_f32_16x16x32_bf16 v[40:43], a[108:111], v[72:75], v[40:43]
v_mfma_f32_16x16x32_bf16 v[44:47], a[108:111], v[76:79], v[44:47]
v_add_u32 v3, s50, v3
s_sub_u32 s50, 0, s50
v_cvt_pk_bf16_f32 v16, v16, v17
v_cvt_pk_bf16_f32 v17, v18, v19
ds_write_b64 v4, v[16:17] offset:0
v_cvt_pk_bf16_f32 v20, v20, v21
v_cvt_pk_bf16_f32 v21, v22, v23
ds_write_b64 v4, v[20:21] offset:7296
v_cvt_pk_bf16_f32 v24, v24, v25
v_cvt_pk_bf16_f32 v25, v26, v27
ds_write_b64 v4, v[24:25] offset:32
v_cvt_pk_bf16_f32 v28, v28, v29
v_cvt_pk_bf16_f32 v29, v30, v31
ds_write_b64 v4, v[28:29] offset:7328
s_cmp_eq_u32 s34, 3
s_cbranch_scc1 L_a_gate
v_cvt_pk_bf16_f32 v32, v32, v33
v_cvt_pk_bf16_f32 v33, v34, v35
ds_write_b64 v4, v[32:33] offset:64
v_cvt_pk_bf16_f32 v36, v36, v37
v_cvt_pk_bf16_f32 v37, v38, v39
ds_write_b64 v4, v[36:37] offset:7360
v_cvt_pk_bf16_f32 v40, v40, v41
v_cvt_pk_bf16_f32 v41, v42, v43
ds_write_b64 v4, v[40:41] offset:96
v_cvt_pk_bf16_f32 v44, v44, v45
v_cvt_pk_bf16_f32 v45, v46, v47
ds_write_b64 v4, v[44:45] offset:7392
s_branch L_a_nog2
L_a_gate:
ds_write_b32 v14, v32
ds_write_b32 v14, v36 offset:64
L_a_nog2:
v_add_u32 v4, 14592, v4
v_add_u32 v14, 128, v14
s_add_u32 s35, s35, 1
s_cmp_lt_u32 s35, 6
s_cbranch_scc1 L_a_loop
s_waitcnt vmcnt(0) lgkmcnt(0)
s_barrier
s_mov_b32 s35, 0
s_mul_i32 s39, s34, 36
s_add_u32 s39, s39, 73728
s_mul_i32 s40, s33, 176
s_mov_b32 s41, 0x3eae1a93
s_mov_b32 s42, 0xbfb8aa3b
L_la_loop:
v_add_u32 v12, s35, v9
v_min_u32 v12, 175, v12
v_add_u32 v2, s40, v12
v_add_u32 v12, 16, v12
v_mul_u32_u24 v14, 456, v12
v_add_u32 v14, s39, v14
v_lshlrev_b32 v12, 2, v12
v_add_u32 v12, 161280, v12
ds_read_b32 v3, v12
ds_read2_b32 v[16:17], v14 offset0:0 offset1:1
ds_read2_b32 v[18:19], v14 offset0:2 offset1:3
ds_read2_b32 v[20:21], v14 offset0:4 offset1:5
ds_read2_b32 v[22:23], v14 offset0:6 offset1:7
ds_read_b32 v24, v14 offset:32
v_subrev_u32 v15, 0, v14
ds_read2_b32 v[26:27], v15 offset0:36 offset1:37
ds_read2_b32 v[28:29], v15 offset0:38 offset1:39
ds_read2_b32 v[30:31], v15 offset0:40 offset1:41
ds_read2_b32 v[32:33], v15 offset0:42 offset1:43
ds_read_b32 v34, v15 offset:176
v_subrev_u32 v15, 912, v14
ds_read2_b32 v[36:37], v15 offset0:36 offset1:37
ds_read2_b32 v[38:39], v15 offset0:38 offset1:39
ds_read2_b32 v[40:41], v15 offset0:40 offset1:41
ds_read2_b32 v[42:43], v15 offset0:42 offset1:43
ds_read_b32 v44, v15 offset:176
s_waitcnt lgkmcnt(5)
v_dot2_f32_bf16 v176, v16, v26, 0
v_dot2_f32_bf16 v176, v17, v27, v176
v_dot2_f32_bf16 v176, v18, v28, v176
v_dot2_f32_bf16 v176, v19, v29, v176
v_dot2_f32_bf16 v176, v20, v30, v176
v_dot2_f32_bf16 v176, v21, v31, v176
v_dot2_f32_bf16 v176, v22, v32, v176
v_dot2_f32_bf16 v176, v23, v33, v176
v_dot2_f32_bf16 v176, v24, v34, v176
v_subrev_u32 v15, 1824, v14
ds_read2_b32 v[46:47], v15 offset0:36 offset1:37
ds_read2_b32 v[48:49], v15 offset0:38 offset1:39
ds_read2_b32 v[50:51], v15 offset0:40 offset1:41
ds_read2_b32 v[52:53], v15 offset0:42 offset1:43
ds_read_b32 v54, v15 offset:176
s_waitcnt lgkmcnt(5)
v_dot2_f32_bf16 v177, v16, v36, 0
v_dot2_f32_bf16 v177, v17, v37, v177
v_dot2_f32_bf16 v177, v18, v38, v177
v_dot2_f32_bf16 v177, v19, v39, v177
v_dot2_f32_bf16 v177, v20, v40, v177
v_dot2_f32_bf16 v177, v21, v41, v177
v_dot2_f32_bf16 v177, v22, v42, v177
v_dot2_f32_bf16 v177, v23, v43, v177
v_dot2_f32_bf16 v177, v24, v44, v177
v_subrev_u32 v15, 2736, v14
ds_read2_b32 v[56:57], v15 offset0:36 offset1:37
ds_read2_b32 v[58:59], v15 offset0:38 offset1:39
ds_read2_b32 v[60:61], v15 offset0:40 offset1:41
ds_read2_b32 v[62:63], v15 offset0:42 offset1:43
ds_read_b32 v64, v15 offset:176
s_waitcnt lgkmcnt(5)
v_dot2_f32_bf16 v178, v16, v46, 0
v_dot2_f32_bf16 v178, v17, v47, v178
v_dot2_f32_bf16 v178, v18, v48, v178
v_dot2_f32_bf16 v178, v19, v49, v178
v_dot2_f32_bf16 v178, v20, v50, v178
v_dot2_f32_bf16 v178, v21, v51, v178
v_dot2_f32_bf16 v178, v22, v52, v178
v_dot2_f32_bf16 v178, v23, v53, v178
v_dot2_f32_bf16 v178, v24, v54, v178
v_subrev_u32 v15, 3648, v14
ds_read2_b32 v[26:27], v15 offset0:36 offset1:37
ds_read2_b32 v[28:29], v15 offset0:38 offset1:39
ds_read2_b32 v[30:31], v15 offset0:40 offset1:41
ds_read2_b32 v[32:33], v15 offset0:42 offset1:43
ds_read_b32 v34, v15 offset:176
s_waitcnt lgkmcnt(5)
v_dot2_f32_bf16 v179, v16, v56, 0
v_dot2_f32_bf16 v179, v17, v57, v179
v_dot2_f32_bf16 v179, v18, v58, v179
v_dot2_f32_bf16 v179, v19, v59, v179
v_dot2_f32_bf16 v179, v20, v60, v179
v_dot2_f32_bf16 v179, v21, v61, v179
v_dot2_f32_bf16 v179, v22, v62, v179
v_dot2_f32_bf16 v179, v23, v63, v179
v_dot2_f32_bf16 v179, v24, v64, v179
v_subrev_u32 v15, 4560, v14
ds_read2_b32 v[36:37], v15 offset0:36 offset1:37
ds_read2_b32 v[38:39], v15 offset0:38 offset1:39
ds_read2_b32 v[40:41], v15 offset0:40 offset1:41
ds_read2_b32 v[42:43], v15 offset0:42 offset1:43
ds_read_b32 v44, v15 offset:176
s_waitcnt lgkmcnt(5)
v_dot2_f32_bf16 v180, v16, v26, 0
v_dot2_f32_bf16 v180, v17, v27, v180
v_dot2_f32_bf16 v180, v18, v28, v180
v_dot2_f32_bf16 v180, v19, v29, v180
v_dot2_f32_bf16 v180, v20, v30, v180
v_dot2_f32_bf16 v180, v21, v31, v180
v_dot2_f32_bf16 v180, v22, v32, v180
v_dot2_f32_bf16 v180, v23, v33, v180
v_dot2_f32_bf16 v180, v24, v34, v180
v_subrev_u32 v15, 5472, v14
ds_read2_b32 v[46:47], v15 offset0:36 offset1:37
ds_read2_b32 v[48:49], v15 offset0:38 offset1:39
ds_read2_b32 v[50:51], v15 offset0:40 offset1:41
ds_read2_b32 v[52:53], v15 offset0:42 offset1:43
ds_read_b32 v54, v15 offset:176
s_waitcnt lgkmcnt(5)
v_dot2_f32_bf16 v181, v16, v36, 0
v_dot2_f32_bf16 v181, v17, v37, v181
v_dot2_f32_bf16 v181, v18, v38, v181
v_dot2_f32_bf16 v181, v19, v39, v181
v_dot2_f32_bf16 v181, v20, v40, v181
v_dot2_f32_bf16 v181, v21, v41, v181
v_dot2_f32_bf16 v181, v22, v42, v181
v_dot2_f32_bf16 v181, v23, v43, v181
v_dot2_f32_bf16 v181, v24, v44, v181
v_subrev_u32 v15, 6384, v14
ds_read2_b32 v[56:57], v15 offset0:36 offset1:37
ds_read2_b32 v[58:59], v15 offset0:38 offset1:39
ds_read2_b32 v[60:61], v15 offset0:40 offset1:41
ds_read2_b32 v[62:63], v15 offset0:42 offset1:43
ds_read_b32 v64, v15 offset:176
s_waitcnt lgkmcnt(5)
v_dot2_f32_bf16 v182, v16, v46, 0
v_dot2_f32_bf16 v182, v17, v47, v182
v_dot2_f32_bf16 v182, v18, v48, v182
v_dot2_f32_bf16 v182, v19, v49, v182
v_dot2_f32_bf16 v182, v20, v50, v182
v_dot2_f32_bf16 v182, v21, v51, v182
v_dot2_f32_bf16 v182, v22, v52, v182
v_dot2_f32_bf16 v182, v23, v53, v182
v_dot2_f32_bf16 v182, v24, v54, v182
s_waitcnt lgkmcnt(0)
v_dot2_f32_bf16 v183, v16, v56, 0
v_dot2_f32_bf16 v183, v17, v57, v183
v_dot2_f32_bf16 v183, v18, v58, v183
v_dot2_f32_bf16 v183, v19, v59, v183
v_dot2_f32_bf16 v183, v20, v60, v183
v_dot2_f32_bf16 v183, v21, v61, v183
v_dot2_f32_bf16 v183, v22, v62, v183
v_dot2_f32_bf16 v183, v23, v63, v183
v_dot2_f32_bf16 v183, v24, v64, v183
v_subrev_u32 v15, 0, v14
ds_read2_b32 v[100:101], v15 offset0:72 offset1:73
ds_read2_b32 v[102:103], v15 offset0:74 offset1:75
ds_read2_b32 v[104:105], v15 offset0:76 offset1:77
ds_read2_b32 v[106:107], v15 offset0:78 offset1:79
ds_read_b32 v108, v15 offset:320
v_subrev_u32 v15, 912, v14
ds_read2_b32 v[110:111], v15 offset0:72 offset1:73
ds_read2_b32 v[112:113], v15 offset0:74 offset1:75
ds_read2_b32 v[114:115], v15 offset0:76 offset1:77
ds_read2_b32 v[116:117], v15 offset0:78 offset1:79
ds_read_b32 v118, v15 offset:320
v_mov_b32 v13, 0xf149f2ca
v_mul_f32 v176, s41, v176
v_mul_f32 v177, s41, v177
v_mul_f32 v178, s41, v178
v_mul_f32 v179, s41, v179
v_mul_f32 v180, s41, v180
v_mul_f32 v181, s41, v181
v_mul_f32 v182, s41, v182
v_mul_f32 v183, s41, v183
v_cmp_le_u32 vcc, 2, v2
s_nop 1
v_cndmask_b32 v177, v13, v177, vcc
v_cmp_le_u32 vcc, 4, v2
s_nop 1
v_cndmask_b32 v178, v13, v178, vcc
v_cmp_le_u32 vcc, 6, v2
s_nop 1
v_cndmask_b32 v179, v13, v179, vcc
v_cmp_le_u32 vcc, 8, v2
s_nop 1
v_cndmask_b32 v180, v13, v180, vcc
v_cmp_le_u32 vcc, 10, v2
s_nop 1
v_cndmask_b32 v181, v13, v181, vcc
v_cmp_le_u32 vcc, 12, v2
s_nop 1
v_cndmask_b32 v182, v13, v182, vcc
v_cmp_le_u32 vcc, 14, v2
s_nop 1
v_cndmask_b32 v183, v13, v183, vcc
v_max3_f32 v12, v176, v177, v178
v_max3_f32 v12, v12, v179, v180
v_max3_f32 v12, v12, v181, v182
v_max_f32 v12, v12, v183
v_sub_f32 v176, v176, v12
v_sub_f32 v177, v177, v12
v_sub_f32 v178, v178, v12
v_sub_f32 v179, v179, v12
v_sub_f32 v180, v180, v12
v_sub_f32 v181, v181, v12
v_sub_f32 v182, v182, v12
v_sub_f32 v183, v183, v12
v_exp_f32 v176, v176
v_exp_f32 v177, v177
v_exp_f32 v178, v178
v_exp_f32 v179, v179
v_exp_f32 v180, v180
v_exp_f32 v181, v181
v_exp_f32 v182, v182
v_exp_f32 v183, v183
v_cvt_pk_bf16_f32 v204, v176, v8
v_cvt_pk_bf16_f32 v205, v177, v8
v_cvt_pk_bf16_f32 v206, v178, v8
v_cvt_pk_bf16_f32 v207, v179, v8
v_cvt_pk_bf16_f32 v208, v180, v8
v_cvt_pk_bf16_f32 v209, v181, v8
v_cvt_pk_bf16_f32 v210, v182, v8
v_cvt_pk_bf16_f32 v211, v183, v8
v_lshlrev_b32 v212, 16, v204
v_lshlrev_b32 v213, 16, v205
v_lshlrev_b32 v214, 16, v206
v_lshlrev_b32 v215, 16, v207
v_lshlrev_b32 v216, 16, v208
v_lshlrev_b32 v217, 16, v209
v_lshlrev_b32 v218, 16, v210
v_lshlrev_b32 v219, 16, v211
v_add_f32 v12, v212, v213
v_add_f32 v13, v214, v215
v_add_f32 v12, v12, v216
v_add_f32 v13, v13, v217
v_add_f32 v12, v12, v218
v_add_f32 v13, v13, v219
v_add_f32 v12, v12, v13
v_mul_f32 v13, s42, v3
v_exp_f32 v3, v13
v_exp_f32 v13, -v13
v_add_f32 v3, 1.0, v3
v_add_f32 v13, 1.0, v13
v_mul_f32 v12, v12, v3
v_rcp_f32 v12, v12
v_rcp_f32 v13, v13
v_subrev_u32 v15, 1824, v14
ds_read2_b32 v[120:121], v15 offset0:72 offset1:73
ds_read2_b32 v[122:123], v15 offset0:74 offset1:75
ds_read2_b32 v[124:125], v15 offset0:76 offset1:77
ds_read2_b32 v[126:127], v15 offset0:78 offset1:79
ds_read_b32 v128, v15 offset:320
s_waitcnt lgkmcnt(10)
v_dot2_f32_bf16 v184, v100, v204, 0
v_dot2_f32_bf16 v185, v100, v212, 0
v_dot2_f32_bf16 v186, v101, v204, 0
v_dot2_f32_bf16 v187, v101, v212, 0
v_dot2_f32_bf16 v188, v102, v204, 0
v_dot2_f32_bf16 v189, v102, v212, 0
v_dot2_f32_bf16 v190, v103, v204, 0
v_dot2_f32_bf16 v191, v103, v212, 0
v_dot2_f32_bf16 v192, v104, v204, 0
v_dot2_f32_bf16 v193, v104, v212, 0
v_dot2_f32_bf16 v194, v105, v204, 0
v_dot2_f32_bf16 v195, v105, v212, 0
v_dot2_f32_bf16 v196, v106, v204, 0
v_dot2_f32_bf16 v197, v106, v212, 0
v_dot2_f32_bf16 v198, v107, v204, 0
v_dot2_f32_bf16 v199, v107, v212, 0
v_dot2_f32_bf16 v200, v108, v204, 0
v_dot2_f32_bf16 v201, v108, v212, 0
v_subrev_u32 v15, 2736, v14
ds_read2_b32 v[130:131], v15 offset0:72 offset1:73
ds_read2_b32 v[132:133], v15 offset0:74 offset1:75
ds_read2_b32 v[134:135], v15 offset0:76 offset1:77
ds_read2_b32 v[136:137], v15 offset0:78 offset1:79
ds_read_b32 v138, v15 offset:320
s_waitcnt lgkmcnt(10)
v_dot2_f32_bf16 v184, v110, v205, v184
v_dot2_f32_bf16 v185, v110, v213, v185
v_dot2_f32_bf16 v186, v111, v205, v186
v_dot2_f32_bf16 v187, v111, v213, v187
v_dot2_f32_bf16 v188, v112, v205, v188
v_dot2_f32_bf16 v189, v112, v213, v189
v_dot2_f32_bf16 v190, v113, v205, v190
v_dot2_f32_bf16 v191, v113, v213, v191
v_dot2_f32_bf16 v192, v114, v205, v192
v_dot2_f32_bf16 v193, v114, v213, v193
v_dot2_f32_bf16 v194, v115, v205, v194
v_dot2_f32_bf16 v195, v115, v213, v195
v_dot2_f32_bf16 v196, v116, v205, v196
v_dot2_f32_bf16 v197, v116, v213, v197
v_dot2_f32_bf16 v198, v117, v205, v198
v_dot2_f32_bf16 v199, v117, v213, v199
v_dot2_f32_bf16 v200, v118, v205, v200
v_dot2_f32_bf16 v201, v118, v213, v201
v_subrev_u32 v15, 3648, v14
ds_read2_b32 v[100:101], v15 offset0:72 offset1:73
ds_read2_b32 v[102:103], v15 offset0:74 offset1:75
ds_read2_b32 v[104:105], v15 offset0:76 offset1:77
ds_read2_b32 v[106:107], v15 offset0:78 offset1:79
ds_read_b32 v108, v15 offset:320
s_waitcnt lgkmcnt(10)
v_dot2_f32_bf16 v184, v120, v206, v184
v_dot2_f32_bf16 v185, v120, v214, v185
v_dot2_f32_bf16 v186, v121, v206, v186
v_dot2_f32_bf16 v187, v121, v214, v187
v_dot2_f32_bf16 v188, v122, v206, v188
v_dot2_f32_bf16 v189, v122, v214, v189
v_dot2_f32_bf16 v190, v123, v206, v190
v_dot2_f32_bf16 v191, v123, v214, v191
v_dot2_f32_bf16 v192, v124, v206, v192
v_dot2_f32_bf16 v193, v124, v214, v193
v_dot2_f32_bf16 v194, v125, v206, v194
v_dot2_f32_bf16 v195, v125, v214, v195
v_dot2_f32_bf16 v196, v126, v206, v196
v_dot2_f32_bf16 v197, v126, v214, v197
v_dot2_f32_bf16 v198, v127, v206, v198
v_dot2_f32_bf16 v199, v127, v214, v199
v_dot2_f32_bf16 v200, v128, v206, v200
v_dot2_f32_bf16 v201, v128, v214, v201
v_subrev_u32 v15, 4560, v14
ds_read2_b32 v[110:111], v15 offset0:72 offset1:73
ds_read2_b32 v[112:113], v15 offset0:74 offset1:75
ds_read2_b32 v[114:115], v15 offset0:76 offset1:77
ds_read2_b32 v[116:117], v15 offset0:78 offset1:79
ds_read_b32 v118, v15 offset:320
s_waitcnt lgkmcnt(10)
v_dot2_f32_bf16 v184, v130, v207, v184
v_dot2_f32_bf16 v185, v130, v215, v185
v_dot2_f32_bf16 v186, v131, v207, v186
v_dot2_f32_bf16 v187, v131, v215, v187
v_dot2_f32_bf16 v188, v132, v207, v188
v_dot2_f32_bf16 v189, v132, v215, v189
v_dot2_f32_bf16 v190, v133, v207, v190
v_dot2_f32_bf16 v191, v133, v215, v191
v_dot2_f32_bf16 v192, v134, v207, v192
v_dot2_f32_bf16 v193, v134, v215, v193
v_dot2_f32_bf16 v194, v135, v207, v194
v_dot2_f32_bf16 v195, v135, v215, v195
v_dot2_f32_bf16 v196, v136, v207, v196
v_dot2_f32_bf16 v197, v136, v215, v197
v_dot2_f32_bf16 v198, v137, v207, v198
v_dot2_f32_bf16 v199, v137, v215, v199
v_dot2_f32_bf16 v200, v138, v207, v200
v_dot2_f32_bf16 v201, v138, v215, v201
v_subrev_u32 v15, 5472, v14
ds_read2_b32 v[120:121], v15 offset0:72 offset1:73
ds_read2_b32 v[122:123], v15 offset0:74 offset1:75
ds_read2_b32 v[124:125], v15 offset0:76 offset1:77
ds_read2_b32 v[126:127], v15 offset0:78 offset1:79
ds_read_b32 v128, v15 offset:320
s_waitcnt lgkmcnt(10)
v_dot2_f32_bf16 v184, v100, v208, v184
v_dot2_f32_bf16 v185, v100, v216, v185
v_dot2_f32_bf16 v186, v101, v208, v186
v_dot2_f32_bf16 v187, v101, v216, v187
v_dot2_f32_bf16 v188, v102, v208, v188
v_dot2_f32_bf16 v189, v102, v216, v189
v_dot2_f32_bf16 v190, v103, v208, v190
v_dot2_f32_bf16 v191, v103, v216, v191
v_dot2_f32_bf16 v192, v104, v208, v192
v_dot2_f32_bf16 v193, v104, v216, v193
v_dot2_f32_bf16 v194, v105, v208, v194
v_dot2_f32_bf16 v195, v105, v216, v195
v_dot2_f32_bf16 v196, v106, v208, v196
v_dot2_f32_bf16 v197, v106, v216, v197
v_dot2_f32_bf16 v198, v107, v208, v198
v_dot2_f32_bf16 v199, v107, v216, v199
v_dot2_f32_bf16 v200, v108, v208, v200
v_dot2_f32_bf16 v201, v108, v216, v201
v_subrev_u32 v15, 6384, v14
ds_read2_b32 v[130:131], v15 offset0:72 offset1:73
ds_read2_b32 v[132:133], v15 offset0:74 offset1:75
ds_read2_b32 v[134:135], v15 offset0:76 offset1:77
ds_read2_b32 v[136:137], v15 offset0:78 offset1:79
ds_read_b32 v138, v15 offset:320
s_waitcnt lgkmcnt(10)
v_dot2_f32_bf16 v184, v110, v209, v184
v_dot2_f32_bf16 v185, v110, v217, v185
v_dot2_f32_bf16 v186, v111, v209, v186
v_dot2_f32_bf16 v187, v111, v217, v187
v_dot2_f32_bf16 v188, v112, v209, v188
v_dot2_f32_bf16 v189, v112, v217, v189
v_dot2_f32_bf16 v190, v113, v209, v190
v_dot2_f32_bf16 v191, v113, v217, v191
v_dot2_f32_bf16 v192, v114, v209, v192
v_dot2_f32_bf16 v193, v114, v217, v193
v_dot2_f32_bf16 v194, v115, v209, v194
v_dot2_f32_bf16 v195, v115, v217, v195
v_dot2_f32_bf16 v196, v116, v209, v196
v_dot2_f32_bf16 v197, v116, v217, v197
v_dot2_f32_bf16 v198, v117, v209, v198
v_dot2_f32_bf16 v199, v117, v217, v199
v_dot2_f32_bf16 v200, v118, v209, v200
v_dot2_f32_bf16 v201, v118, v217, v201
s_waitcnt lgkmcnt(5)
v_dot2_f32_bf16 v184, v120, v210, v184
v_dot2_f32_bf16 v185, v120, v218, v185
v_dot2_f32_bf16 v186, v121, v210, v186
v_dot2_f32_bf16 v187, v121, v218, v187
v_dot2_f32_bf16 v188, v122, v210, v188
v_dot2_f32_bf16 v189, v122, v218, v189
v_dot2_f32_bf16 v190, v123, v210, v190
v_dot2_f32_bf16 v191, v123, v218, v191
v_dot2_f32_bf16 v192, v124, v210, v192
v_dot2_f32_bf16 v193, v124, v218, v193
v_dot2_f32_bf16 v194, v125, v210, v194
v_dot2_f32_bf16 v195, v125, v218, v195
v_dot2_f32_bf16 v196, v126, v210, v196
v_dot2_f32_bf16 v197, v126, v218, v197
v_dot2_f32_bf16 v198, v127, v210, v198
v_dot2_f32_bf16 v199, v127, v218, v199
v_dot2_f32_bf16 v200, v128, v210, v200
v_dot2_f32_bf16 v201, v128, v218, v201
s_waitcnt lgkmcnt(0)
v_dot2_f32_bf16 v184, v130, v211, v184
v_dot2_f32_bf16 v185, v130, v219, v185
v_dot2_f32_bf16 v186, v131, v211, v186
v_dot2_f32_bf16 v187, v131, v219, v187
v_dot2_f32_bf16 v188, v132, v211, v188
v_dot2_f32_bf16 v189, v132, v219, v189
v_dot2_f32_bf16 v190, v133, v211, v190
v_dot2_f32_bf16 v191, v133, v219, v191
v_dot2_f32_bf16 v192, v134, v211, v192
v_dot2_f32_bf16 v193, v134, v219, v193
v_dot2_f32_bf16 v194, v135, v211, v194
v_dot2_f32_bf16 v195, v135, v219, v195
v_dot2_f32_bf16 v196, v136, v211, v196
v_dot2_f32_bf16 v197, v136, v219, v197
v_dot2_f32_bf16 v198, v137, v211, v198
v_dot2_f32_bf16 v199, v137, v219, v199
v_dot2_f32_bf16 v200, v138, v211, v200
v_dot2_f32_bf16 v201, v138, v219, v201
s_or_b32 s37, s32, s34
s_cmp_lg_u32 s37, 0
s_cbranch_scc1 L_la_noomg
v_lshlrev_b32 v15, 2, v2
v_min_u32 v15, 8192, v15
s_mov_b32 s37, 87031808
buffer_store_dword v13, v15, s[4:7], s37 offen sc0 sc1
L_la_noomg:
v_mul_f32 v184, v184, v12
v_mul_f32 v185, v185, v12
v_mul_f32 v186, v186, v12
v_mul_f32 v187, v187, v12
v_mul_f32 v188, v188, v12
v_mul_f32 v189, v189, v12
v_mul_f32 v190, v190, v12
v_mul_f32 v191, v191, v12
v_mul_f32 v192, v192, v12
v_mul_f32 v193, v193, v12
v_mul_f32 v194, v194, v12
v_mul_f32 v195, v195, v12
v_mul_f32 v196, v196, v12
v_mul_f32 v197, v197, v12
v_mul_f32 v198, v198, v12
v_mul_f32 v199, v199, v12
v_mul_f32 v200, v200, v12
v_mul_f32 v201, v201, v12
v_cvt_pk_bf16_f32 v184, v184, v185
v_cvt_pk_bf16_f32 v185, v186, v187
v_cvt_pk_bf16_f32 v186, v188, v189
v_cvt_pk_bf16_f32 v187, v190, v191
v_cvt_pk_bf16_f32 v188, v192, v193
v_cvt_pk_bf16_f32 v189, v194, v195
v_cvt_pk_bf16_f32 v190, v196, v197
v_cvt_pk_bf16_f32 v191, v198, v199
v_cvt_pk_bf16_f32 v192, v200, v201
ds_write2_b32 v14, v184, v185 offset0:0 offset1:1
ds_write2_b32 v14, v186, v187 offset0:2 offset1:3
ds_write2_b32 v14, v188, v189 offset0:4 offset1:5
ds_write2_b32 v14, v190, v191 offset0:6 offset1:7
ds_write_b32 v14, v192 offset:32
s_add_u32 s35, s35, 64
s_cmp_lt_u32 s35, 192
s_cbranch_scc1 L_la_loop
s_waitcnt lgkmcnt(0)
s_barrier
v_mul_u32_u24 v14, 456, v10
v_lshl_add_u32 v14, v11, 4, v14
s_add_u32 s37, s34, 1
s_mul_i32 s37, s37, 7296
s_add_u32 s37, s37, 73728
v_add_u32 v14, s37, v14
s_mul_i32 s40, s33, 11
s_add_u32 s40, s40, s34
s_mov_b32 s35, s34
s_mul_i32 s41, s32, 2304
s_add_u32 s41, s41, 83886080
L_oa_loop:
s_cmp_ge_u32 s40, 128
s_cbranch_scc1 L_oa_done
ds_read2_b64 v[16:19], v14 offset0:0 offset1:1
ds_read2_b64 v[20:23], v14 offset0:8 offset1:9
ds_read2_b64 v[24:27], v14 offset0:16 offset1:17
s_mul_i32 s37, s40, 18432
s_add_u32 s37, s37, s41
s_waitcnt lgkmcnt(2)
buffer_store_dwordx4 v[16:19], v1, s[4:7], s37 offen offset:0 sc0 sc1
s_waitcnt lgkmcnt(1)
buffer_store_dwordx4 v[20:23], v1, s[4:7], s37 offen offset:1024 sc0 sc1
s_waitcnt lgkmcnt(0)
s_mov_b64 exec, 0xffff
buffer_store_dwordx4 v[24:27], v1, s[4:7], s37 offen offset:2048 sc0 sc1
s_mov_b64 exec, -1
v_add_u32 v14, 29184, v14
s_add_u32 s40, s40, 4
s_add_u32 s35, s35, 4
s_cmp_lt_u32 s35, 11
s_cbranch_scc1 L_oa_loop
L_oa_done:
s_waitcnt vmcnt(0)
s_barrier
s_cmp_lg_u32 s34, 0
s_cbranch_scc1 L_a_sig
v_mov_b32 v12, 1
s_mov_b64 exec, 1
buffer_atomic_add v12, v8, s[24:27], 0 offen offset:4 sc1
s_mov_b64 exec, -1
L_a_sig:
s_cmp_ge_u32 s48, 5
s_cbranch_scc1 L_exit_w
v_add_u32 v12, 0, v9
v_mul_u32_u24 v13, 171, v12
v_lshrrev_b32 v13, 10, v13
v_mul_u32_u24 v13, 1056, v13
v_lshl_add_u32 v2, v12, 4, v13
v_add_u32 v12, 64, v9
v_mul_u32_u24 v13, 171, v12
v_lshrrev_b32 v13, 10, v13
v_mul_u32_u24 v13, 1056, v13
v_lshl_add_u32 v3, v12, 4, v13
v_add_u32 v12, 128, v9
v_mul_u32_u24 v13, 171, v12
v_lshrrev_b32 v13, 10, v13
v_mul_u32_u24 v13, 1056, v13
v_lshl_add_u32 v4, v12, 4, v13
v_lshrrev_b32 v12, 2, v10
v_lshl_add_u32 v12, v11, 2, v12
v_mul_u32_u24 v5, 96, v12
v_and_b32 v12, 3, v10
v_lshl_add_u32 v5, v12, 3, v5
v_lshrrev_b32 v12, 2, v10
v_lshl_add_u32 v12, v11, 3, v12
v_mul_u32_u24 v6, 96, v12
v_and_b32 v12, 3, v10
v_lshl_add_u32 v6, v12, 3, v6
s_lshl_b32 s50, s34, 15
v_add_u32 v5, s50, v5
v_add_u32 v6, s50, v6
v_add_u32 v7, s50, v1
s_mul_i32 s37, s49, 96
s_mul_i32 s51, s34, 1179648
s_add_u32 s51, s51, s37
s_mul_i32 s52, s34, 184320
s_add_u32 s52, s52, s37
v_mul_u32_u24 v15, 1152, v10
v_lshl_add_u32 v15, v11, 3, v15
s_lshl_b32 s38, s34, 5
s_add_u32 s37, s37, s38
s_mul_i32 s55, s48, 18432
s_add_u32 s54, s55, 83886080
s_add_u32 s55, s55, s37
s_lshl_b32 s53, s48, 17
s_add_u32 s53, s53, s50
s_add_u32 s53, s53, 67108864
s_lshl_b32 s56, s48, 6
s_add_u32 s56, s56, 87031808
v_lshlrev_b32 v9, 4, v9
v_lshlrev_b32 v10, 2, v10
v_add_u32 v14, 131072, v1
s_add_u32 s37, s52, 0
s_add_u32 m0, s50, 0
s_nop 0
buffer_load_dwordx4 v2, s[16:19], s37 offen lds
s_add_u32 m0, s50, 1024
s_nop 0
buffer_load_dwordx4 v3, s[16:19], s37 offen lds
s_add_u32 m0, s50, 2048
s_nop 0
buffer_load_dwordx4 v4, s[16:19], s37 offen lds
s_add_u32 s37, s52, 36864
s_add_u32 m0, s50, 3072
s_nop 0
buffer_load_dwordx4 v2, s[16:19], s37 offen lds
s_add_u32 m0, s50, 4096
s_nop 0
buffer_load_dwordx4 v3, s[16:19], s37 offen lds
s_add_u32 m0, s50, 5120
s_nop 0
buffer_load_dwordx4 v4, s[16:19], s37 offen lds
s_add_u32 s37, s52, 73728
s_add_u32 m0, s50, 6144
s_nop 0
buffer_load_dwordx4 v2, s[16:19], s37 offen lds
s_add_u32 m0, s50, 7168
s_nop 0
buffer_load_dwordx4 v3, s[16:19], s37 offen lds
s_add_u32 m0, s50, 8192
s_nop 0
buffer_load_dwordx4 v4, s[16:19], s37 offen lds
s_add_u32 s37, s52, 110592
s_add_u32 m0, s50, 9216
s_nop 0
buffer_load_dwordx4 v2, s[16:19], s37 offen lds
s_add_u32 m0, s50, 10240
s_nop 0
buffer_load_dwordx4 v3, s[16:19], s37 offen lds
s_add_u32 m0, s50, 11264
s_nop 0
buffer_load_dwordx4 v4, s[16:19], s37 offen lds
s_add_u32 s37, s52, 147456
s_add_u32 m0, s50, 12288
s_nop 0
buffer_load_dwordx4 v2, s[16:19], s37 offen lds
s_add_u32 m0, s50, 13312
s_nop 0
buffer_load_dwordx4 v3, s[16:19], s37 offen lds
s_add_u32 m0, s50, 14336
s_nop 0
buffer_load_dwordx4 v4, s[16:19], s37 offen lds
s_add_u32 s37, s51, 0
s_add_u32 m0, s50, 15360
s_nop 0
buffer_load_dwordx4 v2, s[20:23], s37 offen lds
s_add_u32 m0, s50, 16384
s_nop 0
buffer_load_dwordx4 v3, s[20:23], s37 offen lds
s_add_u32 m0, s50, 17408
s_nop 0
buffer_load_dwordx4 v4, s[20:23], s37 offen lds
s_add_u32 s37, s51, 36864
s_add_u32 m0, s50, 18432
s_nop 0
buffer_load_dwordx4 v2, s[20:23], s37 offen lds
s_add_u32 m0, s50, 19456
s_nop 0
buffer_load_dwordx4 v3, s[20:23], s37 offen lds
s_add_u32 m0, s50, 20480
s_nop 0
buffer_load_dwordx4 v4, s[20:23], s37 offen lds
s_add_u32 s37, s51, 73728
s_add_u32 m0, s50, 21504
s_nop 0
buffer_load_dwordx4 v2, s[20:23], s37 offen lds
s_add_u32 m0, s50, 22528
s_nop 0
buffer_load_dwordx4 v3, s[20:23], s37 offen lds
s_add_u32 m0, s50, 23552
s_nop 0
buffer_load_dwordx4 v4, s[20:23], s37 offen lds
s_add_u32 s37, s51, 110592
s_add_u32 m0, s50, 24576
s_nop 0
buffer_load_dwordx4 v2, s[20:23], s37 offen lds
s_add_u32 m0, s50, 25600
s_nop 0
buffer_load_dwordx4 v3, s[20:23], s37 offen lds
s_add_u32 m0, s50, 26624
s_nop 0
buffer_load_dwordx4 v4, s[20:23], s37 offen lds
s_waitcnt vmcnt(24)
ds_read_b64_tr_b16 v[68:69], v6 offset:0
ds_read_b64_tr_b16 v[70:71], v6 offset:384
ds_read_b64_tr_b16 v[72:73], v6 offset:32
ds_read_b64_tr_b16 v[74:75], v6 offset:416
ds_read_b64_tr_b16 v[76:77], v6 offset:64
ds_read_b64_tr_b16 v[78:79], v6 offset:448
s_waitcnt lgkmcnt(0)
s_add_u32 s37, s51, 147456
s_add_u32 m0, s50, 27648
s_nop 0
buffer_load_dwordx4 v2, s[20:23], s37 offen lds
s_add_u32 m0, s50, 28672
s_nop 0
buffer_load_dwordx4 v3, s[20:23], s37 offen lds
s_add_u32 m0, s50, 29696
s_nop 0
buffer_load_dwordx4 v4, s[20:23], s37 offen lds
s_waitcnt vmcnt(24)
ds_read_b64_tr_b16 v[80:81], v6 offset:3072
ds_read_b64_tr_b16 v[82:83], v6 offset:3456
ds_read_b64_tr_b16 v[84:85], v6 offset:3104
ds_read_b64_tr_b16 v[86:87], v6 offset:3488
ds_read_b64_tr_b16 v[88:89], v6 offset:3136
ds_read_b64_tr_b16 v[90:91], v6 offset:3520
s_waitcnt lgkmcnt(0)
s_add_u32 s37, s51, 184320
s_add_u32 m0, s50, 0
s_nop 0
buffer_load_dwordx4 v2, s[20:23], s37 offen lds
s_add_u32 m0, s50, 1024
s_nop 0
buffer_load_dwordx4 v3, s[20:23], s37 offen lds
s_add_u32 m0, s50, 2048
s_nop 0
buffer_load_dwordx4 v4, s[20:23], s37 offen lds
s_waitcnt vmcnt(24)
ds_read_b64_tr_b16 v[92:93], v6 offset:6144
ds_read_b64_tr_b16 v[94:95], v6 offset:6528
ds_read_b64_tr_b16 v[96:97], v6 offset:6176
ds_read_b64_tr_b16 v[98:99], v6 offset:6560
ds_read_b64_tr_b16 v[100:101], v6 offset:6208
ds_read_b64_tr_b16 v[102:103], v6 offset:6592
s_waitcnt lgkmcnt(0)
s_add_u32 s37, s51, 221184
s_add_u32 m0, s50, 3072
s_nop 0
buffer_load_dwordx4 v2, s[20:23], s37 offen lds
s_add_u32 m0, s50, 4096
s_nop 0
buffer_load_dwordx4 v3, s[20:23], s37 offen lds
s_add_u32 m0, s50, 5120
s_nop 0
buffer_load_dwordx4 v4, s[20:23], s37 offen lds
s_waitcnt vmcnt(24)
ds_read_b64_tr_b16 v[104:105], v6 offset:9216
ds_read_b64_tr_b16 v[106:107], v6 offset:9600
ds_read_b64_tr_b16 v[108:109], v6 offset:9248
ds_read_b64_tr_b16 v[110:111], v6 offset:9632
ds_read_b64_tr_b16 v[112:113], v6 offset:9280
ds_read_b64_tr_b16 v[114:115], v6 offset:9664
s_waitcnt lgkmcnt(0)
s_add_u32 s37, s51, 258048
s_add_u32 m0, s50, 6144
s_nop 0
buffer_load_dwordx4 v2, s[20:23], s37 offen lds
s_add_u32 m0, s50, 7168
s_nop 0
buffer_load_dwordx4 v3, s[20:23], s37 offen lds
s_add_u32 m0, s50, 8192
s_nop 0
buffer_load_dwordx4 v4, s[20:23], s37 offen lds
s_waitcnt vmcnt(24)
ds_read_b64_tr_b16 v[116:117], v6 offset:12288
ds_read_b64_tr_b16 v[118:119], v6 offset:12672
ds_read_b64_tr_b16 v[120:121], v6 offset:12320
ds_read_b64_tr_b16 v[122:123], v6 offset:12704
ds_read_b64_tr_b16 v[124:125], v6 offset:12352
ds_read_b64_tr_b16 v[126:127], v6 offset:12736
s_waitcnt lgkmcnt(0)
s_add_u32 s37, s51, 294912
s_add_u32 m0, s50, 9216
s_nop 0
buffer_load_dwordx4 v2, s[20:23], s37 offen lds
s_add_u32 m0, s50, 10240
s_nop 0
buffer_load_dwordx4 v3, s[20:23], s37 offen lds
s_add_u32 m0, s50, 11264
s_nop 0
buffer_load_dwordx4 v4, s[20:23], s37 offen lds
s_waitcnt vmcnt(24)
ds_read_b64_tr_b16 v[128:129], v5 offset:15360
ds_read_b64_tr_b16 v[130:131], v5 offset:16896
ds_read_b64_tr_b16 v[132:133], v5 offset:15392
ds_read_b64_tr_b16 v[134:135], v5 offset:16928
ds_read_b64_tr_b16 v[136:137], v5 offset:15424
ds_read_b64_tr_b16 v[138:139], v5 offset:16960
s_waitcnt lgkmcnt(0)
s_add_u32 s37, s51, 331776
s_add_u32 m0, s50, 12288
s_nop 0
buffer_load_dwordx4 v2, s[20:23], s37 offen lds
s_add_u32 m0, s50, 13312
s_nop 0
buffer_load_dwordx4 v3, s[20:23], s37 offen lds
s_add_u32 m0, s50, 14336
s_nop 0
buffer_load_dwordx4 v4, s[20:23], s37 offen lds
s_waitcnt vmcnt(24)
ds_read_b64_tr_b16 v[140:141], v5 offset:18432
ds_read_b64_tr_b16 v[142:143], v5 offset:19968
ds_read_b64_tr_b16 v[144:145], v5 offset:18464
ds_read_b64_tr_b16 v[146:147], v5 offset:20000
ds_read_b64_tr_b16 v[148:149], v5 offset:18496
ds_read_b64_tr_b16 v[150:151], v5 offset:20032
s_waitcnt lgkmcnt(0)
s_add_u32 s37, s51, 368640
s_add_u32 m0, s50, 15360
s_nop 0
buffer_load_dwordx4 v2, s[20:23], s37 offen lds
s_add_u32 m0, s50, 16384
s_nop 0
buffer_load_dwordx4 v3, s[20:23], s37 offen lds
s_add_u32 m0, s50, 17408
s_nop 0
buffer_load_dwordx4 v4, s[20:23], s37 offen lds
s_waitcnt vmcnt(24)
ds_read_b64_tr_b16 v[152:153], v5 offset:21504
ds_read_b64_tr_b16 v[154:155], v5 offset:23040
ds_read_b64_tr_b16 v[156:157], v5 offset:21536
ds_read_b64_tr_b16 v[158:159], v5 offset:23072
ds_read_b64_tr_b16 v[160:161], v5 offset:21568
ds_read_b64_tr_b16 v[162:163], v5 offset:23104
s_waitcnt lgkmcnt(0)
s_add_u32 s37, s51, 405504
s_add_u32 m0, s50, 18432
s_nop 0
buffer_load_dwordx4 v2, s[20:23], s37 offen lds
s_add_u32 m0, s50, 19456
s_nop 0
buffer_load_dwordx4 v3, s[20:23], s37 offen lds
s_add_u32 m0, s50, 20480
s_nop 0
buffer_load_dwordx4 v4, s[20:23], s37 offen lds
s_waitcnt vmcnt(24)
ds_read_b64_tr_b16 v[164:165], v5 offset:24576
ds_read_b64_tr_b16 v[166:167], v5 offset:26112
ds_read_b64_tr_b16 v[168:169], v5 offset:24608
ds_read_b64_tr_b16 v[170:171], v5 offset:26144
ds_read_b64_tr_b16 v[172:173], v5 offset:24640
ds_read_b64_tr_b16 v[174:175], v5 offset:26176
s_waitcnt lgkmcnt(0)
s_add_u32 s37, s51, 442368
s_add_u32 m0, s50, 21504
s_nop 0
buffer_load_dwordx4 v2, s[20:23], s37 offen lds
s_add_u32 m0, s50, 22528
s_nop 0
buffer_load_dwordx4 v3, s[20:23], s37 offen lds
s_add_u32 m0, s50, 23552
s_nop 0
buffer_load_dwordx4 v4, s[20:23], s37 offen lds
s_waitcnt vmcnt(24)
ds_read_b64_tr_b16 v[176:177], v5 offset:27648
ds_read_b64_tr_b16 v[178:179], v5 offset:29184
ds_read_b64_tr_b16 v[180:181], v5 offset:27680
ds_read_b64_tr_b16 v[182:183], v5 offset:29216
ds_read_b64_tr_b16 v[184:185], v5 offset:27712
ds_read_b64_tr_b16 v[186:187], v5 offset:29248
s_waitcnt lgkmcnt(0)
s_add_u32 s37, s51, 479232
s_add_u32 m0, s50, 24576
s_nop 0
buffer_load_dwordx4 v2, s[20:23], s37 offen lds
s_add_u32 m0, s50, 25600
s_nop 0
buffer_load_dwordx4 v3, s[20:23], s37 offen lds
s_add_u32 m0, s50, 26624
s_nop 0
buffer_load_dwordx4 v4, s[20:23], s37 offen lds
s_waitcnt vmcnt(24)
ds_read_b64_tr_b16 v[188:189], v5 offset:0
ds_read_b64_tr_b16 v[190:191], v5 offset:1536
ds_read_b64_tr_b16 v[192:193], v5 offset:32
ds_read_b64_tr_b16 v[194:195], v5 offset:1568
ds_read_b64_tr_b16 v[196:197], v5 offset:64
ds_read_b64_tr_b16 v[198:199], v5 offset:1600
s_waitcnt lgkmcnt(0)
s_add_u32 s37, s51, 516096
s_add_u32 m0, s50, 27648
s_nop 0
buffer_load_dwordx4 v2, s[20:23], s37 offen lds
s_add_u32 m0, s50, 28672
s_nop 0
buffer_load_dwordx4 v3, s[20:23], s37 offen lds
s_add_u32 m0, s50, 29696
s_nop 0
buffer_load_dwordx4 v4, s[20:23], s37 offen lds
s_waitcnt vmcnt(24)
ds_read_b64_tr_b16 v[200:201], v5 offset:3072
ds_read_b64_tr_b16 v[202:203], v5 offset:4608
ds_read_b64_tr_b16 v[204:205], v5 offset:3104
ds_read_b64_tr_b16 v[206:207], v5 offset:4640
ds_read_b64_tr_b16 v[208:209], v5 offset:3136
ds_read_b64_tr_b16 v[210:211], v5 offset:4672
s_waitcnt lgkmcnt(0)
s_add_u32 s37, s51, 552960
s_add_u32 m0, s50, 0
s_nop 0
buffer_load_dwordx4 v2, s[20:23], s37 offen lds
s_add_u32 m0, s50, 1024
s_nop 0
buffer_load_dwordx4 v3, s[20:23], s37 offen lds
s_add_u32 m0, s50, 2048
s_nop 0
buffer_load_dwordx4 v4, s[20:23], s37 offen lds
s_waitcnt vmcnt(24)
ds_read_b64_tr_b16 v[212:213], v5 offset:6144
ds_read_b64_tr_b16 v[214:215], v5 offset:7680
ds_read_b64_tr_b16 v[216:217], v5 offset:6176
ds_read_b64_tr_b16 v[218:219], v5 offset:7712
ds_read_b64_tr_b16 v[220:221], v5 offset:6208
ds_read_b64_tr_b16 v[222:223], v5 offset:7744
s_waitcnt lgkmcnt(0)
s_add_u32 s37, s51, 589824
s_add_u32 m0, s50, 3072
s_nop 0
buffer_load_dwordx4 v2, s[20:23], s37 offen lds
s_add_u32 m0, s50, 4096
s_nop 0
buffer_load_dwordx4 v3, s[20:23], s37 offen lds
s_add_u32 m0, s50, 5120
s_nop 0
buffer_load_dwordx4 v4, s[20:23], s37 offen lds
s_waitcnt vmcnt(24)
ds_read_b64_tr_b16 v[224:225], v5 offset:9216
ds_read_b64_tr_b16 v[226:227], v5 offset:10752
ds_read_b64_tr_b16 v[228:229], v5 offset:9248
ds_read_b64_tr_b16 v[230:231], v5 offset:10784
ds_read_b64_tr_b16 v[232:233], v5 offset:9280
ds_read_b64_tr_b16 v[234:235], v5 offset:10816
s_waitcnt lgkmcnt(0)
s_add_u32 s37, s51, 626688
s_add_u32 m0, s50, 6144
s_nop 0
buffer_load_dwordx4 v2, s[20:23], s37 offen lds
s_add_u32 m0, s50, 7168
s_nop 0
buffer_load_dwordx4 v3, s[20:23], s37 offen lds
s_add_u32 m0, s50, 8192
s_nop 0
buffer_load_dwordx4 v4, s[20:23], s37 offen lds
s_waitcnt vmcnt(24)
ds_read_b64_tr_b16 v[236:237], v5 offset:12288
ds_read_b64_tr_b16 v[238:239], v5 offset:13824
ds_read_b64_tr_b16 v[240:241], v5 offset:12320
ds_read_b64_tr_b16 v[242:243], v5 offset:13856
ds_read_b64_tr_b16 v[244:245], v5 offset:12352
ds_read_b64_tr_b16 v[246:247], v5 offset:13888
s_waitcnt lgkmcnt(0)
s_add_u32 s37, s51, 663552
s_add_u32 m0, s50, 9216
s_nop 0
buffer_load_dwordx4 v2, s[20:23], s37 offen lds
s_add_u32 m0, s50, 10240
s_nop 0
buffer_load_dwordx4 v3, s[20:23], s37 offen lds
s_add_u32 m0, s50, 11264
s_nop 0
buffer_load_dwordx4 v4, s[20:23], s37 offen lds
s_waitcnt vmcnt(24)
ds_read_b64_tr_b16 v[248:249], v5 offset:15360
ds_read_b64_tr_b16 v[250:251], v5 offset:16896
ds_read_b64_tr_b16 v[252:253], v5 offset:15392
ds_read_b64_tr_b16 v[254:255], v5 offset:16928
ds_read_b64_tr_b16 a[0:1], v5 offset:15424
ds_read_b64_tr_b16 a[2:3], v5 offset:16960
s_waitcnt lgkmcnt(0)
s_add_u32 s37, s51, 700416
s_add_u32 m0, s50, 12288
s_nop 0
buffer_load_dwordx4 v2, s[20:23], s37 offen lds
s_add_u32 m0, s50, 13312
s_nop 0
buffer_load_dwordx4 v3, s[20:23], s37 offen lds
s_add_u32 m0, s50, 14336
s_nop 0
buffer_load_dwordx4 v4, s[20:23], s37 offen lds
s_waitcnt vmcnt(24)
ds_read_b64_tr_b16 a[4:5], v5 offset:18432
ds_read_b64_tr_b16 a[6:7], v5 offset:19968
ds_read_b64_tr_b16 a[8:9], v5 offset:18464
ds_read_b64_tr_b16 a[10:11], v5 offset:20000
ds_read_b64_tr_b16 a[12:13], v5 offset:18496
ds_read_b64_tr_b16 a[14:15], v5 offset:20032
s_waitcnt lgkmcnt(0)
s_add_u32 s37, s51, 737280
s_add_u32 m0, s50, 15360
s_nop 0
buffer_load_dwordx4 v2, s[20:23], s37 offen lds
s_add_u32 m0, s50, 16384
s_nop 0
buffer_load_dwordx4 v3, s[20:23], s37 offen lds
s_add_u32 m0, s50, 17408
s_nop 0
buffer_load_dwordx4 v4, s[20:23], s37 offen lds
s_waitcnt vmcnt(24)
ds_read_b64_tr_b16 a[16:17], v5 offset:21504
ds_read_b64_tr_b16 a[18:19], v5 offset:23040
ds_read_b64_tr_b16 a[20:21], v5 offset:21536
ds_read_b64_tr_b16 a[22:23], v5 offset:23072
ds_read_b64_tr_b16 a[24:25], v5 offset:21568
ds_read_b64_tr_b16 a[26:27], v5 offset:23104
s_waitcnt lgkmcnt(0)
s_add_u32 s37, s51, 774144
s_add_u32 m0, s50, 18432
s_nop 0
buffer_load_dwordx4 v2, s[20:23], s37 offen lds
s_add_u32 m0, s50, 19456
s_nop 0
buffer_load_dwordx4 v3, s[20:23], s37 offen lds
s_add_u32 m0, s50, 20480
s_nop 0
buffer_load_dwordx4 v4, s[20:23], s37 offen lds
s_waitcnt vmcnt(24)
ds_read_b64_tr_b16 a[28:29], v5 offset:24576
ds_read_b64_tr_b16 a[30:31], v5 offset:26112
ds_read_b64_tr_b16 a[32:33], v5 offset:24608
ds_read_b64_tr_b16 a[34:35], v5 offset:26144
ds_read_b64_tr_b16 a[36:37], v5 offset:24640
ds_read_b64_tr_b16 a[38:39], v5 offset:26176
s_waitcnt lgkmcnt(0)
s_add_u32 s37, s51, 811008
s_add_u32 m0, s50, 21504
s_nop 0
buffer_load_dwordx4 v2, s[20:23], s37 offen lds
s_add_u32 m0, s50, 22528
s_nop 0
buffer_load_dwordx4 v3, s[20:23], s37 offen lds
s_add_u32 m0, s50, 23552
s_nop 0
buffer_load_dwordx4 v4, s[20:23], s37 offen lds
s_waitcnt vmcnt(24)
ds_read_b64_tr_b16 a[40:41], v5 offset:27648
ds_read_b64_tr_b16 a[42:43], v5 offset:29184
ds_read_b64_tr_b16 a[44:45], v5 offset:27680
ds_read_b64_tr_b16 a[46:47], v5 offset:29216
ds_read_b64_tr_b16 a[48:49], v5 offset:27712
ds_read_b64_tr_b16 a[50:51], v5 offset:29248
s_waitcnt lgkmcnt(0)
s_add_u32 s37, s51, 847872
s_add_u32 m0, s50, 24576
s_nop 0
buffer_load_dwordx4 v2, s[20:23], s37 offen lds
s_add_u32 m0, s50, 25600
s_nop 0
buffer_load_dwordx4 v3, s[20:23], s37 offen lds
s_add_u32 m0, s50, 26624
s_nop 0
buffer_load_dwordx4 v4, s[20:23], s37 offen lds
s_waitcnt vmcnt(24)
ds_read_b64_tr_b16 a[52:53], v5 offset:0
ds_read_b64_tr_b16 a[54:55], v5 offset:1536
ds_read_b64_tr_b16 a[56:57], v5 offset:32
ds_read_b64_tr_b16 a[58:59], v5 offset:1568
ds_read_b64_tr_b16 a[60:61], v5 offset:64
ds_read_b64_tr_b16 a[62:63], v5 offset:1600
s_waitcnt lgkmcnt(0)
s_add_u32 s37, s51, 884736
s_add_u32 m0, s50, 27648
s_nop 0
buffer_load_dwordx4 v2, s[20:23], s37 offen lds
s_add_u32 m0, s50, 28672
s_nop 0
buffer_load_dwordx4 v3, s[20:23], s37 offen lds
s_add_u32 m0, s50, 29696
s_nop 0
buffer_load_dwordx4 v4, s[20:23], s37 offen lds
s_waitcnt vmcnt(24)
ds_read_b64_tr_b16 a[64:65], v5 offset:3072
ds_read_b64_tr_b16 a[66:67], v5 offset:4608
ds_read_b64_tr_b16 a[68:69], v5 offset:3104
ds_read_b64_tr_b16 a[70:71], v5 offset:4640
ds_read_b64_tr_b16 a[72:73], v5 offset:3136
ds_read_b64_tr_b16 a[74:75], v5 offset:4672
s_waitcnt lgkmcnt(0)
s_add_u32 s37, s51, 921600
s_add_u32 m0, s50, 0
s_nop 0
buffer_load_dwordx4 v2, s[20:23], s37 offen lds
s_add_u32 m0, s50, 1024
s_nop 0
buffer_load_dwordx4 v3, s[20:23], s37 offen lds
s_add_u32 m0, s50, 2048
s_nop 0
buffer_load_dwordx4 v4, s[20:23], s37 offen lds
s_waitcnt vmcnt(24)
ds_read_b64_tr_b16 a[76:77], v5 offset:6144
ds_read_b64_tr_b16 a[78:79], v5 offset:7680
ds_read_b64_tr_b16 a[80:81], v5 offset:6176
ds_read_b64_tr_b16 a[82:83], v5 offset:7712
ds_read_b64_tr_b16 a[84:85], v5 offset:6208
ds_read_b64_tr_b16 a[86:87], v5 offset:7744
s_waitcnt lgkmcnt(0)
s_add_u32 s37, s51, 958464
s_add_u32 m0, s50, 3072
s_nop 0
buffer_load_dwordx4 v2, s[20:23], s37 offen lds
s_add_u32 m0, s50, 4096
s_nop 0
buffer_load_dwordx4 v3, s[20:23], s37 offen lds
s_add_u32 m0, s50, 5120
s_nop 0
buffer_load_dwordx4 v4, s[20:23], s37 offen lds
s_waitcnt vmcnt(24)
ds_read_b64_tr_b16 a[88:89], v5 offset:9216
ds_read_b64_tr_b16 a[90:91], v5 offset:10752
ds_read_b64_tr_b16 a[92:93], v5 offset:9248
ds_read_b64_tr_b16 a[94:95], v5 offset:10784
ds_read_b64_tr_b16 a[96:97], v5 offset:9280
ds_read_b64_tr_b16 a[98:99], v5 offset:10816
s_waitcnt lgkmcnt(0)
s_add_u32 s37, s51, 995328
s_add_u32 m0, s50, 6144
s_nop 0
buffer_load_dwordx4 v2, s[20:23], s37 offen lds
s_add_u32 m0, s50, 7168
s_nop 0
buffer_load_dwordx4 v3, s[20:23], s37 offen lds
s_add_u32 m0, s50, 8192
s_nop 0
buffer_load_dwordx4 v4, s[20:23], s37 offen lds
s_waitcnt vmcnt(24)
ds_read_b64_tr_b16 a[100:101], v5 offset:12288
ds_read_b64_tr_b16 a[102:103], v5 offset:13824
ds_read_b64_tr_b16 a[104:105], v5 offset:12320
ds_read_b64_tr_b16 a[106:107], v5 offset:13856
ds_read_b64_tr_b16 a[108:109], v5 offset:12352
ds_read_b64_tr_b16 a[110:111], v5 offset:13888
s_waitcnt lgkmcnt(0)
s_add_u32 s37, s51, 1032192
s_add_u32 m0, s50, 9216
s_nop 0
buffer_load_dwordx4 v2, s[20:23], s37 offen lds
s_add_u32 m0, s50, 10240
s_nop 0
buffer_load_dwordx4 v3, s[20:23], s37 offen lds
s_add_u32 m0, s50, 11264
s_nop 0
buffer_load_dwordx4 v4, s[20:23], s37 offen lds
s_waitcnt vmcnt(24)
ds_read_b64_tr_b16 a[112:113], v5 offset:15360
ds_read_b64_tr_b16 a[114:115], v5 offset:16896
ds_read_b64_tr_b16 a[116:117], v5 offset:15392
ds_read_b64_tr_b16 a[118:119], v5 offset:16928
ds_read_b64_tr_b16 a[120:121], v5 offset:15424
ds_read_b64_tr_b16 a[122:123], v5 offset:16960
s_waitcnt lgkmcnt(0)
s_add_u32 s37, s51, 1069056
s_add_u32 m0, s50, 12288
s_nop 0
buffer_load_dwordx4 v2, s[20:23], s37 offen lds
s_add_u32 m0, s50, 13312
s_nop 0
buffer_load_dwordx4 v3, s[20:23], s37 offen lds
s_add_u32 m0, s50, 14336
s_nop 0
buffer_load_dwordx4 v4, s[20:23], s37 offen lds
s_waitcnt vmcnt(24)
ds_read_b64_tr_b16 a[124:125], v5 offset:18432
ds_read_b64_tr_b16 a[126:127], v5 offset:19968
ds_read_b64_tr_b16 a[128:129], v5 offset:18464
ds_read_b64_tr_b16 a[130:131], v5 offset:20000
ds_read_b64_tr_b16 a[132:133], v5 offset:18496
ds_read_b64_tr_b16 a[134:135], v5 offset:20032
s_waitcnt lgkmcnt(0)
s_add_u32 s37, s51, 1105920
s_add_u32 m0, s50, 15360
s_nop 0
buffer_load_dwordx4 v2, s[20:23], s37 offen lds
s_add_u32 m0, s50, 16384
s_nop 0
buffer_load_dwordx4 v3, s[20:23], s37 offen lds
s_add_u32 m0, s50, 17408
s_nop 0
buffer_load_dwordx4 v4, s[20:23], s37 offen lds
s_waitcnt vmcnt(24)
ds_read_b64_tr_b16 a[136:137], v5 offset:21504
ds_read_b64_tr_b16 a[138:139], v5 offset:23040
ds_read_b64_tr_b16 a[140:141], v5 offset:21536
ds_read_b64_tr_b16 a[142:143], v5 offset:23072
ds_read_b64_tr_b16 a[144:145], v5 offset:21568
ds_read_b64_tr_b16 a[146:147], v5 offset:23104
s_waitcnt lgkmcnt(0)
s_add_u32 s37, s51, 1142784
s_add_u32 m0, s50, 18432
s_nop 0
buffer_load_dwordx4 v2, s[20:23], s37 offen lds
s_add_u32 m0, s50, 19456
s_nop 0
buffer_load_dwordx4 v3, s[20:23], s37 offen lds
s_add_u32 m0, s50, 20480
s_nop 0
buffer_load_dwordx4 v4, s[20:23], s37 offen lds
s_waitcnt vmcnt(24)
ds_read_b64_tr_b16 a[148:149], v5 offset:24576
ds_read_b64_tr_b16 a[150:151], v5 offset:26112
ds_read_b64_tr_b16 a[152:153], v5 offset:24608
ds_read_b64_tr_b16 a[154:155], v5 offset:26144
ds_read_b64_tr_b16 a[156:157], v5 offset:24640
ds_read_b64_tr_b16 a[158:159], v5 offset:26176
s_waitcnt lgkmcnt(0)
s_waitcnt vmcnt(21)
ds_read_b64_tr_b16 a[160:161], v5 offset:27648
ds_read_b64_tr_b16 a[162:163], v5 offset:29184
ds_read_b64_tr_b16 a[164:165], v5 offset:27680
ds_read_b64_tr_b16 a[166:167], v5 offset:29216
ds_read_b64_tr_b16 a[168:169], v5 offset:27712
ds_read_b64_tr_b16 a[170:171], v5 offset:29248
s_waitcnt lgkmcnt(0)
s_waitcnt vmcnt(18)
ds_read_b64_tr_b16 a[172:173], v5 offset:0
ds_read_b64_tr_b16 a[174:175], v5 offset:1536
ds_read_b64_tr_b16 a[176:177], v5 offset:32
ds_read_b64_tr_b16 a[178:179], v5 offset:1568
ds_read_b64_tr_b16 a[180:181], v5 offset:64
ds_read_b64_tr_b16 a[182:183], v5 offset:1600
s_waitcnt lgkmcnt(0)
s_waitcnt vmcnt(15)
ds_read_b64_tr_b16 a[184:185], v5 offset:3072
ds_read_b64_tr_b16 a[186:187], v5 offset:4608
ds_read_b64_tr_b16 a[188:189], v5 offset:3104
ds_read_b64_tr_b16 a[190:191], v5 offset:4640
ds_read_b64_tr_b16 a[192:193], v5 offset:3136
ds_read_b64_tr_b16 a[194:195], v5 offset:4672
s_waitcnt lgkmcnt(0)
s_waitcnt vmcnt(12)
ds_read_b64_tr_b16 a[196:197], v5 offset:6144
ds_read_b64_tr_b16 a[198:199], v5 offset:7680
ds_read_b64_tr_b16 a[200:201], v5 offset:6176
ds_read_b64_tr_b16 a[202:203], v5 offset:7712
ds_read_b64_tr_b16 a[204:205], v5 offset:6208
ds_read_b64_tr_b16 a[206:207], v5 offset:7744
s_waitcnt lgkmcnt(0)
s_waitcnt vmcnt(9)
ds_read_b64_tr_b16 a[208:209], v5 offset:9216
ds_read_b64_tr_b16 a[210:211], v5 offset:10752
ds_read_b64_tr_b16 a[212:213], v5 offset:9248
ds_read_b64_tr_b16 a[214:215], v5 offset:10784
ds_read_b64_tr_b16 a[216:217], v5 offset:9280
ds_read_b64_tr_b16 a[218:219], v5 offset:10816
s_waitcnt lgkmcnt(0)
s_waitcnt vmcnt(6)
ds_read_b64_tr_b16 a[220:221], v5 offset:12288
ds_read_b64_tr_b16 a[222:223], v5 offset:13824
ds_read_b64_tr_b16 a[224:225], v5 offset:12320
ds_read_b64_tr_b16 a[226:227], v5 offset:13856
ds_read_b64_tr_b16 a[228:229], v5 offset:12352
ds_read_b64_tr_b16 a[230:231], v5 offset:13888
s_waitcnt lgkmcnt(0)
s_waitcnt vmcnt(3)
ds_read_b64_tr_b16 a[232:233], v5 offset:15360
ds_read_b64_tr_b16 a[234:235], v5 offset:16896
ds_read_b64_tr_b16 a[236:237], v5 offset:15392
ds_read_b64_tr_b16 a[238:239], v5 offset:16928
ds_read_b64_tr_b16 a[240:241], v5 offset:15424
ds_read_b64_tr_b16 a[242:243], v5 offset:16960
s_waitcnt lgkmcnt(0)
s_waitcnt vmcnt(0)
ds_read_b64_tr_b16 a[244:245], v5 offset:18432
ds_read_b64_tr_b16 a[246:247], v5 offset:19968
ds_read_b64_tr_b16 a[248:249], v5 offset:18464
ds_read_b64_tr_b16 a[250:251], v5 offset:20000
ds_read_b64_tr_b16 a[252:253], v5 offset:18496
ds_read_b64_tr_b16 a[254:255], v5 offset:20032
s_waitcnt lgkmcnt(0)
s_branch L_w_init_in
L_w_init:
s_sleep 4
L_w_init_in:
buffer_load_dword v12, v8, s[24:27], 0 offen offset:0 sc0 sc1
s_sub_u32 s36, s36, 1
s_cbranch_scc1 L_exit_w
s_waitcnt vmcnt(0)
v_readfirstlane_b32 s37, v12
s_nop 0
s_and_b32 s37, s37, 0xff
s_cmp_eq_u32 s37, 32
s_cbranch_scc0 L_w_init
s_branch L_w_adone_in
L_w_adone:
s_sleep 4
L_w_adone_in:
buffer_load_dword v12, v8, s[24:27], 0 offen offset:4 sc0 sc1
s_sub_u32 s36, s36, 1
s_cbranch_scc1 L_exit_w
s_waitcnt vmcnt(0)
v_readfirstlane_b32 s37, v12
s_nop 0
s_cmp_eq_u32 s37, 96
s_cbranch_scc0 L_w_adone
s_mov_b32 s35, 0
s_mul_i32 s52, s34, 5
s_mul_i32 s58, s34, 3072
v_add_u32 v2, s58, v14
s_lshl_b32 s37, s34, 10
v_add_u32 v14, s37, v14
s_cmp_eq_u32 s34, 3
s_cselect_b32 s37, 0x400000, 0
v_add_u32 v15, s37, v15
L_w_wait:
s_and_b32 s57, s48, 7
s_lshl_b32 s57, s57, 10
s_add_u32 s57, s57, 331776
s_lshr_b32 s35, s48, 3
s_add_u32 s37, s52, 0
s_min_u32 s37, s37, 17
s_lshl_b32 s37, s37, 10
s_add_u32 s37, s37, s54
buffer_load_dwordx4 v[40:43], v1, s[4:7], s37 offen sc1
s_add_u32 s37, s52, 1
s_min_u32 s37, s37, 17
s_lshl_b32 s37, s37, 10
s_add_u32 s37, s37, s54
buffer_load_dwordx4 v[44:47], v1, s[4:7], s37 offen sc1
s_add_u32 s37, s52, 2
s_min_u32 s37, s37, 17
s_lshl_b32 s37, s37, 10
s_add_u32 s37, s37, s54
buffer_load_dwordx4 v[48:51], v1, s[4:7], s37 offen sc1
s_add_u32 s37, s52, 3
s_min_u32 s37, s37, 17
s_lshl_b32 s37, s37, 10
s_add_u32 s37, s37, s54
buffer_load_dwordx4 v[52:55], v1, s[4:7], s37 offen sc1
s_add_u32 s37, s52, 4
s_min_u32 s37, s37, 17
s_lshl_b32 s37, s37, 10
s_add_u32 s37, s37, s54
buffer_load_dwordx4 v[56:59], v1, s[4:7], s37 offen sc1
buffer_load_dword v4, v10, s[4:7], s56 offen sc1
s_waitcnt vmcnt(5)
v_mfma_f32_16x16x32_bf16 v[28:31], v[68:71], v[40:43], 0
v_mfma_f32_16x16x32_bf16 v[32:35], v[72:75], v[40:43], 0
v_mfma_f32_16x16x32_bf16 v[36:39], v[76:79], v[40:43], 0
s_waitcnt vmcnt(4)
v_mfma_f32_16x16x32_bf16 v[28:31], v[80:83], v[44:47], v[28:31]
v_mfma_f32_16x16x32_bf16 v[32:35], v[84:87], v[44:47], v[32:35]
v_mfma_f32_16x16x32_bf16 v[36:39], v[88:91], v[44:47], v[36:39]
s_waitcnt vmcnt(3)
v_mfma_f32_16x16x32_bf16 v[28:31], v[92:95], v[48:51], v[28:31]
v_mfma_f32_16x16x32_bf16 v[32:35], v[96:99], v[48:51], v[32:35]
v_mfma_f32_16x16x32_bf16 v[36:39], v[100:103], v[48:51], v[36:39]
s_waitcnt vmcnt(2)
v_mfma_f32_16x16x32_bf16 v[28:31], v[104:107], v[52:55], v[28:31]
v_mfma_f32_16x16x32_bf16 v[32:35], v[108:111], v[52:55], v[32:35]
v_mfma_f32_16x16x32_bf16 v[36:39], v[112:115], v[52:55], v[36:39]
s_waitcnt vmcnt(1)
v_mfma_f32_16x16x32_bf16 v[28:31], v[116:119], v[56:59], v[28:31]
v_mfma_f32_16x16x32_bf16 v[32:35], v[120:123], v[56:59], v[32:35]
v_mfma_f32_16x16x32_bf16 v[36:39], v[124:127], v[56:59], v[36:39]
s_branch L_w_poll_in
L_w_poll:
s_sleep 2
L_w_poll_in:
buffer_load_dword v12, v9, s[4:7], s57 offen offset:0 sc0 sc1
s_sub_u32 s36, s36, 1
s_cbranch_scc1 L_exit_w
s_waitcnt vmcnt(0)
v_cmp_ge_u32 vcc, s35, v12
s_nop 1
s_cmp_eq_u64 vcc, 0
s_cbranch_scc0 L_w_poll
s_add_u32 s37, s53, 0
s_add_u32 m0, s50, 0
s_nop 0
buffer_load_dwordx4 v1, s[4:7], s37 offen offset:0 sc1 lds
buffer_load_dwordx4 v1, s[4:7], s37 offen offset:1024 sc1 lds
buffer_load_dwordx4 v1, s[4:7], s37 offen offset:2048 sc1 lds
buffer_load_dwordx4 v1, s[4:7], s37 offen offset:3072 sc1 lds
s_add_u32 s37, s53, 4096
s_add_u32 m0, s50, 4096
s_nop 0
buffer_load_dwordx4 v1, s[4:7], s37 offen offset:0 sc1 lds
buffer_load_dwordx4 v1, s[4:7], s37 offen offset:1024 sc1 lds
buffer_load_dwordx4 v1, s[4:7], s37 offen offset:2048 sc1 lds
buffer_load_dwordx4 v1, s[4:7], s37 offen offset:3072 sc1 lds
s_add_u32 s37, s53, 8192
s_add_u32 m0, s50, 8192
s_nop 0
buffer_load_dwordx4 v1, s[4:7], s37 offen offset:0 sc1 lds
buffer_load_dwordx4 v1, s[4:7], s37 offen offset:1024 sc1 lds
buffer_load_dwordx4 v1, s[4:7], s37 offen offset:2048 sc1 lds
buffer_load_dwordx4 v1, s[4:7], s37 offen offset:3072 sc1 lds
s_add_u32 s37, s53, 12288
s_add_u32 m0, s50, 12288
s_nop 0
buffer_load_dwordx4 v1, s[4:7], s37 offen offset:0 sc1 lds
buffer_load_dwordx4 v1, s[4:7], s37 offen offset:1024 sc1 lds
buffer_load_dwordx4 v1, s[4:7], s37 offen offset:2048 sc1 lds
buffer_load_dwordx4 v1, s[4:7], s37 offen offset:3072 sc1 lds
s_branch L_w_b
L_w_ready:
s_add_u32 s37, s52, 0
s_min_u32 s37, s37, 17
s_lshl_b32 s37, s37, 10
s_add_u32 s37, s37, s54
buffer_load_dwordx4 v[40:43], v1, s[4:7], s37 offen sc1
s_add_u32 s37, s52, 1
s_min_u32 s37, s37, 17
s_lshl_b32 s37, s37, 10
s_add_u32 s37, s37, s54
buffer_load_dwordx4 v[44:47], v1, s[4:7], s37 offen sc1
s_add_u32 s37, s52, 2
s_min_u32 s37, s37, 17
s_lshl_b32 s37, s37, 10
s_add_u32 s37, s37, s54
buffer_load_dwordx4 v[48:51], v1, s[4:7], s37 offen sc1
s_add_u32 s37, s52, 3
s_min_u32 s37, s37, 17
s_lshl_b32 s37, s37, 10
s_add_u32 s37, s37, s54
buffer_load_dwordx4 v[52:55], v1, s[4:7], s37 offen sc1
s_add_u32 s37, s52, 4
s_min_u32 s37, s37, 17
s_lshl_b32 s37, s37, 10
s_add_u32 s37, s37, s54
buffer_load_dwordx4 v[56:59], v1, s[4:7], s37 offen sc1
buffer_load_dword v4, v10, s[4:7], s56 offen sc1
s_add_u32 s37, s53, 0
s_add_u32 m0, s50, 0
s_nop 0
buffer_load_dwordx4 v1, s[4:7], s37 offen offset:0 sc1 lds
buffer_load_dwordx4 v1, s[4:7], s37 offen offset:1024 sc1 lds
buffer_load_dwordx4 v1, s[4:7], s37 offen offset:2048 sc1 lds
buffer_load_dwordx4 v1, s[4:7], s37 offen offset:3072 sc1 lds
s_add_u32 s37, s53, 4096
s_add_u32 m0, s50, 4096
s_nop 0
buffer_load_dwordx4 v1, s[4:7], s37 offen offset:0 sc1 lds
buffer_load_dwordx4 v1, s[4:7], s37 offen offset:1024 sc1 lds
buffer_load_dwordx4 v1, s[4:7], s37 offen offset:2048 sc1 lds
buffer_load_dwordx4 v1, s[4:7], s37 offen offset:3072 sc1 lds
s_add_u32 s37, s53, 8192
s_add_u32 m0, s50, 8192
s_nop 0
buffer_load_dwordx4 v1, s[4:7], s37 offen offset:0 sc1 lds
buffer_load_dwordx4 v1, s[4:7], s37 offen offset:1024 sc1 lds
buffer_load_dwordx4 v1, s[4:7], s37 offen offset:2048 sc1 lds
buffer_load_dwordx4 v1, s[4:7], s37 offen offset:3072 sc1 lds
s_add_u32 s37, s53, 12288
s_add_u32 m0, s50, 12288
s_nop 0
buffer_load_dwordx4 v1, s[4:7], s37 offen offset:0 sc1 lds
buffer_load_dwordx4 v1, s[4:7], s37 offen offset:1024 sc1 lds
buffer_load_dwordx4 v1, s[4:7], s37 offen offset:2048 sc1 lds
buffer_load_dwordx4 v1, s[4:7], s37 offen offset:3072 sc1 lds
s_waitcnt lgkmcnt(0)
s_barrier
ds_read_b128 v[16:19], v14 offset:0
ds_read_b128 v[20:23], v14 offset:3072
ds_read_b128 v[24:27], v14 offset:6144
ds_read_b128 v[28:31], v14 offset:9216
s_waitcnt lgkmcnt(0)
v_pk_add_f32 v[16:17], v[16:17], v[20:21]
v_pk_add_f32 v[18:19], v[18:19], v[22:23]
v_pk_add_f32 v[24:25], v[24:25], v[28:29]
v_pk_add_f32 v[26:27], v[26:27], v[30:31]
v_pk_add_f32 v[16:17], v[16:17], v[24:25]
v_pk_add_f32 v[18:19], v[18:19], v[26:27]
v_cvt_pk_bf16_f32 v60, v16, v17
v_cvt_pk_bf16_f32 v61, v18, v19
v_xor_b32 v14, 16384, v14
buffer_store_dwordx2 v[60:61], v15, s[28:31], s59 offen
s_waitcnt vmcnt(22)
v_mfma_f32_16x16x32_bf16 v[28:31], v[68:71], v[40:43], 0
v_mfma_f32_16x16x32_bf16 v[32:35], v[72:75], v[40:43], 0
v_mfma_f32_16x16x32_bf16 v[36:39], v[76:79], v[40:43], 0
s_waitcnt vmcnt(21)
v_mfma_f32_16x16x32_bf16 v[28:31], v[80:83], v[44:47], v[28:31]
v_mfma_f32_16x16x32_bf16 v[32:35], v[84:87], v[44:47], v[32:35]
v_mfma_f32_16x16x32_bf16 v[36:39], v[88:91], v[44:47], v[36:39]
s_waitcnt vmcnt(20)
v_mfma_f32_16x16x32_bf16 v[28:31], v[92:95], v[48:51], v[28:31]
v_mfma_f32_16x16x32_bf16 v[32:35], v[96:99], v[48:51], v[32:35]
v_mfma_f32_16x16x32_bf16 v[36:39], v[100:103], v[48:51], v[36:39]
s_waitcnt vmcnt(19)
v_mfma_f32_16x16x32_bf16 v[28:31], v[104:107], v[52:55], v[28:31]
v_mfma_f32_16x16x32_bf16 v[32:35], v[108:111], v[52:55], v[32:35]
v_mfma_f32_16x16x32_bf16 v[36:39], v[112:115], v[52:55], v[36:39]
s_waitcnt vmcnt(18)
v_mfma_f32_16x16x32_bf16 v[28:31], v[116:119], v[56:59], v[28:31]
v_mfma_f32_16x16x32_bf16 v[32:35], v[120:123], v[56:59], v[32:35]
v_mfma_f32_16x16x32_bf16 v[36:39], v[124:127], v[56:59], v[36:39]
L_w_b:
s_waitcnt vmcnt(15)
ds_read_b128 v[40:43], v7 offset:0
s_waitcnt vmcnt(14)
ds_read_b128 v[44:47], v7 offset:1024
s_add_u32 s37, s53, 16384
s_add_u32 m0, s50, 16384
s_nop 0
buffer_load_dwordx4 v1, s[4:7], s37 offen offset:0 sc1 lds
s_waitcnt vmcnt(14)
ds_read_b128 v[48:51], v7 offset:2048
s_waitcnt lgkmcnt(2)
v_mfma_f32_16x16x32_bf16 v[16:19], v[128:131], v[40:43], 0
v_mfma_f32_16x16x32_bf16 v[20:23], v[132:135], v[40:43], 0
v_mfma_f32_16x16x32_bf16 v[24:27], v[136:139], v[40:43], 0
buffer_load_dwordx4 v1, s[4:7], s37 offen offset:1024 sc1 lds
s_waitcnt vmcnt(14)
ds_read_b128 v[52:55], v7 offset:3072
s_waitcnt lgkmcnt(2)
v_mfma_f32_16x16x32_bf16 v[16:19], v[140:143], v[44:47], v[16:19]
v_mfma_f32_16x16x32_bf16 v[20:23], v[144:147], v[44:47], v[20:23]
v_mfma_f32_16x16x32_bf16 v[24:27], v[148:151], v[44:47], v[24:27]
buffer_load_dwordx4 v1, s[4:7], s37 offen offset:2048 sc1 lds
s_waitcnt vmcnt(14)
ds_read_b128 v[40:43], v7 offset:4096
s_waitcnt lgkmcnt(2)
v_mfma_f32_16x16x32_bf16 v[16:19], v[152:155], v[48:51], v[16:19]
v_mfma_f32_16x16x32_bf16 v[20:23], v[156:159], v[48:51], v[20:23]
v_mfma_f32_16x16x32_bf16 v[24:27], v[160:163], v[48:51], v[24:27]
buffer_load_dwordx4 v1, s[4:7], s37 offen offset:3072 sc1 lds
s_waitcnt vmcnt(14)
ds_read_b128 v[44:47], v7 offset:5120
s_waitcnt lgkmcnt(2)
v_mfma_f32_16x16x32_bf16 v[16:19], v[164:167], v[52:55], v[16:19]
v_mfma_f32_16x16x32_bf16 v[20:23], v[168:171], v[52:55], v[20:23]
v_mfma_f32_16x16x32_bf16 v[24:27], v[172:175], v[52:55], v[24:27]
s_add_u32 s37, s53, 20480
s_add_u32 m0, s50, 20480
s_nop 0
buffer_load_dwordx4 v1, s[4:7], s37 offen offset:0 sc1 lds
s_waitcnt vmcnt(14)
ds_read_b128 v[48:51], v7 offset:6144
s_waitcnt lgkmcnt(2)
v_mfma_f32_16x16x32_bf16 v[16:19], v[176:179], v[40:43], v[16:19]
v_mfma_f32_16x16x32_bf16 v[20:23], v[180:183], v[40:43], v[20:23]
v_mfma_f32_16x16x32_bf16 v[24:27], v[184:187], v[40:43], v[24:27]
buffer_load_dwordx4 v1, s[4:7], s37 offen offset:1024 sc1 lds
s_waitcnt vmcnt(14)
ds_read_b128 v[52:55], v7 offset:7168
s_waitcnt lgkmcnt(2)
v_mfma_f32_16x16x32_bf16 v[16:19], v[188:191], v[44:47], v[16:19]
v_mfma_f32_16x16x32_bf16 v[20:23], v[192:195], v[44:47], v[20:23]
v_mfma_f32_16x16x32_bf16 v[24:27], v[196:199], v[44:47], v[24:27]
buffer_load_dwordx4 v1, s[4:7], s37 offen offset:2048 sc1 lds
s_waitcnt vmcnt(14)
ds_read_b128 v[40:43], v7 offset:8192
s_waitcnt lgkmcnt(2)
v_mfma_f32_16x16x32_bf16 v[16:19], v[200:203], v[48:51], v[16:19]
v_mfma_f32_16x16x32_bf16 v[20:23], v[204:207], v[48:51], v[20:23]
v_mfma_f32_16x16x32_bf16 v[24:27], v[208:211], v[48:51], v[24:27]
buffer_load_dwordx4 v1, s[4:7], s37 offen offset:3072 sc1 lds
s_waitcnt vmcnt(14)
ds_read_b128 v[44:47], v7 offset:9216
s_waitcnt lgkmcnt(2)
v_mfma_f32_16x16x32_bf16 v[16:19], v[212:215], v[52:55], v[16:19]
v_mfma_f32_16x16x32_bf16 v[20:23], v[216:219], v[52:55], v[20:23]
v_mfma_f32_16x16x32_bf16 v[24:27], v[220:223], v[52:55], v[24:27]
s_add_u32 s37, s53, 24576
s_add_u32 m0, s50, 24576
s_nop 0
buffer_load_dwordx4 v1, s[4:7], s37 offen offset:0 sc1 lds
s_waitcnt vmcnt(14)
ds_read_b128 v[48:51], v7 offset:10240
s_waitcnt lgkmcnt(2)
v_mfma_f32_16x16x32_bf16 v[16:19], v[224:227], v[40:43], v[16:19]
v_mfma_f32_16x16x32_bf16 v[20:23], v[228:231], v[40:43], v[20:23]
v_mfma_f32_16x16x32_bf16 v[24:27], v[232:235], v[40:43], v[24:27]
buffer_load_dwordx4 v1, s[4:7], s37 offen offset:1024 sc1 lds
s_waitcnt vmcnt(14)
ds_read_b128 v[52:55], v7 offset:11264
s_waitcnt lgkmcnt(2)
v_mfma_f32_16x16x32_bf16 v[16:19], v[236:239], v[44:47], v[16:19]
v_mfma_f32_16x16x32_bf16 v[20:23], v[240:243], v[44:47], v[20:23]
v_mfma_f32_16x16x32_bf16 v[24:27], v[244:247], v[44:47], v[24:27]
buffer_load_dwordx4 v1, s[4:7], s37 offen offset:2048 sc1 lds
s_waitcnt vmcnt(14)
ds_read_b128 v[40:43], v7 offset:12288
s_waitcnt lgkmcnt(2)
v_mfma_f32_16x16x32_bf16 v[16:19], v[248:251], v[48:51], v[16:19]
v_mfma_f32_16x16x32_bf16 v[20:23], v[252:255], v[48:51], v[20:23]
v_mfma_f32_16x16x32_bf16 v[24:27], a[0:3], v[48:51], v[24:27]
buffer_load_dwordx4 v1, s[4:7], s37 offen offset:3072 sc1 lds
s_waitcnt vmcnt(14)
ds_read_b128 v[44:47], v7 offset:13312
s_waitcnt lgkmcnt(2)
v_mfma_f32_16x16x32_bf16 v[16:19], a[4:7], v[52:55], v[16:19]
v_mfma_f32_16x16x32_bf16 v[20:23], a[8:11], v[52:55], v[20:23]
v_mfma_f32_16x16x32_bf16 v[24:27], a[12:15], v[52:55], v[24:27]
s_add_u32 s37, s53, 28672
s_add_u32 m0, s50, 28672
s_nop 0
buffer_load_dwordx4 v1, s[4:7], s37 offen offset:0 sc1 lds
s_waitcnt vmcnt(14)
ds_read_b128 v[48:51], v7 offset:14336
s_waitcnt lgkmcnt(2)
v_mfma_f32_16x16x32_bf16 v[16:19], a[16:19], v[40:43], v[16:19]
v_mfma_f32_16x16x32_bf16 v[20:23], a[20:23], v[40:43], v[20:23]
v_mfma_f32_16x16x32_bf16 v[24:27], a[24:27], v[40:43], v[24:27]
buffer_load_dwordx4 v1, s[4:7], s37 offen offset:1024 sc1 lds
s_waitcnt vmcnt(14)
ds_read_b128 v[52:55], v7 offset:15360
s_waitcnt lgkmcnt(2)
v_mfma_f32_16x16x32_bf16 v[16:19], a[28:31], v[44:47], v[16:19]
v_mfma_f32_16x16x32_bf16 v[20:23], a[32:35], v[44:47], v[20:23]
v_mfma_f32_16x16x32_bf16 v[24:27], a[36:39], v[44:47], v[24:27]
buffer_load_dwordx4 v1, s[4:7], s37 offen offset:2048 sc1 lds
s_waitcnt vmcnt(14)
ds_read_b128 v[40:43], v7 offset:16384
s_waitcnt lgkmcnt(2)
v_mfma_f32_16x16x32_bf16 v[16:19], a[40:43], v[48:51], v[16:19]
v_mfma_f32_16x16x32_bf16 v[20:23], a[44:47], v[48:51], v[20:23]
v_mfma_f32_16x16x32_bf16 v[24:27], a[48:51], v[48:51], v[24:27]
buffer_load_dwordx4 v1, s[4:7], s37 offen offset:3072 sc1 lds
s_add_u32 s38, s48, 5
s_and_b32 s57, s38, 7
s_lshl_b32 s57, s57, 10
s_add_u32 s57, s57, 331776
s_lshr_b32 s35, s38, 3
buffer_load_dword v3, v9, s[4:7], s57 offen sc0 sc1
s_waitcnt vmcnt(15)
ds_read_b128 v[44:47], v7 offset:17408
s_waitcnt lgkmcnt(2)
v_mfma_f32_16x16x32_bf16 v[16:19], a[52:55], v[52:55], v[16:19]
v_mfma_f32_16x16x32_bf16 v[20:23], a[56:59], v[52:55], v[20:23]
v_mfma_f32_16x16x32_bf16 v[24:27], a[60:63], v[52:55], v[24:27]
s_waitcnt vmcnt(14)
ds_read_b128 v[48:51], v7 offset:18432
s_waitcnt lgkmcnt(2)
v_mfma_f32_16x16x32_bf16 v[16:19], a[64:67], v[40:43], v[16:19]
v_mfma_f32_16x16x32_bf16 v[20:23], a[68:71], v[40:43], v[20:23]
v_mfma_f32_16x16x32_bf16 v[24:27], a[72:75], v[40:43], v[24:27]
s_waitcnt vmcnt(13)
ds_read_b128 v[52:55], v7 offset:19456
s_waitcnt lgkmcnt(2)
v_mfma_f32_16x16x32_bf16 v[16:19], a[76:79], v[44:47], v[16:19]
v_mfma_f32_16x16x32_bf16 v[20:23], a[80:83], v[44:47], v[20:23]
v_mfma_f32_16x16x32_bf16 v[24:27], a[84:87], v[44:47], v[24:27]
s_waitcnt vmcnt(12)
ds_read_b128 v[40:43], v7 offset:20480
s_waitcnt lgkmcnt(2)
v_mfma_f32_16x16x32_bf16 v[16:19], a[88:91], v[48:51], v[16:19]
v_mfma_f32_16x16x32_bf16 v[20:23], a[92:95], v[48:51], v[20:23]
v_mfma_f32_16x16x32_bf16 v[24:27], a[96:99], v[48:51], v[24:27]
s_waitcnt vmcnt(11)
ds_read_b128 v[44:47], v7 offset:21504
s_waitcnt lgkmcnt(2)
v_mfma_f32_16x16x32_bf16 v[16:19], a[100:103], v[52:55], v[16:19]
v_mfma_f32_16x16x32_bf16 v[20:23], a[104:107], v[52:55], v[20:23]
v_mfma_f32_16x16x32_bf16 v[24:27], a[108:111], v[52:55], v[24:27]
s_waitcnt vmcnt(10)
ds_read_b128 v[48:51], v7 offset:22528
s_waitcnt lgkmcnt(2)
v_mfma_f32_16x16x32_bf16 v[16:19], a[112:115], v[40:43], v[16:19]
v_mfma_f32_16x16x32_bf16 v[20:23], a[116:119], v[40:43], v[20:23]
v_mfma_f32_16x16x32_bf16 v[24:27], a[120:123], v[40:43], v[24:27]
s_waitcnt vmcnt(9)
ds_read_b128 v[52:55], v7 offset:23552
s_waitcnt lgkmcnt(2)
v_mfma_f32_16x16x32_bf16 v[16:19], a[124:127], v[44:47], v[16:19]
v_mfma_f32_16x16x32_bf16 v[20:23], a[128:131], v[44:47], v[20:23]
v_mfma_f32_16x16x32_bf16 v[24:27], a[132:135], v[44:47], v[24:27]
s_waitcnt vmcnt(8)
ds_read_b128 v[40:43], v7 offset:24576
s_waitcnt lgkmcnt(2)
v_mfma_f32_16x16x32_bf16 v[16:19], a[136:139], v[48:51], v[16:19]
v_mfma_f32_16x16x32_bf16 v[20:23], a[140:143], v[48:51], v[20:23]
v_mfma_f32_16x16x32_bf16 v[24:27], a[144:147], v[48:51], v[24:27]
s_waitcnt vmcnt(7)
ds_read_b128 v[44:47], v7 offset:25600
s_waitcnt lgkmcnt(2)
v_mfma_f32_16x16x32_bf16 v[16:19], a[148:151], v[52:55], v[16:19]
v_mfma_f32_16x16x32_bf16 v[20:23], a[152:155], v[52:55], v[20:23]
v_mfma_f32_16x16x32_bf16 v[24:27], a[156:159], v[52:55], v[24:27]
s_waitcnt vmcnt(6)
ds_read_b128 v[48:51], v7 offset:26624
s_waitcnt lgkmcnt(2)
v_mfma_f32_16x16x32_bf16 v[16:19], a[160:163], v[40:43], v[16:19]
v_mfma_f32_16x16x32_bf16 v[20:23], a[164:167], v[40:43], v[20:23]
v_mfma_f32_16x16x32_bf16 v[24:27], a[168:171], v[40:43], v[24:27]
s_waitcnt vmcnt(5)
ds_read_b128 v[52:55], v7 offset:27648
s_waitcnt lgkmcnt(2)
v_mfma_f32_16x16x32_bf16 v[16:19], a[172:175], v[44:47], v[16:19]
v_mfma_f32_16x16x32_bf16 v[20:23], a[176:179], v[44:47], v[20:23]
v_mfma_f32_16x16x32_bf16 v[24:27], a[180:183], v[44:47], v[24:27]
s_waitcnt vmcnt(4)
ds_read_b128 v[40:43], v7 offset:28672
s_waitcnt lgkmcnt(2)
v_mfma_f32_16x16x32_bf16 v[16:19], a[184:187], v[48:51], v[16:19]
v_mfma_f32_16x16x32_bf16 v[20:23], a[188:191], v[48:51], v[20:23]
v_mfma_f32_16x16x32_bf16 v[24:27], a[192:195], v[48:51], v[24:27]
s_waitcnt vmcnt(3)
ds_read_b128 v[44:47], v7 offset:29696
s_waitcnt lgkmcnt(2)
v_mfma_f32_16x16x32_bf16 v[16:19], a[196:199], v[52:55], v[16:19]
v_mfma_f32_16x16x32_bf16 v[20:23], a[200:203], v[52:55], v[20:23]
v_mfma_f32_16x16x32_bf16 v[24:27], a[204:207], v[52:55], v[24:27]
s_waitcnt vmcnt(2)
ds_read_b128 v[48:51], v7 offset:30720
s_waitcnt lgkmcnt(2)
v_mfma_f32_16x16x32_bf16 v[16:19], a[208:211], v[40:43], v[16:19]
v_mfma_f32_16x16x32_bf16 v[20:23], a[212:215], v[40:43], v[20:23]
v_mfma_f32_16x16x32_bf16 v[24:27], a[216:219], v[40:43], v[24:27]
s_waitcnt vmcnt(1)
ds_read_b128 v[52:55], v7 offset:31744
s_waitcnt lgkmcnt(2)
v_mfma_f32_16x16x32_bf16 v[16:19], a[220:223], v[44:47], v[16:19]
v_mfma_f32_16x16x32_bf16 v[20:23], a[224:227], v[44:47], v[20:23]
v_mfma_f32_16x16x32_bf16 v[24:27], a[228:231], v[44:47], v[24:27]
s_waitcnt lgkmcnt(1)
v_mfma_f32_16x16x32_bf16 v[16:19], a[232:235], v[48:51], v[16:19]
v_mfma_f32_16x16x32_bf16 v[20:23], a[236:239], v[48:51], v[20:23]
v_mfma_f32_16x16x32_bf16 v[24:27], a[240:243], v[48:51], v[24:27]
s_waitcnt lgkmcnt(0)
v_mfma_f32_16x16x32_bf16 v[16:19], a[244:247], v[52:55], v[16:19]
v_mfma_f32_16x16x32_bf16 v[20:23], a[248:251], v[52:55], v[20:23]
v_mfma_f32_16x16x32_bf16 v[24:27], a[252:255], v[52:55], v[24:27]
s_mov_b32 s59, s55
s_add_u32 s55, s55, 92160
s_add_u32 s54, s54, 92160
s_add_u32 s53, s53, 655360
s_add_u32 s56, s56, 320
s_add_u32 s48, s48, 5
v_fma_f32 v16, v16, v4, v28
v_fma_f32 v17, v17, v4, v29
v_fma_f32 v18, v18, v4, v30
v_fma_f32 v19, v19, v4, v31
ds_write_b128 v2, v[16:19] offset:0
v_fma_f32 v20, v20, v4, v32
v_fma_f32 v21, v21, v4, v33
v_fma_f32 v22, v22, v4, v34
v_fma_f32 v23, v23, v4, v35
ds_write_b128 v2, v[20:23] offset:1024
v_fma_f32 v24, v24, v4, v36
v_fma_f32 v25, v25, v4, v37
v_fma_f32 v26, v26, v4, v38
v_fma_f32 v27, v27, v4, v39
ds_write_b128 v2, v[24:27] offset:2048
v_xor_b32 v2, 16384, v2
s_cmp_ge_u32 s48, 128
s_cbranch_scc1 L_w_now
s_waitcnt vmcnt(0)
v_cmp_ge_u32 vcc, s35, v3
s_cbranch_vccz L_w_ready
L_w_now:
s_waitcnt lgkmcnt(0)
s_barrier
ds_read_b128 v[16:19], v14 offset:0
ds_read_b128 v[20:23], v14 offset:3072
ds_read_b128 v[24:27], v14 offset:6144
ds_read_b128 v[28:31], v14 offset:9216
s_waitcnt lgkmcnt(0)
v_pk_add_f32 v[16:17], v[16:17], v[20:21]
v_pk_add_f32 v[18:19], v[18:19], v[22:23]
v_pk_add_f32 v[24:25], v[24:25], v[28:29]
v_pk_add_f32 v[26:27], v[26:27], v[30:31]
v_pk_add_f32 v[16:17], v[16:17], v[24:25]
v_pk_add_f32 v[18:19], v[18:19], v[26:27]
v_cvt_pk_bf16_f32 v60, v16, v17
v_cvt_pk_bf16_f32 v61, v18, v19
v_xor_b32 v14, 16384, v14
buffer_store_dwordx2 v[60:61], v15, s[28:31], s59 offen
s_cmp_lt_u32 s48, 128
s_cbranch_scc1 L_w_wait
s_waitcnt vmcnt(0)
s_endpgm
L_pro_w0:
v_and_b32 v20, 63, v0
v_lshlrev_b32 v1, 4, v20
v_add_u32 v2, 16384, v1
v_and_b32 v23, 1, v22
v_lshl_add_u32 v23, v24, 4, v23
v_mul_u32_u24 v23, 1152, v23
v_lshlrev_b32 v28, 2, v22
v_xor_b32 v28, v28, v21
v_lshl_add_u32 v28, v28, 4, v23
s_mul_i32 s55, s32, 147456
v_lshrrev_b32 v23, 2, v21
v_and_b32 v24, 1, v21
v_lshl_add_u32 v23, v23, 1, v24
v_mul_u32_u24 v23, 1152, v23
v_lshl_add_u32 v23, v22, 5, v23
v_bfe_u32 v24, v21, 1, 1
v_lshl_add_u32 v23, v24, 4, v23
s_lshl_b32 s56, s32, 7
s_waitcnt lgkmcnt(0)
buffer_load_dwordx4 v[12:15], v23, s[24:27], s56 offen
v_and_b32 v23, 1, v22
v_lshrrev_b32 v24, 2, v21
v_lshl_add_u32 v23, v23, 2, v24
v_lshlrev_b32 v23, 1, v23
v_bfe_u32 v44, v21, 1, 1
v_add_u32 v44, 0, v44
v_xor_b32 v44, v44, v23
v_lshlrev_b32 v44, 4, v44
v_lshl_add_u32 v44, v24, 8, v44
v_and_b32 v23, 1, v22
v_lshl_add_u32 v44, v23, 11, v44
v_and_b32 v23, 1, v21
v_lshl_add_u32 v44, v23, 3, v44
v_lshrrev_b32 v23, 1, v22
v_mul_u32_u24 v23, 40960, v23
v_add_u32 v23, 16384, v23
v_add_u32 v44, v44, v23
v_and_b32 v23, 1, v22
v_lshrrev_b32 v24, 2, v21
v_lshl_add_u32 v23, v23, 2, v24
v_lshlrev_b32 v23, 1, v23
v_bfe_u32 v45, v21, 1, 1
v_add_u32 v45, 2, v45
v_xor_b32 v45, v45, v23
v_lshlrev_b32 v45, 4, v45
v_lshl_add_u32 v45, v24, 8, v45
v_and_b32 v23, 1, v22
v_lshl_add_u32 v45, v23, 11, v45
v_and_b32 v23, 1, v21
v_lshl_add_u32 v45, v23, 3, v45
v_lshrrev_b32 v23, 1, v22
v_mul_u32_u24 v23, 40960, v23
v_add_u32 v23, 16384, v23
v_add_u32 v45, v45, v23
v_and_b32 v23, 1, v22
v_lshrrev_b32 v24, 2, v21
v_lshl_add_u32 v23, v23, 2, v24
v_lshlrev_b32 v23, 1, v23
v_bfe_u32 v46, v21, 1, 1
v_add_u32 v46, 0, v46
v_xor_b32 v46, v46, v23
v_lshlrev_b32 v46, 4, v46
v_lshl_add_u32 v46, v24, 8, v46
v_and_b32 v23, 1, v22
v_lshl_add_u32 v46, v23, 11, v46
v_and_b32 v23, 1, v21
v_lshl_add_u32 v46, v23, 3, v46
v_lshrrev_b32 v23, 1, v22
v_mul_u32_u24 v23, 32768, v23
v_add_u32 v23, 98304, v23
v_add_u32 v46, v46, v23
v_and_b32 v23, 1, v22
v_lshrrev_b32 v24, 2, v21
v_lshl_add_u32 v23, v23, 2, v24
v_lshlrev_b32 v23, 1, v23
v_bfe_u32 v47, v21, 1, 1
v_add_u32 v47, 2, v47
v_xor_b32 v47, v47, v23
v_lshlrev_b32 v47, 4, v47
v_lshl_add_u32 v47, v24, 8, v47
v_and_b32 v23, 1, v22
v_lshl_add_u32 v47, v23, 11, v47
v_and_b32 v23, 1, v21
v_lshl_add_u32 v47, v23, 3, v47
v_lshrrev_b32 v23, 1, v22
v_mul_u32_u24 v23, 32768, v23
v_add_u32 v23, 98304, v23
v_add_u32 v47, v47, v23
v_and_b32 v23, 1, v22
v_bfe_u32 v24, v21, 2, 1
v_lshl_add_u32 v23, v23, 1, v24
v_xor_b32 v24, 0, v23
v_lshlrev_b32 v24, 6, v24
v_lshl_add_u32 v48, v23, 8, v24
v_and_b32 v23, 3, v21
v_lshl_add_u32 v48, v23, 4, v48
v_and_b32 v23, 8, v21
v_add_u32 v48, v48, v23
v_lshrrev_b32 v23, 1, v22
v_mul_u32_u24 v23, 40960, v23
v_add_u32 v23, 16384, v23
v_add_u32 v48, v48, v23
v_and_b32 v23, 1, v22
v_bfe_u32 v24, v21, 2, 1
v_lshl_add_u32 v23, v23, 1, v24
v_xor_b32 v24, 0, v23
v_lshlrev_b32 v24, 6, v24
v_lshl_add_u32 v49, v23, 8, v24
v_and_b32 v23, 3, v21
v_lshl_add_u32 v49, v23, 4, v49
v_and_b32 v23, 8, v21
v_add_u32 v49, v49, v23
v_lshrrev_b32 v23, 1, v22
v_mul_u32_u24 v23, 32768, v23
v_add_u32 v23, 98304, v23
v_add_u32 v49, v49, v23
v_bfe_u32 v23, v21, 1, 1
v_mul_u32_u24 v23, 0xaaaa, v23
v_add_u32 v0, 0x4444, v23
v_lshlrev_b32 v3, 3, v20
v_lshrrev_b32 v25, 5, v20
v_lshlrev_b32 v25, 6, v25
v_xor_b32 v3, v3, v25
v_lshrrev_b32 v25, 2, v20
v_and_b32 v4, 3, v21
v_lshl_add_u32 v4, v4, 4, v25
v_lshlrev_b32 v4, 3, v4
v_bfe_u32 v25, v21, 1, 1
v_lshlrev_b32 v23, 6, v25
v_xor_b32 v4, v4, v23
v_lshlrev_b32 v5, 4, v21
v_lshl_add_u32 v5, v22, 2, v5
v_mul_u32_u24 v23, 1024, v25
v_add_u32 v5, v5, v23
v_lshlrev_b32 v9, 8, v22
v_lshl_add_u32 v9, v25, 6, v9
v_bfe_u32 v23, v21, 3, 1
v_lshl_add_u32 v9, v23, 7, v9
v_bfe_u32 v23, v21, 2, 1
v_lshl_add_u32 v9, v23, 5, v9
v_and_b32 v23, 1, v21
v_lshl_add_u32 v9, v23, 4, v9
v_lshrrev_b32 v23, 1, v22
v_and_b32 v24, 1, v22
v_and_b32 v25, 7, v21
v_lshrrev_b32 v7, 3, v21
v_lshl_add_u32 v8, v7, 1, v23
v_lshlrev_b32 v8, 12, v8
v_lshl_add_u32 v8, v24, 7, v8
v_and_b32 v25, 4, v21
v_lshl_add_u32 v8, v25, 3, v8
v_and_b32 v25, 1, v21
v_lshl_add_u32 v8, v25, 4, v8
v_bfe_u32 v25, v21, 1, 1
v_lshl_add_u32 v8, v25, 3, v8
s_lshr_b32 s56, s32, 1
s_lshl_b32 s56, s56, 8
s_and_b32 s57, s32, 1
s_lshl_b32 s57, s57, 6
s_add_u32 s56, s56, s57
s_add_u32 s56, s56, 0
v_add_u32 v8, s56, v8
v_and_b32 v7, 0x3d0, v1
s_mov_b32 s42, 0
s_mov_b32 s43, 65536
s_mov_b32 s44, 131072
s_mov_b32 s45, 196608
s_mov_b32 s46, 262144
s_mov_b32 s47, 294912
s_mov_b32 s48, 299008
s_mov_b32 s49, 303104
s_mov_b32 s50, 0x3e0293ee
s_mov_b32 s51, 0x3e0293ee
s_mov_b32 s52, 0x3f803f80
s_mov_b32 s53, 0x3f803f80
v_lshlrev_b32 v11, 2, v21
s_mov_b32 s34, 0
s_mov_b32 s35, -1
s_mov_b32 s36, 0
s_mov_b32 s41, 300000
s_lshl_b32 s37, s32, 14
s_add_u32 s39, s37, 17301504
s_add_u32 s37, s37, 16777216
s_mov_b32 s40, 8749056
v_mov_b64 v[36:37], 0
v_mov_b64 v[38:39], 0
ds_write_b128 v1, v[36:39] offset:14336
s_lshl_b32 s56, s32, 1
s_add_u32 s56, s56, 0
s_cmp_eq_u32 s56, 0
s_cselect_b32 s56, 64, s56
s_mul_i32 s56, s56, 10240
s_add_u32 s56, s56, 8388608
s_add_u32 s57, s56, 4096
v_mov_b32 v40, 0
v_mov_b32 v41, 0
v_mov_b32 v42, 0
v_mov_b32 v43, 0
buffer_store_dwordx4 v[40:43], v1, s[4:7], s56 offen offset:0 sc0 sc1
buffer_store_dwordx4 v[40:43], v1, s[4:7], s56 offen offset:1024 sc0 sc1
buffer_store_dwordx4 v[40:43], v1, s[4:7], s56 offen offset:2048 sc0 sc1
buffer_store_dwordx4 v[40:43], v1, s[4:7], s56 offen offset:3072 sc0 sc1
s_lshl_b32 s56, s32, 10
s_cmp_ge_u32 s32, 9
s_cselect_b32 s56, 268435456, s56
s_add_u32 s57, s56, 8388608
s_add_u32 s56, s56, 294912
s_waitcnt vmcnt(4)
v_or_b32 v12, 1, v12
buffer_store_dwordx4 v[12:15], v1, s[4:7], s56 offen sc0 sc1
buffer_store_dwordx4 v[12:15], v1, s[4:7], s57 offen sc0 sc1
s_getreg_b32 s56, hwreg(HW_REG_XCC_ID)
s_and_b32 s56, s56, 15
s_mul_i32 s57, s56, s56
s_lshl_b32 s57, s57, 18
s_lshl_b32 s56, s56, 8
s_add_u32 s57, s57, s56
s_add_u32 s58, s57, 1
s_lshl_b32 s101, s32, 7
s_add_u32 s101, s101, 327680
v_mov_b32 v24, 0
s_add_u32 s56, s54, 0
s_mov_b32 m0, 28672
s_nop 0
buffer_load_dwordx4 v26, s[12:15], s56 offen lds
s_add_u32 s56, s54, 16384
s_mov_b32 m0, 29696
s_nop 0
buffer_load_dwordx4 v26, s[12:15], s56 offen lds
s_add_u32 s56, s54, 32768
s_mov_b32 m0, 30720
s_nop 0
buffer_load_dwordx4 v27, s[12:15], s56 offen lds
s_add_u32 s56, s54, 49152
s_mov_b32 m0, 31744
s_nop 0
buffer_load_dwordx4 v27, s[12:15], s56 offen lds
s_add_u32 s56, s54, 524288
s_mov_b32 m0, 32768
s_nop 0
buffer_load_dwordx4 v26, s[12:15], s56 offen lds
s_add_u32 s56, s54, 540672
s_mov_b32 m0, 33792
s_nop 0
buffer_load_dwordx4 v26, s[12:15], s56 offen lds
s_add_u32 s56, s54, 557056
s_mov_b32 m0, 34816
s_nop 0
buffer_load_dwordx4 v27, s[12:15], s56 offen lds
s_add_u32 s56, s54, 573440
s_mov_b32 m0, 35840
s_nop 0
buffer_load_dwordx4 v27, s[12:15], s56 offen lds
v_and_b32 v23, 3, v20
v_lshrrev_b32 v24, 2, v20
v_mul_u32_u24 v29, 1152, v24
v_lshl_add_u32 v29, v23, 4, v29
v_lshrrev_b32 v24, 2, v21
v_and_b32 v25, 1, v22
v_lshlrev_b32 v31, 10, v25
v_lshrrev_b32 v25, 1, v22
v_lshl_add_u32 v31, v25, 8, v31
v_and_b32 v25, 1, v24
v_lshl_add_u32 v31, v25, 6, v31
v_lshrrev_b32 v25, 1, v24
v_lshl_add_u32 v31, v25, 3, v31
v_lshl_add_u32 v31, v23, 4, v31
v_add_u32 v31, 16384, v31
s_add_u32 s56, s55, 1024
s_mov_b32 m0, 49152
s_nop 0
buffer_load_dwordx4 v29, s[20:23], s56 offen lds
s_add_u32 s56, s55, 19456
s_mov_b32 m0, 50176
s_nop 0
buffer_load_dwordx4 v29, s[20:23], s56 offen lds
s_add_u32 s56, s55, 37888
s_mov_b32 m0, 51200
s_nop 0
buffer_load_dwordx4 v29, s[20:23], s56 offen lds
s_add_u32 s56, s55, 56320
s_mov_b32 m0, 52224
s_nop 0
buffer_load_dwordx4 v29, s[20:23], s56 offen lds
s_add_u32 s56, s55, 74752
s_mov_b32 m0, 53248
s_nop 0
buffer_load_dwordx4 v29, s[20:23], s56 offen lds
s_add_u32 s56, s55, 93184
s_mov_b32 m0, 54272
s_nop 0
buffer_load_dwordx4 v29, s[20:23], s56 offen lds
s_add_u32 s56, s55, 111616
s_mov_b32 m0, 55296
s_nop 0
buffer_load_dwordx4 v29, s[20:23], s56 offen lds
s_add_u32 s56, s55, 130048
s_mov_b32 m0, 56320
s_nop 0
buffer_load_dwordx4 v29, s[20:23], s56 offen lds
v_mov_b32 v24, 0
s_barrier
ds_read_b64_tr_b16 v[80:81], v44 offset:20480
ds_read_b64_tr_b16 v[82:83], v44 offset:21504
ds_read_b64_tr_b16 v[84:85], v46 offset:20480
ds_read_b64_tr_b16 v[86:87], v46 offset:21504
ds_read_b64_tr_b16 v[88:89], v45 offset:20480
ds_read_b64_tr_b16 v[90:91], v45 offset:21504
ds_read_b64_tr_b16 v[92:93], v47 offset:20480
ds_read_b64_tr_b16 v[94:95], v47 offset:21504
s_waitcnt lgkmcnt(0)
s_barrier
s_add_u32 s56, s54, 1048576
s_mov_b32 m0, 36864
s_nop 0
buffer_load_dwordx4 v26, s[12:15], s56 offen lds
s_add_u32 s56, s54, 1064960
s_mov_b32 m0, 37888
s_nop 0
buffer_load_dwordx4 v26, s[12:15], s56 offen lds
s_add_u32 s56, s54, 1081344
s_mov_b32 m0, 38912
s_nop 0
buffer_load_dwordx4 v27, s[12:15], s56 offen lds
s_add_u32 s56, s54, 1097728
s_mov_b32 m0, 39936
s_nop 0
buffer_load_dwordx4 v27, s[12:15], s56 offen lds
ds_read_b64_tr_b16 v[96:97], v44 offset:24576
ds_read_b64_tr_b16 v[98:99], v44 offset:25600
ds_read_b64_tr_b16 v[100:101], v46 offset:24576
ds_read_b64_tr_b16 v[102:103], v46 offset:25600
ds_read_b64_tr_b16 v[104:105], v45 offset:24576
ds_read_b64_tr_b16 v[106:107], v45 offset:25600
ds_read_b64_tr_b16 v[108:109], v47 offset:24576
ds_read_b64_tr_b16 v[110:111], v47 offset:25600
s_waitcnt lgkmcnt(0)
s_barrier
s_add_u32 s56, s54, 1572864
s_mov_b32 m0, 40960
s_nop 0
buffer_load_dwordx4 v26, s[12:15], s56 offen lds
s_add_u32 s56, s54, 1589248
s_mov_b32 m0, 41984
s_nop 0
buffer_load_dwordx4 v26, s[12:15], s56 offen lds
s_add_u32 s56, s54, 1605632
s_mov_b32 m0, 43008
s_nop 0
buffer_load_dwordx4 v27, s[12:15], s56 offen lds
s_add_u32 s56, s54, 1622016
s_mov_b32 m0, 44032
s_nop 0
buffer_load_dwordx4 v27, s[12:15], s56 offen lds
ds_read_b64_tr_b16 v[112:113], v44 offset:28672
ds_read_b64_tr_b16 v[114:115], v44 offset:29696
ds_read_b64_tr_b16 v[116:117], v46 offset:28672
ds_read_b64_tr_b16 v[118:119], v46 offset:29696
ds_read_b64_tr_b16 v[120:121], v45 offset:28672
ds_read_b64_tr_b16 v[122:123], v45 offset:29696
ds_read_b64_tr_b16 v[124:125], v47 offset:28672
ds_read_b64_tr_b16 v[126:127], v47 offset:29696
s_waitcnt lgkmcnt(0)
s_barrier
s_add_u32 s56, s54, 2097152
s_mov_b32 m0, 45056
s_nop 0
buffer_load_dwordx4 v26, s[12:15], s56 offen lds
s_add_u32 s56, s54, 2113536
s_mov_b32 m0, 46080
s_nop 0
buffer_load_dwordx4 v26, s[12:15], s56 offen lds
s_add_u32 s56, s54, 2129920
s_mov_b32 m0, 47104
s_nop 0
buffer_load_dwordx4 v27, s[12:15], s56 offen lds
s_add_u32 s56, s54, 2146304
s_mov_b32 m0, 48128
s_nop 0
buffer_load_dwordx4 v27, s[12:15], s56 offen lds
ds_read_b64_tr_b16 v[128:129], v44 offset:0
ds_read_b64_tr_b16 v[130:131], v44 offset:1024
ds_read_b64_tr_b16 v[132:133], v46 offset:0
ds_read_b64_tr_b16 v[134:135], v46 offset:1024
ds_read_b64_tr_b16 v[136:137], v45 offset:0
ds_read_b64_tr_b16 v[138:139], v45 offset:1024
ds_read_b64_tr_b16 v[140:141], v47 offset:0
ds_read_b64_tr_b16 v[142:143], v47 offset:1024
s_waitcnt lgkmcnt(0)
s_barrier
s_add_u32 s56, s54, 3145728
s_mov_b32 m0, 16384
s_nop 0
buffer_load_dwordx4 v26, s[12:15], s56 offen lds
s_add_u32 s56, s54, 3162112
s_mov_b32 m0, 17408
s_nop 0
buffer_load_dwordx4 v26, s[12:15], s56 offen lds
s_add_u32 s56, s54, 3178496
s_mov_b32 m0, 18432
s_nop 0
buffer_load_dwordx4 v27, s[12:15], s56 offen lds
s_add_u32 s56, s54, 3194880
s_mov_b32 m0, 19456
s_nop 0
buffer_load_dwordx4 v27, s[12:15], s56 offen lds
ds_read_b64_tr_b16 v[144:145], v44 offset:4096
ds_read_b64_tr_b16 v[146:147], v44 offset:5120
ds_read_b64_tr_b16 v[148:149], v46 offset:4096
ds_read_b64_tr_b16 v[150:151], v46 offset:5120
ds_read_b64_tr_b16 v[152:153], v45 offset:4096
ds_read_b64_tr_b16 v[154:155], v45 offset:5120
ds_read_b64_tr_b16 v[156:157], v47 offset:4096
ds_read_b64_tr_b16 v[158:159], v47 offset:5120
s_waitcnt lgkmcnt(0)
s_barrier
s_add_u32 s56, s54, 3670016
s_mov_b32 m0, 20480
s_nop 0
buffer_load_dwordx4 v26, s[12:15], s56 offen lds
s_add_u32 s56, s54, 3686400
s_mov_b32 m0, 21504
s_nop 0
buffer_load_dwordx4 v26, s[12:15], s56 offen lds
s_add_u32 s56, s54, 3702784
s_mov_b32 m0, 22528
s_nop 0
buffer_load_dwordx4 v27, s[12:15], s56 offen lds
s_add_u32 s56, s54, 3719168
s_mov_b32 m0, 23552
s_nop 0
buffer_load_dwordx4 v27, s[12:15], s56 offen lds
ds_read_b64_tr_b16 v[160:161], v44 offset:8192
ds_read_b64_tr_b16 v[162:163], v44 offset:9216
ds_read_b64_tr_b16 v[164:165], v46 offset:8192
ds_read_b64_tr_b16 v[166:167], v46 offset:9216
ds_read_b64_tr_b16 v[168:169], v45 offset:8192
ds_read_b64_tr_b16 v[170:171], v45 offset:9216
ds_read_b64_tr_b16 v[172:173], v47 offset:8192
ds_read_b64_tr_b16 v[174:175], v47 offset:9216
s_waitcnt lgkmcnt(0)
s_waitcnt vmcnt(32)
s_barrier
s_add_u32 s56, s54, 4194304
s_mov_b32 m0, 24576
s_nop 0
buffer_load_dwordx4 v26, s[12:15], s56 offen lds
s_add_u32 s56, s54, 4210688
s_mov_b32 m0, 25600
s_nop 0
buffer_load_dwordx4 v26, s[12:15], s56 offen lds
s_add_u32 s56, s54, 4227072
s_mov_b32 m0, 26624
s_nop 0
buffer_load_dwordx4 v27, s[12:15], s56 offen lds
s_add_u32 s56, s54, 4243456
s_mov_b32 m0, 27648
s_nop 0
buffer_load_dwordx4 v27, s[12:15], s56 offen lds
ds_read_b64_tr_b16 v[176:177], v44 offset:12288
ds_read_b64_tr_b16 v[178:179], v44 offset:13312
ds_read_b64_tr_b16 v[180:181], v46 offset:12288
ds_read_b64_tr_b16 v[182:183], v46 offset:13312
ds_read_b64_tr_b16 v[184:185], v45 offset:12288
ds_read_b64_tr_b16 v[186:187], v45 offset:13312
ds_read_b64_tr_b16 v[188:189], v47 offset:12288
ds_read_b64_tr_b16 v[190:191], v47 offset:13312
v_mov_b32 v23, s58
s_mov_b64 exec, 1
buffer_atomic_add v23, v24, s[28:31], 0 offen sc1
s_mov_b64 exec, -1
s_waitcnt lgkmcnt(0)
s_waitcnt vmcnt(33)
s_barrier
s_add_u32 s56, s54, 0
s_mov_b32 m0, 28672
s_nop 0
buffer_load_dwordx4 v26, s[16:19], s56 offen lds
s_add_u32 s56, s54, 16384
s_mov_b32 m0, 29696
s_nop 0
buffer_load_dwordx4 v26, s[16:19], s56 offen lds
s_add_u32 s56, s54, 32768
s_mov_b32 m0, 30720
s_nop 0
buffer_load_dwordx4 v27, s[16:19], s56 offen lds
s_add_u32 s56, s54, 49152
s_mov_b32 m0, 31744
s_nop 0
buffer_load_dwordx4 v27, s[16:19], s56 offen lds
ds_read_b64_tr_b16 v[192:193], v44 offset:16384
ds_read_b64_tr_b16 v[194:195], v44 offset:17408
ds_read_b64_tr_b16 v[196:197], v46 offset:16384
ds_read_b64_tr_b16 v[198:199], v46 offset:17408
ds_read_b64_tr_b16 v[200:201], v45 offset:16384
ds_read_b64_tr_b16 v[202:203], v45 offset:17408
ds_read_b64_tr_b16 v[204:205], v47 offset:16384
ds_read_b64_tr_b16 v[206:207], v47 offset:17408
s_waitcnt lgkmcnt(0)
s_waitcnt vmcnt(25)
s_barrier
s_add_u32 s56, s54, 524288
s_mov_b32 m0, 32768
s_nop 0
buffer_load_dwordx4 v26, s[16:19], s56 offen lds
s_add_u32 s56, s54, 540672
s_mov_b32 m0, 33792
s_nop 0
buffer_load_dwordx4 v26, s[16:19], s56 offen lds
s_add_u32 s56, s54, 557056
s_mov_b32 m0, 34816
s_nop 0
buffer_load_dwordx4 v27, s[16:19], s56 offen lds
s_add_u32 s56, s54, 573440
s_mov_b32 m0, 35840
s_nop 0
buffer_load_dwordx4 v27, s[16:19], s56 offen lds
ds_read_b64_tr_b16 v[208:209], v44 offset:20480
ds_read_b64_tr_b16 v[210:211], v44 offset:21504
ds_read_b64_tr_b16 v[212:213], v46 offset:20480
ds_read_b64_tr_b16 v[214:215], v46 offset:21504
ds_read_b64_tr_b16 v[216:217], v45 offset:20480
ds_read_b64_tr_b16 v[218:219], v45 offset:21504
ds_read_b64_tr_b16 v[220:221], v47 offset:20480
ds_read_b64_tr_b16 v[222:223], v47 offset:21504
s_waitcnt lgkmcnt(0)
s_waitcnt vmcnt(25)
s_barrier
s_add_u32 s56, s54, 1048576
s_mov_b32 m0, 36864
s_nop 0
buffer_load_dwordx4 v26, s[16:19], s56 offen lds
s_add_u32 s56, s54, 1064960
s_mov_b32 m0, 37888
s_nop 0
buffer_load_dwordx4 v26, s[16:19], s56 offen lds
s_add_u32 s56, s54, 1081344
s_mov_b32 m0, 38912
s_nop 0
buffer_load_dwordx4 v27, s[16:19], s56 offen lds
s_add_u32 s56, s54, 1097728
s_mov_b32 m0, 39936
s_nop 0
buffer_load_dwordx4 v27, s[16:19], s56 offen lds
ds_read_b64_tr_b16 v[224:225], v44 offset:24576
ds_read_b64_tr_b16 v[226:227], v44 offset:25600
ds_read_b64_tr_b16 v[228:229], v46 offset:24576
ds_read_b64_tr_b16 v[230:231], v46 offset:25600
ds_read_b64_tr_b16 v[232:233], v45 offset:24576
ds_read_b64_tr_b16 v[234:235], v45 offset:25600
ds_read_b64_tr_b16 v[236:237], v47 offset:24576
ds_read_b64_tr_b16 v[238:239], v47 offset:25600
ds_read_b64_tr_b16 v[60:61], v31 offset:32768
ds_read_b64_tr_b16 v[62:63], v31 offset:32896
ds_read_b64_tr_b16 v[64:65], v31 offset:33280
ds_read_b64_tr_b16 v[66:67], v31 offset:33408
ds_read_b64_tr_b16 v[68:69], v31 offset:34816
ds_read_b64_tr_b16 v[70:71], v31 offset:34944
ds_read_b64_tr_b16 v[72:73], v31 offset:35328
ds_read_b64_tr_b16 v[74:75], v31 offset:35456
s_waitcnt lgkmcnt(0)
ds_write_b128 v2, v[60:63] offset:32768
ds_write_b128 v2, v[64:67] offset:33792
ds_write_b128 v2, v[68:71] offset:34816
ds_write_b128 v2, v[72:75] offset:35840
s_waitcnt lgkmcnt(0)
s_waitcnt vmcnt(25)
s_barrier
s_add_u32 s56, s54, 1572864
s_mov_b32 m0, 40960
s_nop 0
buffer_load_dwordx4 v26, s[16:19], s56 offen lds
s_add_u32 s56, s54, 1589248
s_mov_b32 m0, 41984
s_nop 0
buffer_load_dwordx4 v26, s[16:19], s56 offen lds
s_add_u32 s56, s54, 1605632
s_mov_b32 m0, 43008
s_nop 0
buffer_load_dwordx4 v27, s[16:19], s56 offen lds
s_add_u32 s56, s54, 1622016
s_mov_b32 m0, 44032
s_nop 0
buffer_load_dwordx4 v27, s[16:19], s56 offen lds
ds_read_b64_tr_b16 v[240:241], v44 offset:28672
ds_read_b64_tr_b16 v[242:243], v44 offset:29696
ds_read_b64_tr_b16 v[244:245], v46 offset:28672
ds_read_b64_tr_b16 v[246:247], v46 offset:29696
ds_read_b64_tr_b16 v[248:249], v45 offset:28672
ds_read_b64_tr_b16 v[250:251], v45 offset:29696
ds_read_b64_tr_b16 v[252:253], v47 offset:28672
ds_read_b64_tr_b16 v[254:255], v47 offset:29696
ds_read_b64_tr_b16 v[60:61], v31 offset:36864
ds_read_b64_tr_b16 v[62:63], v31 offset:36992
ds_read_b64_tr_b16 v[64:65], v31 offset:37376
ds_read_b64_tr_b16 v[66:67], v31 offset:37504
ds_read_b64_tr_b16 v[68:69], v31 offset:38912
ds_read_b64_tr_b16 v[70:71], v31 offset:39040
ds_read_b64_tr_b16 v[72:73], v31 offset:39424
ds_read_b64_tr_b16 v[74:75], v31 offset:39552
s_waitcnt lgkmcnt(0)
ds_write_b128 v2, v[60:63] offset:36864
ds_write_b128 v2, v[64:67] offset:37888
ds_write_b128 v2, v[68:71] offset:38912
ds_write_b128 v2, v[72:75] offset:39936
s_waitcnt lgkmcnt(0)
s_waitcnt vmcnt(25)
s_barrier
s_add_u32 s56, s54, 2097152
s_mov_b32 m0, 45056
s_nop 0
buffer_load_dwordx4 v26, s[16:19], s56 offen lds
s_add_u32 s56, s54, 2113536
s_mov_b32 m0, 46080
s_nop 0
buffer_load_dwordx4 v26, s[16:19], s56 offen lds
s_add_u32 s56, s54, 2129920
s_mov_b32 m0, 47104
s_nop 0
buffer_load_dwordx4 v27, s[16:19], s56 offen lds
s_add_u32 s56, s54, 2146304
s_mov_b32 m0, 48128
s_nop 0
buffer_load_dwordx4 v27, s[16:19], s56 offen lds
ds_read_b64_tr_b16 a[0:1], v44 offset:0
ds_read_b64_tr_b16 a[2:3], v44 offset:1024
ds_read_b64_tr_b16 a[4:5], v46 offset:0
ds_read_b64_tr_b16 a[6:7], v46 offset:1024
ds_read_b64_tr_b16 a[8:9], v45 offset:0
ds_read_b64_tr_b16 a[10:11], v45 offset:1024
ds_read_b64_tr_b16 a[12:13], v47 offset:0
ds_read_b64_tr_b16 a[14:15], v47 offset:1024
s_waitcnt lgkmcnt(0)
s_waitcnt vmcnt(25)
s_barrier
s_add_u32 s56, s54, 2621440
s_mov_b32 m0, 16384
s_nop 0
buffer_load_dwordx4 v26, s[16:19], s56 offen lds
s_add_u32 s56, s54, 2637824
s_mov_b32 m0, 17408
s_nop 0
buffer_load_dwordx4 v26, s[16:19], s56 offen lds
s_add_u32 s56, s54, 2654208
s_mov_b32 m0, 18432
s_nop 0
buffer_load_dwordx4 v27, s[16:19], s56 offen lds
s_add_u32 s56, s54, 2670592
s_mov_b32 m0, 19456
s_nop 0
buffer_load_dwordx4 v27, s[16:19], s56 offen lds
ds_read_b64_tr_b16 a[16:17], v44 offset:4096
ds_read_b64_tr_b16 a[18:19], v44 offset:5120
ds_read_b64_tr_b16 a[20:21], v46 offset:4096
ds_read_b64_tr_b16 a[22:23], v46 offset:5120
ds_read_b64_tr_b16 a[24:25], v45 offset:4096
ds_read_b64_tr_b16 a[26:27], v45 offset:5120
ds_read_b64_tr_b16 a[28:29], v47 offset:4096
ds_read_b64_tr_b16 a[30:31], v47 offset:5120
s_waitcnt lgkmcnt(0)
s_waitcnt vmcnt(25)
s_barrier
s_add_u32 s56, s54, 3145728
s_mov_b32 m0, 20480
s_nop 0
buffer_load_dwordx4 v26, s[16:19], s56 offen lds
s_add_u32 s56, s54, 3162112
s_mov_b32 m0, 21504
s_nop 0
buffer_load_dwordx4 v26, s[16:19], s56 offen lds
s_add_u32 s56, s54, 3178496
s_mov_b32 m0, 22528
s_nop 0
buffer_load_dwordx4 v27, s[16:19], s56 offen lds
s_add_u32 s56, s54, 3194880
s_mov_b32 m0, 23552
s_nop 0
buffer_load_dwordx4 v27, s[16:19], s56 offen lds
ds_read_b64_tr_b16 a[32:33], v44 offset:8192
ds_read_b64_tr_b16 a[34:35], v44 offset:9216
ds_read_b64_tr_b16 a[36:37], v46 offset:8192
ds_read_b64_tr_b16 a[38:39], v46 offset:9216
ds_read_b64_tr_b16 a[40:41], v45 offset:8192
ds_read_b64_tr_b16 a[42:43], v45 offset:9216
ds_read_b64_tr_b16 a[44:45], v47 offset:8192
ds_read_b64_tr_b16 a[46:47], v47 offset:9216
s_waitcnt lgkmcnt(0)
s_waitcnt vmcnt(24)
s_barrier
s_add_u32 s56, s54, 3670016
s_mov_b32 m0, 24576
s_nop 0
buffer_load_dwordx4 v26, s[16:19], s56 offen lds
s_add_u32 s56, s54, 3686400
s_mov_b32 m0, 25600
s_nop 0
buffer_load_dwordx4 v26, s[16:19], s56 offen lds
s_add_u32 s56, s54, 3702784
s_mov_b32 m0, 26624
s_nop 0
buffer_load_dwordx4 v27, s[16:19], s56 offen lds
s_add_u32 s56, s54, 3719168
s_mov_b32 m0, 27648
s_nop 0
buffer_load_dwordx4 v27, s[16:19], s56 offen lds
ds_read_b64_tr_b16 a[48:49], v44 offset:12288
ds_read_b64_tr_b16 a[50:51], v44 offset:13312
ds_read_b64_tr_b16 a[52:53], v46 offset:12288
ds_read_b64_tr_b16 a[54:55], v46 offset:13312
ds_read_b64_tr_b16 a[56:57], v45 offset:12288
ds_read_b64_tr_b16 a[58:59], v45 offset:13312
ds_read_b64_tr_b16 a[60:61], v47 offset:12288
ds_read_b64_tr_b16 a[62:63], v47 offset:13312
s_waitcnt lgkmcnt(0)
s_waitcnt vmcnt(24)
s_barrier
s_add_u32 s56, s55, 73728
s_mov_b32 m0, 28672
s_nop 0
buffer_load_dwordx4 v28, s[20:23], s56 offen lds
s_add_u32 s56, s55, 76032
s_mov_b32 m0, 29696
s_nop 0
buffer_load_dwordx4 v28, s[20:23], s56 offen lds
s_add_u32 s56, s55, 82944
s_mov_b32 m0, 30720
s_nop 0
buffer_load_dwordx4 v28, s[20:23], s56 offen lds
s_add_u32 s56, s55, 85248
s_mov_b32 m0, 31744
s_nop 0
buffer_load_dwordx4 v28, s[20:23], s56 offen lds
ds_read_b64_tr_b16 a[64:65], v44 offset:16384
ds_read_b64_tr_b16 a[66:67], v44 offset:17408
ds_read_b64_tr_b16 a[68:69], v46 offset:16384
ds_read_b64_tr_b16 a[70:71], v46 offset:17408
ds_read_b64_tr_b16 a[72:73], v45 offset:16384
ds_read_b64_tr_b16 a[74:75], v45 offset:17408
ds_read_b64_tr_b16 a[76:77], v47 offset:16384
ds_read_b64_tr_b16 a[78:79], v47 offset:17408
s_waitcnt lgkmcnt(0)
s_waitcnt vmcnt(24)
s_barrier
s_add_u32 s56, s55, 73984
s_mov_b32 m0, 32768
s_nop 0
buffer_load_dwordx4 v28, s[20:23], s56 offen lds
s_add_u32 s56, s55, 76288
s_mov_b32 m0, 33792
s_nop 0
buffer_load_dwordx4 v28, s[20:23], s56 offen lds
s_add_u32 s56, s55, 83200
s_mov_b32 m0, 34816
s_nop 0
buffer_load_dwordx4 v28, s[20:23], s56 offen lds
s_add_u32 s56, s55, 85504
s_mov_b32 m0, 35840
s_nop 0
buffer_load_dwordx4 v28, s[20:23], s56 offen lds
ds_read_b64_tr_b16 a[80:81], v44 offset:20480
ds_read_b64_tr_b16 a[82:83], v44 offset:21504
ds_read_b64_tr_b16 a[84:85], v46 offset:20480
ds_read_b64_tr_b16 a[86:87], v46 offset:21504
ds_read_b64_tr_b16 a[88:89], v45 offset:20480
ds_read_b64_tr_b16 a[90:91], v45 offset:21504
ds_read_b64_tr_b16 a[92:93], v47 offset:20480
ds_read_b64_tr_b16 a[94:95], v47 offset:21504
s_waitcnt lgkmcnt(0)
s_waitcnt vmcnt(24)
s_barrier
s_add_u32 s56, s55, 74240
s_mov_b32 m0, 36864
s_nop 0
buffer_load_dwordx4 v28, s[20:23], s56 offen lds
s_add_u32 s56, s55, 76544
s_mov_b32 m0, 37888
s_nop 0
buffer_load_dwordx4 v28, s[20:23], s56 offen lds
s_add_u32 s56, s55, 83456
s_mov_b32 m0, 38912
s_nop 0
buffer_load_dwordx4 v28, s[20:23], s56 offen lds
s_add_u32 s56, s55, 85760
s_mov_b32 m0, 39936
s_nop 0
buffer_load_dwordx4 v28, s[20:23], s56 offen lds
ds_read_b64_tr_b16 a[96:97], v44 offset:24576
ds_read_b64_tr_b16 a[98:99], v44 offset:25600
ds_read_b64_tr_b16 a[100:101], v46 offset:24576
ds_read_b64_tr_b16 a[102:103], v46 offset:25600
ds_read_b64_tr_b16 a[104:105], v45 offset:24576
ds_read_b64_tr_b16 a[106:107], v45 offset:25600
ds_read_b64_tr_b16 a[108:109], v47 offset:24576
ds_read_b64_tr_b16 a[110:111], v47 offset:25600
s_waitcnt lgkmcnt(0)
s_waitcnt vmcnt(24)
s_barrier
s_add_u32 s56, s55, 74496
s_mov_b32 m0, 40960
s_nop 0
buffer_load_dwordx4 v28, s[20:23], s56 offen lds
s_add_u32 s56, s55, 76800
s_mov_b32 m0, 41984
s_nop 0
buffer_load_dwordx4 v28, s[20:23], s56 offen lds
s_add_u32 s56, s55, 83712
s_mov_b32 m0, 43008
s_nop 0
buffer_load_dwordx4 v28, s[20:23], s56 offen lds
s_add_u32 s56, s55, 86016
s_mov_b32 m0, 44032
s_nop 0
buffer_load_dwordx4 v28, s[20:23], s56 offen lds
ds_read_b64_tr_b16 a[112:113], v44 offset:28672
ds_read_b64_tr_b16 a[114:115], v44 offset:29696
ds_read_b64_tr_b16 a[116:117], v46 offset:28672
ds_read_b64_tr_b16 a[118:119], v46 offset:29696
ds_read_b64_tr_b16 a[120:121], v45 offset:28672
ds_read_b64_tr_b16 a[122:123], v45 offset:29696
ds_read_b64_tr_b16 a[124:125], v47 offset:28672
ds_read_b64_tr_b16 a[126:127], v47 offset:29696
s_waitcnt lgkmcnt(0)
s_waitcnt vmcnt(24)
s_barrier
s_add_u32 s56, s55, 0
s_mov_b32 m0, 45056
s_nop 0
buffer_load_dwordx4 v28, s[20:23], s56 offen lds
s_add_u32 s56, s55, 2304
s_mov_b32 m0, 46080
s_nop 0
buffer_load_dwordx4 v28, s[20:23], s56 offen lds
s_add_u32 s56, s55, 9216
s_mov_b32 m0, 47104
s_nop 0
buffer_load_dwordx4 v28, s[20:23], s56 offen lds
s_add_u32 s56, s55, 11520
s_mov_b32 m0, 48128
s_nop 0
buffer_load_dwordx4 v28, s[20:23], s56 offen lds
ds_read_b64_tr_b16 a[128:129], v44 offset:0
ds_read_b64_tr_b16 a[130:131], v44 offset:1024
ds_read_b64_tr_b16 a[132:133], v46 offset:0
ds_read_b64_tr_b16 a[134:135], v46 offset:1024
ds_read_b64_tr_b16 a[136:137], v45 offset:0
ds_read_b64_tr_b16 a[138:139], v45 offset:1024
ds_read_b64_tr_b16 a[140:141], v47 offset:0
ds_read_b64_tr_b16 a[142:143], v47 offset:1024
buffer_load_dword v32, v24, s[28:31], 0 offen sc0 sc1
s_waitcnt lgkmcnt(0)
s_waitcnt vmcnt(25)
s_barrier
s_add_u32 s56, s54, 0
s_mov_b32 m0, 16384
s_nop 0
buffer_load_dwordx4 v26, s[8:11], s56 offen lds
s_add_u32 s56, s54, 16384
s_mov_b32 m0, 17408
s_nop 0
buffer_load_dwordx4 v26, s[8:11], s56 offen lds
s_add_u32 s56, s54, 32768
s_mov_b32 m0, 18432
s_nop 0
buffer_load_dwordx4 v27, s[8:11], s56 offen lds
s_add_u32 s56, s54, 49152
s_mov_b32 m0, 19456
s_nop 0
buffer_load_dwordx4 v27, s[8:11], s56 offen lds
ds_read_b64_tr_b16 a[144:145], v44 offset:4096
ds_read_b64_tr_b16 a[146:147], v44 offset:5120
ds_read_b64_tr_b16 a[148:149], v46 offset:4096
ds_read_b64_tr_b16 a[150:151], v46 offset:5120
ds_read_b64_tr_b16 a[152:153], v45 offset:4096
ds_read_b64_tr_b16 a[154:155], v45 offset:5120
ds_read_b64_tr_b16 a[156:157], v47 offset:4096
ds_read_b64_tr_b16 a[158:159], v47 offset:5120
s_waitcnt lgkmcnt(0)
s_waitcnt vmcnt(25)
s_barrier
s_add_u32 s56, s54, 1572864
s_mov_b32 m0, 20480
s_nop 0
buffer_load_dwordx4 v26, s[8:11], s56 offen lds
s_add_u32 s56, s54, 1589248
s_mov_b32 m0, 21504
s_nop 0
buffer_load_dwordx4 v26, s[8:11], s56 offen lds
s_add_u32 s56, s54, 1605632
s_mov_b32 m0, 22528
s_nop 0
buffer_load_dwordx4 v27, s[8:11], s56 offen lds
s_add_u32 s56, s54, 1622016
s_mov_b32 m0, 23552
s_nop 0
buffer_load_dwordx4 v27, s[8:11], s56 offen lds
ds_read_b64_tr_b16 a[160:161], v44 offset:8192
ds_read_b64_tr_b16 a[162:163], v44 offset:9216
ds_read_b64_tr_b16 a[164:165], v46 offset:8192
ds_read_b64_tr_b16 a[166:167], v46 offset:9216
ds_read_b64_tr_b16 a[168:169], v45 offset:8192
ds_read_b64_tr_b16 a[170:171], v45 offset:9216
ds_read_b64_tr_b16 a[172:173], v47 offset:8192
ds_read_b64_tr_b16 a[174:175], v47 offset:9216
s_waitcnt lgkmcnt(0)
s_waitcnt vmcnt(25)
s_barrier
s_add_u32 s56, s54, 2097152
s_mov_b32 m0, 24576
s_nop 0
buffer_load_dwordx4 v26, s[8:11], s56 offen lds
s_add_u32 s56, s54, 2113536
s_mov_b32 m0, 25600
s_nop 0
buffer_load_dwordx4 v26, s[8:11], s56 offen lds
s_add_u32 s56, s54, 2129920
s_mov_b32 m0, 26624
s_nop 0
buffer_load_dwordx4 v27, s[8:11], s56 offen lds
s_add_u32 s56, s54, 2146304
s_mov_b32 m0, 27648
s_nop 0
buffer_load_dwordx4 v27, s[8:11], s56 offen lds
ds_read_b64_tr_b16 a[184:185], v48 offset:12288
ds_read_b64_tr_b16 a[186:187], v48 offset:13312
ds_read_b64_tr_b16 a[188:189], v48 offset:14336
ds_read_b64_tr_b16 a[190:191], v48 offset:15360
ds_read_b64_tr_b16 a[200:201], v49 offset:12288
ds_read_b64_tr_b16 a[202:203], v49 offset:13312
ds_read_b64_tr_b16 a[204:205], v49 offset:14336
ds_read_b64_tr_b16 a[206:207], v49 offset:15360
s_waitcnt lgkmcnt(0)
s_waitcnt vmcnt(25)
s_barrier
s_add_u32 s56, s54, 2621440
s_mov_b32 m0, 28672
s_nop 0
buffer_load_dwordx4 v26, s[12:15], s56 offen lds
s_add_u32 s56, s54, 2637824
s_mov_b32 m0, 29696
s_nop 0
buffer_load_dwordx4 v26, s[12:15], s56 offen lds
s_add_u32 s56, s54, 2654208
s_mov_b32 m0, 30720
s_nop 0
buffer_load_dwordx4 v27, s[12:15], s56 offen lds
s_add_u32 s56, s54, 2670592
s_mov_b32 m0, 31744
s_nop 0
buffer_load_dwordx4 v27, s[12:15], s56 offen lds
ds_read_b64_tr_b16 a[208:209], v48 offset:16384
ds_read_b64_tr_b16 a[210:211], v48 offset:17408
ds_read_b64_tr_b16 a[212:213], v48 offset:18432
ds_read_b64_tr_b16 a[214:215], v48 offset:19456
ds_read_b64_tr_b16 a[216:217], v49 offset:16384
ds_read_b64_tr_b16 a[218:219], v49 offset:17408
ds_read_b64_tr_b16 a[220:221], v49 offset:18432
ds_read_b64_tr_b16 a[222:223], v49 offset:19456
s_waitcnt lgkmcnt(0)
s_waitcnt vmcnt(25)
s_barrier
s_add_u32 s56, s54, 4194304
s_mov_b32 m0, 32768
s_nop 0
buffer_load_dwordx4 v26, s[16:19], s56 offen lds
s_add_u32 s56, s54, 4210688
s_mov_b32 m0, 33792
s_nop 0
buffer_load_dwordx4 v26, s[16:19], s56 offen lds
s_add_u32 s56, s54, 4227072
s_mov_b32 m0, 34816
s_nop 0
buffer_load_dwordx4 v27, s[16:19], s56 offen lds
s_add_u32 s56, s54, 4243456
s_mov_b32 m0, 35840
s_nop 0
buffer_load_dwordx4 v27, s[16:19], s56 offen lds
ds_read_b64_tr_b16 a[224:225], v48 offset:20480
ds_read_b64_tr_b16 a[226:227], v48 offset:21504
ds_read_b64_tr_b16 a[228:229], v48 offset:22528
ds_read_b64_tr_b16 a[230:231], v48 offset:23552
ds_read_b64_tr_b16 a[232:233], v49 offset:20480
ds_read_b64_tr_b16 a[234:235], v49 offset:21504
ds_read_b64_tr_b16 a[236:237], v49 offset:22528
ds_read_b64_tr_b16 a[238:239], v49 offset:23552
s_waitcnt lgkmcnt(0)
s_waitcnt vmcnt(25)
s_barrier
s_add_u32 s56, s55, 256
s_mov_b32 m0, 36864
s_nop 0
buffer_load_dwordx4 v28, s[20:23], s56 offen lds
s_add_u32 s56, s55, 2560
s_mov_b32 m0, 37888
s_nop 0
buffer_load_dwordx4 v28, s[20:23], s56 offen lds
s_add_u32 s56, s55, 9472
s_mov_b32 m0, 38912
s_nop 0
buffer_load_dwordx4 v28, s[20:23], s56 offen lds
s_add_u32 s56, s55, 11776
s_mov_b32 m0, 39936
s_nop 0
buffer_load_dwordx4 v28, s[20:23], s56 offen lds
ds_read_b64_tr_b16 a[240:241], v48 offset:24576
ds_read_b64_tr_b16 a[242:243], v48 offset:25600
ds_read_b64_tr_b16 a[244:245], v48 offset:26624
ds_read_b64_tr_b16 a[246:247], v48 offset:27648
ds_read_b64_tr_b16 a[248:249], v49 offset:24576
ds_read_b64_tr_b16 a[250:251], v49 offset:25600
ds_read_b64_tr_b16 a[252:253], v49 offset:26624
ds_read_b64_tr_b16 a[254:255], v49 offset:27648
s_waitcnt lgkmcnt(0)
s_waitcnt vmcnt(25)
s_barrier
s_add_u32 s56, s55, 512
s_mov_b32 m0, 40960
s_nop 0
buffer_load_dwordx4 v28, s[20:23], s56 offen lds
s_add_u32 s56, s55, 2816
s_mov_b32 m0, 41984
s_nop 0
buffer_load_dwordx4 v28, s[20:23], s56 offen lds
s_add_u32 s56, s55, 9728
s_mov_b32 m0, 43008
s_nop 0
buffer_load_dwordx4 v28, s[20:23], s56 offen lds
s_add_u32 s56, s55, 12032
s_mov_b32 m0, 44032
s_nop 0
buffer_load_dwordx4 v28, s[20:23], s56 offen lds
ds_read_b64_tr_b16 a[176:177], v48 offset:28672
ds_read_b64_tr_b16 a[178:179], v48 offset:29696
ds_read_b64_tr_b16 a[180:181], v48 offset:30720
ds_read_b64_tr_b16 a[182:183], v48 offset:31744
ds_read_b64_tr_b16 a[192:193], v49 offset:28672
ds_read_b64_tr_b16 a[194:195], v49 offset:29696
ds_read_b64_tr_b16 a[196:197], v49 offset:30720
ds_read_b64_tr_b16 a[198:199], v49 offset:31744
s_waitcnt lgkmcnt(0)
s_waitcnt vmcnt(24)
s_barrier
s_add_u32 s56, s55, 768
s_mov_b32 m0, 45056
s_nop 0
buffer_load_dwordx4 v28, s[20:23], s56 offen lds
s_add_u32 s56, s55, 3072
s_mov_b32 m0, 46080
s_nop 0
buffer_load_dwordx4 v28, s[20:23], s56 offen lds
s_add_u32 s56, s55, 9984
s_mov_b32 m0, 47104
s_nop 0
buffer_load_dwordx4 v28, s[20:23], s56 offen lds
s_add_u32 s56, s55, 12288
s_mov_b32 m0, 48128
s_nop 0
buffer_load_dwordx4 v28, s[20:23], s56 offen lds
ds_read_b64_tr_b16 v[60:61], v44 offset:0
ds_read_b64_tr_b16 v[62:63], v44 offset:1024
ds_read_b64_tr_b16 v[64:65], v46 offset:0
ds_read_b64_tr_b16 v[66:67], v46 offset:1024
ds_read_b64_tr_b16 v[68:69], v45 offset:0
ds_read_b64_tr_b16 v[70:71], v45 offset:1024
ds_read_b64_tr_b16 v[72:73], v47 offset:0
ds_read_b64_tr_b16 v[74:75], v47 offset:1024
s_waitcnt lgkmcnt(0)
s_waitcnt vmcnt(24)
s_barrier
ds_write_b128 v2, v[60:63] offset:0
ds_write_b128 v2, v[64:67] offset:1024
ds_write_b128 v2, v[68:71] offset:2048
ds_write_b128 v2, v[72:75] offset:3072
ds_read_b64_tr_b16 v[60:61], v44 offset:4096
ds_read_b64_tr_b16 v[62:63], v44 offset:5120
ds_read_b64_tr_b16 v[64:65], v46 offset:4096
ds_read_b64_tr_b16 v[66:67], v46 offset:5120
ds_read_b64_tr_b16 v[68:69], v45 offset:4096
ds_read_b64_tr_b16 v[70:71], v45 offset:5120
ds_read_b64_tr_b16 v[72:73], v47 offset:4096
ds_read_b64_tr_b16 v[74:75], v47 offset:5120
L_rdv_w0:
v_readfirstlane_b32 s38, v32
s_nop 0
s_and_b32 s57, s38, 0xff
s_cmp_lg_u32 s57, 32
s_cbranch_scc1 L_rdv2_w0
s_waitcnt lgkmcnt(0)
s_waitcnt vmcnt(20)
s_barrier
ds_write_b128 v2, v[60:63] offset:4096
ds_write_b128 v2, v[64:67] offset:5120
ds_write_b128 v2, v[68:71] offset:6144
ds_write_b128 v2, v[72:75] offset:7168
ds_read_b64_tr_b16 v[60:61], v44 offset:8192
ds_read_b64_tr_b16 v[62:63], v44 offset:9216
ds_read_b64_tr_b16 v[64:65], v46 offset:8192
ds_read_b64_tr_b16 v[66:67], v46 offset:9216
ds_read_b64_tr_b16 v[68:69], v45 offset:8192
ds_read_b64_tr_b16 v[70:71], v45 offset:9216
ds_read_b64_tr_b16 v[72:73], v47 offset:8192
ds_read_b64_tr_b16 v[74:75], v47 offset:9216
buffer_load_dwordx4 v[12:15], v9, s[4:7], s37 offen offset:0
buffer_load_dwordx4 v[16:19], v9, s[4:7], s37 offen offset:1024
buffer_load_dwordx4 v[52:55], v1, s[4:7], s37 offen offset:2048
buffer_load_dwordx4 v[56:59], v1, s[4:7], s37 offen offset:3072
s_mov_b32 m0, 1024
s_nop 0
buffer_load_dwordx4 v1, s[4:7], s47 offen offset:0 sc1 lds
s_waitcnt lgkmcnt(0)
s_waitcnt vmcnt(21)
s_barrier
ds_write_b128 v2, v[60:63] offset:8192
ds_write_b128 v2, v[64:67] offset:9216
ds_write_b128 v2, v[68:71] offset:10240
ds_write_b128 v2, v[72:75] offset:11264
ds_read_b64_tr_b16 v[60:61], v44 offset:12288
ds_read_b64_tr_b16 v[62:63], v44 offset:13312
ds_read_b64_tr_b16 v[64:65], v46 offset:12288
ds_read_b64_tr_b16 v[66:67], v46 offset:13312
ds_read_b64_tr_b16 v[68:69], v45 offset:12288
ds_read_b64_tr_b16 v[70:71], v45 offset:13312
ds_read_b64_tr_b16 v[72:73], v47 offset:12288
ds_read_b64_tr_b16 v[74:75], v47 offset:13312
s_waitcnt lgkmcnt(0)
s_waitcnt vmcnt(17)
s_barrier
ds_write_b128 v2, v[60:63] offset:12288
ds_write_b128 v2, v[64:67] offset:13312
ds_write_b128 v2, v[68:71] offset:14336
ds_write_b128 v2, v[72:75] offset:15360
ds_read_b64_tr_b16 v[60:61], v44 offset:16384
ds_read_b64_tr_b16 v[62:63], v44 offset:17408
ds_read_b64_tr_b16 v[64:65], v46 offset:16384
ds_read_b64_tr_b16 v[66:67], v46 offset:17408
ds_read_b64_tr_b16 v[68:69], v45 offset:16384
ds_read_b64_tr_b16 v[70:71], v45 offset:17408
ds_read_b64_tr_b16 v[72:73], v47 offset:16384
ds_read_b64_tr_b16 v[74:75], v47 offset:17408
s_waitcnt lgkmcnt(0)
s_waitcnt vmcnt(13)
s_barrier
ds_write_b128 v2, v[60:63] offset:16384
ds_write_b128 v2, v[64:67] offset:17408
ds_write_b128 v2, v[68:71] offset:18432
ds_write_b128 v2, v[72:75] offset:19456
ds_read_b64_tr_b16 v[60:61], v48 offset:20480
ds_read_b64_tr_b16 v[62:63], v48 offset:21504
ds_read_b64_tr_b16 v[64:65], v48 offset:22528
ds_read_b64_tr_b16 v[66:67], v48 offset:23552
ds_read_b64_tr_b16 v[68:69], v49 offset:20480
ds_read_b64_tr_b16 v[70:71], v49 offset:21504
ds_read_b64_tr_b16 v[72:73], v49 offset:22528
ds_read_b64_tr_b16 v[74:75], v49 offset:23552
s_waitcnt lgkmcnt(0)
s_waitcnt vmcnt(9)
s_barrier
ds_write_b128 v2, v[60:63] offset:20480
ds_write_b128 v2, v[64:67] offset:21504
ds_write_b128 v2, v[68:71] offset:22528
ds_write_b128 v2, v[72:75] offset:23552
ds_read_b64_tr_b16 v[60:61], v48 offset:24576
ds_read_b64_tr_b16 v[62:63], v48 offset:25600
ds_read_b64_tr_b16 v[64:65], v48 offset:26624
ds_read_b64_tr_b16 v[66:67], v48 offset:27648
ds_read_b64_tr_b16 v[68:69], v49 offset:24576
ds_read_b64_tr_b16 v[70:71], v49 offset:25600
ds_read_b64_tr_b16 v[72:73], v49 offset:26624
ds_read_b64_tr_b16 v[74:75], v49 offset:27648
s_waitcnt lgkmcnt(0)
s_waitcnt vmcnt(5)
s_barrier
ds_write_b128 v2, v[60:63] offset:24576
ds_write_b128 v2, v[64:67] offset:25600
ds_write_b128 v2, v[68:71] offset:26624
ds_write_b128 v2, v[72:75] offset:27648
ds_read_b64_tr_b16 v[60:61], v48 offset:28672
ds_read_b64_tr_b16 v[62:63], v48 offset:29696
ds_read_b64_tr_b16 v[64:65], v48 offset:30720
ds_read_b64_tr_b16 v[66:67], v48 offset:31744
ds_read_b64_tr_b16 v[68:69], v49 offset:28672
ds_read_b64_tr_b16 v[70:71], v49 offset:29696
ds_read_b64_tr_b16 v[72:73], v49 offset:30720
ds_read_b64_tr_b16 v[74:75], v49 offset:31744
s_waitcnt lgkmcnt(0)
s_barrier
ds_write_b128 v2, v[60:63] offset:28672
ds_write_b128 v2, v[64:67] offset:29696
ds_write_b128 v2, v[68:71] offset:30720
ds_write_b128 v2, v[72:75] offset:31744
s_lshl_b32 s57, s58, 5
s_mov_b32 s0, 0x3f003f00
s_mov_b32 s1, 0x3f003f00
s_mov_b32 s58, 304128
s_cmp_eq_u32 s38, s57
s_mov_b32 s56, 0x33333333
s_mov_b32 s57, 0x33333333
s_mov_b32 s2, 0x21800000
s_mov_b32 s55, -24
s_cbranch_scc0 L_slow_w0
v_mov_b64 v[20:21], 0
v_mov_b64 v[22:23], 0
v_mov_b64 v[24:25], 0
v_mov_b64 v[26:27], 0
v_mov_b64 v[28:29], 0
v_mov_b64 v[30:31], 0
v_mov_b64 v[32:33], 0
v_mov_b64 v[34:35], 0
v_mov_b64 v[36:37], 0
v_mov_b64 v[38:39], 0
v_mov_b64 v[40:41], 0
v_mov_b64 v[42:43], 0
ds_read_b128 v[44:47], v2 offset:0
ds_read_b128 v[48:51], v2 offset:1024
v_bfe_u32 v77, v1, 6, 1
v_lshl_add_u32 v77, v77, 3, v1
v_lshlrev_b32 v77, 1, v77
v_lshlrev_b32 v78, 3, v1
s_waitcnt vmcnt(0) lgkmcnt(0)
s_branch L_top_w0f
L_done_w0f:
s_waitcnt vmcnt(0) lgkmcnt(0)
s_endpgm
L_rdv2_w0:
buffer_load_dword v32, v24, s[28:31], 0 offen sc0 sc1
s_sub_u32 s41, s41, 1
s_cbranch_scc1 L_exit
s_waitcnt vmcnt(0)
s_branch L_rdv_w0
L_ra0_w0f:
s_mov_b32 m0, 1024
s_nop 0
buffer_load_dwordx4 v1, s[4:7], s47 offen offset:0 sc1 lds
buffer_load_dwordx4 v1, s[4:7], s47 offen offset:1024 sc1 lds
buffer_load_dwordx4 v1, s[4:7], s47 offen offset:2048 sc1 lds
buffer_load_dwordx4 v1, s[4:7], s47 offen offset:3072 sc1 lds
s_sub_u32 s41, s41, 1
s_cbranch_scc1 L_exit
ds_read_b128 v[44:47], v2 offset:0
ds_read_b128 v[48:51], v2 offset:1024
v_mov_b64 v[20:21], 0
v_mov_b64 v[22:23], 0
v_mov_b64 v[24:25], 0
v_mov_b64 v[26:27], 0
v_mov_b64 v[28:29], 0
v_mov_b64 v[30:31], 0
v_mov_b64 v[32:33], 0
v_mov_b64 v[34:35], 0
v_mov_b64 v[36:37], 0
v_mov_b64 v[38:39], 0
v_mov_b64 v[40:41], 0
v_mov_b64 v[42:43], 0
s_waitcnt vmcnt(0)
ds_read_b128 v[60:63], v1 offset:1024
ds_read_b128 v[64:67], v1 offset:2048
ds_read_b128 v[68:71], v1 offset:3072
ds_read_b128 v[72:75], v1 offset:4096
s_branch L_s0_w0f
L_ra1_w0f:
L_ra2_w0f:
s_waitcnt lgkmcnt(0)
s_barrier
s_mov_b32 m0, 5120
s_nop 0
buffer_load_dwordx4 v1, s[4:7], s48 offen offset:0 sc1 lds
s_mov_b32 m0, 9216
s_nop 0
buffer_load_dwordx4 v1, s[4:7], s49 offen offset:0 sc1 lds
s_sub_u32 s41, s41, 1
s_cbranch_scc1 L_exit
s_waitcnt vmcnt(0)
s_barrier
ds_read_b128 v[76:79], v1 offset:5120
ds_read_b128 v[60:63], v1 offset:6144
ds_read_b128 v[64:67], v1 offset:7168
ds_read_b128 v[68:71], v1 offset:8192
ds_read_b128 v[72:75], v1 offset:9216
s_waitcnt lgkmcnt(0)
v_bitop3_b32 v6, v76, v60, s35 bitop3:0x7e
v_bitop3_b32 v6, v6, v64, s35 bitop3:0xf6
v_bitop3_b32 v6, v6, v68, s35 bitop3:0xf6
v_bitop3_b32 v6, v6, v72, s35 bitop3:0xf6
v_and_b32 v6, 1, v6
v_cmp_ne_u32 vcc, 0, v6

s_cbranch_vccnz L_ra2_w0f
s_branch L_a1_w0f
L_mx_w0f:
s_waitcnt lgkmcnt(0)
v_max3_f32 v30, v12, v13, v28
v_max_f32 v30, v30, v29
v_mov_b32 v31, v30
s_nop 1
v_permlane16_swap_b32 v30, v31
v_max_f32 v30, v30, v31
v_mov_b32 v31, v30
s_nop 1
v_permlane32_swap_b32 v30, v31
v_max_f32 v30, v30, v31
ds_write_b32 v1, v30 offset:10240
s_waitcnt lgkmcnt(0)
s_barrier
ds_read_b128 v[32:35], v1 offset:10240
s_waitcnt lgkmcnt(0)
v_max3_f32 v32, v32, v33, v34
v_max_f32 v32, v32, v35
v_sub_f32 v14, v12, v32
v_sub_f32 v15, v13, v32
v_sub_f32 v30, v28, v32
v_sub_f32 v31, v29, v32
v_exp_f32 v14, v14
v_exp_f32 v15, v15
v_exp_f32 v30, v30
v_exp_f32 v31, v31
v_cvt_pk_bf16_f32 v14, v14, v15
v_cvt_pk_bf16_f32 v30, v30, v31
ds_write_b32 v5, v14 offset:14368
v_cndmask_b32_e64 v26, 0, v30, s[56:57]
v_cndmask_b32_e64 v27, 0, v30, s[56:57]
v_mov_b64 v[76:77], s[52:53]
v_mov_b64 v[78:79], s[52:53]
v_mov_b32_dpp v24, v26 quad_perm:[2,3,0,1] row_mask:0xf bank_mask:0xf
v_mov_b32_dpp v25, v26 quad_perm:[2,3,0,1] row_mask:0xf bank_mask:0xf
s_waitcnt lgkmcnt(0)
s_barrier
v_mov_b64 v[14:15], s[0:1]
ds_read_b128 v[16:19], v1 offset:14368
ds_read_b128 v[36:39], v1 offset:14336
s_waitcnt lgkmcnt(0)
v_mfma_f32_16x16x32_bf16 v[32:35], v[76:79], v[16:19], 0
v_mfma_f32_16x16x32_bf16 v[20:23], v[52:55], v[16:19], 0
v_mfma_f32_16x16x32_bf16 v[20:23], v[56:59], v[36:39], v[20:23]
v_mfma_f32_16x16x16_bf16 v[32:35], v[14:15], v[26:27], v[32:35]
v_mfma_f32_16x16x32_bf16 v[20:23], v[40:43], v[24:27], v[20:23]
s_nop 3
v_rcp_f32 v33, v32
s_nop 2
v_mul_f32_dpp v20, v33, v20 quad_perm:[0,1,0,1] row_mask:0xf bank_mask:0xf
v_mul_f32_dpp v21, v33, v21 quad_perm:[0,1,0,1] row_mask:0xf bank_mask:0xf
v_mul_f32_dpp v22, v33, v22 quad_perm:[0,1,0,1] row_mask:0xf bank_mask:0xf
v_mul_f32_dpp v23, v33, v23 quad_perm:[0,1,0,1] row_mask:0xf bank_mask:0xf
v_cvt_pk_bf16_f32 v20, v20, v21
v_cvt_pk_bf16_f32 v21, v22, v23
ds_write_b64 v6, v[20:21] offset:5120
v_mov_b32_dpp v16, v20 quad_perm:[0,1,0,1] row_mask:0xf bank_mask:0xf
v_mov_b32_dpp v17, v21 quad_perm:[0,1,0,1] row_mask:0xf bank_mask:0xf
v_mov_b32_dpp v18, v20 quad_perm:[2,3,2,3] row_mask:0xf bank_mask:0xf
v_mov_b32_dpp v19, v21 quad_perm:[2,3,2,3] row_mask:0xf bank_mask:0xf
v_mov_b64 v[76:77], 0
v_mov_b64 v[78:79], 0
v_mov_b64 v[36:37], 0
v_mov_b64 v[38:39], 0
v_mov_b64 v[24:25], 0
v_mov_b64 v[26:27], 0
v_mov_b64 v[32:33], 0
v_mov_b64 v[34:35], 0
s_waitcnt lgkmcnt(0)
s_branch L_mxb_w0f

L_slow_w0:
v_mov_b64 v[20:21], 0
v_mov_b64 v[22:23], 0
v_mov_b64 v[24:25], 0
v_mov_b64 v[26:27], 0
v_mov_b64 v[28:29], 0
v_mov_b64 v[30:31], 0
v_mov_b64 v[32:33], 0
v_mov_b64 v[34:35], 0
v_mov_b64 v[36:37], 0
v_mov_b64 v[38:39], 0
v_mov_b64 v[40:41], 0
v_mov_b64 v[42:43], 0
ds_read_b128 v[44:47], v2 offset:0
ds_read_b128 v[48:51], v2 offset:1024
v_bfe_u32 v77, v1, 6, 1
v_lshl_add_u32 v77, v77, 3, v1
v_lshlrev_b32 v77, 1, v77
v_lshlrev_b32 v78, 3, v1
s_waitcnt vmcnt(0) lgkmcnt(0)
s_branch L_top_w0s
L_done_w0s:
s_waitcnt vmcnt(0) lgkmcnt(0)
s_endpgm
L_ra0_w0s:
s_mov_b32 m0, 1024
s_nop 0
buffer_load_dwordx4 v1, s[4:7], s47 offen offset:0 sc0 sc1 lds
buffer_load_dwordx4 v1, s[4:7], s47 offen offset:1024 sc0 sc1 lds
buffer_load_dwordx4 v1, s[4:7], s47 offen offset:2048 sc0 sc1 lds
buffer_load_dwordx4 v1, s[4:7], s47 offen offset:3072 sc0 sc1 lds
s_sub_u32 s41, s41, 1
s_cbranch_scc1 L_exit
ds_read_b128 v[44:47], v2 offset:0
ds_read_b128 v[48:51], v2 offset:1024
v_mov_b64 v[20:21], 0
v_mov_b64 v[22:23], 0
v_mov_b64 v[24:25], 0
v_mov_b64 v[26:27], 0
v_mov_b64 v[28:29], 0
v_mov_b64 v[30:31], 0
v_mov_b64 v[32:33], 0
v_mov_b64 v[34:35], 0
v_mov_b64 v[36:37], 0
v_mov_b64 v[38:39], 0
v_mov_b64 v[40:41], 0
v_mov_b64 v[42:43], 0
s_waitcnt vmcnt(0)
ds_read_b128 v[60:63], v1 offset:1024
ds_read_b128 v[64:67], v1 offset:2048
ds_read_b128 v[68:71], v1 offset:3072
ds_read_b128 v[72:75], v1 offset:4096
s_branch L_s0_w0s
L_ra1_w0s:
L_ra2_w0s:
s_waitcnt lgkmcnt(0)
s_barrier
s_mov_b32 m0, 5120
s_nop 0
buffer_load_dwordx4 v1, s[4:7], s48 offen offset:0 sc0 sc1 lds
s_mov_b32 m0, 9216
s_nop 0
buffer_load_dwordx4 v1, s[4:7], s49 offen offset:0 sc0 sc1 lds
s_sub_u32 s41, s41, 1
s_cbranch_scc1 L_exit
s_waitcnt vmcnt(0)
s_barrier
ds_read_b128 v[76:79], v1 offset:5120
ds_read_b128 v[60:63], v1 offset:6144
ds_read_b128 v[64:67], v1 offset:7168
ds_read_b128 v[68:71], v1 offset:8192
ds_read_b128 v[72:75], v1 offset:9216
s_waitcnt lgkmcnt(0)
v_bitop3_b32 v6, v76, v60, s35 bitop3:0x7e
v_bitop3_b32 v6, v6, v64, s35 bitop3:0xf6
v_bitop3_b32 v6, v6, v68, s35 bitop3:0xf6
v_bitop3_b32 v6, v6, v72, s35 bitop3:0xf6
v_and_b32 v6, 1, v6
v_cmp_ne_u32 vcc, 0, v6

s_cbranch_vccnz L_ra2_w0s
s_branch L_a1_w0s
L_mx_w0s:
s_waitcnt lgkmcnt(0)
v_max3_f32 v30, v12, v13, v28
v_max_f32 v30, v30, v29
v_mov_b32 v31, v30
s_nop 1
v_permlane16_swap_b32 v30, v31
v_max_f32 v30, v30, v31
v_mov_b32 v31, v30
s_nop 1
v_permlane32_swap_b32 v30, v31
v_max_f32 v30, v30, v31
ds_write_b32 v1, v30 offset:10240
s_waitcnt lgkmcnt(0)
s_barrier
ds_read_b128 v[32:35], v1 offset:10240
s_waitcnt lgkmcnt(0)
v_max3_f32 v32, v32, v33, v34
v_max_f32 v32, v32, v35
v_sub_f32 v14, v12, v32
v_sub_f32 v15, v13, v32
v_sub_f32 v30, v28, v32
v_sub_f32 v31, v29, v32
v_exp_f32 v14, v14
v_exp_f32 v15, v15
v_exp_f32 v30, v30
v_exp_f32 v31, v31
v_cvt_pk_bf16_f32 v14, v14, v15
v_cvt_pk_bf16_f32 v30, v30, v31
ds_write_b32 v5, v14 offset:14368
v_cndmask_b32_e64 v26, 0, v30, s[56:57]
v_cndmask_b32_e64 v27, 0, v30, s[56:57]
v_mov_b64 v[76:77], s[52:53]
v_mov_b64 v[78:79], s[52:53]
v_mov_b32_dpp v24, v26 quad_perm:[2,3,0,1] row_mask:0xf bank_mask:0xf
v_mov_b32_dpp v25, v26 quad_perm:[2,3,0,1] row_mask:0xf bank_mask:0xf
s_waitcnt lgkmcnt(0)
s_barrier
v_mov_b64 v[14:15], s[0:1]
ds_read_b128 v[16:19], v1 offset:14368
ds_read_b128 v[36:39], v1 offset:14336
s_waitcnt lgkmcnt(0)
v_mfma_f32_16x16x32_bf16 v[32:35], v[76:79], v[16:19], 0
v_mfma_f32_16x16x32_bf16 v[20:23], v[52:55], v[16:19], 0
v_mfma_f32_16x16x32_bf16 v[20:23], v[56:59], v[36:39], v[20:23]
v_mfma_f32_16x16x16_bf16 v[32:35], v[14:15], v[26:27], v[32:35]
v_mfma_f32_16x16x32_bf16 v[20:23], v[40:43], v[24:27], v[20:23]
s_nop 3
v_rcp_f32 v33, v32
s_nop 2
v_mul_f32_dpp v20, v33, v20 quad_perm:[0,1,0,1] row_mask:0xf bank_mask:0xf
v_mul_f32_dpp v21, v33, v21 quad_perm:[0,1,0,1] row_mask:0xf bank_mask:0xf
v_mul_f32_dpp v22, v33, v22 quad_perm:[0,1,0,1] row_mask:0xf bank_mask:0xf
v_mul_f32_dpp v23, v33, v23 quad_perm:[0,1,0,1] row_mask:0xf bank_mask:0xf
v_cvt_pk_bf16_f32 v20, v20, v21
v_cvt_pk_bf16_f32 v21, v22, v23
ds_write_b64 v6, v[20:21] offset:5120
v_mov_b32_dpp v16, v20 quad_perm:[0,1,0,1] row_mask:0xf bank_mask:0xf
v_mov_b32_dpp v17, v21 quad_perm:[0,1,0,1] row_mask:0xf bank_mask:0xf
v_mov_b32_dpp v18, v20 quad_perm:[2,3,2,3] row_mask:0xf bank_mask:0xf
v_mov_b32_dpp v19, v21 quad_perm:[2,3,2,3] row_mask:0xf bank_mask:0xf
v_mov_b64 v[76:77], 0
v_mov_b64 v[78:79], 0
v_mov_b64 v[36:37], 0
v_mov_b64 v[38:39], 0
v_mov_b64 v[24:25], 0
v_mov_b64 v[26:27], 0
v_mov_b64 v[32:33], 0
v_mov_b64 v[34:35], 0
s_waitcnt lgkmcnt(0)
s_branch L_mxb_w0s

L_pro_w0r:
v_and_b32 v20, 63, v0
v_lshlrev_b32 v1, 4, v20
v_add_u32 v2, 16384, v1
v_and_b32 v23, 1, v22
v_lshl_add_u32 v23, v24, 4, v23
v_mul_u32_u24 v23, 1152, v23
v_lshlrev_b32 v28, 2, v22
v_xor_b32 v28, v28, v21
v_lshl_add_u32 v28, v28, 4, v23
s_mul_i32 s55, s32, 147456
v_lshrrev_b32 v23, 2, v21
v_and_b32 v24, 1, v21
v_lshl_add_u32 v23, v23, 1, v24
v_mul_u32_u24 v23, 1152, v23
v_lshl_add_u32 v23, v22, 5, v23
v_bfe_u32 v24, v21, 1, 1
v_lshl_add_u32 v23, v24, 4, v23
s_lshl_b32 s56, s32, 7
s_waitcnt lgkmcnt(0)
buffer_load_dwordx4 v[12:15], v23, s[24:27], s56 offen
v_and_b32 v23, 1, v22
v_lshrrev_b32 v24, 2, v21
v_lshl_add_u32 v23, v23, 2, v24
v_lshlrev_b32 v23, 1, v23
v_bfe_u32 v44, v21, 1, 1
v_add_u32 v44, 0, v44
v_xor_b32 v44, v44, v23
v_lshlrev_b32 v44, 4, v44
v_lshl_add_u32 v44, v24, 8, v44
v_and_b32 v23, 1, v22
v_lshl_add_u32 v44, v23, 11, v44
v_and_b32 v23, 1, v21
v_lshl_add_u32 v44, v23, 3, v44
v_lshrrev_b32 v23, 1, v22
v_mul_u32_u24 v23, 40960, v23
v_add_u32 v23, 16384, v23
v_add_u32 v44, v44, v23
v_and_b32 v23, 1, v22
v_lshrrev_b32 v24, 2, v21
v_lshl_add_u32 v23, v23, 2, v24
v_lshlrev_b32 v23, 1, v23
v_bfe_u32 v45, v21, 1, 1
v_add_u32 v45, 2, v45
v_xor_b32 v45, v45, v23
v_lshlrev_b32 v45, 4, v45
v_lshl_add_u32 v45, v24, 8, v45
v_and_b32 v23, 1, v22
v_lshl_add_u32 v45, v23, 11, v45
v_and_b32 v23, 1, v21
v_lshl_add_u32 v45, v23, 3, v45
v_lshrrev_b32 v23, 1, v22
v_mul_u32_u24 v23, 40960, v23
v_add_u32 v23, 16384, v23
v_add_u32 v45, v45, v23
v_and_b32 v23, 1, v22
v_lshrrev_b32 v24, 2, v21
v_lshl_add_u32 v23, v23, 2, v24
v_lshlrev_b32 v23, 1, v23
v_bfe_u32 v46, v21, 1, 1
v_add_u32 v46, 0, v46
v_xor_b32 v46, v46, v23
v_lshlrev_b32 v46, 4, v46
v_lshl_add_u32 v46, v24, 8, v46
v_and_b32 v23, 1, v22
v_lshl_add_u32 v46, v23, 11, v46
v_and_b32 v23, 1, v21
v_lshl_add_u32 v46, v23, 3, v46
v_lshrrev_b32 v23, 1, v22
v_mul_u32_u24 v23, 32768, v23
v_add_u32 v23, 98304, v23
v_add_u32 v46, v46, v23
v_and_b32 v23, 1, v22
v_lshrrev_b32 v24, 2, v21
v_lshl_add_u32 v23, v23, 2, v24
v_lshlrev_b32 v23, 1, v23
v_bfe_u32 v47, v21, 1, 1
v_add_u32 v47, 2, v47
v_xor_b32 v47, v47, v23
v_lshlrev_b32 v47, 4, v47
v_lshl_add_u32 v47, v24, 8, v47
v_and_b32 v23, 1, v22
v_lshl_add_u32 v47, v23, 11, v47
v_and_b32 v23, 1, v21
v_lshl_add_u32 v47, v23, 3, v47
v_lshrrev_b32 v23, 1, v22
v_mul_u32_u24 v23, 32768, v23
v_add_u32 v23, 98304, v23
v_add_u32 v47, v47, v23
v_and_b32 v23, 1, v22
v_bfe_u32 v24, v21, 2, 1
v_lshl_add_u32 v23, v23, 1, v24
v_xor_b32 v24, 0, v23
v_lshlrev_b32 v24, 6, v24
v_lshl_add_u32 v48, v23, 8, v24
v_and_b32 v23, 3, v21
v_lshl_add_u32 v48, v23, 4, v48
v_and_b32 v23, 8, v21
v_add_u32 v48, v48, v23
v_lshrrev_b32 v23, 1, v22
v_mul_u32_u24 v23, 40960, v23
v_add_u32 v23, 16384, v23
v_add_u32 v48, v48, v23
v_and_b32 v23, 1, v22
v_bfe_u32 v24, v21, 2, 1
v_lshl_add_u32 v23, v23, 1, v24
v_xor_b32 v24, 0, v23
v_lshlrev_b32 v24, 6, v24
v_lshl_add_u32 v49, v23, 8, v24
v_and_b32 v23, 3, v21
v_lshl_add_u32 v49, v23, 4, v49
v_and_b32 v23, 8, v21
v_add_u32 v49, v49, v23
v_lshrrev_b32 v23, 1, v22
v_mul_u32_u24 v23, 32768, v23
v_add_u32 v23, 98304, v23
v_add_u32 v49, v49, v23
v_bfe_u32 v23, v21, 1, 1
v_mul_u32_u24 v23, 0xaaaa, v23
v_add_u32 v0, 0x4444, v23
v_lshlrev_b32 v3, 3, v20
v_lshrrev_b32 v25, 5, v20
v_lshlrev_b32 v25, 6, v25
v_xor_b32 v3, v3, v25
v_lshrrev_b32 v25, 2, v20
v_and_b32 v4, 3, v21
v_lshl_add_u32 v4, v4, 4, v25
v_lshlrev_b32 v4, 3, v4
v_bfe_u32 v25, v21, 1, 1
v_lshlrev_b32 v23, 6, v25
v_xor_b32 v4, v4, v23
v_lshlrev_b32 v5, 4, v21
v_lshl_add_u32 v5, v22, 2, v5
v_mul_u32_u24 v23, 1024, v25
v_add_u32 v5, v5, v23
v_lshlrev_b32 v9, 8, v22
v_lshl_add_u32 v9, v25, 6, v9
v_bfe_u32 v23, v21, 3, 1
v_lshl_add_u32 v9, v23, 7, v9
v_bfe_u32 v23, v21, 2, 1
v_lshl_add_u32 v9, v23, 5, v9
v_and_b32 v23, 1, v21
v_lshl_add_u32 v9, v23, 4, v9
v_lshrrev_b32 v23, 1, v22
v_and_b32 v24, 1, v22
v_and_b32 v25, 7, v21
v_lshrrev_b32 v7, 3, v21
v_lshl_add_u32 v8, v7, 1, v23
v_lshlrev_b32 v8, 12, v8
v_lshl_add_u32 v8, v24, 7, v8
v_and_b32 v25, 4, v21
v_lshl_add_u32 v8, v25, 3, v8
v_and_b32 v25, 1, v21
v_lshl_add_u32 v8, v25, 4, v8
v_bfe_u32 v25, v21, 1, 1
v_lshl_add_u32 v8, v25, 3, v8
s_lshr_b32 s56, s32, 1
s_lshl_b32 s56, s56, 8
s_and_b32 s57, s32, 1
s_lshl_b32 s57, s57, 6
s_add_u32 s56, s56, s57
s_add_u32 s56, s56, 0
v_add_u32 v8, s56, v8
v_and_b32 v7, 0x3d0, v1
s_mov_b32 s42, 0
s_mov_b32 s43, 65536
s_mov_b32 s44, 131072
s_mov_b32 s45, 196608
s_mov_b32 s46, 262144
s_mov_b32 s47, 294912
s_mov_b32 s48, 299008
s_mov_b32 s49, 303104
s_mov_b32 s50, 0x3e0293ee
s_mov_b32 s51, 0x3e0293ee
s_mov_b32 s52, 0x3f803f80
s_mov_b32 s53, 0x3f803f80
v_lshlrev_b32 v11, 2, v21
s_mov_b32 s34, 0
s_mov_b32 s35, -1
s_mov_b32 s36, 0
s_mov_b32 s41, 300000
s_lshl_b32 s37, s32, 14
s_add_u32 s39, s37, 17301504
s_add_u32 s37, s37, 16777216
s_mov_b32 s40, 8749056
v_mov_b64 v[36:37], 0
v_mov_b64 v[38:39], 0
ds_write_b128 v1, v[36:39] offset:14336
s_lshl_b32 s56, s32, 1
s_add_u32 s56, s56, 0
s_cmp_eq_u32 s56, 0
s_cselect_b32 s56, 64, s56
s_mul_i32 s56, s56, 10240
s_add_u32 s56, s56, 8388608
s_add_u32 s57, s56, 4096
v_mov_b32 v40, 0
v_mov_b32 v41, 0
v_mov_b32 v42, 0
v_mov_b32 v43, 0
buffer_store_dwordx4 v[40:43], v1, s[4:7], s56 offen offset:0 sc0 sc1
buffer_store_dwordx4 v[40:43], v1, s[4:7], s56 offen offset:1024 sc0 sc1
buffer_store_dwordx4 v[40:43], v1, s[4:7], s56 offen offset:2048 sc0 sc1
buffer_store_dwordx4 v[40:43], v1, s[4:7], s56 offen offset:3072 sc0 sc1
s_add_u32 s56, s32, 64
s_lshl_b32 s3, s56, 12
v_and_b32 v23, 1, v21
v_bfe_u32 v24, v21, 2, 1
v_bfe_u32 v25, v21, 1, 1
s_lshl_b32 s57, s56, 7
s_add_u32 s57, s57, 294912
v_and_b32 v10, 7, v21
v_lshlrev_b32 v10, 2, v10
v_lshl_add_u32 v10, v22, 5, v10
v_add_u32 v10, s57, v10
s_lshl_b32 s33, s56, 2
s_add_u32 s33, s33, 304128
v_mov_b32 v30, -1
s_mov_b64 exec, 1
buffer_store_dword v30, v1, s[4:7], s33 offen sc0 sc1
s_mov_b64 exec, -1
v_lshl_add_u32 v23, v23, 1, v24
v_lshlrev_b32 v25, 4, v25
v_mov_b32 v24, 0x3f80
v_lshlrev_b32 v24, v25, v24
v_cmp_eq_u32 vcc, 0, v23
s_nop 1
v_cndmask_b32 v76, 0, v24, vcc
v_cmp_eq_u32 vcc, 1, v23
s_nop 1
v_cndmask_b32 v77, 0, v24, vcc
v_cmp_eq_u32 vcc, 2, v23
s_nop 1
v_cndmask_b32 v78, 0, v24, vcc
v_cmp_eq_u32 vcc, 3, v23
s_nop 1
v_cndmask_b32 v79, 0, v24, vcc
buffer_store_dwordx4 v[36:39], v9, s[4:7], s3 offen offset:0 sc0 sc1
buffer_store_dwordx4 v[36:39], v9, s[4:7], s3 offen offset:1024 sc0 sc1
buffer_store_dwordx4 v[36:39], v9, s[4:7], s3 offen offset:2048 sc0 sc1
buffer_store_dwordx4 v[36:39], v9, s[4:7], s3 offen offset:3072 sc0 sc1
s_lshl_b32 s56, s32, 10
s_cmp_ge_u32 s32, 9
s_cselect_b32 s56, 268435456, s56
s_add_u32 s57, s56, 8388608
s_add_u32 s56, s56, 294912
s_waitcnt vmcnt(9)
v_or_b32 v12, 1, v12
buffer_store_dwordx4 v[12:15], v1, s[4:7], s56 offen sc0 sc1
buffer_store_dwordx4 v[12:15], v1, s[4:7], s57 offen sc0 sc1
s_getreg_b32 s56, hwreg(HW_REG_XCC_ID)
s_and_b32 s56, s56, 15
s_mul_i32 s57, s56, s56
s_lshl_b32 s57, s57, 18
s_lshl_b32 s56, s56, 8
s_add_u32 s57, s57, s56
s_add_u32 s58, s57, 1
s_lshl_b32 s101, s32, 7
s_add_u32 s101, s101, 327680
v_mov_b32 v24, 0
s_add_u32 s56, s54, 0
s_mov_b32 m0, 28672
s_nop 0
buffer_load_dwordx4 v26, s[12:15], s56 offen lds
s_add_u32 s56, s54, 16384
s_mov_b32 m0, 29696
s_nop 0
buffer_load_dwordx4 v26, s[12:15], s56 offen lds
s_add_u32 s56, s54, 32768
s_mov_b32 m0, 30720
s_nop 0
buffer_load_dwordx4 v27, s[12:15], s56 offen lds
s_add_u32 s56, s54, 49152
s_mov_b32 m0, 31744
s_nop 0
buffer_load_dwordx4 v27, s[12:15], s56 offen lds
s_add_u32 s56, s54, 524288
s_mov_b32 m0, 32768
s_nop 0
buffer_load_dwordx4 v26, s[12:15], s56 offen lds
s_add_u32 s56, s54, 540672
s_mov_b32 m0, 33792
s_nop 0
buffer_load_dwordx4 v26, s[12:15], s56 offen lds
s_add_u32 s56, s54, 557056
s_mov_b32 m0, 34816
s_nop 0
buffer_load_dwordx4 v27, s[12:15], s56 offen lds
s_add_u32 s56, s54, 573440
s_mov_b32 m0, 35840
s_nop 0
buffer_load_dwordx4 v27, s[12:15], s56 offen lds
v_and_b32 v23, 3, v20
v_lshrrev_b32 v24, 2, v20
v_mul_u32_u24 v29, 1152, v24
v_lshl_add_u32 v29, v23, 4, v29
v_lshrrev_b32 v24, 2, v21
v_and_b32 v25, 1, v22
v_lshlrev_b32 v31, 10, v25
v_lshrrev_b32 v25, 1, v22
v_lshl_add_u32 v31, v25, 8, v31
v_and_b32 v25, 1, v24
v_lshl_add_u32 v31, v25, 6, v31
v_lshrrev_b32 v25, 1, v24
v_lshl_add_u32 v31, v25, 3, v31
v_lshl_add_u32 v31, v23, 4, v31
v_add_u32 v31, 16384, v31
s_add_u32 s56, s55, 1024
s_mov_b32 m0, 49152
s_nop 0
buffer_load_dwordx4 v29, s[20:23], s56 offen lds
s_add_u32 s56, s55, 19456
s_mov_b32 m0, 50176
s_nop 0
buffer_load_dwordx4 v29, s[20:23], s56 offen lds
s_add_u32 s56, s55, 37888
s_mov_b32 m0, 51200
s_nop 0
buffer_load_dwordx4 v29, s[20:23], s56 offen lds
s_add_u32 s56, s55, 56320
s_mov_b32 m0, 52224
s_nop 0
buffer_load_dwordx4 v29, s[20:23], s56 offen lds
s_add_u32 s56, s55, 74752
s_mov_b32 m0, 53248
s_nop 0
buffer_load_dwordx4 v29, s[20:23], s56 offen lds
s_add_u32 s56, s55, 93184
s_mov_b32 m0, 54272
s_nop 0
buffer_load_dwordx4 v29, s[20:23], s56 offen lds
s_add_u32 s56, s55, 111616
s_mov_b32 m0, 55296
s_nop 0
buffer_load_dwordx4 v29, s[20:23], s56 offen lds
s_add_u32 s56, s55, 130048
s_mov_b32 m0, 56320
s_nop 0
buffer_load_dwordx4 v29, s[20:23], s56 offen lds
v_mov_b32 v24, 0
s_barrier
ds_read_b64_tr_b16 v[80:81], v44 offset:20480
ds_read_b64_tr_b16 v[82:83], v44 offset:21504
ds_read_b64_tr_b16 v[84:85], v46 offset:20480
ds_read_b64_tr_b16 v[86:87], v46 offset:21504
ds_read_b64_tr_b16 v[88:89], v45 offset:20480
ds_read_b64_tr_b16 v[90:91], v45 offset:21504
ds_read_b64_tr_b16 v[92:93], v47 offset:20480
ds_read_b64_tr_b16 v[94:95], v47 offset:21504
s_waitcnt lgkmcnt(0)
s_barrier
s_add_u32 s56, s54, 1048576
s_mov_b32 m0, 36864
s_nop 0
buffer_load_dwordx4 v26, s[12:15], s56 offen lds
s_add_u32 s56, s54, 1064960
s_mov_b32 m0, 37888
s_nop 0
buffer_load_dwordx4 v26, s[12:15], s56 offen lds
s_add_u32 s56, s54, 1081344
s_mov_b32 m0, 38912
s_nop 0
buffer_load_dwordx4 v27, s[12:15], s56 offen lds
s_add_u32 s56, s54, 1097728
s_mov_b32 m0, 39936
s_nop 0
buffer_load_dwordx4 v27, s[12:15], s56 offen lds
ds_read_b64_tr_b16 v[96:97], v44 offset:24576
ds_read_b64_tr_b16 v[98:99], v44 offset:25600
ds_read_b64_tr_b16 v[100:101], v46 offset:24576
ds_read_b64_tr_b16 v[102:103], v46 offset:25600
ds_read_b64_tr_b16 v[104:105], v45 offset:24576
ds_read_b64_tr_b16 v[106:107], v45 offset:25600
ds_read_b64_tr_b16 v[108:109], v47 offset:24576
ds_read_b64_tr_b16 v[110:111], v47 offset:25600
s_waitcnt lgkmcnt(0)
s_barrier
s_add_u32 s56, s54, 1572864
s_mov_b32 m0, 40960
s_nop 0
buffer_load_dwordx4 v26, s[12:15], s56 offen lds
s_add_u32 s56, s54, 1589248
s_mov_b32 m0, 41984
s_nop 0
buffer_load_dwordx4 v26, s[12:15], s56 offen lds
s_add_u32 s56, s54, 1605632
s_mov_b32 m0, 43008
s_nop 0
buffer_load_dwordx4 v27, s[12:15], s56 offen lds
s_add_u32 s56, s54, 1622016
s_mov_b32 m0, 44032
s_nop 0
buffer_load_dwordx4 v27, s[12:15], s56 offen lds
ds_read_b64_tr_b16 v[112:113], v44 offset:28672
ds_read_b64_tr_b16 v[114:115], v44 offset:29696
ds_read_b64_tr_b16 v[116:117], v46 offset:28672
ds_read_b64_tr_b16 v[118:119], v46 offset:29696
ds_read_b64_tr_b16 v[120:121], v45 offset:28672
ds_read_b64_tr_b16 v[122:123], v45 offset:29696
ds_read_b64_tr_b16 v[124:125], v47 offset:28672
ds_read_b64_tr_b16 v[126:127], v47 offset:29696
s_waitcnt lgkmcnt(0)
s_barrier
s_add_u32 s56, s54, 2097152
s_mov_b32 m0, 45056
s_nop 0
buffer_load_dwordx4 v26, s[12:15], s56 offen lds
s_add_u32 s56, s54, 2113536
s_mov_b32 m0, 46080
s_nop 0
buffer_load_dwordx4 v26, s[12:15], s56 offen lds
s_add_u32 s56, s54, 2129920
s_mov_b32 m0, 47104
s_nop 0
buffer_load_dwordx4 v27, s[12:15], s56 offen lds
s_add_u32 s56, s54, 2146304
s_mov_b32 m0, 48128
s_nop 0
buffer_load_dwordx4 v27, s[12:15], s56 offen lds
ds_read_b64_tr_b16 v[128:129], v44 offset:0
ds_read_b64_tr_b16 v[130:131], v44 offset:1024
ds_read_b64_tr_b16 v[132:133], v46 offset:0
ds_read_b64_tr_b16 v[134:135], v46 offset:1024
ds_read_b64_tr_b16 v[136:137], v45 offset:0
ds_read_b64_tr_b16 v[138:139], v45 offset:1024
ds_read_b64_tr_b16 v[140:141], v47 offset:0
ds_read_b64_tr_b16 v[142:143], v47 offset:1024
s_waitcnt lgkmcnt(0)
s_barrier
s_add_u32 s56, s54, 3145728
s_mov_b32 m0, 16384
s_nop 0
buffer_load_dwordx4 v26, s[12:15], s56 offen lds
s_add_u32 s56, s54, 3162112
s_mov_b32 m0, 17408
s_nop 0
buffer_load_dwordx4 v26, s[12:15], s56 offen lds
s_add_u32 s56, s54, 3178496
s_mov_b32 m0, 18432
s_nop 0
buffer_load_dwordx4 v27, s[12:15], s56 offen lds
s_add_u32 s56, s54, 3194880
s_mov_b32 m0, 19456
s_nop 0
buffer_load_dwordx4 v27, s[12:15], s56 offen lds
ds_read_b64_tr_b16 v[144:145], v44 offset:4096
ds_read_b64_tr_b16 v[146:147], v44 offset:5120
ds_read_b64_tr_b16 v[148:149], v46 offset:4096
ds_read_b64_tr_b16 v[150:151], v46 offset:5120
ds_read_b64_tr_b16 v[152:153], v45 offset:4096
ds_read_b64_tr_b16 v[154:155], v45 offset:5120
ds_read_b64_tr_b16 v[156:157], v47 offset:4096
ds_read_b64_tr_b16 v[158:159], v47 offset:5120
s_waitcnt lgkmcnt(0)
s_barrier
s_add_u32 s56, s54, 3670016
s_mov_b32 m0, 20480
s_nop 0
buffer_load_dwordx4 v26, s[12:15], s56 offen lds
s_add_u32 s56, s54, 3686400
s_mov_b32 m0, 21504
s_nop 0
buffer_load_dwordx4 v26, s[12:15], s56 offen lds
s_add_u32 s56, s54, 3702784
s_mov_b32 m0, 22528
s_nop 0
buffer_load_dwordx4 v27, s[12:15], s56 offen lds
s_add_u32 s56, s54, 3719168
s_mov_b32 m0, 23552
s_nop 0
buffer_load_dwordx4 v27, s[12:15], s56 offen lds
ds_read_b64_tr_b16 v[160:161], v44 offset:8192
ds_read_b64_tr_b16 v[162:163], v44 offset:9216
ds_read_b64_tr_b16 v[164:165], v46 offset:8192
ds_read_b64_tr_b16 v[166:167], v46 offset:9216
ds_read_b64_tr_b16 v[168:169], v45 offset:8192
ds_read_b64_tr_b16 v[170:171], v45 offset:9216
ds_read_b64_tr_b16 v[172:173], v47 offset:8192
ds_read_b64_tr_b16 v[174:175], v47 offset:9216
s_waitcnt lgkmcnt(0)
s_waitcnt vmcnt(32)
s_barrier
s_add_u32 s56, s54, 4194304
s_mov_b32 m0, 24576
s_nop 0
buffer_load_dwordx4 v26, s[12:15], s56 offen lds
s_add_u32 s56, s54, 4210688
s_mov_b32 m0, 25600
s_nop 0
buffer_load_dwordx4 v26, s[12:15], s56 offen lds
s_add_u32 s56, s54, 4227072
s_mov_b32 m0, 26624
s_nop 0
buffer_load_dwordx4 v27, s[12:15], s56 offen lds
s_add_u32 s56, s54, 4243456
s_mov_b32 m0, 27648
s_nop 0
buffer_load_dwordx4 v27, s[12:15], s56 offen lds
ds_read_b64_tr_b16 v[176:177], v44 offset:12288
ds_read_b64_tr_b16 v[178:179], v44 offset:13312
ds_read_b64_tr_b16 v[180:181], v46 offset:12288
ds_read_b64_tr_b16 v[182:183], v46 offset:13312
ds_read_b64_tr_b16 v[184:185], v45 offset:12288
ds_read_b64_tr_b16 v[186:187], v45 offset:13312
ds_read_b64_tr_b16 v[188:189], v47 offset:12288
ds_read_b64_tr_b16 v[190:191], v47 offset:13312
v_mov_b32 v23, s58
s_mov_b64 exec, 1
buffer_atomic_add v23, v24, s[28:31], 0 offen sc1
s_mov_b64 exec, -1
s_waitcnt lgkmcnt(0)
s_waitcnt vmcnt(33)
s_barrier
s_add_u32 s56, s54, 0
s_mov_b32 m0, 28672
s_nop 0
buffer_load_dwordx4 v26, s[16:19], s56 offen lds
s_add_u32 s56, s54, 16384
s_mov_b32 m0, 29696
s_nop 0
buffer_load_dwordx4 v26, s[16:19], s56 offen lds
s_add_u32 s56, s54, 32768
s_mov_b32 m0, 30720
s_nop 0
buffer_load_dwordx4 v27, s[16:19], s56 offen lds
s_add_u32 s56, s54, 49152
s_mov_b32 m0, 31744
s_nop 0
buffer_load_dwordx4 v27, s[16:19], s56 offen lds
ds_read_b64_tr_b16 v[192:193], v44 offset:16384
ds_read_b64_tr_b16 v[194:195], v44 offset:17408
ds_read_b64_tr_b16 v[196:197], v46 offset:16384
ds_read_b64_tr_b16 v[198:199], v46 offset:17408
ds_read_b64_tr_b16 v[200:201], v45 offset:16384
ds_read_b64_tr_b16 v[202:203], v45 offset:17408
ds_read_b64_tr_b16 v[204:205], v47 offset:16384
ds_read_b64_tr_b16 v[206:207], v47 offset:17408
s_waitcnt lgkmcnt(0)
s_waitcnt vmcnt(25)
s_barrier
s_add_u32 s56, s54, 524288
s_mov_b32 m0, 32768
s_nop 0
buffer_load_dwordx4 v26, s[16:19], s56 offen lds
s_add_u32 s56, s54, 540672
s_mov_b32 m0, 33792
s_nop 0
buffer_load_dwordx4 v26, s[16:19], s56 offen lds
s_add_u32 s56, s54, 557056
s_mov_b32 m0, 34816
s_nop 0
buffer_load_dwordx4 v27, s[16:19], s56 offen lds
s_add_u32 s56, s54, 573440
s_mov_b32 m0, 35840
s_nop 0
buffer_load_dwordx4 v27, s[16:19], s56 offen lds
ds_read_b64_tr_b16 v[208:209], v44 offset:20480
ds_read_b64_tr_b16 v[210:211], v44 offset:21504
ds_read_b64_tr_b16 v[212:213], v46 offset:20480
ds_read_b64_tr_b16 v[214:215], v46 offset:21504
ds_read_b64_tr_b16 v[216:217], v45 offset:20480
ds_read_b64_tr_b16 v[218:219], v45 offset:21504
ds_read_b64_tr_b16 v[220:221], v47 offset:20480
ds_read_b64_tr_b16 v[222:223], v47 offset:21504
s_waitcnt lgkmcnt(0)
s_waitcnt vmcnt(25)
s_barrier
s_add_u32 s56, s54, 1048576
s_mov_b32 m0, 36864
s_nop 0
buffer_load_dwordx4 v26, s[16:19], s56 offen lds
s_add_u32 s56, s54, 1064960
s_mov_b32 m0, 37888
s_nop 0
buffer_load_dwordx4 v26, s[16:19], s56 offen lds
s_add_u32 s56, s54, 1081344
s_mov_b32 m0, 38912
s_nop 0
buffer_load_dwordx4 v27, s[16:19], s56 offen lds
s_add_u32 s56, s54, 1097728
s_mov_b32 m0, 39936
s_nop 0
buffer_load_dwordx4 v27, s[16:19], s56 offen lds
ds_read_b64_tr_b16 v[224:225], v44 offset:24576
ds_read_b64_tr_b16 v[226:227], v44 offset:25600
ds_read_b64_tr_b16 v[228:229], v46 offset:24576
ds_read_b64_tr_b16 v[230:231], v46 offset:25600
ds_read_b64_tr_b16 v[232:233], v45 offset:24576
ds_read_b64_tr_b16 v[234:235], v45 offset:25600
ds_read_b64_tr_b16 v[236:237], v47 offset:24576
ds_read_b64_tr_b16 v[238:239], v47 offset:25600
ds_read_b64_tr_b16 v[60:61], v31 offset:32768
ds_read_b64_tr_b16 v[62:63], v31 offset:32896
ds_read_b64_tr_b16 v[64:65], v31 offset:33280
ds_read_b64_tr_b16 v[66:67], v31 offset:33408
ds_read_b64_tr_b16 v[68:69], v31 offset:34816
ds_read_b64_tr_b16 v[70:71], v31 offset:34944
ds_read_b64_tr_b16 v[72:73], v31 offset:35328
ds_read_b64_tr_b16 v[74:75], v31 offset:35456
s_waitcnt lgkmcnt(0)
ds_write_b128 v2, v[60:63] offset:32768
ds_write_b128 v2, v[64:67] offset:33792
ds_write_b128 v2, v[68:71] offset:34816
ds_write_b128 v2, v[72:75] offset:35840
s_waitcnt lgkmcnt(0)
s_waitcnt vmcnt(25)
s_barrier
s_add_u32 s56, s54, 1572864
s_mov_b32 m0, 40960
s_nop 0
buffer_load_dwordx4 v26, s[16:19], s56 offen lds
s_add_u32 s56, s54, 1589248
s_mov_b32 m0, 41984
s_nop 0
buffer_load_dwordx4 v26, s[16:19], s56 offen lds
s_add_u32 s56, s54, 1605632
s_mov_b32 m0, 43008
s_nop 0
buffer_load_dwordx4 v27, s[16:19], s56 offen lds
s_add_u32 s56, s54, 1622016
s_mov_b32 m0, 44032
s_nop 0
buffer_load_dwordx4 v27, s[16:19], s56 offen lds
ds_read_b64_tr_b16 v[240:241], v44 offset:28672
ds_read_b64_tr_b16 v[242:243], v44 offset:29696
ds_read_b64_tr_b16 v[244:245], v46 offset:28672
ds_read_b64_tr_b16 v[246:247], v46 offset:29696
ds_read_b64_tr_b16 v[248:249], v45 offset:28672
ds_read_b64_tr_b16 v[250:251], v45 offset:29696
ds_read_b64_tr_b16 v[252:253], v47 offset:28672
ds_read_b64_tr_b16 v[254:255], v47 offset:29696
ds_read_b64_tr_b16 v[60:61], v31 offset:36864
ds_read_b64_tr_b16 v[62:63], v31 offset:36992
ds_read_b64_tr_b16 v[64:65], v31 offset:37376
ds_read_b64_tr_b16 v[66:67], v31 offset:37504
ds_read_b64_tr_b16 v[68:69], v31 offset:38912
ds_read_b64_tr_b16 v[70:71], v31 offset:39040
ds_read_b64_tr_b16 v[72:73], v31 offset:39424
ds_read_b64_tr_b16 v[74:75], v31 offset:39552
s_waitcnt lgkmcnt(0)
ds_write_b128 v2, v[60:63] offset:36864
ds_write_b128 v2, v[64:67] offset:37888
ds_write_b128 v2, v[68:71] offset:38912
ds_write_b128 v2, v[72:75] offset:39936
s_waitcnt lgkmcnt(0)
s_waitcnt vmcnt(25)
s_barrier
s_add_u32 s56, s54, 2097152
s_mov_b32 m0, 45056
s_nop 0
buffer_load_dwordx4 v26, s[16:19], s56 offen lds
s_add_u32 s56, s54, 2113536
s_mov_b32 m0, 46080
s_nop 0
buffer_load_dwordx4 v26, s[16:19], s56 offen lds
s_add_u32 s56, s54, 2129920
s_mov_b32 m0, 47104
s_nop 0
buffer_load_dwordx4 v27, s[16:19], s56 offen lds
s_add_u32 s56, s54, 2146304
s_mov_b32 m0, 48128
s_nop 0
buffer_load_dwordx4 v27, s[16:19], s56 offen lds
ds_read_b64_tr_b16 a[0:1], v44 offset:0
ds_read_b64_tr_b16 a[2:3], v44 offset:1024
ds_read_b64_tr_b16 a[4:5], v46 offset:0
ds_read_b64_tr_b16 a[6:7], v46 offset:1024
ds_read_b64_tr_b16 a[8:9], v45 offset:0
ds_read_b64_tr_b16 a[10:11], v45 offset:1024
ds_read_b64_tr_b16 a[12:13], v47 offset:0
ds_read_b64_tr_b16 a[14:15], v47 offset:1024
s_waitcnt lgkmcnt(0)
s_waitcnt vmcnt(25)
s_barrier
s_add_u32 s56, s54, 2621440
s_mov_b32 m0, 16384
s_nop 0
buffer_load_dwordx4 v26, s[16:19], s56 offen lds
s_add_u32 s56, s54, 2637824
s_mov_b32 m0, 17408
s_nop 0
buffer_load_dwordx4 v26, s[16:19], s56 offen lds
s_add_u32 s56, s54, 2654208
s_mov_b32 m0, 18432
s_nop 0
buffer_load_dwordx4 v27, s[16:19], s56 offen lds
s_add_u32 s56, s54, 2670592
s_mov_b32 m0, 19456
s_nop 0
buffer_load_dwordx4 v27, s[16:19], s56 offen lds
ds_read_b64_tr_b16 a[16:17], v44 offset:4096
ds_read_b64_tr_b16 a[18:19], v44 offset:5120
ds_read_b64_tr_b16 a[20:21], v46 offset:4096
ds_read_b64_tr_b16 a[22:23], v46 offset:5120
ds_read_b64_tr_b16 a[24:25], v45 offset:4096
ds_read_b64_tr_b16 a[26:27], v45 offset:5120
ds_read_b64_tr_b16 a[28:29], v47 offset:4096
ds_read_b64_tr_b16 a[30:31], v47 offset:5120
s_waitcnt lgkmcnt(0)
s_waitcnt vmcnt(25)
s_barrier
s_add_u32 s56, s54, 3145728
s_mov_b32 m0, 20480
s_nop 0
buffer_load_dwordx4 v26, s[16:19], s56 offen lds
s_add_u32 s56, s54, 3162112
s_mov_b32 m0, 21504
s_nop 0
buffer_load_dwordx4 v26, s[16:19], s56 offen lds
s_add_u32 s56, s54, 3178496
s_mov_b32 m0, 22528
s_nop 0
buffer_load_dwordx4 v27, s[16:19], s56 offen lds
s_add_u32 s56, s54, 3194880
s_mov_b32 m0, 23552
s_nop 0
buffer_load_dwordx4 v27, s[16:19], s56 offen lds
ds_read_b64_tr_b16 a[32:33], v44 offset:8192
ds_read_b64_tr_b16 a[34:35], v44 offset:9216
ds_read_b64_tr_b16 a[36:37], v46 offset:8192
ds_read_b64_tr_b16 a[38:39], v46 offset:9216
ds_read_b64_tr_b16 a[40:41], v45 offset:8192
ds_read_b64_tr_b16 a[42:43], v45 offset:9216
ds_read_b64_tr_b16 a[44:45], v47 offset:8192
ds_read_b64_tr_b16 a[46:47], v47 offset:9216
s_waitcnt lgkmcnt(0)
s_waitcnt vmcnt(24)
s_barrier
s_add_u32 s56, s54, 3670016
s_mov_b32 m0, 24576
s_nop 0
buffer_load_dwordx4 v26, s[16:19], s56 offen lds
s_add_u32 s56, s54, 3686400
s_mov_b32 m0, 25600
s_nop 0
buffer_load_dwordx4 v26, s[16:19], s56 offen lds
s_add_u32 s56, s54, 3702784
s_mov_b32 m0, 26624
s_nop 0
buffer_load_dwordx4 v27, s[16:19], s56 offen lds
s_add_u32 s56, s54, 3719168
s_mov_b32 m0, 27648
s_nop 0
buffer_load_dwordx4 v27, s[16:19], s56 offen lds
ds_read_b64_tr_b16 a[48:49], v44 offset:12288
ds_read_b64_tr_b16 a[50:51], v44 offset:13312
ds_read_b64_tr_b16 a[52:53], v46 offset:12288
ds_read_b64_tr_b16 a[54:55], v46 offset:13312
ds_read_b64_tr_b16 a[56:57], v45 offset:12288
ds_read_b64_tr_b16 a[58:59], v45 offset:13312
ds_read_b64_tr_b16 a[60:61], v47 offset:12288
ds_read_b64_tr_b16 a[62:63], v47 offset:13312
s_waitcnt lgkmcnt(0)
s_waitcnt vmcnt(24)
s_barrier
s_add_u32 s56, s55, 73728
s_mov_b32 m0, 28672
s_nop 0
buffer_load_dwordx4 v28, s[20:23], s56 offen lds
s_add_u32 s56, s55, 76032
s_mov_b32 m0, 29696
s_nop 0
buffer_load_dwordx4 v28, s[20:23], s56 offen lds
s_add_u32 s56, s55, 82944
s_mov_b32 m0, 30720
s_nop 0
buffer_load_dwordx4 v28, s[20:23], s56 offen lds
s_add_u32 s56, s55, 85248
s_mov_b32 m0, 31744
s_nop 0
buffer_load_dwordx4 v28, s[20:23], s56 offen lds
ds_read_b64_tr_b16 a[64:65], v44 offset:16384
ds_read_b64_tr_b16 a[66:67], v44 offset:17408
ds_read_b64_tr_b16 a[68:69], v46 offset:16384
ds_read_b64_tr_b16 a[70:71], v46 offset:17408
ds_read_b64_tr_b16 a[72:73], v45 offset:16384
ds_read_b64_tr_b16 a[74:75], v45 offset:17408
ds_read_b64_tr_b16 a[76:77], v47 offset:16384
ds_read_b64_tr_b16 a[78:79], v47 offset:17408
s_waitcnt lgkmcnt(0)
s_waitcnt vmcnt(24)
s_barrier
s_add_u32 s56, s55, 73984
s_mov_b32 m0, 32768
s_nop 0
buffer_load_dwordx4 v28, s[20:23], s56 offen lds
s_add_u32 s56, s55, 76288
s_mov_b32 m0, 33792
s_nop 0
buffer_load_dwordx4 v28, s[20:23], s56 offen lds
s_add_u32 s56, s55, 83200
s_mov_b32 m0, 34816
s_nop 0
buffer_load_dwordx4 v28, s[20:23], s56 offen lds
s_add_u32 s56, s55, 85504
s_mov_b32 m0, 35840
s_nop 0
buffer_load_dwordx4 v28, s[20:23], s56 offen lds
ds_read_b64_tr_b16 a[80:81], v44 offset:20480
ds_read_b64_tr_b16 a[82:83], v44 offset:21504
ds_read_b64_tr_b16 a[84:85], v46 offset:20480
ds_read_b64_tr_b16 a[86:87], v46 offset:21504
ds_read_b64_tr_b16 a[88:89], v45 offset:20480
ds_read_b64_tr_b16 a[90:91], v45 offset:21504
ds_read_b64_tr_b16 a[92:93], v47 offset:20480
ds_read_b64_tr_b16 a[94:95], v47 offset:21504
s_waitcnt lgkmcnt(0)
s_waitcnt vmcnt(24)
s_barrier
s_add_u32 s56, s55, 74240
s_mov_b32 m0, 36864
s_nop 0
buffer_load_dwordx4 v28, s[20:23], s56 offen lds
s_add_u32 s56, s55, 76544
s_mov_b32 m0, 37888
s_nop 0
buffer_load_dwordx4 v28, s[20:23], s56 offen lds
s_add_u32 s56, s55, 83456
s_mov_b32 m0, 38912
s_nop 0
buffer_load_dwordx4 v28, s[20:23], s56 offen lds
s_add_u32 s56, s55, 85760
s_mov_b32 m0, 39936
s_nop 0
buffer_load_dwordx4 v28, s[20:23], s56 offen lds
ds_read_b64_tr_b16 a[96:97], v44 offset:24576
ds_read_b64_tr_b16 a[98:99], v44 offset:25600
ds_read_b64_tr_b16 a[100:101], v46 offset:24576
ds_read_b64_tr_b16 a[102:103], v46 offset:25600
ds_read_b64_tr_b16 a[104:105], v45 offset:24576
ds_read_b64_tr_b16 a[106:107], v45 offset:25600
ds_read_b64_tr_b16 a[108:109], v47 offset:24576
ds_read_b64_tr_b16 a[110:111], v47 offset:25600
s_waitcnt lgkmcnt(0)
s_waitcnt vmcnt(24)
s_barrier
s_add_u32 s56, s55, 74496
s_mov_b32 m0, 40960
s_nop 0
buffer_load_dwordx4 v28, s[20:23], s56 offen lds
s_add_u32 s56, s55, 76800
s_mov_b32 m0, 41984
s_nop 0
buffer_load_dwordx4 v28, s[20:23], s56 offen lds
s_add_u32 s56, s55, 83712
s_mov_b32 m0, 43008
s_nop 0
buffer_load_dwordx4 v28, s[20:23], s56 offen lds
s_add_u32 s56, s55, 86016
s_mov_b32 m0, 44032
s_nop 0
buffer_load_dwordx4 v28, s[20:23], s56 offen lds
ds_read_b64_tr_b16 a[112:113], v44 offset:28672
ds_read_b64_tr_b16 a[114:115], v44 offset:29696
ds_read_b64_tr_b16 a[116:117], v46 offset:28672
ds_read_b64_tr_b16 a[118:119], v46 offset:29696
ds_read_b64_tr_b16 a[120:121], v45 offset:28672
ds_read_b64_tr_b16 a[122:123], v45 offset:29696
ds_read_b64_tr_b16 a[124:125], v47 offset:28672
ds_read_b64_tr_b16 a[126:127], v47 offset:29696
s_waitcnt lgkmcnt(0)
s_waitcnt vmcnt(24)
s_barrier
s_add_u32 s56, s55, 0
s_mov_b32 m0, 45056
s_nop 0
buffer_load_dwordx4 v28, s[20:23], s56 offen lds
s_add_u32 s56, s55, 2304
s_mov_b32 m0, 46080
s_nop 0
buffer_load_dwordx4 v28, s[20:23], s56 offen lds
s_add_u32 s56, s55, 9216
s_mov_b32 m0, 47104
s_nop 0
buffer_load_dwordx4 v28, s[20:23], s56 offen lds
s_add_u32 s56, s55, 11520
s_mov_b32 m0, 48128
s_nop 0
buffer_load_dwordx4 v28, s[20:23], s56 offen lds
ds_read_b64_tr_b16 a[128:129], v44 offset:0
ds_read_b64_tr_b16 a[130:131], v44 offset:1024
ds_read_b64_tr_b16 a[132:133], v46 offset:0
ds_read_b64_tr_b16 a[134:135], v46 offset:1024
ds_read_b64_tr_b16 a[136:137], v45 offset:0
ds_read_b64_tr_b16 a[138:139], v45 offset:1024
ds_read_b64_tr_b16 a[140:141], v47 offset:0
ds_read_b64_tr_b16 a[142:143], v47 offset:1024
buffer_load_dword v32, v24, s[28:31], 0 offen sc0 sc1
s_waitcnt lgkmcnt(0)
s_waitcnt vmcnt(25)
s_barrier
s_add_u32 s56, s54, 0
s_mov_b32 m0, 16384
s_nop 0
buffer_load_dwordx4 v26, s[8:11], s56 offen lds
s_add_u32 s56, s54, 16384
s_mov_b32 m0, 17408
s_nop 0
buffer_load_dwordx4 v26, s[8:11], s56 offen lds
s_add_u32 s56, s54, 32768
s_mov_b32 m0, 18432
s_nop 0
buffer_load_dwordx4 v27, s[8:11], s56 offen lds
s_add_u32 s56, s54, 49152
s_mov_b32 m0, 19456
s_nop 0
buffer_load_dwordx4 v27, s[8:11], s56 offen lds
ds_read_b64_tr_b16 a[144:145], v44 offset:4096
ds_read_b64_tr_b16 a[146:147], v44 offset:5120
ds_read_b64_tr_b16 a[148:149], v46 offset:4096
ds_read_b64_tr_b16 a[150:151], v46 offset:5120
ds_read_b64_tr_b16 a[152:153], v45 offset:4096
ds_read_b64_tr_b16 a[154:155], v45 offset:5120
ds_read_b64_tr_b16 a[156:157], v47 offset:4096
ds_read_b64_tr_b16 a[158:159], v47 offset:5120
s_waitcnt lgkmcnt(0)
s_waitcnt vmcnt(25)
s_barrier
s_add_u32 s56, s54, 1572864
s_mov_b32 m0, 20480
s_nop 0
buffer_load_dwordx4 v26, s[8:11], s56 offen lds
s_add_u32 s56, s54, 1589248
s_mov_b32 m0, 21504
s_nop 0
buffer_load_dwordx4 v26, s[8:11], s56 offen lds
s_add_u32 s56, s54, 1605632
s_mov_b32 m0, 22528
s_nop 0
buffer_load_dwordx4 v27, s[8:11], s56 offen lds
s_add_u32 s56, s54, 1622016
s_mov_b32 m0, 23552
s_nop 0
buffer_load_dwordx4 v27, s[8:11], s56 offen lds
ds_read_b64_tr_b16 a[160:161], v44 offset:8192
ds_read_b64_tr_b16 a[162:163], v44 offset:9216
ds_read_b64_tr_b16 a[164:165], v46 offset:8192
ds_read_b64_tr_b16 a[166:167], v46 offset:9216
ds_read_b64_tr_b16 a[168:169], v45 offset:8192
ds_read_b64_tr_b16 a[170:171], v45 offset:9216
ds_read_b64_tr_b16 a[172:173], v47 offset:8192
ds_read_b64_tr_b16 a[174:175], v47 offset:9216
s_waitcnt lgkmcnt(0)
s_waitcnt vmcnt(25)
s_barrier
s_add_u32 s56, s54, 2097152
s_mov_b32 m0, 24576
s_nop 0
buffer_load_dwordx4 v26, s[8:11], s56 offen lds
s_add_u32 s56, s54, 2113536
s_mov_b32 m0, 25600
s_nop 0
buffer_load_dwordx4 v26, s[8:11], s56 offen lds
s_add_u32 s56, s54, 2129920
s_mov_b32 m0, 26624
s_nop 0
buffer_load_dwordx4 v27, s[8:11], s56 offen lds
s_add_u32 s56, s54, 2146304
s_mov_b32 m0, 27648
s_nop 0
buffer_load_dwordx4 v27, s[8:11], s56 offen lds
ds_read_b64_tr_b16 a[184:185], v48 offset:12288
ds_read_b64_tr_b16 a[186:187], v48 offset:13312
ds_read_b64_tr_b16 a[188:189], v48 offset:14336
ds_read_b64_tr_b16 a[190:191], v48 offset:15360
ds_read_b64_tr_b16 a[200:201], v49 offset:12288
ds_read_b64_tr_b16 a[202:203], v49 offset:13312
ds_read_b64_tr_b16 a[204:205], v49 offset:14336
ds_read_b64_tr_b16 a[206:207], v49 offset:15360
s_waitcnt lgkmcnt(0)
s_waitcnt vmcnt(25)
s_barrier
s_add_u32 s56, s54, 2621440
s_mov_b32 m0, 28672
s_nop 0
buffer_load_dwordx4 v26, s[12:15], s56 offen lds
s_add_u32 s56, s54, 2637824
s_mov_b32 m0, 29696
s_nop 0
buffer_load_dwordx4 v26, s[12:15], s56 offen lds
s_add_u32 s56, s54, 2654208
s_mov_b32 m0, 30720
s_nop 0
buffer_load_dwordx4 v27, s[12:15], s56 offen lds
s_add_u32 s56, s54, 2670592
s_mov_b32 m0, 31744
s_nop 0
buffer_load_dwordx4 v27, s[12:15], s56 offen lds
ds_read_b64_tr_b16 a[208:209], v48 offset:16384
ds_read_b64_tr_b16 a[210:211], v48 offset:17408
ds_read_b64_tr_b16 a[212:213], v48 offset:18432
ds_read_b64_tr_b16 a[214:215], v48 offset:19456
ds_read_b64_tr_b16 a[216:217], v49 offset:16384
ds_read_b64_tr_b16 a[218:219], v49 offset:17408
ds_read_b64_tr_b16 a[220:221], v49 offset:18432
ds_read_b64_tr_b16 a[222:223], v49 offset:19456
s_waitcnt lgkmcnt(0)
s_waitcnt vmcnt(25)
s_barrier
s_add_u32 s56, s54, 4194304
s_mov_b32 m0, 32768
s_nop 0
buffer_load_dwordx4 v26, s[16:19], s56 offen lds
s_add_u32 s56, s54, 4210688
s_mov_b32 m0, 33792
s_nop 0
buffer_load_dwordx4 v26, s[16:19], s56 offen lds
s_add_u32 s56, s54, 4227072
s_mov_b32 m0, 34816
s_nop 0
buffer_load_dwordx4 v27, s[16:19], s56 offen lds
s_add_u32 s56, s54, 4243456
s_mov_b32 m0, 35840
s_nop 0
buffer_load_dwordx4 v27, s[16:19], s56 offen lds
ds_read_b64_tr_b16 a[224:225], v48 offset:20480
ds_read_b64_tr_b16 a[226:227], v48 offset:21504
ds_read_b64_tr_b16 a[228:229], v48 offset:22528
ds_read_b64_tr_b16 a[230:231], v48 offset:23552
ds_read_b64_tr_b16 a[232:233], v49 offset:20480
ds_read_b64_tr_b16 a[234:235], v49 offset:21504
ds_read_b64_tr_b16 a[236:237], v49 offset:22528
ds_read_b64_tr_b16 a[238:239], v49 offset:23552
s_waitcnt lgkmcnt(0)
s_waitcnt vmcnt(25)
s_barrier
s_add_u32 s56, s55, 256
s_mov_b32 m0, 36864
s_nop 0
buffer_load_dwordx4 v28, s[20:23], s56 offen lds
s_add_u32 s56, s55, 2560
s_mov_b32 m0, 37888
s_nop 0
buffer_load_dwordx4 v28, s[20:23], s56 offen lds
s_add_u32 s56, s55, 9472
s_mov_b32 m0, 38912
s_nop 0
buffer_load_dwordx4 v28, s[20:23], s56 offen lds
s_add_u32 s56, s55, 11776
s_mov_b32 m0, 39936
s_nop 0
buffer_load_dwordx4 v28, s[20:23], s56 offen lds
ds_read_b64_tr_b16 a[240:241], v48 offset:24576
ds_read_b64_tr_b16 a[242:243], v48 offset:25600
ds_read_b64_tr_b16 a[244:245], v48 offset:26624
ds_read_b64_tr_b16 a[246:247], v48 offset:27648
ds_read_b64_tr_b16 a[248:249], v49 offset:24576
ds_read_b64_tr_b16 a[250:251], v49 offset:25600
ds_read_b64_tr_b16 a[252:253], v49 offset:26624
ds_read_b64_tr_b16 a[254:255], v49 offset:27648
s_waitcnt lgkmcnt(0)
s_waitcnt vmcnt(25)
s_barrier
s_add_u32 s56, s55, 512
s_mov_b32 m0, 40960
s_nop 0
buffer_load_dwordx4 v28, s[20:23], s56 offen lds
s_add_u32 s56, s55, 2816
s_mov_b32 m0, 41984
s_nop 0
buffer_load_dwordx4 v28, s[20:23], s56 offen lds
s_add_u32 s56, s55, 9728
s_mov_b32 m0, 43008
s_nop 0
buffer_load_dwordx4 v28, s[20:23], s56 offen lds
s_add_u32 s56, s55, 12032
s_mov_b32 m0, 44032
s_nop 0
buffer_load_dwordx4 v28, s[20:23], s56 offen lds
ds_read_b64_tr_b16 a[176:177], v48 offset:28672
ds_read_b64_tr_b16 a[178:179], v48 offset:29696
ds_read_b64_tr_b16 a[180:181], v48 offset:30720
ds_read_b64_tr_b16 a[182:183], v48 offset:31744
ds_read_b64_tr_b16 a[192:193], v49 offset:28672
ds_read_b64_tr_b16 a[194:195], v49 offset:29696
ds_read_b64_tr_b16 a[196:197], v49 offset:30720
ds_read_b64_tr_b16 a[198:199], v49 offset:31744
s_waitcnt lgkmcnt(0)
s_waitcnt vmcnt(24)
s_barrier
s_add_u32 s56, s55, 768
s_mov_b32 m0, 45056
s_nop 0
buffer_load_dwordx4 v28, s[20:23], s56 offen lds
s_add_u32 s56, s55, 3072
s_mov_b32 m0, 46080
s_nop 0
buffer_load_dwordx4 v28, s[20:23], s56 offen lds
s_add_u32 s56, s55, 9984
s_mov_b32 m0, 47104
s_nop 0
buffer_load_dwordx4 v28, s[20:23], s56 offen lds
s_add_u32 s56, s55, 12288
s_mov_b32 m0, 48128
s_nop 0
buffer_load_dwordx4 v28, s[20:23], s56 offen lds
ds_read_b64_tr_b16 v[60:61], v44 offset:0
ds_read_b64_tr_b16 v[62:63], v44 offset:1024
ds_read_b64_tr_b16 v[64:65], v46 offset:0
ds_read_b64_tr_b16 v[66:67], v46 offset:1024
ds_read_b64_tr_b16 v[68:69], v45 offset:0
ds_read_b64_tr_b16 v[70:71], v45 offset:1024
ds_read_b64_tr_b16 v[72:73], v47 offset:0
ds_read_b64_tr_b16 v[74:75], v47 offset:1024
s_waitcnt lgkmcnt(0)
s_waitcnt vmcnt(24)
s_barrier
ds_write_b128 v2, v[60:63] offset:0
ds_write_b128 v2, v[64:67] offset:1024
ds_write_b128 v2, v[68:71] offset:2048
ds_write_b128 v2, v[72:75] offset:3072
ds_read_b64_tr_b16 v[60:61], v44 offset:4096
ds_read_b64_tr_b16 v[62:63], v44 offset:5120
ds_read_b64_tr_b16 v[64:65], v46 offset:4096
ds_read_b64_tr_b16 v[66:67], v46 offset:5120
ds_read_b64_tr_b16 v[68:69], v45 offset:4096
ds_read_b64_tr_b16 v[70:71], v45 offset:5120
ds_read_b64_tr_b16 v[72:73], v47 offset:4096
ds_read_b64_tr_b16 v[74:75], v47 offset:5120
L_rdv_w0r:
v_readfirstlane_b32 s38, v32
s_nop 0
s_and_b32 s57, s38, 0xff
s_cmp_lg_u32 s57, 32
s_cbranch_scc1 L_rdv2_w0r
s_waitcnt lgkmcnt(0)
s_waitcnt vmcnt(20)
s_barrier
ds_write_b128 v2, v[60:63] offset:4096
ds_write_b128 v2, v[64:67] offset:5120
ds_write_b128 v2, v[68:71] offset:6144
ds_write_b128 v2, v[72:75] offset:7168
ds_read_b64_tr_b16 v[60:61], v44 offset:8192
ds_read_b64_tr_b16 v[62:63], v44 offset:9216
ds_read_b64_tr_b16 v[64:65], v46 offset:8192
ds_read_b64_tr_b16 v[66:67], v46 offset:9216
ds_read_b64_tr_b16 v[68:69], v45 offset:8192
ds_read_b64_tr_b16 v[70:71], v45 offset:9216
ds_read_b64_tr_b16 v[72:73], v47 offset:8192
ds_read_b64_tr_b16 v[74:75], v47 offset:9216
buffer_load_dwordx4 v[12:15], v9, s[4:7], s37 offen offset:0
buffer_load_dwordx4 v[16:19], v9, s[4:7], s37 offen offset:1024
buffer_load_dwordx4 v[52:55], v1, s[4:7], s37 offen offset:2048
buffer_load_dwordx4 v[56:59], v1, s[4:7], s37 offen offset:3072
s_mov_b32 m0, 1024
s_nop 0
buffer_load_dwordx4 v1, s[4:7], s47 offen offset:0 sc1 lds
buffer_load_dword v33, v1, s[4:7], s3 offen offset:0 sc1
buffer_load_dword v33, v1, s[4:7], s3 offen offset:1024 sc1
buffer_load_dword v33, v1, s[4:7], s3 offen offset:2048 sc1
buffer_load_dword v33, v1, s[4:7], s3 offen offset:3072 sc1
s_waitcnt lgkmcnt(0)
s_waitcnt vmcnt(25)
s_barrier
ds_write_b128 v2, v[60:63] offset:8192
ds_write_b128 v2, v[64:67] offset:9216
ds_write_b128 v2, v[68:71] offset:10240
ds_write_b128 v2, v[72:75] offset:11264
ds_read_b64_tr_b16 v[60:61], v44 offset:12288
ds_read_b64_tr_b16 v[62:63], v44 offset:13312
ds_read_b64_tr_b16 v[64:65], v46 offset:12288
ds_read_b64_tr_b16 v[66:67], v46 offset:13312
ds_read_b64_tr_b16 v[68:69], v45 offset:12288
ds_read_b64_tr_b16 v[70:71], v45 offset:13312
ds_read_b64_tr_b16 v[72:73], v47 offset:12288
ds_read_b64_tr_b16 v[74:75], v47 offset:13312
s_waitcnt lgkmcnt(0)
s_waitcnt vmcnt(21)
s_barrier
ds_write_b128 v2, v[60:63] offset:12288
ds_write_b128 v2, v[64:67] offset:13312
ds_write_b128 v2, v[68:71] offset:14336
ds_write_b128 v2, v[72:75] offset:15360
ds_read_b64_tr_b16 v[60:61], v44 offset:16384
ds_read_b64_tr_b16 v[62:63], v44 offset:17408
ds_read_b64_tr_b16 v[64:65], v46 offset:16384
ds_read_b64_tr_b16 v[66:67], v46 offset:17408
ds_read_b64_tr_b16 v[68:69], v45 offset:16384
ds_read_b64_tr_b16 v[70:71], v45 offset:17408
ds_read_b64_tr_b16 v[72:73], v47 offset:16384
ds_read_b64_tr_b16 v[74:75], v47 offset:17408
s_waitcnt lgkmcnt(0)
s_waitcnt vmcnt(17)
s_barrier
ds_write_b128 v2, v[60:63] offset:16384
ds_write_b128 v2, v[64:67] offset:17408
ds_write_b128 v2, v[68:71] offset:18432
ds_write_b128 v2, v[72:75] offset:19456
ds_read_b64_tr_b16 v[60:61], v48 offset:20480
ds_read_b64_tr_b16 v[62:63], v48 offset:21504
ds_read_b64_tr_b16 v[64:65], v48 offset:22528
ds_read_b64_tr_b16 v[66:67], v48 offset:23552
ds_read_b64_tr_b16 v[68:69], v49 offset:20480
ds_read_b64_tr_b16 v[70:71], v49 offset:21504
ds_read_b64_tr_b16 v[72:73], v49 offset:22528
ds_read_b64_tr_b16 v[74:75], v49 offset:23552
s_waitcnt lgkmcnt(0)
s_waitcnt vmcnt(13)
s_barrier
ds_write_b128 v2, v[60:63] offset:20480
ds_write_b128 v2, v[64:67] offset:21504
ds_write_b128 v2, v[68:71] offset:22528
ds_write_b128 v2, v[72:75] offset:23552
ds_read_b64_tr_b16 v[60:61], v48 offset:24576
ds_read_b64_tr_b16 v[62:63], v48 offset:25600
ds_read_b64_tr_b16 v[64:65], v48 offset:26624
ds_read_b64_tr_b16 v[66:67], v48 offset:27648
ds_read_b64_tr_b16 v[68:69], v49 offset:24576
ds_read_b64_tr_b16 v[70:71], v49 offset:25600
ds_read_b64_tr_b16 v[72:73], v49 offset:26624
ds_read_b64_tr_b16 v[74:75], v49 offset:27648
s_waitcnt lgkmcnt(0)
s_waitcnt vmcnt(9)
s_barrier
ds_write_b128 v2, v[60:63] offset:24576
ds_write_b128 v2, v[64:67] offset:25600
ds_write_b128 v2, v[68:71] offset:26624
ds_write_b128 v2, v[72:75] offset:27648
ds_read_b64_tr_b16 v[60:61], v48 offset:28672
ds_read_b64_tr_b16 v[62:63], v48 offset:29696
ds_read_b64_tr_b16 v[64:65], v48 offset:30720
ds_read_b64_tr_b16 v[66:67], v48 offset:31744
ds_read_b64_tr_b16 v[68:69], v49 offset:28672
ds_read_b64_tr_b16 v[70:71], v49 offset:29696
ds_read_b64_tr_b16 v[72:73], v49 offset:30720
ds_read_b64_tr_b16 v[74:75], v49 offset:31744
s_waitcnt lgkmcnt(0)
s_barrier
ds_write_b128 v2, v[60:63] offset:28672
ds_write_b128 v2, v[64:67] offset:29696
ds_write_b128 v2, v[68:71] offset:30720
ds_write_b128 v2, v[72:75] offset:31744
s_lshl_b32 s57, s58, 5
s_mov_b32 s0, 0x3f003f00
s_mov_b32 s1, 0x3f003f00
s_mov_b32 s58, 304128
s_cmp_eq_u32 s38, s57
s_mov_b32 s56, 0x33333333
s_mov_b32 s57, 0x33333333
s_mov_b32 s2, 0x21800000
s_mov_b32 s55, -24
s_cbranch_scc0 L_slow_w0r
v_mov_b64 v[20:21], 0
v_mov_b64 v[22:23], 0
v_mov_b64 v[24:25], 0
v_mov_b64 v[26:27], 0
v_mov_b64 v[28:29], 0
v_mov_b64 v[30:31], 0
v_mov_b64 v[32:33], 0
v_mov_b64 v[34:35], 0
v_mov_b64 v[36:37], 0
v_mov_b64 v[38:39], 0
v_mov_b64 v[40:41], 0
v_mov_b64 v[42:43], 0
ds_read_b128 v[44:47], v2 offset:0
ds_read_b128 v[48:51], v2 offset:1024
v_bfe_u32 v77, v1, 6, 1
v_lshl_add_u32 v77, v77, 3, v1
v_lshlrev_b32 v77, 1, v77
v_lshlrev_b32 v78, 3, v1
s_waitcnt vmcnt(0) lgkmcnt(0)
s_branch L_top_w0rf
L_done_w0rf:
s_mul_i32 s40, s34, 10240
s_add_u32 s40, s40, 8093696
buffer_store_dword v11, v10, s[4:7], s40 offen sc0 sc1
s_waitcnt vmcnt(0) lgkmcnt(0)
s_endpgm
L_rdv2_w0r:
buffer_load_dword v32, v24, s[28:31], 0 offen sc0 sc1
s_sub_u32 s41, s41, 1
s_cbranch_scc1 L_exit
s_waitcnt vmcnt(0)
s_branch L_rdv_w0r
L_ra0_w0rf:
s_mov_b32 m0, 1024
s_nop 0
buffer_load_dwordx4 v1, s[4:7], s47 offen offset:0 sc1 lds
buffer_load_dwordx4 v1, s[4:7], s47 offen offset:1024 sc1 lds
buffer_load_dwordx4 v1, s[4:7], s47 offen offset:2048 sc1 lds
buffer_load_dwordx4 v1, s[4:7], s47 offen offset:3072 sc1 lds
s_sub_u32 s41, s41, 1
s_cbranch_scc1 L_exit
ds_read_b128 v[44:47], v2 offset:0
ds_read_b128 v[48:51], v2 offset:1024
v_mov_b64 v[20:21], 0
v_mov_b64 v[22:23], 0
v_mov_b64 v[24:25], 0
v_mov_b64 v[26:27], 0
v_mov_b64 v[28:29], 0
v_mov_b64 v[30:31], 0
v_mov_b64 v[32:33], 0
v_mov_b64 v[34:35], 0
v_mov_b64 v[36:37], 0
v_mov_b64 v[38:39], 0
v_mov_b64 v[40:41], 0
v_mov_b64 v[42:43], 0
s_waitcnt vmcnt(0)
ds_read_b128 v[60:63], v1 offset:1024
ds_read_b128 v[64:67], v1 offset:2048
ds_read_b128 v[68:71], v1 offset:3072
ds_read_b128 v[72:75], v1 offset:4096
s_branch L_s0_w0rf
L_ra1_w0rf:
L_ra2_w0rf:
s_waitcnt lgkmcnt(0)
s_barrier
s_mov_b32 m0, 5120
s_nop 0
buffer_load_dwordx4 v1, s[4:7], s48 offen offset:0 sc1 lds
s_mov_b32 m0, 9216
s_nop 0
buffer_load_dwordx4 v1, s[4:7], s49 offen offset:0 sc1 lds
s_sub_u32 s41, s41, 1
s_cbranch_scc1 L_exit
s_waitcnt vmcnt(0)
s_barrier
ds_read_b128 v[76:79], v1 offset:5120
ds_read_b128 v[60:63], v1 offset:6144
ds_read_b128 v[64:67], v1 offset:7168
ds_read_b128 v[68:71], v1 offset:8192
ds_read_b128 v[72:75], v1 offset:9216
s_waitcnt lgkmcnt(0)
v_bitop3_b32 v6, v76, v60, s35 bitop3:0x7e
v_bitop3_b32 v6, v6, v64, s35 bitop3:0xf6
v_bitop3_b32 v6, v6, v68, s35 bitop3:0xf6
v_bitop3_b32 v6, v6, v72, s35 bitop3:0xf6
v_and_b32 v6, 1, v6
v_cmp_ne_u32 vcc, 0, v6

s_cbranch_vccnz L_ra2_w0rf
s_branch L_a1_w0rf
L_mx_w0rf:
s_waitcnt lgkmcnt(0)
v_max3_f32 v30, v12, v13, v28
v_max_f32 v30, v30, v29
v_mov_b32 v31, v30
s_nop 1
v_permlane16_swap_b32 v30, v31
v_max_f32 v30, v30, v31
v_mov_b32 v31, v30
s_nop 1
v_permlane32_swap_b32 v30, v31
v_max_f32 v30, v30, v31
ds_write_b32 v1, v30 offset:10240
s_waitcnt lgkmcnt(0)
s_barrier
ds_read_b128 v[32:35], v1 offset:10240
s_waitcnt lgkmcnt(0)
v_max3_f32 v32, v32, v33, v34
v_max_f32 v32, v32, v35
v_sub_f32 v14, v12, v32
v_sub_f32 v15, v13, v32
v_sub_f32 v30, v28, v32
v_sub_f32 v31, v29, v32
v_exp_f32 v14, v14
v_exp_f32 v15, v15
v_exp_f32 v30, v30
v_exp_f32 v31, v31
v_cvt_pk_bf16_f32 v14, v14, v15
v_cvt_pk_bf16_f32 v30, v30, v31
ds_write_b32 v5, v14 offset:14368
v_cndmask_b32_e64 v26, 0, v30, s[56:57]
v_cndmask_b32_e64 v27, 0, v30, s[56:57]
v_mov_b64 v[76:77], s[52:53]
v_mov_b64 v[78:79], s[52:53]
v_mov_b32_dpp v24, v26 quad_perm:[2,3,0,1] row_mask:0xf bank_mask:0xf
v_mov_b32_dpp v25, v26 quad_perm:[2,3,0,1] row_mask:0xf bank_mask:0xf
s_waitcnt lgkmcnt(0)
s_barrier
v_mov_b64 v[14:15], s[0:1]
ds_read_b128 v[16:19], v1 offset:14368
ds_read_b128 v[36:39], v1 offset:14336
s_waitcnt lgkmcnt(0)
v_mfma_f32_16x16x32_bf16 v[32:35], v[76:79], v[16:19], 0
v_mfma_f32_16x16x32_bf16 v[20:23], v[52:55], v[16:19], 0
v_mfma_f32_16x16x32_bf16 v[20:23], v[56:59], v[36:39], v[20:23]
v_mfma_f32_16x16x16_bf16 v[32:35], v[14:15], v[26:27], v[32:35]
v_mfma_f32_16x16x32_bf16 v[20:23], v[40:43], v[24:27], v[20:23]
s_nop 3
v_rcp_f32 v33, v32
s_nop 2
v_mul_f32_dpp v20, v33, v20 quad_perm:[0,1,0,1] row_mask:0xf bank_mask:0xf
v_mul_f32_dpp v21, v33, v21 quad_perm:[0,1,0,1] row_mask:0xf bank_mask:0xf
v_mul_f32_dpp v22, v33, v22 quad_perm:[0,1,0,1] row_mask:0xf bank_mask:0xf
v_mul_f32_dpp v23, v33, v23 quad_perm:[0,1,0,1] row_mask:0xf bank_mask:0xf
v_cvt_pk_bf16_f32 v20, v20, v21
v_cvt_pk_bf16_f32 v21, v22, v23
ds_write_b64 v6, v[20:21] offset:5120
v_mov_b32_dpp v16, v20 quad_perm:[0,1,0,1] row_mask:0xf bank_mask:0xf
v_mov_b32_dpp v17, v21 quad_perm:[0,1,0,1] row_mask:0xf bank_mask:0xf
v_mov_b32_dpp v18, v20 quad_perm:[2,3,2,3] row_mask:0xf bank_mask:0xf
v_mov_b32_dpp v19, v21 quad_perm:[2,3,2,3] row_mask:0xf bank_mask:0xf
v_mov_b64 v[76:77], 0
v_mov_b64 v[78:79], 0
v_mov_b64 v[36:37], 0
v_mov_b64 v[38:39], 0
v_mov_b64 v[24:25], 0
v_mov_b64 v[26:27], 0
v_mov_b64 v[32:33], 0
v_mov_b64 v[34:35], 0
s_waitcnt lgkmcnt(0)
s_branch L_mxb_w0rf

L_rr_w0rf:
buffer_load_dwordx4 v[60:63], v9, s[4:7], s3 offen offset:0 sc1
buffer_load_dwordx4 v[64:67], v9, s[4:7], s3 offen offset:1024 sc1
buffer_load_dwordx4 v[68:71], v9, s[4:7], s3 offen offset:2048 sc1
buffer_load_dwordx4 v[72:75], v9, s[4:7], s3 offen offset:3072 sc1
s_sub_u32 s41, s41, 1
s_cbranch_scc1 L_exit
s_waitcnt vmcnt(0)
s_branch L_r_w0rf
L_slow_w0r:
v_mov_b64 v[20:21], 0
v_mov_b64 v[22:23], 0
v_mov_b64 v[24:25], 0
v_mov_b64 v[26:27], 0
v_mov_b64 v[28:29], 0
v_mov_b64 v[30:31], 0
v_mov_b64 v[32:33], 0
v_mov_b64 v[34:35], 0
v_mov_b64 v[36:37], 0
v_mov_b64 v[38:39], 0
v_mov_b64 v[40:41], 0
v_mov_b64 v[42:43], 0
ds_read_b128 v[44:47], v2 offset:0
ds_read_b128 v[48:51], v2 offset:1024
v_bfe_u32 v77, v1, 6, 1
v_lshl_add_u32 v77, v77, 3, v1
v_lshlrev_b32 v77, 1, v77
v_lshlrev_b32 v78, 3, v1
s_waitcnt vmcnt(0) lgkmcnt(0)
s_branch L_top_w0rs
L_done_w0rs:
s_mul_i32 s40, s34, 10240
s_add_u32 s40, s40, 8093696
buffer_store_dword v11, v10, s[4:7], s40 offen sc0 sc1
s_waitcnt vmcnt(0) lgkmcnt(0)
s_endpgm
L_ra0_w0rs:
s_mov_b32 m0, 1024
s_nop 0
buffer_load_dwordx4 v1, s[4:7], s47 offen offset:0 sc0 sc1 lds
buffer_load_dwordx4 v1, s[4:7], s47 offen offset:1024 sc0 sc1 lds
buffer_load_dwordx4 v1, s[4:7], s47 offen offset:2048 sc0 sc1 lds
buffer_load_dwordx4 v1, s[4:7], s47 offen offset:3072 sc0 sc1 lds
s_sub_u32 s41, s41, 1
s_cbranch_scc1 L_exit
ds_read_b128 v[44:47], v2 offset:0
ds_read_b128 v[48:51], v2 offset:1024
v_mov_b64 v[20:21], 0
v_mov_b64 v[22:23], 0
v_mov_b64 v[24:25], 0
v_mov_b64 v[26:27], 0
v_mov_b64 v[28:29], 0
v_mov_b64 v[30:31], 0
v_mov_b64 v[32:33], 0
v_mov_b64 v[34:35], 0
v_mov_b64 v[36:37], 0
v_mov_b64 v[38:39], 0
v_mov_b64 v[40:41], 0
v_mov_b64 v[42:43], 0
s_waitcnt vmcnt(0)
ds_read_b128 v[60:63], v1 offset:1024
ds_read_b128 v[64:67], v1 offset:2048
ds_read_b128 v[68:71], v1 offset:3072
ds_read_b128 v[72:75], v1 offset:4096
s_branch L_s0_w0rs
L_ra1_w0rs:
L_ra2_w0rs:
s_waitcnt lgkmcnt(0)
s_barrier
s_mov_b32 m0, 5120
s_nop 0
buffer_load_dwordx4 v1, s[4:7], s48 offen offset:0 sc0 sc1 lds
s_mov_b32 m0, 9216
s_nop 0
buffer_load_dwordx4 v1, s[4:7], s49 offen offset:0 sc0 sc1 lds
s_sub_u32 s41, s41, 1
s_cbranch_scc1 L_exit
s_waitcnt vmcnt(0)
s_barrier
ds_read_b128 v[76:79], v1 offset:5120
ds_read_b128 v[60:63], v1 offset:6144
ds_read_b128 v[64:67], v1 offset:7168
ds_read_b128 v[68:71], v1 offset:8192
ds_read_b128 v[72:75], v1 offset:9216
s_waitcnt lgkmcnt(0)
v_bitop3_b32 v6, v76, v60, s35 bitop3:0x7e
v_bitop3_b32 v6, v6, v64, s35 bitop3:0xf6
v_bitop3_b32 v6, v6, v68, s35 bitop3:0xf6
v_bitop3_b32 v6, v6, v72, s35 bitop3:0xf6
v_and_b32 v6, 1, v6
v_cmp_ne_u32 vcc, 0, v6

s_cbranch_vccnz L_ra2_w0rs
s_branch L_a1_w0rs
L_mx_w0rs:
s_waitcnt lgkmcnt(0)
v_max3_f32 v30, v12, v13, v28
v_max_f32 v30, v30, v29
v_mov_b32 v31, v30
s_nop 1
v_permlane16_swap_b32 v30, v31
v_max_f32 v30, v30, v31
v_mov_b32 v31, v30
s_nop 1
v_permlane32_swap_b32 v30, v31
v_max_f32 v30, v30, v31
ds_write_b32 v1, v30 offset:10240
s_waitcnt lgkmcnt(0)
s_barrier
ds_read_b128 v[32:35], v1 offset:10240
s_waitcnt lgkmcnt(0)
v_max3_f32 v32, v32, v33, v34
v_max_f32 v32, v32, v35
v_sub_f32 v14, v12, v32
v_sub_f32 v15, v13, v32
v_sub_f32 v30, v28, v32
v_sub_f32 v31, v29, v32
v_exp_f32 v14, v14
v_exp_f32 v15, v15
v_exp_f32 v30, v30
v_exp_f32 v31, v31
v_cvt_pk_bf16_f32 v14, v14, v15
v_cvt_pk_bf16_f32 v30, v30, v31
ds_write_b32 v5, v14 offset:14368
v_cndmask_b32_e64 v26, 0, v30, s[56:57]
v_cndmask_b32_e64 v27, 0, v30, s[56:57]
v_mov_b64 v[76:77], s[52:53]
v_mov_b64 v[78:79], s[52:53]
v_mov_b32_dpp v24, v26 quad_perm:[2,3,0,1] row_mask:0xf bank_mask:0xf
v_mov_b32_dpp v25, v26 quad_perm:[2,3,0,1] row_mask:0xf bank_mask:0xf
s_waitcnt lgkmcnt(0)
s_barrier
v_mov_b64 v[14:15], s[0:1]
ds_read_b128 v[16:19], v1 offset:14368
ds_read_b128 v[36:39], v1 offset:14336
s_waitcnt lgkmcnt(0)
v_mfma_f32_16x16x32_bf16 v[32:35], v[76:79], v[16:19], 0
v_mfma_f32_16x16x32_bf16 v[20:23], v[52:55], v[16:19], 0
v_mfma_f32_16x16x32_bf16 v[20:23], v[56:59], v[36:39], v[20:23]
v_mfma_f32_16x16x16_bf16 v[32:35], v[14:15], v[26:27], v[32:35]
v_mfma_f32_16x16x32_bf16 v[20:23], v[40:43], v[24:27], v[20:23]
s_nop 3
v_rcp_f32 v33, v32
s_nop 2
v_mul_f32_dpp v20, v33, v20 quad_perm:[0,1,0,1] row_mask:0xf bank_mask:0xf
v_mul_f32_dpp v21, v33, v21 quad_perm:[0,1,0,1] row_mask:0xf bank_mask:0xf
v_mul_f32_dpp v22, v33, v22 quad_perm:[0,1,0,1] row_mask:0xf bank_mask:0xf
v_mul_f32_dpp v23, v33, v23 quad_perm:[0,1,0,1] row_mask:0xf bank_mask:0xf
v_cvt_pk_bf16_f32 v20, v20, v21
v_cvt_pk_bf16_f32 v21, v22, v23
ds_write_b64 v6, v[20:21] offset:5120
v_mov_b32_dpp v16, v20 quad_perm:[0,1,0,1] row_mask:0xf bank_mask:0xf
v_mov_b32_dpp v17, v21 quad_perm:[0,1,0,1] row_mask:0xf bank_mask:0xf
v_mov_b32_dpp v18, v20 quad_perm:[2,3,2,3] row_mask:0xf bank_mask:0xf
v_mov_b32_dpp v19, v21 quad_perm:[2,3,2,3] row_mask:0xf bank_mask:0xf
v_mov_b64 v[76:77], 0
v_mov_b64 v[78:79], 0
v_mov_b64 v[36:37], 0
v_mov_b64 v[38:39], 0
v_mov_b64 v[24:25], 0
v_mov_b64 v[26:27], 0
v_mov_b64 v[32:33], 0
v_mov_b64 v[34:35], 0
s_waitcnt lgkmcnt(0)
s_branch L_mxb_w0rs

L_rr_w0rs:
buffer_load_dwordx4 v[60:63], v9, s[4:7], s3 offen offset:0 sc0 sc1
buffer_load_dwordx4 v[64:67], v9, s[4:7], s3 offen offset:1024 sc0 sc1
buffer_load_dwordx4 v[68:71], v9, s[4:7], s3 offen offset:2048 sc0 sc1
buffer_load_dwordx4 v[72:75], v9, s[4:7], s3 offen offset:3072 sc0 sc1
s_sub_u32 s41, s41, 1
s_cbranch_scc1 L_exit
s_waitcnt vmcnt(0)
s_branch L_r_w0rs
L_pro_w1r:
v_and_b32 v20, 63, v0
v_lshlrev_b32 v1, 4, v20
v_add_u32 v2, 57344, v1
v_and_b32 v23, 1, v22
v_lshl_add_u32 v23, v24, 4, v23
v_mul_u32_u24 v23, 1152, v23
v_lshlrev_b32 v28, 2, v22
v_xor_b32 v28, v28, v21
v_lshl_add_u32 v28, v28, 4, v23
s_mul_i32 s55, s32, 147456
s_waitcnt lgkmcnt(0)
v_and_b32 v23, 1, v22
v_lshrrev_b32 v24, 2, v21
v_lshl_add_u32 v23, v23, 2, v24
v_lshlrev_b32 v23, 1, v23
v_bfe_u32 v44, v21, 1, 1
v_add_u32 v44, 4, v44
v_xor_b32 v44, v44, v23
v_lshlrev_b32 v44, 4, v44
v_lshl_add_u32 v44, v24, 8, v44
v_and_b32 v23, 1, v22
v_lshl_add_u32 v44, v23, 11, v44
v_and_b32 v23, 1, v21
v_lshl_add_u32 v44, v23, 3, v44
v_lshrrev_b32 v23, 1, v22
v_mul_u32_u24 v23, 40960, v23
v_add_u32 v23, 16384, v23
v_add_u32 v44, v44, v23
v_and_b32 v23, 1, v22
v_lshrrev_b32 v24, 2, v21
v_lshl_add_u32 v23, v23, 2, v24
v_lshlrev_b32 v23, 1, v23
v_bfe_u32 v45, v21, 1, 1
v_add_u32 v45, 6, v45
v_xor_b32 v45, v45, v23
v_lshlrev_b32 v45, 4, v45
v_lshl_add_u32 v45, v24, 8, v45
v_and_b32 v23, 1, v22
v_lshl_add_u32 v45, v23, 11, v45
v_and_b32 v23, 1, v21
v_lshl_add_u32 v45, v23, 3, v45
v_lshrrev_b32 v23, 1, v22
v_mul_u32_u24 v23, 40960, v23
v_add_u32 v23, 16384, v23
v_add_u32 v45, v45, v23
v_and_b32 v23, 1, v22
v_lshrrev_b32 v24, 2, v21
v_lshl_add_u32 v23, v23, 2, v24
v_lshlrev_b32 v23, 1, v23
v_bfe_u32 v46, v21, 1, 1
v_add_u32 v46, 4, v46
v_xor_b32 v46, v46, v23
v_lshlrev_b32 v46, 4, v46
v_lshl_add_u32 v46, v24, 8, v46
v_and_b32 v23, 1, v22
v_lshl_add_u32 v46, v23, 11, v46
v_and_b32 v23, 1, v21
v_lshl_add_u32 v46, v23, 3, v46
v_lshrrev_b32 v23, 1, v22
v_mul_u32_u24 v23, 32768, v23
v_add_u32 v23, 98304, v23
v_add_u32 v46, v46, v23
v_and_b32 v23, 1, v22
v_lshrrev_b32 v24, 2, v21
v_lshl_add_u32 v23, v23, 2, v24
v_lshlrev_b32 v23, 1, v23
v_bfe_u32 v47, v21, 1, 1
v_add_u32 v47, 6, v47
v_xor_b32 v47, v47, v23
v_lshlrev_b32 v47, 4, v47
v_lshl_add_u32 v47, v24, 8, v47
v_and_b32 v23, 1, v22
v_lshl_add_u32 v47, v23, 11, v47
v_and_b32 v23, 1, v21
v_lshl_add_u32 v47, v23, 3, v47
v_lshrrev_b32 v23, 1, v22
v_mul_u32_u24 v23, 32768, v23
v_add_u32 v23, 98304, v23
v_add_u32 v47, v47, v23
v_and_b32 v23, 1, v22
v_bfe_u32 v24, v21, 2, 1
v_lshl_add_u32 v23, v23, 1, v24
v_xor_b32 v24, 1, v23
v_lshlrev_b32 v24, 6, v24
v_lshl_add_u32 v48, v23, 8, v24
v_and_b32 v23, 3, v21
v_lshl_add_u32 v48, v23, 4, v48
v_and_b32 v23, 8, v21
v_add_u32 v48, v48, v23
v_lshrrev_b32 v23, 1, v22
v_mul_u32_u24 v23, 40960, v23
v_add_u32 v23, 16384, v23
v_add_u32 v48, v48, v23
v_and_b32 v23, 1, v22
v_bfe_u32 v24, v21, 2, 1
v_lshl_add_u32 v23, v23, 1, v24
v_xor_b32 v24, 1, v23
v_lshlrev_b32 v24, 6, v24
v_lshl_add_u32 v49, v23, 8, v24
v_and_b32 v23, 3, v21
v_lshl_add_u32 v49, v23, 4, v49
v_and_b32 v23, 8, v21
v_add_u32 v49, v49, v23
v_lshrrev_b32 v23, 1, v22
v_mul_u32_u24 v23, 32768, v23
v_add_u32 v23, 98304, v23
v_add_u32 v49, v49, v23
v_bfe_u32 v23, v21, 1, 1
v_mul_u32_u24 v23, 0xaaaa, v23
v_add_u32 v0, 0x4444, v23
v_lshlrev_b32 v3, 3, v20
v_lshrrev_b32 v25, 5, v20
v_lshlrev_b32 v25, 6, v25
v_xor_b32 v3, v3, v25
v_lshrrev_b32 v25, 2, v20
v_and_b32 v4, 3, v21
v_lshl_add_u32 v4, v4, 4, v25
v_lshlrev_b32 v4, 3, v4
v_bfe_u32 v25, v21, 1, 1
v_lshlrev_b32 v23, 6, v25
v_xor_b32 v4, v4, v23
v_lshlrev_b32 v5, 4, v21
v_lshl_add_u32 v5, v22, 2, v5
v_mul_u32_u24 v23, 768, v25
v_add_u32 v5, v5, v23
v_lshlrev_b32 v9, 8, v22
v_lshl_add_u32 v9, v25, 6, v9
v_bfe_u32 v23, v21, 3, 1
v_lshl_add_u32 v9, v23, 7, v9
v_bfe_u32 v23, v21, 2, 1
v_lshl_add_u32 v9, v23, 5, v9
v_and_b32 v23, 1, v21
v_lshl_add_u32 v9, v23, 4, v9
v_lshrrev_b32 v23, 1, v22
v_and_b32 v24, 1, v22
v_and_b32 v25, 7, v21
v_lshrrev_b32 v7, 3, v21
v_lshl_add_u32 v8, v7, 1, v23
v_lshlrev_b32 v8, 12, v8
v_lshl_add_u32 v8, v24, 7, v8
v_and_b32 v25, 4, v21
v_lshl_add_u32 v8, v25, 3, v8
v_and_b32 v25, 1, v21
v_lshl_add_u32 v8, v25, 4, v8
v_bfe_u32 v25, v21, 1, 1
v_lshl_add_u32 v8, v25, 3, v8
s_lshr_b32 s56, s32, 1
s_lshl_b32 s56, s56, 8
s_and_b32 s57, s32, 1
s_lshl_b32 s57, s57, 6
s_add_u32 s56, s56, s57
s_add_u32 s56, s56, 16384
v_add_u32 v8, s56, v8
v_and_b32 v7, 0x3d0, v1
s_mov_b32 s42, 0
s_mov_b32 s43, 65536
s_mov_b32 s44, 131072
s_mov_b32 s45, 196608
s_mov_b32 s46, 262144
s_mov_b32 s47, 294912
s_mov_b32 s48, 299008
s_mov_b32 s49, 303104
s_mov_b32 s50, 0x3e0293ee
s_mov_b32 s51, 0x3e0293ee
s_mov_b32 s52, 0x3f803f80
s_mov_b32 s53, 0x3f803f80
v_lshlrev_b32 v11, 2, v21
s_mov_b32 s34, 0
s_mov_b32 s35, -1
s_mov_b32 s36, 0
s_mov_b32 s41, 300000
s_lshl_b32 s37, s32, 14
s_add_u32 s39, s37, 17309696
s_add_u32 s37, s37, 16781312
s_mov_b32 s40, 8749056
v_mov_b64 v[36:37], 0
v_mov_b64 v[38:39], 0
ds_write_b128 v1, v[36:39] offset:15360
s_lshl_b32 s56, s32, 1
s_add_u32 s56, s56, 0
s_cmp_eq_u32 s56, 0
s_cselect_b32 s56, 64, s56
s_mul_i32 s56, s56, 10240
s_add_u32 s56, s56, 8392704
s_add_u32 s57, s56, 4096
v_mov_b32 v40, 0
v_mov_b32 v41, 0
v_mov_b32 v42, 0
v_mov_b32 v43, 0
buffer_store_dwordx4 v[40:43], v1, s[4:7], s56 offen offset:0 sc0 sc1
buffer_store_dwordx4 v[40:43], v1, s[4:7], s56 offen offset:1024 sc0 sc1
buffer_store_dwordx4 v[40:43], v1, s[4:7], s56 offen offset:2048 sc0 sc1
buffer_store_dwordx4 v[40:43], v1, s[4:7], s56 offen offset:3072 sc0 sc1
buffer_store_dwordx4 v[40:43], v1, s[4:7], s57 offen offset:0 sc0 sc1
s_add_u32 s56, s32, 32
s_lshl_b32 s3, s56, 12
v_and_b32 v23, 1, v21
v_bfe_u32 v24, v21, 2, 1
v_bfe_u32 v25, v21, 1, 1
s_lshl_b32 s57, s56, 7
s_add_u32 s57, s57, 294912
v_and_b32 v10, 7, v21
v_lshlrev_b32 v10, 2, v10
v_lshl_add_u32 v10, v22, 5, v10
v_add_u32 v10, s57, v10
s_lshl_b32 s33, s56, 2
s_add_u32 s33, s33, 304128
v_mov_b32 v30, -1
s_mov_b64 exec, 1
buffer_store_dword v30, v1, s[4:7], s33 offen sc0 sc1
s_mov_b64 exec, -1
v_lshl_add_u32 v23, v23, 1, v24
v_lshlrev_b32 v25, 4, v25
v_mov_b32 v24, 0x3f80
v_lshlrev_b32 v24, v25, v24
v_cmp_eq_u32 vcc, 0, v23
s_nop 1
v_cndmask_b32 v76, 0, v24, vcc
v_cmp_eq_u32 vcc, 1, v23
s_nop 1
v_cndmask_b32 v77, 0, v24, vcc
v_cmp_eq_u32 vcc, 2, v23
s_nop 1
v_cndmask_b32 v78, 0, v24, vcc
v_cmp_eq_u32 vcc, 3, v23
s_nop 1
v_cndmask_b32 v79, 0, v24, vcc
buffer_store_dwordx4 v[36:39], v9, s[4:7], s3 offen offset:0 sc0 sc1
buffer_store_dwordx4 v[36:39], v9, s[4:7], s3 offen offset:1024 sc0 sc1
buffer_store_dwordx4 v[36:39], v9, s[4:7], s3 offen offset:2048 sc0 sc1
buffer_store_dwordx4 v[36:39], v9, s[4:7], s3 offen offset:3072 sc0 sc1
s_getreg_b32 s56, hwreg(HW_REG_XCC_ID)
s_and_b32 s56, s56, 15
s_mul_i32 s57, s56, s56
s_lshl_b32 s57, s57, 18
s_lshl_b32 s56, s56, 8
s_add_u32 s57, s57, s56
s_add_u32 s58, s57, 1
s_lshl_b32 s101, s32, 7
s_add_u32 s101, s101, 327680
v_mov_b32 v24, 0
s_add_u32 s56, s54, 131072
s_mov_b32 m0, 69632
s_nop 0
buffer_load_dwordx4 v26, s[12:15], s56 offen lds
s_add_u32 s56, s54, 147456
s_mov_b32 m0, 70656
s_nop 0
buffer_load_dwordx4 v26, s[12:15], s56 offen lds
s_add_u32 s56, s54, 163840
s_mov_b32 m0, 71680
s_nop 0
buffer_load_dwordx4 v27, s[12:15], s56 offen lds
s_add_u32 s56, s54, 180224
s_mov_b32 m0, 72704
s_nop 0
buffer_load_dwordx4 v27, s[12:15], s56 offen lds
s_add_u32 s56, s54, 655360
s_mov_b32 m0, 73728
s_nop 0
buffer_load_dwordx4 v26, s[12:15], s56 offen lds
s_add_u32 s56, s54, 671744
s_mov_b32 m0, 74752
s_nop 0
buffer_load_dwordx4 v26, s[12:15], s56 offen lds
s_add_u32 s56, s54, 688128
s_mov_b32 m0, 75776
s_nop 0
buffer_load_dwordx4 v27, s[12:15], s56 offen lds
s_add_u32 s56, s54, 704512
s_mov_b32 m0, 76800
s_nop 0
buffer_load_dwordx4 v27, s[12:15], s56 offen lds
v_and_b32 v23, 3, v20
v_lshrrev_b32 v24, 2, v20
v_mul_u32_u24 v29, 1152, v24
v_lshl_add_u32 v29, v23, 4, v29
v_lshrrev_b32 v24, 2, v21
v_and_b32 v25, 1, v22
v_lshlrev_b32 v31, 10, v25
v_lshrrev_b32 v25, 1, v22
v_lshl_add_u32 v31, v25, 8, v31
v_and_b32 v25, 1, v24
v_lshl_add_u32 v31, v25, 6, v31
v_lshrrev_b32 v25, 1, v24
v_lshl_add_u32 v31, v25, 3, v31
v_lshl_add_u32 v31, v23, 4, v31
v_add_u32 v31, 57344, v31
s_add_u32 s56, s55, 1088
s_mov_b32 m0, 90112
s_nop 0
buffer_load_dwordx4 v29, s[20:23], s56 offen lds
s_add_u32 s56, s55, 19520
s_mov_b32 m0, 91136
s_nop 0
buffer_load_dwordx4 v29, s[20:23], s56 offen lds
s_add_u32 s56, s55, 37952
s_mov_b32 m0, 92160
s_nop 0
buffer_load_dwordx4 v29, s[20:23], s56 offen lds
s_add_u32 s56, s55, 56384
s_mov_b32 m0, 93184
s_nop 0
buffer_load_dwordx4 v29, s[20:23], s56 offen lds
s_add_u32 s56, s55, 74816
s_mov_b32 m0, 94208
s_nop 0
buffer_load_dwordx4 v29, s[20:23], s56 offen lds
s_add_u32 s56, s55, 93248
s_mov_b32 m0, 95232
s_nop 0
buffer_load_dwordx4 v29, s[20:23], s56 offen lds
s_add_u32 s56, s55, 111680
s_mov_b32 m0, 96256
s_nop 0
buffer_load_dwordx4 v29, s[20:23], s56 offen lds
s_add_u32 s56, s55, 130112
s_mov_b32 m0, 97280
s_nop 0
buffer_load_dwordx4 v29, s[20:23], s56 offen lds
v_mov_b32 v24, 0
s_waitcnt vmcnt(46)
s_barrier
ds_read_b64_tr_b16 v[80:81], v44 offset:20480
ds_read_b64_tr_b16 v[82:83], v44 offset:21504
ds_read_b64_tr_b16 v[84:85], v46 offset:20480
ds_read_b64_tr_b16 v[86:87], v46 offset:21504
ds_read_b64_tr_b16 v[88:89], v45 offset:20480
ds_read_b64_tr_b16 v[90:91], v45 offset:21504
ds_read_b64_tr_b16 v[92:93], v47 offset:20480
ds_read_b64_tr_b16 v[94:95], v47 offset:21504
s_waitcnt lgkmcnt(0)
s_waitcnt vmcnt(42)
s_barrier
s_add_u32 s56, s54, 1179648
s_mov_b32 m0, 77824
s_nop 0
buffer_load_dwordx4 v26, s[12:15], s56 offen lds
s_add_u32 s56, s54, 1196032
s_mov_b32 m0, 78848
s_nop 0
buffer_load_dwordx4 v26, s[12:15], s56 offen lds
s_add_u32 s56, s54, 1212416
s_mov_b32 m0, 79872
s_nop 0
buffer_load_dwordx4 v27, s[12:15], s56 offen lds
s_add_u32 s56, s54, 1228800
s_mov_b32 m0, 80896
s_nop 0
buffer_load_dwordx4 v27, s[12:15], s56 offen lds
ds_read_b64_tr_b16 v[96:97], v44 offset:24576
ds_read_b64_tr_b16 v[98:99], v44 offset:25600
ds_read_b64_tr_b16 v[100:101], v46 offset:24576
ds_read_b64_tr_b16 v[102:103], v46 offset:25600
ds_read_b64_tr_b16 v[104:105], v45 offset:24576
ds_read_b64_tr_b16 v[106:107], v45 offset:25600
ds_read_b64_tr_b16 v[108:109], v47 offset:24576
ds_read_b64_tr_b16 v[110:111], v47 offset:25600
s_waitcnt lgkmcnt(0)
s_waitcnt vmcnt(42)
s_barrier
s_add_u32 s56, s54, 1703936
s_mov_b32 m0, 81920
s_nop 0
buffer_load_dwordx4 v26, s[12:15], s56 offen lds
s_add_u32 s56, s54, 1720320
s_mov_b32 m0, 82944
s_nop 0
buffer_load_dwordx4 v26, s[12:15], s56 offen lds
s_add_u32 s56, s54, 1736704
s_mov_b32 m0, 83968
s_nop 0
buffer_load_dwordx4 v27, s[12:15], s56 offen lds
s_add_u32 s56, s54, 1753088
s_mov_b32 m0, 84992
s_nop 0
buffer_load_dwordx4 v27, s[12:15], s56 offen lds
ds_read_b64_tr_b16 v[112:113], v44 offset:28672
ds_read_b64_tr_b16 v[114:115], v44 offset:29696
ds_read_b64_tr_b16 v[116:117], v46 offset:28672
ds_read_b64_tr_b16 v[118:119], v46 offset:29696
ds_read_b64_tr_b16 v[120:121], v45 offset:28672
ds_read_b64_tr_b16 v[122:123], v45 offset:29696
ds_read_b64_tr_b16 v[124:125], v47 offset:28672
ds_read_b64_tr_b16 v[126:127], v47 offset:29696
s_waitcnt lgkmcnt(0)
s_waitcnt vmcnt(42)
s_barrier
s_add_u32 s56, s54, 2228224
s_mov_b32 m0, 86016
s_nop 0
buffer_load_dwordx4 v26, s[12:15], s56 offen lds
s_add_u32 s56, s54, 2244608
s_mov_b32 m0, 87040
s_nop 0
buffer_load_dwordx4 v26, s[12:15], s56 offen lds
s_add_u32 s56, s54, 2260992
s_mov_b32 m0, 88064
s_nop 0
buffer_load_dwordx4 v27, s[12:15], s56 offen lds
s_add_u32 s56, s54, 2277376
s_mov_b32 m0, 89088
s_nop 0
buffer_load_dwordx4 v27, s[12:15], s56 offen lds
ds_read_b64_tr_b16 v[128:129], v44 offset:0
ds_read_b64_tr_b16 v[130:131], v44 offset:1024
ds_read_b64_tr_b16 v[132:133], v46 offset:0
ds_read_b64_tr_b16 v[134:135], v46 offset:1024
ds_read_b64_tr_b16 v[136:137], v45 offset:0
ds_read_b64_tr_b16 v[138:139], v45 offset:1024
ds_read_b64_tr_b16 v[140:141], v47 offset:0
ds_read_b64_tr_b16 v[142:143], v47 offset:1024
s_waitcnt lgkmcnt(0)
s_waitcnt vmcnt(42)
s_barrier
s_add_u32 s56, s54, 3276800
s_mov_b32 m0, 57344
s_nop 0
buffer_load_dwordx4 v26, s[12:15], s56 offen lds
s_add_u32 s56, s54, 3293184
s_mov_b32 m0, 58368
s_nop 0
buffer_load_dwordx4 v26, s[12:15], s56 offen lds
s_add_u32 s56, s54, 3309568
s_mov_b32 m0, 59392
s_nop 0
buffer_load_dwordx4 v27, s[12:15], s56 offen lds
s_add_u32 s56, s54, 3325952
s_mov_b32 m0, 60416
s_nop 0
buffer_load_dwordx4 v27, s[12:15], s56 offen lds
ds_read_b64_tr_b16 v[144:145], v44 offset:4096
ds_read_b64_tr_b16 v[146:147], v44 offset:5120
ds_read_b64_tr_b16 v[148:149], v46 offset:4096
ds_read_b64_tr_b16 v[150:151], v46 offset:5120
ds_read_b64_tr_b16 v[152:153], v45 offset:4096
ds_read_b64_tr_b16 v[154:155], v45 offset:5120
ds_read_b64_tr_b16 v[156:157], v47 offset:4096
ds_read_b64_tr_b16 v[158:159], v47 offset:5120
s_waitcnt lgkmcnt(0)
s_waitcnt vmcnt(42)
s_barrier
s_add_u32 s56, s54, 3801088
s_mov_b32 m0, 61440
s_nop 0
buffer_load_dwordx4 v26, s[12:15], s56 offen lds
s_add_u32 s56, s54, 3817472
s_mov_b32 m0, 62464
s_nop 0
buffer_load_dwordx4 v26, s[12:15], s56 offen lds
s_add_u32 s56, s54, 3833856
s_mov_b32 m0, 63488
s_nop 0
buffer_load_dwordx4 v27, s[12:15], s56 offen lds
s_add_u32 s56, s54, 3850240
s_mov_b32 m0, 64512
s_nop 0
buffer_load_dwordx4 v27, s[12:15], s56 offen lds
ds_read_b64_tr_b16 v[160:161], v44 offset:8192
ds_read_b64_tr_b16 v[162:163], v44 offset:9216
ds_read_b64_tr_b16 v[164:165], v46 offset:8192
ds_read_b64_tr_b16 v[166:167], v46 offset:9216
ds_read_b64_tr_b16 v[168:169], v45 offset:8192
ds_read_b64_tr_b16 v[170:171], v45 offset:9216
ds_read_b64_tr_b16 v[172:173], v47 offset:8192
ds_read_b64_tr_b16 v[174:175], v47 offset:9216
s_waitcnt lgkmcnt(0)
s_waitcnt vmcnt(32)
s_barrier
s_add_u32 s56, s54, 4325376
s_mov_b32 m0, 65536
s_nop 0
buffer_load_dwordx4 v26, s[12:15], s56 offen lds
s_add_u32 s56, s54, 4341760
s_mov_b32 m0, 66560
s_nop 0
buffer_load_dwordx4 v26, s[12:15], s56 offen lds
s_add_u32 s56, s54, 4358144
s_mov_b32 m0, 67584
s_nop 0
buffer_load_dwordx4 v27, s[12:15], s56 offen lds
s_add_u32 s56, s54, 4374528
s_mov_b32 m0, 68608
s_nop 0
buffer_load_dwordx4 v27, s[12:15], s56 offen lds
ds_read_b64_tr_b16 v[176:177], v44 offset:12288
ds_read_b64_tr_b16 v[178:179], v44 offset:13312
ds_read_b64_tr_b16 v[180:181], v46 offset:12288
ds_read_b64_tr_b16 v[182:183], v46 offset:13312
ds_read_b64_tr_b16 v[184:185], v45 offset:12288
ds_read_b64_tr_b16 v[186:187], v45 offset:13312
ds_read_b64_tr_b16 v[188:189], v47 offset:12288
ds_read_b64_tr_b16 v[190:191], v47 offset:13312
s_waitcnt lgkmcnt(0)
s_waitcnt vmcnt(32)
s_barrier
s_add_u32 s56, s54, 131072
s_mov_b32 m0, 69632
s_nop 0
buffer_load_dwordx4 v26, s[16:19], s56 offen lds
s_add_u32 s56, s54, 147456
s_mov_b32 m0, 70656
s_nop 0
buffer_load_dwordx4 v26, s[16:19], s56 offen lds
s_add_u32 s56, s54, 163840
s_mov_b32 m0, 71680
s_nop 0
buffer_load_dwordx4 v27, s[16:19], s56 offen lds
s_add_u32 s56, s54, 180224
s_mov_b32 m0, 72704
s_nop 0
buffer_load_dwordx4 v27, s[16:19], s56 offen lds
ds_read_b64_tr_b16 v[192:193], v44 offset:16384
ds_read_b64_tr_b16 v[194:195], v44 offset:17408
ds_read_b64_tr_b16 v[196:197], v46 offset:16384
ds_read_b64_tr_b16 v[198:199], v46 offset:17408
ds_read_b64_tr_b16 v[200:201], v45 offset:16384
ds_read_b64_tr_b16 v[202:203], v45 offset:17408
ds_read_b64_tr_b16 v[204:205], v47 offset:16384
ds_read_b64_tr_b16 v[206:207], v47 offset:17408
s_waitcnt lgkmcnt(0)
s_waitcnt vmcnt(24)
s_barrier
s_add_u32 s56, s54, 655360
s_mov_b32 m0, 73728
s_nop 0
buffer_load_dwordx4 v26, s[16:19], s56 offen lds
s_add_u32 s56, s54, 671744
s_mov_b32 m0, 74752
s_nop 0
buffer_load_dwordx4 v26, s[16:19], s56 offen lds
s_add_u32 s56, s54, 688128
s_mov_b32 m0, 75776
s_nop 0
buffer_load_dwordx4 v27, s[16:19], s56 offen lds
s_add_u32 s56, s54, 704512
s_mov_b32 m0, 76800
s_nop 0
buffer_load_dwordx4 v27, s[16:19], s56 offen lds
ds_read_b64_tr_b16 v[208:209], v44 offset:20480
ds_read_b64_tr_b16 v[210:211], v44 offset:21504
ds_read_b64_tr_b16 v[212:213], v46 offset:20480
ds_read_b64_tr_b16 v[214:215], v46 offset:21504
ds_read_b64_tr_b16 v[216:217], v45 offset:20480
ds_read_b64_tr_b16 v[218:219], v45 offset:21504
ds_read_b64_tr_b16 v[220:221], v47 offset:20480
ds_read_b64_tr_b16 v[222:223], v47 offset:21504
s_waitcnt lgkmcnt(0)
s_waitcnt vmcnt(24)
s_barrier
s_add_u32 s56, s54, 1179648
s_mov_b32 m0, 77824
s_nop 0
buffer_load_dwordx4 v26, s[16:19], s56 offen lds
s_add_u32 s56, s54, 1196032
s_mov_b32 m0, 78848
s_nop 0
buffer_load_dwordx4 v26, s[16:19], s56 offen lds
s_add_u32 s56, s54, 1212416
s_mov_b32 m0, 79872
s_nop 0
buffer_load_dwordx4 v27, s[16:19], s56 offen lds
s_add_u32 s56, s54, 1228800
s_mov_b32 m0, 80896
s_nop 0
buffer_load_dwordx4 v27, s[16:19], s56 offen lds
ds_read_b64_tr_b16 v[224:225], v44 offset:24576
ds_read_b64_tr_b16 v[226:227], v44 offset:25600
ds_read_b64_tr_b16 v[228:229], v46 offset:24576
ds_read_b64_tr_b16 v[230:231], v46 offset:25600
ds_read_b64_tr_b16 v[232:233], v45 offset:24576
ds_read_b64_tr_b16 v[234:235], v45 offset:25600
ds_read_b64_tr_b16 v[236:237], v47 offset:24576
ds_read_b64_tr_b16 v[238:239], v47 offset:25600
ds_read_b64_tr_b16 v[60:61], v31 offset:32768
ds_read_b64_tr_b16 v[62:63], v31 offset:32896
ds_read_b64_tr_b16 v[64:65], v31 offset:33280
ds_read_b64_tr_b16 v[66:67], v31 offset:33408
ds_read_b64_tr_b16 v[68:69], v31 offset:34816
ds_read_b64_tr_b16 v[70:71], v31 offset:34944
ds_read_b64_tr_b16 v[72:73], v31 offset:35328
ds_read_b64_tr_b16 v[74:75], v31 offset:35456
s_waitcnt lgkmcnt(0)
ds_write_b128 v2, v[60:63] offset:32768
ds_write_b128 v2, v[64:67] offset:33792
ds_write_b128 v2, v[68:71] offset:34816
ds_write_b128 v2, v[72:75] offset:35840
s_waitcnt lgkmcnt(0)
s_waitcnt vmcnt(24)
s_barrier
s_add_u32 s56, s54, 1703936
s_mov_b32 m0, 81920
s_nop 0
buffer_load_dwordx4 v26, s[16:19], s56 offen lds
s_add_u32 s56, s54, 1720320
s_mov_b32 m0, 82944
s_nop 0
buffer_load_dwordx4 v26, s[16:19], s56 offen lds
s_add_u32 s56, s54, 1736704
s_mov_b32 m0, 83968
s_nop 0
buffer_load_dwordx4 v27, s[16:19], s56 offen lds
s_add_u32 s56, s54, 1753088
s_mov_b32 m0, 84992
s_nop 0
buffer_load_dwordx4 v27, s[16:19], s56 offen lds
ds_read_b64_tr_b16 v[240:241], v44 offset:28672
ds_read_b64_tr_b16 v[242:243], v44 offset:29696
ds_read_b64_tr_b16 v[244:245], v46 offset:28672
ds_read_b64_tr_b16 v[246:247], v46 offset:29696
ds_read_b64_tr_b16 v[248:249], v45 offset:28672
ds_read_b64_tr_b16 v[250:251], v45 offset:29696
ds_read_b64_tr_b16 v[252:253], v47 offset:28672
ds_read_b64_tr_b16 v[254:255], v47 offset:29696
ds_read_b64_tr_b16 v[60:61], v31 offset:36864
ds_read_b64_tr_b16 v[62:63], v31 offset:36992
ds_read_b64_tr_b16 v[64:65], v31 offset:37376
ds_read_b64_tr_b16 v[66:67], v31 offset:37504
ds_read_b64_tr_b16 v[68:69], v31 offset:38912
ds_read_b64_tr_b16 v[70:71], v31 offset:39040
ds_read_b64_tr_b16 v[72:73], v31 offset:39424
ds_read_b64_tr_b16 v[74:75], v31 offset:39552
s_waitcnt lgkmcnt(0)
ds_write_b128 v2, v[60:63] offset:36864
ds_write_b128 v2, v[64:67] offset:37888
ds_write_b128 v2, v[68:71] offset:38912
ds_write_b128 v2, v[72:75] offset:39936
s_waitcnt lgkmcnt(0)
s_waitcnt vmcnt(24)
s_barrier
s_add_u32 s56, s54, 2228224
s_mov_b32 m0, 86016
s_nop 0
buffer_load_dwordx4 v26, s[16:19], s56 offen lds
s_add_u32 s56, s54, 2244608
s_mov_b32 m0, 87040
s_nop 0
buffer_load_dwordx4 v26, s[16:19], s56 offen lds
s_add_u32 s56, s54, 2260992
s_mov_b32 m0, 88064
s_nop 0
buffer_load_dwordx4 v27, s[16:19], s56 offen lds
s_add_u32 s56, s54, 2277376
s_mov_b32 m0, 89088
s_nop 0
buffer_load_dwordx4 v27, s[16:19], s56 offen lds
ds_read_b64_tr_b16 a[0:1], v44 offset:0
ds_read_b64_tr_b16 a[2:3], v44 offset:1024
ds_read_b64_tr_b16 a[4:5], v46 offset:0
ds_read_b64_tr_b16 a[6:7], v46 offset:1024
ds_read_b64_tr_b16 a[8:9], v45 offset:0
ds_read_b64_tr_b16 a[10:11], v45 offset:1024
ds_read_b64_tr_b16 a[12:13], v47 offset:0
ds_read_b64_tr_b16 a[14:15], v47 offset:1024
s_waitcnt lgkmcnt(0)
s_waitcnt vmcnt(24)
s_barrier
s_add_u32 s56, s54, 2752512
s_mov_b32 m0, 57344
s_nop 0
buffer_load_dwordx4 v26, s[16:19], s56 offen lds
s_add_u32 s56, s54, 2768896
s_mov_b32 m0, 58368
s_nop 0
buffer_load_dwordx4 v26, s[16:19], s56 offen lds
s_add_u32 s56, s54, 2785280
s_mov_b32 m0, 59392
s_nop 0
buffer_load_dwordx4 v27, s[16:19], s56 offen lds
s_add_u32 s56, s54, 2801664
s_mov_b32 m0, 60416
s_nop 0
buffer_load_dwordx4 v27, s[16:19], s56 offen lds
ds_read_b64_tr_b16 a[16:17], v44 offset:4096
ds_read_b64_tr_b16 a[18:19], v44 offset:5120
ds_read_b64_tr_b16 a[20:21], v46 offset:4096
ds_read_b64_tr_b16 a[22:23], v46 offset:5120
ds_read_b64_tr_b16 a[24:25], v45 offset:4096
ds_read_b64_tr_b16 a[26:27], v45 offset:5120
ds_read_b64_tr_b16 a[28:29], v47 offset:4096
ds_read_b64_tr_b16 a[30:31], v47 offset:5120
s_waitcnt lgkmcnt(0)
s_waitcnt vmcnt(24)
s_barrier
s_add_u32 s56, s54, 3276800
s_mov_b32 m0, 61440
s_nop 0
buffer_load_dwordx4 v26, s[16:19], s56 offen lds
s_add_u32 s56, s54, 3293184
s_mov_b32 m0, 62464
s_nop 0
buffer_load_dwordx4 v26, s[16:19], s56 offen lds
s_add_u32 s56, s54, 3309568
s_mov_b32 m0, 63488
s_nop 0
buffer_load_dwordx4 v27, s[16:19], s56 offen lds
s_add_u32 s56, s54, 3325952
s_mov_b32 m0, 64512
s_nop 0
buffer_load_dwordx4 v27, s[16:19], s56 offen lds
ds_read_b64_tr_b16 a[32:33], v44 offset:8192
ds_read_b64_tr_b16 a[34:35], v44 offset:9216
ds_read_b64_tr_b16 a[36:37], v46 offset:8192
ds_read_b64_tr_b16 a[38:39], v46 offset:9216
ds_read_b64_tr_b16 a[40:41], v45 offset:8192
ds_read_b64_tr_b16 a[42:43], v45 offset:9216
ds_read_b64_tr_b16 a[44:45], v47 offset:8192
ds_read_b64_tr_b16 a[46:47], v47 offset:9216
s_waitcnt lgkmcnt(0)
s_waitcnt vmcnt(24)
s_barrier
s_add_u32 s56, s54, 3801088
s_mov_b32 m0, 65536
s_nop 0
buffer_load_dwordx4 v26, s[16:19], s56 offen lds
s_add_u32 s56, s54, 3817472
s_mov_b32 m0, 66560
s_nop 0
buffer_load_dwordx4 v26, s[16:19], s56 offen lds
s_add_u32 s56, s54, 3833856
s_mov_b32 m0, 67584
s_nop 0
buffer_load_dwordx4 v27, s[16:19], s56 offen lds
s_add_u32 s56, s54, 3850240
s_mov_b32 m0, 68608
s_nop 0
buffer_load_dwordx4 v27, s[16:19], s56 offen lds
ds_read_b64_tr_b16 a[48:49], v44 offset:12288
ds_read_b64_tr_b16 a[50:51], v44 offset:13312
ds_read_b64_tr_b16 a[52:53], v46 offset:12288
ds_read_b64_tr_b16 a[54:55], v46 offset:13312
ds_read_b64_tr_b16 a[56:57], v45 offset:12288
ds_read_b64_tr_b16 a[58:59], v45 offset:13312
ds_read_b64_tr_b16 a[60:61], v47 offset:12288
ds_read_b64_tr_b16 a[62:63], v47 offset:13312
s_waitcnt lgkmcnt(0)
s_waitcnt vmcnt(24)
s_barrier
s_add_u32 s56, s55, 78336
s_mov_b32 m0, 69632
s_nop 0
buffer_load_dwordx4 v28, s[20:23], s56 offen lds
s_add_u32 s56, s55, 80640
s_mov_b32 m0, 70656
s_nop 0
buffer_load_dwordx4 v28, s[20:23], s56 offen lds
s_add_u32 s56, s55, 87552
s_mov_b32 m0, 71680
s_nop 0
buffer_load_dwordx4 v28, s[20:23], s56 offen lds
s_add_u32 s56, s55, 89856
s_mov_b32 m0, 72704
s_nop 0
buffer_load_dwordx4 v28, s[20:23], s56 offen lds
ds_read_b64_tr_b16 a[64:65], v44 offset:16384
ds_read_b64_tr_b16 a[66:67], v44 offset:17408
ds_read_b64_tr_b16 a[68:69], v46 offset:16384
ds_read_b64_tr_b16 a[70:71], v46 offset:17408
ds_read_b64_tr_b16 a[72:73], v45 offset:16384
ds_read_b64_tr_b16 a[74:75], v45 offset:17408
ds_read_b64_tr_b16 a[76:77], v47 offset:16384
ds_read_b64_tr_b16 a[78:79], v47 offset:17408
s_waitcnt lgkmcnt(0)
s_waitcnt vmcnt(24)
s_barrier
s_add_u32 s56, s55, 78592
s_mov_b32 m0, 73728
s_nop 0
buffer_load_dwordx4 v28, s[20:23], s56 offen lds
s_add_u32 s56, s55, 80896
s_mov_b32 m0, 74752
s_nop 0
buffer_load_dwordx4 v28, s[20:23], s56 offen lds
s_add_u32 s56, s55, 87808
s_mov_b32 m0, 75776
s_nop 0
buffer_load_dwordx4 v28, s[20:23], s56 offen lds
s_add_u32 s56, s55, 90112
s_mov_b32 m0, 76800
s_nop 0
buffer_load_dwordx4 v28, s[20:23], s56 offen lds
ds_read_b64_tr_b16 a[80:81], v44 offset:20480
ds_read_b64_tr_b16 a[82:83], v44 offset:21504
ds_read_b64_tr_b16 a[84:85], v46 offset:20480
ds_read_b64_tr_b16 a[86:87], v46 offset:21504
ds_read_b64_tr_b16 a[88:89], v45 offset:20480
ds_read_b64_tr_b16 a[90:91], v45 offset:21504
ds_read_b64_tr_b16 a[92:93], v47 offset:20480
ds_read_b64_tr_b16 a[94:95], v47 offset:21504
s_waitcnt lgkmcnt(0)
s_waitcnt vmcnt(24)
s_barrier
s_add_u32 s56, s55, 78848
s_mov_b32 m0, 77824
s_nop 0
buffer_load_dwordx4 v28, s[20:23], s56 offen lds
s_add_u32 s56, s55, 81152
s_mov_b32 m0, 78848
s_nop 0
buffer_load_dwordx4 v28, s[20:23], s56 offen lds
s_add_u32 s56, s55, 88064
s_mov_b32 m0, 79872
s_nop 0
buffer_load_dwordx4 v28, s[20:23], s56 offen lds
s_add_u32 s56, s55, 90368
s_mov_b32 m0, 80896
s_nop 0
buffer_load_dwordx4 v28, s[20:23], s56 offen lds
ds_read_b64_tr_b16 a[96:97], v44 offset:24576
ds_read_b64_tr_b16 a[98:99], v44 offset:25600
ds_read_b64_tr_b16 a[100:101], v46 offset:24576
ds_read_b64_tr_b16 a[102:103], v46 offset:25600
ds_read_b64_tr_b16 a[104:105], v45 offset:24576
ds_read_b64_tr_b16 a[106:107], v45 offset:25600
ds_read_b64_tr_b16 a[108:109], v47 offset:24576
ds_read_b64_tr_b16 a[110:111], v47 offset:25600
s_waitcnt lgkmcnt(0)
s_waitcnt vmcnt(24)
s_barrier
s_add_u32 s56, s55, 79104
s_mov_b32 m0, 81920
s_nop 0
buffer_load_dwordx4 v28, s[20:23], s56 offen lds
s_add_u32 s56, s55, 81408
s_mov_b32 m0, 82944
s_nop 0
buffer_load_dwordx4 v28, s[20:23], s56 offen lds
s_add_u32 s56, s55, 88320
s_mov_b32 m0, 83968
s_nop 0
buffer_load_dwordx4 v28, s[20:23], s56 offen lds
s_add_u32 s56, s55, 90624
s_mov_b32 m0, 84992
s_nop 0
buffer_load_dwordx4 v28, s[20:23], s56 offen lds
ds_read_b64_tr_b16 a[112:113], v44 offset:28672
ds_read_b64_tr_b16 a[114:115], v44 offset:29696
ds_read_b64_tr_b16 a[116:117], v46 offset:28672
ds_read_b64_tr_b16 a[118:119], v46 offset:29696
ds_read_b64_tr_b16 a[120:121], v45 offset:28672
ds_read_b64_tr_b16 a[122:123], v45 offset:29696
ds_read_b64_tr_b16 a[124:125], v47 offset:28672
ds_read_b64_tr_b16 a[126:127], v47 offset:29696
s_waitcnt lgkmcnt(0)
s_waitcnt vmcnt(24)
s_barrier
s_add_u32 s56, s55, 4608
s_mov_b32 m0, 86016
s_nop 0
buffer_load_dwordx4 v28, s[20:23], s56 offen lds
s_add_u32 s56, s55, 6912
s_mov_b32 m0, 87040
s_nop 0
buffer_load_dwordx4 v28, s[20:23], s56 offen lds
s_add_u32 s56, s55, 13824
s_mov_b32 m0, 88064
s_nop 0
buffer_load_dwordx4 v28, s[20:23], s56 offen lds
s_add_u32 s56, s55, 16128
s_mov_b32 m0, 89088
s_nop 0
buffer_load_dwordx4 v28, s[20:23], s56 offen lds
ds_read_b64_tr_b16 a[128:129], v44 offset:0
ds_read_b64_tr_b16 a[130:131], v44 offset:1024
ds_read_b64_tr_b16 a[132:133], v46 offset:0
ds_read_b64_tr_b16 a[134:135], v46 offset:1024
ds_read_b64_tr_b16 a[136:137], v45 offset:0
ds_read_b64_tr_b16 a[138:139], v45 offset:1024
ds_read_b64_tr_b16 a[140:141], v47 offset:0
ds_read_b64_tr_b16 a[142:143], v47 offset:1024
buffer_load_dword v32, v24, s[28:31], 0 offen sc0 sc1
s_waitcnt lgkmcnt(0)
s_waitcnt vmcnt(25)
s_barrier
s_add_u32 s56, s54, 131072
s_mov_b32 m0, 57344
s_nop 0
buffer_load_dwordx4 v26, s[8:11], s56 offen lds
s_add_u32 s56, s54, 147456
s_mov_b32 m0, 58368
s_nop 0
buffer_load_dwordx4 v26, s[8:11], s56 offen lds
s_add_u32 s56, s54, 163840
s_mov_b32 m0, 59392
s_nop 0
buffer_load_dwordx4 v27, s[8:11], s56 offen lds
s_add_u32 s56, s54, 180224
s_mov_b32 m0, 60416
s_nop 0
buffer_load_dwordx4 v27, s[8:11], s56 offen lds
ds_read_b64_tr_b16 a[144:145], v44 offset:4096
ds_read_b64_tr_b16 a[146:147], v44 offset:5120
ds_read_b64_tr_b16 a[148:149], v46 offset:4096
ds_read_b64_tr_b16 a[150:151], v46 offset:5120
ds_read_b64_tr_b16 a[152:153], v45 offset:4096
ds_read_b64_tr_b16 a[154:155], v45 offset:5120
ds_read_b64_tr_b16 a[156:157], v47 offset:4096
ds_read_b64_tr_b16 a[158:159], v47 offset:5120
s_waitcnt lgkmcnt(0)
s_waitcnt vmcnt(25)
s_barrier
s_add_u32 s56, s54, 1703936
s_mov_b32 m0, 61440
s_nop 0
buffer_load_dwordx4 v26, s[8:11], s56 offen lds
s_add_u32 s56, s54, 1720320
s_mov_b32 m0, 62464
s_nop 0
buffer_load_dwordx4 v26, s[8:11], s56 offen lds
s_add_u32 s56, s54, 1736704
s_mov_b32 m0, 63488
s_nop 0
buffer_load_dwordx4 v27, s[8:11], s56 offen lds
s_add_u32 s56, s54, 1753088
s_mov_b32 m0, 64512
s_nop 0
buffer_load_dwordx4 v27, s[8:11], s56 offen lds
ds_read_b64_tr_b16 a[160:161], v44 offset:8192
ds_read_b64_tr_b16 a[162:163], v44 offset:9216
ds_read_b64_tr_b16 a[164:165], v46 offset:8192
ds_read_b64_tr_b16 a[166:167], v46 offset:9216
ds_read_b64_tr_b16 a[168:169], v45 offset:8192
ds_read_b64_tr_b16 a[170:171], v45 offset:9216
ds_read_b64_tr_b16 a[172:173], v47 offset:8192
ds_read_b64_tr_b16 a[174:175], v47 offset:9216
s_waitcnt lgkmcnt(0)
s_waitcnt vmcnt(25)
s_barrier
s_add_u32 s56, s54, 2228224
s_mov_b32 m0, 65536
s_nop 0
buffer_load_dwordx4 v26, s[8:11], s56 offen lds
s_add_u32 s56, s54, 2244608
s_mov_b32 m0, 66560
s_nop 0
buffer_load_dwordx4 v26, s[8:11], s56 offen lds
s_add_u32 s56, s54, 2260992
s_mov_b32 m0, 67584
s_nop 0
buffer_load_dwordx4 v27, s[8:11], s56 offen lds
s_add_u32 s56, s54, 2277376
s_mov_b32 m0, 68608
s_nop 0
buffer_load_dwordx4 v27, s[8:11], s56 offen lds
ds_read_b64_tr_b16 a[200:201], v48 offset:12288
ds_read_b64_tr_b16 a[202:203], v48 offset:13312
ds_read_b64_tr_b16 a[204:205], v48 offset:14336
ds_read_b64_tr_b16 a[206:207], v48 offset:15360
ds_read_b64_tr_b16 a[184:185], v49 offset:12288
ds_read_b64_tr_b16 a[186:187], v49 offset:13312
ds_read_b64_tr_b16 a[188:189], v49 offset:14336
ds_read_b64_tr_b16 a[190:191], v49 offset:15360
s_waitcnt lgkmcnt(0)
s_waitcnt vmcnt(25)
s_barrier
s_add_u32 s56, s54, 2752512
s_mov_b32 m0, 69632
s_nop 0
buffer_load_dwordx4 v26, s[12:15], s56 offen lds
s_add_u32 s56, s54, 2768896
s_mov_b32 m0, 70656
s_nop 0
buffer_load_dwordx4 v26, s[12:15], s56 offen lds
s_add_u32 s56, s54, 2785280
s_mov_b32 m0, 71680
s_nop 0
buffer_load_dwordx4 v27, s[12:15], s56 offen lds
s_add_u32 s56, s54, 2801664
s_mov_b32 m0, 72704
s_nop 0
buffer_load_dwordx4 v27, s[12:15], s56 offen lds
ds_read_b64_tr_b16 a[216:217], v48 offset:16384
ds_read_b64_tr_b16 a[218:219], v48 offset:17408
ds_read_b64_tr_b16 a[220:221], v48 offset:18432
ds_read_b64_tr_b16 a[222:223], v48 offset:19456
ds_read_b64_tr_b16 a[208:209], v49 offset:16384
ds_read_b64_tr_b16 a[210:211], v49 offset:17408
ds_read_b64_tr_b16 a[212:213], v49 offset:18432
ds_read_b64_tr_b16 a[214:215], v49 offset:19456
s_waitcnt lgkmcnt(0)
s_waitcnt vmcnt(25)
s_barrier
s_add_u32 s56, s54, 4325376
s_mov_b32 m0, 73728
s_nop 0
buffer_load_dwordx4 v26, s[16:19], s56 offen lds
s_add_u32 s56, s54, 4341760
s_mov_b32 m0, 74752
s_nop 0
buffer_load_dwordx4 v26, s[16:19], s56 offen lds
s_add_u32 s56, s54, 4358144
s_mov_b32 m0, 75776
s_nop 0
buffer_load_dwordx4 v27, s[16:19], s56 offen lds
s_add_u32 s56, s54, 4374528
s_mov_b32 m0, 76800
s_nop 0
buffer_load_dwordx4 v27, s[16:19], s56 offen lds
ds_read_b64_tr_b16 a[232:233], v48 offset:20480
ds_read_b64_tr_b16 a[234:235], v48 offset:21504
ds_read_b64_tr_b16 a[236:237], v48 offset:22528
ds_read_b64_tr_b16 a[238:239], v48 offset:23552
ds_read_b64_tr_b16 a[224:225], v49 offset:20480
ds_read_b64_tr_b16 a[226:227], v49 offset:21504
ds_read_b64_tr_b16 a[228:229], v49 offset:22528
ds_read_b64_tr_b16 a[230:231], v49 offset:23552
s_waitcnt lgkmcnt(0)
s_waitcnt vmcnt(25)
s_barrier
s_add_u32 s56, s55, 4864
s_mov_b32 m0, 77824
s_nop 0
buffer_load_dwordx4 v28, s[20:23], s56 offen lds
s_add_u32 s56, s55, 7168
s_mov_b32 m0, 78848
s_nop 0
buffer_load_dwordx4 v28, s[20:23], s56 offen lds
s_add_u32 s56, s55, 14080
s_mov_b32 m0, 79872
s_nop 0
buffer_load_dwordx4 v28, s[20:23], s56 offen lds
s_add_u32 s56, s55, 16384
s_mov_b32 m0, 80896
s_nop 0
buffer_load_dwordx4 v28, s[20:23], s56 offen lds
ds_read_b64_tr_b16 a[248:249], v48 offset:24576
ds_read_b64_tr_b16 a[250:251], v48 offset:25600
ds_read_b64_tr_b16 a[252:253], v48 offset:26624
ds_read_b64_tr_b16 a[254:255], v48 offset:27648
ds_read_b64_tr_b16 a[240:241], v49 offset:24576
ds_read_b64_tr_b16 a[242:243], v49 offset:25600
ds_read_b64_tr_b16 a[244:245], v49 offset:26624
ds_read_b64_tr_b16 a[246:247], v49 offset:27648
s_waitcnt lgkmcnt(0)
s_waitcnt vmcnt(25)
s_barrier
s_add_u32 s56, s55, 5120
s_mov_b32 m0, 81920
s_nop 0
buffer_load_dwordx4 v28, s[20:23], s56 offen lds
s_add_u32 s56, s55, 7424
s_mov_b32 m0, 82944
s_nop 0
buffer_load_dwordx4 v28, s[20:23], s56 offen lds
s_add_u32 s56, s55, 14336
s_mov_b32 m0, 83968
s_nop 0
buffer_load_dwordx4 v28, s[20:23], s56 offen lds
s_add_u32 s56, s55, 16640
s_mov_b32 m0, 84992
s_nop 0
buffer_load_dwordx4 v28, s[20:23], s56 offen lds
ds_read_b64_tr_b16 a[192:193], v48 offset:28672
ds_read_b64_tr_b16 a[194:195], v48 offset:29696
ds_read_b64_tr_b16 a[196:197], v48 offset:30720
ds_read_b64_tr_b16 a[198:199], v48 offset:31744
ds_read_b64_tr_b16 a[176:177], v49 offset:28672
ds_read_b64_tr_b16 a[178:179], v49 offset:29696
ds_read_b64_tr_b16 a[180:181], v49 offset:30720
ds_read_b64_tr_b16 a[182:183], v49 offset:31744
s_waitcnt lgkmcnt(0)
s_waitcnt vmcnt(24)
s_barrier
s_add_u32 s56, s55, 5376
s_mov_b32 m0, 86016
s_nop 0
buffer_load_dwordx4 v28, s[20:23], s56 offen lds
s_add_u32 s56, s55, 7680
s_mov_b32 m0, 87040
s_nop 0
buffer_load_dwordx4 v28, s[20:23], s56 offen lds
s_add_u32 s56, s55, 14592
s_mov_b32 m0, 88064
s_nop 0
buffer_load_dwordx4 v28, s[20:23], s56 offen lds
s_add_u32 s56, s55, 16896
s_mov_b32 m0, 89088
s_nop 0
buffer_load_dwordx4 v28, s[20:23], s56 offen lds
ds_read_b64_tr_b16 v[60:61], v44 offset:0
ds_read_b64_tr_b16 v[62:63], v44 offset:1024
ds_read_b64_tr_b16 v[64:65], v46 offset:0
ds_read_b64_tr_b16 v[66:67], v46 offset:1024
ds_read_b64_tr_b16 v[68:69], v45 offset:0
ds_read_b64_tr_b16 v[70:71], v45 offset:1024
ds_read_b64_tr_b16 v[72:73], v47 offset:0
ds_read_b64_tr_b16 v[74:75], v47 offset:1024
s_waitcnt lgkmcnt(0)
s_waitcnt vmcnt(24)
s_barrier
ds_write_b128 v2, v[60:63] offset:0
ds_write_b128 v2, v[64:67] offset:1024
ds_write_b128 v2, v[68:71] offset:2048
ds_write_b128 v2, v[72:75] offset:3072
ds_read_b64_tr_b16 v[60:61], v44 offset:4096
ds_read_b64_tr_b16 v[62:63], v44 offset:5120
ds_read_b64_tr_b16 v[64:65], v46 offset:4096
ds_read_b64_tr_b16 v[66:67], v46 offset:5120
ds_read_b64_tr_b16 v[68:69], v45 offset:4096
ds_read_b64_tr_b16 v[70:71], v45 offset:5120
ds_read_b64_tr_b16 v[72:73], v47 offset:4096
ds_read_b64_tr_b16 v[74:75], v47 offset:5120
L_rdv_w1r:
v_readfirstlane_b32 s38, v32
s_nop 0
s_and_b32 s57, s38, 0xff
s_cmp_lg_u32 s57, 32
s_cbranch_scc1 L_rdv2_w1r
s_waitcnt lgkmcnt(0)
s_waitcnt vmcnt(20)
s_barrier
ds_write_b128 v2, v[60:63] offset:4096
ds_write_b128 v2, v[64:67] offset:5120
ds_write_b128 v2, v[68:71] offset:6144
ds_write_b128 v2, v[72:75] offset:7168
ds_read_b64_tr_b16 v[60:61], v44 offset:8192
ds_read_b64_tr_b16 v[62:63], v44 offset:9216
ds_read_b64_tr_b16 v[64:65], v46 offset:8192
ds_read_b64_tr_b16 v[66:67], v46 offset:9216
ds_read_b64_tr_b16 v[68:69], v45 offset:8192
ds_read_b64_tr_b16 v[70:71], v45 offset:9216
ds_read_b64_tr_b16 v[72:73], v47 offset:8192
ds_read_b64_tr_b16 v[74:75], v47 offset:9216
buffer_load_dwordx4 v[12:15], v9, s[4:7], s37 offen offset:0
buffer_load_dwordx4 v[16:19], v9, s[4:7], s37 offen offset:1024
buffer_load_dwordx4 v[52:55], v1, s[4:7], s37 offen offset:2048
buffer_load_dwordx4 v[56:59], v1, s[4:7], s37 offen offset:3072
s_mov_b32 m0, 1024
s_nop 0
buffer_load_dwordx4 v1, s[4:7], s47 offen offset:1024 sc1 lds
buffer_load_dword v33, v1, s[4:7], s3 offen offset:0 sc1
buffer_load_dword v33, v1, s[4:7], s3 offen offset:1024 sc1
buffer_load_dword v33, v1, s[4:7], s3 offen offset:2048 sc1
buffer_load_dword v33, v1, s[4:7], s3 offen offset:3072 sc1
s_waitcnt lgkmcnt(0)
s_waitcnt vmcnt(25)
s_barrier
ds_write_b128 v2, v[60:63] offset:8192
ds_write_b128 v2, v[64:67] offset:9216
ds_write_b128 v2, v[68:71] offset:10240
ds_write_b128 v2, v[72:75] offset:11264
ds_read_b64_tr_b16 v[60:61], v44 offset:12288
ds_read_b64_tr_b16 v[62:63], v44 offset:13312
ds_read_b64_tr_b16 v[64:65], v46 offset:12288
ds_read_b64_tr_b16 v[66:67], v46 offset:13312
ds_read_b64_tr_b16 v[68:69], v45 offset:12288
ds_read_b64_tr_b16 v[70:71], v45 offset:13312
ds_read_b64_tr_b16 v[72:73], v47 offset:12288
ds_read_b64_tr_b16 v[74:75], v47 offset:13312
s_waitcnt lgkmcnt(0)
s_waitcnt vmcnt(21)
s_barrier
ds_write_b128 v2, v[60:63] offset:12288
ds_write_b128 v2, v[64:67] offset:13312
ds_write_b128 v2, v[68:71] offset:14336
ds_write_b128 v2, v[72:75] offset:15360
ds_read_b64_tr_b16 v[60:61], v44 offset:16384
ds_read_b64_tr_b16 v[62:63], v44 offset:17408
ds_read_b64_tr_b16 v[64:65], v46 offset:16384
ds_read_b64_tr_b16 v[66:67], v46 offset:17408
ds_read_b64_tr_b16 v[68:69], v45 offset:16384
ds_read_b64_tr_b16 v[70:71], v45 offset:17408
ds_read_b64_tr_b16 v[72:73], v47 offset:16384
ds_read_b64_tr_b16 v[74:75], v47 offset:17408
s_waitcnt lgkmcnt(0)
s_waitcnt vmcnt(17)
s_barrier
ds_write_b128 v2, v[60:63] offset:16384
ds_write_b128 v2, v[64:67] offset:17408
ds_write_b128 v2, v[68:71] offset:18432
ds_write_b128 v2, v[72:75] offset:19456
ds_read_b64_tr_b16 v[60:61], v48 offset:20480
ds_read_b64_tr_b16 v[62:63], v48 offset:21504
ds_read_b64_tr_b16 v[64:65], v48 offset:22528
ds_read_b64_tr_b16 v[66:67], v48 offset:23552
ds_read_b64_tr_b16 v[68:69], v49 offset:20480
ds_read_b64_tr_b16 v[70:71], v49 offset:21504
ds_read_b64_tr_b16 v[72:73], v49 offset:22528
ds_read_b64_tr_b16 v[74:75], v49 offset:23552
s_waitcnt lgkmcnt(0)
s_waitcnt vmcnt(13)
s_barrier
ds_write_b128 v2, v[60:63] offset:20480
ds_write_b128 v2, v[64:67] offset:21504
ds_write_b128 v2, v[68:71] offset:22528
ds_write_b128 v2, v[72:75] offset:23552
ds_read_b64_tr_b16 v[60:61], v48 offset:24576
ds_read_b64_tr_b16 v[62:63], v48 offset:25600
ds_read_b64_tr_b16 v[64:65], v48 offset:26624
ds_read_b64_tr_b16 v[66:67], v48 offset:27648
ds_read_b64_tr_b16 v[68:69], v49 offset:24576
ds_read_b64_tr_b16 v[70:71], v49 offset:25600
ds_read_b64_tr_b16 v[72:73], v49 offset:26624
ds_read_b64_tr_b16 v[74:75], v49 offset:27648
s_waitcnt lgkmcnt(0)
s_waitcnt vmcnt(9)
s_barrier
ds_write_b128 v2, v[60:63] offset:24576
ds_write_b128 v2, v[64:67] offset:25600
ds_write_b128 v2, v[68:71] offset:26624
ds_write_b128 v2, v[72:75] offset:27648
ds_read_b64_tr_b16 v[60:61], v48 offset:28672
ds_read_b64_tr_b16 v[62:63], v48 offset:29696
ds_read_b64_tr_b16 v[64:65], v48 offset:30720
ds_read_b64_tr_b16 v[66:67], v48 offset:31744
ds_read_b64_tr_b16 v[68:69], v49 offset:28672
ds_read_b64_tr_b16 v[70:71], v49 offset:29696
ds_read_b64_tr_b16 v[72:73], v49 offset:30720
ds_read_b64_tr_b16 v[74:75], v49 offset:31744
s_waitcnt lgkmcnt(0)
s_barrier
ds_write_b128 v2, v[60:63] offset:28672
ds_write_b128 v2, v[64:67] offset:29696
ds_write_b128 v2, v[68:71] offset:30720
ds_write_b128 v2, v[72:75] offset:31744
s_lshl_b32 s57, s58, 5
s_mov_b32 s0, 0x3f003f00
s_mov_b32 s1, 0x3f003f00
s_mov_b32 s58, 304128
s_cmp_eq_u32 s38, s57
s_mov_b32 s56, 0x33333333
s_mov_b32 s57, 0x33333333
s_mov_b32 s2, 0x21800000
s_mov_b32 s55, -24
s_cbranch_scc0 L_slow_w1r
v_mov_b64 v[20:21], 0
v_mov_b64 v[22:23], 0
v_mov_b64 v[24:25], 0
v_mov_b64 v[26:27], 0
v_mov_b64 v[28:29], 0
v_mov_b64 v[30:31], 0
v_mov_b64 v[32:33], 0
v_mov_b64 v[34:35], 0
v_mov_b64 v[36:37], 0
v_mov_b64 v[38:39], 0
v_mov_b64 v[40:41], 0
v_mov_b64 v[42:43], 0
ds_read_b128 v[44:47], v2 offset:0
ds_read_b128 v[48:51], v2 offset:1024
v_bfe_u32 v77, v1, 6, 1
v_lshl_add_u32 v77, v77, 3, v1
v_lshlrev_b32 v77, 1, v77
v_lshlrev_b32 v78, 3, v1
s_waitcnt vmcnt(0) lgkmcnt(0)
s_branch L_top_w1rf
L_done_w1rf:
s_mul_i32 s40, s34, 10240
s_add_u32 s40, s40, 8093696
buffer_store_dword v11, v10, s[4:7], s40 offen sc0 sc1
s_waitcnt vmcnt(0) lgkmcnt(0)
s_endpgm
L_rdv2_w1r:
buffer_load_dword v32, v24, s[28:31], 0 offen sc0 sc1
s_sub_u32 s41, s41, 1
s_cbranch_scc1 L_exit
s_waitcnt vmcnt(0)
s_branch L_rdv_w1r
L_ra0_w1rf:
s_mov_b32 m0, 1024
s_nop 0
buffer_load_dwordx4 v1, s[4:7], s47 offen offset:0 sc1 lds
buffer_load_dwordx4 v1, s[4:7], s47 offen offset:1024 sc1 lds
buffer_load_dwordx4 v1, s[4:7], s47 offen offset:2048 sc1 lds
buffer_load_dwordx4 v1, s[4:7], s47 offen offset:3072 sc1 lds
s_sub_u32 s41, s41, 1
s_cbranch_scc1 L_exit
ds_read_b128 v[44:47], v2 offset:0
ds_read_b128 v[48:51], v2 offset:1024
v_mov_b64 v[20:21], 0
v_mov_b64 v[22:23], 0
v_mov_b64 v[24:25], 0
v_mov_b64 v[26:27], 0
v_mov_b64 v[28:29], 0
v_mov_b64 v[30:31], 0
v_mov_b64 v[32:33], 0
v_mov_b64 v[34:35], 0
v_mov_b64 v[36:37], 0
v_mov_b64 v[38:39], 0
v_mov_b64 v[40:41], 0
v_mov_b64 v[42:43], 0
s_waitcnt vmcnt(0)
ds_read_b128 v[60:63], v1 offset:1024
ds_read_b128 v[64:67], v1 offset:2048
ds_read_b128 v[68:71], v1 offset:3072
ds_read_b128 v[72:75], v1 offset:4096
s_branch L_s0_w1rf
L_ra1_w1rf:
L_ra2_w1rf:
s_waitcnt lgkmcnt(0)
s_barrier
s_mov_b32 m0, 5120
s_nop 0
buffer_load_dwordx4 v1, s[4:7], s48 offen offset:1024 sc1 lds
s_sub_u32 s41, s41, 1
s_cbranch_scc1 L_exit
s_waitcnt vmcnt(0)
s_barrier
ds_read_b128 v[76:79], v1 offset:5120
ds_read_b128 v[60:63], v1 offset:6144
ds_read_b128 v[64:67], v1 offset:7168
ds_read_b128 v[68:71], v1 offset:8192
ds_read_b128 v[72:75], v1 offset:9216
s_waitcnt lgkmcnt(0)
v_bitop3_b32 v6, v76, v60, s35 bitop3:0x7e
v_bitop3_b32 v6, v6, v64, s35 bitop3:0xf6
v_bitop3_b32 v6, v6, v68, s35 bitop3:0xf6
v_bitop3_b32 v6, v6, v72, s35 bitop3:0xf6
v_and_b32 v6, 1, v6
v_cmp_ne_u32 vcc, 0, v6

s_cbranch_vccnz L_ra2_w1rf
s_branch L_a1_w1rf
L_mx_w1rf:
s_waitcnt lgkmcnt(0)
v_max3_f32 v30, v12, v13, v28
v_max_f32 v30, v30, v29
v_mov_b32 v31, v30
s_nop 1
v_permlane16_swap_b32 v30, v31
v_max_f32 v30, v30, v31
v_mov_b32 v31, v30
s_nop 1
v_permlane32_swap_b32 v30, v31
v_max_f32 v30, v30, v31
ds_write_b32 v1, v30 offset:10244
s_waitcnt lgkmcnt(0)
s_barrier
ds_read_b128 v[32:35], v1 offset:10240
s_waitcnt lgkmcnt(0)
v_max3_f32 v32, v32, v33, v34
v_max_f32 v32, v32, v35
v_sub_f32 v14, v12, v32
v_sub_f32 v15, v13, v32
v_sub_f32 v30, v28, v32
v_sub_f32 v31, v29, v32
v_exp_f32 v14, v14
v_exp_f32 v15, v15
v_exp_f32 v30, v30
v_exp_f32 v31, v31
v_cvt_pk_bf16_f32 v14, v14, v15
v_cvt_pk_bf16_f32 v30, v30, v31
ds_write_b32 v5, v14 offset:14624
v_cndmask_b32_e64 v26, 0, v30, s[56:57]
v_cndmask_b32_e64 v27, 0, v30, s[56:57]
v_mov_b64 v[76:77], s[52:53]
v_mov_b64 v[78:79], s[52:53]
v_mov_b32_dpp v24, v26 quad_perm:[2,3,0,1] row_mask:0xf bank_mask:0xf
v_mov_b32_dpp v25, v26 quad_perm:[2,3,0,1] row_mask:0xf bank_mask:0xf
s_waitcnt lgkmcnt(0)
s_barrier
v_mov_b64 v[14:15], s[0:1]
ds_read_b128 v[16:19], v1 offset:14368
ds_read_b128 v[36:39], v1 offset:14336
s_waitcnt lgkmcnt(0)
v_mfma_f32_16x16x32_bf16 v[32:35], v[76:79], v[16:19], 0
v_mfma_f32_16x16x32_bf16 v[20:23], v[52:55], v[16:19], 0
v_mfma_f32_16x16x32_bf16 v[20:23], v[56:59], v[36:39], v[20:23]
v_mfma_f32_16x16x16_bf16 v[32:35], v[14:15], v[26:27], v[32:35]
v_mfma_f32_16x16x32_bf16 v[20:23], v[40:43], v[24:27], v[20:23]
s_nop 3
v_rcp_f32 v33, v32
s_nop 2
v_mul_f32_dpp v20, v33, v20 quad_perm:[0,1,0,1] row_mask:0xf bank_mask:0xf
v_mul_f32_dpp v21, v33, v21 quad_perm:[0,1,0,1] row_mask:0xf bank_mask:0xf
v_mul_f32_dpp v22, v33, v22 quad_perm:[0,1,0,1] row_mask:0xf bank_mask:0xf
v_mul_f32_dpp v23, v33, v23 quad_perm:[0,1,0,1] row_mask:0xf bank_mask:0xf
v_cvt_pk_bf16_f32 v20, v20, v21
v_cvt_pk_bf16_f32 v21, v22, v23
ds_write_b64 v6, v[20:21] offset:6144
v_mov_b32_dpp v16, v20 quad_perm:[0,1,0,1] row_mask:0xf bank_mask:0xf
v_mov_b32_dpp v17, v21 quad_perm:[0,1,0,1] row_mask:0xf bank_mask:0xf
v_mov_b32_dpp v18, v20 quad_perm:[2,3,2,3] row_mask:0xf bank_mask:0xf
v_mov_b32_dpp v19, v21 quad_perm:[2,3,2,3] row_mask:0xf bank_mask:0xf
v_mov_b64 v[76:77], 0
v_mov_b64 v[78:79], 0
v_mov_b64 v[36:37], 0
v_mov_b64 v[38:39], 0
v_mov_b64 v[24:25], 0
v_mov_b64 v[26:27], 0
v_mov_b64 v[32:33], 0
v_mov_b64 v[34:35], 0
s_waitcnt lgkmcnt(0)
s_branch L_mxb_w1rf

L_rr_w1rf:
buffer_load_dwordx4 v[60:63], v9, s[4:7], s3 offen offset:0 sc1
buffer_load_dwordx4 v[64:67], v9, s[4:7], s3 offen offset:1024 sc1
buffer_load_dwordx4 v[68:71], v9, s[4:7], s3 offen offset:2048 sc1
buffer_load_dwordx4 v[72:75], v9, s[4:7], s3 offen offset:3072 sc1
s_sub_u32 s41, s41, 1
s_cbranch_scc1 L_exit
s_waitcnt vmcnt(0)
s_branch L_r_w1rf
L_slow_w1r:
v_mov_b64 v[20:21], 0
v_mov_b64 v[22:23], 0
v_mov_b64 v[24:25], 0
v_mov_b64 v[26:27], 0
v_mov_b64 v[28:29], 0
v_mov_b64 v[30:31], 0
v_mov_b64 v[32:33], 0
v_mov_b64 v[34:35], 0
v_mov_b64 v[36:37], 0
v_mov_b64 v[38:39], 0
v_mov_b64 v[40:41], 0
v_mov_b64 v[42:43], 0
ds_read_b128 v[44:47], v2 offset:0
ds_read_b128 v[48:51], v2 offset:1024
v_bfe_u32 v77, v1, 6, 1
v_lshl_add_u32 v77, v77, 3, v1
v_lshlrev_b32 v77, 1, v77
v_lshlrev_b32 v78, 3, v1
s_waitcnt vmcnt(0) lgkmcnt(0)
s_branch L_top_w1rs
L_done_w1rs:
s_mul_i32 s40, s34, 10240
s_add_u32 s40, s40, 8093696
buffer_store_dword v11, v10, s[4:7], s40 offen sc0 sc1
s_waitcnt vmcnt(0) lgkmcnt(0)
s_endpgm
L_ra0_w1rs:
s_mov_b32 m0, 1024
s_nop 0
buffer_load_dwordx4 v1, s[4:7], s47 offen offset:0 sc0 sc1 lds
buffer_load_dwordx4 v1, s[4:7], s47 offen offset:1024 sc0 sc1 lds
buffer_load_dwordx4 v1, s[4:7], s47 offen offset:2048 sc0 sc1 lds
buffer_load_dwordx4 v1, s[4:7], s47 offen offset:3072 sc0 sc1 lds
s_sub_u32 s41, s41, 1
s_cbranch_scc1 L_exit
ds_read_b128 v[44:47], v2 offset:0
ds_read_b128 v[48:51], v2 offset:1024
v_mov_b64 v[20:21], 0
v_mov_b64 v[22:23], 0
v_mov_b64 v[24:25], 0
v_mov_b64 v[26:27], 0
v_mov_b64 v[28:29], 0
v_mov_b64 v[30:31], 0
v_mov_b64 v[32:33], 0
v_mov_b64 v[34:35], 0
v_mov_b64 v[36:37], 0
v_mov_b64 v[38:39], 0
v_mov_b64 v[40:41], 0
v_mov_b64 v[42:43], 0
s_waitcnt vmcnt(0)
ds_read_b128 v[60:63], v1 offset:1024
ds_read_b128 v[64:67], v1 offset:2048
ds_read_b128 v[68:71], v1 offset:3072
ds_read_b128 v[72:75], v1 offset:4096
s_branch L_s0_w1rs
L_ra1_w1rs:
L_ra2_w1rs:
s_waitcnt lgkmcnt(0)
s_barrier
s_mov_b32 m0, 5120
s_nop 0
buffer_load_dwordx4 v1, s[4:7], s48 offen offset:1024 sc0 sc1 lds
s_sub_u32 s41, s41, 1
s_cbranch_scc1 L_exit
s_waitcnt vmcnt(0)
s_barrier
ds_read_b128 v[76:79], v1 offset:5120
ds_read_b128 v[60:63], v1 offset:6144
ds_read_b128 v[64:67], v1 offset:7168
ds_read_b128 v[68:71], v1 offset:8192
ds_read_b128 v[72:75], v1 offset:9216
s_waitcnt lgkmcnt(0)
v_bitop3_b32 v6, v76, v60, s35 bitop3:0x7e
v_bitop3_b32 v6, v6, v64, s35 bitop3:0xf6
v_bitop3_b32 v6, v6, v68, s35 bitop3:0xf6
v_bitop3_b32 v6, v6, v72, s35 bitop3:0xf6
v_and_b32 v6, 1, v6
v_cmp_ne_u32 vcc, 0, v6

s_cbranch_vccnz L_ra2_w1rs
s_branch L_a1_w1rs
L_mx_w1rs:
s_waitcnt lgkmcnt(0)
v_max3_f32 v30, v12, v13, v28
v_max_f32 v30, v30, v29
v_mov_b32 v31, v30
s_nop 1
v_permlane16_swap_b32 v30, v31
v_max_f32 v30, v30, v31
v_mov_b32 v31, v30
s_nop 1
v_permlane32_swap_b32 v30, v31
v_max_f32 v30, v30, v31
ds_write_b32 v1, v30 offset:10244
s_waitcnt lgkmcnt(0)
s_barrier
ds_read_b128 v[32:35], v1 offset:10240
s_waitcnt lgkmcnt(0)
v_max3_f32 v32, v32, v33, v34
v_max_f32 v32, v32, v35
v_sub_f32 v14, v12, v32
v_sub_f32 v15, v13, v32
v_sub_f32 v30, v28, v32
v_sub_f32 v31, v29, v32
v_exp_f32 v14, v14
v_exp_f32 v15, v15
v_exp_f32 v30, v30
v_exp_f32 v31, v31
v_cvt_pk_bf16_f32 v14, v14, v15
v_cvt_pk_bf16_f32 v30, v30, v31
ds_write_b32 v5, v14 offset:14624
v_cndmask_b32_e64 v26, 0, v30, s[56:57]
v_cndmask_b32_e64 v27, 0, v30, s[56:57]
v_mov_b64 v[76:77], s[52:53]
v_mov_b64 v[78:79], s[52:53]
v_mov_b32_dpp v24, v26 quad_perm:[2,3,0,1] row_mask:0xf bank_mask:0xf
v_mov_b32_dpp v25, v26 quad_perm:[2,3,0,1] row_mask:0xf bank_mask:0xf
s_waitcnt lgkmcnt(0)
s_barrier
v_mov_b64 v[14:15], s[0:1]
ds_read_b128 v[16:19], v1 offset:14368
ds_read_b128 v[36:39], v1 offset:14336
s_waitcnt lgkmcnt(0)
v_mfma_f32_16x16x32_bf16 v[32:35], v[76:79], v[16:19], 0
v_mfma_f32_16x16x32_bf16 v[20:23], v[52:55], v[16:19], 0
v_mfma_f32_16x16x32_bf16 v[20:23], v[56:59], v[36:39], v[20:23]
v_mfma_f32_16x16x16_bf16 v[32:35], v[14:15], v[26:27], v[32:35]
v_mfma_f32_16x16x32_bf16 v[20:23], v[40:43], v[24:27], v[20:23]
s_nop 3
v_rcp_f32 v33, v32
s_nop 2
v_mul_f32_dpp v20, v33, v20 quad_perm:[0,1,0,1] row_mask:0xf bank_mask:0xf
v_mul_f32_dpp v21, v33, v21 quad_perm:[0,1,0,1] row_mask:0xf bank_mask:0xf
v_mul_f32_dpp v22, v33, v22 quad_perm:[0,1,0,1] row_mask:0xf bank_mask:0xf
v_mul_f32_dpp v23, v33, v23 quad_perm:[0,1,0,1] row_mask:0xf bank_mask:0xf
v_cvt_pk_bf16_f32 v20, v20, v21
v_cvt_pk_bf16_f32 v21, v22, v23
ds_write_b64 v6, v[20:21] offset:6144
v_mov_b32_dpp v16, v20 quad_perm:[0,1,0,1] row_mask:0xf bank_mask:0xf
v_mov_b32_dpp v17, v21 quad_perm:[0,1,0,1] row_mask:0xf bank_mask:0xf
v_mov_b32_dpp v18, v20 quad_perm:[2,3,2,3] row_mask:0xf bank_mask:0xf
v_mov_b32_dpp v19, v21 quad_perm:[2,3,2,3] row_mask:0xf bank_mask:0xf
v_mov_b64 v[76:77], 0
v_mov_b64 v[78:79], 0
v_mov_b64 v[36:37], 0
v_mov_b64 v[38:39], 0
v_mov_b64 v[24:25], 0
v_mov_b64 v[26:27], 0
v_mov_b64 v[32:33], 0
v_mov_b64 v[34:35], 0
s_waitcnt lgkmcnt(0)
s_branch L_mxb_w1rs

L_rr_w1rs:
buffer_load_dwordx4 v[60:63], v9, s[4:7], s3 offen offset:0 sc0 sc1
buffer_load_dwordx4 v[64:67], v9, s[4:7], s3 offen offset:1024 sc0 sc1
buffer_load_dwordx4 v[68:71], v9, s[4:7], s3 offen offset:2048 sc0 sc1
buffer_load_dwordx4 v[72:75], v9, s[4:7], s3 offen offset:3072 sc0 sc1
s_sub_u32 s41, s41, 1
s_cbranch_scc1 L_exit
s_waitcnt vmcnt(0)
s_branch L_r_w1rs
.p2align 6
L_ex_w0f:
s_add_u32 s34, s34, 1
s_not_b32 s35, s35
s_not_b32 s36, s36
s_add_u32 s37, s37, 524288
s_add_u32 s39, s39, 524288
v_mov_b64 v[20:21], 0
v_mov_b64 v[22:23], 0
v_mov_b64 v[24:25], 0
v_mov_b64 v[26:27], 0
v_mov_b64 v[28:29], 0
v_mov_b64 v[30:31], 0
v_mov_b64 v[32:33], 0
v_mov_b64 v[34:35], 0
v_mov_b64 v[36:37], 0
v_mov_b64 v[38:39], 0
v_mov_b64 v[40:41], 0
v_mov_b64 v[42:43], 0
ds_read_b128 v[44:47], v2 offset:0
ds_read_b128 v[48:51], v2 offset:1024
v_bfe_u32 v77, v1, 6, 1
v_lshl_add_u32 v77, v77, 3, v1
v_lshlrev_b32 v77, 1, v77
v_lshlrev_b32 v78, 3, v1
s_barrier
s_cmp_eq_u32 s34, 63
s_cbranch_scc1 L_done_w0f
L_top_w0f:
s_barrier
ds_read_b128 v[60:63], v1 offset:1024
s_mov_b32 m0, 5120
s_nop 0
buffer_load_dwordx4 v1, s[4:7], s48 offen offset:0 sc1 lds
s_barrier
ds_read_b128 v[64:67], v1 offset:2048
ds_read_b128 v[68:71], v1 offset:3072
ds_read_b128 v[72:75], v1 offset:4096
L_s0_w0f:
s_waitcnt lgkmcnt(3)
v_smfmac_f32_16x16x64_bf16 v[32:35], v[60:63], v[184:191], v0
v_smfmac_f32_16x16x64_bf16 v[20:23], v[60:63], v[44:51], v0
v_smfmac_f32_16x16x64_bf16 v[36:39], v[60:63], a[48:55], v0
buffer_load_dwordx4 v[12:15], v9, s[4:7], s37 offen offset:0
v_smfmac_f32_16x16x64_bf16 v[28:31], v[60:63], v[176:183], v0
buffer_load_dwordx4 v[16:19], v9, s[4:7], s37 offen offset:1024
v_smfmac_f32_16x16x64_bf16 v[40:43], v[60:63], a[56:63], v0
s_waitcnt lgkmcnt(2)
v_smfmac_f32_16x16x64_bf16 v[28:31], v[64:67], v[192:199], v0
ds_read_b128 v[48:51], v2 offset:3072
v_smfmac_f32_16x16x64_bf16 v[20:23], v[64:67], v[80:87], v0
ds_read_b128 v[44:47], v2 offset:2048
v_smfmac_f32_16x16x64_bf16 v[32:35], v[64:67], v[200:207], v0
buffer_load_dwordx4 v[52:55], v1, s[4:7], s37 offen offset:2048
v_bitop3_b32 v6, v60, v64, s35 bitop3:0x7e
s_waitcnt lgkmcnt(2)
v_bitop3_b32 v76, v68, v72, s35 bitop3:0x7e
v_bitop3_b32 v6, v6, v76, 1 bitop3:0xa8
v_smfmac_f32_16x16x64_bf16 v[24:27], v[64:67], v[88:95], v0
s_waitcnt lgkmcnt(0)
v_smfmac_f32_16x16x64_bf16 v[24:27], v[60:63], v[44:51], v0
buffer_load_dwordx4 v[56:59], v1, s[4:7], s37 offen offset:3072
v_smfmac_f32_16x16x64_bf16 v[40:43], v[64:67], a[72:79], v0
v_smfmac_f32_16x16x64_bf16 v[36:39], v[64:67], a[64:71], v0
ds_read_b128 v[44:47], v2 offset:4096
v_cmp_ne_u32 vcc, 0, v6
v_smfmac_f32_16x16x64_bf16 v[20:23], v[68:71], v[96:103], v0
ds_read_b128 v[48:51], v2 offset:5120
v_smfmac_f32_16x16x64_bf16 v[24:27], v[68:71], v[104:111], v0
s_cbranch_vccnz L_ra0_w0f
s_waitcnt vmcnt(4)
s_barrier
ds_read_b32 v6, v77 offset:8192
v_smfmac_f32_16x16x64_bf16 v[28:31], v[68:71], v[208:215], v0
s_mov_b32 m0, 0
ds_read_b128 v[60:63], v1 offset:6144
s_waitcnt lgkmcnt(2)
v_smfmac_f32_16x16x64_bf16 v[20:23], v[72:75], v[44:51], v0
buffer_load_dword v78, s[4:7], s39 offen lds
ds_read_b128 v[76:79], v1 offset:5120
v_smfmac_f32_16x16x64_bf16 v[28:31], v[72:75], v[224:231], v0
ds_read_b128 v[64:67], v1 offset:7168
ds_read_b128 v[44:47], v2 offset:6144
v_smfmac_f32_16x16x64_bf16 v[32:35], v[68:71], v[216:223], v0
v_smfmac_f32_16x16x64_bf16 v[36:39], v[68:71], a[80:87], v0
ds_read_b128 v[48:51], v2 offset:7168
s_waitcnt lgkmcnt(4)
v_bitop3_b32 v6, v6, v60, s35 bitop3:0x7e
v_smfmac_f32_16x16x64_bf16 v[40:43], v[68:71], a[88:95], v0
ds_read_b128 v[68:71], v1 offset:8192
v_smfmac_f32_16x16x64_bf16 v[32:35], v[72:75], v[232:239], v0
s_waitcnt lgkmcnt(3)
v_bitop3_b32 v6, v6, v64, s35 bitop3:0xf6
v_bitop3_b32 v6, v6, v76, s35 bitop3:0xf6
v_and_b32 v6, 1, v6
s_waitcnt lgkmcnt(1)
v_smfmac_f32_16x16x64_bf16 v[24:27], v[72:75], v[44:51], v0
ds_read_b128 v[44:47], v2 offset:8192
v_cmp_ne_u32 vcc, 0, v6
v_smfmac_f32_16x16x64_bf16 v[36:39], v[72:75], a[96:103], v0
ds_read_b128 v[48:51], v2 offset:9216
v_smfmac_f32_16x16x64_bf16 v[40:43], v[72:75], a[104:111], v0
ds_read_b128 v[72:75], v1 offset:9216
s_cbranch_vccnz L_ra1_w0f
L_a1_w0f:
v_smfmac_f32_16x16x64_bf16 v[20:23], v[60:63], v[112:119], v0
v_smfmac_f32_16x16x64_bf16 v[20:23], v[64:67], v[128:135], v0
s_waitcnt lgkmcnt(1)
v_smfmac_f32_16x16x64_bf16 v[20:23], v[76:79], v[44:51], v0
ds_read_b128 v[48:51], v2 offset:11264
v_bfe_u32 v6, v1, 5, 1
v_mad_i32_i24 v6, v6, s55, v1
v_smfmac_f32_16x16x64_bf16 v[20:23], v[68:71], v[144:151], v0
s_waitcnt lgkmcnt(1)
v_smfmac_f32_16x16x64_bf16 v[20:23], v[72:75], v[160:167], v0
ds_read_b128 v[44:47], v2 offset:10240
v_smfmac_f32_16x16x64_bf16 v[24:27], v[60:63], v[120:127], v0
v_smfmac_f32_16x16x64_bf16 v[24:27], v[64:67], v[136:143], v0
v_smfmac_f32_16x16x64_bf16 v[24:27], v[68:71], v[152:159], v0
v_add_f32 v21, v21, v23
v_smfmac_f32_16x16x64_bf16 v[24:27], v[72:75], v[168:175], v0
s_waitcnt lgkmcnt(0)
v_smfmac_f32_16x16x64_bf16 v[24:27], v[76:79], v[44:51], v0
ds_read_b128 v[44:47], v2 offset:12288
v_add_f32 v20, v20, v22
v_cvt_pk_bf16_f32 v22, v20, v21
v_smfmac_f32_16x16x64_bf16 v[28:31], v[76:79], v[240:247], v0
v_smfmac_f32_16x16x64_bf16 v[28:31], v[64:67], a[0:7], v0
ds_read_b128 v[48:51], v2 offset:13312
v_add_f32 v25, v25, v27
v_add_f32 v24, v24, v26
v_cvt_pk_bf16_f32 v23, v24, v25
v_smfmac_f32_16x16x64_bf16 v[28:31], v[72:75], a[32:39], v0
ds_write_b64 v3, v[22:23] offset:10240
v_smfmac_f32_16x16x64_bf16 v[28:31], v[68:71], a[16:23], v0
s_waitcnt vmcnt(1)
v_smfmac_f32_16x16x64_bf16 v[32:35], v[76:79], v[248:255], v0
s_waitcnt lgkmcnt(1)
v_smfmac_f32_16x16x64_bf16 v[28:31], v[60:63], v[44:51], v0
ds_read_b128 v[44:47], v2 offset:14336
ds_read_b128 v[48:51], v2 offset:15360
v_smfmac_f32_16x16x64_bf16 v[32:35], v[64:67], a[8:15], v0
s_waitcnt lgkmcnt(2)
s_barrier
ds_read_b64_tr_b16 v[20:21], v4 offset:10240
v_smfmac_f32_16x16x64_bf16 v[32:35], v[68:71], a[24:31], v0
ds_read_b64_tr_b16 v[22:23], v4 offset:10752
v_add_f32 v29, v29, v31
v_smfmac_f32_16x16x64_bf16 v[32:35], v[72:75], a[40:47], v0
ds_read_b64_tr_b16 v[24:25], v4 offset:11264
ds_read_b64_tr_b16 v[26:27], v4 offset:11776
s_waitcnt lgkmcnt(4)
v_smfmac_f32_16x16x64_bf16 v[32:35], v[60:63], v[44:51], v0
ds_read_b128 v[48:51], v2 offset:19456
s_waitcnt lgkmcnt(3)
v_mfma_f32_16x16x32_bf16 v[12:15], v[12:15], v[20:23], 0
ds_read_b128 v[44:47], v2 offset:18432
v_add_f32 v28, v28, v30
s_waitcnt lgkmcnt(2)
v_mfma_f32_16x16x32_bf16 v[12:15], v[16:19], v[24:27], v[12:15]
v_add_f32 v32, v32, v34
v_add_f32 v33, v33, v35
v_cvt_pk_bf16_f32 v31, v32, v33
v_cvt_pk_bf16_f32 v30, v28, v29
v_smfmac_f32_16x16x64_bf16 v[36:39], v[76:79], a[112:119], v0
ds_write_b64 v3, v[30:31] offset:12288
v_add_f32_dpp v12, v14, v12 quad_perm:[2,3,0,1] row_mask:0xf bank_mask:0xf
v_exp_f32 v14, v12
v_add_f32_dpp v13, v15, v13 quad_perm:[2,3,0,1] row_mask:0xf bank_mask:0xf
v_exp_f32 v15, v13
s_nop 0
v_cvt_pk_bf16_f32 v14, v14, v15
v_smfmac_f32_16x16x64_bf16 v[40:43], v[76:79], a[120:127], v0
ds_write_b32 v5, v14 offset:14368
s_waitcnt lgkmcnt(2)
v_smfmac_f32_16x16x64_bf16 v[40:43], v[72:75], v[44:51], v0
ds_read_b128 v[44:47], v2 offset:16384
s_waitcnt lgkmcnt(2)
s_barrier
ds_read_b64_tr_b16 v[28:29], v4 offset:12288
v_smfmac_f32_16x16x64_bf16 v[36:39], v[60:63], a[128:135], v0
ds_read_b64_tr_b16 v[30:31], v4 offset:12800
ds_read_b64_tr_b16 v[32:33], v4 offset:13312
v_smfmac_f32_16x16x64_bf16 v[40:43], v[60:63], a[136:143], v0
ds_read_b64_tr_b16 v[34:35], v4 offset:13824
v_mov_b64 v[76:77], s[52:53]
s_waitcnt lgkmcnt(2)
v_mfma_f32_16x16x32_bf16 v[28:31], v[28:31], v[20:23], 0
s_barrier
ds_read_b128 v[16:19], v1 offset:14368
s_waitcnt lgkmcnt(1)
v_mfma_f32_16x16x32_bf16 v[28:31], v[32:35], v[24:27], v[28:31]
ds_read_b128 v[60:63], v1 offset:14336
v_mov_b64 v[14:15], s[0:1]
v_smfmac_f32_16x16x64_bf16 v[40:43], v[64:67], a[152:159], v0
ds_read_b128 v[48:51], v2 offset:17408
v_mov_b64 v[78:79], s[52:53]
v_smfmac_f32_16x16x64_bf16 v[40:43], v[68:71], a[168:175], v0
v_add_f32_dpp v28, v30, v28 quad_perm:[2,3,0,1] row_mask:0xf bank_mask:0xf
v_smfmac_f32_16x16x64_bf16 v[36:39], v[64:67], a[144:151], v0
ds_read_b128 v[64:67], v2 offset:25600
v_add_f32_dpp v29, v31, v29 quad_perm:[2,3,0,1] row_mask:0xf bank_mask:0xf
s_waitcnt lgkmcnt(1)
v_smfmac_f32_16x16x64_bf16 v[36:39], v[72:75], v[44:51], v0
ds_read_b128 v[72:75], v2 offset:29696
v_mul_f32 v28, s50, v28
v_smfmac_f32_16x16x64_bf16 v[36:39], v[68:71], a[160:167], v0
ds_read_b128 v[68:71], v2 offset:28672
v_cvt_pk_bf16_f32 v40, v40, v41
v_mfma_f32_16x16x32_bf16 v[32:35], v[76:79], v[16:19], 0
v_exp_f32 v30, v28
ds_read_b128 v[44:47], v2 offset:20480
v_mfma_f32_16x16x32_bf16 v[20:23], v[52:55], v[16:19], 0
v_mul_f32 v29, s50, v29
v_cvt_pk_bf16_f32 v41, v42, v43
v_cvt_pk_bf16_f32 v43, v38, v39
v_mov_b64 v[76:77], 0
v_exp_f32 v31, v29
v_mfma_f32_16x16x32_bf16 v[20:23], v[56:59], v[60:63], v[20:23]
v_cvt_pk_bf16_f32 v30, v30, v31
v_cndmask_b32_e64 v26, 0, v30, s[56:57]
v_cndmask_b32_e64 v27, 0, v30, s[56:57]
s_nop 0
v_mov_b32_dpp v24, v26 quad_perm:[2,3,0,1] row_mask:0xf bank_mask:0xf
v_mfma_f32_16x16x16_bf16 v[32:35], v[14:15], v[26:27], v[32:35]
v_mov_b32_dpp v25, v26 quad_perm:[2,3,0,1] row_mask:0xf bank_mask:0xf
v_cvt_pk_bf16_f32 v42, v36, v37
s_nop 1
v_mfma_f32_16x16x32_bf16 v[20:23], v[40:43], v[24:27], v[20:23]
ds_read_b128 v[60:63], v2 offset:24576
ds_read_b128 v[48:51], v2 offset:21504
v_mov_b64 v[78:79], 0
v_rcp_f32 v33, v32
v_mov_b64 v[36:37], 0
v_min_f32 v32, v32, v33
v_cmp_nlt_f32 vcc, s2, v32
v_mul_f32_dpp v23, v33, v23 quad_perm:[0,1,0,1] row_mask:0xf bank_mask:0xf
v_mul_f32_dpp v21, v33, v21 quad_perm:[0,1,0,1] row_mask:0xf bank_mask:0xf
v_mul_f32_dpp v22, v33, v22 quad_perm:[0,1,0,1] row_mask:0xf bank_mask:0xf
v_mul_f32_dpp v20, v33, v20 quad_perm:[0,1,0,1] row_mask:0xf bank_mask:0xf
v_cvt_pk_bf16_f32 v20, v20, v21
v_cvt_pk_bf16_f32 v21, v22, v23
ds_write_b64 v6, v[20:21] offset:5120
s_and_b64 vcc, vcc, s[56:57]
s_cbranch_scc1 L_mx_w0f
L_mxb_w0f:
v_mov_b64 v[38:39], 0
v_mov_b32_dpp v19, v21 quad_perm:[2,3,2,3] row_mask:0xf bank_mask:0xf
v_mov_b32_dpp v16, v20 quad_perm:[0,1,0,1] row_mask:0xf bank_mask:0xf
v_mov_b32_dpp v18, v20 quad_perm:[2,3,2,3] row_mask:0xf bank_mask:0xf
v_mov_b32_dpp v17, v21 quad_perm:[0,1,0,1] row_mask:0xf bank_mask:0xf
v_mov_b64 v[24:25], 0
v_mov_b64 v[26:27], 0
v_smfmac_f32_16x16x64_bf16 v[76:79], v[16:19], a[176:183], v0
s_waitcnt lgkmcnt(0)
s_barrier
v_mov_b64 v[32:33], 0
ds_read_b128 v[12:15], v7 offset:7168
ds_read_b128 v[52:55], v7 offset:6144
v_smfmac_f32_16x16x64_bf16 v[36:39], v[16:19], v[44:51], v0
ds_read_b128 v[48:51], v2 offset:23552
ds_read_b128 v[56:59], v7 offset:8192
v_mov_b64 v[30:31], 0
v_mov_b64 v[34:35], 0
v_smfmac_f32_16x16x64_bf16 v[24:27], v[16:19], v[60:67], v0
ds_read_b128 v[44:47], v2 offset:22528
v_smfmac_f32_16x16x64_bf16 v[32:35], v[16:19], v[68:75], v0
ds_read_b128 v[68:71], v2 offset:30720
s_waitcnt lgkmcnt(5)
v_smfmac_f32_16x16x64_bf16 v[76:79], v[12:15], a[184:191], v0
ds_read_b128 v[60:63], v2 offset:26624
s_waitcnt lgkmcnt(5)
v_smfmac_f32_16x16x64_bf16 v[76:79], v[52:55], a[192:199], v0
ds_read_b128 v[64:67], v2 offset:27648
s_waitcnt lgkmcnt(4)
v_smfmac_f32_16x16x64_bf16 v[76:79], v[56:59], a[200:207], v0
v_mov_b64 v[28:29], 0
v_smfmac_f32_16x16x64_bf16 v[36:39], v[12:15], a[208:215], v0
ds_read_b128 v[72:75], v2 offset:31744
s_waitcnt lgkmcnt(4)
v_smfmac_f32_16x16x64_bf16 v[36:39], v[52:55], v[44:51], v0
ds_read_b128 v[44:47], v2 offset:32768
v_cvt_pk_bf16_f32 v77, v77, v79
v_cvt_pk_bf16_f32 v76, v76, v78
v_bfi_b32 v76, 1, s35, v76
v_smfmac_f32_16x16x64_bf16 v[36:39], v[56:59], a[216:223], v0
v_smfmac_f32_16x16x64_bf16 v[24:27], v[12:15], a[224:231], v0
buffer_store_dwordx2 v[76:77], v8, s[4:7], s42 offen
s_waitcnt lgkmcnt(2)
v_smfmac_f32_16x16x64_bf16 v[24:27], v[52:55], v[60:67], v0
ds_read_b128 v[48:51], v2 offset:33792
ds_read_b128 v[60:63], v2 offset:36864
v_cvt_pk_bf16_f32 v36, v36, v38
v_bfi_b32 v36, 1, s35, v36
v_cvt_pk_bf16_f32 v37, v37, v39
v_smfmac_f32_16x16x64_bf16 v[24:27], v[56:59], a[232:239], v0
buffer_store_dwordx2 v[36:37], v8, s[4:7], s43 offen
ds_read_b128 v[64:67], v2 offset:37888
v_smfmac_f32_16x16x64_bf16 v[32:35], v[12:15], a[240:247], v0
ds_read_b128 v[40:43], v2 offset:35840
s_waitcnt lgkmcnt(5)
v_smfmac_f32_16x16x64_bf16 v[32:35], v[52:55], v[68:75], v0
ds_read_b128 v[72:75], v2 offset:39936
ds_read_b128 v[36:39], v2 offset:34816
v_cvt_pk_bf16_f32 v25, v25, v27
v_cvt_pk_bf16_f32 v24, v24, v26
v_bfi_b32 v24, 1, s35, v24
buffer_store_dwordx2 v[24:25], v8, s[4:7], s44 offen
v_smfmac_f32_16x16x64_bf16 v[32:35], v[56:59], a[248:255], v0
ds_read_b128 v[68:71], v2 offset:38912
s_waitcnt lgkmcnt(6)
v_smfmac_f32_16x16x64_bf16 v[28:31], v[16:19], v[44:51], v0
s_nop 3
v_cvt_pk_bf16_f32 v33, v33, v35
v_cvt_pk_bf16_f32 v32, v32, v34
v_bfi_b32 v32, 1, s35, v32
buffer_store_dwordx2 v[32:33], v8, s[4:7], s45 offen
s_waitcnt lgkmcnt(1)
v_smfmac_f32_16x16x64_bf16 v[28:31], v[52:55], v[36:43], v0
v_smfmac_f32_16x16x64_bf16 v[28:31], v[12:15], v[60:67], v0
s_waitcnt lgkmcnt(0)
v_smfmac_f32_16x16x64_bf16 v[28:31], v[56:59], v[68:75], v0
s_nop 7
v_cvt_pk_bf16_f32 v28, v28, v30
v_bfi_b32 v28, 1, s35, v28
v_cvt_pk_bf16_f32 v29, v29, v31
buffer_store_dwordx2 v[28:29], v8, s[4:7], s46 offen
s_branch L_ex_w0f
.p2align 6
L_ex_w0rf:
v_and_b32 v6, 0x70, v1
ds_read_b128 v[76:79], v6 offset:256
v_bfe_u32 v11, v1, 4, 2
v_lshrrev_b32_e64 v11, v11, 1
v_mov_b64 v[20:21], 0
v_mov_b64 v[22:23], 0
v_mov_b64 v[24:25], 0
v_mov_b64 v[26:27], 0
v_mov_b64 v[28:29], 0
v_mov_b64 v[30:31], 0
v_mov_b64 v[32:33], 0
v_mov_b64 v[34:35], 0
ds_read_b128 v[44:47], v2 offset:0
ds_read_b128 v[48:51], v2 offset:1024
s_add_u32 s34, s34, 1
s_not_b32 s35, s35
s_not_b32 s36, s36
s_barrier
s_waitcnt vmcnt(0)
s_add_u32 s37, s37, 524288
s_add_u32 s39, s39, 524288
s_mul_i32 s40, s34, 10240
s_add_u32 s40, s40, 8093696
buffer_load_dwordx4 v[60:63], v9, s[4:7], s3 offen offset:0 sc1
buffer_load_dwordx4 v[64:67], v9, s[4:7], s3 offen offset:1024 sc1
buffer_load_dwordx4 v[68:71], v9, s[4:7], s3 offen offset:2048 sc1
buffer_load_dwordx4 v[72:75], v9, s[4:7], s3 offen offset:3072 sc1
s_waitcnt lgkmcnt(2)
s_waitcnt vmcnt(3)
L_r_w0rf:
v_mfma_f32_16x16x32_bf16 v[36:39], v[60:63], v[76:79], 0
s_waitcnt vmcnt(2)
v_mfma_f32_16x16x32_bf16 v[36:39], v[64:67], v[76:79], v[36:39]
v_bitop3_b32 v40, v60, v64, s36 bitop3:0x7e
s_waitcnt vmcnt(1)
v_mfma_f32_16x16x32_bf16 v[36:39], v[68:71], v[76:79], v[36:39]
s_waitcnt vmcnt(0)
v_mfma_f32_16x16x32_bf16 v[36:39], v[72:75], v[76:79], v[36:39]
v_bitop3_b32 v41, v68, v72, s36 bitop3:0x7e
v_bitop3_b32 v40, v40, v41, 1 bitop3:0xa8
v_cmp_ne_u32 vcc, 0, v40
v_nop
v_nop
v_nop
v_nop
v_nop
v_pk_add_f32 v[36:37], v[36:37], v[38:39]
v_cvt_pk_bf16_f32 v40, v36, v37
v_bfi_b32 v40, v11, s35, v40
s_cbranch_vccnz L_rr_w0rf
buffer_store_dword v40, v10, s[4:7], 0 offen
s_cmp_eq_u32 s34, 63
v_mov_b32 v11, v40
s_cbranch_scc1 L_done_w0rf
v_mov_b64 v[36:37], 0
v_mov_b64 v[38:39], 0
v_mov_b64 v[40:41], 0
v_mov_b64 v[42:43], 0
v_bfe_u32 v77, v1, 6, 1
v_lshl_add_u32 v77, v77, 3, v1
v_lshlrev_b32 v77, 1, v77
v_lshlrev_b32 v78, 3, v1
L_top_w0rf:
s_barrier
ds_read_b128 v[60:63], v1 offset:1024
s_mov_b32 m0, 5120
s_nop 0
buffer_load_dwordx4 v1, s[4:7], s48 offen offset:0 sc1 lds
s_barrier
ds_read_b128 v[64:67], v1 offset:2048
ds_read_b128 v[68:71], v1 offset:3072
ds_read_b128 v[72:75], v1 offset:4096
L_s0_w0rf:
s_waitcnt lgkmcnt(3)
v_smfmac_f32_16x16x64_bf16 v[32:35], v[60:63], v[184:191], v0
v_smfmac_f32_16x16x64_bf16 v[20:23], v[60:63], v[44:51], v0
v_smfmac_f32_16x16x64_bf16 v[36:39], v[60:63], a[48:55], v0
buffer_load_dwordx4 v[12:15], v9, s[4:7], s37 offen offset:0
v_smfmac_f32_16x16x64_bf16 v[28:31], v[60:63], v[176:183], v0
buffer_load_dwordx4 v[16:19], v9, s[4:7], s37 offen offset:1024
v_smfmac_f32_16x16x64_bf16 v[40:43], v[60:63], a[56:63], v0
s_waitcnt lgkmcnt(2)
v_smfmac_f32_16x16x64_bf16 v[28:31], v[64:67], v[192:199], v0
ds_read_b128 v[48:51], v2 offset:3072
v_smfmac_f32_16x16x64_bf16 v[20:23], v[64:67], v[80:87], v0
ds_read_b128 v[44:47], v2 offset:2048
v_smfmac_f32_16x16x64_bf16 v[32:35], v[64:67], v[200:207], v0
buffer_load_dwordx4 v[52:55], v1, s[4:7], s37 offen offset:2048
v_bitop3_b32 v6, v60, v64, s35 bitop3:0x7e
s_waitcnt lgkmcnt(2)
v_bitop3_b32 v76, v68, v72, s35 bitop3:0x7e
v_bitop3_b32 v6, v6, v76, 1 bitop3:0xa8
v_smfmac_f32_16x16x64_bf16 v[24:27], v[64:67], v[88:95], v0
s_waitcnt lgkmcnt(0)
v_smfmac_f32_16x16x64_bf16 v[24:27], v[60:63], v[44:51], v0
buffer_load_dwordx4 v[56:59], v1, s[4:7], s37 offen offset:3072
v_smfmac_f32_16x16x64_bf16 v[40:43], v[64:67], a[72:79], v0
v_smfmac_f32_16x16x64_bf16 v[36:39], v[64:67], a[64:71], v0
ds_read_b128 v[44:47], v2 offset:4096
v_cmp_ne_u32 vcc, 0, v6
v_smfmac_f32_16x16x64_bf16 v[20:23], v[68:71], v[96:103], v0
ds_read_b128 v[48:51], v2 offset:5120
v_smfmac_f32_16x16x64_bf16 v[24:27], v[68:71], v[104:111], v0
s_cbranch_vccnz L_ra0_w0rf
s_waitcnt vmcnt(4)
s_barrier
ds_read_b32 v6, v77 offset:8192
v_smfmac_f32_16x16x64_bf16 v[28:31], v[68:71], v[208:215], v0
s_mov_b32 m0, 0
ds_read_b128 v[60:63], v1 offset:6144
buffer_store_dword v11, v10, s[4:7], s40 offen sc0 sc1
s_waitcnt lgkmcnt(2)
v_smfmac_f32_16x16x64_bf16 v[20:23], v[72:75], v[44:51], v0
buffer_load_dword v78, s[4:7], s39 offen lds
ds_read_b128 v[76:79], v1 offset:5120
v_smfmac_f32_16x16x64_bf16 v[28:31], v[72:75], v[224:231], v0
ds_read_b128 v[64:67], v1 offset:7168
ds_read_b128 v[44:47], v2 offset:6144
v_smfmac_f32_16x16x64_bf16 v[32:35], v[68:71], v[216:223], v0
v_smfmac_f32_16x16x64_bf16 v[36:39], v[68:71], a[80:87], v0
ds_read_b128 v[48:51], v2 offset:7168
s_waitcnt lgkmcnt(4)
v_bitop3_b32 v6, v6, v60, s35 bitop3:0x7e
v_smfmac_f32_16x16x64_bf16 v[40:43], v[68:71], a[88:95], v0
ds_read_b128 v[68:71], v1 offset:8192
v_smfmac_f32_16x16x64_bf16 v[32:35], v[72:75], v[232:239], v0
s_waitcnt lgkmcnt(3)
v_bitop3_b32 v6, v6, v64, s35 bitop3:0xf6
v_bitop3_b32 v6, v6, v76, s35 bitop3:0xf6
v_and_b32 v6, 1, v6
s_waitcnt lgkmcnt(1)
v_smfmac_f32_16x16x64_bf16 v[24:27], v[72:75], v[44:51], v0
ds_read_b128 v[44:47], v2 offset:8192
v_cmp_ne_u32 vcc, 0, v6
v_smfmac_f32_16x16x64_bf16 v[36:39], v[72:75], a[96:103], v0
ds_read_b128 v[48:51], v2 offset:9216
v_smfmac_f32_16x16x64_bf16 v[40:43], v[72:75], a[104:111], v0
ds_read_b128 v[72:75], v1 offset:9216
s_cbranch_vccnz L_ra1_w0rf
L_a1_w0rf:
v_smfmac_f32_16x16x64_bf16 v[20:23], v[60:63], v[112:119], v0
v_smfmac_f32_16x16x64_bf16 v[20:23], v[64:67], v[128:135], v0
s_waitcnt lgkmcnt(1)
v_smfmac_f32_16x16x64_bf16 v[20:23], v[76:79], v[44:51], v0
ds_read_b128 v[48:51], v2 offset:11264
v_bfe_u32 v6, v1, 5, 1
v_mad_i32_i24 v6, v6, s55, v1
v_smfmac_f32_16x16x64_bf16 v[20:23], v[68:71], v[144:151], v0
s_waitcnt lgkmcnt(1)
v_smfmac_f32_16x16x64_bf16 v[20:23], v[72:75], v[160:167], v0
ds_read_b128 v[44:47], v2 offset:10240
v_smfmac_f32_16x16x64_bf16 v[24:27], v[60:63], v[120:127], v0
v_smfmac_f32_16x16x64_bf16 v[24:27], v[64:67], v[136:143], v0
v_smfmac_f32_16x16x64_bf16 v[24:27], v[68:71], v[152:159], v0
v_add_f32 v21, v21, v23
v_smfmac_f32_16x16x64_bf16 v[24:27], v[72:75], v[168:175], v0
s_waitcnt lgkmcnt(0)
v_smfmac_f32_16x16x64_bf16 v[24:27], v[76:79], v[44:51], v0
ds_read_b128 v[44:47], v2 offset:12288
v_add_f32 v20, v20, v22
v_cvt_pk_bf16_f32 v22, v20, v21
v_smfmac_f32_16x16x64_bf16 v[28:31], v[76:79], v[240:247], v0
v_smfmac_f32_16x16x64_bf16 v[28:31], v[64:67], a[0:7], v0
ds_read_b128 v[48:51], v2 offset:13312
v_add_f32 v25, v25, v27
v_add_f32 v24, v24, v26
v_cvt_pk_bf16_f32 v23, v24, v25
v_smfmac_f32_16x16x64_bf16 v[28:31], v[72:75], a[32:39], v0
ds_write_b64 v3, v[22:23] offset:10240
v_smfmac_f32_16x16x64_bf16 v[28:31], v[68:71], a[16:23], v0
s_waitcnt vmcnt(2)
v_smfmac_f32_16x16x64_bf16 v[32:35], v[76:79], v[248:255], v0
s_waitcnt lgkmcnt(1)
v_smfmac_f32_16x16x64_bf16 v[28:31], v[60:63], v[44:51], v0
ds_read_b128 v[44:47], v2 offset:14336
ds_read_b128 v[48:51], v2 offset:15360
v_smfmac_f32_16x16x64_bf16 v[32:35], v[64:67], a[8:15], v0
s_waitcnt lgkmcnt(2)
s_barrier
ds_read_b64_tr_b16 v[20:21], v4 offset:10240
v_smfmac_f32_16x16x64_bf16 v[32:35], v[68:71], a[24:31], v0
ds_read_b64_tr_b16 v[22:23], v4 offset:10752
v_add_f32 v29, v29, v31
v_smfmac_f32_16x16x64_bf16 v[32:35], v[72:75], a[40:47], v0
ds_read_b64_tr_b16 v[24:25], v4 offset:11264
ds_read_b64_tr_b16 v[26:27], v4 offset:11776
s_waitcnt lgkmcnt(4)
v_smfmac_f32_16x16x64_bf16 v[32:35], v[60:63], v[44:51], v0
ds_read_b128 v[48:51], v2 offset:19456
s_waitcnt lgkmcnt(3)
v_mfma_f32_16x16x32_bf16 v[12:15], v[12:15], v[20:23], 0
ds_read_b128 v[44:47], v2 offset:18432
v_add_f32 v28, v28, v30
s_waitcnt lgkmcnt(2)
v_mfma_f32_16x16x32_bf16 v[12:15], v[16:19], v[24:27], v[12:15]
v_add_f32 v32, v32, v34
v_add_f32 v33, v33, v35
v_cvt_pk_bf16_f32 v31, v32, v33
v_cvt_pk_bf16_f32 v30, v28, v29
v_smfmac_f32_16x16x64_bf16 v[36:39], v[76:79], a[112:119], v0
ds_write_b64 v3, v[30:31] offset:12288
v_add_f32_dpp v12, v14, v12 quad_perm:[2,3,0,1] row_mask:0xf bank_mask:0xf
v_exp_f32 v14, v12
v_add_f32_dpp v13, v15, v13 quad_perm:[2,3,0,1] row_mask:0xf bank_mask:0xf
v_exp_f32 v15, v13
s_nop 0
v_cvt_pk_bf16_f32 v14, v14, v15
v_smfmac_f32_16x16x64_bf16 v[40:43], v[76:79], a[120:127], v0
ds_write_b32 v5, v14 offset:14368
s_waitcnt lgkmcnt(2)
v_smfmac_f32_16x16x64_bf16 v[40:43], v[72:75], v[44:51], v0
ds_read_b128 v[44:47], v2 offset:16384
s_waitcnt lgkmcnt(2)
s_barrier
ds_read_b64_tr_b16 v[28:29], v4 offset:12288
v_smfmac_f32_16x16x64_bf16 v[36:39], v[60:63], a[128:135], v0
ds_read_b64_tr_b16 v[30:31], v4 offset:12800
ds_read_b64_tr_b16 v[32:33], v4 offset:13312
v_smfmac_f32_16x16x64_bf16 v[40:43], v[60:63], a[136:143], v0
ds_read_b64_tr_b16 v[34:35], v4 offset:13824
v_mov_b64 v[76:77], s[52:53]
s_waitcnt lgkmcnt(2)
v_mfma_f32_16x16x32_bf16 v[28:31], v[28:31], v[20:23], 0
s_barrier
ds_read_b128 v[16:19], v1 offset:14368
s_waitcnt lgkmcnt(1)
v_mfma_f32_16x16x32_bf16 v[28:31], v[32:35], v[24:27], v[28:31]
ds_read_b128 v[60:63], v1 offset:14336
v_mov_b64 v[14:15], s[0:1]
v_smfmac_f32_16x16x64_bf16 v[40:43], v[64:67], a[152:159], v0
ds_read_b128 v[48:51], v2 offset:17408
v_mov_b64 v[78:79], s[52:53]
v_smfmac_f32_16x16x64_bf16 v[40:43], v[68:71], a[168:175], v0
v_add_f32_dpp v28, v30, v28 quad_perm:[2,3,0,1] row_mask:0xf bank_mask:0xf
v_smfmac_f32_16x16x64_bf16 v[36:39], v[64:67], a[144:151], v0
ds_read_b128 v[64:67], v2 offset:25600
v_add_f32_dpp v29, v31, v29 quad_perm:[2,3,0,1] row_mask:0xf bank_mask:0xf
s_waitcnt lgkmcnt(1)
v_smfmac_f32_16x16x64_bf16 v[36:39], v[72:75], v[44:51], v0
ds_read_b128 v[72:75], v2 offset:29696
v_mul_f32 v28, s50, v28
v_smfmac_f32_16x16x64_bf16 v[36:39], v[68:71], a[160:167], v0
ds_read_b128 v[68:71], v2 offset:28672
v_cvt_pk_bf16_f32 v40, v40, v41
v_mfma_f32_16x16x32_bf16 v[32:35], v[76:79], v[16:19], 0
v_exp_f32 v30, v28
ds_read_b128 v[44:47], v2 offset:20480
v_mfma_f32_16x16x32_bf16 v[20:23], v[52:55], v[16:19], 0
v_mul_f32 v29, s50, v29
v_cvt_pk_bf16_f32 v41, v42, v43
v_cvt_pk_bf16_f32 v43, v38, v39
v_mov_b64 v[76:77], 0
v_exp_f32 v31, v29
v_mfma_f32_16x16x32_bf16 v[20:23], v[56:59], v[60:63], v[20:23]
v_cvt_pk_bf16_f32 v30, v30, v31
v_cndmask_b32_e64 v26, 0, v30, s[56:57]
v_cndmask_b32_e64 v27, 0, v30, s[56:57]
s_nop 0
v_mov_b32_dpp v24, v26 quad_perm:[2,3,0,1] row_mask:0xf bank_mask:0xf
v_mfma_f32_16x16x16_bf16 v[32:35], v[14:15], v[26:27], v[32:35]
v_mov_b32_dpp v25, v26 quad_perm:[2,3,0,1] row_mask:0xf bank_mask:0xf
v_cvt_pk_bf16_f32 v42, v36, v37
s_nop 1
v_mfma_f32_16x16x32_bf16 v[20:23], v[40:43], v[24:27], v[20:23]
ds_read_b128 v[60:63], v2 offset:24576
ds_read_b128 v[48:51], v2 offset:21504
v_mov_b64 v[78:79], 0
v_rcp_f32 v33, v32
v_mov_b64 v[36:37], 0
v_min_f32 v32, v32, v33
v_cmp_nlt_f32 vcc, s2, v32
v_mul_f32_dpp v23, v33, v23 quad_perm:[0,1,0,1] row_mask:0xf bank_mask:0xf
v_mul_f32_dpp v21, v33, v21 quad_perm:[0,1,0,1] row_mask:0xf bank_mask:0xf
v_mul_f32_dpp v22, v33, v22 quad_perm:[0,1,0,1] row_mask:0xf bank_mask:0xf
v_mul_f32_dpp v20, v33, v20 quad_perm:[0,1,0,1] row_mask:0xf bank_mask:0xf
v_cvt_pk_bf16_f32 v20, v20, v21
v_cvt_pk_bf16_f32 v21, v22, v23
ds_write_b64 v6, v[20:21] offset:5120
s_and_b64 vcc, vcc, s[56:57]
s_cbranch_scc1 L_mx_w0rf
L_mxb_w0rf:
v_mov_b64 v[38:39], 0
v_mov_b32_dpp v19, v21 quad_perm:[2,3,2,3] row_mask:0xf bank_mask:0xf
v_mov_b32_dpp v16, v20 quad_perm:[0,1,0,1] row_mask:0xf bank_mask:0xf
v_mov_b32_dpp v18, v20 quad_perm:[2,3,2,3] row_mask:0xf bank_mask:0xf
v_mov_b32_dpp v17, v21 quad_perm:[0,1,0,1] row_mask:0xf bank_mask:0xf
v_mov_b64 v[24:25], 0
v_mov_b64 v[26:27], 0
v_smfmac_f32_16x16x64_bf16 v[76:79], v[16:19], a[176:183], v0
s_waitcnt lgkmcnt(0)
s_barrier
v_mov_b64 v[32:33], 0
ds_read_b128 v[12:15], v7 offset:7168
ds_read_b128 v[52:55], v7 offset:6144
v_smfmac_f32_16x16x64_bf16 v[36:39], v[16:19], v[44:51], v0
ds_read_b128 v[48:51], v2 offset:23552
ds_read_b128 v[56:59], v7 offset:8192
v_mov_b64 v[30:31], 0
v_mov_b64 v[34:35], 0
v_smfmac_f32_16x16x64_bf16 v[24:27], v[16:19], v[60:67], v0
ds_read_b128 v[44:47], v2 offset:22528
v_smfmac_f32_16x16x64_bf16 v[32:35], v[16:19], v[68:75], v0
ds_read_b128 v[68:71], v2 offset:30720
s_waitcnt lgkmcnt(5)
v_smfmac_f32_16x16x64_bf16 v[76:79], v[12:15], a[184:191], v0
ds_read_b128 v[60:63], v2 offset:26624
s_waitcnt lgkmcnt(5)
v_smfmac_f32_16x16x64_bf16 v[76:79], v[52:55], a[192:199], v0
ds_read_b128 v[64:67], v2 offset:27648
s_waitcnt lgkmcnt(4)
v_smfmac_f32_16x16x64_bf16 v[76:79], v[56:59], a[200:207], v0
v_mov_b64 v[28:29], 0
v_smfmac_f32_16x16x64_bf16 v[36:39], v[12:15], a[208:215], v0
ds_read_b128 v[72:75], v2 offset:31744
s_waitcnt lgkmcnt(4)
v_smfmac_f32_16x16x64_bf16 v[36:39], v[52:55], v[44:51], v0
ds_read_b128 v[44:47], v2 offset:32768
v_cvt_pk_bf16_f32 v77, v77, v79
v_cvt_pk_bf16_f32 v76, v76, v78
v_bfi_b32 v76, 1, s35, v76
v_smfmac_f32_16x16x64_bf16 v[36:39], v[56:59], a[216:223], v0
v_smfmac_f32_16x16x64_bf16 v[24:27], v[12:15], a[224:231], v0
buffer_store_dwordx2 v[76:77], v8, s[4:7], s42 offen
s_waitcnt lgkmcnt(2)
v_smfmac_f32_16x16x64_bf16 v[24:27], v[52:55], v[60:67], v0
ds_read_b128 v[48:51], v2 offset:33792
ds_read_b128 v[60:63], v2 offset:36864
v_cvt_pk_bf16_f32 v36, v36, v38
v_bfi_b32 v36, 1, s35, v36
v_cvt_pk_bf16_f32 v37, v37, v39
v_smfmac_f32_16x16x64_bf16 v[24:27], v[56:59], a[232:239], v0
buffer_store_dwordx2 v[36:37], v8, s[4:7], s43 offen
ds_read_b128 v[64:67], v2 offset:37888
v_smfmac_f32_16x16x64_bf16 v[32:35], v[12:15], a[240:247], v0
ds_read_b128 v[40:43], v2 offset:35840
s_waitcnt lgkmcnt(5)
v_smfmac_f32_16x16x64_bf16 v[32:35], v[52:55], v[68:75], v0
ds_read_b128 v[72:75], v2 offset:39936
ds_read_b128 v[36:39], v2 offset:34816
v_cvt_pk_bf16_f32 v25, v25, v27
v_cvt_pk_bf16_f32 v24, v24, v26
v_bfi_b32 v24, 1, s35, v24
buffer_store_dwordx2 v[24:25], v8, s[4:7], s44 offen
v_smfmac_f32_16x16x64_bf16 v[32:35], v[56:59], a[248:255], v0
ds_read_b128 v[68:71], v2 offset:38912
s_waitcnt lgkmcnt(6)
v_smfmac_f32_16x16x64_bf16 v[28:31], v[16:19], v[44:51], v0
s_nop 3
v_cvt_pk_bf16_f32 v33, v33, v35
v_cvt_pk_bf16_f32 v32, v32, v34
v_bfi_b32 v32, 1, s35, v32
buffer_store_dwordx2 v[32:33], v8, s[4:7], s45 offen
s_waitcnt lgkmcnt(1)
v_smfmac_f32_16x16x64_bf16 v[28:31], v[52:55], v[36:43], v0
v_smfmac_f32_16x16x64_bf16 v[28:31], v[12:15], v[60:67], v0
s_waitcnt lgkmcnt(0)
v_smfmac_f32_16x16x64_bf16 v[28:31], v[56:59], v[68:75], v0
s_nop 7
v_cvt_pk_bf16_f32 v28, v28, v30
v_bfi_b32 v28, 1, s35, v28
v_cvt_pk_bf16_f32 v29, v29, v31
buffer_store_dwordx2 v[28:29], v8, s[4:7], s46 offen
s_branch L_ex_w0rf
.p2align 6
L_ex_w1rf:
v_and_b32 v6, 0x70, v1
ds_read_b128 v[76:79], v6 offset:256
v_bfe_u32 v11, v1, 4, 2
v_lshrrev_b32_e64 v11, v11, 1
v_mov_b64 v[20:21], 0
v_mov_b64 v[22:23], 0
v_mov_b64 v[24:25], 0
v_mov_b64 v[26:27], 0
v_mov_b64 v[28:29], 0
v_mov_b64 v[30:31], 0
v_mov_b64 v[32:33], 0
v_mov_b64 v[34:35], 0
ds_read_b128 v[44:47], v2 offset:0
ds_read_b128 v[48:51], v2 offset:1024
s_add_u32 s34, s34, 1
s_not_b32 s35, s35
s_not_b32 s36, s36
s_add_u32 s37, s37, 524288
s_mul_i32 s40, s34, 10240
s_add_u32 s40, s40, 8093696
s_barrier
s_waitcnt vmcnt(0)
buffer_load_dwordx4 v[60:63], v9, s[4:7], s3 offen offset:0 sc1
buffer_load_dwordx4 v[64:67], v9, s[4:7], s3 offen offset:1024 sc1
buffer_load_dwordx4 v[68:71], v9, s[4:7], s3 offen offset:2048 sc1
buffer_load_dwordx4 v[72:75], v9, s[4:7], s3 offen offset:3072 sc1
s_waitcnt lgkmcnt(2)
s_waitcnt vmcnt(3)
L_r_w1rf:
v_mfma_f32_16x16x32_bf16 v[36:39], v[60:63], v[76:79], 0
s_waitcnt vmcnt(2)
v_mfma_f32_16x16x32_bf16 v[36:39], v[64:67], v[76:79], v[36:39]
v_bitop3_b32 v40, v60, v64, s36 bitop3:0x7e
s_waitcnt vmcnt(1)
v_mfma_f32_16x16x32_bf16 v[36:39], v[68:71], v[76:79], v[36:39]
s_waitcnt vmcnt(0)
v_mfma_f32_16x16x32_bf16 v[36:39], v[72:75], v[76:79], v[36:39]
v_bitop3_b32 v41, v68, v72, s36 bitop3:0x7e
v_bitop3_b32 v40, v40, v41, 1 bitop3:0xa8
v_cmp_ne_u32 vcc, 0, v40
v_nop
v_nop
v_nop
v_nop
v_nop
v_pk_add_f32 v[36:37], v[36:37], v[38:39]
v_cvt_pk_bf16_f32 v40, v36, v37
v_bfi_b32 v40, v11, s35, v40
s_cbranch_vccnz L_rr_w1rf
buffer_store_dword v40, v10, s[4:7], 0 offen
s_cmp_eq_u32 s34, 63
v_mov_b32 v11, v40
s_cbranch_scc1 L_done_w1rf
v_mov_b64 v[36:37], 0
v_mov_b64 v[38:39], 0
v_mov_b64 v[40:41], 0
v_mov_b64 v[42:43], 0
v_bfe_u32 v77, v1, 6, 1
v_lshl_add_u32 v77, v77, 3, v1
v_lshlrev_b32 v77, 1, v77
v_lshlrev_b32 v78, 3, v1
L_top_w1rf:
s_barrier
ds_read_b128 v[60:63], v1 offset:1024
s_mov_b32 m0, 5120
s_nop 0
buffer_load_dwordx4 v1, s[4:7], s48 offen offset:1024 sc1 lds
s_barrier
ds_read_b128 v[64:67], v1 offset:2048
ds_read_b128 v[68:71], v1 offset:3072
ds_read_b128 v[72:75], v1 offset:4096
L_s0_w1rf:
s_waitcnt lgkmcnt(3)
v_smfmac_f32_16x16x64_bf16 v[32:35], v[60:63], v[184:191], v0
v_smfmac_f32_16x16x64_bf16 v[20:23], v[60:63], v[44:51], v0
v_smfmac_f32_16x16x64_bf16 v[36:39], v[60:63], a[48:55], v0
s_waitcnt lgkmcnt(2)
v_smfmac_f32_16x16x64_bf16 v[28:31], v[64:67], v[192:199], v0
v_smfmac_f32_16x16x64_bf16 v[28:31], v[60:63], v[176:183], v0
buffer_load_dwordx4 v[12:15], v9, s[4:7], s37 offen offset:0
ds_read_b128 v[48:51], v2 offset:3072
ds_read_b128 v[44:47], v2 offset:2048
v_smfmac_f32_16x16x64_bf16 v[20:23], v[64:67], v[80:87], v0
buffer_load_dwordx4 v[16:19], v9, s[4:7], s37 offen offset:1024
v_smfmac_f32_16x16x64_bf16 v[32:35], v[64:67], v[200:207], v0
v_smfmac_f32_16x16x64_bf16 v[40:43], v[60:63], a[56:63], v0
v_bitop3_b32 v6, v60, v64, s35 bitop3:0x7e
v_smfmac_f32_16x16x64_bf16 v[24:27], v[64:67], v[88:95], v0
buffer_load_dwordx4 v[52:55], v1, s[4:7], s37 offen offset:2048
s_waitcnt lgkmcnt(0)
v_smfmac_f32_16x16x64_bf16 v[24:27], v[60:63], v[44:51], v0
v_bitop3_b32 v76, v68, v72, s35 bitop3:0x7e
v_smfmac_f32_16x16x64_bf16 v[36:39], v[64:67], a[64:71], v0
v_bitop3_b32 v6, v6, v76, 1 bitop3:0xa8
v_smfmac_f32_16x16x64_bf16 v[40:43], v[64:67], a[72:79], v0
buffer_load_dwordx4 v[56:59], v1, s[4:7], s37 offen offset:3072
ds_read_b128 v[44:47], v2 offset:4096
v_cmp_ne_u32 vcc, 0, v6
v_smfmac_f32_16x16x64_bf16 v[20:23], v[68:71], v[96:103], v0
ds_read_b128 v[48:51], v2 offset:5120
v_smfmac_f32_16x16x64_bf16 v[24:27], v[68:71], v[104:111], v0
s_cbranch_vccnz L_ra0_w1rf
s_waitcnt vmcnt(4)
s_barrier
ds_read_b32 v6, v77 offset:8192
v_smfmac_f32_16x16x64_bf16 v[28:31], v[68:71], v[208:215], v0
ds_read_b128 v[60:63], v1 offset:6144
s_waitcnt lgkmcnt(2)
v_smfmac_f32_16x16x64_bf16 v[20:23], v[72:75], v[44:51], v0
ds_read_b128 v[76:79], v1 offset:5120
ds_read_b128 v[44:47], v2 offset:6144
buffer_store_dword v11, v10, s[4:7], s40 offen sc0 sc1
v_smfmac_f32_16x16x64_bf16 v[28:31], v[72:75], v[224:231], v0
ds_read_b128 v[64:67], v1 offset:7168
v_smfmac_f32_16x16x64_bf16 v[36:39], v[68:71], a[80:87], v0
v_smfmac_f32_16x16x64_bf16 v[32:35], v[68:71], v[216:223], v0
ds_read_b128 v[48:51], v2 offset:7168
s_waitcnt lgkmcnt(4)
v_bitop3_b32 v6, v6, v60, s35 bitop3:0x7e
v_smfmac_f32_16x16x64_bf16 v[40:43], v[68:71], a[88:95], v0
ds_read_b128 v[68:71], v1 offset:8192
v_smfmac_f32_16x16x64_bf16 v[32:35], v[72:75], v[232:239], v0
s_waitcnt lgkmcnt(2)
v_bitop3_b32 v6, v6, v64, s35 bitop3:0xf6
v_bitop3_b32 v6, v6, v76, s35 bitop3:0xf6
v_and_b32 v6, 1, v6
s_waitcnt lgkmcnt(1)
v_smfmac_f32_16x16x64_bf16 v[24:27], v[72:75], v[44:51], v0
ds_read_b128 v[44:47], v2 offset:8192
v_cmp_ne_u32 vcc, 0, v6
v_smfmac_f32_16x16x64_bf16 v[36:39], v[72:75], a[96:103], v0
ds_read_b128 v[48:51], v2 offset:9216
v_smfmac_f32_16x16x64_bf16 v[40:43], v[72:75], a[104:111], v0
ds_read_b128 v[72:75], v1 offset:9216
s_cbranch_vccnz L_ra1_w1rf
L_a1_w1rf:
v_smfmac_f32_16x16x64_bf16 v[20:23], v[60:63], v[112:119], v0
v_smfmac_f32_16x16x64_bf16 v[20:23], v[64:67], v[128:135], v0
s_waitcnt lgkmcnt(1)
v_smfmac_f32_16x16x64_bf16 v[20:23], v[76:79], v[44:51], v0
ds_read_b128 v[48:51], v2 offset:11264
s_waitcnt lgkmcnt(1)
v_smfmac_f32_16x16x64_bf16 v[20:23], v[72:75], v[160:167], v0
v_bfe_u32 v6, v1, 5, 1
v_mad_i32_i24 v6, v6, s55, v1
v_smfmac_f32_16x16x64_bf16 v[20:23], v[68:71], v[144:151], v0
ds_read_b128 v[44:47], v2 offset:10240
v_smfmac_f32_16x16x64_bf16 v[24:27], v[60:63], v[120:127], v0
v_smfmac_f32_16x16x64_bf16 v[24:27], v[64:67], v[136:143], v0
v_smfmac_f32_16x16x64_bf16 v[24:27], v[68:71], v[152:159], v0
v_add_f32 v21, v21, v23
v_smfmac_f32_16x16x64_bf16 v[24:27], v[72:75], v[168:175], v0
s_waitcnt lgkmcnt(0)
v_smfmac_f32_16x16x64_bf16 v[24:27], v[76:79], v[44:51], v0
ds_read_b128 v[44:47], v2 offset:12288
v_add_f32 v20, v20, v22
v_cvt_pk_bf16_f32 v22, v20, v21
v_smfmac_f32_16x16x64_bf16 v[28:31], v[76:79], v[240:247], v0
ds_read_b128 v[48:51], v2 offset:13312
v_smfmac_f32_16x16x64_bf16 v[28:31], v[64:67], a[0:7], v0
v_add_f32 v25, v25, v27
v_add_f32 v24, v24, v26
v_cvt_pk_bf16_f32 v23, v24, v25
v_smfmac_f32_16x16x64_bf16 v[28:31], v[72:75], a[32:39], v0
ds_write_b64 v3, v[22:23] offset:10752
v_smfmac_f32_16x16x64_bf16 v[28:31], v[68:71], a[16:23], v0
v_smfmac_f32_16x16x64_bf16 v[32:35], v[76:79], v[248:255], v0
s_waitcnt vmcnt(1)
s_waitcnt lgkmcnt(1)
v_smfmac_f32_16x16x64_bf16 v[28:31], v[60:63], v[44:51], v0
ds_read_b128 v[44:47], v2 offset:14336
ds_read_b128 v[48:51], v2 offset:15360
v_smfmac_f32_16x16x64_bf16 v[32:35], v[64:67], a[8:15], v0
s_waitcnt lgkmcnt(2)
s_barrier
v_smfmac_f32_16x16x64_bf16 v[32:35], v[68:71], a[24:31], v0
ds_read_b64_tr_b16 v[20:21], v4 offset:10240
ds_read_b64_tr_b16 v[22:23], v4 offset:10752
v_add_f32 v29, v29, v31
v_smfmac_f32_16x16x64_bf16 v[32:35], v[72:75], a[40:47], v0
ds_read_b64_tr_b16 v[24:25], v4 offset:11264
ds_read_b64_tr_b16 v[26:27], v4 offset:11776
s_waitcnt lgkmcnt(4)
v_smfmac_f32_16x16x64_bf16 v[32:35], v[60:63], v[44:51], v0
ds_read_b128 v[48:51], v2 offset:19456
s_waitcnt lgkmcnt(3)
v_mfma_f32_16x16x32_bf16 v[12:15], v[12:15], v[20:23], 0
ds_read_b128 v[44:47], v2 offset:18432
v_add_f32 v28, v28, v30
s_waitcnt lgkmcnt(2)
v_mfma_f32_16x16x32_bf16 v[12:15], v[16:19], v[24:27], v[12:15]
v_add_f32 v32, v32, v34
v_add_f32 v33, v33, v35
v_cvt_pk_bf16_f32 v30, v28, v29
v_cvt_pk_bf16_f32 v31, v32, v33
v_smfmac_f32_16x16x64_bf16 v[36:39], v[76:79], a[112:119], v0
ds_write_b64 v3, v[30:31] offset:12800
v_add_f32_dpp v12, v14, v12 quad_perm:[2,3,0,1] row_mask:0xf bank_mask:0xf
v_exp_f32 v14, v12
v_add_f32_dpp v13, v15, v13 quad_perm:[2,3,0,1] row_mask:0xf bank_mask:0xf
v_exp_f32 v15, v13
s_nop 0
v_cvt_pk_bf16_f32 v14, v14, v15
v_smfmac_f32_16x16x64_bf16 v[40:43], v[76:79], a[120:127], v0
ds_write_b32 v5, v14 offset:14624
s_waitcnt lgkmcnt(1)
s_barrier
ds_read_b64_tr_b16 v[28:29], v4 offset:12288
v_smfmac_f32_16x16x64_bf16 v[36:39], v[60:63], a[128:135], v0
ds_read_b64_tr_b16 v[30:31], v4 offset:12800
ds_read_b64_tr_b16 v[32:33], v4 offset:13312
v_smfmac_f32_16x16x64_bf16 v[40:43], v[60:63], a[136:143], v0
ds_read_b64_tr_b16 v[34:35], v4 offset:13824
v_mov_b64 v[76:77], s[52:53]
v_smfmac_f32_16x16x64_bf16 v[40:43], v[72:75], v[44:51], v0
ds_read_b128 v[44:47], v2 offset:16384
s_waitcnt lgkmcnt(3)
v_mfma_f32_16x16x32_bf16 v[28:31], v[28:31], v[20:23], 0
s_barrier
ds_read_b128 v[16:19], v1 offset:14368
s_waitcnt lgkmcnt(2)
v_mfma_f32_16x16x32_bf16 v[28:31], v[32:35], v[24:27], v[28:31]
ds_read_b128 v[60:63], v1 offset:14336
v_mov_b64 v[14:15], s[0:1]
v_smfmac_f32_16x16x64_bf16 v[40:43], v[64:67], a[152:159], v0
ds_read_b128 v[48:51], v2 offset:17408
v_mov_b64 v[78:79], s[52:53]
v_smfmac_f32_16x16x64_bf16 v[40:43], v[68:71], a[168:175], v0
v_add_f32_dpp v28, v30, v28 quad_perm:[2,3,0,1] row_mask:0xf bank_mask:0xf
v_smfmac_f32_16x16x64_bf16 v[36:39], v[64:67], a[144:151], v0
ds_read_b128 v[64:67], v2 offset:27648
v_mul_f32 v28, s50, v28
v_add_f32_dpp v29, v31, v29 quad_perm:[2,3,0,1] row_mask:0xf bank_mask:0xf
v_smfmac_f32_16x16x64_bf16 v[36:39], v[68:71], a[160:167], v0
ds_read_b128 v[68:71], v2 offset:30720
s_waitcnt lgkmcnt(2)
v_smfmac_f32_16x16x64_bf16 v[36:39], v[72:75], v[44:51], v0
ds_read_b128 v[72:75], v2 offset:31744
v_mul_f32 v29, s50, v29
v_cvt_pk_bf16_f32 v40, v40, v41
v_mfma_f32_16x16x32_bf16 v[32:35], v[76:79], v[16:19], 0
v_exp_f32 v30, v28
ds_read_b128 v[44:47], v2 offset:22528
v_mfma_f32_16x16x32_bf16 v[20:23], v[52:55], v[16:19], 0
v_exp_f32 v31, v29
v_mov_b64 v[76:77], 0
v_mfma_f32_16x16x32_bf16 v[20:23], v[56:59], v[60:63], v[20:23]
v_cvt_pk_bf16_f32 v41, v42, v43
v_cvt_pk_bf16_f32 v43, v38, v39
v_cvt_pk_bf16_f32 v30, v30, v31
v_cndmask_b32_e64 v26, 0, v30, s[56:57]
v_cndmask_b32_e64 v27, 0, v30, s[56:57]
s_nop 0
v_mov_b32_dpp v24, v26 quad_perm:[2,3,0,1] row_mask:0xf bank_mask:0xf
v_mfma_f32_16x16x16_bf16 v[32:35], v[14:15], v[26:27], v[32:35]
v_cvt_pk_bf16_f32 v42, v36, v37
v_mov_b32_dpp v25, v26 quad_perm:[2,3,0,1] row_mask:0xf bank_mask:0xf
s_nop 1
v_mfma_f32_16x16x32_bf16 v[20:23], v[40:43], v[24:27], v[20:23]
ds_read_b128 v[48:51], v2 offset:23552
ds_read_b128 v[60:63], v2 offset:26624
v_mov_b64 v[78:79], 0
v_rcp_f32 v33, v32
v_mov_b64 v[36:37], 0
v_min_f32 v32, v32, v33
v_cmp_nlt_f32 vcc, s2, v32
v_mul_f32_dpp v23, v33, v23 quad_perm:[0,1,0,1] row_mask:0xf bank_mask:0xf
v_mul_f32_dpp v21, v33, v21 quad_perm:[0,1,0,1] row_mask:0xf bank_mask:0xf
v_mul_f32_dpp v22, v33, v22 quad_perm:[0,1,0,1] row_mask:0xf bank_mask:0xf
v_mul_f32_dpp v20, v33, v20 quad_perm:[0,1,0,1] row_mask:0xf bank_mask:0xf
v_cvt_pk_bf16_f32 v20, v20, v21
v_cvt_pk_bf16_f32 v21, v22, v23
ds_write_b64 v6, v[20:21] offset:6144
s_and_b64 vcc, vcc, s[56:57]
v_mov_b32_dpp v19, v21 quad_perm:[2,3,2,3] row_mask:0xf bank_mask:0xf
s_cbranch_scc1 L_mx_w1rf
L_mxb_w1rf:
v_mov_b32_dpp v16, v20 quad_perm:[0,1,0,1] row_mask:0xf bank_mask:0xf
v_mov_b32_dpp v17, v21 quad_perm:[0,1,0,1] row_mask:0xf bank_mask:0xf
v_mov_b64 v[38:39], 0
v_mov_b32_dpp v18, v20 quad_perm:[2,3,2,3] row_mask:0xf bank_mask:0xf
v_mov_b64 v[26:27], 0
v_mov_b64 v[24:25], 0
v_smfmac_f32_16x16x64_bf16 v[76:79], v[16:19], a[176:183], v0
s_waitcnt lgkmcnt(0)
s_barrier
ds_read_b128 v[12:15], v7 offset:8192
v_mov_b64 v[32:33], 0
ds_read_b128 v[52:55], v7 offset:5120
v_smfmac_f32_16x16x64_bf16 v[36:39], v[16:19], v[44:51], v0
ds_read_b128 v[48:51], v2 offset:21504
ds_read_b128 v[44:47], v2 offset:20480
ds_read_b128 v[56:59], v7 offset:7168
v_mov_b64 v[30:31], 0
v_mov_b64 v[34:35], 0
v_smfmac_f32_16x16x64_bf16 v[24:27], v[16:19], v[60:67], v0
v_smfmac_f32_16x16x64_bf16 v[32:35], v[16:19], v[68:75], v0
ds_read_b128 v[68:71], v2 offset:28672
s_waitcnt lgkmcnt(5)
v_smfmac_f32_16x16x64_bf16 v[76:79], v[12:15], a[184:191], v0
ds_read_b128 v[60:63], v2 offset:24576
s_waitcnt lgkmcnt(5)
v_smfmac_f32_16x16x64_bf16 v[76:79], v[52:55], a[192:199], v0
ds_read_b128 v[64:67], v2 offset:25600
s_waitcnt lgkmcnt(3)
v_smfmac_f32_16x16x64_bf16 v[76:79], v[56:59], a[200:207], v0
v_mov_b64 v[28:29], 0
v_smfmac_f32_16x16x64_bf16 v[36:39], v[12:15], a[208:215], v0
ds_read_b128 v[72:75], v2 offset:29696
v_smfmac_f32_16x16x64_bf16 v[36:39], v[52:55], v[44:51], v0
ds_read_b128 v[44:47], v2 offset:34816
v_cvt_pk_bf16_f32 v77, v77, v79
v_cvt_pk_bf16_f32 v76, v76, v78
v_bfi_b32 v76, 1, s35, v76
v_smfmac_f32_16x16x64_bf16 v[36:39], v[56:59], a[216:223], v0
buffer_store_dwordx2 v[76:77], v8, s[4:7], s42 offen
ds_read_b128 v[48:51], v2 offset:35840
v_smfmac_f32_16x16x64_bf16 v[24:27], v[12:15], a[224:231], v0
s_waitcnt lgkmcnt(3)
v_smfmac_f32_16x16x64_bf16 v[24:27], v[52:55], v[60:67], v0
ds_read_b128 v[60:63], v2 offset:38912
v_cvt_pk_bf16_f32 v37, v37, v39
v_cvt_pk_bf16_f32 v36, v36, v38
v_bfi_b32 v36, 1, s35, v36
v_smfmac_f32_16x16x64_bf16 v[24:27], v[56:59], a[232:239], v0
buffer_store_dwordx2 v[36:37], v8, s[4:7], s43 offen
ds_read_b128 v[64:67], v2 offset:39936
ds_read_b128 v[40:43], v2 offset:33792
v_smfmac_f32_16x16x64_bf16 v[32:35], v[12:15], a[240:247], v0
s_waitcnt lgkmcnt(5)
v_smfmac_f32_16x16x64_bf16 v[32:35], v[52:55], v[68:75], v0
ds_read_b128 v[72:75], v2 offset:37888
ds_read_b128 v[36:39], v2 offset:32768
v_cvt_pk_bf16_f32 v25, v25, v27
v_cvt_pk_bf16_f32 v24, v24, v26
v_bfi_b32 v24, 1, s35, v24
buffer_store_dwordx2 v[24:25], v8, s[4:7], s44 offen
v_smfmac_f32_16x16x64_bf16 v[32:35], v[56:59], a[248:255], v0
ds_read_b128 v[68:71], v2 offset:36864
s_waitcnt lgkmcnt(6)
v_smfmac_f32_16x16x64_bf16 v[28:31], v[16:19], v[44:51], v0
s_nop 3
v_cvt_pk_bf16_f32 v33, v33, v35
v_cvt_pk_bf16_f32 v32, v32, v34
v_bfi_b32 v32, 1, s35, v32
buffer_store_dwordx2 v[32:33], v8, s[4:7], s45 offen
s_waitcnt lgkmcnt(1)
v_smfmac_f32_16x16x64_bf16 v[28:31], v[52:55], v[36:43], v0
v_smfmac_f32_16x16x64_bf16 v[28:31], v[12:15], v[60:67], v0
s_waitcnt lgkmcnt(0)
v_smfmac_f32_16x16x64_bf16 v[28:31], v[56:59], v[68:75], v0
s_nop 7
v_cvt_pk_bf16_f32 v28, v28, v30
v_bfi_b32 v28, 1, s35, v28
v_cvt_pk_bf16_f32 v29, v29, v31
buffer_store_dwordx2 v[28:29], v8, s[4:7], s46 offen
s_branch L_ex_w1rf
.p2align 6
L_ex_w2rf:
s_add_u32 s34, s34, 1
s_not_b32 s35, s35
s_not_b32 s36, s36
v_and_b32 v6, 0x70, v1
ds_read_b128 v[76:79], v6 offset:256
v_bfe_u32 v11, v1, 4, 2
v_lshrrev_b32_e64 v11, v11, 1
v_bfe_u32 v6, v1, 2, 7
s_mov_b32 m0, 1024
v_mov_b32 v42, s35
s_waitcnt vmcnt(1)
buffer_load_dwordx4 v[60:63], v9, s[4:7], s3 offen offset:0 sc1
buffer_load_dwordx4 v[64:67], v9, s[4:7], s3 offen offset:1024 sc1
buffer_load_dwordx4 v[68:71], v9, s[4:7], s3 offen offset:2048 sc1
buffer_load_dwordx4 v[72:75], v9, s[4:7], s3 offen offset:3072 sc1
s_barrier
s_waitcnt lgkmcnt(0)
s_waitcnt vmcnt(3)
L_r_w2rf:
v_mfma_f32_16x16x32_bf16 v[36:39], v[60:63], v[76:79], 0
s_waitcnt vmcnt(2)
v_mfma_f32_16x16x32_bf16 v[36:39], v[64:67], v[76:79], v[36:39]
v_bitop3_b32 v40, v60, v64, s36 bitop3:0x7e
s_waitcnt vmcnt(1)
v_mfma_f32_16x16x32_bf16 v[36:39], v[68:71], v[76:79], v[36:39]
s_waitcnt vmcnt(0)
v_mfma_f32_16x16x32_bf16 v[36:39], v[72:75], v[76:79], v[36:39]
v_bitop3_b32 v41, v68, v72, s36 bitop3:0x7e
v_bitop3_b32 v40, v40, v41, 1 bitop3:0xa8
v_cmp_ne_u32 vcc, 0, v40
v_nop
v_nop
v_nop
v_nop
v_nop
v_pk_add_f32 v[36:37], v[36:37], v[38:39]
v_cvt_pk_bf16_f32 v40, v36, v37
v_bfi_b32 v40, v11, s35, v40
s_cbranch_vccnz L_rr_w2rf
buffer_store_dword v40, v10, s[4:7], 0 offen
s_cmp_eq_u32 s34, 63
v_mov_b32 v11, v40
s_cbranch_scc1 L_done_w2rf
s_mov_b64 exec, 1
buffer_store_dword v42, v1, s[4:7], s33 offen
s_mov_b64 exec, -1
v_mov_b64 v[20:21], 0
v_mov_b64 v[22:23], 0
v_mov_b64 v[24:25], 0
v_mov_b64 v[26:27], 0
v_mov_b64 v[28:29], 0
v_mov_b64 v[30:31], 0
v_mov_b64 v[32:33], 0
v_mov_b64 v[34:35], 0
v_mov_b64 v[36:37], 0
v_mov_b64 v[38:39], 0
v_mov_b64 v[40:41], 0
v_mov_b64 v[42:43], 0
v_bfe_u32 v77, v1, 6, 1
v_lshl_add_u32 v77, v77, 3, v1
v_lshlrev_b32 v77, 1, v77
v_lshlrev_b32 v78, 3, v1
ds_read_b128 v[44:47], v2 offset:0
ds_read_b128 v[48:51], v2 offset:1024
s_add_u32 s37, s37, 524288
s_mul_i32 s40, s34, 10240
s_add_u32 s40, s40, 8093696
v_mov_b32 v79, s36
L_sp_w2rf:
buffer_load_dword v79, v6, s[4:7], s58 offen sc1
s_sub_u32 s41, s41, 1
s_cbranch_scc1 L_exit
buffer_load_dwordx4 v1, s[4:7], s47 offen offset:0 sc1 lds
buffer_load_dwordx4 v1, s[4:7], s47 offen offset:1024 sc1 lds
buffer_load_dwordx4 v1, s[4:7], s47 offen offset:2048 sc1 lds
buffer_load_dwordx4 v1, s[4:7], s47 offen offset:3072 sc1 lds
s_waitcnt vmcnt(9)
v_cmp_ne_u32 vcc, s35, v79
s_cbranch_vccnz L_sp_w2rf
L_top_w2rf:
s_waitcnt vmcnt(8)
s_barrier
ds_read_b128 v[60:63], v1 offset:1024
s_mov_b32 m0, 5120
s_nop 0
buffer_load_dwordx4 v1, s[4:7], s48 offen offset:2048 sc1 lds
s_waitcnt vmcnt(6)
s_barrier
ds_read_b128 v[64:67], v1 offset:2048
ds_read_b128 v[68:71], v1 offset:3072
ds_read_b128 v[72:75], v1 offset:4096
L_s0_w2rf:
s_waitcnt lgkmcnt(3)
v_smfmac_f32_16x16x64_bf16 v[32:35], v[60:63], v[184:191], v0
v_smfmac_f32_16x16x64_bf16 v[36:39], v[60:63], a[48:55], v0
v_smfmac_f32_16x16x64_bf16 v[20:23], v[60:63], v[44:51], v0
ds_read_b128 v[48:51], v2 offset:3072
v_smfmac_f32_16x16x64_bf16 v[28:31], v[60:63], v[176:183], v0
buffer_load_dwordx4 v[12:15], v9, s[4:7], s37 offen offset:0
v_smfmac_f32_16x16x64_bf16 v[40:43], v[60:63], a[56:63], v0
s_waitcnt lgkmcnt(3)
v_smfmac_f32_16x16x64_bf16 v[28:31], v[64:67], v[192:199], v0
ds_read_b128 v[44:47], v2 offset:2048
v_smfmac_f32_16x16x64_bf16 v[20:23], v[64:67], v[80:87], v0
buffer_load_dwordx4 v[16:19], v9, s[4:7], s37 offen offset:1024
v_smfmac_f32_16x16x64_bf16 v[32:35], v[64:67], v[200:207], v0
v_bitop3_b32 v6, v60, v64, s35 bitop3:0x7e
s_waitcnt lgkmcnt(2)
v_bitop3_b32 v76, v68, v72, s35 bitop3:0x7e
v_smfmac_f32_16x16x64_bf16 v[24:27], v[64:67], v[88:95], v0
buffer_load_dwordx4 v[52:55], v1, s[4:7], s37 offen offset:2048
s_waitcnt lgkmcnt(0)
v_smfmac_f32_16x16x64_bf16 v[24:27], v[60:63], v[44:51], v0
v_smfmac_f32_16x16x64_bf16 v[36:39], v[64:67], a[64:71], v0
v_bitop3_b32 v6, v6, v76, 1 bitop3:0xa8
v_smfmac_f32_16x16x64_bf16 v[40:43], v[64:67], a[72:79], v0
ds_read_b128 v[44:47], v2 offset:4096
v_cmp_ne_u32 vcc, 0, v6
v_smfmac_f32_16x16x64_bf16 v[20:23], v[68:71], v[96:103], v0
buffer_load_dwordx4 v[56:59], v1, s[4:7], s37 offen offset:3072
ds_read_b128 v[48:51], v2 offset:5120
v_smfmac_f32_16x16x64_bf16 v[24:27], v[68:71], v[104:111], v0
s_cbranch_vccnz L_ra0_w2rf
s_waitcnt vmcnt(4)
s_barrier
ds_read_b32 v6, v77 offset:8192
v_smfmac_f32_16x16x64_bf16 v[28:31], v[68:71], v[208:215], v0
ds_read_b128 v[60:63], v1 offset:6144
ds_read_b128 v[64:67], v1 offset:7168
s_waitcnt lgkmcnt(3)
v_smfmac_f32_16x16x64_bf16 v[20:23], v[72:75], v[44:51], v0
ds_read_b128 v[76:79], v1 offset:5120
ds_read_b128 v[44:47], v2 offset:6144
buffer_store_dword v11, v10, s[4:7], s40 offen sc0 sc1
v_smfmac_f32_16x16x64_bf16 v[28:31], v[72:75], v[224:231], v0
v_smfmac_f32_16x16x64_bf16 v[32:35], v[68:71], v[216:223], v0
v_smfmac_f32_16x16x64_bf16 v[36:39], v[68:71], a[80:87], v0
ds_read_b128 v[48:51], v2 offset:7168
s_waitcnt lgkmcnt(4)
v_bitop3_b32 v6, v6, v60, s35 bitop3:0x7e
v_smfmac_f32_16x16x64_bf16 v[40:43], v[68:71], a[88:95], v0
ds_read_b128 v[68:71], v1 offset:8192
v_smfmac_f32_16x16x64_bf16 v[32:35], v[72:75], v[232:239], v0
s_waitcnt lgkmcnt(4)
v_bitop3_b32 v6, v6, v64, s35 bitop3:0xf6
s_waitcnt lgkmcnt(3)
v_bitop3_b32 v6, v6, v76, s35 bitop3:0xf6
v_and_b32 v6, 1, v6
s_waitcnt lgkmcnt(1)
v_smfmac_f32_16x16x64_bf16 v[24:27], v[72:75], v[44:51], v0
ds_read_b128 v[44:47], v2 offset:8192
v_cmp_ne_u32 vcc, 0, v6
v_smfmac_f32_16x16x64_bf16 v[36:39], v[72:75], a[96:103], v0
ds_read_b128 v[48:51], v2 offset:9216
v_smfmac_f32_16x16x64_bf16 v[40:43], v[72:75], a[104:111], v0
ds_read_b128 v[72:75], v1 offset:9216
s_cbranch_vccnz L_ra1_w2rf
L_a1_w2rf:
v_smfmac_f32_16x16x64_bf16 v[20:23], v[60:63], v[112:119], v0
v_smfmac_f32_16x16x64_bf16 v[20:23], v[64:67], v[128:135], v0
s_waitcnt lgkmcnt(1)
v_smfmac_f32_16x16x64_bf16 v[20:23], v[76:79], v[44:51], v0
ds_read_b128 v[48:51], v2 offset:11264
v_bfe_u32 v6, v1, 5, 1
v_mad_i32_i24 v6, v6, s55, v1
v_smfmac_f32_16x16x64_bf16 v[20:23], v[68:71], v[144:151], v0
s_waitcnt lgkmcnt(1)
v_smfmac_f32_16x16x64_bf16 v[20:23], v[72:75], v[160:167], v0
ds_read_b128 v[44:47], v2 offset:10240
v_smfmac_f32_16x16x64_bf16 v[24:27], v[60:63], v[120:127], v0
v_smfmac_f32_16x16x64_bf16 v[24:27], v[64:67], v[136:143], v0
v_smfmac_f32_16x16x64_bf16 v[24:27], v[68:71], v[152:159], v0
v_add_f32 v21, v21, v23
v_smfmac_f32_16x16x64_bf16 v[24:27], v[72:75], v[168:175], v0
s_waitcnt lgkmcnt(0)
v_smfmac_f32_16x16x64_bf16 v[24:27], v[76:79], v[44:51], v0
ds_read_b128 v[44:47], v2 offset:12288
v_add_f32 v20, v20, v22
v_cvt_pk_bf16_f32 v22, v20, v21
v_smfmac_f32_16x16x64_bf16 v[28:31], v[76:79], v[240:247], v0
ds_read_b128 v[48:51], v2 offset:13312
v_smfmac_f32_16x16x64_bf16 v[28:31], v[64:67], a[0:7], v0
v_add_f32 v25, v25, v27
v_add_f32 v24, v24, v26
v_cvt_pk_bf16_f32 v23, v24, v25
v_smfmac_f32_16x16x64_bf16 v[28:31], v[72:75], a[32:39], v0
ds_write_b64 v3, v[22:23] offset:11264
v_smfmac_f32_16x16x64_bf16 v[32:35], v[76:79], v[248:255], v0
s_waitcnt lgkmcnt(1)
v_smfmac_f32_16x16x64_bf16 v[28:31], v[60:63], v[44:51], v0
ds_read_b128 v[48:51], v2 offset:15360
v_smfmac_f32_16x16x64_bf16 v[28:31], v[68:71], a[16:23], v0
ds_read_b128 v[44:47], v2 offset:14336
s_waitcnt vmcnt(1)
v_smfmac_f32_16x16x64_bf16 v[32:35], v[64:67], a[8:15], v0
s_waitcnt lgkmcnt(2)
s_barrier
ds_read_b64_tr_b16 v[20:21], v4 offset:10240
v_smfmac_f32_16x16x64_bf16 v[32:35], v[68:71], a[24:31], v0
ds_read_b64_tr_b16 v[22:23], v4 offset:10752
v_add_f32 v29, v29, v31
v_smfmac_f32_16x16x64_bf16 v[32:35], v[72:75], a[40:47], v0
ds_read_b64_tr_b16 v[24:25], v4 offset:11264
ds_read_b64_tr_b16 v[26:27], v4 offset:11776
s_waitcnt lgkmcnt(4)
v_smfmac_f32_16x16x64_bf16 v[32:35], v[60:63], v[44:51], v0
ds_read_b128 v[48:51], v2 offset:19456
s_waitcnt lgkmcnt(3)
v_mfma_f32_16x16x32_bf16 v[12:15], v[12:15], v[20:23], 0
ds_read_b128 v[44:47], v2 offset:18432
v_add_f32 v28, v28, v30
s_waitcnt lgkmcnt(2)
v_mfma_f32_16x16x32_bf16 v[12:15], v[16:19], v[24:27], v[12:15]
v_add_f32 v33, v33, v35
v_add_f32 v32, v32, v34
v_cvt_pk_bf16_f32 v30, v28, v29
v_cvt_pk_bf16_f32 v31, v32, v33
v_smfmac_f32_16x16x64_bf16 v[36:39], v[76:79], a[112:119], v0
ds_write_b64 v3, v[30:31] offset:13312
v_add_f32_dpp v12, v14, v12 quad_perm:[2,3,0,1] row_mask:0xf bank_mask:0xf
v_exp_f32 v14, v12
v_add_f32_dpp v13, v15, v13 quad_perm:[2,3,0,1] row_mask:0xf bank_mask:0xf
v_exp_f32 v15, v13
s_nop 0
v_cvt_pk_bf16_f32 v14, v14, v15
v_smfmac_f32_16x16x64_bf16 v[40:43], v[76:79], a[120:127], v0
ds_write_b32 v5, v14 offset:14880
s_waitcnt lgkmcnt(2)
v_smfmac_f32_16x16x64_bf16 v[40:43], v[72:75], v[44:51], v0
ds_read_b128 v[44:47], v2 offset:16384
s_waitcnt lgkmcnt(2)
s_barrier
ds_read_b64_tr_b16 v[28:29], v4 offset:12288
v_smfmac_f32_16x16x64_bf16 v[36:39], v[60:63], a[128:135], v0
ds_read_b64_tr_b16 v[30:31], v4 offset:12800
ds_read_b64_tr_b16 v[32:33], v4 offset:13312
v_smfmac_f32_16x16x64_bf16 v[40:43], v[60:63], a[136:143], v0
ds_read_b64_tr_b16 v[34:35], v4 offset:13824
v_mov_b64 v[76:77], s[52:53]
s_waitcnt lgkmcnt(2)
v_mfma_f32_16x16x32_bf16 v[28:31], v[28:31], v[20:23], 0
s_barrier
ds_read_b128 v[16:19], v1 offset:14368
s_waitcnt lgkmcnt(1)
v_mfma_f32_16x16x32_bf16 v[28:31], v[32:35], v[24:27], v[28:31]
ds_read_b128 v[60:63], v1 offset:14336
v_mov_b64 v[14:15], s[0:1]
v_smfmac_f32_16x16x64_bf16 v[40:43], v[64:67], a[152:159], v0
ds_read_b128 v[48:51], v2 offset:17408
v_mov_b64 v[78:79], s[52:53]
v_smfmac_f32_16x16x64_bf16 v[40:43], v[68:71], a[168:175], v0
v_add_f32_dpp v28, v30, v28 quad_perm:[2,3,0,1] row_mask:0xf bank_mask:0xf
v_mul_f32 v28, s50, v28
v_smfmac_f32_16x16x64_bf16 v[36:39], v[64:67], a[144:151], v0
ds_read_b128 v[64:67], v2 offset:23552
v_add_f32_dpp v29, v31, v29 quad_perm:[2,3,0,1] row_mask:0xf bank_mask:0xf
v_smfmac_f32_16x16x64_bf16 v[36:39], v[68:71], a[160:167], v0
ds_read_b128 v[68:71], v2 offset:24576
s_waitcnt lgkmcnt(2)
v_smfmac_f32_16x16x64_bf16 v[36:39], v[72:75], v[44:51], v0
ds_read_b128 v[72:75], v2 offset:25600
v_cvt_pk_bf16_f32 v40, v40, v41
v_mfma_f32_16x16x32_bf16 v[32:35], v[76:79], v[16:19], 0
ds_read_b128 v[44:47], v2 offset:20480
v_mul_f32 v29, s50, v29
v_exp_f32 v30, v28
v_mfma_f32_16x16x32_bf16 v[20:23], v[52:55], v[16:19], 0
v_exp_f32 v31, v29
v_cvt_pk_bf16_f32 v41, v42, v43
v_cvt_pk_bf16_f32 v43, v38, v39
v_mov_b64 v[76:77], 0
v_mfma_f32_16x16x32_bf16 v[20:23], v[56:59], v[60:63], v[20:23]
v_cvt_pk_bf16_f32 v30, v30, v31
v_cndmask_b32_e64 v26, 0, v30, s[56:57]
v_cndmask_b32_e64 v27, 0, v30, s[56:57]
s_nop 0
v_mov_b32_dpp v24, v26 quad_perm:[2,3,0,1] row_mask:0xf bank_mask:0xf
v_mfma_f32_16x16x16_bf16 v[32:35], v[14:15], v[26:27], v[32:35]
v_cvt_pk_bf16_f32 v42, v36, v37
v_mov_b32_dpp v25, v26 quad_perm:[2,3,0,1] row_mask:0xf bank_mask:0xf
s_nop 1
v_mfma_f32_16x16x32_bf16 v[20:23], v[40:43], v[24:27], v[20:23]
ds_read_b128 v[60:63], v2 offset:22528
ds_read_b128 v[48:51], v2 offset:21504
v_rcp_f32 v33, v32
v_mov_b64 v[36:37], 0
v_mov_b64 v[78:79], 0
v_min_f32 v32, v32, v33
v_cmp_nlt_f32 vcc, s2, v32
v_mul_f32_dpp v23, v33, v23 quad_perm:[0,1,0,1] row_mask:0xf bank_mask:0xf
v_mul_f32_dpp v21, v33, v21 quad_perm:[0,1,0,1] row_mask:0xf bank_mask:0xf
v_mul_f32_dpp v22, v33, v22 quad_perm:[0,1,0,1] row_mask:0xf bank_mask:0xf
v_mul_f32_dpp v20, v33, v20 quad_perm:[0,1,0,1] row_mask:0xf bank_mask:0xf
v_cvt_pk_bf16_f32 v20, v20, v21
v_cvt_pk_bf16_f32 v21, v22, v23
ds_write_b64 v6, v[20:21] offset:7168
s_and_b64 vcc, vcc, s[56:57]
v_mov_b32_dpp v16, v20 quad_perm:[0,1,0,1] row_mask:0xf bank_mask:0xf
v_mov_b32_dpp v19, v21 quad_perm:[2,3,2,3] row_mask:0xf bank_mask:0xf
s_cbranch_scc1 L_mx_w2rf
L_mxb_w2rf:
v_mov_b32_dpp v18, v20 quad_perm:[2,3,2,3] row_mask:0xf bank_mask:0xf
v_mov_b64 v[38:39], 0
v_mov_b32_dpp v17, v21 quad_perm:[0,1,0,1] row_mask:0xf bank_mask:0xf
v_mov_b64 v[26:27], 0
v_mov_b64 v[24:25], 0
v_mov_b64 v[32:33], 0
v_smfmac_f32_16x16x64_bf16 v[76:79], v[16:19], a[176:183], v0
s_waitcnt lgkmcnt(0)
s_barrier
ds_read_b128 v[12:15], v7 offset:5120
ds_read_b128 v[52:55], v7 offset:8192
v_smfmac_f32_16x16x64_bf16 v[36:39], v[16:19], a[184:191], v0
ds_read_b128 v[56:59], v7 offset:6144
v_mov_b64 v[34:35], 0
v_smfmac_f32_16x16x64_bf16 v[24:27], v[16:19], a[192:199], v0
v_smfmac_f32_16x16x64_bf16 v[32:35], v[16:19], a[200:207], v0
s_waitcnt lgkmcnt(2)
v_smfmac_f32_16x16x64_bf16 v[76:79], v[12:15], a[208:215], v0
s_waitcnt lgkmcnt(1)
v_smfmac_f32_16x16x64_bf16 v[76:79], v[52:55], a[216:223], v0
s_waitcnt lgkmcnt(0)
v_smfmac_f32_16x16x64_bf16 v[76:79], v[56:59], a[224:231], v0
v_smfmac_f32_16x16x64_bf16 v[36:39], v[12:15], v[44:51], v0
ds_read_b128 v[48:51], v2 offset:27648
ds_read_b128 v[44:47], v2 offset:26624
v_smfmac_f32_16x16x64_bf16 v[36:39], v[52:55], a[232:239], v0
v_cvt_pk_bf16_f32 v77, v77, v79
v_cvt_pk_bf16_f32 v76, v76, v78
v_bfi_b32 v76, 1, s35, v76
v_smfmac_f32_16x16x64_bf16 v[36:39], v[56:59], v[60:67], v0
buffer_store_dwordx2 v[76:77], v8, s[4:7], s42 offen
ds_read_b128 v[60:63], v2 offset:28672
v_smfmac_f32_16x16x64_bf16 v[24:27], v[12:15], v[68:75], v0
ds_read_b128 v[64:67], v2 offset:29696
v_smfmac_f32_16x16x64_bf16 v[24:27], v[52:55], a[240:247], v0
ds_read_b128 v[68:71], v2 offset:30720
v_cvt_pk_bf16_f32 v36, v36, v38
v_bfi_b32 v36, 1, s35, v36
v_cvt_pk_bf16_f32 v37, v37, v39
s_waitcnt lgkmcnt(3)
v_smfmac_f32_16x16x64_bf16 v[24:27], v[56:59], v[44:51], v0
buffer_store_dwordx2 v[36:37], v8, s[4:7], s43 offen
ds_read_b128 v[72:75], v2 offset:31744
v_smfmac_f32_16x16x64_bf16 v[32:35], v[52:55], a[248:255], v0
s_waitcnt lgkmcnt(2)
v_smfmac_f32_16x16x64_bf16 v[32:35], v[12:15], v[60:67], v0
v_cvt_pk_bf16_f32 v25, v25, v27
v_cvt_pk_bf16_f32 v24, v24, v26
v_bfi_b32 v24, 1, s35, v24
buffer_store_dwordx2 v[24:25], v8, s[4:7], s44 offen
s_waitcnt lgkmcnt(0)
v_smfmac_f32_16x16x64_bf16 v[32:35], v[56:59], v[68:75], v0
s_nop 7
v_cvt_pk_bf16_f32 v33, v33, v35
v_cvt_pk_bf16_f32 v32, v32, v34
v_bfi_b32 v32, 1, s35, v32
buffer_store_dwordx2 v[32:33], v8, s[4:7], s45 offen
s_branch L_ex_w2rf
.p2align 6
L_ex_w3f:
s_add_u32 s34, s34, 1
s_not_b32 s35, s35
s_not_b32 s36, s36
s_add_u32 s37, s37, 524288
s_add_u32 s39, s39, 524288
v_mov_b64 v[20:21], 0
v_mov_b64 v[22:23], 0
v_mov_b64 v[24:25], 0
v_mov_b64 v[26:27], 0
v_mov_b64 v[28:29], 0
v_mov_b64 v[30:31], 0
v_mov_b64 v[32:33], 0
v_mov_b64 v[34:35], 0
v_mov_b64 v[36:37], 0
v_mov_b64 v[38:39], 0
v_mov_b64 v[40:41], 0
v_mov_b64 v[42:43], 0
ds_read_b128 v[44:47], v2 offset:0
ds_read_b128 v[48:51], v2 offset:1024
v_bfe_u32 v77, v1, 6, 1
v_lshl_add_u32 v77, v77, 3, v1
v_lshlrev_b32 v77, 1, v77
v_lshlrev_b32 v78, 3, v1
s_barrier
s_cmp_eq_u32 s34, 63
s_cbranch_scc1 L_done_w3f
s_add_u32 s100, s34, 1
s_lshr_b32 s100, s100, 2
s_waitcnt vmcnt(4)
L_evb_w3f:
v_cmp_ge_u32 vcc, s100, v10
s_cbranch_vccnz L_ev_w3f
L_top_w3f:
s_barrier
ds_read_b128 v[60:63], v1 offset:1024
s_mov_b32 m0, 5120
s_nop 0
buffer_load_dwordx4 v1, s[4:7], s48 offen offset:3072 sc1 lds
s_barrier
ds_read_b128 v[64:67], v1 offset:2048
ds_read_b128 v[68:71], v1 offset:3072
ds_read_b128 v[72:75], v1 offset:4096
L_s0_w3f:
s_waitcnt lgkmcnt(3)
v_smfmac_f32_16x16x64_bf16 v[32:35], v[60:63], v[184:191], v0
s_mov_b32 m0, 9216
s_nop 0
buffer_load_dwordx4 v1, s[4:7], s49 offen offset:0 sc1 lds
v_smfmac_f32_16x16x64_bf16 v[20:23], v[60:63], v[44:51], v0
v_smfmac_f32_16x16x64_bf16 v[28:31], v[60:63], v[176:183], v0
s_waitcnt lgkmcnt(2)
v_smfmac_f32_16x16x64_bf16 v[28:31], v[64:67], v[192:199], v0
ds_read_b128 v[48:51], v2 offset:3072
v_smfmac_f32_16x16x64_bf16 v[36:39], v[60:63], a[48:55], v0
ds_read_b128 v[44:47], v2 offset:2048
v_smfmac_f32_16x16x64_bf16 v[40:43], v[60:63], a[56:63], v0
buffer_load_dwordx4 v[12:15], v9, s[4:7], s37 offen offset:0
v_smfmac_f32_16x16x64_bf16 v[24:27], v[64:67], v[88:95], v0
v_smfmac_f32_16x16x64_bf16 v[20:23], v[64:67], v[80:87], v0
v_bitop3_b32 v6, v60, v64, s35 bitop3:0x7e
v_smfmac_f32_16x16x64_bf16 v[32:35], v[64:67], v[200:207], v0
buffer_load_dwordx4 v[16:19], v9, s[4:7], s37 offen offset:1024
s_waitcnt lgkmcnt(0)
v_smfmac_f32_16x16x64_bf16 v[24:27], v[60:63], v[44:51], v0
v_bitop3_b32 v76, v68, v72, s35 bitop3:0x7e
v_bitop3_b32 v6, v6, v76, 1 bitop3:0xa8
v_smfmac_f32_16x16x64_bf16 v[36:39], v[64:67], a[64:71], v0
v_cmp_ne_u32 vcc, 0, v6
v_smfmac_f32_16x16x64_bf16 v[40:43], v[64:67], a[72:79], v0
buffer_load_dwordx4 v[52:55], v1, s[4:7], s37 offen offset:2048
ds_read_b128 v[44:47], v2 offset:4096
v_smfmac_f32_16x16x64_bf16 v[20:23], v[68:71], v[96:103], v0
ds_read_b128 v[48:51], v2 offset:5120
buffer_load_dwordx4 v[56:59], v1, s[4:7], s37 offen offset:3072
s_mov_b32 m0, 0
v_smfmac_f32_16x16x64_bf16 v[24:27], v[68:71], v[104:111], v0
s_cbranch_vccnz L_ra0_w3f
s_waitcnt vmcnt(4)
s_barrier
ds_read_b32 v6, v77 offset:8192
v_smfmac_f32_16x16x64_bf16 v[28:31], v[68:71], v[208:215], v0
buffer_load_dword v78, s[4:7], s39 offen lds
buffer_load_dword v10, v11, s[4:7], s101 offen sc1
v_smfmac_f32_16x16x64_bf16 v[36:39], v[68:71], a[80:87], v0
ds_read_b128 v[60:63], v1 offset:6144
v_smfmac_f32_16x16x64_bf16 v[28:31], v[72:75], v[224:231], v0
ds_read_b128 v[76:79], v1 offset:5120
s_waitcnt lgkmcnt(3)
v_smfmac_f32_16x16x64_bf16 v[20:23], v[72:75], v[44:51], v0
ds_read_b128 v[64:67], v1 offset:7168
v_smfmac_f32_16x16x64_bf16 v[32:35], v[68:71], v[216:223], v0
ds_read_b128 v[44:47], v2 offset:6144
v_smfmac_f32_16x16x64_bf16 v[40:43], v[68:71], a[88:95], v0
ds_read_b128 v[48:51], v2 offset:7168
s_waitcnt lgkmcnt(4)
v_bitop3_b32 v6, v6, v60, s35 bitop3:0x7e
ds_read_b128 v[68:71], v1 offset:8192
v_smfmac_f32_16x16x64_bf16 v[32:35], v[72:75], v[232:239], v0
s_waitcnt lgkmcnt(3)
v_bitop3_b32 v6, v6, v64, s35 bitop3:0xf6
v_bitop3_b32 v6, v6, v76, s35 bitop3:0xf6
v_and_b32 v6, 1, v6
s_waitcnt lgkmcnt(1)
v_smfmac_f32_16x16x64_bf16 v[24:27], v[72:75], v[44:51], v0
ds_read_b128 v[44:47], v2 offset:8192
v_cmp_ne_u32 vcc, 0, v6
v_smfmac_f32_16x16x64_bf16 v[36:39], v[72:75], a[96:103], v0
ds_read_b128 v[48:51], v2 offset:9216
v_smfmac_f32_16x16x64_bf16 v[40:43], v[72:75], a[104:111], v0
ds_read_b128 v[72:75], v1 offset:9216
s_cbranch_vccnz L_ra1_w3f
L_a1_w3f:
v_smfmac_f32_16x16x64_bf16 v[20:23], v[60:63], v[112:119], v0
v_smfmac_f32_16x16x64_bf16 v[20:23], v[64:67], v[128:135], v0
s_waitcnt lgkmcnt(1)
v_smfmac_f32_16x16x64_bf16 v[20:23], v[76:79], v[44:51], v0
ds_read_b128 v[48:51], v2 offset:11264
v_bfe_u32 v6, v1, 5, 1
v_mad_i32_i24 v6, v6, s55, v1
v_smfmac_f32_16x16x64_bf16 v[20:23], v[68:71], v[144:151], v0
s_waitcnt lgkmcnt(1)
v_smfmac_f32_16x16x64_bf16 v[20:23], v[72:75], v[160:167], v0
v_smfmac_f32_16x16x64_bf16 v[24:27], v[60:63], v[120:127], v0
ds_read_b128 v[44:47], v2 offset:10240
v_smfmac_f32_16x16x64_bf16 v[24:27], v[64:67], v[136:143], v0
v_smfmac_f32_16x16x64_bf16 v[24:27], v[68:71], v[152:159], v0
v_add_f32 v21, v21, v23
v_smfmac_f32_16x16x64_bf16 v[24:27], v[72:75], v[168:175], v0
s_waitcnt lgkmcnt(0)
v_smfmac_f32_16x16x64_bf16 v[24:27], v[76:79], v[44:51], v0
ds_read_b128 v[44:47], v2 offset:12288
v_add_f32 v20, v20, v22
v_cvt_pk_bf16_f32 v22, v20, v21
v_smfmac_f32_16x16x64_bf16 v[28:31], v[76:79], v[240:247], v0
ds_read_b128 v[48:51], v2 offset:13312
v_smfmac_f32_16x16x64_bf16 v[28:31], v[64:67], a[0:7], v0
v_add_f32 v25, v25, v27
v_add_f32 v24, v24, v26
v_cvt_pk_bf16_f32 v23, v24, v25
v_smfmac_f32_16x16x64_bf16 v[28:31], v[72:75], a[32:39], v0
ds_write_b64 v3, v[22:23] offset:11776
v_smfmac_f32_16x16x64_bf16 v[32:35], v[76:79], v[248:255], v0
s_waitcnt lgkmcnt(1)
v_smfmac_f32_16x16x64_bf16 v[28:31], v[60:63], v[44:51], v0
ds_read_b128 v[48:51], v2 offset:15360
v_smfmac_f32_16x16x64_bf16 v[28:31], v[68:71], a[16:23], v0
ds_read_b128 v[44:47], v2 offset:14336
s_waitcnt vmcnt(2)
v_smfmac_f32_16x16x64_bf16 v[32:35], v[64:67], a[8:15], v0
s_waitcnt lgkmcnt(2)
s_barrier
v_smfmac_f32_16x16x64_bf16 v[32:35], v[68:71], a[24:31], v0
ds_read_b64_tr_b16 v[20:21], v4 offset:10240
ds_read_b64_tr_b16 v[22:23], v4 offset:10752
v_add_f32 v29, v29, v31
v_smfmac_f32_16x16x64_bf16 v[32:35], v[72:75], a[40:47], v0
ds_read_b64_tr_b16 v[24:25], v4 offset:11264
ds_read_b64_tr_b16 v[26:27], v4 offset:11776
s_waitcnt lgkmcnt(4)
v_smfmac_f32_16x16x64_bf16 v[32:35], v[60:63], v[44:51], v0
ds_read_b128 v[48:51], v2 offset:19456
s_waitcnt lgkmcnt(3)
v_mfma_f32_16x16x32_bf16 v[12:15], v[12:15], v[20:23], 0
ds_read_b128 v[44:47], v2 offset:18432
v_add_f32 v28, v28, v30
s_waitcnt lgkmcnt(2)
v_mfma_f32_16x16x32_bf16 v[12:15], v[16:19], v[24:27], v[12:15]
v_add_f32 v32, v32, v34
v_add_f32 v33, v33, v35
v_cvt_pk_bf16_f32 v30, v28, v29
v_cvt_pk_bf16_f32 v31, v32, v33
v_smfmac_f32_16x16x64_bf16 v[36:39], v[76:79], a[112:119], v0
ds_write_b64 v3, v[30:31] offset:13824
v_add_f32_dpp v12, v14, v12 quad_perm:[2,3,0,1] row_mask:0xf bank_mask:0xf
v_exp_f32 v14, v12
v_add_f32_dpp v13, v15, v13 quad_perm:[2,3,0,1] row_mask:0xf bank_mask:0xf
v_exp_f32 v15, v13
s_nop 0
v_cvt_pk_bf16_f32 v14, v14, v15
v_smfmac_f32_16x16x64_bf16 v[40:43], v[76:79], a[120:127], v0
ds_write_b32 v5, v14 offset:15136
s_waitcnt lgkmcnt(1)
s_barrier
ds_read_b64_tr_b16 v[28:29], v4 offset:12288
v_smfmac_f32_16x16x64_bf16 v[36:39], v[60:63], a[128:135], v0
ds_read_b64_tr_b16 v[30:31], v4 offset:12800
ds_read_b64_tr_b16 v[32:33], v4 offset:13312
v_smfmac_f32_16x16x64_bf16 v[40:43], v[60:63], a[136:143], v0
ds_read_b64_tr_b16 v[34:35], v4 offset:13824
v_mov_b64 v[76:77], s[52:53]
v_smfmac_f32_16x16x64_bf16 v[40:43], v[72:75], v[44:51], v0
ds_read_b128 v[44:47], v2 offset:16384
s_waitcnt lgkmcnt(3)
v_mfma_f32_16x16x32_bf16 v[28:31], v[28:31], v[20:23], 0
s_barrier
ds_read_b128 v[16:19], v1 offset:14368
s_waitcnt lgkmcnt(2)
v_mfma_f32_16x16x32_bf16 v[28:31], v[32:35], v[24:27], v[28:31]
ds_read_b128 v[60:63], v1 offset:14336
v_mov_b64 v[14:15], s[0:1]
v_smfmac_f32_16x16x64_bf16 v[40:43], v[64:67], a[152:159], v0
ds_read_b128 v[48:51], v2 offset:17408
v_mov_b64 v[78:79], s[52:53]
v_smfmac_f32_16x16x64_bf16 v[40:43], v[68:71], a[168:175], v0
v_add_f32_dpp v28, v30, v28 quad_perm:[2,3,0,1] row_mask:0xf bank_mask:0xf
v_mul_f32 v28, s50, v28
v_smfmac_f32_16x16x64_bf16 v[36:39], v[64:67], a[144:151], v0
ds_read_b128 v[64:67], v2 offset:21504
v_add_f32_dpp v29, v31, v29 quad_perm:[2,3,0,1] row_mask:0xf bank_mask:0xf
v_smfmac_f32_16x16x64_bf16 v[36:39], v[68:71], a[160:167], v0
ds_read_b128 v[68:71], v2 offset:26624
s_waitcnt lgkmcnt(2)
v_smfmac_f32_16x16x64_bf16 v[36:39], v[72:75], v[44:51], v0
ds_read_b128 v[72:75], v2 offset:27648
v_cvt_pk_bf16_f32 v40, v40, v41
v_exp_f32 v30, v28
v_mfma_f32_16x16x32_bf16 v[32:35], v[76:79], v[16:19], 0
ds_read_b128 v[44:47], v2 offset:22528
v_mul_f32 v29, s50, v29
v_mfma_f32_16x16x32_bf16 v[20:23], v[52:55], v[16:19], 0
v_exp_f32 v31, v29
v_mfma_f32_16x16x32_bf16 v[20:23], v[56:59], v[60:63], v[20:23]
v_cvt_pk_bf16_f32 v41, v42, v43
v_cvt_pk_bf16_f32 v30, v30, v31
v_cndmask_b32_e64 v26, 0, v30, s[56:57]
v_cvt_pk_bf16_f32 v43, v38, v39
v_cndmask_b32_e64 v27, 0, v30, s[56:57]
v_mov_b32_dpp v24, v26 quad_perm:[2,3,0,1] row_mask:0xf bank_mask:0xf
v_mov_b64 v[76:77], 0
v_mfma_f32_16x16x16_bf16 v[32:35], v[14:15], v[26:27], v[32:35]
v_cvt_pk_bf16_f32 v42, v36, v37
v_mov_b32_dpp v25, v26 quad_perm:[2,3,0,1] row_mask:0xf bank_mask:0xf
s_nop 1
v_mfma_f32_16x16x32_bf16 v[20:23], v[40:43], v[24:27], v[20:23]
ds_read_b128 v[48:51], v2 offset:23552
s_nop 0
v_rcp_f32 v33, v32
ds_read_b128 v[60:63], v2 offset:20480
v_mov_b64 v[36:37], 0
v_min_f32 v32, v32, v33
v_cmp_nlt_f32 vcc, s2, v32
v_mov_b64 v[78:79], 0
v_mul_f32_dpp v23, v33, v23 quad_perm:[0,1,0,1] row_mask:0xf bank_mask:0xf
v_mul_f32_dpp v21, v33, v21 quad_perm:[0,1,0,1] row_mask:0xf bank_mask:0xf
v_mul_f32_dpp v22, v33, v22 quad_perm:[0,1,0,1] row_mask:0xf bank_mask:0xf
v_mul_f32_dpp v20, v33, v20 quad_perm:[0,1,0,1] row_mask:0xf bank_mask:0xf
v_cvt_pk_bf16_f32 v20, v20, v21
v_cvt_pk_bf16_f32 v21, v22, v23
ds_write_b64 v6, v[20:21] offset:8192
s_and_b64 vcc, vcc, s[56:57]
v_mov_b64 v[38:39], 0
s_cbranch_scc1 L_mx_w3f
L_mxb_w3f:
v_mov_b32_dpp v16, v20 quad_perm:[0,1,0,1] row_mask:0xf bank_mask:0xf
v_mov_b32_dpp v19, v21 quad_perm:[2,3,2,3] row_mask:0xf bank_mask:0xf
v_mov_b64 v[24:25], 0
v_mov_b32_dpp v18, v20 quad_perm:[2,3,2,3] row_mask:0xf bank_mask:0xf
v_mov_b32_dpp v17, v21 quad_perm:[0,1,0,1] row_mask:0xf bank_mask:0xf
v_mov_b64 v[26:27], 0
v_mov_b64 v[32:33], 0
v_smfmac_f32_16x16x64_bf16 v[76:79], v[16:19], a[176:183], v0
s_waitcnt lgkmcnt(0)
s_barrier
ds_read_b128 v[12:15], v7 offset:6144
ds_read_b128 v[52:55], v7 offset:7168
v_smfmac_f32_16x16x64_bf16 v[36:39], v[16:19], a[184:191], v0
ds_read_b128 v[56:59], v7 offset:5120
v_mov_b64 v[34:35], 0
s_nop 1
v_smfmac_f32_16x16x64_bf16 v[32:35], v[16:19], a[200:207], v0
v_smfmac_f32_16x16x64_bf16 v[24:27], v[16:19], a[192:199], v0
s_waitcnt lgkmcnt(2)
v_smfmac_f32_16x16x64_bf16 v[76:79], v[12:15], a[208:215], v0
s_waitcnt lgkmcnt(1)
v_smfmac_f32_16x16x64_bf16 v[76:79], v[52:55], a[216:223], v0
s_waitcnt lgkmcnt(0)
v_smfmac_f32_16x16x64_bf16 v[76:79], v[56:59], a[224:231], v0
v_smfmac_f32_16x16x64_bf16 v[36:39], v[12:15], v[44:51], v0
ds_read_b128 v[48:51], v2 offset:25600
ds_read_b128 v[44:47], v2 offset:24576
v_smfmac_f32_16x16x64_bf16 v[36:39], v[52:55], a[232:239], v0
v_cvt_pk_bf16_f32 v77, v77, v79
v_cvt_pk_bf16_f32 v76, v76, v78
v_bfi_b32 v76, 1, s35, v76
v_smfmac_f32_16x16x64_bf16 v[36:39], v[56:59], v[60:67], v0
buffer_store_dwordx2 v[76:77], v8, s[4:7], s42 offen
ds_read_b128 v[60:63], v2 offset:30720
v_smfmac_f32_16x16x64_bf16 v[24:27], v[12:15], v[68:75], v0
ds_read_b128 v[64:67], v2 offset:31744
v_smfmac_f32_16x16x64_bf16 v[24:27], v[52:55], a[240:247], v0
ds_read_b128 v[68:71], v2 offset:28672
v_cvt_pk_bf16_f32 v36, v36, v38
v_bfi_b32 v36, 1, s35, v36
v_cvt_pk_bf16_f32 v37, v37, v39
s_waitcnt lgkmcnt(3)
v_smfmac_f32_16x16x64_bf16 v[24:27], v[56:59], v[44:51], v0
buffer_store_dwordx2 v[36:37], v8, s[4:7], s43 offen
ds_read_b128 v[72:75], v2 offset:29696
s_nop 5
v_cvt_pk_bf16_f32 v25, v25, v27
v_cvt_pk_bf16_f32 v24, v24, v26
v_bfi_b32 v24, 1, s35, v24
v_smfmac_f32_16x16x64_bf16 v[32:35], v[52:55], a[248:255], v0
s_waitcnt lgkmcnt(2)
v_smfmac_f32_16x16x64_bf16 v[32:35], v[12:15], v[60:67], v0
buffer_store_dwordx2 v[24:25], v8, s[4:7], s44 offen
s_waitcnt lgkmcnt(0)
v_smfmac_f32_16x16x64_bf16 v[32:35], v[56:59], v[68:75], v0
s_nop 7
v_cvt_pk_bf16_f32 v33, v33, v35
v_cvt_pk_bf16_f32 v32, v32, v34
v_bfi_b32 v32, 1, s35, v32
buffer_store_dwordx2 v[32:33], v8, s[4:7], s45 offen
s_branch L_ex_w3f
.p2align 6
L_ex_w0s:
s_add_u32 s34, s34, 1
s_not_b32 s35, s35
s_not_b32 s36, s36
s_add_u32 s37, s37, 524288
s_add_u32 s39, s39, 524288
v_mov_b64 v[20:21], 0
v_mov_b64 v[22:23], 0
v_mov_b64 v[24:25], 0
v_mov_b64 v[26:27], 0
v_mov_b64 v[28:29], 0
v_mov_b64 v[30:31], 0
v_mov_b64 v[32:33], 0
v_mov_b64 v[34:35], 0
v_mov_b64 v[36:37], 0
v_mov_b64 v[38:39], 0
v_mov_b64 v[40:41], 0
v_mov_b64 v[42:43], 0
ds_read_b128 v[44:47], v2 offset:0
ds_read_b128 v[48:51], v2 offset:1024
v_bfe_u32 v77, v1, 6, 1
v_lshl_add_u32 v77, v77, 3, v1
v_lshlrev_b32 v77, 1, v77
v_lshlrev_b32 v78, 3, v1
s_barrier
s_cmp_eq_u32 s34, 63
s_cbranch_scc1 L_done_w0s
L_top_w0s:
s_barrier
ds_read_b128 v[60:63], v1 offset:1024
s_mov_b32 m0, 5120
s_nop 0
buffer_load_dwordx4 v1, s[4:7], s48 offen offset:0 sc0 sc1 lds
s_barrier
ds_read_b128 v[64:67], v1 offset:2048
ds_read_b128 v[68:71], v1 offset:3072
ds_read_b128 v[72:75], v1 offset:4096
L_s0_w0s:
s_waitcnt lgkmcnt(3)
v_smfmac_f32_16x16x64_bf16 v[32:35], v[60:63], v[184:191], v0
v_smfmac_f32_16x16x64_bf16 v[20:23], v[60:63], v[44:51], v0
v_smfmac_f32_16x16x64_bf16 v[36:39], v[60:63], a[48:55], v0
buffer_load_dwordx4 v[12:15], v9, s[4:7], s37 offen offset:0
v_smfmac_f32_16x16x64_bf16 v[28:31], v[60:63], v[176:183], v0
buffer_load_dwordx4 v[16:19], v9, s[4:7], s37 offen offset:1024
v_smfmac_f32_16x16x64_bf16 v[40:43], v[60:63], a[56:63], v0
s_waitcnt lgkmcnt(2)
v_smfmac_f32_16x16x64_bf16 v[28:31], v[64:67], v[192:199], v0
ds_read_b128 v[48:51], v2 offset:3072
v_smfmac_f32_16x16x64_bf16 v[20:23], v[64:67], v[80:87], v0
ds_read_b128 v[44:47], v2 offset:2048
v_smfmac_f32_16x16x64_bf16 v[32:35], v[64:67], v[200:207], v0
buffer_load_dwordx4 v[52:55], v1, s[4:7], s37 offen offset:2048
v_bitop3_b32 v6, v60, v64, s35 bitop3:0x7e
s_waitcnt lgkmcnt(2)
v_bitop3_b32 v76, v68, v72, s35 bitop3:0x7e
v_bitop3_b32 v6, v6, v76, 1 bitop3:0xa8
v_smfmac_f32_16x16x64_bf16 v[24:27], v[64:67], v[88:95], v0
s_waitcnt lgkmcnt(0)
v_smfmac_f32_16x16x64_bf16 v[24:27], v[60:63], v[44:51], v0
buffer_load_dwordx4 v[56:59], v1, s[4:7], s37 offen offset:3072
v_smfmac_f32_16x16x64_bf16 v[40:43], v[64:67], a[72:79], v0
v_smfmac_f32_16x16x64_bf16 v[36:39], v[64:67], a[64:71], v0
ds_read_b128 v[44:47], v2 offset:4096
v_cmp_ne_u32 vcc, 0, v6
v_smfmac_f32_16x16x64_bf16 v[20:23], v[68:71], v[96:103], v0
ds_read_b128 v[48:51], v2 offset:5120
v_smfmac_f32_16x16x64_bf16 v[24:27], v[68:71], v[104:111], v0
s_cbranch_vccnz L_ra0_w0s
s_waitcnt vmcnt(4)
s_barrier
ds_read_b32 v6, v77 offset:8192
v_smfmac_f32_16x16x64_bf16 v[28:31], v[68:71], v[208:215], v0
s_mov_b32 m0, 0
ds_read_b128 v[60:63], v1 offset:6144
s_waitcnt lgkmcnt(2)
v_smfmac_f32_16x16x64_bf16 v[20:23], v[72:75], v[44:51], v0
buffer_load_dword v78, s[4:7], s39 offen lds
ds_read_b128 v[76:79], v1 offset:5120
v_smfmac_f32_16x16x64_bf16 v[28:31], v[72:75], v[224:231], v0
ds_read_b128 v[64:67], v1 offset:7168
ds_read_b128 v[44:47], v2 offset:6144
v_smfmac_f32_16x16x64_bf16 v[32:35], v[68:71], v[216:223], v0
v_smfmac_f32_16x16x64_bf16 v[36:39], v[68:71], a[80:87], v0
ds_read_b128 v[48:51], v2 offset:7168
s_waitcnt lgkmcnt(4)
v_bitop3_b32 v6, v6, v60, s35 bitop3:0x7e
v_smfmac_f32_16x16x64_bf16 v[40:43], v[68:71], a[88:95], v0
ds_read_b128 v[68:71], v1 offset:8192
v_smfmac_f32_16x16x64_bf16 v[32:35], v[72:75], v[232:239], v0
s_waitcnt lgkmcnt(3)
v_bitop3_b32 v6, v6, v64, s35 bitop3:0xf6
v_bitop3_b32 v6, v6, v76, s35 bitop3:0xf6
v_and_b32 v6, 1, v6
s_waitcnt lgkmcnt(1)
v_smfmac_f32_16x16x64_bf16 v[24:27], v[72:75], v[44:51], v0
ds_read_b128 v[44:47], v2 offset:8192
v_cmp_ne_u32 vcc, 0, v6
v_smfmac_f32_16x16x64_bf16 v[36:39], v[72:75], a[96:103], v0
ds_read_b128 v[48:51], v2 offset:9216
v_smfmac_f32_16x16x64_bf16 v[40:43], v[72:75], a[104:111], v0
ds_read_b128 v[72:75], v1 offset:9216
s_cbranch_vccnz L_ra1_w0s
L_a1_w0s:
v_smfmac_f32_16x16x64_bf16 v[20:23], v[60:63], v[112:119], v0
v_smfmac_f32_16x16x64_bf16 v[20:23], v[64:67], v[128:135], v0
s_waitcnt lgkmcnt(1)
v_smfmac_f32_16x16x64_bf16 v[20:23], v[76:79], v[44:51], v0
ds_read_b128 v[48:51], v2 offset:11264
v_bfe_u32 v6, v1, 5, 1
v_mad_i32_i24 v6, v6, s55, v1
v_smfmac_f32_16x16x64_bf16 v[20:23], v[68:71], v[144:151], v0
s_waitcnt lgkmcnt(1)
v_smfmac_f32_16x16x64_bf16 v[20:23], v[72:75], v[160:167], v0
ds_read_b128 v[44:47], v2 offset:10240
v_smfmac_f32_16x16x64_bf16 v[24:27], v[60:63], v[120:127], v0
v_smfmac_f32_16x16x64_bf16 v[24:27], v[64:67], v[136:143], v0
v_smfmac_f32_16x16x64_bf16 v[24:27], v[68:71], v[152:159], v0
v_add_f32 v21, v21, v23
v_smfmac_f32_16x16x64_bf16 v[24:27], v[72:75], v[168:175], v0
s_waitcnt lgkmcnt(0)
v_smfmac_f32_16x16x64_bf16 v[24:27], v[76:79], v[44:51], v0
ds_read_b128 v[44:47], v2 offset:12288
v_add_f32 v20, v20, v22
v_cvt_pk_bf16_f32 v22, v20, v21
v_smfmac_f32_16x16x64_bf16 v[28:31], v[76:79], v[240:247], v0
v_smfmac_f32_16x16x64_bf16 v[28:31], v[64:67], a[0:7], v0
ds_read_b128 v[48:51], v2 offset:13312
v_add_f32 v25, v25, v27
v_add_f32 v24, v24, v26
v_cvt_pk_bf16_f32 v23, v24, v25
v_smfmac_f32_16x16x64_bf16 v[28:31], v[72:75], a[32:39], v0
ds_write_b64 v3, v[22:23] offset:10240
v_smfmac_f32_16x16x64_bf16 v[28:31], v[68:71], a[16:23], v0
s_waitcnt vmcnt(1)
v_smfmac_f32_16x16x64_bf16 v[32:35], v[76:79], v[248:255], v0
s_waitcnt lgkmcnt(1)
v_smfmac_f32_16x16x64_bf16 v[28:31], v[60:63], v[44:51], v0
ds_read_b128 v[44:47], v2 offset:14336
ds_read_b128 v[48:51], v2 offset:15360
v_smfmac_f32_16x16x64_bf16 v[32:35], v[64:67], a[8:15], v0
s_waitcnt lgkmcnt(2)
s_barrier
ds_read_b64_tr_b16 v[20:21], v4 offset:10240
v_smfmac_f32_16x16x64_bf16 v[32:35], v[68:71], a[24:31], v0
ds_read_b64_tr_b16 v[22:23], v4 offset:10752
v_add_f32 v29, v29, v31
v_smfmac_f32_16x16x64_bf16 v[32:35], v[72:75], a[40:47], v0
ds_read_b64_tr_b16 v[24:25], v4 offset:11264
ds_read_b64_tr_b16 v[26:27], v4 offset:11776
s_waitcnt lgkmcnt(4)
v_smfmac_f32_16x16x64_bf16 v[32:35], v[60:63], v[44:51], v0
ds_read_b128 v[48:51], v2 offset:19456
s_waitcnt lgkmcnt(3)
v_mfma_f32_16x16x32_bf16 v[12:15], v[12:15], v[20:23], 0
ds_read_b128 v[44:47], v2 offset:18432
v_add_f32 v28, v28, v30
s_waitcnt lgkmcnt(2)
v_mfma_f32_16x16x32_bf16 v[12:15], v[16:19], v[24:27], v[12:15]
v_add_f32 v32, v32, v34
v_add_f32 v33, v33, v35
v_cvt_pk_bf16_f32 v31, v32, v33
v_cvt_pk_bf16_f32 v30, v28, v29
v_smfmac_f32_16x16x64_bf16 v[36:39], v[76:79], a[112:119], v0
ds_write_b64 v3, v[30:31] offset:12288
v_add_f32_dpp v12, v14, v12 quad_perm:[2,3,0,1] row_mask:0xf bank_mask:0xf
v_exp_f32 v14, v12
v_add_f32_dpp v13, v15, v13 quad_perm:[2,3,0,1] row_mask:0xf bank_mask:0xf
v_exp_f32 v15, v13
s_nop 0
v_cvt_pk_bf16_f32 v14, v14, v15
v_smfmac_f32_16x16x64_bf16 v[40:43], v[76:79], a[120:127], v0
ds_write_b32 v5, v14 offset:14368
s_waitcnt lgkmcnt(2)
v_smfmac_f32_16x16x64_bf16 v[40:43], v[72:75], v[44:51], v0
ds_read_b128 v[44:47], v2 offset:16384
s_waitcnt lgkmcnt(2)
s_barrier
ds_read_b64_tr_b16 v[28:29], v4 offset:12288
v_smfmac_f32_16x16x64_bf16 v[36:39], v[60:63], a[128:135], v0
ds_read_b64_tr_b16 v[30:31], v4 offset:12800
ds_read_b64_tr_b16 v[32:33], v4 offset:13312
v_smfmac_f32_16x16x64_bf16 v[40:43], v[60:63], a[136:143], v0
ds_read_b64_tr_b16 v[34:35], v4 offset:13824
v_mov_b64 v[76:77], s[52:53]
s_waitcnt lgkmcnt(2)
v_mfma_f32_16x16x32_bf16 v[28:31], v[28:31], v[20:23], 0
s_barrier
ds_read_b128 v[16:19], v1 offset:14368
s_waitcnt lgkmcnt(1)
v_mfma_f32_16x16x32_bf16 v[28:31], v[32:35], v[24:27], v[28:31]
ds_read_b128 v[60:63], v1 offset:14336
v_mov_b64 v[14:15], s[0:1]
v_smfmac_f32_16x16x64_bf16 v[40:43], v[64:67], a[152:159], v0
ds_read_b128 v[48:51], v2 offset:17408
v_mov_b64 v[78:79], s[52:53]
v_smfmac_f32_16x16x64_bf16 v[40:43], v[68:71], a[168:175], v0
v_add_f32_dpp v28, v30, v28 quad_perm:[2,3,0,1] row_mask:0xf bank_mask:0xf
v_smfmac_f32_16x16x64_bf16 v[36:39], v[64:67], a[144:151], v0
ds_read_b128 v[64:67], v2 offset:25600
v_add_f32_dpp v29, v31, v29 quad_perm:[2,3,0,1] row_mask:0xf bank_mask:0xf
s_waitcnt lgkmcnt(1)
v_smfmac_f32_16x16x64_bf16 v[36:39], v[72:75], v[44:51], v0
ds_read_b128 v[72:75], v2 offset:29696
v_mul_f32 v28, s50, v28
v_smfmac_f32_16x16x64_bf16 v[36:39], v[68:71], a[160:167], v0
ds_read_b128 v[68:71], v2 offset:28672
v_cvt_pk_bf16_f32 v40, v40, v41
v_mfma_f32_16x16x32_bf16 v[32:35], v[76:79], v[16:19], 0
v_exp_f32 v30, v28
ds_read_b128 v[44:47], v2 offset:20480
v_mfma_f32_16x16x32_bf16 v[20:23], v[52:55], v[16:19], 0
v_mul_f32 v29, s50, v29
v_cvt_pk_bf16_f32 v41, v42, v43
v_cvt_pk_bf16_f32 v43, v38, v39
v_mov_b64 v[76:77], 0
v_exp_f32 v31, v29
v_mfma_f32_16x16x32_bf16 v[20:23], v[56:59], v[60:63], v[20:23]
v_cvt_pk_bf16_f32 v30, v30, v31
v_cndmask_b32_e64 v26, 0, v30, s[56:57]
v_cndmask_b32_e64 v27, 0, v30, s[56:57]
s_nop 0
v_mov_b32_dpp v24, v26 quad_perm:[2,3,0,1] row_mask:0xf bank_mask:0xf
v_mfma_f32_16x16x16_bf16 v[32:35], v[14:15], v[26:27], v[32:35]
v_mov_b32_dpp v25, v26 quad_perm:[2,3,0,1] row_mask:0xf bank_mask:0xf
v_cvt_pk_bf16_f32 v42, v36, v37
s_nop 1
v_mfma_f32_16x16x32_bf16 v[20:23], v[40:43], v[24:27], v[20:23]
ds_read_b128 v[60:63], v2 offset:24576
ds_read_b128 v[48:51], v2 offset:21504
v_mov_b64 v[78:79], 0
v_rcp_f32 v33, v32
v_mov_b64 v[36:37], 0
v_min_f32 v32, v32, v33
v_cmp_nlt_f32 vcc, s2, v32
v_mul_f32_dpp v23, v33, v23 quad_perm:[0,1,0,1] row_mask:0xf bank_mask:0xf
v_mul_f32_dpp v21, v33, v21 quad_perm:[0,1,0,1] row_mask:0xf bank_mask:0xf
v_mul_f32_dpp v22, v33, v22 quad_perm:[0,1,0,1] row_mask:0xf bank_mask:0xf
v_mul_f32_dpp v20, v33, v20 quad_perm:[0,1,0,1] row_mask:0xf bank_mask:0xf
v_cvt_pk_bf16_f32 v20, v20, v21
v_cvt_pk_bf16_f32 v21, v22, v23
ds_write_b64 v6, v[20:21] offset:5120
s_and_b64 vcc, vcc, s[56:57]
s_cbranch_scc1 L_mx_w0s
L_mxb_w0s:
v_mov_b64 v[38:39], 0
v_mov_b32_dpp v19, v21 quad_perm:[2,3,2,3] row_mask:0xf bank_mask:0xf
v_mov_b32_dpp v16, v20 quad_perm:[0,1,0,1] row_mask:0xf bank_mask:0xf
v_mov_b32_dpp v18, v20 quad_perm:[2,3,2,3] row_mask:0xf bank_mask:0xf
v_mov_b32_dpp v17, v21 quad_perm:[0,1,0,1] row_mask:0xf bank_mask:0xf
v_mov_b64 v[24:25], 0
v_mov_b64 v[26:27], 0
v_smfmac_f32_16x16x64_bf16 v[76:79], v[16:19], a[176:183], v0
s_waitcnt lgkmcnt(0)
s_barrier
v_mov_b64 v[32:33], 0
ds_read_b128 v[12:15], v7 offset:7168
ds_read_b128 v[52:55], v7 offset:6144
v_smfmac_f32_16x16x64_bf16 v[36:39], v[16:19], v[44:51], v0
ds_read_b128 v[48:51], v2 offset:23552
ds_read_b128 v[56:59], v7 offset:8192
v_mov_b64 v[30:31], 0
v_mov_b64 v[34:35], 0
v_smfmac_f32_16x16x64_bf16 v[24:27], v[16:19], v[60:67], v0
ds_read_b128 v[44:47], v2 offset:22528
v_smfmac_f32_16x16x64_bf16 v[32:35], v[16:19], v[68:75], v0
ds_read_b128 v[68:71], v2 offset:30720
s_waitcnt lgkmcnt(5)
v_smfmac_f32_16x16x64_bf16 v[76:79], v[12:15], a[184:191], v0
ds_read_b128 v[60:63], v2 offset:26624
s_waitcnt lgkmcnt(5)
v_smfmac_f32_16x16x64_bf16 v[76:79], v[52:55], a[192:199], v0
ds_read_b128 v[64:67], v2 offset:27648
s_waitcnt lgkmcnt(4)
v_smfmac_f32_16x16x64_bf16 v[76:79], v[56:59], a[200:207], v0
v_mov_b64 v[28:29], 0
v_smfmac_f32_16x16x64_bf16 v[36:39], v[12:15], a[208:215], v0
ds_read_b128 v[72:75], v2 offset:31744
s_waitcnt lgkmcnt(4)
v_smfmac_f32_16x16x64_bf16 v[36:39], v[52:55], v[44:51], v0
ds_read_b128 v[44:47], v2 offset:32768
v_cvt_pk_bf16_f32 v77, v77, v79
v_cvt_pk_bf16_f32 v76, v76, v78
v_bfi_b32 v76, 1, s35, v76
v_smfmac_f32_16x16x64_bf16 v[36:39], v[56:59], a[216:223], v0
v_smfmac_f32_16x16x64_bf16 v[24:27], v[12:15], a[224:231], v0
buffer_store_dwordx2 v[76:77], v8, s[4:7], s42 offen sc0 sc1
s_waitcnt lgkmcnt(2)
v_smfmac_f32_16x16x64_bf16 v[24:27], v[52:55], v[60:67], v0
ds_read_b128 v[48:51], v2 offset:33792
ds_read_b128 v[60:63], v2 offset:36864
v_cvt_pk_bf16_f32 v36, v36, v38
v_bfi_b32 v36, 1, s35, v36
v_cvt_pk_bf16_f32 v37, v37, v39
v_smfmac_f32_16x16x64_bf16 v[24:27], v[56:59], a[232:239], v0
buffer_store_dwordx2 v[36:37], v8, s[4:7], s43 offen sc0 sc1
ds_read_b128 v[64:67], v2 offset:37888
v_smfmac_f32_16x16x64_bf16 v[32:35], v[12:15], a[240:247], v0
ds_read_b128 v[40:43], v2 offset:35840
s_waitcnt lgkmcnt(5)
v_smfmac_f32_16x16x64_bf16 v[32:35], v[52:55], v[68:75], v0
ds_read_b128 v[72:75], v2 offset:39936
ds_read_b128 v[36:39], v2 offset:34816
v_cvt_pk_bf16_f32 v25, v25, v27
v_cvt_pk_bf16_f32 v24, v24, v26
v_bfi_b32 v24, 1, s35, v24
buffer_store_dwordx2 v[24:25], v8, s[4:7], s44 offen sc0 sc1
v_smfmac_f32_16x16x64_bf16 v[32:35], v[56:59], a[248:255], v0
ds_read_b128 v[68:71], v2 offset:38912
s_waitcnt lgkmcnt(6)
v_smfmac_f32_16x16x64_bf16 v[28:31], v[16:19], v[44:51], v0
s_nop 3
v_cvt_pk_bf16_f32 v33, v33, v35
v_cvt_pk_bf16_f32 v32, v32, v34
v_bfi_b32 v32, 1, s35, v32
buffer_store_dwordx2 v[32:33], v8, s[4:7], s45 offen sc0 sc1
s_waitcnt lgkmcnt(1)
v_smfmac_f32_16x16x64_bf16 v[28:31], v[52:55], v[36:43], v0
v_smfmac_f32_16x16x64_bf16 v[28:31], v[12:15], v[60:67], v0
s_waitcnt lgkmcnt(0)
v_smfmac_f32_16x16x64_bf16 v[28:31], v[56:59], v[68:75], v0
s_nop 7
v_cvt_pk_bf16_f32 v28, v28, v30
v_bfi_b32 v28, 1, s35, v28
v_cvt_pk_bf16_f32 v29, v29, v31
buffer_store_dwordx2 v[28:29], v8, s[4:7], s46 offen sc0 sc1
s_branch L_ex_w0s
.p2align 6
L_ex_w0rs:
v_and_b32 v6, 0x70, v1
ds_read_b128 v[76:79], v6 offset:256
v_bfe_u32 v11, v1, 4, 2
v_lshrrev_b32_e64 v11, v11, 1
v_mov_b64 v[20:21], 0
v_mov_b64 v[22:23], 0
v_mov_b64 v[24:25], 0
v_mov_b64 v[26:27], 0
v_mov_b64 v[28:29], 0
v_mov_b64 v[30:31], 0
v_mov_b64 v[32:33], 0
v_mov_b64 v[34:35], 0
ds_read_b128 v[44:47], v2 offset:0
ds_read_b128 v[48:51], v2 offset:1024
s_add_u32 s34, s34, 1
s_not_b32 s35, s35
s_not_b32 s36, s36
s_barrier
s_waitcnt vmcnt(0)
s_add_u32 s37, s37, 524288
s_add_u32 s39, s39, 524288
s_mul_i32 s40, s34, 10240
s_add_u32 s40, s40, 8093696
buffer_load_dwordx4 v[60:63], v9, s[4:7], s3 offen offset:0 sc0 sc1
buffer_load_dwordx4 v[64:67], v9, s[4:7], s3 offen offset:1024 sc0 sc1
buffer_load_dwordx4 v[68:71], v9, s[4:7], s3 offen offset:2048 sc0 sc1
buffer_load_dwordx4 v[72:75], v9, s[4:7], s3 offen offset:3072 sc0 sc1
s_waitcnt lgkmcnt(2)
s_waitcnt vmcnt(3)
L_r_w0rs:
v_mfma_f32_16x16x32_bf16 v[36:39], v[60:63], v[76:79], 0
s_waitcnt vmcnt(2)
v_mfma_f32_16x16x32_bf16 v[36:39], v[64:67], v[76:79], v[36:39]
v_bitop3_b32 v40, v60, v64, s36 bitop3:0x7e
s_waitcnt vmcnt(1)
v_mfma_f32_16x16x32_bf16 v[36:39], v[68:71], v[76:79], v[36:39]
s_waitcnt vmcnt(0)
v_mfma_f32_16x16x32_bf16 v[36:39], v[72:75], v[76:79], v[36:39]
v_bitop3_b32 v41, v68, v72, s36 bitop3:0x7e
v_bitop3_b32 v40, v40, v41, 1 bitop3:0xa8
v_cmp_ne_u32 vcc, 0, v40
v_nop
v_nop
v_nop
v_nop
v_nop
v_pk_add_f32 v[36:37], v[36:37], v[38:39]
v_cvt_pk_bf16_f32 v40, v36, v37
v_bfi_b32 v40, v11, s35, v40
s_cbranch_vccnz L_rr_w0rs
buffer_store_dword v40, v10, s[4:7], 0 offen sc0 sc1
s_cmp_eq_u32 s34, 63
v_mov_b32 v11, v40
s_cbranch_scc1 L_done_w0rs
v_mov_b64 v[36:37], 0
v_mov_b64 v[38:39], 0
v_mov_b64 v[40:41], 0
v_mov_b64 v[42:43], 0
v_bfe_u32 v77, v1, 6, 1
v_lshl_add_u32 v77, v77, 3, v1
v_lshlrev_b32 v77, 1, v77
v_lshlrev_b32 v78, 3, v1
L_top_w0rs:
s_barrier
ds_read_b128 v[60:63], v1 offset:1024
s_mov_b32 m0, 5120
s_nop 0
buffer_load_dwordx4 v1, s[4:7], s48 offen offset:0 sc0 sc1 lds
s_barrier
ds_read_b128 v[64:67], v1 offset:2048
ds_read_b128 v[68:71], v1 offset:3072
ds_read_b128 v[72:75], v1 offset:4096
L_s0_w0rs:
s_waitcnt lgkmcnt(3)
v_smfmac_f32_16x16x64_bf16 v[32:35], v[60:63], v[184:191], v0
v_smfmac_f32_16x16x64_bf16 v[20:23], v[60:63], v[44:51], v0
v_smfmac_f32_16x16x64_bf16 v[36:39], v[60:63], a[48:55], v0
buffer_load_dwordx4 v[12:15], v9, s[4:7], s37 offen offset:0
v_smfmac_f32_16x16x64_bf16 v[28:31], v[60:63], v[176:183], v0
buffer_load_dwordx4 v[16:19], v9, s[4:7], s37 offen offset:1024
v_smfmac_f32_16x16x64_bf16 v[40:43], v[60:63], a[56:63], v0
s_waitcnt lgkmcnt(2)
v_smfmac_f32_16x16x64_bf16 v[28:31], v[64:67], v[192:199], v0
ds_read_b128 v[48:51], v2 offset:3072
v_smfmac_f32_16x16x64_bf16 v[20:23], v[64:67], v[80:87], v0
ds_read_b128 v[44:47], v2 offset:2048
v_smfmac_f32_16x16x64_bf16 v[32:35], v[64:67], v[200:207], v0
buffer_load_dwordx4 v[52:55], v1, s[4:7], s37 offen offset:2048
v_bitop3_b32 v6, v60, v64, s35 bitop3:0x7e
s_waitcnt lgkmcnt(2)
v_bitop3_b32 v76, v68, v72, s35 bitop3:0x7e
v_bitop3_b32 v6, v6, v76, 1 bitop3:0xa8
v_smfmac_f32_16x16x64_bf16 v[24:27], v[64:67], v[88:95], v0
s_waitcnt lgkmcnt(0)
v_smfmac_f32_16x16x64_bf16 v[24:27], v[60:63], v[44:51], v0
buffer_load_dwordx4 v[56:59], v1, s[4:7], s37 offen offset:3072
v_smfmac_f32_16x16x64_bf16 v[40:43], v[64:67], a[72:79], v0
v_smfmac_f32_16x16x64_bf16 v[36:39], v[64:67], a[64:71], v0
ds_read_b128 v[44:47], v2 offset:4096
v_cmp_ne_u32 vcc, 0, v6
v_smfmac_f32_16x16x64_bf16 v[20:23], v[68:71], v[96:103], v0
ds_read_b128 v[48:51], v2 offset:5120
v_smfmac_f32_16x16x64_bf16 v[24:27], v[68:71], v[104:111], v0
s_cbranch_vccnz L_ra0_w0rs
s_waitcnt vmcnt(4)
s_barrier
ds_read_b32 v6, v77 offset:8192
v_smfmac_f32_16x16x64_bf16 v[28:31], v[68:71], v[208:215], v0
s_mov_b32 m0, 0
ds_read_b128 v[60:63], v1 offset:6144
buffer_store_dword v11, v10, s[4:7], s40 offen sc0 sc1
s_waitcnt lgkmcnt(2)
v_smfmac_f32_16x16x64_bf16 v[20:23], v[72:75], v[44:51], v0
buffer_load_dword v78, s[4:7], s39 offen lds
ds_read_b128 v[76:79], v1 offset:5120
v_smfmac_f32_16x16x64_bf16 v[28:31], v[72:75], v[224:231], v0
ds_read_b128 v[64:67], v1 offset:7168
ds_read_b128 v[44:47], v2 offset:6144
v_smfmac_f32_16x16x64_bf16 v[32:35], v[68:71], v[216:223], v0
v_smfmac_f32_16x16x64_bf16 v[36:39], v[68:71], a[80:87], v0
ds_read_b128 v[48:51], v2 offset:7168
s_waitcnt lgkmcnt(4)
v_bitop3_b32 v6, v6, v60, s35 bitop3:0x7e
v_smfmac_f32_16x16x64_bf16 v[40:43], v[68:71], a[88:95], v0
ds_read_b128 v[68:71], v1 offset:8192
v_smfmac_f32_16x16x64_bf16 v[32:35], v[72:75], v[232:239], v0
s_waitcnt lgkmcnt(3)
v_bitop3_b32 v6, v6, v64, s35 bitop3:0xf6
v_bitop3_b32 v6, v6, v76, s35 bitop3:0xf6
v_and_b32 v6, 1, v6
s_waitcnt lgkmcnt(1)
v_smfmac_f32_16x16x64_bf16 v[24:27], v[72:75], v[44:51], v0
ds_read_b128 v[44:47], v2 offset:8192
v_cmp_ne_u32 vcc, 0, v6
v_smfmac_f32_16x16x64_bf16 v[36:39], v[72:75], a[96:103], v0
ds_read_b128 v[48:51], v2 offset:9216
v_smfmac_f32_16x16x64_bf16 v[40:43], v[72:75], a[104:111], v0
ds_read_b128 v[72:75], v1 offset:9216
s_cbranch_vccnz L_ra1_w0rs
L_a1_w0rs:
v_smfmac_f32_16x16x64_bf16 v[20:23], v[60:63], v[112:119], v0
v_smfmac_f32_16x16x64_bf16 v[20:23], v[64:67], v[128:135], v0
s_waitcnt lgkmcnt(1)
v_smfmac_f32_16x16x64_bf16 v[20:23], v[76:79], v[44:51], v0
ds_read_b128 v[48:51], v2 offset:11264
v_bfe_u32 v6, v1, 5, 1
v_mad_i32_i24 v6, v6, s55, v1
v_smfmac_f32_16x16x64_bf16 v[20:23], v[68:71], v[144:151], v0
s_waitcnt lgkmcnt(1)
v_smfmac_f32_16x16x64_bf16 v[20:23], v[72:75], v[160:167], v0
ds_read_b128 v[44:47], v2 offset:10240
v_smfmac_f32_16x16x64_bf16 v[24:27], v[60:63], v[120:127], v0
v_smfmac_f32_16x16x64_bf16 v[24:27], v[64:67], v[136:143], v0
v_smfmac_f32_16x16x64_bf16 v[24:27], v[68:71], v[152:159], v0
v_add_f32 v21, v21, v23
v_smfmac_f32_16x16x64_bf16 v[24:27], v[72:75], v[168:175], v0
s_waitcnt lgkmcnt(0)
v_smfmac_f32_16x16x64_bf16 v[24:27], v[76:79], v[44:51], v0
ds_read_b128 v[44:47], v2 offset:12288
v_add_f32 v20, v20, v22
v_cvt_pk_bf16_f32 v22, v20, v21
v_smfmac_f32_16x16x64_bf16 v[28:31], v[76:79], v[240:247], v0
v_smfmac_f32_16x16x64_bf16 v[28:31], v[64:67], a[0:7], v0
ds_read_b128 v[48:51], v2 offset:13312
v_add_f32 v25, v25, v27
v_add_f32 v24, v24, v26
v_cvt_pk_bf16_f32 v23, v24, v25
v_smfmac_f32_16x16x64_bf16 v[28:31], v[72:75], a[32:39], v0
ds_write_b64 v3, v[22:23] offset:10240
v_smfmac_f32_16x16x64_bf16 v[28:31], v[68:71], a[16:23], v0
s_waitcnt vmcnt(2)
v_smfmac_f32_16x16x64_bf16 v[32:35], v[76:79], v[248:255], v0
s_waitcnt lgkmcnt(1)
v_smfmac_f32_16x16x64_bf16 v[28:31], v[60:63], v[44:51], v0
ds_read_b128 v[44:47], v2 offset:14336
ds_read_b128 v[48:51], v2 offset:15360
v_smfmac_f32_16x16x64_bf16 v[32:35], v[64:67], a[8:15], v0
s_waitcnt lgkmcnt(2)
s_barrier
ds_read_b64_tr_b16 v[20:21], v4 offset:10240
v_smfmac_f32_16x16x64_bf16 v[32:35], v[68:71], a[24:31], v0
ds_read_b64_tr_b16 v[22:23], v4 offset:10752
v_add_f32 v29, v29, v31
v_smfmac_f32_16x16x64_bf16 v[32:35], v[72:75], a[40:47], v0
ds_read_b64_tr_b16 v[24:25], v4 offset:11264
ds_read_b64_tr_b16 v[26:27], v4 offset:11776
s_waitcnt lgkmcnt(4)
v_smfmac_f32_16x16x64_bf16 v[32:35], v[60:63], v[44:51], v0
ds_read_b128 v[48:51], v2 offset:19456
s_waitcnt lgkmcnt(3)
v_mfma_f32_16x16x32_bf16 v[12:15], v[12:15], v[20:23], 0
ds_read_b128 v[44:47], v2 offset:18432
v_add_f32 v28, v28, v30
s_waitcnt lgkmcnt(2)
v_mfma_f32_16x16x32_bf16 v[12:15], v[16:19], v[24:27], v[12:15]
v_add_f32 v32, v32, v34
v_add_f32 v33, v33, v35
v_cvt_pk_bf16_f32 v31, v32, v33
v_cvt_pk_bf16_f32 v30, v28, v29
v_smfmac_f32_16x16x64_bf16 v[36:39], v[76:79], a[112:119], v0
ds_write_b64 v3, v[30:31] offset:12288
v_add_f32_dpp v12, v14, v12 quad_perm:[2,3,0,1] row_mask:0xf bank_mask:0xf
v_exp_f32 v14, v12
v_add_f32_dpp v13, v15, v13 quad_perm:[2,3,0,1] row_mask:0xf bank_mask:0xf
v_exp_f32 v15, v13
s_nop 0
v_cvt_pk_bf16_f32 v14, v14, v15
v_smfmac_f32_16x16x64_bf16 v[40:43], v[76:79], a[120:127], v0
ds_write_b32 v5, v14 offset:14368
s_waitcnt lgkmcnt(2)
v_smfmac_f32_16x16x64_bf16 v[40:43], v[72:75], v[44:51], v0
ds_read_b128 v[44:47], v2 offset:16384
s_waitcnt lgkmcnt(2)
s_barrier
ds_read_b64_tr_b16 v[28:29], v4 offset:12288
v_smfmac_f32_16x16x64_bf16 v[36:39], v[60:63], a[128:135], v0
ds_read_b64_tr_b16 v[30:31], v4 offset:12800
ds_read_b64_tr_b16 v[32:33], v4 offset:13312
v_smfmac_f32_16x16x64_bf16 v[40:43], v[60:63], a[136:143], v0
ds_read_b64_tr_b16 v[34:35], v4 offset:13824
v_mov_b64 v[76:77], s[52:53]
s_waitcnt lgkmcnt(2)
v_mfma_f32_16x16x32_bf16 v[28:31], v[28:31], v[20:23], 0
s_barrier
ds_read_b128 v[16:19], v1 offset:14368
s_waitcnt lgkmcnt(1)
v_mfma_f32_16x16x32_bf16 v[28:31], v[32:35], v[24:27], v[28:31]
ds_read_b128 v[60:63], v1 offset:14336
v_mov_b64 v[14:15], s[0:1]
v_smfmac_f32_16x16x64_bf16 v[40:43], v[64:67], a[152:159], v0
ds_read_b128 v[48:51], v2 offset:17408
v_mov_b64 v[78:79], s[52:53]
v_smfmac_f32_16x16x64_bf16 v[40:43], v[68:71], a[168:175], v0
v_add_f32_dpp v28, v30, v28 quad_perm:[2,3,0,1] row_mask:0xf bank_mask:0xf
v_smfmac_f32_16x16x64_bf16 v[36:39], v[64:67], a[144:151], v0
ds_read_b128 v[64:67], v2 offset:25600
v_add_f32_dpp v29, v31, v29 quad_perm:[2,3,0,1] row_mask:0xf bank_mask:0xf
s_waitcnt lgkmcnt(1)
v_smfmac_f32_16x16x64_bf16 v[36:39], v[72:75], v[44:51], v0
ds_read_b128 v[72:75], v2 offset:29696
v_mul_f32 v28, s50, v28
v_smfmac_f32_16x16x64_bf16 v[36:39], v[68:71], a[160:167], v0
ds_read_b128 v[68:71], v2 offset:28672
v_cvt_pk_bf16_f32 v40, v40, v41
v_mfma_f32_16x16x32_bf16 v[32:35], v[76:79], v[16:19], 0
v_exp_f32 v30, v28
ds_read_b128 v[44:47], v2 offset:20480
v_mfma_f32_16x16x32_bf16 v[20:23], v[52:55], v[16:19], 0
v_mul_f32 v29, s50, v29
v_cvt_pk_bf16_f32 v41, v42, v43
v_cvt_pk_bf16_f32 v43, v38, v39
v_mov_b64 v[76:77], 0
v_exp_f32 v31, v29
v_mfma_f32_16x16x32_bf16 v[20:23], v[56:59], v[60:63], v[20:23]
v_cvt_pk_bf16_f32 v30, v30, v31
v_cndmask_b32_e64 v26, 0, v30, s[56:57]
v_cndmask_b32_e64 v27, 0, v30, s[56:57]
s_nop 0
v_mov_b32_dpp v24, v26 quad_perm:[2,3,0,1] row_mask:0xf bank_mask:0xf
v_mfma_f32_16x16x16_bf16 v[32:35], v[14:15], v[26:27], v[32:35]
v_mov_b32_dpp v25, v26 quad_perm:[2,3,0,1] row_mask:0xf bank_mask:0xf
v_cvt_pk_bf16_f32 v42, v36, v37
s_nop 1
v_mfma_f32_16x16x32_bf16 v[20:23], v[40:43], v[24:27], v[20:23]
ds_read_b128 v[60:63], v2 offset:24576
ds_read_b128 v[48:51], v2 offset:21504
v_mov_b64 v[78:79], 0
v_rcp_f32 v33, v32
v_mov_b64 v[36:37], 0
v_min_f32 v32, v32, v33
v_cmp_nlt_f32 vcc, s2, v32
v_mul_f32_dpp v23, v33, v23 quad_perm:[0,1,0,1] row_mask:0xf bank_mask:0xf
v_mul_f32_dpp v21, v33, v21 quad_perm:[0,1,0,1] row_mask:0xf bank_mask:0xf
v_mul_f32_dpp v22, v33, v22 quad_perm:[0,1,0,1] row_mask:0xf bank_mask:0xf
v_mul_f32_dpp v20, v33, v20 quad_perm:[0,1,0,1] row_mask:0xf bank_mask:0xf
v_cvt_pk_bf16_f32 v20, v20, v21
v_cvt_pk_bf16_f32 v21, v22, v23
ds_write_b64 v6, v[20:21] offset:5120
s_and_b64 vcc, vcc, s[56:57]
s_cbranch_scc1 L_mx_w0rs
L_mxb_w0rs:
v_mov_b64 v[38:39], 0
v_mov_b32_dpp v19, v21 quad_perm:[2,3,2,3] row_mask:0xf bank_mask:0xf
v_mov_b32_dpp v16, v20 quad_perm:[0,1,0,1] row_mask:0xf bank_mask:0xf
v_mov_b32_dpp v18, v20 quad_perm:[2,3,2,3] row_mask:0xf bank_mask:0xf
v_mov_b32_dpp v17, v21 quad_perm:[0,1,0,1] row_mask:0xf bank_mask:0xf
v_mov_b64 v[24:25], 0
v_mov_b64 v[26:27], 0
v_smfmac_f32_16x16x64_bf16 v[76:79], v[16:19], a[176:183], v0
s_waitcnt lgkmcnt(0)
s_barrier
v_mov_b64 v[32:33], 0
ds_read_b128 v[12:15], v7 offset:7168
ds_read_b128 v[52:55], v7 offset:6144
v_smfmac_f32_16x16x64_bf16 v[36:39], v[16:19], v[44:51], v0
ds_read_b128 v[48:51], v2 offset:23552
ds_read_b128 v[56:59], v7 offset:8192
v_mov_b64 v[30:31], 0
v_mov_b64 v[34:35], 0
v_smfmac_f32_16x16x64_bf16 v[24:27], v[16:19], v[60:67], v0
ds_read_b128 v[44:47], v2 offset:22528
v_smfmac_f32_16x16x64_bf16 v[32:35], v[16:19], v[68:75], v0
ds_read_b128 v[68:71], v2 offset:30720
s_waitcnt lgkmcnt(5)
v_smfmac_f32_16x16x64_bf16 v[76:79], v[12:15], a[184:191], v0
ds_read_b128 v[60:63], v2 offset:26624
s_waitcnt lgkmcnt(5)
v_smfmac_f32_16x16x64_bf16 v[76:79], v[52:55], a[192:199], v0
ds_read_b128 v[64:67], v2 offset:27648
s_waitcnt lgkmcnt(4)
v_smfmac_f32_16x16x64_bf16 v[76:79], v[56:59], a[200:207], v0
v_mov_b64 v[28:29], 0
v_smfmac_f32_16x16x64_bf16 v[36:39], v[12:15], a[208:215], v0
ds_read_b128 v[72:75], v2 offset:31744
s_waitcnt lgkmcnt(4)
v_smfmac_f32_16x16x64_bf16 v[36:39], v[52:55], v[44:51], v0
ds_read_b128 v[44:47], v2 offset:32768
v_cvt_pk_bf16_f32 v77, v77, v79
v_cvt_pk_bf16_f32 v76, v76, v78
v_bfi_b32 v76, 1, s35, v76
v_smfmac_f32_16x16x64_bf16 v[36:39], v[56:59], a[216:223], v0
v_smfmac_f32_16x16x64_bf16 v[24:27], v[12:15], a[224:231], v0
buffer_store_dwordx2 v[76:77], v8, s[4:7], s42 offen sc0 sc1
s_waitcnt lgkmcnt(2)
v_smfmac_f32_16x16x64_bf16 v[24:27], v[52:55], v[60:67], v0
ds_read_b128 v[48:51], v2 offset:33792
ds_read_b128 v[60:63], v2 offset:36864
v_cvt_pk_bf16_f32 v36, v36, v38
v_bfi_b32 v36, 1, s35, v36
v_cvt_pk_bf16_f32 v37, v37, v39
v_smfmac_f32_16x16x64_bf16 v[24:27], v[56:59], a[232:239], v0
buffer_store_dwordx2 v[36:37], v8, s[4:7], s43 offen sc0 sc1
ds_read_b128 v[64:67], v2 offset:37888
v_smfmac_f32_16x16x64_bf16 v[32:35], v[12:15], a[240:247], v0
ds_read_b128 v[40:43], v2 offset:35840
s_waitcnt lgkmcnt(5)
v_smfmac_f32_16x16x64_bf16 v[32:35], v[52:55], v[68:75], v0
ds_read_b128 v[72:75], v2 offset:39936
ds_read_b128 v[36:39], v2 offset:34816
v_cvt_pk_bf16_f32 v25, v25, v27
v_cvt_pk_bf16_f32 v24, v24, v26
v_bfi_b32 v24, 1, s35, v24
buffer_store_dwordx2 v[24:25], v8, s[4:7], s44 offen sc0 sc1
v_smfmac_f32_16x16x64_bf16 v[32:35], v[56:59], a[248:255], v0
ds_read_b128 v[68:71], v2 offset:38912
s_waitcnt lgkmcnt(6)
v_smfmac_f32_16x16x64_bf16 v[28:31], v[16:19], v[44:51], v0
s_nop 3
v_cvt_pk_bf16_f32 v33, v33, v35
v_cvt_pk_bf16_f32 v32, v32, v34
v_bfi_b32 v32, 1, s35, v32
buffer_store_dwordx2 v[32:33], v8, s[4:7], s45 offen sc0 sc1
s_waitcnt lgkmcnt(1)
v_smfmac_f32_16x16x64_bf16 v[28:31], v[52:55], v[36:43], v0
v_smfmac_f32_16x16x64_bf16 v[28:31], v[12:15], v[60:67], v0
s_waitcnt lgkmcnt(0)
v_smfmac_f32_16x16x64_bf16 v[28:31], v[56:59], v[68:75], v0
s_nop 7
v_cvt_pk_bf16_f32 v28, v28, v30
v_bfi_b32 v28, 1, s35, v28
v_cvt_pk_bf16_f32 v29, v29, v31
buffer_store_dwordx2 v[28:29], v8, s[4:7], s46 offen sc0 sc1
s_branch L_ex_w0rs
.p2align 6
L_ex_w1rs:
v_and_b32 v6, 0x70, v1
ds_read_b128 v[76:79], v6 offset:256
v_bfe_u32 v11, v1, 4, 2
v_lshrrev_b32_e64 v11, v11, 1
v_mov_b64 v[20:21], 0
v_mov_b64 v[22:23], 0
v_mov_b64 v[24:25], 0
v_mov_b64 v[26:27], 0
v_mov_b64 v[28:29], 0
v_mov_b64 v[30:31], 0
v_mov_b64 v[32:33], 0
v_mov_b64 v[34:35], 0
ds_read_b128 v[44:47], v2 offset:0
ds_read_b128 v[48:51], v2 offset:1024
s_add_u32 s34, s34, 1
s_not_b32 s35, s35
s_not_b32 s36, s36
s_add_u32 s37, s37, 524288
s_mul_i32 s40, s34, 10240
s_add_u32 s40, s40, 8093696
s_barrier
s_waitcnt vmcnt(0)
buffer_load_dwordx4 v[60:63], v9, s[4:7], s3 offen offset:0 sc0 sc1
buffer_load_dwordx4 v[64:67], v9, s[4:7], s3 offen offset:1024 sc0 sc1
buffer_load_dwordx4 v[68:71], v9, s[4:7], s3 offen offset:2048 sc0 sc1
buffer_load_dwordx4 v[72:75], v9, s[4:7], s3 offen offset:3072 sc0 sc1
s_waitcnt lgkmcnt(2)
s_waitcnt vmcnt(3)
L_r_w1rs:
v_mfma_f32_16x16x32_bf16 v[36:39], v[60:63], v[76:79], 0
s_waitcnt vmcnt(2)
v_mfma_f32_16x16x32_bf16 v[36:39], v[64:67], v[76:79], v[36:39]
v_bitop3_b32 v40, v60, v64, s36 bitop3:0x7e
s_waitcnt vmcnt(1)
v_mfma_f32_16x16x32_bf16 v[36:39], v[68:71], v[76:79], v[36:39]
s_waitcnt vmcnt(0)
v_mfma_f32_16x16x32_bf16 v[36:39], v[72:75], v[76:79], v[36:39]
v_bitop3_b32 v41, v68, v72, s36 bitop3:0x7e
v_bitop3_b32 v40, v40, v41, 1 bitop3:0xa8
v_cmp_ne_u32 vcc, 0, v40
v_nop
v_nop
v_nop
v_nop
v_nop
v_pk_add_f32 v[36:37], v[36:37], v[38:39]
v_cvt_pk_bf16_f32 v40, v36, v37
v_bfi_b32 v40, v11, s35, v40
s_cbranch_vccnz L_rr_w1rs
buffer_store_dword v40, v10, s[4:7], 0 offen sc0 sc1
s_cmp_eq_u32 s34, 63
v_mov_b32 v11, v40
s_cbranch_scc1 L_done_w1rs
v_mov_b64 v[36:37], 0
v_mov_b64 v[38:39], 0
v_mov_b64 v[40:41], 0
v_mov_b64 v[42:43], 0
v_bfe_u32 v77, v1, 6, 1
v_lshl_add_u32 v77, v77, 3, v1
v_lshlrev_b32 v77, 1, v77
v_lshlrev_b32 v78, 3, v1
L_top_w1rs:
s_barrier
ds_read_b128 v[60:63], v1 offset:1024
s_mov_b32 m0, 5120
s_nop 0
buffer_load_dwordx4 v1, s[4:7], s48 offen offset:1024 sc0 sc1 lds
s_barrier
ds_read_b128 v[64:67], v1 offset:2048
ds_read_b128 v[68:71], v1 offset:3072
ds_read_b128 v[72:75], v1 offset:4096
L_s0_w1rs:
s_waitcnt lgkmcnt(3)
v_smfmac_f32_16x16x64_bf16 v[32:35], v[60:63], v[184:191], v0
v_smfmac_f32_16x16x64_bf16 v[20:23], v[60:63], v[44:51], v0
v_smfmac_f32_16x16x64_bf16 v[36:39], v[60:63], a[48:55], v0
s_waitcnt lgkmcnt(2)
v_smfmac_f32_16x16x64_bf16 v[28:31], v[64:67], v[192:199], v0
v_smfmac_f32_16x16x64_bf16 v[28:31], v[60:63], v[176:183], v0
buffer_load_dwordx4 v[12:15], v9, s[4:7], s37 offen offset:0
ds_read_b128 v[48:51], v2 offset:3072
ds_read_b128 v[44:47], v2 offset:2048
v_smfmac_f32_16x16x64_bf16 v[20:23], v[64:67], v[80:87], v0
buffer_load_dwordx4 v[16:19], v9, s[4:7], s37 offen offset:1024
v_smfmac_f32_16x16x64_bf16 v[32:35], v[64:67], v[200:207], v0
v_smfmac_f32_16x16x64_bf16 v[40:43], v[60:63], a[56:63], v0
v_bitop3_b32 v6, v60, v64, s35 bitop3:0x7e
v_smfmac_f32_16x16x64_bf16 v[24:27], v[64:67], v[88:95], v0
buffer_load_dwordx4 v[52:55], v1, s[4:7], s37 offen offset:2048
s_waitcnt lgkmcnt(0)
v_smfmac_f32_16x16x64_bf16 v[24:27], v[60:63], v[44:51], v0
v_bitop3_b32 v76, v68, v72, s35 bitop3:0x7e
v_smfmac_f32_16x16x64_bf16 v[36:39], v[64:67], a[64:71], v0
v_bitop3_b32 v6, v6, v76, 1 bitop3:0xa8
v_smfmac_f32_16x16x64_bf16 v[40:43], v[64:67], a[72:79], v0
buffer_load_dwordx4 v[56:59], v1, s[4:7], s37 offen offset:3072
ds_read_b128 v[44:47], v2 offset:4096
v_cmp_ne_u32 vcc, 0, v6
v_smfmac_f32_16x16x64_bf16 v[20:23], v[68:71], v[96:103], v0
ds_read_b128 v[48:51], v2 offset:5120
v_smfmac_f32_16x16x64_bf16 v[24:27], v[68:71], v[104:111], v0
s_cbranch_vccnz L_ra0_w1rs
s_waitcnt vmcnt(4)
s_barrier
ds_read_b32 v6, v77 offset:8192
v_smfmac_f32_16x16x64_bf16 v[28:31], v[68:71], v[208:215], v0
ds_read_b128 v[60:63], v1 offset:6144
s_waitcnt lgkmcnt(2)
v_smfmac_f32_16x16x64_bf16 v[20:23], v[72:75], v[44:51], v0
ds_read_b128 v[76:79], v1 offset:5120
ds_read_b128 v[44:47], v2 offset:6144
buffer_store_dword v11, v10, s[4:7], s40 offen sc0 sc1
v_smfmac_f32_16x16x64_bf16 v[28:31], v[72:75], v[224:231], v0
ds_read_b128 v[64:67], v1 offset:7168
v_smfmac_f32_16x16x64_bf16 v[36:39], v[68:71], a[80:87], v0
v_smfmac_f32_16x16x64_bf16 v[32:35], v[68:71], v[216:223], v0
ds_read_b128 v[48:51], v2 offset:7168
s_waitcnt lgkmcnt(4)
v_bitop3_b32 v6, v6, v60, s35 bitop3:0x7e
v_smfmac_f32_16x16x64_bf16 v[40:43], v[68:71], a[88:95], v0
ds_read_b128 v[68:71], v1 offset:8192
v_smfmac_f32_16x16x64_bf16 v[32:35], v[72:75], v[232:239], v0
s_waitcnt lgkmcnt(2)
v_bitop3_b32 v6, v6, v64, s35 bitop3:0xf6
v_bitop3_b32 v6, v6, v76, s35 bitop3:0xf6
v_and_b32 v6, 1, v6
s_waitcnt lgkmcnt(1)
v_smfmac_f32_16x16x64_bf16 v[24:27], v[72:75], v[44:51], v0
ds_read_b128 v[44:47], v2 offset:8192
v_cmp_ne_u32 vcc, 0, v6
v_smfmac_f32_16x16x64_bf16 v[36:39], v[72:75], a[96:103], v0
ds_read_b128 v[48:51], v2 offset:9216
v_smfmac_f32_16x16x64_bf16 v[40:43], v[72:75], a[104:111], v0
ds_read_b128 v[72:75], v1 offset:9216
s_cbranch_vccnz L_ra1_w1rs
L_a1_w1rs:
v_smfmac_f32_16x16x64_bf16 v[20:23], v[60:63], v[112:119], v0
v_smfmac_f32_16x16x64_bf16 v[20:23], v[64:67], v[128:135], v0
s_waitcnt lgkmcnt(1)
v_smfmac_f32_16x16x64_bf16 v[20:23], v[76:79], v[44:51], v0
ds_read_b128 v[48:51], v2 offset:11264
s_waitcnt lgkmcnt(1)
v_smfmac_f32_16x16x64_bf16 v[20:23], v[72:75], v[160:167], v0
v_bfe_u32 v6, v1, 5, 1
v_mad_i32_i24 v6, v6, s55, v1
v_smfmac_f32_16x16x64_bf16 v[20:23], v[68:71], v[144:151], v0
ds_read_b128 v[44:47], v2 offset:10240
v_smfmac_f32_16x16x64_bf16 v[24:27], v[60:63], v[120:127], v0
v_smfmac_f32_16x16x64_bf16 v[24:27], v[64:67], v[136:143], v0
v_smfmac_f32_16x16x64_bf16 v[24:27], v[68:71], v[152:159], v0
v_add_f32 v21, v21, v23
v_smfmac_f32_16x16x64_bf16 v[24:27], v[72:75], v[168:175], v0
s_waitcnt lgkmcnt(0)
v_smfmac_f32_16x16x64_bf16 v[24:27], v[76:79], v[44:51], v0
ds_read_b128 v[44:47], v2 offset:12288
v_add_f32 v20, v20, v22
v_cvt_pk_bf16_f32 v22, v20, v21
v_smfmac_f32_16x16x64_bf16 v[28:31], v[76:79], v[240:247], v0
ds_read_b128 v[48:51], v2 offset:13312
v_smfmac_f32_16x16x64_bf16 v[28:31], v[64:67], a[0:7], v0
v_add_f32 v25, v25, v27
v_add_f32 v24, v24, v26
v_cvt_pk_bf16_f32 v23, v24, v25
v_smfmac_f32_16x16x64_bf16 v[28:31], v[72:75], a[32:39], v0
ds_write_b64 v3, v[22:23] offset:10752
v_smfmac_f32_16x16x64_bf16 v[28:31], v[68:71], a[16:23], v0
v_smfmac_f32_16x16x64_bf16 v[32:35], v[76:79], v[248:255], v0
s_waitcnt vmcnt(1)
s_waitcnt lgkmcnt(1)
v_smfmac_f32_16x16x64_bf16 v[28:31], v[60:63], v[44:51], v0
ds_read_b128 v[44:47], v2 offset:14336
ds_read_b128 v[48:51], v2 offset:15360
v_smfmac_f32_16x16x64_bf16 v[32:35], v[64:67], a[8:15], v0
s_waitcnt lgkmcnt(2)
s_barrier
v_smfmac_f32_16x16x64_bf16 v[32:35], v[68:71], a[24:31], v0
ds_read_b64_tr_b16 v[20:21], v4 offset:10240
ds_read_b64_tr_b16 v[22:23], v4 offset:10752
v_add_f32 v29, v29, v31
v_smfmac_f32_16x16x64_bf16 v[32:35], v[72:75], a[40:47], v0
ds_read_b64_tr_b16 v[24:25], v4 offset:11264
ds_read_b64_tr_b16 v[26:27], v4 offset:11776
s_waitcnt lgkmcnt(4)
v_smfmac_f32_16x16x64_bf16 v[32:35], v[60:63], v[44:51], v0
ds_read_b128 v[48:51], v2 offset:19456
s_waitcnt lgkmcnt(3)
v_mfma_f32_16x16x32_bf16 v[12:15], v[12:15], v[20:23], 0
ds_read_b128 v[44:47], v2 offset:18432
v_add_f32 v28, v28, v30
s_waitcnt lgkmcnt(2)
v_mfma_f32_16x16x32_bf16 v[12:15], v[16:19], v[24:27], v[12:15]
v_add_f32 v32, v32, v34
v_add_f32 v33, v33, v35
v_cvt_pk_bf16_f32 v30, v28, v29
v_cvt_pk_bf16_f32 v31, v32, v33
v_smfmac_f32_16x16x64_bf16 v[36:39], v[76:79], a[112:119], v0
ds_write_b64 v3, v[30:31] offset:12800
v_add_f32_dpp v12, v14, v12 quad_perm:[2,3,0,1] row_mask:0xf bank_mask:0xf
v_exp_f32 v14, v12
v_add_f32_dpp v13, v15, v13 quad_perm:[2,3,0,1] row_mask:0xf bank_mask:0xf
v_exp_f32 v15, v13
s_nop 0
v_cvt_pk_bf16_f32 v14, v14, v15
v_smfmac_f32_16x16x64_bf16 v[40:43], v[76:79], a[120:127], v0
ds_write_b32 v5, v14 offset:14624
s_waitcnt lgkmcnt(1)
s_barrier
ds_read_b64_tr_b16 v[28:29], v4 offset:12288
v_smfmac_f32_16x16x64_bf16 v[36:39], v[60:63], a[128:135], v0
ds_read_b64_tr_b16 v[30:31], v4 offset:12800
ds_read_b64_tr_b16 v[32:33], v4 offset:13312
v_smfmac_f32_16x16x64_bf16 v[40:43], v[60:63], a[136:143], v0
ds_read_b64_tr_b16 v[34:35], v4 offset:13824
v_mov_b64 v[76:77], s[52:53]
v_smfmac_f32_16x16x64_bf16 v[40:43], v[72:75], v[44:51], v0
ds_read_b128 v[44:47], v2 offset:16384
s_waitcnt lgkmcnt(3)
v_mfma_f32_16x16x32_bf16 v[28:31], v[28:31], v[20:23], 0
s_barrier
ds_read_b128 v[16:19], v1 offset:14368
s_waitcnt lgkmcnt(2)
v_mfma_f32_16x16x32_bf16 v[28:31], v[32:35], v[24:27], v[28:31]
ds_read_b128 v[60:63], v1 offset:14336
v_mov_b64 v[14:15], s[0:1]
v_smfmac_f32_16x16x64_bf16 v[40:43], v[64:67], a[152:159], v0
ds_read_b128 v[48:51], v2 offset:17408
v_mov_b64 v[78:79], s[52:53]
v_smfmac_f32_16x16x64_bf16 v[40:43], v[68:71], a[168:175], v0
v_add_f32_dpp v28, v30, v28 quad_perm:[2,3,0,1] row_mask:0xf bank_mask:0xf
v_smfmac_f32_16x16x64_bf16 v[36:39], v[64:67], a[144:151], v0
ds_read_b128 v[64:67], v2 offset:27648
v_mul_f32 v28, s50, v28
v_add_f32_dpp v29, v31, v29 quad_perm:[2,3,0,1] row_mask:0xf bank_mask:0xf
v_smfmac_f32_16x16x64_bf16 v[36:39], v[68:71], a[160:167], v0
ds_read_b128 v[68:71], v2 offset:30720
s_waitcnt lgkmcnt(2)
v_smfmac_f32_16x16x64_bf16 v[36:39], v[72:75], v[44:51], v0
ds_read_b128 v[72:75], v2 offset:31744
v_mul_f32 v29, s50, v29
v_cvt_pk_bf16_f32 v40, v40, v41
v_mfma_f32_16x16x32_bf16 v[32:35], v[76:79], v[16:19], 0
v_exp_f32 v30, v28
ds_read_b128 v[44:47], v2 offset:22528
v_mfma_f32_16x16x32_bf16 v[20:23], v[52:55], v[16:19], 0
v_exp_f32 v31, v29
v_mov_b64 v[76:77], 0
v_mfma_f32_16x16x32_bf16 v[20:23], v[56:59], v[60:63], v[20:23]
v_cvt_pk_bf16_f32 v41, v42, v43
v_cvt_pk_bf16_f32 v43, v38, v39
v_cvt_pk_bf16_f32 v30, v30, v31
v_cndmask_b32_e64 v26, 0, v30, s[56:57]
v_cndmask_b32_e64 v27, 0, v30, s[56:57]
s_nop 0
v_mov_b32_dpp v24, v26 quad_perm:[2,3,0,1] row_mask:0xf bank_mask:0xf
v_mfma_f32_16x16x16_bf16 v[32:35], v[14:15], v[26:27], v[32:35]
v_cvt_pk_bf16_f32 v42, v36, v37
v_mov_b32_dpp v25, v26 quad_perm:[2,3,0,1] row_mask:0xf bank_mask:0xf
s_nop 1
v_mfma_f32_16x16x32_bf16 v[20:23], v[40:43], v[24:27], v[20:23]
ds_read_b128 v[48:51], v2 offset:23552
ds_read_b128 v[60:63], v2 offset:26624
v_mov_b64 v[78:79], 0
v_rcp_f32 v33, v32
v_mov_b64 v[36:37], 0
v_min_f32 v32, v32, v33
v_cmp_nlt_f32 vcc, s2, v32
v_mul_f32_dpp v23, v33, v23 quad_perm:[0,1,0,1] row_mask:0xf bank_mask:0xf
v_mul_f32_dpp v21, v33, v21 quad_perm:[0,1,0,1] row_mask:0xf bank_mask:0xf
v_mul_f32_dpp v22, v33, v22 quad_perm:[0,1,0,1] row_mask:0xf bank_mask:0xf
v_mul_f32_dpp v20, v33, v20 quad_perm:[0,1,0,1] row_mask:0xf bank_mask:0xf
v_cvt_pk_bf16_f32 v20, v20, v21
v_cvt_pk_bf16_f32 v21, v22, v23
ds_write_b64 v6, v[20:21] offset:6144
s_and_b64 vcc, vcc, s[56:57]
v_mov_b32_dpp v19, v21 quad_perm:[2,3,2,3] row_mask:0xf bank_mask:0xf
s_cbranch_scc1 L_mx_w1rs
L_mxb_w1rs:
v_mov_b32_dpp v16, v20 quad_perm:[0,1,0,1] row_mask:0xf bank_mask:0xf
v_mov_b32_dpp v17, v21 quad_perm:[0,1,0,1] row_mask:0xf bank_mask:0xf
v_mov_b64 v[38:39], 0
v_mov_b32_dpp v18, v20 quad_perm:[2,3,2,3] row_mask:0xf bank_mask:0xf
v_mov_b64 v[26:27], 0
v_mov_b64 v[24:25], 0
v_smfmac_f32_16x16x64_bf16 v[76:79], v[16:19], a[176:183], v0
s_waitcnt lgkmcnt(0)
s_barrier
ds_read_b128 v[12:15], v7 offset:8192
v_mov_b64 v[32:33], 0
ds_read_b128 v[52:55], v7 offset:5120
v_smfmac_f32_16x16x64_bf16 v[36:39], v[16:19], v[44:51], v0
ds_read_b128 v[48:51], v2 offset:21504
ds_read_b128 v[44:47], v2 offset:20480
ds_read_b128 v[56:59], v7 offset:7168
v_mov_b64 v[30:31], 0
v_mov_b64 v[34:35], 0
v_smfmac_f32_16x16x64_bf16 v[24:27], v[16:19], v[60:67], v0
v_smfmac_f32_16x16x64_bf16 v[32:35], v[16:19], v[68:75], v0
ds_read_b128 v[68:71], v2 offset:28672
s_waitcnt lgkmcnt(5)
v_smfmac_f32_16x16x64_bf16 v[76:79], v[12:15], a[184:191], v0
ds_read_b128 v[60:63], v2 offset:24576
s_waitcnt lgkmcnt(5)
v_smfmac_f32_16x16x64_bf16 v[76:79], v[52:55], a[192:199], v0
ds_read_b128 v[64:67], v2 offset:25600
s_waitcnt lgkmcnt(3)
v_smfmac_f32_16x16x64_bf16 v[76:79], v[56:59], a[200:207], v0
v_mov_b64 v[28:29], 0
v_smfmac_f32_16x16x64_bf16 v[36:39], v[12:15], a[208:215], v0
ds_read_b128 v[72:75], v2 offset:29696
v_smfmac_f32_16x16x64_bf16 v[36:39], v[52:55], v[44:51], v0
ds_read_b128 v[44:47], v2 offset:34816
v_cvt_pk_bf16_f32 v77, v77, v79
v_cvt_pk_bf16_f32 v76, v76, v78
v_bfi_b32 v76, 1, s35, v76
v_smfmac_f32_16x16x64_bf16 v[36:39], v[56:59], a[216:223], v0
buffer_store_dwordx2 v[76:77], v8, s[4:7], s42 offen sc0 sc1
ds_read_b128 v[48:51], v2 offset:35840
v_smfmac_f32_16x16x64_bf16 v[24:27], v[12:15], a[224:231], v0
s_waitcnt lgkmcnt(3)
v_smfmac_f32_16x16x64_bf16 v[24:27], v[52:55], v[60:67], v0
ds_read_b128 v[60:63], v2 offset:38912
v_cvt_pk_bf16_f32 v37, v37, v39
v_cvt_pk_bf16_f32 v36, v36, v38
v_bfi_b32 v36, 1, s35, v36
v_smfmac_f32_16x16x64_bf16 v[24:27], v[56:59], a[232:239], v0
buffer_store_dwordx2 v[36:37], v8, s[4:7], s43 offen sc0 sc1
ds_read_b128 v[64:67], v2 offset:39936
ds_read_b128 v[40:43], v2 offset:33792
v_smfmac_f32_16x16x64_bf16 v[32:35], v[12:15], a[240:247], v0
s_waitcnt lgkmcnt(5)
v_smfmac_f32_16x16x64_bf16 v[32:35], v[52:55], v[68:75], v0
ds_read_b128 v[72:75], v2 offset:37888
ds_read_b128 v[36:39], v2 offset:32768
v_cvt_pk_bf16_f32 v25, v25, v27
v_cvt_pk_bf16_f32 v24, v24, v26
v_bfi_b32 v24, 1, s35, v24
buffer_store_dwordx2 v[24:25], v8, s[4:7], s44 offen sc0 sc1
v_smfmac_f32_16x16x64_bf16 v[32:35], v[56:59], a[248:255], v0
ds_read_b128 v[68:71], v2 offset:36864
s_waitcnt lgkmcnt(6)
v_smfmac_f32_16x16x64_bf16 v[28:31], v[16:19], v[44:51], v0
s_nop 3
v_cvt_pk_bf16_f32 v33, v33, v35
v_cvt_pk_bf16_f32 v32, v32, v34
v_bfi_b32 v32, 1, s35, v32
buffer_store_dwordx2 v[32:33], v8, s[4:7], s45 offen sc0 sc1
s_waitcnt lgkmcnt(1)
v_smfmac_f32_16x16x64_bf16 v[28:31], v[52:55], v[36:43], v0
v_smfmac_f32_16x16x64_bf16 v[28:31], v[12:15], v[60:67], v0
s_waitcnt lgkmcnt(0)
v_smfmac_f32_16x16x64_bf16 v[28:31], v[56:59], v[68:75], v0
s_nop 7
v_cvt_pk_bf16_f32 v28, v28, v30
v_bfi_b32 v28, 1, s35, v28
v_cvt_pk_bf16_f32 v29, v29, v31
buffer_store_dwordx2 v[28:29], v8, s[4:7], s46 offen sc0 sc1
s_branch L_ex_w1rs
.p2align 6
L_ex_w2rs:
s_add_u32 s34, s34, 1
s_not_b32 s35, s35
s_not_b32 s36, s36
v_and_b32 v6, 0x70, v1
ds_read_b128 v[76:79], v6 offset:256
v_bfe_u32 v11, v1, 4, 2
v_lshrrev_b32_e64 v11, v11, 1
v_bfe_u32 v6, v1, 2, 7
s_mov_b32 m0, 1024
v_mov_b32 v42, s35
s_waitcnt vmcnt(1)
buffer_load_dwordx4 v[60:63], v9, s[4:7], s3 offen offset:0 sc0 sc1
buffer_load_dwordx4 v[64:67], v9, s[4:7], s3 offen offset:1024 sc0 sc1
buffer_load_dwordx4 v[68:71], v9, s[4:7], s3 offen offset:2048 sc0 sc1
buffer_load_dwordx4 v[72:75], v9, s[4:7], s3 offen offset:3072 sc0 sc1
s_barrier
s_waitcnt lgkmcnt(0)
s_waitcnt vmcnt(3)
L_r_w2rs:
v_mfma_f32_16x16x32_bf16 v[36:39], v[60:63], v[76:79], 0
s_waitcnt vmcnt(2)
v_mfma_f32_16x16x32_bf16 v[36:39], v[64:67], v[76:79], v[36:39]
v_bitop3_b32 v40, v60, v64, s36 bitop3:0x7e
s_waitcnt vmcnt(1)
v_mfma_f32_16x16x32_bf16 v[36:39], v[68:71], v[76:79], v[36:39]
s_waitcnt vmcnt(0)
v_mfma_f32_16x16x32_bf16 v[36:39], v[72:75], v[76:79], v[36:39]
v_bitop3_b32 v41, v68, v72, s36 bitop3:0x7e
v_bitop3_b32 v40, v40, v41, 1 bitop3:0xa8
v_cmp_ne_u32 vcc, 0, v40
v_nop
v_nop
v_nop
v_nop
v_nop
v_pk_add_f32 v[36:37], v[36:37], v[38:39]
v_cvt_pk_bf16_f32 v40, v36, v37
v_bfi_b32 v40, v11, s35, v40
s_cbranch_vccnz L_rr_w2rs
buffer_store_dword v40, v10, s[4:7], 0 offen sc0 sc1
s_cmp_eq_u32 s34, 63
v_mov_b32 v11, v40
s_cbranch_scc1 L_done_w2rs
s_mov_b64 exec, 1
buffer_store_dword v42, v1, s[4:7], s33 offen sc0 sc1
s_mov_b64 exec, -1
v_mov_b64 v[20:21], 0
v_mov_b64 v[22:23], 0
v_mov_b64 v[24:25], 0
v_mov_b64 v[26:27], 0
v_mov_b64 v[28:29], 0
v_mov_b64 v[30:31], 0
v_mov_b64 v[32:33], 0
v_mov_b64 v[34:35], 0
v_mov_b64 v[36:37], 0
v_mov_b64 v[38:39], 0
v_mov_b64 v[40:41], 0
v_mov_b64 v[42:43], 0
v_bfe_u32 v77, v1, 6, 1
v_lshl_add_u32 v77, v77, 3, v1
v_lshlrev_b32 v77, 1, v77
v_lshlrev_b32 v78, 3, v1
ds_read_b128 v[44:47], v2 offset:0
ds_read_b128 v[48:51], v2 offset:1024
s_add_u32 s37, s37, 524288
s_mul_i32 s40, s34, 10240
s_add_u32 s40, s40, 8093696
v_mov_b32 v79, s36
L_sp_w2rs:
buffer_load_dword v79, v6, s[4:7], s58 offen sc0 sc1
s_sub_u32 s41, s41, 1
s_cbranch_scc1 L_exit
buffer_load_dwordx4 v1, s[4:7], s47 offen offset:0 sc0 sc1 lds
buffer_load_dwordx4 v1, s[4:7], s47 offen offset:1024 sc0 sc1 lds
buffer_load_dwordx4 v1, s[4:7], s47 offen offset:2048 sc0 sc1 lds
buffer_load_dwordx4 v1, s[4:7], s47 offen offset:3072 sc0 sc1 lds
s_waitcnt vmcnt(4)
v_cmp_ne_u32 vcc, s35, v79
s_cbranch_vccnz L_sp_w2rs
L_top_w2rs:
s_waitcnt vmcnt(3)
s_barrier
ds_read_b128 v[60:63], v1 offset:1024
s_mov_b32 m0, 5120
s_nop 0
buffer_load_dwordx4 v1, s[4:7], s48 offen offset:2048 sc0 sc1 lds
s_waitcnt vmcnt(1)
s_barrier
ds_read_b128 v[64:67], v1 offset:2048
ds_read_b128 v[68:71], v1 offset:3072
ds_read_b128 v[72:75], v1 offset:4096
L_s0_w2rs:
s_waitcnt lgkmcnt(3)
v_smfmac_f32_16x16x64_bf16 v[32:35], v[60:63], v[184:191], v0
v_smfmac_f32_16x16x64_bf16 v[36:39], v[60:63], a[48:55], v0
v_smfmac_f32_16x16x64_bf16 v[20:23], v[60:63], v[44:51], v0
ds_read_b128 v[48:51], v2 offset:3072
v_smfmac_f32_16x16x64_bf16 v[28:31], v[60:63], v[176:183], v0
buffer_load_dwordx4 v[12:15], v9, s[4:7], s37 offen offset:0
v_smfmac_f32_16x16x64_bf16 v[40:43], v[60:63], a[56:63], v0
s_waitcnt lgkmcnt(3)
v_smfmac_f32_16x16x64_bf16 v[28:31], v[64:67], v[192:199], v0
ds_read_b128 v[44:47], v2 offset:2048
v_smfmac_f32_16x16x64_bf16 v[20:23], v[64:67], v[80:87], v0
buffer_load_dwordx4 v[16:19], v9, s[4:7], s37 offen offset:1024
v_smfmac_f32_16x16x64_bf16 v[32:35], v[64:67], v[200:207], v0
v_bitop3_b32 v6, v60, v64, s35 bitop3:0x7e
s_waitcnt lgkmcnt(2)
v_bitop3_b32 v76, v68, v72, s35 bitop3:0x7e
v_smfmac_f32_16x16x64_bf16 v[24:27], v[64:67], v[88:95], v0
buffer_load_dwordx4 v[52:55], v1, s[4:7], s37 offen offset:2048
s_waitcnt lgkmcnt(0)
v_smfmac_f32_16x16x64_bf16 v[24:27], v[60:63], v[44:51], v0
v_smfmac_f32_16x16x64_bf16 v[36:39], v[64:67], a[64:71], v0
v_bitop3_b32 v6, v6, v76, 1 bitop3:0xa8
v_smfmac_f32_16x16x64_bf16 v[40:43], v[64:67], a[72:79], v0
ds_read_b128 v[44:47], v2 offset:4096
v_cmp_ne_u32 vcc, 0, v6
v_smfmac_f32_16x16x64_bf16 v[20:23], v[68:71], v[96:103], v0
buffer_load_dwordx4 v[56:59], v1, s[4:7], s37 offen offset:3072
ds_read_b128 v[48:51], v2 offset:5120
v_smfmac_f32_16x16x64_bf16 v[24:27], v[68:71], v[104:111], v0
s_cbranch_vccnz L_ra0_w2rs
s_waitcnt vmcnt(4)
s_barrier
ds_read_b32 v6, v77 offset:8192
v_smfmac_f32_16x16x64_bf16 v[28:31], v[68:71], v[208:215], v0
ds_read_b128 v[60:63], v1 offset:6144
ds_read_b128 v[64:67], v1 offset:7168
s_waitcnt lgkmcnt(3)
v_smfmac_f32_16x16x64_bf16 v[20:23], v[72:75], v[44:51], v0
ds_read_b128 v[76:79], v1 offset:5120
ds_read_b128 v[44:47], v2 offset:6144
buffer_store_dword v11, v10, s[4:7], s40 offen sc0 sc1
v_smfmac_f32_16x16x64_bf16 v[28:31], v[72:75], v[224:231], v0
v_smfmac_f32_16x16x64_bf16 v[32:35], v[68:71], v[216:223], v0
v_smfmac_f32_16x16x64_bf16 v[36:39], v[68:71], a[80:87], v0
ds_read_b128 v[48:51], v2 offset:7168
s_waitcnt lgkmcnt(4)
v_bitop3_b32 v6, v6, v60, s35 bitop3:0x7e
v_smfmac_f32_16x16x64_bf16 v[40:43], v[68:71], a[88:95], v0
ds_read_b128 v[68:71], v1 offset:8192
v_smfmac_f32_16x16x64_bf16 v[32:35], v[72:75], v[232:239], v0
s_waitcnt lgkmcnt(4)
v_bitop3_b32 v6, v6, v64, s35 bitop3:0xf6
s_waitcnt lgkmcnt(3)
v_bitop3_b32 v6, v6, v76, s35 bitop3:0xf6
v_and_b32 v6, 1, v6
s_waitcnt lgkmcnt(1)
v_smfmac_f32_16x16x64_bf16 v[24:27], v[72:75], v[44:51], v0
ds_read_b128 v[44:47], v2 offset:8192
v_cmp_ne_u32 vcc, 0, v6
v_smfmac_f32_16x16x64_bf16 v[36:39], v[72:75], a[96:103], v0
ds_read_b128 v[48:51], v2 offset:9216
v_smfmac_f32_16x16x64_bf16 v[40:43], v[72:75], a[104:111], v0
ds_read_b128 v[72:75], v1 offset:9216
s_cbranch_vccnz L_ra1_w2rs
L_a1_w2rs:
v_smfmac_f32_16x16x64_bf16 v[20:23], v[60:63], v[112:119], v0
v_smfmac_f32_16x16x64_bf16 v[20:23], v[64:67], v[128:135], v0
s_waitcnt lgkmcnt(1)
v_smfmac_f32_16x16x64_bf16 v[20:23], v[76:79], v[44:51], v0
ds_read_b128 v[48:51], v2 offset:11264
v_bfe_u32 v6, v1, 5, 1
v_mad_i32_i24 v6, v6, s55, v1
v_smfmac_f32_16x16x64_bf16 v[20:23], v[68:71], v[144:151], v0
s_waitcnt lgkmcnt(1)
v_smfmac_f32_16x16x64_bf16 v[20:23], v[72:75], v[160:167], v0
ds_read_b128 v[44:47], v2 offset:10240
v_smfmac_f32_16x16x64_bf16 v[24:27], v[60:63], v[120:127], v0
v_smfmac_f32_16x16x64_bf16 v[24:27], v[64:67], v[136:143], v0
v_smfmac_f32_16x16x64_bf16 v[24:27], v[68:71], v[152:159], v0
v_add_f32 v21, v21, v23
v_smfmac_f32_16x16x64_bf16 v[24:27], v[72:75], v[168:175], v0
s_waitcnt lgkmcnt(0)
v_smfmac_f32_16x16x64_bf16 v[24:27], v[76:79], v[44:51], v0
ds_read_b128 v[44:47], v2 offset:12288
v_add_f32 v20, v20, v22
v_cvt_pk_bf16_f32 v22, v20, v21
v_smfmac_f32_16x16x64_bf16 v[28:31], v[76:79], v[240:247], v0
ds_read_b128 v[48:51], v2 offset:13312
v_smfmac_f32_16x16x64_bf16 v[28:31], v[64:67], a[0:7], v0
v_add_f32 v25, v25, v27
v_add_f32 v24, v24, v26
v_cvt_pk_bf16_f32 v23, v24, v25
v_smfmac_f32_16x16x64_bf16 v[28:31], v[72:75], a[32:39], v0
ds_write_b64 v3, v[22:23] offset:11264
v_smfmac_f32_16x16x64_bf16 v[32:35], v[76:79], v[248:255], v0
s_waitcnt lgkmcnt(1)
v_smfmac_f32_16x16x64_bf16 v[28:31], v[60:63], v[44:51], v0
ds_read_b128 v[48:51], v2 offset:15360
v_smfmac_f32_16x16x64_bf16 v[28:31], v[68:71], a[16:23], v0
ds_read_b128 v[44:47], v2 offset:14336
s_waitcnt vmcnt(1)
v_smfmac_f32_16x16x64_bf16 v[32:35], v[64:67], a[8:15], v0
s_waitcnt lgkmcnt(2)
s_barrier
ds_read_b64_tr_b16 v[20:21], v4 offset:10240
v_smfmac_f32_16x16x64_bf16 v[32:35], v[68:71], a[24:31], v0
ds_read_b64_tr_b16 v[22:23], v4 offset:10752
v_add_f32 v29, v29, v31
v_smfmac_f32_16x16x64_bf16 v[32:35], v[72:75], a[40:47], v0
ds_read_b64_tr_b16 v[24:25], v4 offset:11264
ds_read_b64_tr_b16 v[26:27], v4 offset:11776
s_waitcnt lgkmcnt(4)
v_smfmac_f32_16x16x64_bf16 v[32:35], v[60:63], v[44:51], v0
ds_read_b128 v[48:51], v2 offset:19456
s_waitcnt lgkmcnt(3)
v_mfma_f32_16x16x32_bf16 v[12:15], v[12:15], v[20:23], 0
ds_read_b128 v[44:47], v2 offset:18432
v_add_f32 v28, v28, v30
s_waitcnt lgkmcnt(2)
v_mfma_f32_16x16x32_bf16 v[12:15], v[16:19], v[24:27], v[12:15]
v_add_f32 v33, v33, v35
v_add_f32 v32, v32, v34
v_cvt_pk_bf16_f32 v30, v28, v29
v_cvt_pk_bf16_f32 v31, v32, v33
v_smfmac_f32_16x16x64_bf16 v[36:39], v[76:79], a[112:119], v0
ds_write_b64 v3, v[30:31] offset:13312
v_add_f32_dpp v12, v14, v12 quad_perm:[2,3,0,1] row_mask:0xf bank_mask:0xf
v_exp_f32 v14, v12
v_add_f32_dpp v13, v15, v13 quad_perm:[2,3,0,1] row_mask:0xf bank_mask:0xf
v_exp_f32 v15, v13
s_nop 0
v_cvt_pk_bf16_f32 v14, v14, v15
v_smfmac_f32_16x16x64_bf16 v[40:43], v[76:79], a[120:127], v0
ds_write_b32 v5, v14 offset:14880
s_waitcnt lgkmcnt(2)
v_smfmac_f32_16x16x64_bf16 v[40:43], v[72:75], v[44:51], v0
ds_read_b128 v[44:47], v2 offset:16384
s_waitcnt lgkmcnt(2)
s_barrier
ds_read_b64_tr_b16 v[28:29], v4 offset:12288
v_smfmac_f32_16x16x64_bf16 v[36:39], v[60:63], a[128:135], v0
ds_read_b64_tr_b16 v[30:31], v4 offset:12800
ds_read_b64_tr_b16 v[32:33], v4 offset:13312
v_smfmac_f32_16x16x64_bf16 v[40:43], v[60:63], a[136:143], v0
ds_read_b64_tr_b16 v[34:35], v4 offset:13824
v_mov_b64 v[76:77], s[52:53]
s_waitcnt lgkmcnt(2)
v_mfma_f32_16x16x32_bf16 v[28:31], v[28:31], v[20:23], 0
s_barrier
ds_read_b128 v[16:19], v1 offset:14368
s_waitcnt lgkmcnt(1)
v_mfma_f32_16x16x32_bf16 v[28:31], v[32:35], v[24:27], v[28:31]
ds_read_b128 v[60:63], v1 offset:14336
v_mov_b64 v[14:15], s[0:1]
v_smfmac_f32_16x16x64_bf16 v[40:43], v[64:67], a[152:159], v0
ds_read_b128 v[48:51], v2 offset:17408
v_mov_b64 v[78:79], s[52:53]
v_smfmac_f32_16x16x64_bf16 v[40:43], v[68:71], a[168:175], v0
v_add_f32_dpp v28, v30, v28 quad_perm:[2,3,0,1] row_mask:0xf bank_mask:0xf
v_mul_f32 v28, s50, v28
v_smfmac_f32_16x16x64_bf16 v[36:39], v[64:67], a[144:151], v0
ds_read_b128 v[64:67], v2 offset:23552
v_add_f32_dpp v29, v31, v29 quad_perm:[2,3,0,1] row_mask:0xf bank_mask:0xf
v_smfmac_f32_16x16x64_bf16 v[36:39], v[68:71], a[160:167], v0
ds_read_b128 v[68:71], v2 offset:24576
s_waitcnt lgkmcnt(2)
v_smfmac_f32_16x16x64_bf16 v[36:39], v[72:75], v[44:51], v0
ds_read_b128 v[72:75], v2 offset:25600
v_cvt_pk_bf16_f32 v40, v40, v41
v_mfma_f32_16x16x32_bf16 v[32:35], v[76:79], v[16:19], 0
ds_read_b128 v[44:47], v2 offset:20480
v_mul_f32 v29, s50, v29
v_exp_f32 v30, v28
v_mfma_f32_16x16x32_bf16 v[20:23], v[52:55], v[16:19], 0
v_exp_f32 v31, v29
v_cvt_pk_bf16_f32 v41, v42, v43
v_cvt_pk_bf16_f32 v43, v38, v39
v_mov_b64 v[76:77], 0
v_mfma_f32_16x16x32_bf16 v[20:23], v[56:59], v[60:63], v[20:23]
v_cvt_pk_bf16_f32 v30, v30, v31
v_cndmask_b32_e64 v26, 0, v30, s[56:57]
v_cndmask_b32_e64 v27, 0, v30, s[56:57]
s_nop 0
v_mov_b32_dpp v24, v26 quad_perm:[2,3,0,1] row_mask:0xf bank_mask:0xf
v_mfma_f32_16x16x16_bf16 v[32:35], v[14:15], v[26:27], v[32:35]
v_cvt_pk_bf16_f32 v42, v36, v37
v_mov_b32_dpp v25, v26 quad_perm:[2,3,0,1] row_mask:0xf bank_mask:0xf
s_nop 1
v_mfma_f32_16x16x32_bf16 v[20:23], v[40:43], v[24:27], v[20:23]
ds_read_b128 v[60:63], v2 offset:22528
ds_read_b128 v[48:51], v2 offset:21504
v_rcp_f32 v33, v32
v_mov_b64 v[36:37], 0
v_mov_b64 v[78:79], 0
v_min_f32 v32, v32, v33
v_cmp_nlt_f32 vcc, s2, v32
v_mul_f32_dpp v23, v33, v23 quad_perm:[0,1,0,1] row_mask:0xf bank_mask:0xf
v_mul_f32_dpp v21, v33, v21 quad_perm:[0,1,0,1] row_mask:0xf bank_mask:0xf
v_mul_f32_dpp v22, v33, v22 quad_perm:[0,1,0,1] row_mask:0xf bank_mask:0xf
v_mul_f32_dpp v20, v33, v20 quad_perm:[0,1,0,1] row_mask:0xf bank_mask:0xf
v_cvt_pk_bf16_f32 v20, v20, v21
v_cvt_pk_bf16_f32 v21, v22, v23
ds_write_b64 v6, v[20:21] offset:7168
s_and_b64 vcc, vcc, s[56:57]
v_mov_b32_dpp v16, v20 quad_perm:[0,1,0,1] row_mask:0xf bank_mask:0xf
v_mov_b32_dpp v19, v21 quad_perm:[2,3,2,3] row_mask:0xf bank_mask:0xf
s_cbranch_scc1 L_mx_w2rs
L_mxb_w2rs:
v_mov_b32_dpp v18, v20 quad_perm:[2,3,2,3] row_mask:0xf bank_mask:0xf
v_mov_b64 v[38:39], 0
v_mov_b32_dpp v17, v21 quad_perm:[0,1,0,1] row_mask:0xf bank_mask:0xf
v_mov_b64 v[26:27], 0
v_mov_b64 v[24:25], 0
v_mov_b64 v[32:33], 0
v_smfmac_f32_16x16x64_bf16 v[76:79], v[16:19], a[176:183], v0
s_waitcnt lgkmcnt(0)
s_barrier
ds_read_b128 v[12:15], v7 offset:5120
ds_read_b128 v[52:55], v7 offset:8192
v_smfmac_f32_16x16x64_bf16 v[36:39], v[16:19], a[184:191], v0
ds_read_b128 v[56:59], v7 offset:6144
v_mov_b64 v[34:35], 0
v_smfmac_f32_16x16x64_bf16 v[24:27], v[16:19], a[192:199], v0
v_smfmac_f32_16x16x64_bf16 v[32:35], v[16:19], a[200:207], v0
s_waitcnt lgkmcnt(2)
v_smfmac_f32_16x16x64_bf16 v[76:79], v[12:15], a[208:215], v0
s_waitcnt lgkmcnt(1)
v_smfmac_f32_16x16x64_bf16 v[76:79], v[52:55], a[216:223], v0
s_waitcnt lgkmcnt(0)
v_smfmac_f32_16x16x64_bf16 v[76:79], v[56:59], a[224:231], v0
v_smfmac_f32_16x16x64_bf16 v[36:39], v[12:15], v[44:51], v0
ds_read_b128 v[48:51], v2 offset:27648
ds_read_b128 v[44:47], v2 offset:26624
v_smfmac_f32_16x16x64_bf16 v[36:39], v[52:55], a[232:239], v0
v_cvt_pk_bf16_f32 v77, v77, v79
v_cvt_pk_bf16_f32 v76, v76, v78
v_bfi_b32 v76, 1, s35, v76
v_smfmac_f32_16x16x64_bf16 v[36:39], v[56:59], v[60:67], v0
buffer_store_dwordx2 v[76:77], v8, s[4:7], s42 offen sc0 sc1
ds_read_b128 v[60:63], v2 offset:28672
v_smfmac_f32_16x16x64_bf16 v[24:27], v[12:15], v[68:75], v0
ds_read_b128 v[64:67], v2 offset:29696
v_smfmac_f32_16x16x64_bf16 v[24:27], v[52:55], a[240:247], v0
ds_read_b128 v[68:71], v2 offset:30720
v_cvt_pk_bf16_f32 v36, v36, v38
v_bfi_b32 v36, 1, s35, v36
v_cvt_pk_bf16_f32 v37, v37, v39
s_waitcnt lgkmcnt(3)
v_smfmac_f32_16x16x64_bf16 v[24:27], v[56:59], v[44:51], v0
buffer_store_dwordx2 v[36:37], v8, s[4:7], s43 offen sc0 sc1
ds_read_b128 v[72:75], v2 offset:31744
v_smfmac_f32_16x16x64_bf16 v[32:35], v[52:55], a[248:255], v0
s_waitcnt lgkmcnt(2)
v_smfmac_f32_16x16x64_bf16 v[32:35], v[12:15], v[60:67], v0
v_cvt_pk_bf16_f32 v25, v25, v27
v_cvt_pk_bf16_f32 v24, v24, v26
v_bfi_b32 v24, 1, s35, v24
buffer_store_dwordx2 v[24:25], v8, s[4:7], s44 offen sc0 sc1
s_waitcnt lgkmcnt(0)
v_smfmac_f32_16x16x64_bf16 v[32:35], v[56:59], v[68:75], v0
s_nop 7
v_cvt_pk_bf16_f32 v33, v33, v35
v_cvt_pk_bf16_f32 v32, v32, v34
v_bfi_b32 v32, 1, s35, v32
buffer_store_dwordx2 v[32:33], v8, s[4:7], s45 offen sc0 sc1
s_branch L_ex_w2rs
.p2align 6
L_ex_w3s:
s_add_u32 s34, s34, 1
s_not_b32 s35, s35
s_not_b32 s36, s36
s_add_u32 s37, s37, 524288
s_add_u32 s39, s39, 524288
v_mov_b64 v[20:21], 0
v_mov_b64 v[22:23], 0
v_mov_b64 v[24:25], 0
v_mov_b64 v[26:27], 0
v_mov_b64 v[28:29], 0
v_mov_b64 v[30:31], 0
v_mov_b64 v[32:33], 0
v_mov_b64 v[34:35], 0
v_mov_b64 v[36:37], 0
v_mov_b64 v[38:39], 0
v_mov_b64 v[40:41], 0
v_mov_b64 v[42:43], 0
ds_read_b128 v[44:47], v2 offset:0
ds_read_b128 v[48:51], v2 offset:1024
v_bfe_u32 v77, v1, 6, 1
v_lshl_add_u32 v77, v77, 3, v1
v_lshlrev_b32 v77, 1, v77
v_lshlrev_b32 v78, 3, v1
s_barrier
s_cmp_eq_u32 s34, 63
s_cbranch_scc1 L_done_w3s
s_add_u32 s100, s34, 1
s_lshr_b32 s100, s100, 2
s_waitcnt vmcnt(4)
L_evb_w3s:
v_cmp_ge_u32 vcc, s100, v10
s_cbranch_vccnz L_ev_w3s
L_top_w3s:
s_barrier
ds_read_b128 v[60:63], v1 offset:1024
s_mov_b32 m0, 5120
s_nop 0
buffer_load_dwordx4 v1, s[4:7], s48 offen offset:3072 sc0 sc1 lds
s_barrier
ds_read_b128 v[64:67], v1 offset:2048
ds_read_b128 v[68:71], v1 offset:3072
ds_read_b128 v[72:75], v1 offset:4096
L_s0_w3s:
s_waitcnt lgkmcnt(3)
v_smfmac_f32_16x16x64_bf16 v[32:35], v[60:63], v[184:191], v0
s_mov_b32 m0, 9216
s_nop 0
buffer_load_dwordx4 v1, s[4:7], s49 offen offset:0 sc0 sc1 lds
v_smfmac_f32_16x16x64_bf16 v[20:23], v[60:63], v[44:51], v0
v_smfmac_f32_16x16x64_bf16 v[28:31], v[60:63], v[176:183], v0
s_waitcnt lgkmcnt(2)
v_smfmac_f32_16x16x64_bf16 v[28:31], v[64:67], v[192:199], v0
ds_read_b128 v[48:51], v2 offset:3072
v_smfmac_f32_16x16x64_bf16 v[36:39], v[60:63], a[48:55], v0
ds_read_b128 v[44:47], v2 offset:2048
v_smfmac_f32_16x16x64_bf16 v[40:43], v[60:63], a[56:63], v0
buffer_load_dwordx4 v[12:15], v9, s[4:7], s37 offen offset:0
v_smfmac_f32_16x16x64_bf16 v[24:27], v[64:67], v[88:95], v0
v_smfmac_f32_16x16x64_bf16 v[20:23], v[64:67], v[80:87], v0
v_bitop3_b32 v6, v60, v64, s35 bitop3:0x7e
v_smfmac_f32_16x16x64_bf16 v[32:35], v[64:67], v[200:207], v0
buffer_load_dwordx4 v[16:19], v9, s[4:7], s37 offen offset:1024
s_waitcnt lgkmcnt(0)
v_smfmac_f32_16x16x64_bf16 v[24:27], v[60:63], v[44:51], v0
v_bitop3_b32 v76, v68, v72, s35 bitop3:0x7e
v_bitop3_b32 v6, v6, v76, 1 bitop3:0xa8
v_smfmac_f32_16x16x64_bf16 v[36:39], v[64:67], a[64:71], v0
v_cmp_ne_u32 vcc, 0, v6
v_smfmac_f32_16x16x64_bf16 v[40:43], v[64:67], a[72:79], v0
buffer_load_dwordx4 v[52:55], v1, s[4:7], s37 offen offset:2048
ds_read_b128 v[44:47], v2 offset:4096
v_smfmac_f32_16x16x64_bf16 v[20:23], v[68:71], v[96:103], v0
ds_read_b128 v[48:51], v2 offset:5120
buffer_load_dwordx4 v[56:59], v1, s[4:7], s37 offen offset:3072
s_mov_b32 m0, 0
v_smfmac_f32_16x16x64_bf16 v[24:27], v[68:71], v[104:111], v0
s_cbranch_vccnz L_ra0_w3s
s_waitcnt vmcnt(4)
s_barrier
ds_read_b32 v6, v77 offset:8192
v_smfmac_f32_16x16x64_bf16 v[28:31], v[68:71], v[208:215], v0
buffer_load_dword v78, s[4:7], s39 offen lds
buffer_load_dword v10, v11, s[4:7], s101 offen sc1
v_smfmac_f32_16x16x64_bf16 v[36:39], v[68:71], a[80:87], v0
ds_read_b128 v[60:63], v1 offset:6144
v_smfmac_f32_16x16x64_bf16 v[28:31], v[72:75], v[224:231], v0
ds_read_b128 v[76:79], v1 offset:5120
s_waitcnt lgkmcnt(3)
v_smfmac_f32_16x16x64_bf16 v[20:23], v[72:75], v[44:51], v0
ds_read_b128 v[64:67], v1 offset:7168
v_smfmac_f32_16x16x64_bf16 v[32:35], v[68:71], v[216:223], v0
ds_read_b128 v[44:47], v2 offset:6144
v_smfmac_f32_16x16x64_bf16 v[40:43], v[68:71], a[88:95], v0
ds_read_b128 v[48:51], v2 offset:7168
s_waitcnt lgkmcnt(4)
v_bitop3_b32 v6, v6, v60, s35 bitop3:0x7e
ds_read_b128 v[68:71], v1 offset:8192
v_smfmac_f32_16x16x64_bf16 v[32:35], v[72:75], v[232:239], v0
s_waitcnt lgkmcnt(3)
v_bitop3_b32 v6, v6, v64, s35 bitop3:0xf6
v_bitop3_b32 v6, v6, v76, s35 bitop3:0xf6
v_and_b32 v6, 1, v6
s_waitcnt lgkmcnt(1)
v_smfmac_f32_16x16x64_bf16 v[24:27], v[72:75], v[44:51], v0
ds_read_b128 v[44:47], v2 offset:8192
v_cmp_ne_u32 vcc, 0, v6
v_smfmac_f32_16x16x64_bf16 v[36:39], v[72:75], a[96:103], v0
ds_read_b128 v[48:51], v2 offset:9216
v_smfmac_f32_16x16x64_bf16 v[40:43], v[72:75], a[104:111], v0
ds_read_b128 v[72:75], v1 offset:9216
s_cbranch_vccnz L_ra1_w3s
L_a1_w3s:
v_smfmac_f32_16x16x64_bf16 v[20:23], v[60:63], v[112:119], v0
v_smfmac_f32_16x16x64_bf16 v[20:23], v[64:67], v[128:135], v0
s_waitcnt lgkmcnt(1)
v_smfmac_f32_16x16x64_bf16 v[20:23], v[76:79], v[44:51], v0
ds_read_b128 v[48:51], v2 offset:11264
v_bfe_u32 v6, v1, 5, 1
v_mad_i32_i24 v6, v6, s55, v1
v_smfmac_f32_16x16x64_bf16 v[20:23], v[68:71], v[144:151], v0
s_waitcnt lgkmcnt(1)
v_smfmac_f32_16x16x64_bf16 v[20:23], v[72:75], v[160:167], v0
v_smfmac_f32_16x16x64_bf16 v[24:27], v[60:63], v[120:127], v0
ds_read_b128 v[44:47], v2 offset:10240
v_smfmac_f32_16x16x64_bf16 v[24:27], v[64:67], v[136:143], v0
v_smfmac_f32_16x16x64_bf16 v[24:27], v[68:71], v[152:159], v0
v_add_f32 v21, v21, v23
v_smfmac_f32_16x16x64_bf16 v[24:27], v[72:75], v[168:175], v0
s_waitcnt lgkmcnt(0)
v_smfmac_f32_16x16x64_bf16 v[24:27], v[76:79], v[44:51], v0
ds_read_b128 v[44:47], v2 offset:12288
v_add_f32 v20, v20, v22
v_cvt_pk_bf16_f32 v22, v20, v21
v_smfmac_f32_16x16x64_bf16 v[28:31], v[76:79], v[240:247], v0
ds_read_b128 v[48:51], v2 offset:13312
v_smfmac_f32_16x16x64_bf16 v[28:31], v[64:67], a[0:7], v0
v_add_f32 v25, v25, v27
v_add_f32 v24, v24, v26
v_cvt_pk_bf16_f32 v23, v24, v25
v_smfmac_f32_16x16x64_bf16 v[28:31], v[72:75], a[32:39], v0
ds_write_b64 v3, v[22:23] offset:11776
v_smfmac_f32_16x16x64_bf16 v[32:35], v[76:79], v[248:255], v0
s_waitcnt lgkmcnt(1)
v_smfmac_f32_16x16x64_bf16 v[28:31], v[60:63], v[44:51], v0
ds_read_b128 v[48:51], v2 offset:15360
v_smfmac_f32_16x16x64_bf16 v[28:31], v[68:71], a[16:23], v0
ds_read_b128 v[44:47], v2 offset:14336
s_waitcnt vmcnt(2)
v_smfmac_f32_16x16x64_bf16 v[32:35], v[64:67], a[8:15], v0
s_waitcnt lgkmcnt(2)
s_barrier
v_smfmac_f32_16x16x64_bf16 v[32:35], v[68:71], a[24:31], v0
ds_read_b64_tr_b16 v[20:21], v4 offset:10240
ds_read_b64_tr_b16 v[22:23], v4 offset:10752
v_add_f32 v29, v29, v31
v_smfmac_f32_16x16x64_bf16 v[32:35], v[72:75], a[40:47], v0
ds_read_b64_tr_b16 v[24:25], v4 offset:11264
ds_read_b64_tr_b16 v[26:27], v4 offset:11776
s_waitcnt lgkmcnt(4)
v_smfmac_f32_16x16x64_bf16 v[32:35], v[60:63], v[44:51], v0
ds_read_b128 v[48:51], v2 offset:19456
s_waitcnt lgkmcnt(3)
v_mfma_f32_16x16x32_bf16 v[12:15], v[12:15], v[20:23], 0
ds_read_b128 v[44:47], v2 offset:18432
v_add_f32 v28, v28, v30
s_waitcnt lgkmcnt(2)
v_mfma_f32_16x16x32_bf16 v[12:15], v[16:19], v[24:27], v[12:15]
v_add_f32 v32, v32, v34
v_add_f32 v33, v33, v35
v_cvt_pk_bf16_f32 v30, v28, v29
v_cvt_pk_bf16_f32 v31, v32, v33
v_smfmac_f32_16x16x64_bf16 v[36:39], v[76:79], a[112:119], v0
ds_write_b64 v3, v[30:31] offset:13824
v_add_f32_dpp v12, v14, v12 quad_perm:[2,3,0,1] row_mask:0xf bank_mask:0xf
v_exp_f32 v14, v12
v_add_f32_dpp v13, v15, v13 quad_perm:[2,3,0,1] row_mask:0xf bank_mask:0xf
v_exp_f32 v15, v13
s_nop 0
v_cvt_pk_bf16_f32 v14, v14, v15
v_smfmac_f32_16x16x64_bf16 v[40:43], v[76:79], a[120:127], v0
ds_write_b32 v5, v14 offset:15136
s_waitcnt lgkmcnt(1)
s_barrier
ds_read_b64_tr_b16 v[28:29], v4 offset:12288
v_smfmac_f32_16x16x64_bf16 v[36:39], v[60:63], a[128:135], v0
ds_read_b64_tr_b16 v[30:31], v4 offset:12800
ds_read_b64_tr_b16 v[32:33], v4 offset:13312
v_smfmac_f32_16x16x64_bf16 v[40:43], v[60:63], a[136:143], v0
ds_read_b64_tr_b16 v[34:35], v4 offset:13824
v_mov_b64 v[76:77], s[52:53]
v_smfmac_f32_16x16x64_bf16 v[40:43], v[72:75], v[44:51], v0
ds_read_b128 v[44:47], v2 offset:16384
s_waitcnt lgkmcnt(3)
v_mfma_f32_16x16x32_bf16 v[28:31], v[28:31], v[20:23], 0
s_barrier
ds_read_b128 v[16:19], v1 offset:14368
s_waitcnt lgkmcnt(2)
v_mfma_f32_16x16x32_bf16 v[28:31], v[32:35], v[24:27], v[28:31]
ds_read_b128 v[60:63], v1 offset:14336
v_mov_b64 v[14:15], s[0:1]
v_smfmac_f32_16x16x64_bf16 v[40:43], v[64:67], a[152:159], v0
ds_read_b128 v[48:51], v2 offset:17408
v_mov_b64 v[78:79], s[52:53]
v_smfmac_f32_16x16x64_bf16 v[40:43], v[68:71], a[168:175], v0
v_add_f32_dpp v28, v30, v28 quad_perm:[2,3,0,1] row_mask:0xf bank_mask:0xf
v_mul_f32 v28, s50, v28
v_smfmac_f32_16x16x64_bf16 v[36:39], v[64:67], a[144:151], v0
ds_read_b128 v[64:67], v2 offset:21504
v_add_f32_dpp v29, v31, v29 quad_perm:[2,3,0,1] row_mask:0xf bank_mask:0xf
v_smfmac_f32_16x16x64_bf16 v[36:39], v[68:71], a[160:167], v0
ds_read_b128 v[68:71], v2 offset:26624
s_waitcnt lgkmcnt(2)
v_smfmac_f32_16x16x64_bf16 v[36:39], v[72:75], v[44:51], v0
ds_read_b128 v[72:75], v2 offset:27648
v_cvt_pk_bf16_f32 v40, v40, v41
v_exp_f32 v30, v28
v_mfma_f32_16x16x32_bf16 v[32:35], v[76:79], v[16:19], 0
ds_read_b128 v[44:47], v2 offset:22528
v_mul_f32 v29, s50, v29
v_mfma_f32_16x16x32_bf16 v[20:23], v[52:55], v[16:19], 0
v_exp_f32 v31, v29
v_mfma_f32_16x16x32_bf16 v[20:23], v[56:59], v[60:63], v[20:23]
v_cvt_pk_bf16_f32 v41, v42, v43
v_cvt_pk_bf16_f32 v30, v30, v31
v_cndmask_b32_e64 v26, 0, v30, s[56:57]
v_cvt_pk_bf16_f32 v43, v38, v39
v_cndmask_b32_e64 v27, 0, v30, s[56:57]
v_mov_b32_dpp v24, v26 quad_perm:[2,3,0,1] row_mask:0xf bank_mask:0xf
v_mov_b64 v[76:77], 0
v_mfma_f32_16x16x16_bf16 v[32:35], v[14:15], v[26:27], v[32:35]
v_cvt_pk_bf16_f32 v42, v36, v37
v_mov_b32_dpp v25, v26 quad_perm:[2,3,0,1] row_mask:0xf bank_mask:0xf
s_nop 1
v_mfma_f32_16x16x32_bf16 v[20:23], v[40:43], v[24:27], v[20:23]
ds_read_b128 v[48:51], v2 offset:23552
s_nop 0
v_rcp_f32 v33, v32
ds_read_b128 v[60:63], v2 offset:20480
v_mov_b64 v[36:37], 0
v_min_f32 v32, v32, v33
v_cmp_nlt_f32 vcc, s2, v32
v_mov_b64 v[78:79], 0
v_mul_f32_dpp v23, v33, v23 quad_perm:[0,1,0,1] row_mask:0xf bank_mask:0xf
v_mul_f32_dpp v21, v33, v21 quad_perm:[0,1,0,1] row_mask:0xf bank_mask:0xf
v_mul_f32_dpp v22, v33, v22 quad_perm:[0,1,0,1] row_mask:0xf bank_mask:0xf
v_mul_f32_dpp v20, v33, v20 quad_perm:[0,1,0,1] row_mask:0xf bank_mask:0xf
v_cvt_pk_bf16_f32 v20, v20, v21
v_cvt_pk_bf16_f32 v21, v22, v23
ds_write_b64 v6, v[20:21] offset:8192
s_and_b64 vcc, vcc, s[56:57]
v_mov_b64 v[38:39], 0
s_cbranch_scc1 L_mx_w3s
L_mxb_w3s:
v_mov_b32_dpp v16, v20 quad_perm:[0,1,0,1] row_mask:0xf bank_mask:0xf
v_mov_b32_dpp v19, v21 quad_perm:[2,3,2,3] row_mask:0xf bank_mask:0xf
v_mov_b64 v[24:25], 0
v_mov_b32_dpp v18, v20 quad_perm:[2,3,2,3] row_mask:0xf bank_mask:0xf
v_mov_b32_dpp v17, v21 quad_perm:[0,1,0,1] row_mask:0xf bank_mask:0xf
v_mov_b64 v[26:27], 0
v_mov_b64 v[32:33], 0
v_smfmac_f32_16x16x64_bf16 v[76:79], v[16:19], a[176:183], v0
s_waitcnt lgkmcnt(0)
s_barrier
ds_read_b128 v[12:15], v7 offset:6144
ds_read_b128 v[52:55], v7 offset:7168
v_smfmac_f32_16x16x64_bf16 v[36:39], v[16:19], a[184:191], v0
ds_read_b128 v[56:59], v7 offset:5120
v_mov_b64 v[34:35], 0
s_nop 1
v_smfmac_f32_16x16x64_bf16 v[32:35], v[16:19], a[200:207], v0
v_smfmac_f32_16x16x64_bf16 v[24:27], v[16:19], a[192:199], v0
s_waitcnt lgkmcnt(2)
v_smfmac_f32_16x16x64_bf16 v[76:79], v[12:15], a[208:215], v0
s_waitcnt lgkmcnt(1)
v_smfmac_f32_16x16x64_bf16 v[76:79], v[52:55], a[216:223], v0
s_waitcnt lgkmcnt(0)
v_smfmac_f32_16x16x64_bf16 v[76:79], v[56:59], a[224:231], v0
v_smfmac_f32_16x16x64_bf16 v[36:39], v[12:15], v[44:51], v0
ds_read_b128 v[48:51], v2 offset:25600
ds_read_b128 v[44:47], v2 offset:24576
v_smfmac_f32_16x16x64_bf16 v[36:39], v[52:55], a[232:239], v0
v_cvt_pk_bf16_f32 v77, v77, v79
v_cvt_pk_bf16_f32 v76, v76, v78
v_bfi_b32 v76, 1, s35, v76
v_smfmac_f32_16x16x64_bf16 v[36:39], v[56:59], v[60:67], v0
buffer_store_dwordx2 v[76:77], v8, s[4:7], s42 offen sc0 sc1
ds_read_b128 v[60:63], v2 offset:30720
v_smfmac_f32_16x16x64_bf16 v[24:27], v[12:15], v[68:75], v0
ds_read_b128 v[64:67], v2 offset:31744
v_smfmac_f32_16x16x64_bf16 v[24:27], v[52:55], a[240:247], v0
ds_read_b128 v[68:71], v2 offset:28672
v_cvt_pk_bf16_f32 v36, v36, v38
v_bfi_b32 v36, 1, s35, v36
v_cvt_pk_bf16_f32 v37, v37, v39
s_waitcnt lgkmcnt(3)
v_smfmac_f32_16x16x64_bf16 v[24:27], v[56:59], v[44:51], v0
buffer_store_dwordx2 v[36:37], v8, s[4:7], s43 offen sc0 sc1
ds_read_b128 v[72:75], v2 offset:29696
s_nop 5
v_cvt_pk_bf16_f32 v25, v25, v27
v_cvt_pk_bf16_f32 v24, v24, v26
v_bfi_b32 v24, 1, s35, v24
v_smfmac_f32_16x16x64_bf16 v[32:35], v[52:55], a[248:255], v0
s_waitcnt lgkmcnt(2)
v_smfmac_f32_16x16x64_bf16 v[32:35], v[12:15], v[60:67], v0
buffer_store_dwordx2 v[24:25], v8, s[4:7], s44 offen sc0 sc1
s_waitcnt lgkmcnt(0)
v_smfmac_f32_16x16x64_bf16 v[32:35], v[56:59], v[68:75], v0
s_nop 7
v_cvt_pk_bf16_f32 v33, v33, v35
v_cvt_pk_bf16_f32 v32, v32, v34
v_bfi_b32 v32, 1, s35, v32
buffer_store_dwordx2 v[32:33], v8, s[4:7], s45 offen sc0 sc1
s_branch L_ex_w3s
L_pro_w2r:
v_and_b32 v20, 63, v0
v_lshlrev_b32 v1, 4, v20
v_add_u32 v2, 98304, v1
v_and_b32 v23, 1, v22
v_lshl_add_u32 v23, v24, 4, v23
v_mul_u32_u24 v23, 1152, v23
v_lshlrev_b32 v28, 2, v22
v_xor_b32 v28, v28, v21
v_lshl_add_u32 v28, v28, 4, v23
s_mul_i32 s55, s32, 147456
s_waitcnt lgkmcnt(0)
v_and_b32 v23, 1, v22
v_lshrrev_b32 v24, 2, v21
v_lshl_add_u32 v23, v23, 2, v24
v_lshlrev_b32 v23, 1, v23
v_bfe_u32 v44, v21, 1, 1
v_add_u32 v44, 8, v44
v_xor_b32 v44, v44, v23
v_lshlrev_b32 v44, 4, v44
v_lshl_add_u32 v44, v24, 8, v44
v_and_b32 v23, 1, v22
v_lshl_add_u32 v44, v23, 11, v44
v_and_b32 v23, 1, v21
v_lshl_add_u32 v44, v23, 3, v44
v_lshrrev_b32 v23, 1, v22
v_mul_u32_u24 v23, 40960, v23
v_add_u32 v23, 16384, v23
v_add_u32 v44, v44, v23
v_and_b32 v23, 1, v22
v_lshrrev_b32 v24, 2, v21
v_lshl_add_u32 v23, v23, 2, v24
v_lshlrev_b32 v23, 1, v23
v_bfe_u32 v45, v21, 1, 1
v_add_u32 v45, 10, v45
v_xor_b32 v45, v45, v23
v_lshlrev_b32 v45, 4, v45
v_lshl_add_u32 v45, v24, 8, v45
v_and_b32 v23, 1, v22
v_lshl_add_u32 v45, v23, 11, v45
v_and_b32 v23, 1, v21
v_lshl_add_u32 v45, v23, 3, v45
v_lshrrev_b32 v23, 1, v22
v_mul_u32_u24 v23, 40960, v23
v_add_u32 v23, 16384, v23
v_add_u32 v45, v45, v23
v_and_b32 v23, 1, v22
v_lshrrev_b32 v24, 2, v21
v_lshl_add_u32 v23, v23, 2, v24
v_lshlrev_b32 v23, 1, v23
v_bfe_u32 v46, v21, 1, 1
v_add_u32 v46, 8, v46
v_xor_b32 v46, v46, v23
v_lshlrev_b32 v46, 4, v46
v_lshl_add_u32 v46, v24, 8, v46
v_and_b32 v23, 1, v22
v_lshl_add_u32 v46, v23, 11, v46
v_and_b32 v23, 1, v21
v_lshl_add_u32 v46, v23, 3, v46
v_lshrrev_b32 v23, 1, v22
v_mul_u32_u24 v23, 32768, v23
v_add_u32 v23, 98304, v23
v_add_u32 v46, v46, v23
v_and_b32 v23, 1, v22
v_lshrrev_b32 v24, 2, v21
v_lshl_add_u32 v23, v23, 2, v24
v_lshlrev_b32 v23, 1, v23
v_bfe_u32 v47, v21, 1, 1
v_add_u32 v47, 10, v47
v_xor_b32 v47, v47, v23
v_lshlrev_b32 v47, 4, v47
v_lshl_add_u32 v47, v24, 8, v47
v_and_b32 v23, 1, v22
v_lshl_add_u32 v47, v23, 11, v47
v_and_b32 v23, 1, v21
v_lshl_add_u32 v47, v23, 3, v47
v_lshrrev_b32 v23, 1, v22
v_mul_u32_u24 v23, 32768, v23
v_add_u32 v23, 98304, v23
v_add_u32 v47, v47, v23
v_and_b32 v23, 1, v22
v_bfe_u32 v24, v21, 2, 1
v_lshl_add_u32 v23, v23, 1, v24
v_xor_b32 v24, 2, v23
v_lshlrev_b32 v24, 6, v24
v_lshl_add_u32 v48, v23, 8, v24
v_and_b32 v23, 3, v21
v_lshl_add_u32 v48, v23, 4, v48
v_and_b32 v23, 8, v21
v_add_u32 v48, v48, v23
v_lshrrev_b32 v23, 1, v22
v_mul_u32_u24 v23, 40960, v23
v_add_u32 v23, 16384, v23
v_add_u32 v48, v48, v23
v_and_b32 v23, 1, v22
v_bfe_u32 v24, v21, 2, 1
v_lshl_add_u32 v23, v23, 1, v24
v_xor_b32 v24, 2, v23
v_lshlrev_b32 v24, 6, v24
v_lshl_add_u32 v49, v23, 8, v24
v_and_b32 v23, 3, v21
v_lshl_add_u32 v49, v23, 4, v49
v_and_b32 v23, 8, v21
v_add_u32 v49, v49, v23
v_lshrrev_b32 v23, 1, v22
v_mul_u32_u24 v23, 32768, v23
v_add_u32 v23, 98304, v23
v_add_u32 v49, v49, v23
v_bfe_u32 v23, v21, 1, 1
v_mul_u32_u24 v23, 0xaaaa, v23
v_add_u32 v0, 0x4444, v23
v_lshlrev_b32 v3, 3, v20
v_lshrrev_b32 v25, 5, v20
v_lshlrev_b32 v25, 6, v25
v_xor_b32 v3, v3, v25
v_lshrrev_b32 v25, 2, v20
v_and_b32 v4, 3, v21
v_lshl_add_u32 v4, v4, 4, v25
v_lshlrev_b32 v4, 3, v4
v_bfe_u32 v25, v21, 1, 1
v_lshlrev_b32 v23, 6, v25
v_xor_b32 v4, v4, v23
v_lshlrev_b32 v5, 4, v21
v_lshl_add_u32 v5, v22, 2, v5
v_mul_u32_u24 v23, 512, v25
v_add_u32 v5, v5, v23
v_lshlrev_b32 v9, 8, v22
v_lshl_add_u32 v9, v25, 6, v9
v_bfe_u32 v23, v21, 3, 1
v_lshl_add_u32 v9, v23, 7, v9
v_bfe_u32 v23, v21, 2, 1
v_lshl_add_u32 v9, v23, 5, v9
v_and_b32 v23, 1, v21
v_lshl_add_u32 v9, v23, 4, v9
v_lshrrev_b32 v23, 1, v22
v_and_b32 v24, 1, v22
v_and_b32 v25, 7, v21
v_lshrrev_b32 v7, 3, v21
v_lshl_add_u32 v8, v7, 1, v23
v_lshlrev_b32 v8, 12, v8
v_lshl_add_u32 v8, v24, 7, v8
v_and_b32 v25, 4, v21
v_lshl_add_u32 v8, v25, 3, v8
v_and_b32 v25, 1, v21
v_lshl_add_u32 v8, v25, 4, v8
v_bfe_u32 v25, v21, 1, 1
v_lshl_add_u32 v8, v25, 3, v8
s_lshr_b32 s56, s32, 1
s_lshl_b32 s56, s56, 8
s_and_b32 s57, s32, 1
s_lshl_b32 s57, s57, 6
s_add_u32 s56, s56, s57
s_add_u32 s56, s56, 32768
v_add_u32 v8, s56, v8
v_and_b32 v7, 0x3d0, v1
s_mov_b32 s42, 0
s_mov_b32 s43, 65536
s_mov_b32 s44, 131072
s_mov_b32 s45, 196608
s_mov_b32 s46, 262144
s_mov_b32 s47, 294912
s_mov_b32 s48, 299008
s_mov_b32 s49, 303104
s_mov_b32 s50, 0x3e0293ee
s_mov_b32 s51, 0x3e0293ee
s_mov_b32 s52, 0x3f803f80
s_mov_b32 s53, 0x3f803f80
v_lshlrev_b32 v11, 2, v21
s_mov_b32 s34, 0
s_mov_b32 s35, -1
s_mov_b32 s36, 0
s_mov_b32 s41, 300000
s_lshl_b32 s37, s32, 14
s_add_u32 s39, s37, 17301504
s_add_u32 s37, s37, 16785408
s_mov_b32 s40, 8749056
v_mov_b64 v[36:37], 0
v_mov_b64 v[38:39], 0
s_lshl_b32 s56, s32, 1
s_add_u32 s56, s56, 1
s_cmp_eq_u32 s56, 0
s_cselect_b32 s56, 64, s56
s_mul_i32 s56, s56, 10240
s_add_u32 s56, s56, 8388608
s_add_u32 s57, s56, 4096
v_mov_b32 v40, 1
v_mov_b32 v41, 1
v_mov_b32 v42, 1
v_mov_b32 v43, 1
buffer_store_dwordx4 v[40:43], v1, s[4:7], s56 offen offset:0 sc0 sc1
buffer_store_dwordx4 v[40:43], v1, s[4:7], s56 offen offset:1024 sc0 sc1
buffer_store_dwordx4 v[40:43], v1, s[4:7], s56 offen offset:2048 sc0 sc1
buffer_store_dwordx4 v[40:43], v1, s[4:7], s56 offen offset:3072 sc0 sc1
s_add_u32 s56, s32, 0
s_lshl_b32 s3, s56, 12
v_and_b32 v23, 1, v21
v_bfe_u32 v24, v21, 2, 1
v_bfe_u32 v25, v21, 1, 1
s_lshl_b32 s57, s56, 7
s_add_u32 s57, s57, 294912
v_and_b32 v10, 7, v21
v_lshlrev_b32 v10, 2, v10
v_lshl_add_u32 v10, v22, 5, v10
v_add_u32 v10, s57, v10
s_lshl_b32 s33, s56, 2
s_add_u32 s33, s33, 304128
v_mov_b32 v30, -1
s_mov_b64 exec, 1
buffer_store_dword v30, v1, s[4:7], s33 offen sc0 sc1
s_mov_b64 exec, -1
v_lshl_add_u32 v23, v23, 1, v24
v_lshlrev_b32 v25, 4, v25
v_mov_b32 v24, 0x3f80
v_lshlrev_b32 v24, v25, v24
v_cmp_eq_u32 vcc, 0, v23
s_nop 1
v_cndmask_b32 v76, 0, v24, vcc
v_cmp_eq_u32 vcc, 1, v23
s_nop 1
v_cndmask_b32 v77, 0, v24, vcc
v_cmp_eq_u32 vcc, 2, v23
s_nop 1
v_cndmask_b32 v78, 0, v24, vcc
v_cmp_eq_u32 vcc, 3, v23
s_nop 1
v_cndmask_b32 v79, 0, v24, vcc
v_and_b32 v23, 0x70, v1
ds_write_b128 v23, v[76:79] offset:256
buffer_store_dwordx4 v[36:39], v9, s[4:7], s3 offen offset:0 sc0 sc1
buffer_store_dwordx4 v[36:39], v9, s[4:7], s3 offen offset:1024 sc0 sc1
buffer_store_dwordx4 v[36:39], v9, s[4:7], s3 offen offset:2048 sc0 sc1
buffer_store_dwordx4 v[36:39], v9, s[4:7], s3 offen offset:3072 sc0 sc1
s_getreg_b32 s56, hwreg(HW_REG_XCC_ID)
s_and_b32 s56, s56, 15
s_mul_i32 s57, s56, s56
s_lshl_b32 s57, s57, 18
s_lshl_b32 s56, s56, 8
s_add_u32 s57, s57, s56
s_add_u32 s58, s57, 1
s_lshl_b32 s101, s32, 7
s_add_u32 s101, s101, 327680
v_mov_b32 v24, 0
s_add_u32 s56, s54, 262144
s_mov_b32 m0, 110592
s_nop 0
buffer_load_dwordx4 v26, s[12:15], s56 offen lds
s_add_u32 s56, s54, 278528
s_mov_b32 m0, 111616
s_nop 0
buffer_load_dwordx4 v26, s[12:15], s56 offen lds
s_add_u32 s56, s54, 294912
s_mov_b32 m0, 112640
s_nop 0
buffer_load_dwordx4 v27, s[12:15], s56 offen lds
s_add_u32 s56, s54, 311296
s_mov_b32 m0, 113664
s_nop 0
buffer_load_dwordx4 v27, s[12:15], s56 offen lds
s_add_u32 s56, s54, 786432
s_mov_b32 m0, 114688
s_nop 0
buffer_load_dwordx4 v26, s[12:15], s56 offen lds
s_add_u32 s56, s54, 802816
s_mov_b32 m0, 115712
s_nop 0
buffer_load_dwordx4 v26, s[12:15], s56 offen lds
s_add_u32 s56, s54, 819200
s_mov_b32 m0, 116736
s_nop 0
buffer_load_dwordx4 v27, s[12:15], s56 offen lds
s_add_u32 s56, s54, 835584
s_mov_b32 m0, 117760
s_nop 0
buffer_load_dwordx4 v27, s[12:15], s56 offen lds
v_mov_b32 v24, 0
s_waitcnt vmcnt(37)
s_barrier
ds_read_b64_tr_b16 v[80:81], v44 offset:20480
ds_read_b64_tr_b16 v[82:83], v44 offset:21504
ds_read_b64_tr_b16 v[84:85], v46 offset:20480
ds_read_b64_tr_b16 v[86:87], v46 offset:21504
ds_read_b64_tr_b16 v[88:89], v45 offset:20480
ds_read_b64_tr_b16 v[90:91], v45 offset:21504
ds_read_b64_tr_b16 v[92:93], v47 offset:20480
ds_read_b64_tr_b16 v[94:95], v47 offset:21504
s_waitcnt lgkmcnt(0)
s_waitcnt vmcnt(33)
s_barrier
s_add_u32 s56, s54, 1310720
s_mov_b32 m0, 118784
s_nop 0
buffer_load_dwordx4 v26, s[12:15], s56 offen lds
s_add_u32 s56, s54, 1327104
s_mov_b32 m0, 119808
s_nop 0
buffer_load_dwordx4 v26, s[12:15], s56 offen lds
s_add_u32 s56, s54, 1343488
s_mov_b32 m0, 120832
s_nop 0
buffer_load_dwordx4 v27, s[12:15], s56 offen lds
s_add_u32 s56, s54, 1359872
s_mov_b32 m0, 121856
s_nop 0
buffer_load_dwordx4 v27, s[12:15], s56 offen lds
ds_read_b64_tr_b16 v[96:97], v44 offset:24576
ds_read_b64_tr_b16 v[98:99], v44 offset:25600
ds_read_b64_tr_b16 v[100:101], v46 offset:24576
ds_read_b64_tr_b16 v[102:103], v46 offset:25600
ds_read_b64_tr_b16 v[104:105], v45 offset:24576
ds_read_b64_tr_b16 v[106:107], v45 offset:25600
ds_read_b64_tr_b16 v[108:109], v47 offset:24576
ds_read_b64_tr_b16 v[110:111], v47 offset:25600
s_waitcnt lgkmcnt(0)
s_waitcnt vmcnt(33)
s_barrier
s_add_u32 s56, s54, 1835008
s_mov_b32 m0, 122880
s_nop 0
buffer_load_dwordx4 v26, s[12:15], s56 offen lds
s_add_u32 s56, s54, 1851392
s_mov_b32 m0, 123904
s_nop 0
buffer_load_dwordx4 v26, s[12:15], s56 offen lds
s_add_u32 s56, s54, 1867776
s_mov_b32 m0, 124928
s_nop 0
buffer_load_dwordx4 v27, s[12:15], s56 offen lds
s_add_u32 s56, s54, 1884160
s_mov_b32 m0, 125952
s_nop 0
buffer_load_dwordx4 v27, s[12:15], s56 offen lds
ds_read_b64_tr_b16 v[112:113], v44 offset:28672
ds_read_b64_tr_b16 v[114:115], v44 offset:29696
ds_read_b64_tr_b16 v[116:117], v46 offset:28672
ds_read_b64_tr_b16 v[118:119], v46 offset:29696
ds_read_b64_tr_b16 v[120:121], v45 offset:28672
ds_read_b64_tr_b16 v[122:123], v45 offset:29696
ds_read_b64_tr_b16 v[124:125], v47 offset:28672
ds_read_b64_tr_b16 v[126:127], v47 offset:29696
s_waitcnt lgkmcnt(0)
s_waitcnt vmcnt(33)
s_barrier
s_add_u32 s56, s54, 2359296
s_mov_b32 m0, 126976
s_nop 0
buffer_load_dwordx4 v26, s[12:15], s56 offen lds
s_add_u32 s56, s54, 2375680
s_mov_b32 m0, 128000
s_nop 0
buffer_load_dwordx4 v26, s[12:15], s56 offen lds
s_add_u32 s56, s54, 2392064
s_mov_b32 m0, 129024
s_nop 0
buffer_load_dwordx4 v27, s[12:15], s56 offen lds
s_add_u32 s56, s54, 2408448
s_mov_b32 m0, 130048
s_nop 0
buffer_load_dwordx4 v27, s[12:15], s56 offen lds
ds_read_b64_tr_b16 v[128:129], v44 offset:0
ds_read_b64_tr_b16 v[130:131], v44 offset:1024
ds_read_b64_tr_b16 v[132:133], v46 offset:0
ds_read_b64_tr_b16 v[134:135], v46 offset:1024
ds_read_b64_tr_b16 v[136:137], v45 offset:0
ds_read_b64_tr_b16 v[138:139], v45 offset:1024
ds_read_b64_tr_b16 v[140:141], v47 offset:0
ds_read_b64_tr_b16 v[142:143], v47 offset:1024
s_waitcnt lgkmcnt(0)
s_waitcnt vmcnt(33)
s_barrier
s_add_u32 s56, s54, 3407872
s_mov_b32 m0, 98304
s_nop 0
buffer_load_dwordx4 v26, s[12:15], s56 offen lds
s_add_u32 s56, s54, 3424256
s_mov_b32 m0, 99328
s_nop 0
buffer_load_dwordx4 v26, s[12:15], s56 offen lds
s_add_u32 s56, s54, 3440640
s_mov_b32 m0, 100352
s_nop 0
buffer_load_dwordx4 v27, s[12:15], s56 offen lds
s_add_u32 s56, s54, 3457024
s_mov_b32 m0, 101376
s_nop 0
buffer_load_dwordx4 v27, s[12:15], s56 offen lds
ds_read_b64_tr_b16 v[144:145], v44 offset:4096
ds_read_b64_tr_b16 v[146:147], v44 offset:5120
ds_read_b64_tr_b16 v[148:149], v46 offset:4096
ds_read_b64_tr_b16 v[150:151], v46 offset:5120
ds_read_b64_tr_b16 v[152:153], v45 offset:4096
ds_read_b64_tr_b16 v[154:155], v45 offset:5120
ds_read_b64_tr_b16 v[156:157], v47 offset:4096
ds_read_b64_tr_b16 v[158:159], v47 offset:5120
s_waitcnt lgkmcnt(0)
s_waitcnt vmcnt(33)
s_barrier
s_add_u32 s56, s54, 3932160
s_mov_b32 m0, 102400
s_nop 0
buffer_load_dwordx4 v26, s[12:15], s56 offen lds
s_add_u32 s56, s54, 3948544
s_mov_b32 m0, 103424
s_nop 0
buffer_load_dwordx4 v26, s[12:15], s56 offen lds
s_add_u32 s56, s54, 3964928
s_mov_b32 m0, 104448
s_nop 0
buffer_load_dwordx4 v27, s[12:15], s56 offen lds
s_add_u32 s56, s54, 3981312
s_mov_b32 m0, 105472
s_nop 0
buffer_load_dwordx4 v27, s[12:15], s56 offen lds
ds_read_b64_tr_b16 v[160:161], v44 offset:8192
ds_read_b64_tr_b16 v[162:163], v44 offset:9216
ds_read_b64_tr_b16 v[164:165], v46 offset:8192
ds_read_b64_tr_b16 v[166:167], v46 offset:9216
ds_read_b64_tr_b16 v[168:169], v45 offset:8192
ds_read_b64_tr_b16 v[170:171], v45 offset:9216
ds_read_b64_tr_b16 v[172:173], v47 offset:8192
ds_read_b64_tr_b16 v[174:175], v47 offset:9216
s_waitcnt lgkmcnt(0)
s_waitcnt vmcnt(24)
s_barrier
s_add_u32 s56, s54, 4456448
s_mov_b32 m0, 106496
s_nop 0
buffer_load_dwordx4 v26, s[12:15], s56 offen lds
s_add_u32 s56, s54, 4472832
s_mov_b32 m0, 107520
s_nop 0
buffer_load_dwordx4 v26, s[12:15], s56 offen lds
s_add_u32 s56, s54, 4489216
s_mov_b32 m0, 108544
s_nop 0
buffer_load_dwordx4 v27, s[12:15], s56 offen lds
s_add_u32 s56, s54, 4505600
s_mov_b32 m0, 109568
s_nop 0
buffer_load_dwordx4 v27, s[12:15], s56 offen lds
ds_read_b64_tr_b16 v[176:177], v44 offset:12288
ds_read_b64_tr_b16 v[178:179], v44 offset:13312
ds_read_b64_tr_b16 v[180:181], v46 offset:12288
ds_read_b64_tr_b16 v[182:183], v46 offset:13312
ds_read_b64_tr_b16 v[184:185], v45 offset:12288
ds_read_b64_tr_b16 v[186:187], v45 offset:13312
ds_read_b64_tr_b16 v[188:189], v47 offset:12288
ds_read_b64_tr_b16 v[190:191], v47 offset:13312
s_waitcnt lgkmcnt(0)
s_waitcnt vmcnt(24)
s_barrier
s_add_u32 s56, s54, 262144
s_mov_b32 m0, 110592
s_nop 0
buffer_load_dwordx4 v26, s[16:19], s56 offen lds
s_add_u32 s56, s54, 278528
s_mov_b32 m0, 111616
s_nop 0
buffer_load_dwordx4 v26, s[16:19], s56 offen lds
s_add_u32 s56, s54, 294912
s_mov_b32 m0, 112640
s_nop 0
buffer_load_dwordx4 v27, s[16:19], s56 offen lds
s_add_u32 s56, s54, 311296
s_mov_b32 m0, 113664
s_nop 0
buffer_load_dwordx4 v27, s[16:19], s56 offen lds
ds_read_b64_tr_b16 v[192:193], v44 offset:16384
ds_read_b64_tr_b16 v[194:195], v44 offset:17408
ds_read_b64_tr_b16 v[196:197], v46 offset:16384
ds_read_b64_tr_b16 v[198:199], v46 offset:17408
ds_read_b64_tr_b16 v[200:201], v45 offset:16384
ds_read_b64_tr_b16 v[202:203], v45 offset:17408
ds_read_b64_tr_b16 v[204:205], v47 offset:16384
ds_read_b64_tr_b16 v[206:207], v47 offset:17408
s_waitcnt lgkmcnt(0)
s_waitcnt vmcnt(24)
s_barrier
s_add_u32 s56, s54, 786432
s_mov_b32 m0, 114688
s_nop 0
buffer_load_dwordx4 v26, s[16:19], s56 offen lds
s_add_u32 s56, s54, 802816
s_mov_b32 m0, 115712
s_nop 0
buffer_load_dwordx4 v26, s[16:19], s56 offen lds
s_add_u32 s56, s54, 819200
s_mov_b32 m0, 116736
s_nop 0
buffer_load_dwordx4 v27, s[16:19], s56 offen lds
s_add_u32 s56, s54, 835584
s_mov_b32 m0, 117760
s_nop 0
buffer_load_dwordx4 v27, s[16:19], s56 offen lds
ds_read_b64_tr_b16 v[208:209], v44 offset:20480
ds_read_b64_tr_b16 v[210:211], v44 offset:21504
ds_read_b64_tr_b16 v[212:213], v46 offset:20480
ds_read_b64_tr_b16 v[214:215], v46 offset:21504
ds_read_b64_tr_b16 v[216:217], v45 offset:20480
ds_read_b64_tr_b16 v[218:219], v45 offset:21504
ds_read_b64_tr_b16 v[220:221], v47 offset:20480
ds_read_b64_tr_b16 v[222:223], v47 offset:21504
s_waitcnt lgkmcnt(0)
s_waitcnt vmcnt(24)
s_barrier
s_add_u32 s56, s54, 1310720
s_mov_b32 m0, 118784
s_nop 0
buffer_load_dwordx4 v26, s[16:19], s56 offen lds
s_add_u32 s56, s54, 1327104
s_mov_b32 m0, 119808
s_nop 0
buffer_load_dwordx4 v26, s[16:19], s56 offen lds
s_add_u32 s56, s54, 1343488
s_mov_b32 m0, 120832
s_nop 0
buffer_load_dwordx4 v27, s[16:19], s56 offen lds
s_add_u32 s56, s54, 1359872
s_mov_b32 m0, 121856
s_nop 0
buffer_load_dwordx4 v27, s[16:19], s56 offen lds
ds_read_b64_tr_b16 v[224:225], v44 offset:24576
ds_read_b64_tr_b16 v[226:227], v44 offset:25600
ds_read_b64_tr_b16 v[228:229], v46 offset:24576
ds_read_b64_tr_b16 v[230:231], v46 offset:25600
ds_read_b64_tr_b16 v[232:233], v45 offset:24576
ds_read_b64_tr_b16 v[234:235], v45 offset:25600
ds_read_b64_tr_b16 v[236:237], v47 offset:24576
ds_read_b64_tr_b16 v[238:239], v47 offset:25600
s_waitcnt lgkmcnt(0)
s_waitcnt vmcnt(24)
s_barrier
s_add_u32 s56, s54, 1835008
s_mov_b32 m0, 122880
s_nop 0
buffer_load_dwordx4 v26, s[16:19], s56 offen lds
s_add_u32 s56, s54, 1851392
s_mov_b32 m0, 123904
s_nop 0
buffer_load_dwordx4 v26, s[16:19], s56 offen lds
s_add_u32 s56, s54, 1867776
s_mov_b32 m0, 124928
s_nop 0
buffer_load_dwordx4 v27, s[16:19], s56 offen lds
s_add_u32 s56, s54, 1884160
s_mov_b32 m0, 125952
s_nop 0
buffer_load_dwordx4 v27, s[16:19], s56 offen lds
ds_read_b64_tr_b16 v[240:241], v44 offset:28672
ds_read_b64_tr_b16 v[242:243], v44 offset:29696
ds_read_b64_tr_b16 v[244:245], v46 offset:28672
ds_read_b64_tr_b16 v[246:247], v46 offset:29696
ds_read_b64_tr_b16 v[248:249], v45 offset:28672
ds_read_b64_tr_b16 v[250:251], v45 offset:29696
ds_read_b64_tr_b16 v[252:253], v47 offset:28672
ds_read_b64_tr_b16 v[254:255], v47 offset:29696
s_waitcnt lgkmcnt(0)
s_waitcnt vmcnt(24)
s_barrier
s_add_u32 s56, s54, 2359296
s_mov_b32 m0, 126976
s_nop 0
buffer_load_dwordx4 v26, s[16:19], s56 offen lds
s_add_u32 s56, s54, 2375680
s_mov_b32 m0, 128000
s_nop 0
buffer_load_dwordx4 v26, s[16:19], s56 offen lds
s_add_u32 s56, s54, 2392064
s_mov_b32 m0, 129024
s_nop 0
buffer_load_dwordx4 v27, s[16:19], s56 offen lds
s_add_u32 s56, s54, 2408448
s_mov_b32 m0, 130048
s_nop 0
buffer_load_dwordx4 v27, s[16:19], s56 offen lds
ds_read_b64_tr_b16 a[0:1], v44 offset:0
ds_read_b64_tr_b16 a[2:3], v44 offset:1024
ds_read_b64_tr_b16 a[4:5], v46 offset:0
ds_read_b64_tr_b16 a[6:7], v46 offset:1024
ds_read_b64_tr_b16 a[8:9], v45 offset:0
ds_read_b64_tr_b16 a[10:11], v45 offset:1024
ds_read_b64_tr_b16 a[12:13], v47 offset:0
ds_read_b64_tr_b16 a[14:15], v47 offset:1024
s_waitcnt lgkmcnt(0)
s_waitcnt vmcnt(24)
s_barrier
s_add_u32 s56, s54, 2883584
s_mov_b32 m0, 98304
s_nop 0
buffer_load_dwordx4 v26, s[16:19], s56 offen lds
s_add_u32 s56, s54, 2899968
s_mov_b32 m0, 99328
s_nop 0
buffer_load_dwordx4 v26, s[16:19], s56 offen lds
s_add_u32 s56, s54, 2916352
s_mov_b32 m0, 100352
s_nop 0
buffer_load_dwordx4 v27, s[16:19], s56 offen lds
s_add_u32 s56, s54, 2932736
s_mov_b32 m0, 101376
s_nop 0
buffer_load_dwordx4 v27, s[16:19], s56 offen lds
ds_read_b64_tr_b16 a[16:17], v44 offset:4096
ds_read_b64_tr_b16 a[18:19], v44 offset:5120
ds_read_b64_tr_b16 a[20:21], v46 offset:4096
ds_read_b64_tr_b16 a[22:23], v46 offset:5120
ds_read_b64_tr_b16 a[24:25], v45 offset:4096
ds_read_b64_tr_b16 a[26:27], v45 offset:5120
ds_read_b64_tr_b16 a[28:29], v47 offset:4096
ds_read_b64_tr_b16 a[30:31], v47 offset:5120
s_waitcnt lgkmcnt(0)
s_waitcnt vmcnt(24)
s_barrier
s_add_u32 s56, s54, 3407872
s_mov_b32 m0, 102400
s_nop 0
buffer_load_dwordx4 v26, s[16:19], s56 offen lds
s_add_u32 s56, s54, 3424256
s_mov_b32 m0, 103424
s_nop 0
buffer_load_dwordx4 v26, s[16:19], s56 offen lds
s_add_u32 s56, s54, 3440640
s_mov_b32 m0, 104448
s_nop 0
buffer_load_dwordx4 v27, s[16:19], s56 offen lds
s_add_u32 s56, s54, 3457024
s_mov_b32 m0, 105472
s_nop 0
buffer_load_dwordx4 v27, s[16:19], s56 offen lds
ds_read_b64_tr_b16 a[32:33], v44 offset:8192
ds_read_b64_tr_b16 a[34:35], v44 offset:9216
ds_read_b64_tr_b16 a[36:37], v46 offset:8192
ds_read_b64_tr_b16 a[38:39], v46 offset:9216
ds_read_b64_tr_b16 a[40:41], v45 offset:8192
ds_read_b64_tr_b16 a[42:43], v45 offset:9216
ds_read_b64_tr_b16 a[44:45], v47 offset:8192
ds_read_b64_tr_b16 a[46:47], v47 offset:9216
s_waitcnt lgkmcnt(0)
s_waitcnt vmcnt(24)
s_barrier
s_add_u32 s56, s54, 3932160
s_mov_b32 m0, 106496
s_nop 0
buffer_load_dwordx4 v26, s[16:19], s56 offen lds
s_add_u32 s56, s54, 3948544
s_mov_b32 m0, 107520
s_nop 0
buffer_load_dwordx4 v26, s[16:19], s56 offen lds
s_add_u32 s56, s54, 3964928
s_mov_b32 m0, 108544
s_nop 0
buffer_load_dwordx4 v27, s[16:19], s56 offen lds
s_add_u32 s56, s54, 3981312
s_mov_b32 m0, 109568
s_nop 0
buffer_load_dwordx4 v27, s[16:19], s56 offen lds
ds_read_b64_tr_b16 a[48:49], v44 offset:12288
ds_read_b64_tr_b16 a[50:51], v44 offset:13312
ds_read_b64_tr_b16 a[52:53], v46 offset:12288
ds_read_b64_tr_b16 a[54:55], v46 offset:13312
ds_read_b64_tr_b16 a[56:57], v45 offset:12288
ds_read_b64_tr_b16 a[58:59], v45 offset:13312
ds_read_b64_tr_b16 a[60:61], v47 offset:12288
ds_read_b64_tr_b16 a[62:63], v47 offset:13312
s_waitcnt lgkmcnt(0)
s_waitcnt vmcnt(24)
s_barrier
s_add_u32 s56, s55, 110592
s_mov_b32 m0, 110592
s_nop 0
buffer_load_dwordx4 v28, s[20:23], s56 offen lds
s_add_u32 s56, s55, 112896
s_mov_b32 m0, 111616
s_nop 0
buffer_load_dwordx4 v28, s[20:23], s56 offen lds
s_add_u32 s56, s55, 119808
s_mov_b32 m0, 112640
s_nop 0
buffer_load_dwordx4 v28, s[20:23], s56 offen lds
s_add_u32 s56, s55, 122112
s_mov_b32 m0, 113664
s_nop 0
buffer_load_dwordx4 v28, s[20:23], s56 offen lds
ds_read_b64_tr_b16 a[64:65], v44 offset:16384
ds_read_b64_tr_b16 a[66:67], v44 offset:17408
ds_read_b64_tr_b16 a[68:69], v46 offset:16384
ds_read_b64_tr_b16 a[70:71], v46 offset:17408
ds_read_b64_tr_b16 a[72:73], v45 offset:16384
ds_read_b64_tr_b16 a[74:75], v45 offset:17408
ds_read_b64_tr_b16 a[76:77], v47 offset:16384
ds_read_b64_tr_b16 a[78:79], v47 offset:17408
s_waitcnt lgkmcnt(0)
s_waitcnt vmcnt(24)
s_barrier
s_add_u32 s56, s55, 110848
s_mov_b32 m0, 114688
s_nop 0
buffer_load_dwordx4 v28, s[20:23], s56 offen lds
s_add_u32 s56, s55, 113152
s_mov_b32 m0, 115712
s_nop 0
buffer_load_dwordx4 v28, s[20:23], s56 offen lds
s_add_u32 s56, s55, 120064
s_mov_b32 m0, 116736
s_nop 0
buffer_load_dwordx4 v28, s[20:23], s56 offen lds
s_add_u32 s56, s55, 122368
s_mov_b32 m0, 117760
s_nop 0
buffer_load_dwordx4 v28, s[20:23], s56 offen lds
ds_read_b64_tr_b16 a[80:81], v44 offset:20480
ds_read_b64_tr_b16 a[82:83], v44 offset:21504
ds_read_b64_tr_b16 a[84:85], v46 offset:20480
ds_read_b64_tr_b16 a[86:87], v46 offset:21504
ds_read_b64_tr_b16 a[88:89], v45 offset:20480
ds_read_b64_tr_b16 a[90:91], v45 offset:21504
ds_read_b64_tr_b16 a[92:93], v47 offset:20480
ds_read_b64_tr_b16 a[94:95], v47 offset:21504
s_waitcnt lgkmcnt(0)
s_waitcnt vmcnt(24)
s_barrier
s_add_u32 s56, s55, 111104
s_mov_b32 m0, 118784
s_nop 0
buffer_load_dwordx4 v28, s[20:23], s56 offen lds
s_add_u32 s56, s55, 113408
s_mov_b32 m0, 119808
s_nop 0
buffer_load_dwordx4 v28, s[20:23], s56 offen lds
s_add_u32 s56, s55, 120320
s_mov_b32 m0, 120832
s_nop 0
buffer_load_dwordx4 v28, s[20:23], s56 offen lds
s_add_u32 s56, s55, 122624
s_mov_b32 m0, 121856
s_nop 0
buffer_load_dwordx4 v28, s[20:23], s56 offen lds
ds_read_b64_tr_b16 a[96:97], v44 offset:24576
ds_read_b64_tr_b16 a[98:99], v44 offset:25600
ds_read_b64_tr_b16 a[100:101], v46 offset:24576
ds_read_b64_tr_b16 a[102:103], v46 offset:25600
ds_read_b64_tr_b16 a[104:105], v45 offset:24576
ds_read_b64_tr_b16 a[106:107], v45 offset:25600
ds_read_b64_tr_b16 a[108:109], v47 offset:24576
ds_read_b64_tr_b16 a[110:111], v47 offset:25600
s_waitcnt lgkmcnt(0)
s_waitcnt vmcnt(24)
s_barrier
s_add_u32 s56, s55, 111360
s_mov_b32 m0, 122880
s_nop 0
buffer_load_dwordx4 v28, s[20:23], s56 offen lds
s_add_u32 s56, s55, 113664
s_mov_b32 m0, 123904
s_nop 0
buffer_load_dwordx4 v28, s[20:23], s56 offen lds
s_add_u32 s56, s55, 120576
s_mov_b32 m0, 124928
s_nop 0
buffer_load_dwordx4 v28, s[20:23], s56 offen lds
s_add_u32 s56, s55, 122880
s_mov_b32 m0, 125952
s_nop 0
buffer_load_dwordx4 v28, s[20:23], s56 offen lds
ds_read_b64_tr_b16 a[112:113], v44 offset:28672
ds_read_b64_tr_b16 a[114:115], v44 offset:29696
ds_read_b64_tr_b16 a[116:117], v46 offset:28672
ds_read_b64_tr_b16 a[118:119], v46 offset:29696
ds_read_b64_tr_b16 a[120:121], v45 offset:28672
ds_read_b64_tr_b16 a[122:123], v45 offset:29696
ds_read_b64_tr_b16 a[124:125], v47 offset:28672
ds_read_b64_tr_b16 a[126:127], v47 offset:29696
s_waitcnt lgkmcnt(0)
s_waitcnt vmcnt(24)
s_barrier
s_add_u32 s56, s55, 36864
s_mov_b32 m0, 126976
s_nop 0
buffer_load_dwordx4 v28, s[20:23], s56 offen lds
s_add_u32 s56, s55, 39168
s_mov_b32 m0, 128000
s_nop 0
buffer_load_dwordx4 v28, s[20:23], s56 offen lds
s_add_u32 s56, s55, 46080
s_mov_b32 m0, 129024
s_nop 0
buffer_load_dwordx4 v28, s[20:23], s56 offen lds
s_add_u32 s56, s55, 48384
s_mov_b32 m0, 130048
s_nop 0
buffer_load_dwordx4 v28, s[20:23], s56 offen lds
ds_read_b64_tr_b16 a[128:129], v44 offset:0
ds_read_b64_tr_b16 a[130:131], v44 offset:1024
ds_read_b64_tr_b16 a[132:133], v46 offset:0
ds_read_b64_tr_b16 a[134:135], v46 offset:1024
ds_read_b64_tr_b16 a[136:137], v45 offset:0
ds_read_b64_tr_b16 a[138:139], v45 offset:1024
ds_read_b64_tr_b16 a[140:141], v47 offset:0
ds_read_b64_tr_b16 a[142:143], v47 offset:1024
buffer_load_dword v32, v24, s[28:31], 0 offen sc0 sc1
s_waitcnt lgkmcnt(0)
s_waitcnt vmcnt(25)
s_barrier
s_add_u32 s56, s54, 262144
s_mov_b32 m0, 98304
s_nop 0
buffer_load_dwordx4 v26, s[8:11], s56 offen lds
s_add_u32 s56, s54, 278528
s_mov_b32 m0, 99328
s_nop 0
buffer_load_dwordx4 v26, s[8:11], s56 offen lds
s_add_u32 s56, s54, 294912
s_mov_b32 m0, 100352
s_nop 0
buffer_load_dwordx4 v27, s[8:11], s56 offen lds
s_add_u32 s56, s54, 311296
s_mov_b32 m0, 101376
s_nop 0
buffer_load_dwordx4 v27, s[8:11], s56 offen lds
ds_read_b64_tr_b16 a[144:145], v44 offset:4096
ds_read_b64_tr_b16 a[146:147], v44 offset:5120
ds_read_b64_tr_b16 a[148:149], v46 offset:4096
ds_read_b64_tr_b16 a[150:151], v46 offset:5120
ds_read_b64_tr_b16 a[152:153], v45 offset:4096
ds_read_b64_tr_b16 a[154:155], v45 offset:5120
ds_read_b64_tr_b16 a[156:157], v47 offset:4096
ds_read_b64_tr_b16 a[158:159], v47 offset:5120
s_waitcnt lgkmcnt(0)
s_waitcnt vmcnt(25)
s_barrier
s_add_u32 s56, s54, 1835008
s_mov_b32 m0, 102400
s_nop 0
buffer_load_dwordx4 v26, s[8:11], s56 offen lds
s_add_u32 s56, s54, 1851392
s_mov_b32 m0, 103424
s_nop 0
buffer_load_dwordx4 v26, s[8:11], s56 offen lds
s_add_u32 s56, s54, 1867776
s_mov_b32 m0, 104448
s_nop 0
buffer_load_dwordx4 v27, s[8:11], s56 offen lds
s_add_u32 s56, s54, 1884160
s_mov_b32 m0, 105472
s_nop 0
buffer_load_dwordx4 v27, s[8:11], s56 offen lds
ds_read_b64_tr_b16 a[160:161], v44 offset:8192
ds_read_b64_tr_b16 a[162:163], v44 offset:9216
ds_read_b64_tr_b16 a[164:165], v46 offset:8192
ds_read_b64_tr_b16 a[166:167], v46 offset:9216
ds_read_b64_tr_b16 a[168:169], v45 offset:8192
ds_read_b64_tr_b16 a[170:171], v45 offset:9216
ds_read_b64_tr_b16 a[172:173], v47 offset:8192
ds_read_b64_tr_b16 a[174:175], v47 offset:9216
s_waitcnt lgkmcnt(0)
s_waitcnt vmcnt(25)
s_barrier
s_add_u32 s56, s54, 2359296
s_mov_b32 m0, 106496
s_nop 0
buffer_load_dwordx4 v26, s[8:11], s56 offen lds
s_add_u32 s56, s54, 2375680
s_mov_b32 m0, 107520
s_nop 0
buffer_load_dwordx4 v26, s[8:11], s56 offen lds
s_add_u32 s56, s54, 2392064
s_mov_b32 m0, 108544
s_nop 0
buffer_load_dwordx4 v27, s[8:11], s56 offen lds
s_add_u32 s56, s54, 2408448
s_mov_b32 m0, 109568
s_nop 0
buffer_load_dwordx4 v27, s[8:11], s56 offen lds
ds_read_b64_tr_b16 a[176:177], v48 offset:12288
ds_read_b64_tr_b16 a[178:179], v48 offset:13312
ds_read_b64_tr_b16 a[180:181], v48 offset:14336
ds_read_b64_tr_b16 a[182:183], v48 offset:15360
ds_read_b64_tr_b16 a[216:217], v49 offset:12288
ds_read_b64_tr_b16 a[218:219], v49 offset:13312
ds_read_b64_tr_b16 a[220:221], v49 offset:14336
ds_read_b64_tr_b16 a[222:223], v49 offset:15360
s_waitcnt lgkmcnt(0)
s_waitcnt vmcnt(25)
s_barrier
s_add_u32 s56, s54, 2883584
s_mov_b32 m0, 110592
s_nop 0
buffer_load_dwordx4 v26, s[12:15], s56 offen lds
s_add_u32 s56, s54, 2899968
s_mov_b32 m0, 111616
s_nop 0
buffer_load_dwordx4 v26, s[12:15], s56 offen lds
s_add_u32 s56, s54, 2916352
s_mov_b32 m0, 112640
s_nop 0
buffer_load_dwordx4 v27, s[12:15], s56 offen lds
s_add_u32 s56, s54, 2932736
s_mov_b32 m0, 113664
s_nop 0
buffer_load_dwordx4 v27, s[12:15], s56 offen lds
ds_read_b64_tr_b16 a[184:185], v48 offset:16384
ds_read_b64_tr_b16 a[186:187], v48 offset:17408
ds_read_b64_tr_b16 a[188:189], v48 offset:18432
ds_read_b64_tr_b16 a[190:191], v48 offset:19456
ds_read_b64_tr_b16 a[232:233], v49 offset:16384
ds_read_b64_tr_b16 a[234:235], v49 offset:17408
ds_read_b64_tr_b16 a[236:237], v49 offset:18432
ds_read_b64_tr_b16 a[238:239], v49 offset:19456
s_waitcnt lgkmcnt(0)
s_waitcnt vmcnt(25)
s_barrier
s_add_u32 s56, s54, 4456448
s_mov_b32 m0, 114688
s_nop 0
buffer_load_dwordx4 v26, s[16:19], s56 offen lds
s_add_u32 s56, s54, 4472832
s_mov_b32 m0, 115712
s_nop 0
buffer_load_dwordx4 v26, s[16:19], s56 offen lds
s_add_u32 s56, s54, 4489216
s_mov_b32 m0, 116736
s_nop 0
buffer_load_dwordx4 v27, s[16:19], s56 offen lds
s_add_u32 s56, s54, 4505600
s_mov_b32 m0, 117760
s_nop 0
buffer_load_dwordx4 v27, s[16:19], s56 offen lds
ds_read_b64_tr_b16 a[192:193], v48 offset:20480
ds_read_b64_tr_b16 a[194:195], v48 offset:21504
ds_read_b64_tr_b16 a[196:197], v48 offset:22528
ds_read_b64_tr_b16 a[198:199], v48 offset:23552
ds_read_b64_tr_b16 a[240:241], v49 offset:20480
ds_read_b64_tr_b16 a[242:243], v49 offset:21504
ds_read_b64_tr_b16 a[244:245], v49 offset:22528
ds_read_b64_tr_b16 a[246:247], v49 offset:23552
s_waitcnt lgkmcnt(0)
s_waitcnt vmcnt(25)
s_barrier
s_add_u32 s56, s55, 37120
s_mov_b32 m0, 118784
s_nop 0
buffer_load_dwordx4 v28, s[20:23], s56 offen lds
s_add_u32 s56, s55, 39424
s_mov_b32 m0, 119808
s_nop 0
buffer_load_dwordx4 v28, s[20:23], s56 offen lds
s_add_u32 s56, s55, 46336
s_mov_b32 m0, 120832
s_nop 0
buffer_load_dwordx4 v28, s[20:23], s56 offen lds
s_add_u32 s56, s55, 48640
s_mov_b32 m0, 121856
s_nop 0
buffer_load_dwordx4 v28, s[20:23], s56 offen lds
ds_read_b64_tr_b16 a[200:201], v48 offset:24576
ds_read_b64_tr_b16 a[202:203], v48 offset:25600
ds_read_b64_tr_b16 a[204:205], v48 offset:26624
ds_read_b64_tr_b16 a[206:207], v48 offset:27648
ds_read_b64_tr_b16 a[248:249], v49 offset:24576
ds_read_b64_tr_b16 a[250:251], v49 offset:25600
ds_read_b64_tr_b16 a[252:253], v49 offset:26624
ds_read_b64_tr_b16 a[254:255], v49 offset:27648
s_waitcnt lgkmcnt(0)
s_waitcnt vmcnt(25)
s_barrier
s_add_u32 s56, s55, 37376
s_mov_b32 m0, 122880
s_nop 0
buffer_load_dwordx4 v28, s[20:23], s56 offen lds
s_add_u32 s56, s55, 39680
s_mov_b32 m0, 123904
s_nop 0
buffer_load_dwordx4 v28, s[20:23], s56 offen lds
s_add_u32 s56, s55, 46592
s_mov_b32 m0, 124928
s_nop 0
buffer_load_dwordx4 v28, s[20:23], s56 offen lds
s_add_u32 s56, s55, 48896
s_mov_b32 m0, 125952
s_nop 0
buffer_load_dwordx4 v28, s[20:23], s56 offen lds
ds_read_b64_tr_b16 a[208:209], v48 offset:28672
ds_read_b64_tr_b16 a[210:211], v48 offset:29696
ds_read_b64_tr_b16 a[212:213], v48 offset:30720
ds_read_b64_tr_b16 a[214:215], v48 offset:31744
ds_read_b64_tr_b16 a[224:225], v49 offset:28672
ds_read_b64_tr_b16 a[226:227], v49 offset:29696
ds_read_b64_tr_b16 a[228:229], v49 offset:30720
ds_read_b64_tr_b16 a[230:231], v49 offset:31744
s_waitcnt lgkmcnt(0)
s_waitcnt vmcnt(24)
s_barrier
s_add_u32 s56, s55, 37632
s_mov_b32 m0, 126976
s_nop 0
buffer_load_dwordx4 v28, s[20:23], s56 offen lds
s_add_u32 s56, s55, 39936
s_mov_b32 m0, 128000
s_nop 0
buffer_load_dwordx4 v28, s[20:23], s56 offen lds
s_add_u32 s56, s55, 46848
s_mov_b32 m0, 129024
s_nop 0
buffer_load_dwordx4 v28, s[20:23], s56 offen lds
s_add_u32 s56, s55, 49152
s_mov_b32 m0, 130048
s_nop 0
buffer_load_dwordx4 v28, s[20:23], s56 offen lds
ds_read_b64_tr_b16 v[60:61], v44 offset:0
ds_read_b64_tr_b16 v[62:63], v44 offset:1024
ds_read_b64_tr_b16 v[64:65], v46 offset:0
ds_read_b64_tr_b16 v[66:67], v46 offset:1024
ds_read_b64_tr_b16 v[68:69], v45 offset:0
ds_read_b64_tr_b16 v[70:71], v45 offset:1024
ds_read_b64_tr_b16 v[72:73], v47 offset:0
ds_read_b64_tr_b16 v[74:75], v47 offset:1024
s_waitcnt lgkmcnt(0)
s_waitcnt vmcnt(24)
s_barrier
ds_write_b128 v2, v[60:63] offset:0
ds_write_b128 v2, v[64:67] offset:1024
ds_write_b128 v2, v[68:71] offset:2048
ds_write_b128 v2, v[72:75] offset:3072
ds_read_b64_tr_b16 v[60:61], v44 offset:4096
ds_read_b64_tr_b16 v[62:63], v44 offset:5120
ds_read_b64_tr_b16 v[64:65], v46 offset:4096
ds_read_b64_tr_b16 v[66:67], v46 offset:5120
ds_read_b64_tr_b16 v[68:69], v45 offset:4096
ds_read_b64_tr_b16 v[70:71], v45 offset:5120
ds_read_b64_tr_b16 v[72:73], v47 offset:4096
ds_read_b64_tr_b16 v[74:75], v47 offset:5120
L_rdv_w2r:
v_readfirstlane_b32 s38, v32
s_nop 0
s_and_b32 s57, s38, 0xff
s_cmp_lg_u32 s57, 32
s_cbranch_scc1 L_rdv2_w2r
s_waitcnt lgkmcnt(0)
s_waitcnt vmcnt(20)
s_barrier
ds_write_b128 v2, v[60:63] offset:4096
ds_write_b128 v2, v[64:67] offset:5120
ds_write_b128 v2, v[68:71] offset:6144
ds_write_b128 v2, v[72:75] offset:7168
ds_read_b64_tr_b16 v[60:61], v44 offset:8192
ds_read_b64_tr_b16 v[62:63], v44 offset:9216
ds_read_b64_tr_b16 v[64:65], v46 offset:8192
ds_read_b64_tr_b16 v[66:67], v46 offset:9216
ds_read_b64_tr_b16 v[68:69], v45 offset:8192
ds_read_b64_tr_b16 v[70:71], v45 offset:9216
ds_read_b64_tr_b16 v[72:73], v47 offset:8192
ds_read_b64_tr_b16 v[74:75], v47 offset:9216
buffer_load_dwordx4 v[12:15], v9, s[4:7], s37 offen offset:0
buffer_load_dwordx4 v[16:19], v9, s[4:7], s37 offen offset:1024
buffer_load_dwordx4 v[52:55], v1, s[4:7], s37 offen offset:2048
buffer_load_dwordx4 v[56:59], v1, s[4:7], s37 offen offset:3072
s_mov_b32 m0, 1024
s_nop 0
buffer_load_dwordx4 v1, s[4:7], s47 offen offset:2048 sc1 lds
s_mov_b32 s56, 304128
buffer_load_dword v33, v24, s[4:7], s56 offen sc1
buffer_load_dword v33, v1, s[4:7], s3 offen offset:0 sc1
buffer_load_dword v33, v1, s[4:7], s3 offen offset:1024 sc1
buffer_load_dword v33, v1, s[4:7], s3 offen offset:2048 sc1
buffer_load_dword v33, v1, s[4:7], s3 offen offset:3072 sc1
s_waitcnt lgkmcnt(0)
s_waitcnt vmcnt(26)
s_barrier
ds_write_b128 v2, v[60:63] offset:8192
ds_write_b128 v2, v[64:67] offset:9216
ds_write_b128 v2, v[68:71] offset:10240
ds_write_b128 v2, v[72:75] offset:11264
ds_read_b64_tr_b16 v[60:61], v44 offset:12288
ds_read_b64_tr_b16 v[62:63], v44 offset:13312
ds_read_b64_tr_b16 v[64:65], v46 offset:12288
ds_read_b64_tr_b16 v[66:67], v46 offset:13312
ds_read_b64_tr_b16 v[68:69], v45 offset:12288
ds_read_b64_tr_b16 v[70:71], v45 offset:13312
ds_read_b64_tr_b16 v[72:73], v47 offset:12288
ds_read_b64_tr_b16 v[74:75], v47 offset:13312
s_waitcnt lgkmcnt(0)
s_waitcnt vmcnt(22)
s_barrier
ds_write_b128 v2, v[60:63] offset:12288
ds_write_b128 v2, v[64:67] offset:13312
ds_write_b128 v2, v[68:71] offset:14336
ds_write_b128 v2, v[72:75] offset:15360
ds_read_b64_tr_b16 v[60:61], v44 offset:16384
ds_read_b64_tr_b16 v[62:63], v44 offset:17408
ds_read_b64_tr_b16 v[64:65], v46 offset:16384
ds_read_b64_tr_b16 v[66:67], v46 offset:17408
ds_read_b64_tr_b16 v[68:69], v45 offset:16384
ds_read_b64_tr_b16 v[70:71], v45 offset:17408
ds_read_b64_tr_b16 v[72:73], v47 offset:16384
ds_read_b64_tr_b16 v[74:75], v47 offset:17408
s_waitcnt lgkmcnt(0)
s_waitcnt vmcnt(18)
s_barrier
ds_write_b128 v2, v[60:63] offset:16384
ds_write_b128 v2, v[64:67] offset:17408
ds_write_b128 v2, v[68:71] offset:18432
ds_write_b128 v2, v[72:75] offset:19456
ds_read_b64_tr_b16 v[60:61], v48 offset:20480
ds_read_b64_tr_b16 v[62:63], v48 offset:21504
ds_read_b64_tr_b16 v[64:65], v48 offset:22528
ds_read_b64_tr_b16 v[66:67], v48 offset:23552
ds_read_b64_tr_b16 v[68:69], v49 offset:20480
ds_read_b64_tr_b16 v[70:71], v49 offset:21504
ds_read_b64_tr_b16 v[72:73], v49 offset:22528
ds_read_b64_tr_b16 v[74:75], v49 offset:23552
s_waitcnt lgkmcnt(0)
s_waitcnt vmcnt(14)
s_barrier
ds_write_b128 v2, v[60:63] offset:20480
ds_write_b128 v2, v[64:67] offset:21504
ds_write_b128 v2, v[68:71] offset:22528
ds_write_b128 v2, v[72:75] offset:23552
ds_read_b64_tr_b16 v[60:61], v48 offset:24576
ds_read_b64_tr_b16 v[62:63], v48 offset:25600
ds_read_b64_tr_b16 v[64:65], v48 offset:26624
ds_read_b64_tr_b16 v[66:67], v48 offset:27648
ds_read_b64_tr_b16 v[68:69], v49 offset:24576
ds_read_b64_tr_b16 v[70:71], v49 offset:25600
ds_read_b64_tr_b16 v[72:73], v49 offset:26624
ds_read_b64_tr_b16 v[74:75], v49 offset:27648
s_waitcnt lgkmcnt(0)
s_waitcnt vmcnt(10)
s_barrier
ds_write_b128 v2, v[60:63] offset:24576
ds_write_b128 v2, v[64:67] offset:25600
ds_write_b128 v2, v[68:71] offset:26624
ds_write_b128 v2, v[72:75] offset:27648
ds_read_b64_tr_b16 v[60:61], v48 offset:28672
ds_read_b64_tr_b16 v[62:63], v48 offset:29696
ds_read_b64_tr_b16 v[64:65], v48 offset:30720
ds_read_b64_tr_b16 v[66:67], v48 offset:31744
ds_read_b64_tr_b16 v[68:69], v49 offset:28672
ds_read_b64_tr_b16 v[70:71], v49 offset:29696
ds_read_b64_tr_b16 v[72:73], v49 offset:30720
ds_read_b64_tr_b16 v[74:75], v49 offset:31744
s_waitcnt lgkmcnt(0)
s_barrier
ds_write_b128 v2, v[60:63] offset:28672
ds_write_b128 v2, v[64:67] offset:29696
ds_write_b128 v2, v[68:71] offset:30720
ds_write_b128 v2, v[72:75] offset:31744
s_lshl_b32 s57, s58, 5
s_mov_b32 s0, 0x3f003f00
s_mov_b32 s1, 0x3f003f00
s_mov_b32 s58, 304128
s_cmp_eq_u32 s38, s57
s_mov_b32 s56, 0x33333333
s_mov_b32 s57, 0x33333333
s_mov_b32 s2, 0x21800000
s_mov_b32 s55, -24
s_cbranch_scc0 L_slow_w2r
v_mov_b64 v[20:21], 0
v_mov_b64 v[22:23], 0
v_mov_b64 v[24:25], 0
v_mov_b64 v[26:27], 0
v_mov_b64 v[28:29], 0
v_mov_b64 v[30:31], 0
v_mov_b64 v[32:33], 0
v_mov_b64 v[34:35], 0
v_mov_b64 v[36:37], 0
v_mov_b64 v[38:39], 0
v_mov_b64 v[40:41], 0
v_mov_b64 v[42:43], 0
ds_read_b128 v[44:47], v2 offset:0
ds_read_b128 v[48:51], v2 offset:1024
v_bfe_u32 v77, v1, 6, 1
v_lshl_add_u32 v77, v77, 3, v1
v_lshlrev_b32 v77, 1, v77
v_lshlrev_b32 v78, 3, v1
s_waitcnt vmcnt(0) lgkmcnt(0)
s_branch L_top_w2rf
L_done_w2rf:
s_mul_i32 s40, s34, 10240
s_add_u32 s40, s40, 8093696
buffer_store_dword v11, v10, s[4:7], s40 offen sc0 sc1
s_waitcnt vmcnt(0) lgkmcnt(0)
s_endpgm
L_rdv2_w2r:
buffer_load_dword v32, v24, s[28:31], 0 offen sc0 sc1
s_sub_u32 s41, s41, 1
s_cbranch_scc1 L_exit
s_waitcnt vmcnt(0)
s_branch L_rdv_w2r
L_ra0_w2rf:
s_mov_b32 m0, 1024
s_nop 0
buffer_load_dwordx4 v1, s[4:7], s47 offen offset:0 sc1 lds
buffer_load_dwordx4 v1, s[4:7], s47 offen offset:1024 sc1 lds
buffer_load_dwordx4 v1, s[4:7], s47 offen offset:2048 sc1 lds
buffer_load_dwordx4 v1, s[4:7], s47 offen offset:3072 sc1 lds
s_sub_u32 s41, s41, 1
s_cbranch_scc1 L_exit
ds_read_b128 v[44:47], v2 offset:0
ds_read_b128 v[48:51], v2 offset:1024
v_mov_b64 v[20:21], 0
v_mov_b64 v[22:23], 0
v_mov_b64 v[24:25], 0
v_mov_b64 v[26:27], 0
v_mov_b64 v[28:29], 0
v_mov_b64 v[30:31], 0
v_mov_b64 v[32:33], 0
v_mov_b64 v[34:35], 0
v_mov_b64 v[36:37], 0
v_mov_b64 v[38:39], 0
v_mov_b64 v[40:41], 0
v_mov_b64 v[42:43], 0
s_waitcnt vmcnt(0)
ds_read_b128 v[60:63], v1 offset:1024
ds_read_b128 v[64:67], v1 offset:2048
ds_read_b128 v[68:71], v1 offset:3072
ds_read_b128 v[72:75], v1 offset:4096
s_branch L_s0_w2rf
L_ra1_w2rf:
L_ra2_w2rf:
s_waitcnt lgkmcnt(0)
s_barrier
s_mov_b32 m0, 5120
s_nop 0
buffer_load_dwordx4 v1, s[4:7], s48 offen offset:2048 sc1 lds
s_sub_u32 s41, s41, 1
s_cbranch_scc1 L_exit
s_waitcnt vmcnt(0)
s_barrier
ds_read_b128 v[76:79], v1 offset:5120
ds_read_b128 v[60:63], v1 offset:6144
ds_read_b128 v[64:67], v1 offset:7168
ds_read_b128 v[68:71], v1 offset:8192
ds_read_b128 v[72:75], v1 offset:9216
s_waitcnt lgkmcnt(0)
v_bitop3_b32 v6, v76, v60, s35 bitop3:0x7e
v_bitop3_b32 v6, v6, v64, s35 bitop3:0xf6
v_bitop3_b32 v6, v6, v68, s35 bitop3:0xf6
v_bitop3_b32 v6, v6, v72, s35 bitop3:0xf6
v_and_b32 v6, 1, v6
v_cmp_ne_u32 vcc, 0, v6

s_cbranch_vccnz L_ra2_w2rf
s_branch L_a1_w2rf
L_mx_w2rf:
s_waitcnt lgkmcnt(0)
v_max3_f32 v30, v12, v13, v28
v_max_f32 v30, v30, v29
v_mov_b32 v31, v30
s_nop 1
v_permlane16_swap_b32 v30, v31
v_max_f32 v30, v30, v31
v_mov_b32 v31, v30
s_nop 1
v_permlane32_swap_b32 v30, v31
v_max_f32 v30, v30, v31
ds_write_b32 v1, v30 offset:10248
s_waitcnt lgkmcnt(0)
s_barrier
ds_read_b128 v[32:35], v1 offset:10240
s_waitcnt lgkmcnt(0)
v_max3_f32 v32, v32, v33, v34
v_max_f32 v32, v32, v35
v_sub_f32 v14, v12, v32
v_sub_f32 v15, v13, v32
v_sub_f32 v30, v28, v32
v_sub_f32 v31, v29, v32
v_exp_f32 v14, v14
v_exp_f32 v15, v15
v_exp_f32 v30, v30
v_exp_f32 v31, v31
v_cvt_pk_bf16_f32 v14, v14, v15
v_cvt_pk_bf16_f32 v30, v30, v31
ds_write_b32 v5, v14 offset:14880
v_cndmask_b32_e64 v26, 0, v30, s[56:57]
v_cndmask_b32_e64 v27, 0, v30, s[56:57]
v_mov_b64 v[76:77], s[52:53]
v_mov_b64 v[78:79], s[52:53]
v_mov_b32_dpp v24, v26 quad_perm:[2,3,0,1] row_mask:0xf bank_mask:0xf
v_mov_b32_dpp v25, v26 quad_perm:[2,3,0,1] row_mask:0xf bank_mask:0xf
s_waitcnt lgkmcnt(0)
s_barrier
v_mov_b64 v[14:15], s[0:1]
ds_read_b128 v[16:19], v1 offset:14368
ds_read_b128 v[36:39], v1 offset:14336
s_waitcnt lgkmcnt(0)
v_mfma_f32_16x16x32_bf16 v[32:35], v[76:79], v[16:19], 0
v_mfma_f32_16x16x32_bf16 v[20:23], v[52:55], v[16:19], 0
v_mfma_f32_16x16x32_bf16 v[20:23], v[56:59], v[36:39], v[20:23]
v_mfma_f32_16x16x16_bf16 v[32:35], v[14:15], v[26:27], v[32:35]
v_mfma_f32_16x16x32_bf16 v[20:23], v[40:43], v[24:27], v[20:23]
s_nop 3
v_rcp_f32 v33, v32
s_nop 2
v_mul_f32_dpp v20, v33, v20 quad_perm:[0,1,0,1] row_mask:0xf bank_mask:0xf
v_mul_f32_dpp v21, v33, v21 quad_perm:[0,1,0,1] row_mask:0xf bank_mask:0xf
v_mul_f32_dpp v22, v33, v22 quad_perm:[0,1,0,1] row_mask:0xf bank_mask:0xf
v_mul_f32_dpp v23, v33, v23 quad_perm:[0,1,0,1] row_mask:0xf bank_mask:0xf
v_cvt_pk_bf16_f32 v20, v20, v21
v_cvt_pk_bf16_f32 v21, v22, v23
ds_write_b64 v6, v[20:21] offset:7168
v_mov_b32_dpp v16, v20 quad_perm:[0,1,0,1] row_mask:0xf bank_mask:0xf
v_mov_b32_dpp v17, v21 quad_perm:[0,1,0,1] row_mask:0xf bank_mask:0xf
v_mov_b32_dpp v18, v20 quad_perm:[2,3,2,3] row_mask:0xf bank_mask:0xf
v_mov_b32_dpp v19, v21 quad_perm:[2,3,2,3] row_mask:0xf bank_mask:0xf
v_mov_b64 v[76:77], 0
v_mov_b64 v[78:79], 0
v_mov_b64 v[36:37], 0
v_mov_b64 v[38:39], 0
v_mov_b64 v[24:25], 0
v_mov_b64 v[26:27], 0
v_mov_b64 v[32:33], 0
v_mov_b64 v[34:35], 0
s_waitcnt lgkmcnt(0)
s_branch L_mxb_w2rf

L_rr_w2rf:
buffer_load_dwordx4 v[60:63], v9, s[4:7], s3 offen offset:0 sc1
buffer_load_dwordx4 v[64:67], v9, s[4:7], s3 offen offset:1024 sc1
buffer_load_dwordx4 v[68:71], v9, s[4:7], s3 offen offset:2048 sc1
buffer_load_dwordx4 v[72:75], v9, s[4:7], s3 offen offset:3072 sc1
s_sub_u32 s41, s41, 1
s_cbranch_scc1 L_exit
s_waitcnt vmcnt(0)
s_branch L_r_w2rf
L_slow_w2r:
v_mov_b64 v[20:21], 0
v_mov_b64 v[22:23], 0
v_mov_b64 v[24:25], 0
v_mov_b64 v[26:27], 0
v_mov_b64 v[28:29], 0
v_mov_b64 v[30:31], 0
v_mov_b64 v[32:33], 0
v_mov_b64 v[34:35], 0
v_mov_b64 v[36:37], 0
v_mov_b64 v[38:39], 0
v_mov_b64 v[40:41], 0
v_mov_b64 v[42:43], 0
ds_read_b128 v[44:47], v2 offset:0
ds_read_b128 v[48:51], v2 offset:1024
v_bfe_u32 v77, v1, 6, 1
v_lshl_add_u32 v77, v77, 3, v1
v_lshlrev_b32 v77, 1, v77
v_lshlrev_b32 v78, 3, v1
s_waitcnt vmcnt(0) lgkmcnt(0)
s_branch L_top_w2rs
L_done_w2rs:
s_mul_i32 s40, s34, 10240
s_add_u32 s40, s40, 8093696
buffer_store_dword v11, v10, s[4:7], s40 offen sc0 sc1
s_waitcnt vmcnt(0) lgkmcnt(0)
s_endpgm
L_ra0_w2rs:
s_mov_b32 m0, 1024
s_nop 0
buffer_load_dwordx4 v1, s[4:7], s47 offen offset:0 sc0 sc1 lds
buffer_load_dwordx4 v1, s[4:7], s47 offen offset:1024 sc0 sc1 lds
buffer_load_dwordx4 v1, s[4:7], s47 offen offset:2048 sc0 sc1 lds
buffer_load_dwordx4 v1, s[4:7], s47 offen offset:3072 sc0 sc1 lds
s_sub_u32 s41, s41, 1
s_cbranch_scc1 L_exit
ds_read_b128 v[44:47], v2 offset:0
ds_read_b128 v[48:51], v2 offset:1024
v_mov_b64 v[20:21], 0
v_mov_b64 v[22:23], 0
v_mov_b64 v[24:25], 0
v_mov_b64 v[26:27], 0
v_mov_b64 v[28:29], 0
v_mov_b64 v[30:31], 0
v_mov_b64 v[32:33], 0
v_mov_b64 v[34:35], 0
v_mov_b64 v[36:37], 0
v_mov_b64 v[38:39], 0
v_mov_b64 v[40:41], 0
v_mov_b64 v[42:43], 0
s_waitcnt vmcnt(0)
ds_read_b128 v[60:63], v1 offset:1024
ds_read_b128 v[64:67], v1 offset:2048
ds_read_b128 v[68:71], v1 offset:3072
ds_read_b128 v[72:75], v1 offset:4096
s_branch L_s0_w2rs
L_ra1_w2rs:
L_ra2_w2rs:
s_waitcnt lgkmcnt(0)
s_barrier
s_mov_b32 m0, 5120
s_nop 0
buffer_load_dwordx4 v1, s[4:7], s48 offen offset:2048 sc0 sc1 lds
s_sub_u32 s41, s41, 1
s_cbranch_scc1 L_exit
s_waitcnt vmcnt(0)
s_barrier
ds_read_b128 v[76:79], v1 offset:5120
ds_read_b128 v[60:63], v1 offset:6144
ds_read_b128 v[64:67], v1 offset:7168
ds_read_b128 v[68:71], v1 offset:8192
ds_read_b128 v[72:75], v1 offset:9216
s_waitcnt lgkmcnt(0)
v_bitop3_b32 v6, v76, v60, s35 bitop3:0x7e
v_bitop3_b32 v6, v6, v64, s35 bitop3:0xf6
v_bitop3_b32 v6, v6, v68, s35 bitop3:0xf6
v_bitop3_b32 v6, v6, v72, s35 bitop3:0xf6
v_and_b32 v6, 1, v6
v_cmp_ne_u32 vcc, 0, v6

s_cbranch_vccnz L_ra2_w2rs
s_branch L_a1_w2rs
L_mx_w2rs:
s_waitcnt lgkmcnt(0)
v_max3_f32 v30, v12, v13, v28
v_max_f32 v30, v30, v29
v_mov_b32 v31, v30
s_nop 1
v_permlane16_swap_b32 v30, v31
v_max_f32 v30, v30, v31
v_mov_b32 v31, v30
s_nop 1
v_permlane32_swap_b32 v30, v31
v_max_f32 v30, v30, v31
ds_write_b32 v1, v30 offset:10248
s_waitcnt lgkmcnt(0)
s_barrier
ds_read_b128 v[32:35], v1 offset:10240
s_waitcnt lgkmcnt(0)
v_max3_f32 v32, v32, v33, v34
v_max_f32 v32, v32, v35
v_sub_f32 v14, v12, v32
v_sub_f32 v15, v13, v32
v_sub_f32 v30, v28, v32
v_sub_f32 v31, v29, v32
v_exp_f32 v14, v14
v_exp_f32 v15, v15
v_exp_f32 v30, v30
v_exp_f32 v31, v31
v_cvt_pk_bf16_f32 v14, v14, v15
v_cvt_pk_bf16_f32 v30, v30, v31
ds_write_b32 v5, v14 offset:14880
v_cndmask_b32_e64 v26, 0, v30, s[56:57]
v_cndmask_b32_e64 v27, 0, v30, s[56:57]
v_mov_b64 v[76:77], s[52:53]
v_mov_b64 v[78:79], s[52:53]
v_mov_b32_dpp v24, v26 quad_perm:[2,3,0,1] row_mask:0xf bank_mask:0xf
v_mov_b32_dpp v25, v26 quad_perm:[2,3,0,1] row_mask:0xf bank_mask:0xf
s_waitcnt lgkmcnt(0)
s_barrier
v_mov_b64 v[14:15], s[0:1]
ds_read_b128 v[16:19], v1 offset:14368
ds_read_b128 v[36:39], v1 offset:14336
s_waitcnt lgkmcnt(0)
v_mfma_f32_16x16x32_bf16 v[32:35], v[76:79], v[16:19], 0
v_mfma_f32_16x16x32_bf16 v[20:23], v[52:55], v[16:19], 0
v_mfma_f32_16x16x32_bf16 v[20:23], v[56:59], v[36:39], v[20:23]
v_mfma_f32_16x16x16_bf16 v[32:35], v[14:15], v[26:27], v[32:35]
v_mfma_f32_16x16x32_bf16 v[20:23], v[40:43], v[24:27], v[20:23]
s_nop 3
v_rcp_f32 v33, v32
s_nop 2
v_mul_f32_dpp v20, v33, v20 quad_perm:[0,1,0,1] row_mask:0xf bank_mask:0xf
v_mul_f32_dpp v21, v33, v21 quad_perm:[0,1,0,1] row_mask:0xf bank_mask:0xf
v_mul_f32_dpp v22, v33, v22 quad_perm:[0,1,0,1] row_mask:0xf bank_mask:0xf
v_mul_f32_dpp v23, v33, v23 quad_perm:[0,1,0,1] row_mask:0xf bank_mask:0xf
v_cvt_pk_bf16_f32 v20, v20, v21
v_cvt_pk_bf16_f32 v21, v22, v23
ds_write_b64 v6, v[20:21] offset:7168
v_mov_b32_dpp v16, v20 quad_perm:[0,1,0,1] row_mask:0xf bank_mask:0xf
v_mov_b32_dpp v17, v21 quad_perm:[0,1,0,1] row_mask:0xf bank_mask:0xf
v_mov_b32_dpp v18, v20 quad_perm:[2,3,2,3] row_mask:0xf bank_mask:0xf
v_mov_b32_dpp v19, v21 quad_perm:[2,3,2,3] row_mask:0xf bank_mask:0xf
v_mov_b64 v[76:77], 0
v_mov_b64 v[78:79], 0
v_mov_b64 v[36:37], 0
v_mov_b64 v[38:39], 0
v_mov_b64 v[24:25], 0
v_mov_b64 v[26:27], 0
v_mov_b64 v[32:33], 0
v_mov_b64 v[34:35], 0
s_waitcnt lgkmcnt(0)
s_branch L_mxb_w2rs

L_rr_w2rs:
buffer_load_dwordx4 v[60:63], v9, s[4:7], s3 offen offset:0 sc0 sc1
buffer_load_dwordx4 v[64:67], v9, s[4:7], s3 offen offset:1024 sc0 sc1
buffer_load_dwordx4 v[68:71], v9, s[4:7], s3 offen offset:2048 sc0 sc1
buffer_load_dwordx4 v[72:75], v9, s[4:7], s3 offen offset:3072 sc0 sc1
s_sub_u32 s41, s41, 1
s_cbranch_scc1 L_exit
s_waitcnt vmcnt(0)
s_branch L_r_w2rs
L_pro_w3:
v_and_b32 v20, 63, v0
v_lshlrev_b32 v1, 4, v20
v_add_u32 v2, 131072, v1
v_and_b32 v23, 1, v22
v_lshl_add_u32 v23, v24, 4, v23
v_mul_u32_u24 v23, 1152, v23
v_lshlrev_b32 v28, 2, v22
v_xor_b32 v28, v28, v21
v_lshl_add_u32 v28, v28, 4, v23
s_mul_i32 s55, s32, 147456
s_waitcnt lgkmcnt(0)
v_and_b32 v23, 1, v22
v_lshrrev_b32 v24, 2, v21
v_lshl_add_u32 v23, v23, 2, v24
v_lshlrev_b32 v23, 1, v23
v_bfe_u32 v44, v21, 1, 1
v_add_u32 v44, 12, v44
v_xor_b32 v44, v44, v23
v_lshlrev_b32 v44, 4, v44
v_lshl_add_u32 v44, v24, 8, v44
v_and_b32 v23, 1, v22
v_lshl_add_u32 v44, v23, 11, v44
v_and_b32 v23, 1, v21
v_lshl_add_u32 v44, v23, 3, v44
v_lshrrev_b32 v23, 1, v22
v_mul_u32_u24 v23, 40960, v23
v_add_u32 v23, 16384, v23
v_add_u32 v44, v44, v23
v_and_b32 v23, 1, v22
v_lshrrev_b32 v24, 2, v21
v_lshl_add_u32 v23, v23, 2, v24
v_lshlrev_b32 v23, 1, v23
v_bfe_u32 v45, v21, 1, 1
v_add_u32 v45, 14, v45
v_xor_b32 v45, v45, v23
v_lshlrev_b32 v45, 4, v45
v_lshl_add_u32 v45, v24, 8, v45
v_and_b32 v23, 1, v22
v_lshl_add_u32 v45, v23, 11, v45
v_and_b32 v23, 1, v21
v_lshl_add_u32 v45, v23, 3, v45
v_lshrrev_b32 v23, 1, v22
v_mul_u32_u24 v23, 40960, v23
v_add_u32 v23, 16384, v23
v_add_u32 v45, v45, v23
v_and_b32 v23, 1, v22
v_lshrrev_b32 v24, 2, v21
v_lshl_add_u32 v23, v23, 2, v24
v_lshlrev_b32 v23, 1, v23
v_bfe_u32 v46, v21, 1, 1
v_add_u32 v46, 12, v46
v_xor_b32 v46, v46, v23
v_lshlrev_b32 v46, 4, v46
v_lshl_add_u32 v46, v24, 8, v46
v_and_b32 v23, 1, v22
v_lshl_add_u32 v46, v23, 11, v46
v_and_b32 v23, 1, v21
v_lshl_add_u32 v46, v23, 3, v46
v_lshrrev_b32 v23, 1, v22
v_mul_u32_u24 v23, 32768, v23
v_add_u32 v23, 98304, v23
v_add_u32 v46, v46, v23
v_and_b32 v23, 1, v22
v_lshrrev_b32 v24, 2, v21
v_lshl_add_u32 v23, v23, 2, v24
v_lshlrev_b32 v23, 1, v23
v_bfe_u32 v47, v21, 1, 1
v_add_u32 v47, 14, v47
v_xor_b32 v47, v47, v23
v_lshlrev_b32 v47, 4, v47
v_lshl_add_u32 v47, v24, 8, v47
v_and_b32 v23, 1, v22
v_lshl_add_u32 v47, v23, 11, v47
v_and_b32 v23, 1, v21
v_lshl_add_u32 v47, v23, 3, v47
v_lshrrev_b32 v23, 1, v22
v_mul_u32_u24 v23, 32768, v23
v_add_u32 v23, 98304, v23
v_add_u32 v47, v47, v23
v_and_b32 v23, 1, v22
v_bfe_u32 v24, v21, 2, 1
v_lshl_add_u32 v23, v23, 1, v24
v_xor_b32 v24, 3, v23
v_lshlrev_b32 v24, 6, v24
v_lshl_add_u32 v48, v23, 8, v24
v_and_b32 v23, 3, v21
v_lshl_add_u32 v48, v23, 4, v48
v_and_b32 v23, 8, v21
v_add_u32 v48, v48, v23
v_lshrrev_b32 v23, 1, v22
v_mul_u32_u24 v23, 40960, v23
v_add_u32 v23, 16384, v23
v_add_u32 v48, v48, v23
v_and_b32 v23, 1, v22
v_bfe_u32 v24, v21, 2, 1
v_lshl_add_u32 v23, v23, 1, v24
v_xor_b32 v24, 3, v23
v_lshlrev_b32 v24, 6, v24
v_lshl_add_u32 v49, v23, 8, v24
v_and_b32 v23, 3, v21
v_lshl_add_u32 v49, v23, 4, v49
v_and_b32 v23, 8, v21
v_add_u32 v49, v49, v23
v_lshrrev_b32 v23, 1, v22
v_mul_u32_u24 v23, 32768, v23
v_add_u32 v23, 98304, v23
v_add_u32 v49, v49, v23
v_bfe_u32 v23, v21, 1, 1
v_mul_u32_u24 v23, 0xaaaa, v23
v_add_u32 v0, 0x4444, v23
v_lshlrev_b32 v3, 3, v20
v_lshrrev_b32 v25, 5, v20
v_lshlrev_b32 v25, 6, v25
v_xor_b32 v3, v3, v25
v_lshrrev_b32 v25, 2, v20
v_and_b32 v4, 3, v21
v_lshl_add_u32 v4, v4, 4, v25
v_lshlrev_b32 v4, 3, v4
v_bfe_u32 v25, v21, 1, 1
v_lshlrev_b32 v23, 6, v25
v_xor_b32 v4, v4, v23
v_lshlrev_b32 v5, 4, v21
v_lshl_add_u32 v5, v22, 2, v5
v_mul_u32_u24 v23, 256, v25
v_add_u32 v5, v5, v23
v_lshlrev_b32 v9, 8, v22
v_lshl_add_u32 v9, v25, 6, v9
v_bfe_u32 v23, v21, 3, 1
v_lshl_add_u32 v9, v23, 7, v9
v_bfe_u32 v23, v21, 2, 1
v_lshl_add_u32 v9, v23, 5, v9
v_and_b32 v23, 1, v21
v_lshl_add_u32 v9, v23, 4, v9
v_lshrrev_b32 v23, 1, v22
v_and_b32 v24, 1, v22
v_and_b32 v25, 7, v21
v_lshrrev_b32 v7, 3, v21
v_lshl_add_u32 v8, v7, 1, v23
v_lshlrev_b32 v8, 12, v8
v_lshl_add_u32 v8, v24, 7, v8
v_and_b32 v25, 4, v21
v_lshl_add_u32 v8, v25, 3, v8
v_and_b32 v25, 1, v21
v_lshl_add_u32 v8, v25, 4, v8
v_bfe_u32 v25, v21, 1, 1
v_lshl_add_u32 v8, v25, 3, v8
s_lshr_b32 s56, s32, 1
s_lshl_b32 s56, s56, 8
s_and_b32 s57, s32, 1
s_lshl_b32 s57, s57, 6
s_add_u32 s56, s56, s57
s_add_u32 s56, s56, 49152
v_add_u32 v8, s56, v8
v_and_b32 v7, 0x3d0, v1
s_mov_b32 s42, 0
s_mov_b32 s43, 65536
s_mov_b32 s44, 131072
s_mov_b32 s45, 196608
s_mov_b32 s46, 262144
s_mov_b32 s47, 294912
s_mov_b32 s48, 299008
s_mov_b32 s49, 303104
s_mov_b32 s50, 0x3e0293ee
s_mov_b32 s51, 0x3e0293ee
s_mov_b32 s52, 0x3f803f80
s_mov_b32 s53, 0x3f803f80
v_lshlrev_b32 v11, 2, v21
s_mov_b32 s34, 0
s_mov_b32 s35, -1
s_mov_b32 s36, 0
s_mov_b32 s41, 300000
s_lshl_b32 s37, s32, 14
s_add_u32 s39, s37, 17309696
s_add_u32 s37, s37, 16789504
s_mov_b32 s40, 8749056
v_mov_b64 v[36:37], 0
v_mov_b64 v[38:39], 0
s_lshl_b32 s56, s32, 1
s_add_u32 s56, s56, 1
s_cmp_eq_u32 s56, 0
s_cselect_b32 s56, 64, s56
s_mul_i32 s56, s56, 10240
s_add_u32 s56, s56, 8392704
s_add_u32 s57, s56, 4096
v_mov_b32 v40, 1
v_mov_b32 v41, 1
v_mov_b32 v42, 1
v_mov_b32 v43, 1
buffer_store_dwordx4 v[40:43], v1, s[4:7], s56 offen offset:0 sc0 sc1
buffer_store_dwordx4 v[40:43], v1, s[4:7], s56 offen offset:1024 sc0 sc1
buffer_store_dwordx4 v[40:43], v1, s[4:7], s56 offen offset:2048 sc0 sc1
buffer_store_dwordx4 v[40:43], v1, s[4:7], s56 offen offset:3072 sc0 sc1
buffer_store_dwordx4 v[40:43], v1, s[4:7], s57 offen offset:0 sc0 sc1
s_lshl_b32 s56, s32, 10
s_add_u32 s56, s56, 327680
buffer_store_dwordx4 v[36:39], v1, s[4:7], s56 offen sc0 sc1
s_getreg_b32 s56, hwreg(HW_REG_XCC_ID)
s_and_b32 s56, s56, 15
s_mul_i32 s57, s56, s56
s_lshl_b32 s57, s57, 18
s_lshl_b32 s56, s56, 8
s_add_u32 s57, s57, s56
s_add_u32 s58, s57, 1
s_lshl_b32 s101, s32, 7
s_add_u32 s101, s101, 327680
v_mov_b32 v24, 0
s_add_u32 s56, s54, 393216
s_mov_b32 m0, 143360
s_nop 0
buffer_load_dwordx4 v26, s[12:15], s56 offen lds
s_add_u32 s56, s54, 409600
s_mov_b32 m0, 144384
s_nop 0
buffer_load_dwordx4 v26, s[12:15], s56 offen lds
s_add_u32 s56, s54, 425984
s_mov_b32 m0, 145408
s_nop 0
buffer_load_dwordx4 v27, s[12:15], s56 offen lds
s_add_u32 s56, s54, 442368
s_mov_b32 m0, 146432
s_nop 0
buffer_load_dwordx4 v27, s[12:15], s56 offen lds
s_add_u32 s56, s54, 917504
s_mov_b32 m0, 147456
s_nop 0
buffer_load_dwordx4 v26, s[12:15], s56 offen lds
s_add_u32 s56, s54, 933888
s_mov_b32 m0, 148480
s_nop 0
buffer_load_dwordx4 v26, s[12:15], s56 offen lds
s_add_u32 s56, s54, 950272
s_mov_b32 m0, 149504
s_nop 0
buffer_load_dwordx4 v27, s[12:15], s56 offen lds
s_add_u32 s56, s54, 966656
s_mov_b32 m0, 150528
s_nop 0
buffer_load_dwordx4 v27, s[12:15], s56 offen lds
v_mov_b32 v24, 0
s_waitcnt vmcnt(34)
s_barrier
ds_read_b64_tr_b16 v[80:81], v44 offset:20480
ds_read_b64_tr_b16 v[82:83], v44 offset:21504
ds_read_b64_tr_b16 v[84:85], v46 offset:20480
ds_read_b64_tr_b16 v[86:87], v46 offset:21504
ds_read_b64_tr_b16 v[88:89], v45 offset:20480
ds_read_b64_tr_b16 v[90:91], v45 offset:21504
ds_read_b64_tr_b16 v[92:93], v47 offset:20480
ds_read_b64_tr_b16 v[94:95], v47 offset:21504
s_waitcnt lgkmcnt(0)
s_waitcnt vmcnt(30)
s_barrier
s_add_u32 s56, s54, 1441792
s_mov_b32 m0, 151552
s_nop 0
buffer_load_dwordx4 v26, s[12:15], s56 offen lds
s_add_u32 s56, s54, 1458176
s_mov_b32 m0, 152576
s_nop 0
buffer_load_dwordx4 v26, s[12:15], s56 offen lds
s_add_u32 s56, s54, 1474560
s_mov_b32 m0, 153600
s_nop 0
buffer_load_dwordx4 v27, s[12:15], s56 offen lds
s_add_u32 s56, s54, 1490944
s_mov_b32 m0, 154624
s_nop 0
buffer_load_dwordx4 v27, s[12:15], s56 offen lds
ds_read_b64_tr_b16 v[96:97], v44 offset:24576
ds_read_b64_tr_b16 v[98:99], v44 offset:25600
ds_read_b64_tr_b16 v[100:101], v46 offset:24576
ds_read_b64_tr_b16 v[102:103], v46 offset:25600
ds_read_b64_tr_b16 v[104:105], v45 offset:24576
ds_read_b64_tr_b16 v[106:107], v45 offset:25600
ds_read_b64_tr_b16 v[108:109], v47 offset:24576
ds_read_b64_tr_b16 v[110:111], v47 offset:25600
s_waitcnt lgkmcnt(0)
s_waitcnt vmcnt(30)
s_barrier
s_add_u32 s56, s54, 1966080
s_mov_b32 m0, 155648
s_nop 0
buffer_load_dwordx4 v26, s[12:15], s56 offen lds
s_add_u32 s56, s54, 1982464
s_mov_b32 m0, 156672
s_nop 0
buffer_load_dwordx4 v26, s[12:15], s56 offen lds
s_add_u32 s56, s54, 1998848
s_mov_b32 m0, 157696
s_nop 0
buffer_load_dwordx4 v27, s[12:15], s56 offen lds
s_add_u32 s56, s54, 2015232
s_mov_b32 m0, 158720
s_nop 0
buffer_load_dwordx4 v27, s[12:15], s56 offen lds
ds_read_b64_tr_b16 v[112:113], v44 offset:28672
ds_read_b64_tr_b16 v[114:115], v44 offset:29696
ds_read_b64_tr_b16 v[116:117], v46 offset:28672
ds_read_b64_tr_b16 v[118:119], v46 offset:29696
ds_read_b64_tr_b16 v[120:121], v45 offset:28672
ds_read_b64_tr_b16 v[122:123], v45 offset:29696
ds_read_b64_tr_b16 v[124:125], v47 offset:28672
ds_read_b64_tr_b16 v[126:127], v47 offset:29696
s_waitcnt lgkmcnt(0)
s_waitcnt vmcnt(30)
s_barrier
s_add_u32 s56, s54, 2490368
s_mov_b32 m0, 159744
s_nop 0
buffer_load_dwordx4 v26, s[12:15], s56 offen lds
s_add_u32 s56, s54, 2506752
s_mov_b32 m0, 160768
s_nop 0
buffer_load_dwordx4 v26, s[12:15], s56 offen lds
s_add_u32 s56, s54, 2523136
s_mov_b32 m0, 161792
s_nop 0
buffer_load_dwordx4 v27, s[12:15], s56 offen lds
s_add_u32 s56, s54, 2539520
s_mov_b32 m0, 162816
s_nop 0
buffer_load_dwordx4 v27, s[12:15], s56 offen lds
ds_read_b64_tr_b16 v[128:129], v44 offset:0
ds_read_b64_tr_b16 v[130:131], v44 offset:1024
ds_read_b64_tr_b16 v[132:133], v46 offset:0
ds_read_b64_tr_b16 v[134:135], v46 offset:1024
ds_read_b64_tr_b16 v[136:137], v45 offset:0
ds_read_b64_tr_b16 v[138:139], v45 offset:1024
ds_read_b64_tr_b16 v[140:141], v47 offset:0
ds_read_b64_tr_b16 v[142:143], v47 offset:1024
s_waitcnt lgkmcnt(0)
s_waitcnt vmcnt(30)
s_barrier
s_add_u32 s56, s54, 3538944
s_mov_b32 m0, 131072
s_nop 0
buffer_load_dwordx4 v26, s[12:15], s56 offen lds
s_add_u32 s56, s54, 3555328
s_mov_b32 m0, 132096
s_nop 0
buffer_load_dwordx4 v26, s[12:15], s56 offen lds
s_add_u32 s56, s54, 3571712
s_mov_b32 m0, 133120
s_nop 0
buffer_load_dwordx4 v27, s[12:15], s56 offen lds
s_add_u32 s56, s54, 3588096
s_mov_b32 m0, 134144
s_nop 0
buffer_load_dwordx4 v27, s[12:15], s56 offen lds
ds_read_b64_tr_b16 v[144:145], v44 offset:4096
ds_read_b64_tr_b16 v[146:147], v44 offset:5120
ds_read_b64_tr_b16 v[148:149], v46 offset:4096
ds_read_b64_tr_b16 v[150:151], v46 offset:5120
ds_read_b64_tr_b16 v[152:153], v45 offset:4096
ds_read_b64_tr_b16 v[154:155], v45 offset:5120
ds_read_b64_tr_b16 v[156:157], v47 offset:4096
ds_read_b64_tr_b16 v[158:159], v47 offset:5120
s_waitcnt lgkmcnt(0)
s_waitcnt vmcnt(30)
s_barrier
s_add_u32 s56, s54, 4063232
s_mov_b32 m0, 135168
s_nop 0
buffer_load_dwordx4 v26, s[12:15], s56 offen lds
s_add_u32 s56, s54, 4079616
s_mov_b32 m0, 136192
s_nop 0
buffer_load_dwordx4 v26, s[12:15], s56 offen lds
s_add_u32 s56, s54, 4096000
s_mov_b32 m0, 137216
s_nop 0
buffer_load_dwordx4 v27, s[12:15], s56 offen lds
s_add_u32 s56, s54, 4112384
s_mov_b32 m0, 138240
s_nop 0
buffer_load_dwordx4 v27, s[12:15], s56 offen lds
ds_read_b64_tr_b16 v[160:161], v44 offset:8192
ds_read_b64_tr_b16 v[162:163], v44 offset:9216
ds_read_b64_tr_b16 v[164:165], v46 offset:8192
ds_read_b64_tr_b16 v[166:167], v46 offset:9216
ds_read_b64_tr_b16 v[168:169], v45 offset:8192
ds_read_b64_tr_b16 v[170:171], v45 offset:9216
ds_read_b64_tr_b16 v[172:173], v47 offset:8192
ds_read_b64_tr_b16 v[174:175], v47 offset:9216
s_waitcnt lgkmcnt(0)
s_waitcnt vmcnt(24)
s_barrier
s_add_u32 s56, s54, 4587520
s_mov_b32 m0, 139264
s_nop 0
buffer_load_dwordx4 v26, s[12:15], s56 offen lds
s_add_u32 s56, s54, 4603904
s_mov_b32 m0, 140288
s_nop 0
buffer_load_dwordx4 v26, s[12:15], s56 offen lds
s_add_u32 s56, s54, 4620288
s_mov_b32 m0, 141312
s_nop 0
buffer_load_dwordx4 v27, s[12:15], s56 offen lds
s_add_u32 s56, s54, 4636672
s_mov_b32 m0, 142336
s_nop 0
buffer_load_dwordx4 v27, s[12:15], s56 offen lds
ds_read_b64_tr_b16 v[176:177], v44 offset:12288
ds_read_b64_tr_b16 v[178:179], v44 offset:13312
ds_read_b64_tr_b16 v[180:181], v46 offset:12288
ds_read_b64_tr_b16 v[182:183], v46 offset:13312
ds_read_b64_tr_b16 v[184:185], v45 offset:12288
ds_read_b64_tr_b16 v[186:187], v45 offset:13312
ds_read_b64_tr_b16 v[188:189], v47 offset:12288
ds_read_b64_tr_b16 v[190:191], v47 offset:13312
s_waitcnt lgkmcnt(0)
s_waitcnt vmcnt(24)
s_barrier
s_add_u32 s56, s54, 393216
s_mov_b32 m0, 143360
s_nop 0
buffer_load_dwordx4 v26, s[16:19], s56 offen lds
s_add_u32 s56, s54, 409600
s_mov_b32 m0, 144384
s_nop 0
buffer_load_dwordx4 v26, s[16:19], s56 offen lds
s_add_u32 s56, s54, 425984
s_mov_b32 m0, 145408
s_nop 0
buffer_load_dwordx4 v27, s[16:19], s56 offen lds
s_add_u32 s56, s54, 442368
s_mov_b32 m0, 146432
s_nop 0
buffer_load_dwordx4 v27, s[16:19], s56 offen lds
ds_read_b64_tr_b16 v[192:193], v44 offset:16384
ds_read_b64_tr_b16 v[194:195], v44 offset:17408
ds_read_b64_tr_b16 v[196:197], v46 offset:16384
ds_read_b64_tr_b16 v[198:199], v46 offset:17408
ds_read_b64_tr_b16 v[200:201], v45 offset:16384
ds_read_b64_tr_b16 v[202:203], v45 offset:17408
ds_read_b64_tr_b16 v[204:205], v47 offset:16384
ds_read_b64_tr_b16 v[206:207], v47 offset:17408
s_waitcnt lgkmcnt(0)
s_waitcnt vmcnt(24)
s_barrier
s_add_u32 s56, s54, 917504
s_mov_b32 m0, 147456
s_nop 0
buffer_load_dwordx4 v26, s[16:19], s56 offen lds
s_add_u32 s56, s54, 933888
s_mov_b32 m0, 148480
s_nop 0
buffer_load_dwordx4 v26, s[16:19], s56 offen lds
s_add_u32 s56, s54, 950272
s_mov_b32 m0, 149504
s_nop 0
buffer_load_dwordx4 v27, s[16:19], s56 offen lds
s_add_u32 s56, s54, 966656
s_mov_b32 m0, 150528
s_nop 0
buffer_load_dwordx4 v27, s[16:19], s56 offen lds
ds_read_b64_tr_b16 v[208:209], v44 offset:20480
ds_read_b64_tr_b16 v[210:211], v44 offset:21504
ds_read_b64_tr_b16 v[212:213], v46 offset:20480
ds_read_b64_tr_b16 v[214:215], v46 offset:21504
ds_read_b64_tr_b16 v[216:217], v45 offset:20480
ds_read_b64_tr_b16 v[218:219], v45 offset:21504
ds_read_b64_tr_b16 v[220:221], v47 offset:20480
ds_read_b64_tr_b16 v[222:223], v47 offset:21504
s_waitcnt lgkmcnt(0)
s_waitcnt vmcnt(24)
s_barrier
s_add_u32 s56, s54, 1441792
s_mov_b32 m0, 151552
s_nop 0
buffer_load_dwordx4 v26, s[16:19], s56 offen lds
s_add_u32 s56, s54, 1458176
s_mov_b32 m0, 152576
s_nop 0
buffer_load_dwordx4 v26, s[16:19], s56 offen lds
s_add_u32 s56, s54, 1474560
s_mov_b32 m0, 153600
s_nop 0
buffer_load_dwordx4 v27, s[16:19], s56 offen lds
s_add_u32 s56, s54, 1490944
s_mov_b32 m0, 154624
s_nop 0
buffer_load_dwordx4 v27, s[16:19], s56 offen lds
ds_read_b64_tr_b16 v[224:225], v44 offset:24576
ds_read_b64_tr_b16 v[226:227], v44 offset:25600
ds_read_b64_tr_b16 v[228:229], v46 offset:24576
ds_read_b64_tr_b16 v[230:231], v46 offset:25600
ds_read_b64_tr_b16 v[232:233], v45 offset:24576
ds_read_b64_tr_b16 v[234:235], v45 offset:25600
ds_read_b64_tr_b16 v[236:237], v47 offset:24576
ds_read_b64_tr_b16 v[238:239], v47 offset:25600
s_waitcnt lgkmcnt(0)
s_waitcnt vmcnt(24)
s_barrier
s_add_u32 s56, s54, 1966080
s_mov_b32 m0, 155648
s_nop 0
buffer_load_dwordx4 v26, s[16:19], s56 offen lds
s_add_u32 s56, s54, 1982464
s_mov_b32 m0, 156672
s_nop 0
buffer_load_dwordx4 v26, s[16:19], s56 offen lds
s_add_u32 s56, s54, 1998848
s_mov_b32 m0, 157696
s_nop 0
buffer_load_dwordx4 v27, s[16:19], s56 offen lds
s_add_u32 s56, s54, 2015232
s_mov_b32 m0, 158720
s_nop 0
buffer_load_dwordx4 v27, s[16:19], s56 offen lds
ds_read_b64_tr_b16 v[240:241], v44 offset:28672
ds_read_b64_tr_b16 v[242:243], v44 offset:29696
ds_read_b64_tr_b16 v[244:245], v46 offset:28672
ds_read_b64_tr_b16 v[246:247], v46 offset:29696
ds_read_b64_tr_b16 v[248:249], v45 offset:28672
ds_read_b64_tr_b16 v[250:251], v45 offset:29696
ds_read_b64_tr_b16 v[252:253], v47 offset:28672
ds_read_b64_tr_b16 v[254:255], v47 offset:29696
s_waitcnt lgkmcnt(0)
s_waitcnt vmcnt(24)
s_barrier
s_add_u32 s56, s54, 2490368
s_mov_b32 m0, 159744
s_nop 0
buffer_load_dwordx4 v26, s[16:19], s56 offen lds
s_add_u32 s56, s54, 2506752
s_mov_b32 m0, 160768
s_nop 0
buffer_load_dwordx4 v26, s[16:19], s56 offen lds
s_add_u32 s56, s54, 2523136
s_mov_b32 m0, 161792
s_nop 0
buffer_load_dwordx4 v27, s[16:19], s56 offen lds
s_add_u32 s56, s54, 2539520
s_mov_b32 m0, 162816
s_nop 0
buffer_load_dwordx4 v27, s[16:19], s56 offen lds
ds_read_b64_tr_b16 a[0:1], v44 offset:0
ds_read_b64_tr_b16 a[2:3], v44 offset:1024
ds_read_b64_tr_b16 a[4:5], v46 offset:0
ds_read_b64_tr_b16 a[6:7], v46 offset:1024
ds_read_b64_tr_b16 a[8:9], v45 offset:0
ds_read_b64_tr_b16 a[10:11], v45 offset:1024
ds_read_b64_tr_b16 a[12:13], v47 offset:0
ds_read_b64_tr_b16 a[14:15], v47 offset:1024
s_waitcnt lgkmcnt(0)
s_waitcnt vmcnt(24)
s_barrier
s_add_u32 s56, s54, 3014656
s_mov_b32 m0, 131072
s_nop 0
buffer_load_dwordx4 v26, s[16:19], s56 offen lds
s_add_u32 s56, s54, 3031040
s_mov_b32 m0, 132096
s_nop 0
buffer_load_dwordx4 v26, s[16:19], s56 offen lds
s_add_u32 s56, s54, 3047424
s_mov_b32 m0, 133120
s_nop 0
buffer_load_dwordx4 v27, s[16:19], s56 offen lds
s_add_u32 s56, s54, 3063808
s_mov_b32 m0, 134144
s_nop 0
buffer_load_dwordx4 v27, s[16:19], s56 offen lds
ds_read_b64_tr_b16 a[16:17], v44 offset:4096
ds_read_b64_tr_b16 a[18:19], v44 offset:5120
ds_read_b64_tr_b16 a[20:21], v46 offset:4096
ds_read_b64_tr_b16 a[22:23], v46 offset:5120
ds_read_b64_tr_b16 a[24:25], v45 offset:4096
ds_read_b64_tr_b16 a[26:27], v45 offset:5120
ds_read_b64_tr_b16 a[28:29], v47 offset:4096
ds_read_b64_tr_b16 a[30:31], v47 offset:5120
s_waitcnt lgkmcnt(0)
s_waitcnt vmcnt(24)
s_barrier
s_add_u32 s56, s54, 3538944
s_mov_b32 m0, 135168
s_nop 0
buffer_load_dwordx4 v26, s[16:19], s56 offen lds
s_add_u32 s56, s54, 3555328
s_mov_b32 m0, 136192
s_nop 0
buffer_load_dwordx4 v26, s[16:19], s56 offen lds
s_add_u32 s56, s54, 3571712
s_mov_b32 m0, 137216
s_nop 0
buffer_load_dwordx4 v27, s[16:19], s56 offen lds
s_add_u32 s56, s54, 3588096
s_mov_b32 m0, 138240
s_nop 0
buffer_load_dwordx4 v27, s[16:19], s56 offen lds
ds_read_b64_tr_b16 a[32:33], v44 offset:8192
ds_read_b64_tr_b16 a[34:35], v44 offset:9216
ds_read_b64_tr_b16 a[36:37], v46 offset:8192
ds_read_b64_tr_b16 a[38:39], v46 offset:9216
ds_read_b64_tr_b16 a[40:41], v45 offset:8192
ds_read_b64_tr_b16 a[42:43], v45 offset:9216
ds_read_b64_tr_b16 a[44:45], v47 offset:8192
ds_read_b64_tr_b16 a[46:47], v47 offset:9216
s_waitcnt lgkmcnt(0)
s_waitcnt vmcnt(24)
s_barrier
s_add_u32 s56, s54, 4063232
s_mov_b32 m0, 139264
s_nop 0
buffer_load_dwordx4 v26, s[16:19], s56 offen lds
s_add_u32 s56, s54, 4079616
s_mov_b32 m0, 140288
s_nop 0
buffer_load_dwordx4 v26, s[16:19], s56 offen lds
s_add_u32 s56, s54, 4096000
s_mov_b32 m0, 141312
s_nop 0
buffer_load_dwordx4 v27, s[16:19], s56 offen lds
s_add_u32 s56, s54, 4112384
s_mov_b32 m0, 142336
s_nop 0
buffer_load_dwordx4 v27, s[16:19], s56 offen lds
ds_read_b64_tr_b16 a[48:49], v44 offset:12288
ds_read_b64_tr_b16 a[50:51], v44 offset:13312
ds_read_b64_tr_b16 a[52:53], v46 offset:12288
ds_read_b64_tr_b16 a[54:55], v46 offset:13312
ds_read_b64_tr_b16 a[56:57], v45 offset:12288
ds_read_b64_tr_b16 a[58:59], v45 offset:13312
ds_read_b64_tr_b16 a[60:61], v47 offset:12288
ds_read_b64_tr_b16 a[62:63], v47 offset:13312
s_waitcnt lgkmcnt(0)
s_waitcnt vmcnt(24)
s_barrier
s_add_u32 s56, s55, 115200
s_mov_b32 m0, 143360
s_nop 0
buffer_load_dwordx4 v28, s[20:23], s56 offen lds
s_add_u32 s56, s55, 117504
s_mov_b32 m0, 144384
s_nop 0
buffer_load_dwordx4 v28, s[20:23], s56 offen lds
s_add_u32 s56, s55, 124416
s_mov_b32 m0, 145408
s_nop 0
buffer_load_dwordx4 v28, s[20:23], s56 offen lds
s_add_u32 s56, s55, 126720
s_mov_b32 m0, 146432
s_nop 0
buffer_load_dwordx4 v28, s[20:23], s56 offen lds
ds_read_b64_tr_b16 a[64:65], v44 offset:16384
ds_read_b64_tr_b16 a[66:67], v44 offset:17408
ds_read_b64_tr_b16 a[68:69], v46 offset:16384
ds_read_b64_tr_b16 a[70:71], v46 offset:17408
ds_read_b64_tr_b16 a[72:73], v45 offset:16384
ds_read_b64_tr_b16 a[74:75], v45 offset:17408
ds_read_b64_tr_b16 a[76:77], v47 offset:16384
ds_read_b64_tr_b16 a[78:79], v47 offset:17408
s_waitcnt lgkmcnt(0)
s_waitcnt vmcnt(24)
s_barrier
s_add_u32 s56, s55, 115456
s_mov_b32 m0, 147456
s_nop 0
buffer_load_dwordx4 v28, s[20:23], s56 offen lds
s_add_u32 s56, s55, 117760
s_mov_b32 m0, 148480
s_nop 0
buffer_load_dwordx4 v28, s[20:23], s56 offen lds
s_add_u32 s56, s55, 124672
s_mov_b32 m0, 149504
s_nop 0
buffer_load_dwordx4 v28, s[20:23], s56 offen lds
s_add_u32 s56, s55, 126976
s_mov_b32 m0, 150528
s_nop 0
buffer_load_dwordx4 v28, s[20:23], s56 offen lds
ds_read_b64_tr_b16 a[80:81], v44 offset:20480
ds_read_b64_tr_b16 a[82:83], v44 offset:21504
ds_read_b64_tr_b16 a[84:85], v46 offset:20480
ds_read_b64_tr_b16 a[86:87], v46 offset:21504
ds_read_b64_tr_b16 a[88:89], v45 offset:20480
ds_read_b64_tr_b16 a[90:91], v45 offset:21504
ds_read_b64_tr_b16 a[92:93], v47 offset:20480
ds_read_b64_tr_b16 a[94:95], v47 offset:21504
s_waitcnt lgkmcnt(0)
s_waitcnt vmcnt(24)
s_barrier
s_add_u32 s56, s55, 115712
s_mov_b32 m0, 151552
s_nop 0
buffer_load_dwordx4 v28, s[20:23], s56 offen lds
s_add_u32 s56, s55, 118016
s_mov_b32 m0, 152576
s_nop 0
buffer_load_dwordx4 v28, s[20:23], s56 offen lds
s_add_u32 s56, s55, 124928
s_mov_b32 m0, 153600
s_nop 0
buffer_load_dwordx4 v28, s[20:23], s56 offen lds
s_add_u32 s56, s55, 127232
s_mov_b32 m0, 154624
s_nop 0
buffer_load_dwordx4 v28, s[20:23], s56 offen lds
ds_read_b64_tr_b16 a[96:97], v44 offset:24576
ds_read_b64_tr_b16 a[98:99], v44 offset:25600
ds_read_b64_tr_b16 a[100:101], v46 offset:24576
ds_read_b64_tr_b16 a[102:103], v46 offset:25600
ds_read_b64_tr_b16 a[104:105], v45 offset:24576
ds_read_b64_tr_b16 a[106:107], v45 offset:25600
ds_read_b64_tr_b16 a[108:109], v47 offset:24576
ds_read_b64_tr_b16 a[110:111], v47 offset:25600
s_waitcnt lgkmcnt(0)
s_waitcnt vmcnt(24)
s_barrier
s_add_u32 s56, s55, 115968
s_mov_b32 m0, 155648
s_nop 0
buffer_load_dwordx4 v28, s[20:23], s56 offen lds
s_add_u32 s56, s55, 118272
s_mov_b32 m0, 156672
s_nop 0
buffer_load_dwordx4 v28, s[20:23], s56 offen lds
s_add_u32 s56, s55, 125184
s_mov_b32 m0, 157696
s_nop 0
buffer_load_dwordx4 v28, s[20:23], s56 offen lds
s_add_u32 s56, s55, 127488
s_mov_b32 m0, 158720
s_nop 0
buffer_load_dwordx4 v28, s[20:23], s56 offen lds
ds_read_b64_tr_b16 a[112:113], v44 offset:28672
ds_read_b64_tr_b16 a[114:115], v44 offset:29696
ds_read_b64_tr_b16 a[116:117], v46 offset:28672
ds_read_b64_tr_b16 a[118:119], v46 offset:29696
ds_read_b64_tr_b16 a[120:121], v45 offset:28672
ds_read_b64_tr_b16 a[122:123], v45 offset:29696
ds_read_b64_tr_b16 a[124:125], v47 offset:28672
ds_read_b64_tr_b16 a[126:127], v47 offset:29696
s_waitcnt lgkmcnt(0)
s_waitcnt vmcnt(24)
s_barrier
s_add_u32 s56, s55, 41472
s_mov_b32 m0, 159744
s_nop 0
buffer_load_dwordx4 v28, s[20:23], s56 offen lds
s_add_u32 s56, s55, 43776
s_mov_b32 m0, 160768
s_nop 0
buffer_load_dwordx4 v28, s[20:23], s56 offen lds
s_add_u32 s56, s55, 50688
s_mov_b32 m0, 161792
s_nop 0
buffer_load_dwordx4 v28, s[20:23], s56 offen lds
s_add_u32 s56, s55, 52992
s_mov_b32 m0, 162816
s_nop 0
buffer_load_dwordx4 v28, s[20:23], s56 offen lds
ds_read_b64_tr_b16 a[128:129], v44 offset:0
ds_read_b64_tr_b16 a[130:131], v44 offset:1024
ds_read_b64_tr_b16 a[132:133], v46 offset:0
ds_read_b64_tr_b16 a[134:135], v46 offset:1024
ds_read_b64_tr_b16 a[136:137], v45 offset:0
ds_read_b64_tr_b16 a[138:139], v45 offset:1024
ds_read_b64_tr_b16 a[140:141], v47 offset:0
ds_read_b64_tr_b16 a[142:143], v47 offset:1024
buffer_load_dword v32, v24, s[28:31], 0 offen sc0 sc1
s_waitcnt lgkmcnt(0)
s_waitcnt vmcnt(25)
s_barrier
s_add_u32 s56, s54, 393216
s_mov_b32 m0, 131072
s_nop 0
buffer_load_dwordx4 v26, s[8:11], s56 offen lds
s_add_u32 s56, s54, 409600
s_mov_b32 m0, 132096
s_nop 0
buffer_load_dwordx4 v26, s[8:11], s56 offen lds
s_add_u32 s56, s54, 425984
s_mov_b32 m0, 133120
s_nop 0
buffer_load_dwordx4 v27, s[8:11], s56 offen lds
s_add_u32 s56, s54, 442368
s_mov_b32 m0, 134144
s_nop 0
buffer_load_dwordx4 v27, s[8:11], s56 offen lds
ds_read_b64_tr_b16 a[144:145], v44 offset:4096
ds_read_b64_tr_b16 a[146:147], v44 offset:5120
ds_read_b64_tr_b16 a[148:149], v46 offset:4096
ds_read_b64_tr_b16 a[150:151], v46 offset:5120
ds_read_b64_tr_b16 a[152:153], v45 offset:4096
ds_read_b64_tr_b16 a[154:155], v45 offset:5120
ds_read_b64_tr_b16 a[156:157], v47 offset:4096
ds_read_b64_tr_b16 a[158:159], v47 offset:5120
s_waitcnt lgkmcnt(0)
s_waitcnt vmcnt(25)
s_barrier
s_add_u32 s56, s54, 1966080
s_mov_b32 m0, 135168
s_nop 0
buffer_load_dwordx4 v26, s[8:11], s56 offen lds
s_add_u32 s56, s54, 1982464
s_mov_b32 m0, 136192
s_nop 0
buffer_load_dwordx4 v26, s[8:11], s56 offen lds
s_add_u32 s56, s54, 1998848
s_mov_b32 m0, 137216
s_nop 0
buffer_load_dwordx4 v27, s[8:11], s56 offen lds
s_add_u32 s56, s54, 2015232
s_mov_b32 m0, 138240
s_nop 0
buffer_load_dwordx4 v27, s[8:11], s56 offen lds
ds_read_b64_tr_b16 a[160:161], v44 offset:8192
ds_read_b64_tr_b16 a[162:163], v44 offset:9216
ds_read_b64_tr_b16 a[164:165], v46 offset:8192
ds_read_b64_tr_b16 a[166:167], v46 offset:9216
ds_read_b64_tr_b16 a[168:169], v45 offset:8192
ds_read_b64_tr_b16 a[170:171], v45 offset:9216
ds_read_b64_tr_b16 a[172:173], v47 offset:8192
ds_read_b64_tr_b16 a[174:175], v47 offset:9216
s_waitcnt lgkmcnt(0)
s_waitcnt vmcnt(25)
s_barrier
s_add_u32 s56, s54, 2490368
s_mov_b32 m0, 139264
s_nop 0
buffer_load_dwordx4 v26, s[8:11], s56 offen lds
s_add_u32 s56, s54, 2506752
s_mov_b32 m0, 140288
s_nop 0
buffer_load_dwordx4 v26, s[8:11], s56 offen lds
s_add_u32 s56, s54, 2523136
s_mov_b32 m0, 141312
s_nop 0
buffer_load_dwordx4 v27, s[8:11], s56 offen lds
s_add_u32 s56, s54, 2539520
s_mov_b32 m0, 142336
s_nop 0
buffer_load_dwordx4 v27, s[8:11], s56 offen lds
ds_read_b64_tr_b16 a[216:217], v48 offset:12288
ds_read_b64_tr_b16 a[218:219], v48 offset:13312
ds_read_b64_tr_b16 a[220:221], v48 offset:14336
ds_read_b64_tr_b16 a[222:223], v48 offset:15360
ds_read_b64_tr_b16 a[176:177], v49 offset:12288
ds_read_b64_tr_b16 a[178:179], v49 offset:13312
ds_read_b64_tr_b16 a[180:181], v49 offset:14336
ds_read_b64_tr_b16 a[182:183], v49 offset:15360
s_waitcnt lgkmcnt(0)
s_waitcnt vmcnt(25)
s_barrier
s_add_u32 s56, s54, 3014656
s_mov_b32 m0, 143360
s_nop 0
buffer_load_dwordx4 v26, s[12:15], s56 offen lds
s_add_u32 s56, s54, 3031040
s_mov_b32 m0, 144384
s_nop 0
buffer_load_dwordx4 v26, s[12:15], s56 offen lds
s_add_u32 s56, s54, 3047424
s_mov_b32 m0, 145408
s_nop 0
buffer_load_dwordx4 v27, s[12:15], s56 offen lds
s_add_u32 s56, s54, 3063808
s_mov_b32 m0, 146432
s_nop 0
buffer_load_dwordx4 v27, s[12:15], s56 offen lds
ds_read_b64_tr_b16 a[232:233], v48 offset:16384
ds_read_b64_tr_b16 a[234:235], v48 offset:17408
ds_read_b64_tr_b16 a[236:237], v48 offset:18432
ds_read_b64_tr_b16 a[238:239], v48 offset:19456
ds_read_b64_tr_b16 a[184:185], v49 offset:16384
ds_read_b64_tr_b16 a[186:187], v49 offset:17408
ds_read_b64_tr_b16 a[188:189], v49 offset:18432
ds_read_b64_tr_b16 a[190:191], v49 offset:19456
s_waitcnt lgkmcnt(0)
s_waitcnt vmcnt(25)
s_barrier
s_add_u32 s56, s54, 4587520
s_mov_b32 m0, 147456
s_nop 0
buffer_load_dwordx4 v26, s[16:19], s56 offen lds
s_add_u32 s56, s54, 4603904
s_mov_b32 m0, 148480
s_nop 0
buffer_load_dwordx4 v26, s[16:19], s56 offen lds
s_add_u32 s56, s54, 4620288
s_mov_b32 m0, 149504
s_nop 0
buffer_load_dwordx4 v27, s[16:19], s56 offen lds
s_add_u32 s56, s54, 4636672
s_mov_b32 m0, 150528
s_nop 0
buffer_load_dwordx4 v27, s[16:19], s56 offen lds
ds_read_b64_tr_b16 a[240:241], v48 offset:20480
ds_read_b64_tr_b16 a[242:243], v48 offset:21504
ds_read_b64_tr_b16 a[244:245], v48 offset:22528
ds_read_b64_tr_b16 a[246:247], v48 offset:23552
ds_read_b64_tr_b16 a[192:193], v49 offset:20480
ds_read_b64_tr_b16 a[194:195], v49 offset:21504
ds_read_b64_tr_b16 a[196:197], v49 offset:22528
ds_read_b64_tr_b16 a[198:199], v49 offset:23552
s_waitcnt lgkmcnt(0)
s_waitcnt vmcnt(25)
s_barrier
s_add_u32 s56, s55, 41728
s_mov_b32 m0, 151552
s_nop 0
buffer_load_dwordx4 v28, s[20:23], s56 offen lds
s_add_u32 s56, s55, 44032
s_mov_b32 m0, 152576
s_nop 0
buffer_load_dwordx4 v28, s[20:23], s56 offen lds
s_add_u32 s56, s55, 50944
s_mov_b32 m0, 153600
s_nop 0
buffer_load_dwordx4 v28, s[20:23], s56 offen lds
s_add_u32 s56, s55, 53248
s_mov_b32 m0, 154624
s_nop 0
buffer_load_dwordx4 v28, s[20:23], s56 offen lds
ds_read_b64_tr_b16 a[248:249], v48 offset:24576
ds_read_b64_tr_b16 a[250:251], v48 offset:25600
ds_read_b64_tr_b16 a[252:253], v48 offset:26624
ds_read_b64_tr_b16 a[254:255], v48 offset:27648
ds_read_b64_tr_b16 a[200:201], v49 offset:24576
ds_read_b64_tr_b16 a[202:203], v49 offset:25600
ds_read_b64_tr_b16 a[204:205], v49 offset:26624
ds_read_b64_tr_b16 a[206:207], v49 offset:27648
s_waitcnt lgkmcnt(0)
s_waitcnt vmcnt(25)
s_barrier
s_add_u32 s56, s55, 41984
s_mov_b32 m0, 155648
s_nop 0
buffer_load_dwordx4 v28, s[20:23], s56 offen lds
s_add_u32 s56, s55, 44288
s_mov_b32 m0, 156672
s_nop 0
buffer_load_dwordx4 v28, s[20:23], s56 offen lds
s_add_u32 s56, s55, 51200
s_mov_b32 m0, 157696
s_nop 0
buffer_load_dwordx4 v28, s[20:23], s56 offen lds
s_add_u32 s56, s55, 53504
s_mov_b32 m0, 158720
s_nop 0
buffer_load_dwordx4 v28, s[20:23], s56 offen lds
ds_read_b64_tr_b16 a[224:225], v48 offset:28672
ds_read_b64_tr_b16 a[226:227], v48 offset:29696
ds_read_b64_tr_b16 a[228:229], v48 offset:30720
ds_read_b64_tr_b16 a[230:231], v48 offset:31744
ds_read_b64_tr_b16 a[208:209], v49 offset:28672
ds_read_b64_tr_b16 a[210:211], v49 offset:29696
ds_read_b64_tr_b16 a[212:213], v49 offset:30720
ds_read_b64_tr_b16 a[214:215], v49 offset:31744
s_waitcnt lgkmcnt(0)
s_waitcnt vmcnt(24)
s_barrier
s_add_u32 s56, s55, 42240
s_mov_b32 m0, 159744
s_nop 0
buffer_load_dwordx4 v28, s[20:23], s56 offen lds
s_add_u32 s56, s55, 44544
s_mov_b32 m0, 160768
s_nop 0
buffer_load_dwordx4 v28, s[20:23], s56 offen lds
s_add_u32 s56, s55, 51456
s_mov_b32 m0, 161792
s_nop 0
buffer_load_dwordx4 v28, s[20:23], s56 offen lds
s_add_u32 s56, s55, 53760
s_mov_b32 m0, 162816
s_nop 0
buffer_load_dwordx4 v28, s[20:23], s56 offen lds
ds_read_b64_tr_b16 v[60:61], v44 offset:0
ds_read_b64_tr_b16 v[62:63], v44 offset:1024
ds_read_b64_tr_b16 v[64:65], v46 offset:0
ds_read_b64_tr_b16 v[66:67], v46 offset:1024
ds_read_b64_tr_b16 v[68:69], v45 offset:0
ds_read_b64_tr_b16 v[70:71], v45 offset:1024
ds_read_b64_tr_b16 v[72:73], v47 offset:0
ds_read_b64_tr_b16 v[74:75], v47 offset:1024
s_waitcnt lgkmcnt(0)
s_waitcnt vmcnt(24)
s_barrier
ds_write_b128 v2, v[60:63] offset:0
ds_write_b128 v2, v[64:67] offset:1024
ds_write_b128 v2, v[68:71] offset:2048
ds_write_b128 v2, v[72:75] offset:3072
ds_read_b64_tr_b16 v[60:61], v44 offset:4096
ds_read_b64_tr_b16 v[62:63], v44 offset:5120
ds_read_b64_tr_b16 v[64:65], v46 offset:4096
ds_read_b64_tr_b16 v[66:67], v46 offset:5120
ds_read_b64_tr_b16 v[68:69], v45 offset:4096
ds_read_b64_tr_b16 v[70:71], v45 offset:5120
ds_read_b64_tr_b16 v[72:73], v47 offset:4096
ds_read_b64_tr_b16 v[74:75], v47 offset:5120
L_rdv_w3:
v_readfirstlane_b32 s38, v32
s_nop 0
s_and_b32 s57, s38, 0xff
s_cmp_lg_u32 s57, 32
s_cbranch_scc1 L_rdv2_w3
L_kvw_w3p:
s_load_dwordx16 s[64:79], s[4:5], s101 glc
s_sub_u32 s41, s41, 1
s_cbranch_scc1 L_exit
s_waitcnt lgkmcnt(0)
s_min_u32 s64, s64, s65
s_min_u32 s64, s64, s66
s_min_u32 s64, s64, s67
s_min_u32 s64, s64, s68
s_min_u32 s64, s64, s69
s_min_u32 s64, s64, s70
s_min_u32 s64, s64, s71
s_min_u32 s64, s64, s72
s_min_u32 s64, s64, s73
s_min_u32 s64, s64, s74
s_min_u32 s64, s64, s75
s_min_u32 s64, s64, s76
s_min_u32 s64, s64, s77
s_min_u32 s64, s64, s78
s_min_u32 s64, s64, s79
s_lshl_b32 s100, s64, 2
s_sub_u32 s100, s100, 1
s_cmp_ge_i32 s34, s100
s_cbranch_scc1 L_kvw_w3p
s_waitcnt lgkmcnt(0)
s_waitcnt vmcnt(20)
s_barrier
ds_write_b128 v2, v[60:63] offset:4096
ds_write_b128 v2, v[64:67] offset:5120
ds_write_b128 v2, v[68:71] offset:6144
ds_write_b128 v2, v[72:75] offset:7168
ds_read_b64_tr_b16 v[60:61], v44 offset:8192
ds_read_b64_tr_b16 v[62:63], v44 offset:9216
ds_read_b64_tr_b16 v[64:65], v46 offset:8192
ds_read_b64_tr_b16 v[66:67], v46 offset:9216
ds_read_b64_tr_b16 v[68:69], v45 offset:8192
ds_read_b64_tr_b16 v[70:71], v45 offset:9216
ds_read_b64_tr_b16 v[72:73], v47 offset:8192
ds_read_b64_tr_b16 v[74:75], v47 offset:9216
buffer_load_dwordx4 v[12:15], v9, s[4:7], s37 offen offset:0
buffer_load_dwordx4 v[16:19], v9, s[4:7], s37 offen offset:1024
buffer_load_dwordx4 v[52:55], v1, s[4:7], s37 offen offset:2048
buffer_load_dwordx4 v[56:59], v1, s[4:7], s37 offen offset:3072
s_mov_b32 m0, 1024
s_nop 0
buffer_load_dwordx4 v1, s[4:7], s47 offen offset:3072 sc1 lds
s_waitcnt lgkmcnt(0)
s_waitcnt vmcnt(21)
s_barrier
ds_write_b128 v2, v[60:63] offset:8192
ds_write_b128 v2, v[64:67] offset:9216
ds_write_b128 v2, v[68:71] offset:10240
ds_write_b128 v2, v[72:75] offset:11264
ds_read_b64_tr_b16 v[60:61], v44 offset:12288
ds_read_b64_tr_b16 v[62:63], v44 offset:13312
ds_read_b64_tr_b16 v[64:65], v46 offset:12288
ds_read_b64_tr_b16 v[66:67], v46 offset:13312
ds_read_b64_tr_b16 v[68:69], v45 offset:12288
ds_read_b64_tr_b16 v[70:71], v45 offset:13312
ds_read_b64_tr_b16 v[72:73], v47 offset:12288
ds_read_b64_tr_b16 v[74:75], v47 offset:13312
s_waitcnt lgkmcnt(0)
s_waitcnt vmcnt(17)
s_barrier
ds_write_b128 v2, v[60:63] offset:12288
ds_write_b128 v2, v[64:67] offset:13312
ds_write_b128 v2, v[68:71] offset:14336
ds_write_b128 v2, v[72:75] offset:15360
ds_read_b64_tr_b16 v[60:61], v44 offset:16384
ds_read_b64_tr_b16 v[62:63], v44 offset:17408
ds_read_b64_tr_b16 v[64:65], v46 offset:16384
ds_read_b64_tr_b16 v[66:67], v46 offset:17408
ds_read_b64_tr_b16 v[68:69], v45 offset:16384
ds_read_b64_tr_b16 v[70:71], v45 offset:17408
ds_read_b64_tr_b16 v[72:73], v47 offset:16384
ds_read_b64_tr_b16 v[74:75], v47 offset:17408
s_waitcnt lgkmcnt(0)
s_waitcnt vmcnt(13)
s_barrier
ds_write_b128 v2, v[60:63] offset:16384
ds_write_b128 v2, v[64:67] offset:17408
ds_write_b128 v2, v[68:71] offset:18432
ds_write_b128 v2, v[72:75] offset:19456
ds_read_b64_tr_b16 v[60:61], v48 offset:20480
ds_read_b64_tr_b16 v[62:63], v48 offset:21504
ds_read_b64_tr_b16 v[64:65], v48 offset:22528
ds_read_b64_tr_b16 v[66:67], v48 offset:23552
ds_read_b64_tr_b16 v[68:69], v49 offset:20480
ds_read_b64_tr_b16 v[70:71], v49 offset:21504
ds_read_b64_tr_b16 v[72:73], v49 offset:22528
ds_read_b64_tr_b16 v[74:75], v49 offset:23552
s_waitcnt lgkmcnt(0)
s_waitcnt vmcnt(9)
s_barrier
ds_write_b128 v2, v[60:63] offset:20480
ds_write_b128 v2, v[64:67] offset:21504
ds_write_b128 v2, v[68:71] offset:22528
ds_write_b128 v2, v[72:75] offset:23552
ds_read_b64_tr_b16 v[60:61], v48 offset:24576
ds_read_b64_tr_b16 v[62:63], v48 offset:25600
ds_read_b64_tr_b16 v[64:65], v48 offset:26624
ds_read_b64_tr_b16 v[66:67], v48 offset:27648
ds_read_b64_tr_b16 v[68:69], v49 offset:24576
ds_read_b64_tr_b16 v[70:71], v49 offset:25600
ds_read_b64_tr_b16 v[72:73], v49 offset:26624
ds_read_b64_tr_b16 v[74:75], v49 offset:27648
s_waitcnt lgkmcnt(0)
s_waitcnt vmcnt(5)
s_barrier
ds_write_b128 v2, v[60:63] offset:24576
ds_write_b128 v2, v[64:67] offset:25600
ds_write_b128 v2, v[68:71] offset:26624
ds_write_b128 v2, v[72:75] offset:27648
ds_read_b64_tr_b16 v[60:61], v48 offset:28672
ds_read_b64_tr_b16 v[62:63], v48 offset:29696
ds_read_b64_tr_b16 v[64:65], v48 offset:30720
ds_read_b64_tr_b16 v[66:67], v48 offset:31744
ds_read_b64_tr_b16 v[68:69], v49 offset:28672
ds_read_b64_tr_b16 v[70:71], v49 offset:29696
ds_read_b64_tr_b16 v[72:73], v49 offset:30720
ds_read_b64_tr_b16 v[74:75], v49 offset:31744
s_waitcnt lgkmcnt(0)
s_barrier
ds_write_b128 v2, v[60:63] offset:28672
ds_write_b128 v2, v[64:67] offset:29696
ds_write_b128 v2, v[68:71] offset:30720
ds_write_b128 v2, v[72:75] offset:31744
s_lshl_b32 s57, s58, 5
s_mov_b32 s0, 0x3f003f00
s_mov_b32 s1, 0x3f003f00
s_mov_b32 s58, 304128
s_cmp_eq_u32 s38, s57
s_mov_b32 s56, 0x33333333
s_mov_b32 s57, 0x33333333
s_mov_b32 s2, 0x21800000
s_mov_b32 s55, -24
s_cbranch_scc0 L_slow_w3
v_mov_b64 v[20:21], 0
v_mov_b64 v[22:23], 0
v_mov_b64 v[24:25], 0
v_mov_b64 v[26:27], 0
v_mov_b64 v[28:29], 0
v_mov_b64 v[30:31], 0
v_mov_b64 v[32:33], 0
v_mov_b64 v[34:35], 0
v_mov_b64 v[36:37], 0
v_mov_b64 v[38:39], 0
v_mov_b64 v[40:41], 0
v_mov_b64 v[42:43], 0
ds_read_b128 v[44:47], v2 offset:0
ds_read_b128 v[48:51], v2 offset:1024
v_bfe_u32 v77, v1, 6, 1
v_lshl_add_u32 v77, v77, 3, v1
v_lshlrev_b32 v77, 1, v77
v_lshlrev_b32 v78, 3, v1
s_waitcnt vmcnt(0) lgkmcnt(0)
s_branch L_top_w3f
L_done_w3f:
s_waitcnt vmcnt(0) lgkmcnt(0)
s_endpgm
L_rdv2_w3:
buffer_load_dword v32, v24, s[28:31], 0 offen sc0 sc1
s_sub_u32 s41, s41, 1
s_cbranch_scc1 L_exit
s_waitcnt vmcnt(0)
s_branch L_rdv_w3
L_ra0_w3f:
s_mov_b32 m0, 1024
s_nop 0
buffer_load_dwordx4 v1, s[4:7], s47 offen offset:0 sc1 lds
buffer_load_dwordx4 v1, s[4:7], s47 offen offset:1024 sc1 lds
buffer_load_dwordx4 v1, s[4:7], s47 offen offset:2048 sc1 lds
buffer_load_dwordx4 v1, s[4:7], s47 offen offset:3072 sc1 lds
s_sub_u32 s41, s41, 1
s_cbranch_scc1 L_exit
ds_read_b128 v[44:47], v2 offset:0
ds_read_b128 v[48:51], v2 offset:1024
v_mov_b64 v[20:21], 0
v_mov_b64 v[22:23], 0
v_mov_b64 v[24:25], 0
v_mov_b64 v[26:27], 0
v_mov_b64 v[28:29], 0
v_mov_b64 v[30:31], 0
v_mov_b64 v[32:33], 0
v_mov_b64 v[34:35], 0
v_mov_b64 v[36:37], 0
v_mov_b64 v[38:39], 0
v_mov_b64 v[40:41], 0
v_mov_b64 v[42:43], 0
s_waitcnt vmcnt(0)
ds_read_b128 v[60:63], v1 offset:1024
ds_read_b128 v[64:67], v1 offset:2048
ds_read_b128 v[68:71], v1 offset:3072
ds_read_b128 v[72:75], v1 offset:4096
s_branch L_s0_w3f
L_ra1_w3f:
L_ra2_w3f:
s_waitcnt lgkmcnt(0)
s_barrier
s_mov_b32 m0, 5120
s_nop 0
buffer_load_dwordx4 v1, s[4:7], s48 offen offset:3072 sc1 lds
s_sub_u32 s41, s41, 1
s_cbranch_scc1 L_exit
s_waitcnt vmcnt(0)
s_barrier
ds_read_b128 v[76:79], v1 offset:5120
ds_read_b128 v[60:63], v1 offset:6144
ds_read_b128 v[64:67], v1 offset:7168
ds_read_b128 v[68:71], v1 offset:8192
ds_read_b128 v[72:75], v1 offset:9216
s_waitcnt lgkmcnt(0)
v_bitop3_b32 v6, v76, v60, s35 bitop3:0x7e
v_bitop3_b32 v6, v6, v64, s35 bitop3:0xf6
v_bitop3_b32 v6, v6, v68, s35 bitop3:0xf6
v_bitop3_b32 v6, v6, v72, s35 bitop3:0xf6
v_and_b32 v6, 1, v6
v_cmp_ne_u32 vcc, 0, v6

s_cbranch_vccnz L_ra2_w3f
s_branch L_a1_w3f
L_mx_w3f:
s_waitcnt lgkmcnt(0)
v_max3_f32 v30, v12, v13, v28
v_max_f32 v30, v30, v29
v_mov_b32 v31, v30
s_nop 1
v_permlane16_swap_b32 v30, v31
v_max_f32 v30, v30, v31
v_mov_b32 v31, v30
s_nop 1
v_permlane32_swap_b32 v30, v31
v_max_f32 v30, v30, v31
ds_write_b32 v1, v30 offset:10252
s_waitcnt lgkmcnt(0)
s_barrier
ds_read_b128 v[32:35], v1 offset:10240
s_waitcnt lgkmcnt(0)
v_max3_f32 v32, v32, v33, v34
v_max_f32 v32, v32, v35
v_sub_f32 v14, v12, v32
v_sub_f32 v15, v13, v32
v_sub_f32 v30, v28, v32
v_sub_f32 v31, v29, v32
v_exp_f32 v14, v14
v_exp_f32 v15, v15
v_exp_f32 v30, v30
v_exp_f32 v31, v31
v_cvt_pk_bf16_f32 v14, v14, v15
v_cvt_pk_bf16_f32 v30, v30, v31
ds_write_b32 v5, v14 offset:15136
v_cndmask_b32_e64 v26, 0, v30, s[56:57]
v_cndmask_b32_e64 v27, 0, v30, s[56:57]
v_mov_b64 v[76:77], s[52:53]
v_mov_b64 v[78:79], s[52:53]
v_mov_b32_dpp v24, v26 quad_perm:[2,3,0,1] row_mask:0xf bank_mask:0xf
v_mov_b32_dpp v25, v26 quad_perm:[2,3,0,1] row_mask:0xf bank_mask:0xf
s_waitcnt lgkmcnt(0)
s_barrier
v_mov_b64 v[14:15], s[0:1]
ds_read_b128 v[16:19], v1 offset:14368
ds_read_b128 v[36:39], v1 offset:14336
s_waitcnt lgkmcnt(0)
v_mfma_f32_16x16x32_bf16 v[32:35], v[76:79], v[16:19], 0
v_mfma_f32_16x16x32_bf16 v[20:23], v[52:55], v[16:19], 0
v_mfma_f32_16x16x32_bf16 v[20:23], v[56:59], v[36:39], v[20:23]
v_mfma_f32_16x16x16_bf16 v[32:35], v[14:15], v[26:27], v[32:35]
v_mfma_f32_16x16x32_bf16 v[20:23], v[40:43], v[24:27], v[20:23]
s_nop 3
v_rcp_f32 v33, v32
s_nop 2
v_mul_f32_dpp v20, v33, v20 quad_perm:[0,1,0,1] row_mask:0xf bank_mask:0xf
v_mul_f32_dpp v21, v33, v21 quad_perm:[0,1,0,1] row_mask:0xf bank_mask:0xf
v_mul_f32_dpp v22, v33, v22 quad_perm:[0,1,0,1] row_mask:0xf bank_mask:0xf
v_mul_f32_dpp v23, v33, v23 quad_perm:[0,1,0,1] row_mask:0xf bank_mask:0xf
v_cvt_pk_bf16_f32 v20, v20, v21
v_cvt_pk_bf16_f32 v21, v22, v23
ds_write_b64 v6, v[20:21] offset:8192
v_mov_b32_dpp v16, v20 quad_perm:[0,1,0,1] row_mask:0xf bank_mask:0xf
v_mov_b32_dpp v17, v21 quad_perm:[0,1,0,1] row_mask:0xf bank_mask:0xf
v_mov_b32_dpp v18, v20 quad_perm:[2,3,2,3] row_mask:0xf bank_mask:0xf
v_mov_b32_dpp v19, v21 quad_perm:[2,3,2,3] row_mask:0xf bank_mask:0xf
v_mov_b64 v[76:77], 0
v_mov_b64 v[78:79], 0
v_mov_b64 v[36:37], 0
v_mov_b64 v[38:39], 0
v_mov_b64 v[24:25], 0
v_mov_b64 v[26:27], 0
v_mov_b64 v[32:33], 0
v_mov_b64 v[34:35], 0
s_waitcnt lgkmcnt(0)
s_branch L_mxb_w3f

L_ev_w3f:
buffer_load_dword v10, v11, s[4:7], s101 offen sc0 sc1
s_sub_u32 s41, s41, 1
s_cbranch_scc1 L_exit
s_waitcnt vmcnt(0)
s_branch L_evb_w3f
L_slow_w3:
v_mov_b64 v[20:21], 0
v_mov_b64 v[22:23], 0
v_mov_b64 v[24:25], 0
v_mov_b64 v[26:27], 0
v_mov_b64 v[28:29], 0
v_mov_b64 v[30:31], 0
v_mov_b64 v[32:33], 0
v_mov_b64 v[34:35], 0
v_mov_b64 v[36:37], 0
v_mov_b64 v[38:39], 0
v_mov_b64 v[40:41], 0
v_mov_b64 v[42:43], 0
ds_read_b128 v[44:47], v2 offset:0
ds_read_b128 v[48:51], v2 offset:1024
v_bfe_u32 v77, v1, 6, 1
v_lshl_add_u32 v77, v77, 3, v1
v_lshlrev_b32 v77, 1, v77
v_lshlrev_b32 v78, 3, v1
s_waitcnt vmcnt(0) lgkmcnt(0)
s_branch L_top_w3s
L_done_w3s:
s_waitcnt vmcnt(0) lgkmcnt(0)
s_endpgm
L_ra0_w3s:
s_mov_b32 m0, 1024
s_nop 0
buffer_load_dwordx4 v1, s[4:7], s47 offen offset:0 sc0 sc1 lds
buffer_load_dwordx4 v1, s[4:7], s47 offen offset:1024 sc0 sc1 lds
buffer_load_dwordx4 v1, s[4:7], s47 offen offset:2048 sc0 sc1 lds
buffer_load_dwordx4 v1, s[4:7], s47 offen offset:3072 sc0 sc1 lds
s_sub_u32 s41, s41, 1
s_cbranch_scc1 L_exit
ds_read_b128 v[44:47], v2 offset:0
ds_read_b128 v[48:51], v2 offset:1024
v_mov_b64 v[20:21], 0
v_mov_b64 v[22:23], 0
v_mov_b64 v[24:25], 0
v_mov_b64 v[26:27], 0
v_mov_b64 v[28:29], 0
v_mov_b64 v[30:31], 0
v_mov_b64 v[32:33], 0
v_mov_b64 v[34:35], 0
v_mov_b64 v[36:37], 0
v_mov_b64 v[38:39], 0
v_mov_b64 v[40:41], 0
v_mov_b64 v[42:43], 0
s_waitcnt vmcnt(0)
ds_read_b128 v[60:63], v1 offset:1024
ds_read_b128 v[64:67], v1 offset:2048
ds_read_b128 v[68:71], v1 offset:3072
ds_read_b128 v[72:75], v1 offset:4096
s_branch L_s0_w3s
L_ra1_w3s:
L_ra2_w3s:
s_waitcnt lgkmcnt(0)
s_barrier
s_mov_b32 m0, 5120
s_nop 0
buffer_load_dwordx4 v1, s[4:7], s48 offen offset:3072 sc0 sc1 lds
s_sub_u32 s41, s41, 1
s_cbranch_scc1 L_exit
s_waitcnt vmcnt(0)
s_barrier
ds_read_b128 v[76:79], v1 offset:5120
ds_read_b128 v[60:63], v1 offset:6144
ds_read_b128 v[64:67], v1 offset:7168
ds_read_b128 v[68:71], v1 offset:8192
ds_read_b128 v[72:75], v1 offset:9216
s_waitcnt lgkmcnt(0)
v_bitop3_b32 v6, v76, v60, s35 bitop3:0x7e
v_bitop3_b32 v6, v6, v64, s35 bitop3:0xf6
v_bitop3_b32 v6, v6, v68, s35 bitop3:0xf6
v_bitop3_b32 v6, v6, v72, s35 bitop3:0xf6
v_and_b32 v6, 1, v6
v_cmp_ne_u32 vcc, 0, v6

s_cbranch_vccnz L_ra2_w3s
s_branch L_a1_w3s
L_mx_w3s:
s_waitcnt lgkmcnt(0)
v_max3_f32 v30, v12, v13, v28
v_max_f32 v30, v30, v29
v_mov_b32 v31, v30
s_nop 1
v_permlane16_swap_b32 v30, v31
v_max_f32 v30, v30, v31
v_mov_b32 v31, v30
s_nop 1
v_permlane32_swap_b32 v30, v31
v_max_f32 v30, v30, v31
ds_write_b32 v1, v30 offset:10252
s_waitcnt lgkmcnt(0)
s_barrier
ds_read_b128 v[32:35], v1 offset:10240
s_waitcnt lgkmcnt(0)
v_max3_f32 v32, v32, v33, v34
v_max_f32 v32, v32, v35
v_sub_f32 v14, v12, v32
v_sub_f32 v15, v13, v32
v_sub_f32 v30, v28, v32
v_sub_f32 v31, v29, v32
v_exp_f32 v14, v14
v_exp_f32 v15, v15
v_exp_f32 v30, v30
v_exp_f32 v31, v31
v_cvt_pk_bf16_f32 v14, v14, v15
v_cvt_pk_bf16_f32 v30, v30, v31
ds_write_b32 v5, v14 offset:15136
v_cndmask_b32_e64 v26, 0, v30, s[56:57]
v_cndmask_b32_e64 v27, 0, v30, s[56:57]
v_mov_b64 v[76:77], s[52:53]
v_mov_b64 v[78:79], s[52:53]
v_mov_b32_dpp v24, v26 quad_perm:[2,3,0,1] row_mask:0xf bank_mask:0xf
v_mov_b32_dpp v25, v26 quad_perm:[2,3,0,1] row_mask:0xf bank_mask:0xf
s_waitcnt lgkmcnt(0)
s_barrier
v_mov_b64 v[14:15], s[0:1]
ds_read_b128 v[16:19], v1 offset:14368
ds_read_b128 v[36:39], v1 offset:14336
s_waitcnt lgkmcnt(0)
v_mfma_f32_16x16x32_bf16 v[32:35], v[76:79], v[16:19], 0
v_mfma_f32_16x16x32_bf16 v[20:23], v[52:55], v[16:19], 0
v_mfma_f32_16x16x32_bf16 v[20:23], v[56:59], v[36:39], v[20:23]
v_mfma_f32_16x16x16_bf16 v[32:35], v[14:15], v[26:27], v[32:35]
v_mfma_f32_16x16x32_bf16 v[20:23], v[40:43], v[24:27], v[20:23]
s_nop 3
v_rcp_f32 v33, v32
s_nop 2
v_mul_f32_dpp v20, v33, v20 quad_perm:[0,1,0,1] row_mask:0xf bank_mask:0xf
v_mul_f32_dpp v21, v33, v21 quad_perm:[0,1,0,1] row_mask:0xf bank_mask:0xf
v_mul_f32_dpp v22, v33, v22 quad_perm:[0,1,0,1] row_mask:0xf bank_mask:0xf
v_mul_f32_dpp v23, v33, v23 quad_perm:[0,1,0,1] row_mask:0xf bank_mask:0xf
v_cvt_pk_bf16_f32 v20, v20, v21
v_cvt_pk_bf16_f32 v21, v22, v23
ds_write_b64 v6, v[20:21] offset:8192
v_mov_b32_dpp v16, v20 quad_perm:[0,1,0,1] row_mask:0xf bank_mask:0xf
v_mov_b32_dpp v17, v21 quad_perm:[0,1,0,1] row_mask:0xf bank_mask:0xf
v_mov_b32_dpp v18, v20 quad_perm:[2,3,2,3] row_mask:0xf bank_mask:0xf
v_mov_b32_dpp v19, v21 quad_perm:[2,3,2,3] row_mask:0xf bank_mask:0xf
v_mov_b64 v[76:77], 0
v_mov_b64 v[78:79], 0
v_mov_b64 v[36:37], 0
v_mov_b64 v[38:39], 0
v_mov_b64 v[24:25], 0
v_mov_b64 v[26:27], 0
v_mov_b64 v[32:33], 0
v_mov_b64 v[34:35], 0
s_waitcnt lgkmcnt(0)
s_branch L_mxb_w3s

L_ev_w3s:
buffer_load_dword v10, v11, s[4:7], s101 offen sc0 sc1
s_sub_u32 s41, s41, 1
s_cbranch_scc1 L_exit
s_waitcnt vmcnt(0)
s_branch L_evb_w3s
s_endpgm

.section .rodata,"a"
.p2align 6
.amdhsa_kernel gated_mix__sliding_local_dilated__memory_aug_recurrent_mem_tr__prompt_kernel
  .amdhsa_next_free_vgpr 512
  .amdhsa_next_free_sgpr 102
  .amdhsa_accum_offset 256
  .amdhsa_group_segment_fixed_size 0
  .amdhsa_kernarg_size 112
  .amdhsa_user_sgpr_count 2
  .amdhsa_user_sgpr_kernarg_segment_ptr 1
  .amdhsa_system_sgpr_workgroup_id_x 1
  .amdhsa_float_denorm_mode_32 3
.end_amdhsa_kernel
```

```asm
; @launch grid=(256,1,1) block=(256,1,1) lds=163840
.amdgcn_target "amdgcn-amd-amdhsa--gfx950"
.text
.globl gated_mix__sliding_local_dilated__memory_aug_recurrent_mem_tr__prompt_kernel
.p2align 8
.type gated_mix__sliding_local_dilated__memory_aug_recurrent_mem_tr__prompt_kernel,@function
gated_mix__sliding_local_dilated__memory_aug_recurrent_mem_tr__prompt_kernel:

s_cmp_ge_u32 s2, 256
s_cbranch_scc1 L_exit_w
s_and_b32 s3, s2, 7
s_lshr_b32 s32, s2, 3
s_cmp_lg_u32 s3, 0
s_cbranch_scc1 L_other
s_load_dwordx2 s[24:25], s[0:1], 32
s_load_dwordx2 s[8:9], s[0:1], 40
s_load_dwordx2 s[12:13], s[0:1], 48
s_load_dwordx2 s[16:17], s[0:1], 56
s_load_dwordx2 s[20:21], s[0:1], 64
s_load_dwordx2 s[28:29], s[0:1], 96
s_load_dwordx2 s[4:5], s[0:1], 104
s_mov_b32 s26, 9216
s_mov_b32 s27, 0x20000
s_mov_b32 s10, 4718592
s_mov_b32 s11, 0x20000
s_mov_b32 s14, 4718592
s_mov_b32 s15, 0x20000
s_mov_b32 s18, 4718592
s_mov_b32 s19, 0x20000
s_mov_b32 s22, 4718592
s_mov_b32 s23, 0x20000
s_mov_b32 s30, 256
s_mov_b32 s31, 0x20000
s_mov_b32 s6, 268435456
s_mov_b32 s7, 0x20000
v_lshrrev_b32 v1, 6, v0
v_and_b32 v21, 15, v0
v_readfirstlane_b32 s33, v1
v_bfe_u32 v22, v0, 4, 2
v_lshrrev_b32 v24, 1, v22
v_and_b32 v23, 1, v22
v_lshl_add_u32 v23, v24, 3, v23
v_lshlrev_b32 v23, 13, v23
v_lshlrev_b32 v26, 1, v22
v_xor_b32 v26, v26, v21
v_lshl_add_u32 v26, v26, 4, v23
v_xor_b32 v27, 128, v26
s_lshl_b32 s54, s32, 8
s_lshl_b32 s55, s33, 17
s_add_u32 s55, s55, s54
s_mul_i32 s57, s33, 40960
s_min_u32 s57, s57, 114688
s_waitcnt lgkmcnt(0)
s_add_u32 s56, s55, 524288
s_add_u32 m0, s57, 36864
s_nop 0
buffer_load_dwordx4 v26, s[8:11], s56 offen lds
s_add_u32 s56, s55, 540672
s_add_u32 m0, s57, 37888
s_nop 0
buffer_load_dwordx4 v26, s[8:11], s56 offen lds
s_add_u32 s56, s55, 557056
s_add_u32 m0, s57, 38912
s_nop 0
buffer_load_dwordx4 v27, s[8:11], s56 offen lds
s_add_u32 s56, s55, 573440
s_add_u32 m0, s57, 39936
s_nop 0
buffer_load_dwordx4 v27, s[8:11], s56 offen lds
s_add_u32 s56, s55, 1048576
s_add_u32 m0, s57, 40960
s_nop 0
buffer_load_dwordx4 v26, s[8:11], s56 offen lds
s_add_u32 s56, s55, 1064960
s_add_u32 m0, s57, 41984
s_nop 0
buffer_load_dwordx4 v26, s[8:11], s56 offen lds
s_add_u32 s56, s55, 1081344
s_add_u32 m0, s57, 43008
s_nop 0
buffer_load_dwordx4 v27, s[8:11], s56 offen lds
s_add_u32 s56, s55, 1097728
s_add_u32 m0, s57, 44032
s_nop 0
buffer_load_dwordx4 v27, s[8:11], s56 offen lds
s_add_u32 s56, s55, 2621440
s_add_u32 m0, s57, 45056
s_nop 0
buffer_load_dwordx4 v26, s[8:11], s56 offen lds
s_add_u32 s56, s55, 2637824
s_add_u32 m0, s57, 46080
s_nop 0
buffer_load_dwordx4 v26, s[8:11], s56 offen lds
s_add_u32 s56, s55, 2654208
s_add_u32 m0, s57, 47104
s_nop 0
buffer_load_dwordx4 v27, s[8:11], s56 offen lds
s_add_u32 s56, s55, 2670592
s_add_u32 m0, s57, 48128
s_nop 0
buffer_load_dwordx4 v27, s[8:11], s56 offen lds
s_add_u32 s56, s55, 3145728
s_add_u32 m0, s57, 16384
s_nop 0
buffer_load_dwordx4 v26, s[8:11], s56 offen lds
s_add_u32 s56, s55, 3162112
s_add_u32 m0, s57, 17408
s_nop 0
buffer_load_dwordx4 v26, s[8:11], s56 offen lds
s_add_u32 s56, s55, 3178496
s_add_u32 m0, s57, 18432
s_nop 0
buffer_load_dwordx4 v27, s[8:11], s56 offen lds
s_add_u32 s56, s55, 3194880
s_add_u32 m0, s57, 19456
s_nop 0
buffer_load_dwordx4 v27, s[8:11], s56 offen lds
s_add_u32 s56, s55, 3670016
s_add_u32 m0, s57, 20480
s_nop 0
buffer_load_dwordx4 v26, s[8:11], s56 offen lds
s_add_u32 s56, s55, 3686400
s_add_u32 m0, s57, 21504
s_nop 0
buffer_load_dwordx4 v26, s[8:11], s56 offen lds
s_add_u32 s56, s55, 3702784
s_add_u32 m0, s57, 22528
s_nop 0
buffer_load_dwordx4 v27, s[8:11], s56 offen lds
s_add_u32 s56, s55, 3719168
s_add_u32 m0, s57, 23552
s_nop 0
buffer_load_dwordx4 v27, s[8:11], s56 offen lds
s_add_u32 s56, s55, 4194304
s_add_u32 m0, s57, 24576
s_nop 0
buffer_load_dwordx4 v26, s[8:11], s56 offen lds
s_add_u32 s56, s55, 4210688
s_add_u32 m0, s57, 25600
s_nop 0
buffer_load_dwordx4 v26, s[8:11], s56 offen lds
s_add_u32 s56, s55, 4227072
s_add_u32 m0, s57, 26624
s_nop 0
buffer_load_dwordx4 v27, s[8:11], s56 offen lds
s_add_u32 s56, s55, 4243456
s_add_u32 m0, s57, 27648
s_nop 0
buffer_load_dwordx4 v27, s[8:11], s56 offen lds
s_cmp_eq_u32 s33, 1
s_cbranch_scc1 L_pro_w1r
s_cmp_eq_u32 s33, 2
s_cbranch_scc1 L_pro_w2r
s_cmp_eq_u32 s33, 3
s_cbranch_scc1 L_pro_w3
s_cmp_lt_u32 s32, 8
s_cbranch_scc1 L_pro_w0r
s_branch L_pro_w0
L_exit:
s_endpgm

L_other:
s_lshl_b32 s3, s3, 2
s_lshr_b32 s3, 0x64352170, s3
s_and_b32 s3, s3, 7
s_cmp_ge_u32 s3, 5
s_cbranch_scc1 L_pre_aw
s_lshr_b32 s33, s32, 3
s_and_b32 s32, s32, 7
s_sub_u32 s3, s3, 1
s_lshl_b32 s3, s3, 3
s_add_u32 s32, s32, s3
s_branch L_role_q
L_pre_aw:
s_sub_u32 s3, s3, 5
s_lshl_b32 s49, s3, 5
s_add_u32 s49, s49, s32
s_lshr_b32 s33, s49, 3
s_and_b32 s32, s32, 7
s_branch L_role_aw
L_exit_w:
s_endpgm
L_role_q:
s_load_dwordx2 s[4:5], s[0:1], 104
s_mov_b32 s6, 268435456
s_mov_b32 s7, 0x20000
s_load_dwordx2 s[8:9], s[0:1], 0
s_mov_b32 s10, 2359296
s_mov_b32 s11, 0x20000
s_load_dwordx2 s[12:13], s[0:1], 40
s_mov_b32 s14, 4718592
s_mov_b32 s15, 0x20000
s_load_dwordx2 s[16:17], s[0:1], 48
s_mov_b32 s18, 4718592
s_mov_b32 s19, 0x20000
s_load_dwordx2 s[20:21], s[0:1], 56
s_mov_b32 s22, 4718592
s_mov_b32 s23, 0x20000
s_load_dwordx2 s[24:25], s[0:1], 96
s_mov_b32 s26, 256
s_mov_b32 s27, 0x20000
v_and_b32 v9, 63, v0
v_and_b32 v10, 15, v0
v_bfe_u32 v11, v0, 4, 2
v_lshrrev_b32 v1, 6, v0
s_nop 0
v_readfirstlane_b32 s34, v1
v_lshrrev_b32 v12, 2, v9
v_mul_u32_u24 v2, 1152, v12
v_lshrrev_b32 v12, 5, v9
v_lshlrev_b32 v12, 1, v12
v_and_b32 v13, 3, v9
v_xor_b32 v12, v12, v13
v_lshl_add_u32 v2, v12, 4, v2
v_lshrrev_b32 v12, 3, v10
v_lshlrev_b32 v12, 1, v12
v_xor_b32 v12, v12, v11
v_lshlrev_b32 v12, 4, v12
v_lshl_add_u32 v3, v10, 6, v12
v_lshlrev_b32 v12, 13, v11
v_lshlrev_b32 v5, 1, v11
v_xor_b32 v5, v5, v10
v_lshl_add_u32 v5, v5, 4, v12
v_xor_b32 v6, 128, v5
v_lshlrev_b32 v1, 4, v9
s_mul_i32 s38, s34, 20480
s_add_u32 s38, s38, 73728
s_lshl_b32 s39, s32, 8
s_lshl_b32 s40, s34, 17
s_add_u32 s39, s39, s40
s_lshl_b32 s43, s33, 1
s_and_b32 s41, s34, 1
s_add_u32 s43, s43, s41
s_mul_i32 s43, s43, 18432
s_lshr_b32 s41, s34, 1
s_lshl_b32 s41, s41, 6
s_add_u32 s43, s43, s41
s_lshl_b32 s44, s34, 10
s_mov_b32 s36, 400000
s_mov_b32 s46, 0x3e0293ee
s_mov_b32 s47, 0x3e0293ee
v_mov_b32 v8, 0
v_lshrrev_b32 v12, 2, v10
v_lshlrev_b32 v4, 12, v12
v_lshl_add_u32 v4, v11, 8, v4
v_and_b32 v12, 3, v10
v_lshl_add_u32 v4, v12, 4, v4
s_waitcnt lgkmcnt(0)
s_add_u32 s37, s39, 0
s_add_u32 m0, s38, 0
s_nop 0
buffer_load_dwordx4 v5, s[12:15], s37 offen lds
s_add_u32 s37, s39, 32768
s_add_u32 m0, s38, 1024
s_nop 0
buffer_load_dwordx4 v5, s[12:15], s37 offen lds
s_add_u32 s37, s39, 65536
s_add_u32 m0, s38, 2048
s_nop 0
buffer_load_dwordx4 v6, s[12:15], s37 offen lds
s_add_u32 s37, s39, 98304
s_add_u32 m0, s38, 3072
s_nop 0
buffer_load_dwordx4 v6, s[12:15], s37 offen lds
s_add_u32 s37, s39, 524288
s_add_u32 m0, s38, 4096
s_nop 0
buffer_load_dwordx4 v5, s[12:15], s37 offen lds
s_add_u32 s37, s39, 557056
s_add_u32 m0, s38, 5120
s_nop 0
buffer_load_dwordx4 v5, s[12:15], s37 offen lds
s_add_u32 s37, s39, 589824
s_add_u32 m0, s38, 6144
s_nop 0
buffer_load_dwordx4 v6, s[12:15], s37 offen lds
s_add_u32 s37, s39, 622592
s_add_u32 m0, s38, 7168
s_nop 0
buffer_load_dwordx4 v6, s[12:15], s37 offen lds
s_add_u32 s37, s39, 1048576
s_add_u32 m0, s38, 8192
s_nop 0
buffer_load_dwordx4 v5, s[12:15], s37 offen lds
s_add_u32 s37, s39, 1081344
s_add_u32 m0, s38, 9216
s_nop 0
buffer_load_dwordx4 v5, s[12:15], s37 offen lds
s_add_u32 s37, s39, 1114112
s_add_u32 m0, s38, 10240
s_nop 0
buffer_load_dwordx4 v6, s[12:15], s37 offen lds
s_add_u32 s37, s39, 1146880
s_add_u32 m0, s38, 11264
s_nop 0
buffer_load_dwordx4 v6, s[12:15], s37 offen lds
s_add_u32 s37, s39, 1572864
s_add_u32 m0, s38, 12288
s_nop 0
buffer_load_dwordx4 v5, s[12:15], s37 offen lds
s_add_u32 s37, s39, 1605632
s_add_u32 m0, s38, 13312
s_nop 0
buffer_load_dwordx4 v5, s[12:15], s37 offen lds
s_add_u32 s37, s39, 1638400
s_add_u32 m0, s38, 14336
s_nop 0
buffer_load_dwordx4 v6, s[12:15], s37 offen lds
s_add_u32 s37, s39, 1671168
s_add_u32 m0, s38, 15360
s_nop 0
buffer_load_dwordx4 v6, s[12:15], s37 offen lds
s_add_u32 s37, s39, 2097152
s_add_u32 m0, s38, 16384
s_nop 0
buffer_load_dwordx4 v5, s[12:15], s37 offen lds
s_add_u32 s37, s39, 2129920
s_add_u32 m0, s38, 17408
s_nop 0
buffer_load_dwordx4 v5, s[12:15], s37 offen lds
s_add_u32 s37, s39, 2162688
s_add_u32 m0, s38, 18432
s_nop 0
buffer_load_dwordx4 v6, s[12:15], s37 offen lds
s_add_u32 s37, s39, 2195456
s_add_u32 m0, s38, 19456
s_nop 0
buffer_load_dwordx4 v6, s[12:15], s37 offen lds
s_add_u32 s37, s43, 0
s_add_u32 m0, s44, 0
s_nop 0
buffer_load_dwordx4 v2, s[8:11], s37 offen lds
s_add_u32 s37, s43, 128
s_add_u32 m0, s44, 4096
s_nop 0
buffer_load_dwordx4 v2, s[8:11], s37 offen lds
s_add_u32 s37, s43, 256
s_add_u32 m0, s44, 8192
s_nop 0
buffer_load_dwordx4 v2, s[8:11], s37 offen lds
s_add_u32 s37, s43, 384
s_add_u32 m0, s44, 12288
s_nop 0
buffer_load_dwordx4 v2, s[8:11], s37 offen lds
s_add_u32 s37, s43, 512
s_add_u32 m0, s44, 16384
s_nop 0
buffer_load_dwordx4 v2, s[8:11], s37 offen lds
s_add_u32 s37, s43, 640
s_add_u32 m0, s44, 20480
s_nop 0
buffer_load_dwordx4 v2, s[8:11], s37 offen lds
s_add_u32 s37, s43, 768
s_add_u32 m0, s44, 24576
s_nop 0
buffer_load_dwordx4 v2, s[8:11], s37 offen lds
s_add_u32 s37, s43, 896
s_add_u32 m0, s44, 28672
s_nop 0
buffer_load_dwordx4 v2, s[8:11], s37 offen lds
s_add_u32 s37, s43, 1024
s_add_u32 m0, s44, 32768
s_nop 0
buffer_load_dwordx4 v2, s[8:11], s37 offen lds
s_lshr_b32 s40, s34, 1
s_lshl_b32 s40, s40, 3
s_and_b32 s41, s34, 1
s_lshl_b32 s41, s41, 1
s_add_u32 s40, s40, s41
s_add_u32 s40, s40, 0
s_lshl_b32 s41, s34, 2
s_add_u32 s41, s41, 0
v_and_b32 v12, 1, v11
v_lshrrev_b32 v13, 2, v10
v_lshl_add_u32 v12, v12, 2, v13
v_lshlrev_b32 v12, 1, v12
v_bfe_u32 v16, v10, 1, 1
v_add_u32 v16, s40, v16
v_xor_b32 v16, v16, v12
v_lshlrev_b32 v16, 4, v16
v_lshl_add_u32 v16, v13, 8, v16
v_and_b32 v12, 1, v11
v_lshl_add_u32 v16, v12, 11, v16
v_and_b32 v12, 1, v10
v_lshl_add_u32 v16, v12, 3, v16
v_lshrrev_b32 v12, 1, v11
v_mul_u32_u24 v12, 20480, v12
v_add_u32 v12, 73728, v12
v_add_u32 v16, v16, v12
v_and_b32 v12, 1, v11
v_lshrrev_b32 v13, 2, v10
v_lshl_add_u32 v12, v12, 2, v13
v_lshlrev_b32 v12, 1, v12
v_bfe_u32 v20, v10, 1, 1
v_add_u32 v20, s41, v20
v_xor_b32 v20, v20, v12
v_lshlrev_b32 v20, 4, v20
v_lshl_add_u32 v20, v13, 8, v20
v_and_b32 v12, 1, v11
v_lshl_add_u32 v20, v12, 11, v20
v_and_b32 v12, 1, v10
v_lshl_add_u32 v20, v12, 3, v20
v_lshrrev_b32 v12, 1, v11
v_mul_u32_u24 v12, 20480, v12
v_add_u32 v12, 73728, v12
v_add_u32 v20, v20, v12
v_and_b32 v12, 1, v11
v_lshrrev_b32 v13, 2, v10
v_lshl_add_u32 v12, v12, 2, v13
v_lshlrev_b32 v12, 1, v12
v_bfe_u32 v18, v10, 1, 1
v_add_u32 v18, s40, v18
v_xor_b32 v18, v18, v12
v_lshlrev_b32 v18, 4, v18
v_lshl_add_u32 v18, v13, 8, v18
v_and_b32 v12, 1, v11
v_lshl_add_u32 v18, v12, 11, v18
v_and_b32 v12, 1, v10
v_lshl_add_u32 v18, v12, 3, v18
v_lshrrev_b32 v12, 1, v11
v_mul_u32_u24 v12, 20480, v12
v_add_u32 v12, 114688, v12
v_add_u32 v18, v18, v12
v_and_b32 v12, 1, v11
v_lshrrev_b32 v13, 2, v10
v_lshl_add_u32 v12, v12, 2, v13
v_lshlrev_b32 v12, 1, v12
v_bfe_u32 v22, v10, 1, 1
v_add_u32 v22, s41, v22
v_xor_b32 v22, v22, v12
v_lshlrev_b32 v22, 4, v22
v_lshl_add_u32 v22, v13, 8, v22
v_and_b32 v12, 1, v11
v_lshl_add_u32 v22, v12, 11, v22
v_and_b32 v12, 1, v10
v_lshl_add_u32 v22, v12, 3, v22
v_lshrrev_b32 v12, 1, v11
v_mul_u32_u24 v12, 20480, v12
v_add_u32 v12, 114688, v12
v_add_u32 v22, v22, v12
s_lshr_b32 s40, s34, 1
s_lshl_b32 s40, s40, 3
s_and_b32 s41, s34, 1
s_lshl_b32 s41, s41, 1
s_add_u32 s40, s40, s41
s_add_u32 s40, s40, 4
s_lshl_b32 s41, s34, 2
s_add_u32 s41, s41, 2
v_and_b32 v12, 1, v11
v_lshrrev_b32 v13, 2, v10
v_lshl_add_u32 v12, v12, 2, v13
v_lshlrev_b32 v12, 1, v12
v_bfe_u32 v17, v10, 1, 1
v_add_u32 v17, s40, v17
v_xor_b32 v17, v17, v12
v_lshlrev_b32 v17, 4, v17
v_lshl_add_u32 v17, v13, 8, v17
v_and_b32 v12, 1, v11
v_lshl_add_u32 v17, v12, 11, v17
v_and_b32 v12, 1, v10
v_lshl_add_u32 v17, v12, 3, v17
v_lshrrev_b32 v12, 1, v11
v_mul_u32_u24 v12, 20480, v12
v_add_u32 v12, 73728, v12
v_add_u32 v17, v17, v12
v_and_b32 v12, 1, v11
v_lshrrev_b32 v13, 2, v10
v_lshl_add_u32 v12, v12, 2, v13
v_lshlrev_b32 v12, 1, v12
v_bfe_u32 v21, v10, 1, 1
v_add_u32 v21, s41, v21
v_xor_b32 v21, v21, v12
v_lshlrev_b32 v21, 4, v21
v_lshl_add_u32 v21, v13, 8, v21
v_and_b32 v12, 1, v11
v_lshl_add_u32 v21, v12, 11, v21
v_and_b32 v12, 1, v10
v_lshl_add_u32 v21, v12, 3, v21
v_lshrrev_b32 v12, 1, v11
v_mul_u32_u24 v12, 20480, v12
v_add_u32 v12, 73728, v12
v_add_u32 v21, v21, v12
v_and_b32 v12, 1, v11
v_lshrrev_b32 v13, 2, v10
v_lshl_add_u32 v12, v12, 2, v13
v_lshlrev_b32 v12, 1, v12
v_bfe_u32 v19, v10, 1, 1
v_add_u32 v19, s40, v19
v_xor_b32 v19, v19, v12
v_lshlrev_b32 v19, 4, v19
v_lshl_add_u32 v19, v13, 8, v19
v_and_b32 v12, 1, v11
v_lshl_add_u32 v19, v12, 11, v19
v_and_b32 v12, 1, v10
v_lshl_add_u32 v19, v12, 3, v19
v_lshrrev_b32 v12, 1, v11
v_mul_u32_u24 v12, 20480, v12
v_add_u32 v12, 114688, v12
v_add_u32 v19, v19, v12
v_and_b32 v12, 1, v11
v_lshrrev_b32 v13, 2, v10
v_lshl_add_u32 v12, v12, 2, v13
v_lshlrev_b32 v12, 1, v12
v_bfe_u32 v23, v10, 1, 1
v_add_u32 v23, s41, v23
v_xor_b32 v23, v23, v12
v_lshlrev_b32 v23, 4, v23
v_lshl_add_u32 v23, v13, 8, v23
v_and_b32 v12, 1, v11
v_lshl_add_u32 v23, v12, 11, v23
v_and_b32 v12, 1, v10
v_lshl_add_u32 v23, v12, 3, v23
v_lshrrev_b32 v12, 1, v11
v_mul_u32_u24 v12, 20480, v12
v_add_u32 v12, 114688, v12
v_add_u32 v23, v23, v12
s_waitcnt vmcnt(25)
s_barrier
ds_read_b64_tr_b16 v[80:81], v16 offset:0
ds_read_b64_tr_b16 v[82:83], v16 offset:1024
ds_read_b64_tr_b16 v[84:85], v18 offset:0
ds_read_b64_tr_b16 v[86:87], v18 offset:1024
ds_read_b64_tr_b16 v[152:153], v17 offset:0
ds_read_b64_tr_b16 v[154:155], v17 offset:1024
ds_read_b64_tr_b16 v[156:157], v19 offset:0
ds_read_b64_tr_b16 v[158:159], v19 offset:1024
s_waitcnt lgkmcnt(0)
s_waitcnt vmcnt(21)
s_barrier
s_add_u32 s37, s39, 2621440
s_add_u32 m0, s38, 0
s_nop 0
buffer_load_dwordx4 v5, s[12:15], s37 offen lds
s_add_u32 s37, s39, 2654208
s_add_u32 m0, s38, 1024
s_nop 0
buffer_load_dwordx4 v5, s[12:15], s37 offen lds
s_add_u32 s37, s39, 2686976
s_add_u32 m0, s38, 2048
s_nop 0
buffer_load_dwordx4 v6, s[12:15], s37 offen lds
s_add_u32 s37, s39, 2719744
s_add_u32 m0, s38, 3072
s_nop 0
buffer_load_dwordx4 v6, s[12:15], s37 offen lds
ds_read_b64_tr_b16 v[88:89], v16 offset:4096
ds_read_b64_tr_b16 v[90:91], v16 offset:5120
ds_read_b64_tr_b16 v[92:93], v18 offset:4096
ds_read_b64_tr_b16 v[94:95], v18 offset:5120
ds_read_b64_tr_b16 v[160:161], v17 offset:4096
ds_read_b64_tr_b16 v[162:163], v17 offset:5120
ds_read_b64_tr_b16 v[164:165], v19 offset:4096
ds_read_b64_tr_b16 v[166:167], v19 offset:5120
s_waitcnt lgkmcnt(0)
s_waitcnt vmcnt(21)
s_barrier
s_add_u32 s37, s39, 3145728
s_add_u32 m0, s38, 4096
s_nop 0
buffer_load_dwordx4 v5, s[12:15], s37 offen lds
s_add_u32 s37, s39, 3178496
s_add_u32 m0, s38, 5120
s_nop 0
buffer_load_dwordx4 v5, s[12:15], s37 offen lds
s_add_u32 s37, s39, 3211264
s_add_u32 m0, s38, 6144
s_nop 0
buffer_load_dwordx4 v6, s[12:15], s37 offen lds
s_add_u32 s37, s39, 3244032
s_add_u32 m0, s38, 7168
s_nop 0
buffer_load_dwordx4 v6, s[12:15], s37 offen lds
ds_read_b64_tr_b16 v[96:97], v16 offset:8192
ds_read_b64_tr_b16 v[98:99], v16 offset:9216
ds_read_b64_tr_b16 v[100:101], v18 offset:8192
ds_read_b64_tr_b16 v[102:103], v18 offset:9216
ds_read_b64_tr_b16 v[168:169], v17 offset:8192
ds_read_b64_tr_b16 v[170:171], v17 offset:9216
ds_read_b64_tr_b16 v[172:173], v19 offset:8192
ds_read_b64_tr_b16 v[174:175], v19 offset:9216
s_waitcnt lgkmcnt(0)
s_waitcnt vmcnt(21)
s_barrier
s_add_u32 s37, s39, 3670016
s_add_u32 m0, s38, 8192
s_nop 0
buffer_load_dwordx4 v5, s[12:15], s37 offen lds
s_add_u32 s37, s39, 3702784
s_add_u32 m0, s38, 9216
s_nop 0
buffer_load_dwordx4 v5, s[12:15], s37 offen lds
s_add_u32 s37, s39, 3735552
s_add_u32 m0, s38, 10240
s_nop 0
buffer_load_dwordx4 v6, s[12:15], s37 offen lds
s_add_u32 s37, s39, 3768320
s_add_u32 m0, s38, 11264
s_nop 0
buffer_load_dwordx4 v6, s[12:15], s37 offen lds
ds_read_b64_tr_b16 v[104:105], v16 offset:12288
ds_read_b64_tr_b16 v[106:107], v16 offset:13312
ds_read_b64_tr_b16 v[108:109], v18 offset:12288
ds_read_b64_tr_b16 v[110:111], v18 offset:13312
ds_read_b64_tr_b16 v[176:177], v17 offset:12288
ds_read_b64_tr_b16 v[178:179], v17 offset:13312
ds_read_b64_tr_b16 v[180:181], v19 offset:12288
ds_read_b64_tr_b16 v[182:183], v19 offset:13312
s_waitcnt lgkmcnt(0)
s_waitcnt vmcnt(21)
s_barrier
s_add_u32 s37, s39, 4194304
s_add_u32 m0, s38, 12288
s_nop 0
buffer_load_dwordx4 v5, s[12:15], s37 offen lds
s_add_u32 s37, s39, 4227072
s_add_u32 m0, s38, 13312
s_nop 0
buffer_load_dwordx4 v5, s[12:15], s37 offen lds
s_add_u32 s37, s39, 4259840
s_add_u32 m0, s38, 14336
s_nop 0
buffer_load_dwordx4 v6, s[12:15], s37 offen lds
s_add_u32 s37, s39, 4292608
s_add_u32 m0, s38, 15360
s_nop 0
buffer_load_dwordx4 v6, s[12:15], s37 offen lds
ds_read_b64_tr_b16 v[112:113], v16 offset:16384
ds_read_b64_tr_b16 v[114:115], v16 offset:17408
ds_read_b64_tr_b16 v[116:117], v18 offset:16384
ds_read_b64_tr_b16 v[118:119], v18 offset:17408
ds_read_b64_tr_b16 v[184:185], v17 offset:16384
ds_read_b64_tr_b16 v[186:187], v17 offset:17408
ds_read_b64_tr_b16 v[188:189], v19 offset:16384
ds_read_b64_tr_b16 v[190:191], v19 offset:17408
s_waitcnt lgkmcnt(0)
s_waitcnt vmcnt(12)
s_barrier
s_add_u32 s37, s39, 0
s_add_u32 m0, s38, 16384
s_nop 0
buffer_load_dwordx4 v5, s[16:19], s37 offen lds
s_add_u32 s37, s39, 32768
s_add_u32 m0, s38, 17408
s_nop 0
buffer_load_dwordx4 v5, s[16:19], s37 offen lds
s_add_u32 s37, s39, 65536
s_add_u32 m0, s38, 18432
s_nop 0
buffer_load_dwordx4 v6, s[16:19], s37 offen lds
s_add_u32 s37, s39, 98304
s_add_u32 m0, s38, 19456
s_nop 0
buffer_load_dwordx4 v6, s[16:19], s37 offen lds
ds_read_b64_tr_b16 v[120:121], v16 offset:0
ds_read_b64_tr_b16 v[122:123], v16 offset:1024
ds_read_b64_tr_b16 v[124:125], v18 offset:0
ds_read_b64_tr_b16 v[126:127], v18 offset:1024
ds_read_b64_tr_b16 v[192:193], v17 offset:0
ds_read_b64_tr_b16 v[194:195], v17 offset:1024
ds_read_b64_tr_b16 v[196:197], v19 offset:0
ds_read_b64_tr_b16 v[198:199], v19 offset:1024
s_waitcnt lgkmcnt(0)
s_waitcnt vmcnt(12)
s_barrier
s_add_u32 s37, s39, 524288
s_add_u32 m0, s38, 0
s_nop 0
buffer_load_dwordx4 v5, s[16:19], s37 offen lds
s_add_u32 s37, s39, 557056
s_add_u32 m0, s38, 1024
s_nop 0
buffer_load_dwordx4 v5, s[16:19], s37 offen lds
s_add_u32 s37, s39, 589824
s_add_u32 m0, s38, 2048
s_nop 0
buffer_load_dwordx4 v6, s[16:19], s37 offen lds
s_add_u32 s37, s39, 622592
s_add_u32 m0, s38, 3072
s_nop 0
buffer_load_dwordx4 v6, s[16:19], s37 offen lds
ds_read_b64_tr_b16 v[128:129], v16 offset:4096
ds_read_b64_tr_b16 v[130:131], v16 offset:5120
ds_read_b64_tr_b16 v[132:133], v18 offset:4096
ds_read_b64_tr_b16 v[134:135], v18 offset:5120
ds_read_b64_tr_b16 v[200:201], v17 offset:4096
ds_read_b64_tr_b16 v[202:203], v17 offset:5120
ds_read_b64_tr_b16 v[204:205], v19 offset:4096
ds_read_b64_tr_b16 v[206:207], v19 offset:5120
s_waitcnt lgkmcnt(0)
s_waitcnt vmcnt(12)
s_barrier
s_add_u32 s37, s39, 1048576
s_add_u32 m0, s38, 4096
s_nop 0
buffer_load_dwordx4 v5, s[16:19], s37 offen lds
s_add_u32 s37, s39, 1081344
s_add_u32 m0, s38, 5120
s_nop 0
buffer_load_dwordx4 v5, s[16:19], s37 offen lds
s_add_u32 s37, s39, 1114112
s_add_u32 m0, s38, 6144
s_nop 0
buffer_load_dwordx4 v6, s[16:19], s37 offen lds
s_add_u32 s37, s39, 1146880
s_add_u32 m0, s38, 7168
s_nop 0
buffer_load_dwordx4 v6, s[16:19], s37 offen lds
ds_read_b64_tr_b16 v[136:137], v16 offset:8192
ds_read_b64_tr_b16 v[138:139], v16 offset:9216
ds_read_b64_tr_b16 v[140:141], v18 offset:8192
ds_read_b64_tr_b16 v[142:143], v18 offset:9216
ds_read_b64_tr_b16 v[208:209], v17 offset:8192
ds_read_b64_tr_b16 v[210:211], v17 offset:9216
ds_read_b64_tr_b16 v[212:213], v19 offset:8192
ds_read_b64_tr_b16 v[214:215], v19 offset:9216
s_waitcnt lgkmcnt(0)
s_waitcnt vmcnt(12)
s_barrier
s_add_u32 s37, s39, 1572864
s_add_u32 m0, s38, 8192
s_nop 0
buffer_load_dwordx4 v5, s[16:19], s37 offen lds
s_add_u32 s37, s39, 1605632
s_add_u32 m0, s38, 9216
s_nop 0
buffer_load_dwordx4 v5, s[16:19], s37 offen lds
s_add_u32 s37, s39, 1638400
s_add_u32 m0, s38, 10240
s_nop 0
buffer_load_dwordx4 v6, s[16:19], s37 offen lds
s_add_u32 s37, s39, 1671168
s_add_u32 m0, s38, 11264
s_nop 0
buffer_load_dwordx4 v6, s[16:19], s37 offen lds
ds_read_b64_tr_b16 v[144:145], v16 offset:12288
ds_read_b64_tr_b16 v[146:147], v16 offset:13312
ds_read_b64_tr_b16 v[148:149], v18 offset:12288
ds_read_b64_tr_b16 v[150:151], v18 offset:13312
ds_read_b64_tr_b16 v[216:217], v17 offset:12288
ds_read_b64_tr_b16 v[218:219], v17 offset:13312
ds_read_b64_tr_b16 v[220:221], v19 offset:12288
ds_read_b64_tr_b16 v[222:223], v19 offset:13312
s_waitcnt lgkmcnt(0)
s_waitcnt vmcnt(12)
s_barrier
s_add_u32 s37, s39, 2097152
s_add_u32 m0, s38, 12288
s_nop 0
buffer_load_dwordx4 v5, s[16:19], s37 offen lds
s_add_u32 s37, s39, 2129920
s_add_u32 m0, s38, 13312
s_nop 0
buffer_load_dwordx4 v5, s[16:19], s37 offen lds
s_add_u32 s37, s39, 2162688
s_add_u32 m0, s38, 14336
s_nop 0
buffer_load_dwordx4 v6, s[16:19], s37 offen lds
s_add_u32 s37, s39, 2195456
s_add_u32 m0, s38, 15360
s_nop 0
buffer_load_dwordx4 v6, s[16:19], s37 offen lds
ds_read_b64_tr_b16 v[224:225], v16 offset:16384
ds_read_b64_tr_b16 v[226:227], v16 offset:17408
ds_read_b64_tr_b16 v[228:229], v18 offset:16384
ds_read_b64_tr_b16 v[230:231], v18 offset:17408
ds_read_b64_tr_b16 a[40:41], v17 offset:16384
ds_read_b64_tr_b16 a[42:43], v17 offset:17408
ds_read_b64_tr_b16 a[44:45], v19 offset:16384
ds_read_b64_tr_b16 a[46:47], v19 offset:17408
s_waitcnt lgkmcnt(0)
s_waitcnt vmcnt(12)
s_barrier
s_add_u32 s37, s39, 2621440
s_add_u32 m0, s38, 16384
s_nop 0
buffer_load_dwordx4 v5, s[16:19], s37 offen lds
s_add_u32 s37, s39, 2654208
s_add_u32 m0, s38, 17408
s_nop 0
buffer_load_dwordx4 v5, s[16:19], s37 offen lds
s_add_u32 s37, s39, 2686976
s_add_u32 m0, s38, 18432
s_nop 0
buffer_load_dwordx4 v6, s[16:19], s37 offen lds
s_add_u32 s37, s39, 2719744
s_add_u32 m0, s38, 19456
s_nop 0
buffer_load_dwordx4 v6, s[16:19], s37 offen lds
ds_read_b64_tr_b16 v[232:233], v16 offset:0
ds_read_b64_tr_b16 v[234:235], v16 offset:1024
ds_read_b64_tr_b16 v[236:237], v18 offset:0
ds_read_b64_tr_b16 v[238:239], v18 offset:1024
ds_read_b64_tr_b16 a[48:49], v17 offset:0
ds_read_b64_tr_b16 a[50:51], v17 offset:1024
ds_read_b64_tr_b16 a[52:53], v19 offset:0
ds_read_b64_tr_b16 a[54:55], v19 offset:1024
s_waitcnt lgkmcnt(0)
s_waitcnt vmcnt(12)
s_barrier
s_add_u32 s37, s39, 3145728
s_add_u32 m0, s38, 0
s_nop 0
buffer_load_dwordx4 v5, s[16:19], s37 offen lds
s_add_u32 s37, s39, 3178496
s_add_u32 m0, s38, 1024
s_nop 0
buffer_load_dwordx4 v5, s[16:19], s37 offen lds
s_add_u32 s37, s39, 3211264
s_add_u32 m0, s38, 2048
s_nop 0
buffer_load_dwordx4 v6, s[16:19], s37 offen lds
s_add_u32 s37, s39, 3244032
s_add_u32 m0, s38, 3072
s_nop 0
buffer_load_dwordx4 v6, s[16:19], s37 offen lds
ds_read_b64_tr_b16 v[240:241], v16 offset:4096
ds_read_b64_tr_b16 v[242:243], v16 offset:5120
ds_read_b64_tr_b16 v[244:245], v18 offset:4096
ds_read_b64_tr_b16 v[246:247], v18 offset:5120
ds_read_b64_tr_b16 a[56:57], v17 offset:4096
ds_read_b64_tr_b16 a[58:59], v17 offset:5120
ds_read_b64_tr_b16 a[60:61], v19 offset:4096
ds_read_b64_tr_b16 a[62:63], v19 offset:5120
s_waitcnt lgkmcnt(0)
s_waitcnt vmcnt(12)
s_barrier
s_add_u32 s37, s39, 3670016
s_add_u32 m0, s38, 4096
s_nop 0
buffer_load_dwordx4 v5, s[16:19], s37 offen lds
s_add_u32 s37, s39, 3702784
s_add_u32 m0, s38, 5120
s_nop 0
buffer_load_dwordx4 v5, s[16:19], s37 offen lds
s_add_u32 s37, s39, 3735552
s_add_u32 m0, s38, 6144
s_nop 0
buffer_load_dwordx4 v6, s[16:19], s37 offen lds
s_add_u32 s37, s39, 3768320
s_add_u32 m0, s38, 7168
s_nop 0
buffer_load_dwordx4 v6, s[16:19], s37 offen lds
ds_read_b64_tr_b16 v[248:249], v16 offset:8192
ds_read_b64_tr_b16 v[250:251], v16 offset:9216
ds_read_b64_tr_b16 v[252:253], v18 offset:8192
ds_read_b64_tr_b16 v[254:255], v18 offset:9216
ds_read_b64_tr_b16 a[64:65], v17 offset:8192
ds_read_b64_tr_b16 a[66:67], v17 offset:9216
ds_read_b64_tr_b16 a[68:69], v19 offset:8192
ds_read_b64_tr_b16 a[70:71], v19 offset:9216
s_waitcnt lgkmcnt(0)
s_waitcnt vmcnt(12)
s_barrier
s_add_u32 s37, s39, 4194304
s_add_u32 m0, s38, 8192
s_nop 0
buffer_load_dwordx4 v5, s[16:19], s37 offen lds
s_add_u32 s37, s39, 4227072
s_add_u32 m0, s38, 9216
s_nop 0
buffer_load_dwordx4 v5, s[16:19], s37 offen lds
s_add_u32 s37, s39, 4259840
s_add_u32 m0, s38, 10240
s_nop 0
buffer_load_dwordx4 v6, s[16:19], s37 offen lds
s_add_u32 s37, s39, 4292608
s_add_u32 m0, s38, 11264
s_nop 0
buffer_load_dwordx4 v6, s[16:19], s37 offen lds
ds_read_b64_tr_b16 a[0:1], v16 offset:12288
ds_read_b64_tr_b16 a[2:3], v16 offset:13312
ds_read_b64_tr_b16 a[4:5], v18 offset:12288
ds_read_b64_tr_b16 a[6:7], v18 offset:13312
ds_read_b64_tr_b16 a[72:73], v17 offset:12288
ds_read_b64_tr_b16 a[74:75], v17 offset:13312
ds_read_b64_tr_b16 a[76:77], v19 offset:12288
ds_read_b64_tr_b16 a[78:79], v19 offset:13312
s_waitcnt lgkmcnt(0)
s_waitcnt vmcnt(12)
s_barrier
s_add_u32 s37, s39, 0
s_add_u32 m0, s38, 12288
s_nop 0
buffer_load_dwordx4 v5, s[20:23], s37 offen lds
s_add_u32 s37, s39, 32768
s_add_u32 m0, s38, 13312
s_nop 0
buffer_load_dwordx4 v5, s[20:23], s37 offen lds
s_add_u32 s37, s39, 65536
s_add_u32 m0, s38, 14336
s_nop 0
buffer_load_dwordx4 v6, s[20:23], s37 offen lds
s_add_u32 s37, s39, 98304
s_add_u32 m0, s38, 15360
s_nop 0
buffer_load_dwordx4 v6, s[20:23], s37 offen lds
ds_read_b64_tr_b16 a[8:9], v16 offset:16384
ds_read_b64_tr_b16 a[10:11], v16 offset:17408
ds_read_b64_tr_b16 a[12:13], v18 offset:16384
ds_read_b64_tr_b16 a[14:15], v18 offset:17408
ds_read_b64_tr_b16 a[80:81], v17 offset:16384
ds_read_b64_tr_b16 a[82:83], v17 offset:17408
ds_read_b64_tr_b16 a[84:85], v19 offset:16384
ds_read_b64_tr_b16 a[86:87], v19 offset:17408
s_waitcnt lgkmcnt(0)
s_waitcnt vmcnt(12)
s_barrier
s_add_u32 s37, s39, 524288
s_add_u32 m0, s38, 16384
s_nop 0
buffer_load_dwordx4 v5, s[20:23], s37 offen lds
s_add_u32 s37, s39, 557056
s_add_u32 m0, s38, 17408
s_nop 0
buffer_load_dwordx4 v5, s[20:23], s37 offen lds
s_add_u32 s37, s39, 589824
s_add_u32 m0, s38, 18432
s_nop 0
buffer_load_dwordx4 v6, s[20:23], s37 offen lds
s_add_u32 s37, s39, 622592
s_add_u32 m0, s38, 19456
s_nop 0
buffer_load_dwordx4 v6, s[20:23], s37 offen lds
ds_read_b64_tr_b16 a[16:17], v16 offset:0
ds_read_b64_tr_b16 a[18:19], v16 offset:1024
ds_read_b64_tr_b16 a[20:21], v18 offset:0
ds_read_b64_tr_b16 a[22:23], v18 offset:1024
ds_read_b64_tr_b16 a[88:89], v17 offset:0
ds_read_b64_tr_b16 a[90:91], v17 offset:1024
ds_read_b64_tr_b16 a[92:93], v19 offset:0
ds_read_b64_tr_b16 a[94:95], v19 offset:1024
s_waitcnt lgkmcnt(0)
s_waitcnt vmcnt(12)
s_barrier
s_add_u32 s37, s39, 1048576
s_add_u32 m0, s38, 0
s_nop 0
buffer_load_dwordx4 v5, s[20:23], s37 offen lds
s_add_u32 s37, s39, 1081344
s_add_u32 m0, s38, 1024
s_nop 0
buffer_load_dwordx4 v5, s[20:23], s37 offen lds
s_add_u32 s37, s39, 1114112
s_add_u32 m0, s38, 2048
s_nop 0
buffer_load_dwordx4 v6, s[20:23], s37 offen lds
s_add_u32 s37, s39, 1146880
s_add_u32 m0, s38, 3072
s_nop 0
buffer_load_dwordx4 v6, s[20:23], s37 offen lds
ds_read_b64_tr_b16 a[24:25], v16 offset:4096
ds_read_b64_tr_b16 a[26:27], v16 offset:5120
ds_read_b64_tr_b16 a[28:29], v18 offset:4096
ds_read_b64_tr_b16 a[30:31], v18 offset:5120
ds_read_b64_tr_b16 a[96:97], v17 offset:4096
ds_read_b64_tr_b16 a[98:99], v17 offset:5120
ds_read_b64_tr_b16 a[100:101], v19 offset:4096
ds_read_b64_tr_b16 a[102:103], v19 offset:5120
s_waitcnt lgkmcnt(0)
s_waitcnt vmcnt(12)
s_barrier
s_add_u32 s37, s39, 1572864
s_add_u32 m0, s38, 4096
s_nop 0
buffer_load_dwordx4 v5, s[20:23], s37 offen lds
s_add_u32 s37, s39, 1605632
s_add_u32 m0, s38, 5120
s_nop 0
buffer_load_dwordx4 v5, s[20:23], s37 offen lds
s_add_u32 s37, s39, 1638400
s_add_u32 m0, s38, 6144
s_nop 0
buffer_load_dwordx4 v6, s[20:23], s37 offen lds
s_add_u32 s37, s39, 1671168
s_add_u32 m0, s38, 7168
s_nop 0
buffer_load_dwordx4 v6, s[20:23], s37 offen lds
ds_read_b64_tr_b16 a[32:33], v16 offset:8192
ds_read_b64_tr_b16 a[34:35], v16 offset:9216
ds_read_b64_tr_b16 a[36:37], v18 offset:8192
ds_read_b64_tr_b16 a[38:39], v18 offset:9216
ds_read_b64_tr_b16 a[104:105], v17 offset:8192
ds_read_b64_tr_b16 a[106:107], v17 offset:9216
ds_read_b64_tr_b16 a[108:109], v19 offset:8192
ds_read_b64_tr_b16 a[110:111], v19 offset:9216
s_waitcnt lgkmcnt(0)
s_waitcnt vmcnt(12)
s_barrier
s_add_u32 s37, s39, 2097152
s_add_u32 m0, s38, 8192
s_nop 0
buffer_load_dwordx4 v5, s[20:23], s37 offen lds
s_add_u32 s37, s39, 2129920
s_add_u32 m0, s38, 9216
s_nop 0
buffer_load_dwordx4 v5, s[20:23], s37 offen lds
s_add_u32 s37, s39, 2162688
s_add_u32 m0, s38, 10240
s_nop 0
buffer_load_dwordx4 v6, s[20:23], s37 offen lds
s_add_u32 s37, s39, 2195456
s_add_u32 m0, s38, 11264
s_nop 0
buffer_load_dwordx4 v6, s[20:23], s37 offen lds
ds_read_b64_tr_b16 a[112:113], v20 offset:12288
ds_read_b64_tr_b16 a[114:115], v20 offset:13312
ds_read_b64_tr_b16 a[116:117], v22 offset:12288
ds_read_b64_tr_b16 a[118:119], v22 offset:13312
ds_read_b64_tr_b16 a[184:185], v21 offset:12288
ds_read_b64_tr_b16 a[186:187], v21 offset:13312
ds_read_b64_tr_b16 a[188:189], v23 offset:12288
ds_read_b64_tr_b16 a[190:191], v23 offset:13312
s_waitcnt lgkmcnt(0)
s_waitcnt vmcnt(12)
s_barrier
s_add_u32 s37, s39, 2621440
s_add_u32 m0, s38, 12288
s_nop 0
buffer_load_dwordx4 v5, s[20:23], s37 offen lds
s_add_u32 s37, s39, 2654208
s_add_u32 m0, s38, 13312
s_nop 0
buffer_load_dwordx4 v5, s[20:23], s37 offen lds
s_add_u32 s37, s39, 2686976
s_add_u32 m0, s38, 14336
s_nop 0
buffer_load_dwordx4 v6, s[20:23], s37 offen lds
s_add_u32 s37, s39, 2719744
s_add_u32 m0, s38, 15360
s_nop 0
buffer_load_dwordx4 v6, s[20:23], s37 offen lds
ds_read_b64_tr_b16 a[120:121], v20 offset:16384
ds_read_b64_tr_b16 a[122:123], v20 offset:17408
ds_read_b64_tr_b16 a[124:125], v22 offset:16384
ds_read_b64_tr_b16 a[126:127], v22 offset:17408
ds_read_b64_tr_b16 a[192:193], v21 offset:16384
ds_read_b64_tr_b16 a[194:195], v21 offset:17408
ds_read_b64_tr_b16 a[196:197], v23 offset:16384
ds_read_b64_tr_b16 a[198:199], v23 offset:17408
s_waitcnt lgkmcnt(0)
s_waitcnt vmcnt(12)
s_barrier
s_add_u32 s37, s39, 3145728
s_add_u32 m0, s38, 16384
s_nop 0
buffer_load_dwordx4 v5, s[20:23], s37 offen lds
s_add_u32 s37, s39, 3178496
s_add_u32 m0, s38, 17408
s_nop 0
buffer_load_dwordx4 v5, s[20:23], s37 offen lds
s_add_u32 s37, s39, 3211264
s_add_u32 m0, s38, 18432
s_nop 0
buffer_load_dwordx4 v6, s[20:23], s37 offen lds
s_add_u32 s37, s39, 3244032
s_add_u32 m0, s38, 19456
s_nop 0
buffer_load_dwordx4 v6, s[20:23], s37 offen lds
ds_read_b64_tr_b16 a[128:129], v20 offset:0
ds_read_b64_tr_b16 a[130:131], v20 offset:1024
ds_read_b64_tr_b16 a[132:133], v22 offset:0
ds_read_b64_tr_b16 a[134:135], v22 offset:1024
ds_read_b64_tr_b16 a[200:201], v21 offset:0
ds_read_b64_tr_b16 a[202:203], v21 offset:1024
ds_read_b64_tr_b16 a[204:205], v23 offset:0
ds_read_b64_tr_b16 a[206:207], v23 offset:1024
s_waitcnt lgkmcnt(0)
s_waitcnt vmcnt(12)
s_barrier
s_add_u32 s37, s39, 3670016
s_add_u32 m0, s38, 0
s_nop 0
buffer_load_dwordx4 v5, s[20:23], s37 offen lds
s_add_u32 s37, s39, 3702784
s_add_u32 m0, s38, 1024
s_nop 0
buffer_load_dwordx4 v5, s[20:23], s37 offen lds
s_add_u32 s37, s39, 3735552
s_add_u32 m0, s38, 2048
s_nop 0
buffer_load_dwordx4 v6, s[20:23], s37 offen lds
s_add_u32 s37, s39, 3768320
s_add_u32 m0, s38, 3072
s_nop 0
buffer_load_dwordx4 v6, s[20:23], s37 offen lds
ds_read_b64_tr_b16 a[136:137], v20 offset:4096
ds_read_b64_tr_b16 a[138:139], v20 offset:5120
ds_read_b64_tr_b16 a[140:141], v22 offset:4096
ds_read_b64_tr_b16 a[142:143], v22 offset:5120
ds_read_b64_tr_b16 a[208:209], v21 offset:4096
ds_read_b64_tr_b16 a[210:211], v21 offset:5120
ds_read_b64_tr_b16 a[212:213], v23 offset:4096
ds_read_b64_tr_b16 a[214:215], v23 offset:5120
s_waitcnt lgkmcnt(0)
s_waitcnt vmcnt(12)
s_barrier
s_add_u32 s37, s39, 4194304
s_add_u32 m0, s38, 4096
s_nop 0
buffer_load_dwordx4 v5, s[20:23], s37 offen lds
s_add_u32 s37, s39, 4227072
s_add_u32 m0, s38, 5120
s_nop 0
buffer_load_dwordx4 v5, s[20:23], s37 offen lds
s_add_u32 s37, s39, 4259840
s_add_u32 m0, s38, 6144
s_nop 0
buffer_load_dwordx4 v6, s[20:23], s37 offen lds
s_add_u32 s37, s39, 4292608
s_add_u32 m0, s38, 7168
s_nop 0
buffer_load_dwordx4 v6, s[20:23], s37 offen lds
ds_read_b64_tr_b16 a[144:145], v20 offset:8192
ds_read_b64_tr_b16 a[146:147], v20 offset:9216
ds_read_b64_tr_b16 a[148:149], v22 offset:8192
ds_read_b64_tr_b16 a[150:151], v22 offset:9216
ds_read_b64_tr_b16 a[216:217], v21 offset:8192
ds_read_b64_tr_b16 a[218:219], v21 offset:9216
ds_read_b64_tr_b16 a[220:221], v23 offset:8192
ds_read_b64_tr_b16 a[222:223], v23 offset:9216
s_waitcnt lgkmcnt(0)
s_waitcnt vmcnt(12)
s_barrier
ds_read_b64_tr_b16 a[152:153], v20 offset:12288
ds_read_b64_tr_b16 a[154:155], v20 offset:13312
ds_read_b64_tr_b16 a[156:157], v22 offset:12288
ds_read_b64_tr_b16 a[158:159], v22 offset:13312
ds_read_b64_tr_b16 a[224:225], v21 offset:12288
ds_read_b64_tr_b16 a[226:227], v21 offset:13312
ds_read_b64_tr_b16 a[228:229], v23 offset:12288
ds_read_b64_tr_b16 a[230:231], v23 offset:13312
s_waitcnt lgkmcnt(0)
s_waitcnt vmcnt(8)
s_barrier
ds_read_b64_tr_b16 a[160:161], v20 offset:16384
ds_read_b64_tr_b16 a[162:163], v20 offset:17408
ds_read_b64_tr_b16 a[164:165], v22 offset:16384
ds_read_b64_tr_b16 a[166:167], v22 offset:17408
ds_read_b64_tr_b16 a[232:233], v21 offset:16384
ds_read_b64_tr_b16 a[234:235], v21 offset:17408
ds_read_b64_tr_b16 a[236:237], v23 offset:16384
ds_read_b64_tr_b16 a[238:239], v23 offset:17408
s_waitcnt lgkmcnt(0)
s_waitcnt vmcnt(4)
s_barrier
ds_read_b64_tr_b16 a[168:169], v20 offset:0
ds_read_b64_tr_b16 a[170:171], v20 offset:1024
ds_read_b64_tr_b16 a[172:173], v22 offset:0
ds_read_b64_tr_b16 a[174:175], v22 offset:1024
ds_read_b64_tr_b16 a[240:241], v21 offset:0
ds_read_b64_tr_b16 a[242:243], v21 offset:1024
ds_read_b64_tr_b16 a[244:245], v23 offset:0
ds_read_b64_tr_b16 a[246:247], v23 offset:1024
s_waitcnt lgkmcnt(0)
s_waitcnt vmcnt(0)
s_barrier
ds_read_b64_tr_b16 a[176:177], v20 offset:4096
ds_read_b64_tr_b16 a[178:179], v20 offset:5120
ds_read_b64_tr_b16 a[180:181], v22 offset:4096
ds_read_b64_tr_b16 a[182:183], v22 offset:5120
ds_read_b64_tr_b16 a[248:249], v21 offset:4096
ds_read_b64_tr_b16 a[250:251], v21 offset:5120
ds_read_b64_tr_b16 a[252:253], v23 offset:4096
ds_read_b64_tr_b16 a[254:255], v23 offset:5120
s_waitcnt lgkmcnt(0)
s_lshl_b32 s42, s33, 5
s_add_u32 s42, s42, s32
s_lshl_b32 s39, s42, 13
s_lshl_b32 s37, s34, 11
s_add_u32 s39, s39, s37
s_add_u32 s39, s39, 50331648
s_lshl_b32 s40, s42, 14
s_add_u32 s40, s40, 16777216
s_lshl_b32 s37, s34, 12
s_add_u32 s41, s40, s37
s_lshr_b32 s37, s34, 1
s_lshl_b32 s37, s37, 10
s_add_u32 s40, s40, s37
s_and_b32 s37, s34, 1
s_lshl_b32 s37, s37, 6
s_add_u32 s40, s40, s37
s_mov_b32 s35, 0
s_mov_b32 s48, 36864
s_lshl_b32 s49, s32, 5
s_lshl_b32 s37, s33, 2
s_add_u32 s49, s49, s37
s_add_u32 s49, s49, s34
s_lshl_b32 s49, s49, 2
s_add_u32 s49, s49, 327680
s_waitcnt vmcnt(0)
.p2align 6
L_q_loop:
s_waitcnt vmcnt(7)
s_barrier
s_add_u32 s43, s43, 147456
s_add_u32 s44, s44, s48
ds_read_b128 v[64:67], v3 offset:0
ds_read_b128 v[68:71], v3 offset:1024
ds_read_b128 v[72:75], v3 offset:2048
ds_read_b128 v[76:79], v3 offset:3072
s_waitcnt lgkmcnt(2)
v_mfma_f32_16x16x32_bf16 v[16:19], v[80:83], v[64:67], 0
v_mfma_f32_16x16x32_bf16 v[20:23], v[80:83], v[68:71], 0
v_mfma_f32_16x16x32_bf16 v[24:27], v[152:155], v[64:67], 0
v_mfma_f32_16x16x32_bf16 v[28:31], v[152:155], v[68:71], 0
s_add_u32 s37, s43, 0
s_add_u32 m0, s44, 0
s_nop 0
buffer_load_dwordx4 v2, s[8:11], s37 offen lds
v_mfma_f32_16x16x32_bf16 v[32:35], v[224:227], v[64:67], 0
v_mfma_f32_16x16x32_bf16 v[36:39], v[224:227], v[68:71], 0
v_mfma_f32_16x16x32_bf16 v[40:43], a[40:43], v[64:67], 0
v_mfma_f32_16x16x32_bf16 v[44:47], a[40:43], v[68:71], 0
v_mfma_f32_16x16x32_bf16 v[48:51], v[64:67], a[112:115], 0
v_mfma_f32_16x16x32_bf16 v[52:55], v[68:71], a[112:115], 0
v_mfma_f32_16x16x32_bf16 v[56:59], v[64:67], a[184:187], 0
v_mfma_f32_16x16x32_bf16 v[60:63], v[68:71], a[184:187], 0
ds_read_b128 v[64:67], v3 offset:4096
ds_read_b128 v[68:71], v3 offset:5120
s_waitcnt lgkmcnt(2)
v_mfma_f32_16x16x32_bf16 v[16:19], v[84:87], v[72:75], v[16:19]
v_mfma_f32_16x16x32_bf16 v[20:23], v[84:87], v[76:79], v[20:23]
v_mfma_f32_16x16x32_bf16 v[24:27], v[156:159], v[72:75], v[24:27]
v_mfma_f32_16x16x32_bf16 v[28:31], v[156:159], v[76:79], v[28:31]
s_add_u32 s37, s43, 128
s_add_u32 m0, s44, 4096
s_nop 0
buffer_load_dwordx4 v2, s[8:11], s37 offen lds
v_mfma_f32_16x16x32_bf16 v[32:35], v[228:231], v[72:75], v[32:35]
v_mfma_f32_16x16x32_bf16 v[36:39], v[228:231], v[76:79], v[36:39]
v_mfma_f32_16x16x32_bf16 v[40:43], a[44:47], v[72:75], v[40:43]
v_mfma_f32_16x16x32_bf16 v[44:47], a[44:47], v[76:79], v[44:47]
v_mfma_f32_16x16x32_bf16 v[48:51], v[72:75], a[116:119], v[48:51]
v_mfma_f32_16x16x32_bf16 v[52:55], v[76:79], a[116:119], v[52:55]
v_mfma_f32_16x16x32_bf16 v[56:59], v[72:75], a[188:191], v[56:59]
v_mfma_f32_16x16x32_bf16 v[60:63], v[76:79], a[188:191], v[60:63]
ds_read_b128 v[72:75], v3 offset:6144
ds_read_b128 v[76:79], v3 offset:7168
s_waitcnt lgkmcnt(2)
v_mfma_f32_16x16x32_bf16 v[16:19], v[88:91], v[64:67], v[16:19]
v_mfma_f32_16x16x32_bf16 v[20:23], v[88:91], v[68:71], v[20:23]
v_mfma_f32_16x16x32_bf16 v[24:27], v[160:163], v[64:67], v[24:27]
v_mfma_f32_16x16x32_bf16 v[28:31], v[160:163], v[68:71], v[28:31]
s_add_u32 s37, s43, 256
s_add_u32 m0, s44, 8192
s_nop 0
buffer_load_dwordx4 v2, s[8:11], s37 offen lds
v_mfma_f32_16x16x32_bf16 v[32:35], v[232:235], v[64:67], v[32:35]
v_mfma_f32_16x16x32_bf16 v[36:39], v[232:235], v[68:71], v[36:39]
v_mfma_f32_16x16x32_bf16 v[40:43], a[48:51], v[64:67], v[40:43]
v_mfma_f32_16x16x32_bf16 v[44:47], a[48:51], v[68:71], v[44:47]
v_mfma_f32_16x16x32_bf16 v[48:51], v[64:67], a[120:123], v[48:51]
v_mfma_f32_16x16x32_bf16 v[52:55], v[68:71], a[120:123], v[52:55]
v_mfma_f32_16x16x32_bf16 v[56:59], v[64:67], a[192:195], v[56:59]
v_mfma_f32_16x16x32_bf16 v[60:63], v[68:71], a[192:195], v[60:63]
ds_read_b128 v[64:67], v3 offset:8192
ds_read_b128 v[68:71], v3 offset:9216
s_waitcnt lgkmcnt(2)
v_mfma_f32_16x16x32_bf16 v[16:19], v[92:95], v[72:75], v[16:19]
v_mfma_f32_16x16x32_bf16 v[20:23], v[92:95], v[76:79], v[20:23]
v_mfma_f32_16x16x32_bf16 v[24:27], v[164:167], v[72:75], v[24:27]
v_mfma_f32_16x16x32_bf16 v[28:31], v[164:167], v[76:79], v[28:31]
s_add_u32 s37, s43, 384
s_add_u32 m0, s44, 12288
s_nop 0
buffer_load_dwordx4 v2, s[8:11], s37 offen lds
v_mfma_f32_16x16x32_bf16 v[32:35], v[236:239], v[72:75], v[32:35]
v_mfma_f32_16x16x32_bf16 v[36:39], v[236:239], v[76:79], v[36:39]
v_mfma_f32_16x16x32_bf16 v[40:43], a[52:55], v[72:75], v[40:43]
v_mfma_f32_16x16x32_bf16 v[44:47], a[52:55], v[76:79], v[44:47]
v_mfma_f32_16x16x32_bf16 v[48:51], v[72:75], a[124:127], v[48:51]
v_mfma_f32_16x16x32_bf16 v[52:55], v[76:79], a[124:127], v[52:55]
v_mfma_f32_16x16x32_bf16 v[56:59], v[72:75], a[196:199], v[56:59]
v_mfma_f32_16x16x32_bf16 v[60:63], v[76:79], a[196:199], v[60:63]
ds_read_b128 v[72:75], v3 offset:10240
ds_read_b128 v[76:79], v3 offset:11264
s_waitcnt lgkmcnt(2)
v_mfma_f32_16x16x32_bf16 v[16:19], v[96:99], v[64:67], v[16:19]
v_mfma_f32_16x16x32_bf16 v[20:23], v[96:99], v[68:71], v[20:23]
v_mfma_f32_16x16x32_bf16 v[24:27], v[168:171], v[64:67], v[24:27]
v_mfma_f32_16x16x32_bf16 v[28:31], v[168:171], v[68:71], v[28:31]
s_add_u32 s37, s43, 512
s_add_u32 m0, s44, 16384
s_nop 0
buffer_load_dwordx4 v2, s[8:11], s37 offen lds
v_mfma_f32_16x16x32_bf16 v[32:35], v[240:243], v[64:67], v[32:35]
v_mfma_f32_16x16x32_bf16 v[36:39], v[240:243], v[68:71], v[36:39]
v_mfma_f32_16x16x32_bf16 v[40:43], a[56:59], v[64:67], v[40:43]
v_mfma_f32_16x16x32_bf16 v[44:47], a[56:59], v[68:71], v[44:47]
v_mfma_f32_16x16x32_bf16 v[48:51], v[64:67], a[128:131], v[48:51]
v_mfma_f32_16x16x32_bf16 v[52:55], v[68:71], a[128:131], v[52:55]
v_mfma_f32_16x16x32_bf16 v[56:59], v[64:67], a[200:203], v[56:59]
v_mfma_f32_16x16x32_bf16 v[60:63], v[68:71], a[200:203], v[60:63]
ds_read_b128 v[64:67], v3 offset:12288
ds_read_b128 v[68:71], v3 offset:13312
s_waitcnt lgkmcnt(2)
v_mfma_f32_16x16x32_bf16 v[16:19], v[100:103], v[72:75], v[16:19]
v_mfma_f32_16x16x32_bf16 v[20:23], v[100:103], v[76:79], v[20:23]
v_mfma_f32_16x16x32_bf16 v[24:27], v[172:175], v[72:75], v[24:27]
v_mfma_f32_16x16x32_bf16 v[28:31], v[172:175], v[76:79], v[28:31]
s_add_u32 s37, s43, 640
s_add_u32 m0, s44, 20480
s_nop 0
buffer_load_dwordx4 v2, s[8:11], s37 offen lds
v_mfma_f32_16x16x32_bf16 v[32:35], v[244:247], v[72:75], v[32:35]
v_mfma_f32_16x16x32_bf16 v[36:39], v[244:247], v[76:79], v[36:39]
v_mfma_f32_16x16x32_bf16 v[40:43], a[60:63], v[72:75], v[40:43]
v_mfma_f32_16x16x32_bf16 v[44:47], a[60:63], v[76:79], v[44:47]
v_mfma_f32_16x16x32_bf16 v[48:51], v[72:75], a[132:135], v[48:51]
v_mfma_f32_16x16x32_bf16 v[52:55], v[76:79], a[132:135], v[52:55]
v_mfma_f32_16x16x32_bf16 v[56:59], v[72:75], a[204:207], v[56:59]
v_mfma_f32_16x16x32_bf16 v[60:63], v[76:79], a[204:207], v[60:63]
ds_read_b128 v[72:75], v3 offset:14336
ds_read_b128 v[76:79], v3 offset:15360
s_waitcnt lgkmcnt(2)
v_mfma_f32_16x16x32_bf16 v[16:19], v[104:107], v[64:67], v[16:19]
v_mfma_f32_16x16x32_bf16 v[20:23], v[104:107], v[68:71], v[20:23]
v_mfma_f32_16x16x32_bf16 v[24:27], v[176:179], v[64:67], v[24:27]
v_mfma_f32_16x16x32_bf16 v[28:31], v[176:179], v[68:71], v[28:31]
s_add_u32 s37, s43, 768
s_add_u32 m0, s44, 24576
s_nop 0
buffer_load_dwordx4 v2, s[8:11], s37 offen lds
v_mfma_f32_16x16x32_bf16 v[32:35], v[248:251], v[64:67], v[32:35]
v_mfma_f32_16x16x32_bf16 v[36:39], v[248:251], v[68:71], v[36:39]
v_mfma_f32_16x16x32_bf16 v[40:43], a[64:67], v[64:67], v[40:43]
v_mfma_f32_16x16x32_bf16 v[44:47], a[64:67], v[68:71], v[44:47]
v_mfma_f32_16x16x32_bf16 v[48:51], v[64:67], a[136:139], v[48:51]
v_mfma_f32_16x16x32_bf16 v[52:55], v[68:71], a[136:139], v[52:55]
v_mfma_f32_16x16x32_bf16 v[56:59], v[64:67], a[208:211], v[56:59]
v_mfma_f32_16x16x32_bf16 v[60:63], v[68:71], a[208:211], v[60:63]
ds_read_b128 v[64:67], v3 offset:16384
ds_read_b128 v[68:71], v3 offset:17408
s_waitcnt lgkmcnt(2)
v_mfma_f32_16x16x32_bf16 v[16:19], v[108:111], v[72:75], v[16:19]
v_mfma_f32_16x16x32_bf16 v[20:23], v[108:111], v[76:79], v[20:23]
v_mfma_f32_16x16x32_bf16 v[24:27], v[180:183], v[72:75], v[24:27]
v_mfma_f32_16x16x32_bf16 v[28:31], v[180:183], v[76:79], v[28:31]
s_add_u32 s37, s43, 896
s_add_u32 m0, s44, 28672
s_nop 0
buffer_load_dwordx4 v2, s[8:11], s37 offen lds
v_mfma_f32_16x16x32_bf16 v[32:35], v[252:255], v[72:75], v[32:35]
v_mfma_f32_16x16x32_bf16 v[36:39], v[252:255], v[76:79], v[36:39]
v_mfma_f32_16x16x32_bf16 v[40:43], a[68:71], v[72:75], v[40:43]
v_mfma_f32_16x16x32_bf16 v[44:47], a[68:71], v[76:79], v[44:47]
v_mfma_f32_16x16x32_bf16 v[48:51], v[72:75], a[140:143], v[48:51]
v_mfma_f32_16x16x32_bf16 v[52:55], v[76:79], a[140:143], v[52:55]
v_mfma_f32_16x16x32_bf16 v[56:59], v[72:75], a[212:215], v[56:59]
v_mfma_f32_16x16x32_bf16 v[60:63], v[76:79], a[212:215], v[60:63]
ds_read_b128 v[72:75], v3 offset:18432
ds_read_b128 v[76:79], v3 offset:19456
s_waitcnt lgkmcnt(2)
v_mfma_f32_16x16x32_bf16 v[16:19], v[112:115], v[64:67], v[16:19]
v_mfma_f32_16x16x32_bf16 v[20:23], v[112:115], v[68:71], v[20:23]
v_mfma_f32_16x16x32_bf16 v[24:27], v[184:187], v[64:67], v[24:27]
v_mfma_f32_16x16x32_bf16 v[28:31], v[184:187], v[68:71], v[28:31]
s_add_u32 s37, s43, 1024
s_add_u32 m0, s44, 32768
s_nop 0
buffer_load_dwordx4 v2, s[8:11], s37 offen lds
v_mfma_f32_16x16x32_bf16 v[32:35], a[0:3], v[64:67], v[32:35]
v_mfma_f32_16x16x32_bf16 v[36:39], a[0:3], v[68:71], v[36:39]
v_mfma_f32_16x16x32_bf16 v[40:43], a[72:75], v[64:67], v[40:43]
v_mfma_f32_16x16x32_bf16 v[44:47], a[72:75], v[68:71], v[44:47]
v_mfma_f32_16x16x32_bf16 v[48:51], v[64:67], a[144:147], v[48:51]
v_mfma_f32_16x16x32_bf16 v[52:55], v[68:71], a[144:147], v[52:55]
v_mfma_f32_16x16x32_bf16 v[56:59], v[64:67], a[216:219], v[56:59]
v_mfma_f32_16x16x32_bf16 v[60:63], v[68:71], a[216:219], v[60:63]
ds_read_b128 v[64:67], v3 offset:20480
ds_read_b128 v[68:71], v3 offset:21504
s_waitcnt lgkmcnt(2)
v_mfma_f32_16x16x32_bf16 v[16:19], v[116:119], v[72:75], v[16:19]
v_mfma_f32_16x16x32_bf16 v[20:23], v[116:119], v[76:79], v[20:23]
v_mfma_f32_16x16x32_bf16 v[24:27], v[188:191], v[72:75], v[24:27]
v_mfma_f32_16x16x32_bf16 v[28:31], v[188:191], v[76:79], v[28:31]
v_mfma_f32_16x16x32_bf16 v[32:35], a[4:7], v[72:75], v[32:35]
v_mfma_f32_16x16x32_bf16 v[36:39], a[4:7], v[76:79], v[36:39]
v_mfma_f32_16x16x32_bf16 v[40:43], a[76:79], v[72:75], v[40:43]
v_mfma_f32_16x16x32_bf16 v[44:47], a[76:79], v[76:79], v[44:47]
v_mfma_f32_16x16x32_bf16 v[48:51], v[72:75], a[148:151], v[48:51]
v_mfma_f32_16x16x32_bf16 v[52:55], v[76:79], a[148:151], v[52:55]
v_mfma_f32_16x16x32_bf16 v[56:59], v[72:75], a[220:223], v[56:59]
v_mfma_f32_16x16x32_bf16 v[60:63], v[76:79], a[220:223], v[60:63]
ds_read_b128 v[72:75], v3 offset:22528
ds_read_b128 v[76:79], v3 offset:23552
s_waitcnt lgkmcnt(2)
v_mfma_f32_16x16x32_bf16 v[16:19], v[120:123], v[64:67], v[16:19]
v_mfma_f32_16x16x32_bf16 v[20:23], v[120:123], v[68:71], v[20:23]
v_mfma_f32_16x16x32_bf16 v[24:27], v[192:195], v[64:67], v[24:27]
v_mfma_f32_16x16x32_bf16 v[28:31], v[192:195], v[68:71], v[28:31]
s_waitcnt vmcnt(9)
v_mov_b32 v12, s35
s_mov_b64 exec, 1
buffer_store_dword v12, v8, s[4:7], s49 offen sc0 sc1
s_mov_b64 exec, -1
v_mfma_f32_16x16x32_bf16 v[32:35], a[8:11], v[64:67], v[32:35]
v_mfma_f32_16x16x32_bf16 v[36:39], a[8:11], v[68:71], v[36:39]
v_mfma_f32_16x16x32_bf16 v[40:43], a[80:83], v[64:67], v[40:43]
v_mfma_f32_16x16x32_bf16 v[44:47], a[80:83], v[68:71], v[44:47]
v_mfma_f32_16x16x32_bf16 v[48:51], v[64:67], a[152:155], v[48:51]
v_mfma_f32_16x16x32_bf16 v[52:55], v[68:71], a[152:155], v[52:55]
v_mfma_f32_16x16x32_bf16 v[56:59], v[64:67], a[224:227], v[56:59]
v_mfma_f32_16x16x32_bf16 v[60:63], v[68:71], a[224:227], v[60:63]
ds_read_b128 v[64:67], v3 offset:24576
ds_read_b128 v[68:71], v3 offset:25600
s_waitcnt lgkmcnt(2)
v_mfma_f32_16x16x32_bf16 v[16:19], v[124:127], v[72:75], v[16:19]
v_mfma_f32_16x16x32_bf16 v[20:23], v[124:127], v[76:79], v[20:23]
v_mfma_f32_16x16x32_bf16 v[24:27], v[196:199], v[72:75], v[24:27]
v_mfma_f32_16x16x32_bf16 v[28:31], v[196:199], v[76:79], v[28:31]
v_mfma_f32_16x16x32_bf16 v[32:35], a[12:15], v[72:75], v[32:35]
v_mfma_f32_16x16x32_bf16 v[36:39], a[12:15], v[76:79], v[36:39]
v_mfma_f32_16x16x32_bf16 v[40:43], a[84:87], v[72:75], v[40:43]
v_mfma_f32_16x16x32_bf16 v[44:47], a[84:87], v[76:79], v[44:47]
v_mfma_f32_16x16x32_bf16 v[48:51], v[72:75], a[156:159], v[48:51]
v_mfma_f32_16x16x32_bf16 v[52:55], v[76:79], a[156:159], v[52:55]
v_mfma_f32_16x16x32_bf16 v[56:59], v[72:75], a[228:231], v[56:59]
v_mfma_f32_16x16x32_bf16 v[60:63], v[76:79], a[228:231], v[60:63]
ds_read_b128 v[72:75], v3 offset:26624
ds_read_b128 v[76:79], v3 offset:27648
s_waitcnt lgkmcnt(2)
v_mfma_f32_16x16x32_bf16 v[16:19], v[128:131], v[64:67], v[16:19]
v_mfma_f32_16x16x32_bf16 v[20:23], v[128:131], v[68:71], v[20:23]
v_mfma_f32_16x16x32_bf16 v[24:27], v[200:203], v[64:67], v[24:27]
v_mfma_f32_16x16x32_bf16 v[28:31], v[200:203], v[68:71], v[28:31]
v_mfma_f32_16x16x32_bf16 v[32:35], a[16:19], v[64:67], v[32:35]
v_mfma_f32_16x16x32_bf16 v[36:39], a[16:19], v[68:71], v[36:39]
v_mfma_f32_16x16x32_bf16 v[40:43], a[88:91], v[64:67], v[40:43]
v_mfma_f32_16x16x32_bf16 v[44:47], a[88:91], v[68:71], v[44:47]
v_mfma_f32_16x16x32_bf16 v[48:51], v[64:67], a[160:163], v[48:51]
v_mfma_f32_16x16x32_bf16 v[52:55], v[68:71], a[160:163], v[52:55]
v_mfma_f32_16x16x32_bf16 v[56:59], v[64:67], a[232:235], v[56:59]
v_mfma_f32_16x16x32_bf16 v[60:63], v[68:71], a[232:235], v[60:63]
ds_read_b128 v[64:67], v3 offset:28672
ds_read_b128 v[68:71], v3 offset:29696
s_waitcnt lgkmcnt(2)
v_mfma_f32_16x16x32_bf16 v[16:19], v[132:135], v[72:75], v[16:19]
v_mfma_f32_16x16x32_bf16 v[20:23], v[132:135], v[76:79], v[20:23]
v_mfma_f32_16x16x32_bf16 v[24:27], v[204:207], v[72:75], v[24:27]
v_mfma_f32_16x16x32_bf16 v[28:31], v[204:207], v[76:79], v[28:31]
v_mfma_f32_16x16x32_bf16 v[32:35], a[20:23], v[72:75], v[32:35]
v_mfma_f32_16x16x32_bf16 v[36:39], a[20:23], v[76:79], v[36:39]
v_mfma_f32_16x16x32_bf16 v[40:43], a[92:95], v[72:75], v[40:43]
v_mfma_f32_16x16x32_bf16 v[44:47], a[92:95], v[76:79], v[44:47]
v_mfma_f32_16x16x32_bf16 v[48:51], v[72:75], a[164:167], v[48:51]
v_mfma_f32_16x16x32_bf16 v[52:55], v[76:79], a[164:167], v[52:55]
v_mfma_f32_16x16x32_bf16 v[56:59], v[72:75], a[236:239], v[56:59]
v_mfma_f32_16x16x32_bf16 v[60:63], v[76:79], a[236:239], v[60:63]
ds_read_b128 v[72:75], v3 offset:30720
ds_read_b128 v[76:79], v3 offset:31744
s_waitcnt lgkmcnt(2)
v_mfma_f32_16x16x32_bf16 v[16:19], v[136:139], v[64:67], v[16:19]
v_mfma_f32_16x16x32_bf16 v[20:23], v[136:139], v[68:71], v[20:23]
v_mfma_f32_16x16x32_bf16 v[24:27], v[208:211], v[64:67], v[24:27]
v_mfma_f32_16x16x32_bf16 v[28:31], v[208:211], v[68:71], v[28:31]
v_mfma_f32_16x16x32_bf16 v[32:35], a[24:27], v[64:67], v[32:35]
v_mfma_f32_16x16x32_bf16 v[36:39], a[24:27], v[68:71], v[36:39]
v_mfma_f32_16x16x32_bf16 v[40:43], a[96:99], v[64:67], v[40:43]
v_mfma_f32_16x16x32_bf16 v[44:47], a[96:99], v[68:71], v[44:47]
v_mfma_f32_16x16x32_bf16 v[48:51], v[64:67], a[168:171], v[48:51]
v_mfma_f32_16x16x32_bf16 v[52:55], v[68:71], a[168:171], v[52:55]
v_mfma_f32_16x16x32_bf16 v[56:59], v[64:67], a[240:243], v[56:59]
v_mfma_f32_16x16x32_bf16 v[60:63], v[68:71], a[240:243], v[60:63]
ds_read_b128 v[64:67], v3 offset:32768
ds_read_b128 v[68:71], v3 offset:33792
s_waitcnt lgkmcnt(2)
v_mfma_f32_16x16x32_bf16 v[16:19], v[140:143], v[72:75], v[16:19]
v_mfma_f32_16x16x32_bf16 v[20:23], v[140:143], v[76:79], v[20:23]
v_mfma_f32_16x16x32_bf16 v[24:27], v[212:215], v[72:75], v[24:27]
v_mfma_f32_16x16x32_bf16 v[28:31], v[212:215], v[76:79], v[28:31]
v_mfma_f32_16x16x32_bf16 v[32:35], a[28:31], v[72:75], v[32:35]
v_mfma_f32_16x16x32_bf16 v[36:39], a[28:31], v[76:79], v[36:39]
v_mfma_f32_16x16x32_bf16 v[40:43], a[100:103], v[72:75], v[40:43]
v_mfma_f32_16x16x32_bf16 v[44:47], a[100:103], v[76:79], v[44:47]
v_mfma_f32_16x16x32_bf16 v[48:51], v[72:75], a[172:175], v[48:51]
v_mfma_f32_16x16x32_bf16 v[52:55], v[76:79], a[172:175], v[52:55]
v_mfma_f32_16x16x32_bf16 v[56:59], v[72:75], a[244:247], v[56:59]
v_mfma_f32_16x16x32_bf16 v[60:63], v[76:79], a[244:247], v[60:63]
ds_read_b128 v[72:75], v3 offset:34816
ds_read_b128 v[76:79], v3 offset:35840
s_waitcnt lgkmcnt(2)
v_mfma_f32_16x16x32_bf16 v[16:19], v[144:147], v[64:67], v[16:19]
v_mfma_f32_16x16x32_bf16 v[20:23], v[144:147], v[68:71], v[20:23]
v_mfma_f32_16x16x32_bf16 v[24:27], v[216:219], v[64:67], v[24:27]
v_mfma_f32_16x16x32_bf16 v[28:31], v[216:219], v[68:71], v[28:31]
v_mfma_f32_16x16x32_bf16 v[32:35], a[32:35], v[64:67], v[32:35]
v_mfma_f32_16x16x32_bf16 v[36:39], a[32:35], v[68:71], v[36:39]
v_mfma_f32_16x16x32_bf16 v[40:43], a[104:107], v[64:67], v[40:43]
v_mfma_f32_16x16x32_bf16 v[44:47], a[104:107], v[68:71], v[44:47]
v_mfma_f32_16x16x32_bf16 v[48:51], v[64:67], a[176:179], v[48:51]
v_mfma_f32_16x16x32_bf16 v[52:55], v[68:71], a[176:179], v[52:55]
v_mfma_f32_16x16x32_bf16 v[56:59], v[64:67], a[248:251], v[56:59]
v_mfma_f32_16x16x32_bf16 v[60:63], v[68:71], a[248:251], v[60:63]
s_waitcnt lgkmcnt(0)
v_mfma_f32_16x16x32_bf16 v[16:19], v[148:151], v[72:75], v[16:19]
v_mfma_f32_16x16x32_bf16 v[20:23], v[148:151], v[76:79], v[20:23]
v_mfma_f32_16x16x32_bf16 v[24:27], v[220:223], v[72:75], v[24:27]
v_mfma_f32_16x16x32_bf16 v[28:31], v[220:223], v[76:79], v[28:31]
v_mfma_f32_16x16x32_bf16 v[32:35], a[36:39], v[72:75], v[32:35]
v_mfma_f32_16x16x32_bf16 v[36:39], a[36:39], v[76:79], v[36:39]
v_mfma_f32_16x16x32_bf16 v[40:43], a[108:111], v[72:75], v[40:43]
v_mfma_f32_16x16x32_bf16 v[44:47], a[108:111], v[76:79], v[44:47]
v_mfma_f32_16x16x32_bf16 v[48:51], v[72:75], a[180:183], v[48:51]
v_mfma_f32_16x16x32_bf16 v[52:55], v[76:79], a[180:183], v[52:55]
v_mfma_f32_16x16x32_bf16 v[56:59], v[72:75], a[252:255], v[56:59]
v_mfma_f32_16x16x32_bf16 v[60:63], v[76:79], a[252:255], v[60:63]
v_add_u32 v3, s48, v3
s_sub_u32 s48, 0, s48
v_cvt_pk_bf16_f32 v64, v16, v17
v_cvt_pk_bf16_f32 v65, v18, v19
v_cvt_pk_bf16_f32 v66, v24, v25
v_cvt_pk_bf16_f32 v67, v26, v27
buffer_store_dwordx4 v[64:67], v1, s[4:7], s39 offen offset:0
v_cvt_pk_bf16_f32 v68, v20, v21
v_cvt_pk_bf16_f32 v69, v22, v23
v_cvt_pk_bf16_f32 v70, v28, v29
v_cvt_pk_bf16_f32 v71, v30, v31
buffer_store_dwordx4 v[68:71], v1, s[4:7], s39 offen offset:1024
v_pk_mul_f32 v[32:33], v[32:33], s[46:47]
v_pk_mul_f32 v[34:35], v[34:35], s[46:47]
v_pk_mul_f32 v[36:37], v[36:37], s[46:47]
v_pk_mul_f32 v[38:39], v[38:39], s[46:47]
v_pk_mul_f32 v[40:41], v[40:41], s[46:47]
v_pk_mul_f32 v[42:43], v[42:43], s[46:47]
v_pk_mul_f32 v[44:45], v[44:45], s[46:47]
v_pk_mul_f32 v[46:47], v[46:47], s[46:47]
v_cvt_pk_bf16_f32 v72, v32, v33
v_cvt_pk_bf16_f32 v73, v34, v35
v_cvt_pk_bf16_f32 v74, v40, v41
v_cvt_pk_bf16_f32 v75, v42, v43
buffer_store_dwordx4 v[72:75], v4, s[4:7], s40 offen offset:0 sc0 sc1
v_cvt_pk_bf16_f32 v76, v36, v37
v_cvt_pk_bf16_f32 v77, v38, v39
v_cvt_pk_bf16_f32 v78, v44, v45
v_cvt_pk_bf16_f32 v79, v46, v47
buffer_store_dwordx4 v[76:79], v4, s[4:7], s40 offen offset:128 sc0 sc1
v_cvt_pk_bf16_f32 v16, v48, v49
v_cvt_pk_bf16_f32 v17, v50, v51
v_cvt_pk_bf16_f32 v18, v52, v53
v_cvt_pk_bf16_f32 v19, v54, v55
buffer_store_dwordx4 v[16:19], v1, s[4:7], s41 offen offset:2048 sc0 sc1
v_cvt_pk_bf16_f32 v20, v56, v57
v_cvt_pk_bf16_f32 v21, v58, v59
v_cvt_pk_bf16_f32 v22, v60, v61
v_cvt_pk_bf16_f32 v23, v62, v63
buffer_store_dwordx4 v[20:23], v1, s[4:7], s41 offen offset:3072 sc0 sc1
s_add_u32 s39, s39, 1048576
s_add_u32 s40, s40, 2097152
s_add_u32 s41, s41, 2097152
s_add_u32 s35, s35, 1
s_cmp_lg_u32 s35, 1
s_cbranch_scc1 L_q_n1
s_branch L_q_init_in
L_q_init:
s_sleep 4
L_q_init_in:
buffer_load_dword v12, v8, s[24:27], 0 offen offset:0 sc0 sc1
s_sub_u32 s36, s36, 1
s_cbranch_scc1 L_exit_w
s_waitcnt vmcnt(0)
v_readfirstlane_b32 s37, v12
s_nop 0
s_and_b32 s37, s37, 0xff
s_cmp_eq_u32 s37, 32
s_cbranch_scc0 L_q_init
v_mov_b32 v12, s35
s_mov_b64 exec, 1
buffer_store_dword v12, v8, s[4:7], s49 offen sc0 sc1
s_mov_b64 exec, -1
s_waitcnt vmcnt(0)
L_q_n1:
s_cmp_lt_u32 s35, 16
s_cbranch_scc1 L_q_loop
s_waitcnt vmcnt(0)
v_mov_b32 v12, s35
s_mov_b64 exec, 1
buffer_store_dword v12, v8, s[4:7], s49 offen sc0 sc1
s_mov_b64 exec, -1
s_barrier
s_lshr_b32 s37, s34, 1
s_and_b32 s38, s34, 1
s_lshl_b32 s50, s42, 13
s_lshl_b32 s39, s37, 10
s_add_u32 s50, s50, s39
s_add_u32 s50, s50, 50331648
s_lshl_b32 s52, s42, 14
s_add_u32 s52, s52, 16777216
s_lshl_b32 s39, s38, 13
s_add_u32 s53, s52, s39
s_mul_i32 s55, s33, 10240
s_add_u32 s55, s55, 8388608
s_and_b32 s59, s33, 1
s_sub_u32 s59, s59, 1
s_lshl_b32 s39, s33, 1
s_add_u32 s39, s39, s37
s_lshl_b32 s56, s39, 6
s_lshl_b32 s40, s32, 1
s_add_u32 s40, s40, s38
s_add_u32 s56, s56, s40
s_lshl_b32 s58, s56, 4
s_add_u32 s58, s58, 331776
s_lshl_b32 s56, s56, 11
s_add_u32 s56, s56, 67108864
s_mov_b32 s35, 0
s_lshl_b32 s37, s37, 4
v_add_u32 v12, s37, v10
v_lshlrev_b32 v13, 2, v11
v_sub_u32 v12, v12, v13
v_mov_b32 v13, 0xf149f2ca
v_cmp_le_i32 vcc, 0, v12
s_nop 1
v_cndmask_b32 v80, v13, v8, vcc
v_cmp_le_i32 vcc, 1, v12
s_nop 1
v_cndmask_b32 v81, v13, v8, vcc
v_cmp_le_i32 vcc, 2, v12
s_nop 1
v_cndmask_b32 v82, v13, v8, vcc
v_cmp_le_i32 vcc, 3, v12
s_nop 1
v_cndmask_b32 v83, v13, v8, vcc
v_cmp_le_i32 vcc, 16, v12
s_nop 1
v_cndmask_b32 v84, v13, v8, vcc
v_cmp_le_i32 vcc, 17, v12
s_nop 1
v_cndmask_b32 v85, v13, v8, vcc
v_cmp_le_i32 vcc, 18, v12
s_nop 1
v_cndmask_b32 v86, v13, v8, vcc
v_cmp_le_i32 vcc, 19, v12
s_nop 1
v_cndmask_b32 v87, v13, v8, vcc
v_cmp_gt_u32 vcc, 2, v11
s_nop 1
v_cndmask_b32 v88, v13, v8, vcc
v_cndmask_b32 v89, v13, v8, vcc
v_cndmask_b32 v90, v13, v8, vcc
v_cndmask_b32 v91, v13, v8, vcc
v_mov_b32 v92, 0x3f803f80
v_mov_b32 v93, 0x3f803f80
v_mov_b32 v94, 0x3f803f80
v_mov_b32 v95, 0x3f803f80
v_lshrrev_b32 v12, 1, v11
v_lshlrev_b32 v14, 8, v12
v_and_b32 v12, 1, v11
v_lshl_add_u32 v14, v12, 5, v14
v_bfe_u32 v12, v10, 1, 2
v_lshl_add_u32 v14, v12, 6, v14
v_and_b32 v12, 1, v10
v_lshl_add_u32 v14, v12, 4, v14
s_lshl_b32 s37, s34, 8
v_lshl_add_u32 v15, v9, 2, s37
s_lshl_b32 s37, s34, 10
v_add_u32 v6, s37, v1
s_lshl_b32 s38, s38, 11
v_add_u32 v3, s38, v1
v_and_b32 v12, 3, v10
v_cmp_eq_u32 vcc, 0, v12
s_nop 1
v_cndmask_b32 v5, 0, 1, vcc
L_at_loop:
s_add_u32 s51, s50, 4096
s_add_u32 s54, s53, 4096
s_add_u32 s60, s55, 4096
s_add_u32 s57, s55, 8192
buffer_load_dwordx4 v[16:19], v1, s[4:7], s50 offen offset:0
buffer_load_dwordx4 v[32:35], v4, s[4:7], s52 offen offset:0 sc1
buffer_load_dwordx4 v[48:51], v4, s[4:7], s52 offen offset:128 sc1
buffer_load_dwordx4 v[20:23], v1, s[4:7], s50 offen offset:2048
buffer_load_dwordx4 v[36:39], v4, s[4:7], s52 offen offset:64 sc1
buffer_load_dwordx4 v[52:55], v4, s[4:7], s52 offen offset:192 sc1
buffer_load_dwordx4 v[24:27], v1, s[4:7], s51 offen offset:0
buffer_load_dwordx4 v[40:43], v4, s[4:7], s52 offen offset:1024 sc1
buffer_load_dwordx4 v[56:59], v4, s[4:7], s52 offen offset:1152 sc1
buffer_load_dwordx4 v[28:31], v1, s[4:7], s51 offen offset:2048
buffer_load_dwordx4 v[44:47], v4, s[4:7], s52 offen offset:1088 sc1
buffer_load_dwordx4 v[60:63], v4, s[4:7], s52 offen offset:1216 sc1
buffer_load_dwordx4 v[64:67], v1, s[4:7], s53 offen offset:2048 sc1
buffer_load_dwordx4 v[68:71], v1, s[4:7], s53 offen offset:3072 sc1
buffer_load_dwordx4 v[72:75], v1, s[4:7], s54 offen offset:2048 sc1
buffer_load_dwordx4 v[76:79], v1, s[4:7], s54 offen offset:3072 sc1
s_waitcnt vmcnt(13)
v_mfma_f32_16x16x32_bf16 v[96:99], v[32:35], v[16:19], v[80:83]
v_mfma_f32_16x16x32_bf16 v[100:103], v[48:51], v[16:19], v[84:87]
s_waitcnt vmcnt(10)
v_mfma_f32_16x16x32_bf16 v[96:99], v[36:39], v[20:23], v[96:99]
v_mfma_f32_16x16x32_bf16 v[100:103], v[52:55], v[20:23], v[100:103]
s_waitcnt vmcnt(7)
v_mfma_f32_16x16x32_bf16 v[96:99], v[40:43], v[24:27], v[96:99]
v_mfma_f32_16x16x32_bf16 v[100:103], v[56:59], v[24:27], v[100:103]
s_waitcnt vmcnt(4)
v_mfma_f32_16x16x32_bf16 v[96:99], v[44:47], v[28:31], v[96:99]
v_mfma_f32_16x16x32_bf16 v[100:103], v[60:63], v[28:31], v[100:103]
s_nop 3
v_max3_f32 v160, v96, v97, v98
s_nop 2
v_max3_f32 v160, v160, v99, v100
v_max3_f32 v160, v160, v101, v102
v_max_f32 v160, v160, v103
s_branch L_at_in
L_at_poll:
s_sleep 2
L_at_in:
buffer_load_dwordx4 v[164:167], v6, s[4:7], s55 offen sc0 sc1
buffer_load_dwordx4 v[168:171], v6, s[4:7], s60 offen sc0 sc1
buffer_load_dword v172, v15, s[4:7], s57 offen sc0 sc1
s_sub_u32 s36, s36, 1
s_cbranch_scc1 L_exit_w
s_waitcnt vmcnt(0)
v_bitop3_b32 v12, v164, v168, s59 bitop3:0x7e
v_bitop3_b32 v13, v172, s59, v5 bitop3:0x28
v_and_or_b32 v12, v12, 1, v13
v_cmp_ne_u32 vcc, 0, v12
s_cbranch_vccnz L_at_poll
ds_write_b128 v6, v[164:167]
ds_write_b128 v6, v[168:171] offset:4096
ds_write_b32 v15, v172 offset:8192
s_waitcnt lgkmcnt(0)
s_barrier
ds_read_b128 v[176:179], v14 offset:0
ds_read_b128 v[180:183], v14 offset:512
ds_read_b128 v[184:187], v14 offset:1024
ds_read_b128 v[188:191], v14 offset:1536
s_waitcnt lgkmcnt(3)
v_mfma_f32_16x16x32_bf16 v[192:195], v[224:227], v[176:179], 0
v_mfma_f32_16x16x32_bf16 v[196:199], a[40:43], v[176:179], 0
v_mfma_f32_16x16x32_bf16 v[200:203], v[176:179], a[112:115], 0
v_mfma_f32_16x16x32_bf16 v[204:207], v[176:179], a[184:187], 0
ds_read_b128 v[176:179], v14 offset:2048
s_waitcnt lgkmcnt(3)
v_mfma_f32_16x16x32_bf16 v[192:195], v[228:231], v[180:183], v[192:195]
v_mfma_f32_16x16x32_bf16 v[196:199], a[44:47], v[180:183], v[196:199]
v_mfma_f32_16x16x32_bf16 v[200:203], v[180:183], a[116:119], v[200:203]
v_mfma_f32_16x16x32_bf16 v[204:207], v[180:183], a[188:191], v[204:207]
ds_read_b128 v[180:183], v14 offset:2560
s_waitcnt lgkmcnt(3)
v_mfma_f32_16x16x32_bf16 v[192:195], v[232:235], v[184:187], v[192:195]
v_mfma_f32_16x16x32_bf16 v[196:199], a[48:51], v[184:187], v[196:199]
v_mfma_f32_16x16x32_bf16 v[200:203], v[184:187], a[120:123], v[200:203]
v_mfma_f32_16x16x32_bf16 v[204:207], v[184:187], a[192:195], v[204:207]
ds_read_b128 v[184:187], v14 offset:3072
s_waitcnt lgkmcnt(3)
v_mfma_f32_16x16x32_bf16 v[192:195], v[236:239], v[188:191], v[192:195]
v_mfma_f32_16x16x32_bf16 v[196:199], a[52:55], v[188:191], v[196:199]
v_mfma_f32_16x16x32_bf16 v[200:203], v[188:191], a[124:127], v[200:203]
v_mfma_f32_16x16x32_bf16 v[204:207], v[188:191], a[196:199], v[204:207]
ds_read_b128 v[188:191], v14 offset:3584
s_waitcnt lgkmcnt(3)
v_mfma_f32_16x16x32_bf16 v[192:195], v[240:243], v[176:179], v[192:195]
v_mfma_f32_16x16x32_bf16 v[196:199], a[56:59], v[176:179], v[196:199]
v_mfma_f32_16x16x32_bf16 v[200:203], v[176:179], a[128:131], v[200:203]
v_mfma_f32_16x16x32_bf16 v[204:207], v[176:179], a[200:203], v[204:207]
ds_read_b128 v[176:179], v14 offset:4096
s_waitcnt lgkmcnt(3)
v_mfma_f32_16x16x32_bf16 v[192:195], v[244:247], v[180:183], v[192:195]
v_mfma_f32_16x16x32_bf16 v[196:199], a[60:63], v[180:183], v[196:199]
v_mfma_f32_16x16x32_bf16 v[200:203], v[180:183], a[132:135], v[200:203]
v_mfma_f32_16x16x32_bf16 v[204:207], v[180:183], a[204:207], v[204:207]
ds_read_b128 v[180:183], v14 offset:4608
s_waitcnt lgkmcnt(3)
v_mfma_f32_16x16x32_bf16 v[192:195], v[248:251], v[184:187], v[192:195]
v_mfma_f32_16x16x32_bf16 v[196:199], a[64:67], v[184:187], v[196:199]
v_mfma_f32_16x16x32_bf16 v[200:203], v[184:187], a[136:139], v[200:203]
v_mfma_f32_16x16x32_bf16 v[204:207], v[184:187], a[208:211], v[204:207]
ds_read_b128 v[184:187], v14 offset:5120
s_waitcnt lgkmcnt(3)
v_mfma_f32_16x16x32_bf16 v[192:195], v[252:255], v[188:191], v[192:195]
v_mfma_f32_16x16x32_bf16 v[196:199], a[68:71], v[188:191], v[196:199]
v_mfma_f32_16x16x32_bf16 v[200:203], v[188:191], a[140:143], v[200:203]
v_mfma_f32_16x16x32_bf16 v[204:207], v[188:191], a[212:215], v[204:207]
ds_read_b128 v[188:191], v14 offset:5632
s_waitcnt lgkmcnt(3)
v_mfma_f32_16x16x32_bf16 v[192:195], a[0:3], v[176:179], v[192:195]
v_mfma_f32_16x16x32_bf16 v[196:199], a[72:75], v[176:179], v[196:199]
v_mfma_f32_16x16x32_bf16 v[200:203], v[176:179], a[144:147], v[200:203]
v_mfma_f32_16x16x32_bf16 v[204:207], v[176:179], a[216:219], v[204:207]
ds_read_b128 v[176:179], v14 offset:6144
s_waitcnt lgkmcnt(3)
v_mfma_f32_16x16x32_bf16 v[192:195], a[4:7], v[180:183], v[192:195]
v_mfma_f32_16x16x32_bf16 v[196:199], a[76:79], v[180:183], v[196:199]
v_mfma_f32_16x16x32_bf16 v[200:203], v[180:183], a[148:151], v[200:203]
v_mfma_f32_16x16x32_bf16 v[204:207], v[180:183], a[220:223], v[204:207]
ds_read_b128 v[180:183], v14 offset:6656
s_waitcnt lgkmcnt(3)
v_mfma_f32_16x16x32_bf16 v[192:195], a[8:11], v[184:187], v[192:195]
v_mfma_f32_16x16x32_bf16 v[196:199], a[80:83], v[184:187], v[196:199]
v_mfma_f32_16x16x32_bf16 v[200:203], v[184:187], a[152:155], v[200:203]
v_mfma_f32_16x16x32_bf16 v[204:207], v[184:187], a[224:227], v[204:207]
ds_read_b128 v[184:187], v14 offset:7168
s_waitcnt lgkmcnt(3)
v_mfma_f32_16x16x32_bf16 v[192:195], a[12:15], v[188:191], v[192:195]
v_mfma_f32_16x16x32_bf16 v[196:199], a[84:87], v[188:191], v[196:199]
v_mfma_f32_16x16x32_bf16 v[200:203], v[188:191], a[156:159], v[200:203]
v_mfma_f32_16x16x32_bf16 v[204:207], v[188:191], a[228:231], v[204:207]
ds_read_b128 v[188:191], v14 offset:7680
s_waitcnt lgkmcnt(3)
v_mfma_f32_16x16x32_bf16 v[192:195], a[16:19], v[176:179], v[192:195]
v_mfma_f32_16x16x32_bf16 v[196:199], a[88:91], v[176:179], v[196:199]
v_mfma_f32_16x16x32_bf16 v[200:203], v[176:179], a[160:163], v[200:203]
v_mfma_f32_16x16x32_bf16 v[204:207], v[176:179], a[232:235], v[204:207]
ds_read_b128 v[176:179], v14 offset:8192
s_waitcnt lgkmcnt(3)
v_mfma_f32_16x16x32_bf16 v[192:195], a[20:23], v[180:183], v[192:195]
v_mfma_f32_16x16x32_bf16 v[196:199], a[92:95], v[180:183], v[196:199]
v_mfma_f32_16x16x32_bf16 v[200:203], v[180:183], a[164:167], v[200:203]
v_mfma_f32_16x16x32_bf16 v[204:207], v[180:183], a[236:239], v[204:207]
ds_read_b128 v[180:183], v14 offset:8704
s_waitcnt lgkmcnt(3)
v_mfma_f32_16x16x32_bf16 v[192:195], a[24:27], v[184:187], v[192:195]
v_mfma_f32_16x16x32_bf16 v[196:199], a[96:99], v[184:187], v[196:199]
v_mfma_f32_16x16x32_bf16 v[200:203], v[184:187], a[168:171], v[200:203]
v_mfma_f32_16x16x32_bf16 v[204:207], v[184:187], a[240:243], v[204:207]
s_waitcnt lgkmcnt(2)
v_mfma_f32_16x16x32_bf16 v[192:195], a[28:31], v[188:191], v[192:195]
v_mfma_f32_16x16x32_bf16 v[196:199], a[100:103], v[188:191], v[196:199]
v_mfma_f32_16x16x32_bf16 v[200:203], v[188:191], a[172:175], v[200:203]
v_mfma_f32_16x16x32_bf16 v[204:207], v[188:191], a[244:247], v[204:207]
s_waitcnt lgkmcnt(1)
v_mfma_f32_16x16x32_bf16 v[192:195], a[32:35], v[176:179], v[192:195]
v_mfma_f32_16x16x32_bf16 v[196:199], a[104:107], v[176:179], v[196:199]
v_mfma_f32_16x16x32_bf16 v[200:203], v[176:179], a[176:179], v[200:203]
v_mfma_f32_16x16x32_bf16 v[204:207], v[176:179], a[248:251], v[204:207]
s_waitcnt lgkmcnt(0)
v_mfma_f32_16x16x32_bf16 v[192:195], a[36:39], v[180:183], v[192:195]
v_mfma_f32_16x16x32_bf16 v[196:199], a[108:111], v[180:183], v[196:199]
v_mfma_f32_16x16x32_bf16 v[200:203], v[180:183], a[180:183], v[200:203]
v_mfma_f32_16x16x32_bf16 v[204:207], v[180:183], a[252:255], v[204:207]
v_mul_f32 v192, s46, v192
v_mul_f32 v193, s46, v193
v_mul_f32 v194, s46, v194
v_mul_f32 v195, s46, v195
v_mul_f32 v196, s46, v196
v_mul_f32 v197, s46, v197
v_mul_f32 v198, s46, v198
v_mul_f32 v199, s46, v199
v_cvt_pk_bf16_f32 v208, v192, v193
v_cvt_pk_bf16_f32 v209, v194, v195
v_cvt_pk_bf16_f32 v210, v196, v197
v_cvt_pk_bf16_f32 v211, v198, v199
ds_write_b128 v6, v[208:211] offset:9216
v_cvt_pk_bf16_f32 v212, v200, v201
v_cvt_pk_bf16_f32 v213, v202, v203
v_cvt_pk_bf16_f32 v214, v204, v205
v_cvt_pk_bf16_f32 v215, v206, v207
ds_write_b128 v6, v[212:215] offset:13312
s_waitcnt lgkmcnt(0)
s_barrier
ds_read_b128 v[108:111], v1 offset:9216
ds_read_b128 v[112:115], v1 offset:10240
ds_read_b128 v[116:119], v1 offset:11264
ds_read_b128 v[120:123], v1 offset:12288
ds_read_b128 v[124:127], v3 offset:13312
ds_read_b128 v[128:131], v3 offset:14336
s_waitcnt lgkmcnt(5)
v_mfma_f32_16x16x32_bf16 v[104:107], v[108:111], v[16:19], v[88:91]
s_waitcnt lgkmcnt(4)
v_mfma_f32_16x16x32_bf16 v[104:107], v[112:115], v[20:23], v[104:107]
s_waitcnt lgkmcnt(3)
v_mfma_f32_16x16x32_bf16 v[104:107], v[116:119], v[24:27], v[104:107]
s_waitcnt lgkmcnt(2)
v_mfma_f32_16x16x32_bf16 v[104:107], v[120:123], v[28:31], v[104:107]
s_nop 7
v_max3_f32 v160, v160, v104, v105
v_max3_f32 v161, v160, v106, v107
v_max3_f32 v160, v160, v106, v107
s_nop 1
v_permlane16_swap_b32 v160, v161
v_max_f32 v162, v160, v161
v_max_f32 v163, v160, v161
s_nop 1
v_permlane32_swap_b32 v162, v163
v_max_f32 v160, v162, v163
v_pk_add_f32 v[96:97], v[96:97], v[160:161] op_sel_hi:[1,0] neg_lo:[0,1] neg_hi:[0,1]
v_pk_add_f32 v[98:99], v[98:99], v[160:161] op_sel_hi:[1,0] neg_lo:[0,1] neg_hi:[0,1]
v_pk_add_f32 v[100:101], v[100:101], v[160:161] op_sel_hi:[1,0] neg_lo:[0,1] neg_hi:[0,1]
v_pk_add_f32 v[102:103], v[102:103], v[160:161] op_sel_hi:[1,0] neg_lo:[0,1] neg_hi:[0,1]
v_pk_add_f32 v[104:105], v[104:105], v[160:161] op_sel_hi:[1,0] neg_lo:[0,1] neg_hi:[0,1]
v_pk_add_f32 v[106:107], v[106:107], v[160:161] op_sel_hi:[1,0] neg_lo:[0,1] neg_hi:[0,1]
v_exp_f32 v96, v96
v_exp_f32 v97, v97
v_exp_f32 v98, v98
v_exp_f32 v99, v99
v_exp_f32 v100, v100
v_exp_f32 v101, v101
v_exp_f32 v102, v102
v_exp_f32 v103, v103
v_exp_f32 v104, v104
v_exp_f32 v105, v105
v_exp_f32 v106, v106
v_exp_f32 v107, v107
v_cvt_pk_bf16_f32 v132, v96, v97
v_cvt_pk_bf16_f32 v133, v98, v99
v_cvt_pk_bf16_f32 v134, v100, v101
v_cvt_pk_bf16_f32 v135, v102, v103
v_cvt_pk_bf16_f32 v136, v104, v105
v_cvt_pk_bf16_f32 v137, v106, v107
v_mfma_f32_16x16x32_bf16 v[156:159], v[92:95], v[132:135], 0
v_mfma_f32_16x16x32_bf16 v[140:143], v[64:67], v[132:135], 0
v_mfma_f32_16x16x32_bf16 v[144:147], v[68:71], v[132:135], 0
v_mfma_f32_16x16x32_bf16 v[148:151], v[72:75], v[132:135], 0
v_mfma_f32_16x16x32_bf16 v[152:155], v[76:79], v[132:135], 0
s_waitcnt lgkmcnt(0)
v_mfma_f32_16x16x16_bf16 v[156:159], v[92:93], v[136:137], v[156:159]
v_mfma_f32_16x16x16_bf16 v[140:143], v[124:125], v[136:137], v[140:143]
v_mfma_f32_16x16x16_bf16 v[144:147], v[126:127], v[136:137], v[144:147]
v_mfma_f32_16x16x16_bf16 v[148:151], v[128:129], v[136:137], v[148:151]
v_mfma_f32_16x16x16_bf16 v[152:155], v[130:131], v[136:137], v[152:155]
v_rcp_f32 v156, v156
s_nop 0
v_mul_f32 v140, v140, v156
v_mul_f32 v141, v141, v156
v_mul_f32 v142, v142, v156
v_mul_f32 v143, v143, v156
v_mul_f32 v144, v144, v156
v_mul_f32 v145, v145, v156
v_mul_f32 v146, v146, v156
v_mul_f32 v147, v147, v156
v_cvt_pk_bf16_f32 v140, v140, v141
v_cvt_pk_bf16_f32 v141, v142, v143
v_cvt_pk_bf16_f32 v142, v144, v145
v_cvt_pk_bf16_f32 v143, v146, v147
buffer_store_dwordx4 v[140:143], v1, s[4:7], s56 offen offset:0 sc0 sc1
v_mul_f32 v148, v148, v156
v_mul_f32 v149, v149, v156
v_mul_f32 v150, v150, v156
v_mul_f32 v151, v151, v156
v_mul_f32 v152, v152, v156
v_mul_f32 v153, v153, v156
v_mul_f32 v154, v154, v156
v_mul_f32 v155, v155, v156
v_cvt_pk_bf16_f32 v148, v148, v149
v_cvt_pk_bf16_f32 v149, v150, v151
v_cvt_pk_bf16_f32 v150, v152, v153
v_cvt_pk_bf16_f32 v151, v154, v155
buffer_store_dwordx4 v[148:151], v1, s[4:7], s56 offen offset:1024 sc0 sc1
s_add_u32 s35, s35, 1
v_mov_b32 v13, s35
s_add_u32 s50, s50, 1048576
s_add_u32 s52, s52, 2097152
s_add_u32 s53, s53, 2097152
s_add_u32 s55, s55, 40960
s_add_u32 s56, s56, 1048576
s_waitcnt vmcnt(0)
s_mov_b64 exec, 1
buffer_store_dword v13, v8, s[4:7], s58 offen sc0 sc1
s_mov_b64 exec, -1
s_cmp_lt_u32 s35, 16
s_cbranch_scc1 L_at_loop
s_waitcnt vmcnt(0)
s_endpgm
L_role_aw:
s_load_dwordx2 s[4:5], s[0:1], 104
s_mov_b32 s6, 268435456
s_mov_b32 s7, 0x20000
s_load_dwordx2 s[8:9], s[0:1], 0
s_mov_b32 s10, 2359296
s_mov_b32 s11, 0x20000
s_load_dwordx2 s[12:13], s[0:1], 8
s_mov_b32 s14, 1990656
s_mov_b32 s15, 0x20000
s_load_dwordx2 s[16:17], s[0:1], 16
s_mov_b32 s18, 663552
s_mov_b32 s19, 0x20000
s_load_dwordx2 s[20:21], s[0:1], 64
s_mov_b32 s22, 4718592
s_mov_b32 s23, 0x20000
s_load_dwordx2 s[24:25], s[0:1], 96
s_mov_b32 s26, 256
s_mov_b32 s27, 0x20000
s_load_dwordx2 s[28:29], s[0:1], 88
s_mov_b32 s30, 2359296
s_mov_b32 s31, 0x20000
s_load_dwordx2 s[64:65], s[0:1], 80
s_mov_b32 s66, 1152
s_mov_b32 s67, 0x20000
v_and_b32 v9, 63, v0
v_and_b32 v10, 15, v0
v_bfe_u32 v11, v0, 4, 2
v_lshrrev_b32 v1, 6, v0
s_nop 0
v_readfirstlane_b32 s34, v1
v_lshrrev_b32 v12, 2, v9
v_mul_u32_u24 v2, 1152, v12
v_lshrrev_b32 v12, 5, v9
v_lshlrev_b32 v12, 1, v12
v_and_b32 v13, 3, v9
v_xor_b32 v12, v12, v13
v_lshl_add_u32 v2, v12, 4, v2
v_lshrrev_b32 v12, 3, v10
v_lshlrev_b32 v12, 1, v12
v_xor_b32 v12, v12, v11
v_lshlrev_b32 v12, 4, v12
v_lshl_add_u32 v3, v10, 6, v12
v_lshrrev_b32 v12, 2, v10
v_lshl_add_u32 v12, v11, 3, v12
v_mul_u32_u24 v7, 64, v12
v_and_b32 v12, 3, v10
v_lshl_add_u32 v7, v12, 3, v7
v_lshlrev_b32 v1, 4, v9
s_mul_i32 s38, s34, 20480
s_add_u32 s38, s38, 73728
v_add_u32 v7, s38, v7
v_mov_b32 v8, 0
s_lshl_b32 s37, s34, 3
s_add_u32 s37, s37, 0
v_and_b32 v12, 3, v9
v_add_u32 v12, s37, v12
v_min_u32 v12, 26, v12
v_mul_u32_u24 v13, 57, v12
v_lshrrev_b32 v13, 9, v13
v_mul_u32_u24 v13, 1008, v13
v_lshl_add_u32 v13, v12, 4, v13
v_lshrrev_b32 v12, 2, v9
v_mul_u32_u24 v12, 3456, v12
v_add_u32 v5, v12, v13
s_lshl_b32 s37, s34, 3
s_add_u32 s37, s37, 4
v_and_b32 v12, 3, v9
v_add_u32 v12, s37, v12
v_min_u32 v12, 26, v12
v_mul_u32_u24 v13, 57, v12
v_lshrrev_b32 v13, 9, v13
v_mul_u32_u24 v13, 1008, v13
v_lshl_add_u32 v13, v12, 4, v13
v_lshrrev_b32 v12, 2, v9
v_mul_u32_u24 v12, 3456, v12
v_add_u32 v6, v12, v13
s_mul_i32 s39, s32, 144
s_mul_i32 s40, s33, 11
s_and_b32 s41, s34, 1
s_add_u32 s40, s40, s41
s_sub_u32 s40, s40, 1
s_max_i32 s41, s40, 0
s_lshr_b32 s42, s34, 1
s_lshl_b32 s42, s42, 6
s_mul_i32 s43, s41, 18432
s_add_u32 s43, s43, s42
s_mul_i32 s40, s40, 18432
s_add_u32 s40, s40, s42
s_lshl_b32 s44, s34, 10
s_mov_b32 s36, 400000
v_mul_u32_u24 v4, 456, v10
v_lshl_add_u32 v4, v11, 3, v4
s_lshl_b32 s37, s34, 7
s_add_u32 s37, s37, 73728
v_add_u32 v4, s37, v4
v_lshlrev_b32 v14, 2, v10
v_add_u32 v14, 161280, v14
s_waitcnt lgkmcnt(0)
s_add_u32 s37, s39, 0
s_add_u32 m0, s38, 0
s_nop 0
buffer_load_dwordx4 v5, s[12:15], s37 offen lds
s_add_u32 s37, s39, 55296
s_add_u32 m0, s38, 1024
s_nop 0
buffer_load_dwordx4 v5, s[12:15], s37 offen lds
s_add_u32 s37, s39, 110592
s_add_u32 m0, s38, 2048
s_nop 0
buffer_load_dwordx4 v5, s[12:15], s37 offen lds
s_add_u32 s37, s39, 165888
s_add_u32 m0, s38, 3072
s_nop 0
buffer_load_dwordx4 v5, s[12:15], s37 offen lds
s_add_u32 s37, s39, 221184
s_add_u32 m0, s38, 4096
s_nop 0
buffer_load_dwordx4 v5, s[12:15], s37 offen lds
s_add_u32 s37, s39, 276480
s_add_u32 m0, s38, 5120
s_nop 0
buffer_load_dwordx4 v5, s[12:15], s37 offen lds
s_add_u32 s37, s39, 331776
s_add_u32 m0, s38, 6144
s_nop 0
buffer_load_dwordx4 v5, s[12:15], s37 offen lds
s_add_u32 s37, s39, 387072
s_add_u32 m0, s38, 7168
s_nop 0
buffer_load_dwordx4 v5, s[12:15], s37 offen lds
s_add_u32 s37, s39, 442368
s_add_u32 m0, s38, 8192
s_nop 0
buffer_load_dwordx4 v5, s[12:15], s37 offen lds
s_add_u32 s37, s39, 497664
s_add_u32 m0, s38, 9216
s_nop 0
buffer_load_dwordx4 v5, s[12:15], s37 offen lds
s_add_u32 s37, s39, 552960
s_add_u32 m0, s38, 10240
s_nop 0
buffer_load_dwordx4 v5, s[12:15], s37 offen lds
s_add_u32 s37, s39, 608256
s_add_u32 m0, s38, 11264
s_nop 0
buffer_load_dwordx4 v5, s[12:15], s37 offen lds
s_add_u32 s37, s39, 663552
s_add_u32 m0, s38, 12288
s_nop 0
buffer_load_dwordx4 v5, s[12:15], s37 offen lds
s_add_u32 s37, s39, 718848
s_add_u32 m0, s38, 13312
s_nop 0
buffer_load_dwordx4 v5, s[12:15], s37 offen lds
s_add_u32 s37, s39, 774144
s_add_u32 m0, s38, 14336
s_nop 0
buffer_load_dwordx4 v5, s[12:15], s37 offen lds
s_add_u32 s37, s39, 829440
s_add_u32 m0, s38, 15360
s_nop 0
buffer_load_dwordx4 v5, s[12:15], s37 offen lds
s_add_u32 s37, s43, 0
s_add_u32 m0, s44, 0
s_nop 0
buffer_load_dwordx4 v2, s[8:11], s37 offen lds
s_add_u32 s37, s43, 128
s_add_u32 m0, s44, 4096
s_nop 0
buffer_load_dwordx4 v2, s[8:11], s37 offen lds
s_add_u32 s37, s43, 256
s_add_u32 m0, s44, 8192
s_nop 0
buffer_load_dwordx4 v2, s[8:11], s37 offen lds
s_add_u32 s37, s43, 384
s_add_u32 m0, s44, 12288
s_nop 0
buffer_load_dwordx4 v2, s[8:11], s37 offen lds
s_add_u32 s37, s43, 512
s_add_u32 m0, s44, 16384
s_nop 0
buffer_load_dwordx4 v2, s[8:11], s37 offen lds
s_add_u32 s37, s43, 640
s_add_u32 m0, s44, 20480
s_nop 0
buffer_load_dwordx4 v2, s[8:11], s37 offen lds
s_add_u32 s37, s43, 768
s_add_u32 m0, s44, 24576
s_nop 0
buffer_load_dwordx4 v2, s[8:11], s37 offen lds
s_add_u32 s37, s43, 896
s_add_u32 m0, s44, 28672
s_nop 0
buffer_load_dwordx4 v2, s[8:11], s37 offen lds
s_add_u32 s37, s43, 1024
s_add_u32 m0, s44, 32768
s_nop 0
buffer_load_dwordx4 v2, s[8:11], s37 offen lds
s_waitcnt vmcnt(21)
ds_read_b64_tr_b16 v[80:81], v7 offset:0
ds_read_b64_tr_b16 v[82:83], v7 offset:256
ds_read_b64_tr_b16 v[84:85], v7 offset:2048
ds_read_b64_tr_b16 v[86:87], v7 offset:2304
ds_read_b64_tr_b16 v[152:153], v7 offset:32
ds_read_b64_tr_b16 v[154:155], v7 offset:288
ds_read_b64_tr_b16 v[156:157], v7 offset:2080
ds_read_b64_tr_b16 v[158:159], v7 offset:2336
s_waitcnt lgkmcnt(0)
s_add_u32 s37, s39, 884736
s_add_u32 m0, s38, 16384
s_nop 0
buffer_load_dwordx4 v5, s[12:15], s37 offen lds
s_add_u32 s37, s39, 940032
s_add_u32 m0, s38, 17408
s_nop 0
buffer_load_dwordx4 v5, s[12:15], s37 offen lds
s_add_u32 s37, s39, 995328
s_add_u32 m0, s38, 18432
s_nop 0
buffer_load_dwordx4 v5, s[12:15], s37 offen lds
s_add_u32 s37, s39, 1050624
s_add_u32 m0, s38, 19456
s_nop 0
buffer_load_dwordx4 v5, s[12:15], s37 offen lds
s_waitcnt vmcnt(21)
ds_read_b64_tr_b16 v[88:89], v7 offset:4096
ds_read_b64_tr_b16 v[90:91], v7 offset:4352
ds_read_b64_tr_b16 v[92:93], v7 offset:6144
ds_read_b64_tr_b16 v[94:95], v7 offset:6400
ds_read_b64_tr_b16 v[160:161], v7 offset:4128
ds_read_b64_tr_b16 v[162:163], v7 offset:4384
ds_read_b64_tr_b16 v[164:165], v7 offset:6176
ds_read_b64_tr_b16 v[166:167], v7 offset:6432
s_waitcnt lgkmcnt(0)
s_add_u32 s37, s39, 1105920
s_add_u32 m0, s38, 0
s_nop 0
buffer_load_dwordx4 v5, s[12:15], s37 offen lds
s_add_u32 s37, s39, 1161216
s_add_u32 m0, s38, 1024
s_nop 0
buffer_load_dwordx4 v5, s[12:15], s37 offen lds
s_add_u32 s37, s39, 1216512
s_add_u32 m0, s38, 2048
s_nop 0
buffer_load_dwordx4 v5, s[12:15], s37 offen lds
s_add_u32 s37, s39, 1271808
s_add_u32 m0, s38, 3072
s_nop 0
buffer_load_dwordx4 v5, s[12:15], s37 offen lds
s_waitcnt vmcnt(21)
ds_read_b64_tr_b16 v[96:97], v7 offset:8192
ds_read_b64_tr_b16 v[98:99], v7 offset:8448
ds_read_b64_tr_b16 v[100:101], v7 offset:10240
ds_read_b64_tr_b16 v[102:103], v7 offset:10496
ds_read_b64_tr_b16 v[168:169], v7 offset:8224
ds_read_b64_tr_b16 v[170:171], v7 offset:8480
ds_read_b64_tr_b16 v[172:173], v7 offset:10272
ds_read_b64_tr_b16 v[174:175], v7 offset:10528
s_waitcnt lgkmcnt(0)
s_add_u32 s37, s39, 1327104
s_add_u32 m0, s38, 4096
s_nop 0
buffer_load_dwordx4 v5, s[12:15], s37 offen lds
s_add_u32 s37, s39, 1382400
s_add_u32 m0, s38, 5120
s_nop 0
buffer_load_dwordx4 v5, s[12:15], s37 offen lds
s_add_u32 s37, s39, 1437696
s_add_u32 m0, s38, 6144
s_nop 0
buffer_load_dwordx4 v5, s[12:15], s37 offen lds
s_add_u32 s37, s39, 1492992
s_add_u32 m0, s38, 7168
s_nop 0
buffer_load_dwordx4 v5, s[12:15], s37 offen lds
s_waitcnt vmcnt(21)
ds_read_b64_tr_b16 v[104:105], v7 offset:12288
ds_read_b64_tr_b16 v[106:107], v7 offset:12544
ds_read_b64_tr_b16 v[108:109], v7 offset:14336
ds_read_b64_tr_b16 v[110:111], v7 offset:14592
ds_read_b64_tr_b16 v[176:177], v7 offset:12320
ds_read_b64_tr_b16 v[178:179], v7 offset:12576
ds_read_b64_tr_b16 v[180:181], v7 offset:14368
ds_read_b64_tr_b16 v[182:183], v7 offset:14624
s_waitcnt lgkmcnt(0)
s_add_u32 s37, s39, 1548288
s_add_u32 m0, s38, 8192
s_nop 0
buffer_load_dwordx4 v5, s[12:15], s37 offen lds
s_add_u32 s37, s39, 1603584
s_add_u32 m0, s38, 9216
s_nop 0
buffer_load_dwordx4 v5, s[12:15], s37 offen lds
s_add_u32 s37, s39, 1658880
s_add_u32 m0, s38, 10240
s_nop 0
buffer_load_dwordx4 v5, s[12:15], s37 offen lds
s_add_u32 s37, s39, 1714176
s_add_u32 m0, s38, 11264
s_nop 0
buffer_load_dwordx4 v5, s[12:15], s37 offen lds
s_waitcnt vmcnt(12)
ds_read_b64_tr_b16 v[112:113], v7 offset:16384
ds_read_b64_tr_b16 v[114:115], v7 offset:16640
ds_read_b64_tr_b16 v[116:117], v7 offset:18432
ds_read_b64_tr_b16 v[118:119], v7 offset:18688
ds_read_b64_tr_b16 v[184:185], v7 offset:16416
ds_read_b64_tr_b16 v[186:187], v7 offset:16672
ds_read_b64_tr_b16 v[188:189], v7 offset:18464
ds_read_b64_tr_b16 v[190:191], v7 offset:18720
s_waitcnt lgkmcnt(0)
s_add_u32 s37, s39, 1769472
s_add_u32 m0, s38, 12288
s_nop 0
buffer_load_dwordx4 v5, s[12:15], s37 offen lds
s_add_u32 s37, s39, 1824768
s_add_u32 m0, s38, 13312
s_nop 0
buffer_load_dwordx4 v5, s[12:15], s37 offen lds
s_add_u32 s37, s39, 1880064
s_add_u32 m0, s38, 14336
s_nop 0
buffer_load_dwordx4 v5, s[12:15], s37 offen lds
s_add_u32 s37, s39, 1935360
s_add_u32 m0, s38, 15360
s_nop 0
buffer_load_dwordx4 v5, s[12:15], s37 offen lds
s_waitcnt vmcnt(12)
ds_read_b64_tr_b16 v[120:121], v7 offset:0
ds_read_b64_tr_b16 v[122:123], v7 offset:256
ds_read_b64_tr_b16 v[124:125], v7 offset:2048
ds_read_b64_tr_b16 v[126:127], v7 offset:2304
ds_read_b64_tr_b16 v[192:193], v7 offset:32
ds_read_b64_tr_b16 v[194:195], v7 offset:288
ds_read_b64_tr_b16 v[196:197], v7 offset:2080
ds_read_b64_tr_b16 v[198:199], v7 offset:2336
s_waitcnt lgkmcnt(0)
s_add_u32 s37, s39, 0
s_add_u32 m0, s38, 16384
s_nop 0
buffer_load_dwordx4 v6, s[12:15], s37 offen lds
s_add_u32 s37, s39, 55296
s_add_u32 m0, s38, 17408
s_nop 0
buffer_load_dwordx4 v6, s[12:15], s37 offen lds
s_add_u32 s37, s39, 110592
s_add_u32 m0, s38, 18432
s_nop 0
buffer_load_dwordx4 v6, s[12:15], s37 offen lds
s_add_u32 s37, s39, 165888
s_add_u32 m0, s38, 19456
s_nop 0
buffer_load_dwordx4 v6, s[12:15], s37 offen lds
s_waitcnt vmcnt(12)
ds_read_b64_tr_b16 v[128:129], v7 offset:4096
ds_read_b64_tr_b16 v[130:131], v7 offset:4352
ds_read_b64_tr_b16 v[132:133], v7 offset:6144
ds_read_b64_tr_b16 v[134:135], v7 offset:6400
ds_read_b64_tr_b16 v[200:201], v7 offset:4128
ds_read_b64_tr_b16 v[202:203], v7 offset:4384
ds_read_b64_tr_b16 v[204:205], v7 offset:6176
ds_read_b64_tr_b16 v[206:207], v7 offset:6432
s_waitcnt lgkmcnt(0)
s_add_u32 s37, s39, 221184
s_add_u32 m0, s38, 0
s_nop 0
buffer_load_dwordx4 v6, s[12:15], s37 offen lds
s_add_u32 s37, s39, 276480
s_add_u32 m0, s38, 1024
s_nop 0
buffer_load_dwordx4 v6, s[12:15], s37 offen lds
s_add_u32 s37, s39, 331776
s_add_u32 m0, s38, 2048
s_nop 0
buffer_load_dwordx4 v6, s[12:15], s37 offen lds
s_add_u32 s37, s39, 387072
s_add_u32 m0, s38, 3072
s_nop 0
buffer_load_dwordx4 v6, s[12:15], s37 offen lds
s_waitcnt vmcnt(12)
ds_read_b64_tr_b16 v[136:137], v7 offset:8192
ds_read_b64_tr_b16 v[138:139], v7 offset:8448
ds_read_b64_tr_b16 v[140:141], v7 offset:10240
ds_read_b64_tr_b16 v[142:143], v7 offset:10496
ds_read_b64_tr_b16 v[208:209], v7 offset:8224
ds_read_b64_tr_b16 v[210:211], v7 offset:8480
ds_read_b64_tr_b16 v[212:213], v7 offset:10272
ds_read_b64_tr_b16 v[214:215], v7 offset:10528
s_waitcnt lgkmcnt(0)
s_add_u32 s37, s39, 442368
s_add_u32 m0, s38, 4096
s_nop 0
buffer_load_dwordx4 v6, s[12:15], s37 offen lds
s_add_u32 s37, s39, 497664
s_add_u32 m0, s38, 5120
s_nop 0
buffer_load_dwordx4 v6, s[12:15], s37 offen lds
s_add_u32 s37, s39, 552960
s_add_u32 m0, s38, 6144
s_nop 0
buffer_load_dwordx4 v6, s[12:15], s37 offen lds
s_add_u32 s37, s39, 608256
s_add_u32 m0, s38, 7168
s_nop 0
buffer_load_dwordx4 v6, s[12:15], s37 offen lds
s_waitcnt vmcnt(12)
ds_read_b64_tr_b16 v[144:145], v7 offset:12288
ds_read_b64_tr_b16 v[146:147], v7 offset:12544
ds_read_b64_tr_b16 v[148:149], v7 offset:14336
ds_read_b64_tr_b16 v[150:151], v7 offset:14592
ds_read_b64_tr_b16 v[216:217], v7 offset:12320
ds_read_b64_tr_b16 v[218:219], v7 offset:12576
ds_read_b64_tr_b16 v[220:221], v7 offset:14368
ds_read_b64_tr_b16 v[222:223], v7 offset:14624
s_waitcnt lgkmcnt(0)
s_add_u32 s37, s39, 663552
s_add_u32 m0, s38, 8192
s_nop 0
buffer_load_dwordx4 v6, s[12:15], s37 offen lds
s_add_u32 s37, s39, 718848
s_add_u32 m0, s38, 9216
s_nop 0
buffer_load_dwordx4 v6, s[12:15], s37 offen lds
s_add_u32 s37, s39, 774144
s_add_u32 m0, s38, 10240
s_nop 0
buffer_load_dwordx4 v6, s[12:15], s37 offen lds
s_add_u32 s37, s39, 829440
s_add_u32 m0, s38, 11264
s_nop 0
buffer_load_dwordx4 v6, s[12:15], s37 offen lds
s_waitcnt vmcnt(12)
ds_read_b64_tr_b16 v[224:225], v7 offset:16384
ds_read_b64_tr_b16 v[226:227], v7 offset:16640
ds_read_b64_tr_b16 v[228:229], v7 offset:18432
ds_read_b64_tr_b16 v[230:231], v7 offset:18688
ds_read_b64_tr_b16 a[40:41], v7 offset:16416
ds_read_b64_tr_b16 a[42:43], v7 offset:16672
ds_read_b64_tr_b16 a[44:45], v7 offset:18464
ds_read_b64_tr_b16 a[46:47], v7 offset:18720
s_waitcnt lgkmcnt(0)
s_add_u32 s37, s39, 884736
s_add_u32 m0, s38, 12288
s_nop 0
buffer_load_dwordx4 v6, s[12:15], s37 offen lds
s_add_u32 s37, s39, 940032
s_add_u32 m0, s38, 13312
s_nop 0
buffer_load_dwordx4 v6, s[12:15], s37 offen lds
s_add_u32 s37, s39, 995328
s_add_u32 m0, s38, 14336
s_nop 0
buffer_load_dwordx4 v6, s[12:15], s37 offen lds
s_add_u32 s37, s39, 1050624
s_add_u32 m0, s38, 15360
s_nop 0
buffer_load_dwordx4 v6, s[12:15], s37 offen lds
s_waitcnt vmcnt(12)
ds_read_b64_tr_b16 v[232:233], v7 offset:0
ds_read_b64_tr_b16 v[234:235], v7 offset:256
ds_read_b64_tr_b16 v[236:237], v7 offset:2048
ds_read_b64_tr_b16 v[238:239], v7 offset:2304
ds_read_b64_tr_b16 a[48:49], v7 offset:32
ds_read_b64_tr_b16 a[50:51], v7 offset:288
ds_read_b64_tr_b16 a[52:53], v7 offset:2080
ds_read_b64_tr_b16 a[54:55], v7 offset:2336
s_waitcnt lgkmcnt(0)
s_add_u32 s37, s39, 1105920
s_add_u32 m0, s38, 16384
s_nop 0
buffer_load_dwordx4 v6, s[12:15], s37 offen lds
s_add_u32 s37, s39, 1161216
s_add_u32 m0, s38, 17408
s_nop 0
buffer_load_dwordx4 v6, s[12:15], s37 offen lds
s_add_u32 s37, s39, 1216512
s_add_u32 m0, s38, 18432
s_nop 0
buffer_load_dwordx4 v6, s[12:15], s37 offen lds
s_add_u32 s37, s39, 1271808
s_add_u32 m0, s38, 19456
s_nop 0
buffer_load_dwordx4 v6, s[12:15], s37 offen lds
s_waitcnt vmcnt(12)
ds_read_b64_tr_b16 v[240:241], v7 offset:4096
ds_read_b64_tr_b16 v[242:243], v7 offset:4352
ds_read_b64_tr_b16 v[244:245], v7 offset:6144
ds_read_b64_tr_b16 v[246:247], v7 offset:6400
ds_read_b64_tr_b16 a[56:57], v7 offset:4128
ds_read_b64_tr_b16 a[58:59], v7 offset:4384
ds_read_b64_tr_b16 a[60:61], v7 offset:6176
ds_read_b64_tr_b16 a[62:63], v7 offset:6432
s_waitcnt lgkmcnt(0)
s_add_u32 s37, s39, 1327104
s_add_u32 m0, s38, 0
s_nop 0
buffer_load_dwordx4 v6, s[12:15], s37 offen lds
s_add_u32 s37, s39, 1382400
s_add_u32 m0, s38, 1024
s_nop 0
buffer_load_dwordx4 v6, s[12:15], s37 offen lds
s_add_u32 s37, s39, 1437696
s_add_u32 m0, s38, 2048
s_nop 0
buffer_load_dwordx4 v6, s[12:15], s37 offen lds
s_add_u32 s37, s39, 1492992
s_add_u32 m0, s38, 3072
s_nop 0
buffer_load_dwordx4 v6, s[12:15], s37 offen lds
s_waitcnt vmcnt(12)
ds_read_b64_tr_b16 v[248:249], v7 offset:8192
ds_read_b64_tr_b16 v[250:251], v7 offset:8448
ds_read_b64_tr_b16 v[252:253], v7 offset:10240
ds_read_b64_tr_b16 v[254:255], v7 offset:10496
ds_read_b64_tr_b16 a[64:65], v7 offset:8224
ds_read_b64_tr_b16 a[66:67], v7 offset:8480
ds_read_b64_tr_b16 a[68:69], v7 offset:10272
ds_read_b64_tr_b16 a[70:71], v7 offset:10528
s_waitcnt lgkmcnt(0)
s_add_u32 s37, s39, 1548288
s_add_u32 m0, s38, 4096
s_nop 0
buffer_load_dwordx4 v6, s[12:15], s37 offen lds
s_add_u32 s37, s39, 1603584
s_add_u32 m0, s38, 5120
s_nop 0
buffer_load_dwordx4 v6, s[12:15], s37 offen lds
s_add_u32 s37, s39, 1658880
s_add_u32 m0, s38, 6144
s_nop 0
buffer_load_dwordx4 v6, s[12:15], s37 offen lds
s_add_u32 s37, s39, 1714176
s_add_u32 m0, s38, 7168
s_nop 0
buffer_load_dwordx4 v6, s[12:15], s37 offen lds
s_waitcnt vmcnt(12)
ds_read_b64_tr_b16 a[0:1], v7 offset:12288
ds_read_b64_tr_b16 a[2:3], v7 offset:12544
ds_read_b64_tr_b16 a[4:5], v7 offset:14336
ds_read_b64_tr_b16 a[6:7], v7 offset:14592
ds_read_b64_tr_b16 a[72:73], v7 offset:12320
ds_read_b64_tr_b16 a[74:75], v7 offset:12576
ds_read_b64_tr_b16 a[76:77], v7 offset:14368
ds_read_b64_tr_b16 a[78:79], v7 offset:14624
s_waitcnt lgkmcnt(0)
s_add_u32 s37, s39, 1769472
s_add_u32 m0, s38, 8192
s_nop 0
buffer_load_dwordx4 v6, s[12:15], s37 offen lds
s_add_u32 s37, s39, 1824768
s_add_u32 m0, s38, 9216
s_nop 0
buffer_load_dwordx4 v6, s[12:15], s37 offen lds
s_add_u32 s37, s39, 1880064
s_add_u32 m0, s38, 10240
s_nop 0
buffer_load_dwordx4 v6, s[12:15], s37 offen lds
s_add_u32 s37, s39, 1935360
s_add_u32 m0, s38, 11264
s_nop 0
buffer_load_dwordx4 v6, s[12:15], s37 offen lds
s_waitcnt vmcnt(12)
ds_read_b64_tr_b16 a[8:9], v7 offset:16384
ds_read_b64_tr_b16 a[10:11], v7 offset:16640
ds_read_b64_tr_b16 a[12:13], v7 offset:18432
ds_read_b64_tr_b16 a[14:15], v7 offset:18688
ds_read_b64_tr_b16 a[80:81], v7 offset:16416
ds_read_b64_tr_b16 a[82:83], v7 offset:16672
ds_read_b64_tr_b16 a[84:85], v7 offset:18464
ds_read_b64_tr_b16 a[86:87], v7 offset:18720
s_waitcnt lgkmcnt(0)
s_waitcnt vmcnt(8)
ds_read_b64_tr_b16 a[16:17], v7 offset:0
ds_read_b64_tr_b16 a[18:19], v7 offset:256
ds_read_b64_tr_b16 a[20:21], v7 offset:2048
ds_read_b64_tr_b16 a[22:23], v7 offset:2304
ds_read_b64_tr_b16 a[88:89], v7 offset:32
ds_read_b64_tr_b16 a[90:91], v7 offset:288
ds_read_b64_tr_b16 a[92:93], v7 offset:2080
ds_read_b64_tr_b16 a[94:95], v7 offset:2336
s_waitcnt lgkmcnt(0)
s_waitcnt vmcnt(4)
ds_read_b64_tr_b16 a[24:25], v7 offset:4096
ds_read_b64_tr_b16 a[26:27], v7 offset:4352
ds_read_b64_tr_b16 a[28:29], v7 offset:6144
ds_read_b64_tr_b16 a[30:31], v7 offset:6400
ds_read_b64_tr_b16 a[96:97], v7 offset:4128
ds_read_b64_tr_b16 a[98:99], v7 offset:4384
ds_read_b64_tr_b16 a[100:101], v7 offset:6176
ds_read_b64_tr_b16 a[102:103], v7 offset:6432
s_waitcnt lgkmcnt(0)
s_waitcnt vmcnt(0)
ds_read_b64_tr_b16 a[32:33], v7 offset:8192
ds_read_b64_tr_b16 a[34:35], v7 offset:8448
ds_read_b64_tr_b16 a[36:37], v7 offset:10240
ds_read_b64_tr_b16 a[38:39], v7 offset:10496
ds_read_b64_tr_b16 a[104:105], v7 offset:8224
ds_read_b64_tr_b16 a[106:107], v7 offset:8480
ds_read_b64_tr_b16 a[108:109], v7 offset:10272
ds_read_b64_tr_b16 a[110:111], v7 offset:10528
s_waitcnt lgkmcnt(0)
s_cmp_lg_u32 s34, 3
s_cbranch_scc1 L_a_nogate
v_lshlrev_b32 v12, 4, v11
buffer_load_dwordx4 v[224:227], v12, s[64:67], 0 offen offset:0
buffer_load_dwordx4 v[228:231], v12, s[64:67], 0 offen offset:64
buffer_load_dwordx4 v[232:235], v12, s[64:67], 0 offen offset:128
buffer_load_dwordx4 v[236:239], v12, s[64:67], 0 offen offset:192
buffer_load_dwordx4 v[240:243], v12, s[64:67], 0 offen offset:256
buffer_load_dwordx4 v[244:247], v12, s[64:67], 0 offen offset:320
buffer_load_dwordx4 v[248:251], v12, s[64:67], 0 offen offset:384
buffer_load_dwordx4 v[252:255], v12, s[64:67], 0 offen offset:448
buffer_load_dwordx4 a[0:3], v12, s[64:67], 0 offen offset:512
buffer_load_dwordx4 a[4:7], v12, s[64:67], 0 offen offset:576
buffer_load_dwordx4 a[8:11], v12, s[64:67], 0 offen offset:640
buffer_load_dwordx4 a[12:15], v12, s[64:67], 0 offen offset:704
buffer_load_dwordx4 a[16:19], v12, s[64:67], 0 offen offset:768
buffer_load_dwordx4 a[20:23], v12, s[64:67], 0 offen offset:832
buffer_load_dwordx4 a[24:27], v12, s[64:67], 0 offen offset:896
buffer_load_dwordx4 a[28:31], v12, s[64:67], 0 offen offset:960
buffer_load_dwordx4 a[32:35], v12, s[64:67], 0 offen offset:1024
buffer_load_dwordx4 a[36:39], v12, s[64:67], 0 offen offset:1088
L_a_nogate:
s_mov_b32 s43, s40
s_mov_b32 s35, 0
s_mov_b32 s50, 36864
.p2align 6
L_a_loop:
s_waitcnt vmcnt(0)
s_barrier
s_add_u32 s43, s43, 36864
s_add_u32 s44, s44, s50
ds_read_b128 v[64:67], v3 offset:0
ds_read_b128 v[68:71], v3 offset:1024
ds_read_b128 v[72:75], v3 offset:2048
ds_read_b128 v[76:79], v3 offset:3072
s_waitcnt lgkmcnt(2)
v_mfma_f32_16x16x32_bf16 v[16:19], v[80:83], v[64:67], 0
v_mfma_f32_16x16x32_bf16 v[20:23], v[80:83], v[68:71], 0
v_mfma_f32_16x16x32_bf16 v[24:27], v[152:155], v[64:67], 0
v_mfma_f32_16x16x32_bf16 v[28:31], v[152:155], v[68:71], 0
s_add_u32 s37, s43, 0
s_add_u32 m0, s44, 0
s_nop 0
buffer_load_dwordx4 v2, s[8:11], s37 offen lds
v_mfma_f32_16x16x32_bf16 v[32:35], v[224:227], v[64:67], 0
v_mfma_f32_16x16x32_bf16 v[36:39], v[224:227], v[68:71], 0
v_mfma_f32_16x16x32_bf16 v[40:43], a[40:43], v[64:67], 0
v_mfma_f32_16x16x32_bf16 v[44:47], a[40:43], v[68:71], 0
ds_read_b128 v[64:67], v3 offset:4096
ds_read_b128 v[68:71], v3 offset:5120
s_waitcnt lgkmcnt(2)
v_mfma_f32_16x16x32_bf16 v[16:19], v[84:87], v[72:75], v[16:19]
v_mfma_f32_16x16x32_bf16 v[20:23], v[84:87], v[76:79], v[20:23]
v_mfma_f32_16x16x32_bf16 v[24:27], v[156:159], v[72:75], v[24:27]
v_mfma_f32_16x16x32_bf16 v[28:31], v[156:159], v[76:79], v[28:31]
s_add_u32 s37, s43, 128
s_add_u32 m0, s44, 4096
s_nop 0
buffer_load_dwordx4 v2, s[8:11], s37 offen lds
v_mfma_f32_16x16x32_bf16 v[32:35], v[228:231], v[72:75], v[32:35]
v_mfma_f32_16x16x32_bf16 v[36:39], v[228:231], v[76:79], v[36:39]
v_mfma_f32_16x16x32_bf16 v[40:43], a[44:47], v[72:75], v[40:43]
v_mfma_f32_16x16x32_bf16 v[44:47], a[44:47], v[76:79], v[44:47]
ds_read_b128 v[72:75], v3 offset:6144
ds_read_b128 v[76:79], v3 offset:7168
s_waitcnt lgkmcnt(2)
v_mfma_f32_16x16x32_bf16 v[16:19], v[88:91], v[64:67], v[16:19]
v_mfma_f32_16x16x32_bf16 v[20:23], v[88:91], v[68:71], v[20:23]
v_mfma_f32_16x16x32_bf16 v[24:27], v[160:163], v[64:67], v[24:27]
v_mfma_f32_16x16x32_bf16 v[28:31], v[160:163], v[68:71], v[28:31]
s_add_u32 s37, s43, 256
s_add_u32 m0, s44, 8192
s_nop 0
buffer_load_dwordx4 v2, s[8:11], s37 offen lds
v_mfma_f32_16x16x32_bf16 v[32:35], v[232:235], v[64:67], v[32:35]
v_mfma_f32_16x16x32_bf16 v[36:39], v[232:235], v[68:71], v[36:39]
v_mfma_f32_16x16x32_bf16 v[40:43], a[48:51], v[64:67], v[40:43]
v_mfma_f32_16x16x32_bf16 v[44:47], a[48:51], v[68:71], v[44:47]
ds_read_b128 v[64:67], v3 offset:8192
ds_read_b128 v[68:71], v3 offset:9216
s_waitcnt lgkmcnt(2)
v_mfma_f32_16x16x32_bf16 v[16:19], v[92:95], v[72:75], v[16:19]
v_mfma_f32_16x16x32_bf16 v[20:23], v[92:95], v[76:79], v[20:23]
v_mfma_f32_16x16x32_bf16 v[24:27], v[164:167], v[72:75], v[24:27]
v_mfma_f32_16x16x32_bf16 v[28:31], v[164:167], v[76:79], v[28:31]
s_add_u32 s37, s43, 384
s_add_u32 m0, s44, 12288
s_nop 0
buffer_load_dwordx4 v2, s[8:11], s37 offen lds
v_mfma_f32_16x16x32_bf16 v[32:35], v[236:239], v[72:75], v[32:35]
v_mfma_f32_16x16x32_bf16 v[36:39], v[236:239], v[76:79], v[36:39]
v_mfma_f32_16x16x32_bf16 v[40:43], a[52:55], v[72:75], v[40:43]
v_mfma_f32_16x16x32_bf16 v[44:47], a[52:55], v[76:79], v[44:47]
ds_read_b128 v[72:75], v3 offset:10240
ds_read_b128 v[76:79], v3 offset:11264
s_waitcnt lgkmcnt(2)
v_mfma_f32_16x16x32_bf16 v[16:19], v[96:99], v[64:67], v[16:19]
v_mfma_f32_16x16x32_bf16 v[20:23], v[96:99], v[68:71], v[20:23]
v_mfma_f32_16x16x32_bf16 v[24:27], v[168:171], v[64:67], v[24:27]
v_mfma_f32_16x16x32_bf16 v[28:31], v[168:171], v[68:71], v[28:31]
s_add_u32 s37, s43, 512
s_add_u32 m0, s44, 16384
s_nop 0
buffer_load_dwordx4 v2, s[8:11], s37 offen lds
v_mfma_f32_16x16x32_bf16 v[32:35], v[240:243], v[64:67], v[32:35]
v_mfma_f32_16x16x32_bf16 v[36:39], v[240:243], v[68:71], v[36:39]
v_mfma_f32_16x16x32_bf16 v[40:43], a[56:59], v[64:67], v[40:43]
v_mfma_f32_16x16x32_bf16 v[44:47], a[56:59], v[68:71], v[44:47]
ds_read_b128 v[64:67], v3 offset:12288
ds_read_b128 v[68:71], v3 offset:13312
s_waitcnt lgkmcnt(2)
v_mfma_f32_16x16x32_bf16 v[16:19], v[100:103], v[72:75], v[16:19]
v_mfma_f32_16x16x32_bf16 v[20:23], v[100:103], v[76:79], v[20:23]
v_mfma_f32_16x16x32_bf16 v[24:27], v[172:175], v[72:75], v[24:27]
v_mfma_f32_16x16x32_bf16 v[28:31], v[172:175], v[76:79], v[28:31]
s_add_u32 s37, s43, 640
s_add_u32 m0, s44, 20480
s_nop 0
buffer_load_dwordx4 v2, s[8:11], s37 offen lds
v_mfma_f32_16x16x32_bf16 v[32:35], v[244:247], v[72:75], v[32:35]
v_mfma_f32_16x16x32_bf16 v[36:39], v[244:247], v[76:79], v[36:39]
v_mfma_f32_16x16x32_bf16 v[40:43], a[60:63], v[72:75], v[40:43]
v_mfma_f32_16x16x32_bf16 v[44:47], a[60:63], v[76:79], v[44:47]
ds_read_b128 v[72:75], v3 offset:14336
ds_read_b128 v[76:79], v3 offset:15360
s_waitcnt lgkmcnt(2)
v_mfma_f32_16x16x32_bf16 v[16:19], v[104:107], v[64:67], v[16:19]
v_mfma_f32_16x16x32_bf16 v[20:23], v[104:107], v[68:71], v[20:23]
v_mfma_f32_16x16x32_bf16 v[24:27], v[176:179], v[64:67], v[24:27]
v_mfma_f32_16x16x32_bf16 v[28:31], v[176:179], v[68:71], v[28:31]
s_add_u32 s37, s43, 768
s_add_u32 m0, s44, 24576
s_nop 0
buffer_load_dwordx4 v2, s[8:11], s37 offen lds
v_mfma_f32_16x16x32_bf16 v[32:35], v[248:251], v[64:67], v[32:35]
v_mfma_f32_16x16x32_bf16 v[36:39], v[248:251], v[68:71], v[36:39]
v_mfma_f32_16x16x32_bf16 v[40:43], a[64:67], v[64:67], v[40:43]
v_mfma_f32_16x16x32_bf16 v[44:47], a[64:67], v[68:71], v[44:47]
ds_read_b128 v[64:67], v3 offset:16384
ds_read_b128 v[68:71], v3 offset:17408
s_waitcnt lgkmcnt(2)
v_mfma_f32_16x16x32_bf16 v[16:19], v[108:111], v[72:75], v[16:19]
v_mfma_f32_16x16x32_bf16 v[20:23], v[108:111], v[76:79], v[20:23]
v_mfma_f32_16x16x32_bf16 v[24:27], v[180:183], v[72:75], v[24:27]
v_mfma_f32_16x16x32_bf16 v[28:31], v[180:183], v[76:79], v[28:31]
s_add_u32 s37, s43, 896
s_add_u32 m0, s44, 28672
s_nop 0
buffer_load_dwordx4 v2, s[8:11], s37 offen lds
v_mfma_f32_16x16x32_bf16 v[32:35], v[252:255], v[72:75], v[32:35]
v_mfma_f32_16x16x32_bf16 v[36:39], v[252:255], v[76:79], v[36:39]
v_mfma_f32_16x16x32_bf16 v[40:43], a[68:71], v[72:75], v[40:43]
v_mfma_f32_16x16x32_bf16 v[44:47], a[68:71], v[76:79], v[44:47]
ds_read_b128 v[72:75], v3 offset:18432
ds_read_b128 v[76:79], v3 offset:19456
s_waitcnt lgkmcnt(2)
v_mfma_f32_16x16x32_bf16 v[16:19], v[112:115], v[64:67], v[16:19]
v_mfma_f32_16x16x32_bf16 v[20:23], v[112:115], v[68:71], v[20:23]
v_mfma_f32_16x16x32_bf16 v[24:27], v[184:187], v[64:67], v[24:27]
v_mfma_f32_16x16x32_bf16 v[28:31], v[184:187], v[68:71], v[28:31]
s_add_u32 s37, s43, 1024
s_add_u32 m0, s44, 32768
s_nop 0
buffer_load_dwordx4 v2, s[8:11], s37 offen lds
v_mfma_f32_16x16x32_bf16 v[32:35], a[0:3], v[64:67], v[32:35]
v_mfma_f32_16x16x32_bf16 v[36:39], a[0:3], v[68:71], v[36:39]
v_mfma_f32_16x16x32_bf16 v[40:43], a[72:75], v[64:67], v[40:43]
v_mfma_f32_16x16x32_bf16 v[44:47], a[72:75], v[68:71], v[44:47]
ds_read_b128 v[64:67], v3 offset:20480
ds_read_b128 v[68:71], v3 offset:21504
s_waitcnt lgkmcnt(2)
v_mfma_f32_16x16x32_bf16 v[16:19], v[116:119], v[72:75], v[16:19]
v_mfma_f32_16x16x32_bf16 v[20:23], v[116:119], v[76:79], v[20:23]
v_mfma_f32_16x16x32_bf16 v[24:27], v[188:191], v[72:75], v[24:27]
v_mfma_f32_16x16x32_bf16 v[28:31], v[188:191], v[76:79], v[28:31]
v_mfma_f32_16x16x32_bf16 v[32:35], a[4:7], v[72:75], v[32:35]
v_mfma_f32_16x16x32_bf16 v[36:39], a[4:7], v[76:79], v[36:39]
v_mfma_f32_16x16x32_bf16 v[40:43], a[76:79], v[72:75], v[40:43]
v_mfma_f32_16x16x32_bf16 v[44:47], a[76:79], v[76:79], v[44:47]
ds_read_b128 v[72:75], v3 offset:22528
ds_read_b128 v[76:79], v3 offset:23552
s_waitcnt lgkmcnt(2)
v_mfma_f32_16x16x32_bf16 v[16:19], v[120:123], v[64:67], v[16:19]
v_mfma_f32_16x16x32_bf16 v[20:23], v[120:123], v[68:71], v[20:23]
v_mfma_f32_16x16x32_bf16 v[24:27], v[192:195], v[64:67], v[24:27]
v_mfma_f32_16x16x32_bf16 v[28:31], v[192:195], v[68:71], v[28:31]
v_mfma_f32_16x16x32_bf16 v[32:35], a[8:11], v[64:67], v[32:35]
v_mfma_f32_16x16x32_bf16 v[36:39], a[8:11], v[68:71], v[36:39]
v_mfma_f32_16x16x32_bf16 v[40:43], a[80:83], v[64:67], v[40:43]
v_mfma_f32_16x16x32_bf16 v[44:47], a[80:83], v[68:71], v[44:47]
ds_read_b128 v[64:67], v3 offset:24576
ds_read_b128 v[68:71], v3 offset:25600
s_waitcnt lgkmcnt(2)
v_mfma_f32_16x16x32_bf16 v[16:19], v[124:127], v[72:75], v[16:19]
v_mfma_f32_16x16x32_bf16 v[20:23], v[124:127], v[76:79], v[20:23]
v_mfma_f32_16x16x32_bf16 v[24:27], v[196:199], v[72:75], v[24:27]
v_mfma_f32_16x16x32_bf16 v[28:31], v[196:199], v[76:79], v[28:31]
v_mfma_f32_16x16x32_bf16 v[32:35], a[12:15], v[72:75], v[32:35]
v_mfma_f32_16x16x32_bf16 v[36:39], a[12:15], v[76:79], v[36:39]
v_mfma_f32_16x16x32_bf16 v[40:43], a[84:87], v[72:75], v[40:43]
v_mfma_f32_16x16x32_bf16 v[44:47], a[84:87], v[76:79], v[44:47]
ds_read_b128 v[72:75], v3 offset:26624
ds_read_b128 v[76:79], v3 offset:27648
s_waitcnt lgkmcnt(2)
v_mfma_f32_16x16x32_bf16 v[16:19], v[128:131], v[64:67], v[16:19]
v_mfma_f32_16x16x32_bf16 v[20:23], v[128:131], v[68:71], v[20:23]
v_mfma_f32_16x16x32_bf16 v[24:27], v[200:203], v[64:67], v[24:27]
v_mfma_f32_16x16x32_bf16 v[28:31], v[200:203], v[68:71], v[28:31]
v_mfma_f32_16x16x32_bf16 v[32:35], a[16:19], v[64:67], v[32:35]
v_mfma_f32_16x16x32_bf16 v[36:39], a[16:19], v[68:71], v[36:39]
v_mfma_f32_16x16x32_bf16 v[40:43], a[88:91], v[64:67], v[40:43]
v_mfma_f32_16x16x32_bf16 v[44:47], a[88:91], v[68:71], v[44:47]
ds_read_b128 v[64:67], v3 offset:28672
ds_read_b128 v[68:71], v3 offset:29696
s_waitcnt lgkmcnt(2)
v_mfma_f32_16x16x32_bf16 v[16:19], v[132:135], v[72:75], v[16:19]
v_mfma_f32_16x16x32_bf16 v[20:23], v[132:135], v[76:79], v[20:23]
v_mfma_f32_16x16x32_bf16 v[24:27], v[204:207], v[72:75], v[24:27]
v_mfma_f32_16x16x32_bf16 v[28:31], v[204:207], v[76:79], v[28:31]
v_mfma_f32_16x16x32_bf16 v[32:35], a[20:23], v[72:75], v[32:35]
v_mfma_f32_16x16x32_bf16 v[36:39], a[20:23], v[76:79], v[36:39]
v_mfma_f32_16x16x32_bf16 v[40:43], a[92:95], v[72:75], v[40:43]
v_mfma_f32_16x16x32_bf16 v[44:47], a[92:95], v[76:79], v[44:47]
ds_read_b128 v[72:75], v3 offset:30720
ds_read_b128 v[76:79], v3 offset:31744
s_waitcnt lgkmcnt(2)
v_mfma_f32_16x16x32_bf16 v[16:19], v[136:139], v[64:67], v[16:19]
v_mfma_f32_16x16x32_bf16 v[20:23], v[136:139], v[68:71], v[20:23]
v_mfma_f32_16x16x32_bf16 v[24:27], v[208:211], v[64:67], v[24:27]
v_mfma_f32_16x16x32_bf16 v[28:31], v[208:211], v[68:71], v[28:31]
v_mfma_f32_16x16x32_bf16 v[32:35], a[24:27], v[64:67], v[32:35]
v_mfma_f32_16x16x32_bf16 v[36:39], a[24:27], v[68:71], v[36:39]
v_mfma_f32_16x16x32_bf16 v[40:43], a[96:99], v[64:67], v[40:43]
v_mfma_f32_16x16x32_bf16 v[44:47], a[96:99], v[68:71], v[44:47]
ds_read_b128 v[64:67], v3 offset:32768
ds_read_b128 v[68:71], v3 offset:33792
s_waitcnt lgkmcnt(2)
v_mfma_f32_16x16x32_bf16 v[16:19], v[140:143], v[72:75], v[16:19]
v_mfma_f32_16x16x32_bf16 v[20:23], v[140:143], v[76:79], v[20:23]
v_mfma_f32_16x16x32_bf16 v[24:27], v[212:215], v[72:75], v[24:27]
v_mfma_f32_16x16x32_bf16 v[28:31], v[212:215], v[76:79], v[28:31]
v_mfma_f32_16x16x32_bf16 v[32:35], a[28:31], v[72:75], v[32:35]
v_mfma_f32_16x16x32_bf16 v[36:39], a[28:31], v[76:79], v[36:39]
v_mfma_f32_16x16x32_bf16 v[40:43], a[100:103], v[72:75], v[40:43]
v_mfma_f32_16x16x32_bf16 v[44:47], a[100:103], v[76:79], v[44:47]
ds_read_b128 v[72:75], v3 offset:34816
ds_read_b128 v[76:79], v3 offset:35840
s_waitcnt lgkmcnt(2)
v_mfma_f32_16x16x32_bf16 v[16:19], v[144:147], v[64:67], v[16:19]
v_mfma_f32_16x16x32_bf16 v[20:23], v[144:147], v[68:71], v[20:23]
v_mfma_f32_16x16x32_bf16 v[24:27], v[216:219], v[64:67], v[24:27]
v_mfma_f32_16x16x32_bf16 v[28:31], v[216:219], v[68:71], v[28:31]
v_mfma_f32_16x16x32_bf16 v[32:35], a[32:35], v[64:67], v[32:35]
v_mfma_f32_16x16x32_bf16 v[36:39], a[32:35], v[68:71], v[36:39]
v_mfma_f32_16x16x32_bf16 v[40:43], a[104:107], v[64:67], v[40:43]
v_mfma_f32_16x16x32_bf16 v[44:47], a[104:107], v[68:71], v[44:47]
s_waitcnt lgkmcnt(0)
v_mfma_f32_16x16x32_bf16 v[16:19], v[148:151], v[72:75], v[16:19]
v_mfma_f32_16x16x32_bf16 v[20:23], v[148:151], v[76:79], v[20:23]
v_mfma_f32_16x16x32_bf16 v[24:27], v[220:223], v[72:75], v[24:27]
v_mfma_f32_16x16x32_bf16 v[28:31], v[220:223], v[76:79], v[28:31]
v_mfma_f32_16x16x32_bf16 v[32:35], a[36:39], v[72:75], v[32:35]
v_mfma_f32_16x16x32_bf16 v[36:39], a[36:39], v[76:79], v[36:39]
v_mfma_f32_16x16x32_bf16 v[40:43], a[108:111], v[72:75], v[40:43]
v_mfma_f32_16x16x32_bf16 v[44:47], a[108:111], v[76:79], v[44:47]
v_add_u32 v3, s50, v3
s_sub_u32 s50, 0, s50
v_cvt_pk_bf16_f32 v16, v16, v17
v_cvt_pk_bf16_f32 v17, v18, v19
ds_write_b64 v4, v[16:17] offset:0
v_cvt_pk_bf16_f32 v20, v20, v21
v_cvt_pk_bf16_f32 v21, v22, v23
ds_write_b64 v4, v[20:21] offset:7296
v_cvt_pk_bf16_f32 v24, v24, v25
v_cvt_pk_bf16_f32 v25, v26, v27
ds_write_b64 v4, v[24:25] offset:32
v_cvt_pk_bf16_f32 v28, v28, v29
v_cvt_pk_bf16_f32 v29, v30, v31
ds_write_b64 v4, v[28:29] offset:7328
s_cmp_eq_u32 s34, 3
s_cbranch_scc1 L_a_gate
v_cvt_pk_bf16_f32 v32, v32, v33
v_cvt_pk_bf16_f32 v33, v34, v35
ds_write_b64 v4, v[32:33] offset:64
v_cvt_pk_bf16_f32 v36, v36, v37
v_cvt_pk_bf16_f32 v37, v38, v39
ds_write_b64 v4, v[36:37] offset:7360
v_cvt_pk_bf16_f32 v40, v40, v41
v_cvt_pk_bf16_f32 v41, v42, v43
ds_write_b64 v4, v[40:41] offset:96
v_cvt_pk_bf16_f32 v44, v44, v45
v_cvt_pk_bf16_f32 v45, v46, v47
ds_write_b64 v4, v[44:45] offset:7392
s_branch L_a_nog2
L_a_gate:
ds_write_b32 v14, v32
ds_write_b32 v14, v36 offset:64
L_a_nog2:
v_add_u32 v4, 14592, v4
v_add_u32 v14, 128, v14
s_add_u32 s35, s35, 1
s_cmp_lt_u32 s35, 6
s_cbranch_scc1 L_a_loop
s_waitcnt vmcnt(0) lgkmcnt(0)
s_barrier
s_mov_b32 s35, 0
s_mul_i32 s39, s34, 36
s_add_u32 s39, s39, 73728
s_mul_i32 s40, s33, 176
s_mov_b32 s41, 0x3eae1a93
s_mov_b32 s42, 0xbfb8aa3b
L_la_loop:
v_add_u32 v12, s35, v9
v_min_u32 v12, 175, v12
v_add_u32 v2, s40, v12
v_add_u32 v12, 16, v12
v_mul_u32_u24 v14, 456, v12
v_add_u32 v14, s39, v14
v_lshlrev_b32 v12, 2, v12
v_add_u32 v12, 161280, v12
ds_read_b32 v3, v12
ds_read2_b32 v[16:17], v14 offset0:0 offset1:1
ds_read2_b32 v[18:19], v14 offset0:2 offset1:3
ds_read2_b32 v[20:21], v14 offset0:4 offset1:5
ds_read2_b32 v[22:23], v14 offset0:6 offset1:7
ds_read_b32 v24, v14 offset:32
v_subrev_u32 v15, 0, v14
ds_read2_b32 v[26:27], v15 offset0:36 offset1:37
ds_read2_b32 v[28:29], v15 offset0:38 offset1:39
ds_read2_b32 v[30:31], v15 offset0:40 offset1:41
ds_read2_b32 v[32:33], v15 offset0:42 offset1:43
ds_read_b32 v34, v15 offset:176
v_subrev_u32 v15, 912, v14
ds_read2_b32 v[36:37], v15 offset0:36 offset1:37
ds_read2_b32 v[38:39], v15 offset0:38 offset1:39
ds_read2_b32 v[40:41], v15 offset0:40 offset1:41
ds_read2_b32 v[42:43], v15 offset0:42 offset1:43
ds_read_b32 v44, v15 offset:176
s_waitcnt lgkmcnt(5)
v_dot2_f32_bf16 v176, v16, v26, 0
v_dot2_f32_bf16 v176, v17, v27, v176
v_dot2_f32_bf16 v176, v18, v28, v176
v_dot2_f32_bf16 v176, v19, v29, v176
v_dot2_f32_bf16 v176, v20, v30, v176
v_dot2_f32_bf16 v176, v21, v31, v176
v_dot2_f32_bf16 v176, v22, v32, v176
v_dot2_f32_bf16 v176, v23, v33, v176
v_dot2_f32_bf16 v176, v24, v34, v176
v_subrev_u32 v15, 1824, v14
ds_read2_b32 v[46:47], v15 offset0:36 offset1:37
ds_read2_b32 v[48:49], v15 offset0:38 offset1:39
ds_read2_b32 v[50:51], v15 offset0:40 offset1:41
ds_read2_b32 v[52:53], v15 offset0:42 offset1:43
ds_read_b32 v54, v15 offset:176
s_waitcnt lgkmcnt(5)
v_dot2_f32_bf16 v177, v16, v36, 0
v_dot2_f32_bf16 v177, v17, v37, v177
v_dot2_f32_bf16 v177, v18, v38, v177
v_dot2_f32_bf16 v177, v19, v39, v177
v_dot2_f32_bf16 v177, v20, v40, v177
v_dot2_f32_bf16 v177, v21, v41, v177
v_dot2_f32_bf16 v177, v22, v42, v177
v_dot2_f32_bf16 v177, v23, v43, v177
v_dot2_f32_bf16 v177, v24, v44, v177
v_subrev_u32 v15, 2736, v14
ds_read2_b32 v[56:57], v15 offset0:36 offset1:37
ds_read2_b32 v[58:59], v15 offset0:38 offset1:39
ds_read2_b32 v[60:61], v15 offset0:40 offset1:41
ds_read2_b32 v[62:63], v15 offset0:42 offset1:43
ds_read_b32 v64, v15 offset:176
s_waitcnt lgkmcnt(5)
v_dot2_f32_bf16 v178, v16, v46, 0
v_dot2_f32_bf16 v178, v17, v47, v178
v_dot2_f32_bf16 v178, v18, v48, v178
v_dot2_f32_bf16 v178, v19, v49, v178
v_dot2_f32_bf16 v178, v20, v50, v178
v_dot2_f32_bf16 v178, v21, v51, v178
v_dot2_f32_bf16 v178, v22, v52, v178
v_dot2_f32_bf16 v178, v23, v53, v178
v_dot2_f32_bf16 v178, v24, v54, v178
v_subrev_u32 v15, 3648, v14
ds_read2_b32 v[26:27], v15 offset0:36 offset1:37
ds_read2_b32 v[28:29], v15 offset0:38 offset1:39
ds_read2_b32 v[30:31], v15 offset0:40 offset1:41
ds_read2_b32 v[32:33], v15 offset0:42 offset1:43
ds_read_b32 v34, v15 offset:176
s_waitcnt lgkmcnt(5)
v_dot2_f32_bf16 v179, v16, v56, 0
v_dot2_f32_bf16 v179, v17, v57, v179
v_dot2_f32_bf16 v179, v18, v58, v179
v_dot2_f32_bf16 v179, v19, v59, v179
v_dot2_f32_bf16 v179, v20, v60, v179
v_dot2_f32_bf16 v179, v21, v61, v179
v_dot2_f32_bf16 v179, v22, v62, v179
v_dot2_f32_bf16 v179, v23, v63, v179
v_dot2_f32_bf16 v179, v24, v64, v179
v_subrev_u32 v15, 4560, v14
ds_read2_b32 v[36:37], v15 offset0:36 offset1:37
ds_read2_b32 v[38:39], v15 offset0:38 offset1:39
ds_read2_b32 v[40:41], v15 offset0:40 offset1:41
ds_read2_b32 v[42:43], v15 offset0:42 offset1:43
ds_read_b32 v44, v15 offset:176
s_waitcnt lgkmcnt(5)
v_dot2_f32_bf16 v180, v16, v26, 0
v_dot2_f32_bf16 v180, v17, v27, v180
v_dot2_f32_bf16 v180, v18, v28, v180
v_dot2_f32_bf16 v180, v19, v29, v180
v_dot2_f32_bf16 v180, v20, v30, v180
v_dot2_f32_bf16 v180, v21, v31, v180
v_dot2_f32_bf16 v180, v22, v32, v180
v_dot2_f32_bf16 v180, v23, v33, v180
v_dot2_f32_bf16 v180, v24, v34, v180
v_subrev_u32 v15, 5472, v14
ds_read2_b32 v[46:47], v15 offset0:36 offset1:37
ds_read2_b32 v[48:49], v15 offset0:38 offset1:39
ds_read2_b32 v[50:51], v15 offset0:40 offset1:41
ds_read2_b32 v[52:53], v15 offset0:42 offset1:43
ds_read_b32 v54, v15 offset:176
s_waitcnt lgkmcnt(5)
v_dot2_f32_bf16 v181, v16, v36, 0
v_dot2_f32_bf16 v181, v17, v37, v181
v_dot2_f32_bf16 v181, v18, v38, v181
v_dot2_f32_bf16 v181, v19, v39, v181
v_dot2_f32_bf16 v181, v20, v40, v181
v_dot2_f32_bf16 v181, v21, v41, v181
v_dot2_f32_bf16 v181, v22, v42, v181
v_dot2_f32_bf16 v181, v23, v43, v181
v_dot2_f32_bf16 v181, v24, v44, v181
v_subrev_u32 v15, 6384, v14
ds_read2_b32 v[56:57], v15 offset0:36 offset1:37
ds_read2_b32 v[58:59], v15 offset0:38 offset1:39
ds_read2_b32 v[60:61], v15 offset0:40 offset1:41
ds_read2_b32 v[62:63], v15 offset0:42 offset1:43
ds_read_b32 v64, v15 offset:176
s_waitcnt lgkmcnt(5)
v_dot2_f32_bf16 v182, v16, v46, 0
v_dot2_f32_bf16 v182, v17, v47, v182
v_dot2_f32_bf16 v182, v18, v48, v182
v_dot2_f32_bf16 v182, v19, v49, v182
v_dot2_f32_bf16 v182, v20, v50, v182
v_dot2_f32_bf16 v182, v21, v51, v182
v_dot2_f32_bf16 v182, v22, v52, v182
v_dot2_f32_bf16 v182, v23, v53, v182
v_dot2_f32_bf16 v182, v24, v54, v182
s_waitcnt lgkmcnt(0)
v_dot2_f32_bf16 v183, v16, v56, 0
v_dot2_f32_bf16 v183, v17, v57, v183
v_dot2_f32_bf16 v183, v18, v58, v183
v_dot2_f32_bf16 v183, v19, v59, v183
v_dot2_f32_bf16 v183, v20, v60, v183
v_dot2_f32_bf16 v183, v21, v61, v183
v_dot2_f32_bf16 v183, v22, v62, v183
v_dot2_f32_bf16 v183, v23, v63, v183
v_dot2_f32_bf16 v183, v24, v64, v183
v_subrev_u32 v15, 0, v14
ds_read2_b32 v[100:101], v15 offset0:72 offset1:73
ds_read2_b32 v[102:103], v15 offset0:74 offset1:75
ds_read2_b32 v[104:105], v15 offset0:76 offset1:77
ds_read2_b32 v[106:107], v15 offset0:78 offset1:79
ds_read_b32 v108, v15 offset:320
v_subrev_u32 v15, 912, v14
ds_read2_b32 v[110:111], v15 offset0:72 offset1:73
ds_read2_b32 v[112:113], v15 offset0:74 offset1:75
ds_read2_b32 v[114:115], v15 offset0:76 offset1:77
ds_read2_b32 v[116:117], v15 offset0:78 offset1:79
ds_read_b32 v118, v15 offset:320
v_mov_b32 v13, 0xf149f2ca
v_mul_f32 v176, s41, v176
v_mul_f32 v177, s41, v177
v_mul_f32 v178, s41, v178
v_mul_f32 v179, s41, v179
v_mul_f32 v180, s41, v180
v_mul_f32 v181, s41, v181
v_mul_f32 v182, s41, v182
v_mul_f32 v183, s41, v183
v_cmp_le_u32 vcc, 2, v2
s_nop 1
v_cndmask_b32 v177, v13, v177, vcc
v_cmp_le_u32 vcc, 4, v2
s_nop 1
v_cndmask_b32 v178, v13, v178, vcc
v_cmp_le_u32 vcc, 6, v2
s_nop 1
v_cndmask_b32 v179, v13, v179, vcc
v_cmp_le_u32 vcc, 8, v2
s_nop 1
v_cndmask_b32 v180, v13, v180, vcc
v_cmp_le_u32 vcc, 10, v2
s_nop 1
v_cndmask_b32 v181, v13, v181, vcc
v_cmp_le_u32 vcc, 12, v2
s_nop 1
v_cndmask_b32 v182, v13, v182, vcc
v_cmp_le_u32 vcc, 14, v2
s_nop 1
v_cndmask_b32 v183, v13, v183, vcc
v_max3_f32 v12, v176, v177, v178
v_max3_f32 v12, v12, v179, v180
v_max3_f32 v12, v12, v181, v182
v_max_f32 v12, v12, v183
v_sub_f32 v176, v176, v12
v_sub_f32 v177, v177, v12
v_sub_f32 v178, v178, v12
v_sub_f32 v179, v179, v12
v_sub_f32 v180, v180, v12
v_sub_f32 v181, v181, v12
v_sub_f32 v182, v182, v12
v_sub_f32 v183, v183, v12
v_exp_f32 v176, v176
v_exp_f32 v177, v177
v_exp_f32 v178, v178
v_exp_f32 v179, v179
v_exp_f32 v180, v180
v_exp_f32 v181, v181
v_exp_f32 v182, v182
v_exp_f32 v183, v183
v_cvt_pk_bf16_f32 v204, v176, v8
v_cvt_pk_bf16_f32 v205, v177, v8
v_cvt_pk_bf16_f32 v206, v178, v8
v_cvt_pk_bf16_f32 v207, v179, v8
v_cvt_pk_bf16_f32 v208, v180, v8
v_cvt_pk_bf16_f32 v209, v181, v8
v_cvt_pk_bf16_f32 v210, v182, v8
v_cvt_pk_bf16_f32 v211, v183, v8
v_lshlrev_b32 v212, 16, v204
v_lshlrev_b32 v213, 16, v205
v_lshlrev_b32 v214, 16, v206
v_lshlrev_b32 v215, 16, v207
v_lshlrev_b32 v216, 16, v208
v_lshlrev_b32 v217, 16, v209
v_lshlrev_b32 v218, 16, v210
v_lshlrev_b32 v219, 16, v211
v_add_f32 v12, v212, v213
v_add_f32 v13, v214, v215
v_add_f32 v12, v12, v216
v_add_f32 v13, v13, v217
v_add_f32 v12, v12, v218
v_add_f32 v13, v13, v219
v_add_f32 v12, v12, v13
v_mul_f32 v13, s42, v3
v_exp_f32 v3, v13
v_exp_f32 v13, -v13
v_add_f32 v3, 1.0, v3
v_add_f32 v13, 1.0, v13
v_mul_f32 v12, v12, v3
v_rcp_f32 v12, v12
v_rcp_f32 v13, v13
v_subrev_u32 v15, 1824, v14
ds_read2_b32 v[120:121], v15 offset0:72 offset1:73
ds_read2_b32 v[122:123], v15 offset0:74 offset1:75
ds_read2_b32 v[124:125], v15 offset0:76 offset1:77
ds_read2_b32 v[126:127], v15 offset0:78 offset1:79
ds_read_b32 v128, v15 offset:320
s_waitcnt lgkmcnt(10)
v_dot2_f32_bf16 v184, v100, v204, 0
v_dot2_f32_bf16 v185, v100, v212, 0
v_dot2_f32_bf16 v186, v101, v204, 0
v_dot2_f32_bf16 v187, v101, v212, 0
v_dot2_f32_bf16 v188, v102, v204, 0
v_dot2_f32_bf16 v189, v102, v212, 0
v_dot2_f32_bf16 v190, v103, v204, 0
v_dot2_f32_bf16 v191, v103, v212, 0
v_dot2_f32_bf16 v192, v104, v204, 0
v_dot2_f32_bf16 v193, v104, v212, 0
v_dot2_f32_bf16 v194, v105, v204, 0
v_dot2_f32_bf16 v195, v105, v212, 0
v_dot2_f32_bf16 v196, v106, v204, 0
v_dot2_f32_bf16 v197, v106, v212, 0
v_dot2_f32_bf16 v198, v107, v204, 0
v_dot2_f32_bf16 v199, v107, v212, 0
v_dot2_f32_bf16 v200, v108, v204, 0
v_dot2_f32_bf16 v201, v108, v212, 0
v_subrev_u32 v15, 2736, v14
ds_read2_b32 v[130:131], v15 offset0:72 offset1:73
ds_read2_b32 v[132:133], v15 offset0:74 offset1:75
ds_read2_b32 v[134:135], v15 offset0:76 offset1:77
ds_read2_b32 v[136:137], v15 offset0:78 offset1:79
ds_read_b32 v138, v15 offset:320
s_waitcnt lgkmcnt(10)
v_dot2_f32_bf16 v184, v110, v205, v184
v_dot2_f32_bf16 v185, v110, v213, v185
v_dot2_f32_bf16 v186, v111, v205, v186
v_dot2_f32_bf16 v187, v111, v213, v187
v_dot2_f32_bf16 v188, v112, v205, v188
v_dot2_f32_bf16 v189, v112, v213, v189
v_dot2_f32_bf16 v190, v113, v205, v190
v_dot2_f32_bf16 v191, v113, v213, v191
v_dot2_f32_bf16 v192, v114, v205, v192
v_dot2_f32_bf16 v193, v114, v213, v193
v_dot2_f32_bf16 v194, v115, v205, v194
v_dot2_f32_bf16 v195, v115, v213, v195
v_dot2_f32_bf16 v196, v116, v205, v196
v_dot2_f32_bf16 v197, v116, v213, v197
v_dot2_f32_bf16 v198, v117, v205, v198
v_dot2_f32_bf16 v199, v117, v213, v199
v_dot2_f32_bf16 v200, v118, v205, v200
v_dot2_f32_bf16 v201, v118, v213, v201
v_subrev_u32 v15, 3648, v14
ds_read2_b32 v[100:101], v15 offset0:72 offset1:73
ds_read2_b32 v[102:103], v15 offset0:74 offset1:75
ds_read2_b32 v[104:105], v15 offset0:76 offset1:77
ds_read2_b32 v[106:107], v15 offset0:78 offset1:79
ds_read_b32 v108, v15 offset:320
s_waitcnt lgkmcnt(10)
v_dot2_f32_bf16 v184, v120, v206, v184
v_dot2_f32_bf16 v185, v120, v214, v185
v_dot2_f32_bf16 v186, v121, v206, v186
v_dot2_f32_bf16 v187, v121, v214, v187
v_dot2_f32_bf16 v188, v122, v206, v188
v_dot2_f32_bf16 v189, v122, v214, v189
v_dot2_f32_bf16 v190, v123, v206, v190
v_dot2_f32_bf16 v191, v123, v214, v191
v_dot2_f32_bf16 v192, v124, v206, v192
v_dot2_f32_bf16 v193, v124, v214, v193
v_dot2_f32_bf16 v194, v125, v206, v194
v_dot2_f32_bf16 v195, v125, v214, v195
v_dot2_f32_bf16 v196, v126, v206, v196
v_dot2_f32_bf16 v197, v126, v214, v197
v_dot2_f32_bf16 v198, v127, v206, v198
v_dot2_f32_bf16 v199, v127, v214, v199
v_dot2_f32_bf16 v200, v128, v206, v200
v_dot2_f32_bf16 v201, v128, v214, v201
v_subrev_u32 v15, 4560, v14
ds_read2_b32 v[110:111], v15 offset0:72 offset1:73
ds_read2_b32 v[112:113], v15 offset0:74 offset1:75
ds_read2_b32 v[114:115], v15 offset0:76 offset1:77
ds_read2_b32 v[116:117], v15 offset0:78 offset1:79
ds_read_b32 v118, v15 offset:320
s_waitcnt lgkmcnt(10)
v_dot2_f32_bf16 v184, v130, v207, v184
v_dot2_f32_bf16 v185, v130, v215, v185
v_dot2_f32_bf16 v186, v131, v207, v186
v_dot2_f32_bf16 v187, v131, v215, v187
v_dot2_f32_bf16 v188, v132, v207, v188
v_dot2_f32_bf16 v189, v132, v215, v189
v_dot2_f32_bf16 v190, v133, v207, v190
v_dot2_f32_bf16 v191, v133, v215, v191
v_dot2_f32_bf16 v192, v134, v207, v192
v_dot2_f32_bf16 v193, v134, v215, v193
v_dot2_f32_bf16 v194, v135, v207, v194
v_dot2_f32_bf16 v195, v135, v215, v195
v_dot2_f32_bf16 v196, v136, v207, v196
v_dot2_f32_bf16 v197, v136, v215, v197
v_dot2_f32_bf16 v198, v137, v207, v198
v_dot2_f32_bf16 v199, v137, v215, v199
v_dot2_f32_bf16 v200, v138, v207, v200
v_dot2_f32_bf16 v201, v138, v215, v201
v_subrev_u32 v15, 5472, v14
ds_read2_b32 v[120:121], v15 offset0:72 offset1:73
ds_read2_b32 v[122:123], v15 offset0:74 offset1:75
ds_read2_b32 v[124:125], v15 offset0:76 offset1:77
ds_read2_b32 v[126:127], v15 offset0:78 offset1:79
ds_read_b32 v128, v15 offset:320
s_waitcnt lgkmcnt(10)
v_dot2_f32_bf16 v184, v100, v208, v184
v_dot2_f32_bf16 v185, v100, v216, v185
v_dot2_f32_bf16 v186, v101, v208, v186
v_dot2_f32_bf16 v187, v101, v216, v187
v_dot2_f32_bf16 v188, v102, v208, v188
v_dot2_f32_bf16 v189, v102, v216, v189
v_dot2_f32_bf16 v190, v103, v208, v190
v_dot2_f32_bf16 v191, v103, v216, v191
v_dot2_f32_bf16 v192, v104, v208, v192
v_dot2_f32_bf16 v193, v104, v216, v193
v_dot2_f32_bf16 v194, v105, v208, v194
v_dot2_f32_bf16 v195, v105, v216, v195
v_dot2_f32_bf16 v196, v106, v208, v196
v_dot2_f32_bf16 v197, v106, v216, v197
v_dot2_f32_bf16 v198, v107, v208, v198
v_dot2_f32_bf16 v199, v107, v216, v199
v_dot2_f32_bf16 v200, v108, v208, v200
v_dot2_f32_bf16 v201, v108, v216, v201
v_subrev_u32 v15, 6384, v14
ds_read2_b32 v[130:131], v15 offset0:72 offset1:73
ds_read2_b32 v[132:133], v15 offset0:74 offset1:75
ds_read2_b32 v[134:135], v15 offset0:76 offset1:77
ds_read2_b32 v[136:137], v15 offset0:78 offset1:79
ds_read_b32 v138, v15 offset:320
s_waitcnt lgkmcnt(10)
v_dot2_f32_bf16 v184, v110, v209, v184
v_dot2_f32_bf16 v185, v110, v217, v185
v_dot2_f32_bf16 v186, v111, v209, v186
v_dot2_f32_bf16 v187, v111, v217, v187
v_dot2_f32_bf16 v188, v112, v209, v188
v_dot2_f32_bf16 v189, v112, v217, v189
v_dot2_f32_bf16 v190, v113, v209, v190
v_dot2_f32_bf16 v191, v113, v217, v191
v_dot2_f32_bf16 v192, v114, v209, v192
v_dot2_f32_bf16 v193, v114, v217, v193
v_dot2_f32_bf16 v194, v115, v209, v194
v_dot2_f32_bf16 v195, v115, v217, v195
v_dot2_f32_bf16 v196, v116, v209, v196
v_dot2_f32_bf16 v197, v116, v217, v197
v_dot2_f32_bf16 v198, v117, v209, v198
v_dot2_f32_bf16 v199, v117, v217, v199
v_dot2_f32_bf16 v200, v118, v209, v200
v_dot2_f32_bf16 v201, v118, v217, v201
s_waitcnt lgkmcnt(5)
v_dot2_f32_bf16 v184, v120, v210, v184
v_dot2_f32_bf16 v185, v120, v218, v185
v_dot2_f32_bf16 v186, v121, v210, v186
v_dot2_f32_bf16 v187, v121, v218, v187
v_dot2_f32_bf16 v188, v122, v210, v188
v_dot2_f32_bf16 v189, v122, v218, v189
v_dot2_f32_bf16 v190, v123, v210, v190
v_dot2_f32_bf16 v191, v123, v218, v191
v_dot2_f32_bf16 v192, v124, v210, v192
v_dot2_f32_bf16 v193, v124, v218, v193
v_dot2_f32_bf16 v194, v125, v210, v194
v_dot2_f32_bf16 v195, v125, v218, v195
v_dot2_f32_bf16 v196, v126, v210, v196
v_dot2_f32_bf16 v197, v126, v218, v197
v_dot2_f32_bf16 v198, v127, v210, v198
v_dot2_f32_bf16 v199, v127, v218, v199
v_dot2_f32_bf16 v200, v128, v210, v200
v_dot2_f32_bf16 v201, v128, v218, v201
s_waitcnt lgkmcnt(0)
v_dot2_f32_bf16 v184, v130, v211, v184
v_dot2_f32_bf16 v185, v130, v219, v185
v_dot2_f32_bf16 v186, v131, v211, v186
v_dot2_f32_bf16 v187, v131, v219, v187
v_dot2_f32_bf16 v188, v132, v211, v188
v_dot2_f32_bf16 v189, v132, v219, v189
v_dot2_f32_bf16 v190, v133, v211, v190
v_dot2_f32_bf16 v191, v133, v219, v191
v_dot2_f32_bf16 v192, v134, v211, v192
v_dot2_f32_bf16 v193, v134, v219, v193
v_dot2_f32_bf16 v194, v135, v211, v194
v_dot2_f32_bf16 v195, v135, v219, v195
v_dot2_f32_bf16 v196, v136, v211, v196
v_dot2_f32_bf16 v197, v136, v219, v197
v_dot2_f32_bf16 v198, v137, v211, v198
v_dot2_f32_bf16 v199, v137, v219, v199
v_dot2_f32_bf16 v200, v138, v211, v200
v_dot2_f32_bf16 v201, v138, v219, v201
s_or_b32 s37, s32, s34
s_cmp_lg_u32 s37, 0
s_cbranch_scc1 L_la_noomg
v_lshlrev_b32 v15, 2, v2
v_min_u32 v15, 8192, v15
s_mov_b32 s37, 87031808
buffer_store_dword v13, v15, s[4:7], s37 offen sc0 sc1
L_la_noomg:
v_mul_f32 v184, v184, v12
v_mul_f32 v185, v185, v12
v_mul_f32 v186, v186, v12
v_mul_f32 v187, v187, v12
v_mul_f32 v188, v188, v12
v_mul_f32 v189, v189, v12
v_mul_f32 v190, v190, v12
v_mul_f32 v191, v191, v12
v_mul_f32 v192, v192, v12
v_mul_f32 v193, v193, v12
v_mul_f32 v194, v194, v12
v_mul_f32 v195, v195, v12
v_mul_f32 v196, v196, v12
v_mul_f32 v197, v197, v12
v_mul_f32 v198, v198, v12
v_mul_f32 v199, v199, v12
v_mul_f32 v200, v200, v12
v_mul_f32 v201, v201, v12
v_cvt_pk_bf16_f32 v184, v184, v185
v_cvt_pk_bf16_f32 v185, v186, v187
v_cvt_pk_bf16_f32 v186, v188, v189
v_cvt_pk_bf16_f32 v187, v190, v191
v_cvt_pk_bf16_f32 v188, v192, v193
v_cvt_pk_bf16_f32 v189, v194, v195
v_cvt_pk_bf16_f32 v190, v196, v197
v_cvt_pk_bf16_f32 v191, v198, v199
v_cvt_pk_bf16_f32 v192, v200, v201
ds_write2_b32 v14, v184, v185 offset0:0 offset1:1
ds_write2_b32 v14, v186, v187 offset0:2 offset1:3
ds_write2_b32 v14, v188, v189 offset0:4 offset1:5
ds_write2_b32 v14, v190, v191 offset0:6 offset1:7
ds_write_b32 v14, v192 offset:32
s_add_u32 s35, s35, 64
s_cmp_lt_u32 s35, 192
s_cbranch_scc1 L_la_loop
s_waitcnt lgkmcnt(0)
s_barrier
v_mul_u32_u24 v14, 456, v10
v_lshl_add_u32 v14, v11, 4, v14
s_add_u32 s37, s34, 1
s_mul_i32 s37, s37, 7296
s_add_u32 s37, s37, 73728
v_add_u32 v14, s37, v14
s_mul_i32 s40, s33, 11
s_add_u32 s40, s40, s34
s_mov_b32 s35, s34
s_mul_i32 s41, s32, 2304
s_add_u32 s41, s41, 83886080
L_oa_loop:
s_cmp_ge_u32 s40, 128
s_cbranch_scc1 L_oa_done
ds_read2_b64 v[16:19], v14 offset0:0 offset1:1
ds_read2_b64 v[20:23], v14 offset0:8 offset1:9
ds_read2_b64 v[24:27], v14 offset0:16 offset1:17
s_mul_i32 s37, s40, 18432
s_add_u32 s37, s37, s41
s_waitcnt lgkmcnt(2)
buffer_store_dwordx4 v[16:19], v1, s[4:7], s37 offen offset:0 sc0 sc1
s_waitcnt lgkmcnt(1)
buffer_store_dwordx4 v[20:23], v1, s[4:7], s37 offen offset:1024 sc0 sc1
s_waitcnt lgkmcnt(0)
s_mov_b64 exec, 0xffff
buffer_store_dwordx4 v[24:27], v1, s[4:7], s37 offen offset:2048 sc0 sc1
s_mov_b64 exec, -1
v_add_u32 v14, 29184, v14
s_add_u32 s40, s40, 4
s_add_u32 s35, s35, 4
s_cmp_lt_u32 s35, 11
s_cbranch_scc1 L_oa_loop
L_oa_done:
s_waitcnt vmcnt(0)
s_barrier
s_cmp_lg_u32 s34, 0
s_cbranch_scc1 L_a_sig
v_mov_b32 v12, 1
s_mov_b64 exec, 1
buffer_atomic_add v12, v8, s[24:27], 0 offen offset:4 sc1
s_mov_b64 exec, -1
L_a_sig:
s_branch L_w_init_in
L_w_init:
s_sleep 4
L_w_init_in:
buffer_load_dword v12, v8, s[24:27], 0 offen offset:0 sc0 sc1
s_sub_u32 s36, s36, 1
s_cbranch_scc1 L_exit_w
s_waitcnt vmcnt(0)
v_readfirstlane_b32 s38, v12
s_nop 0
s_and_b32 s37, s38, 0xff
s_cmp_eq_u32 s37, 32
s_cbranch_scc0 L_w_init
s_xor_b32 s37, s49, 96
s_cmp_ge_u32 s49, 32
s_cselect_b32 s37, s37, s49
s_bitcmp1_b32 s38, 13
s_cselect_b32 s49, s37, s49
s_mul_i32 s48, s49, 43
s_lshr_b32 s48, s48, 9
s_mul_i32 s37, s48, 12
s_sub_u32 s49, s49, s37
s_cmp_ge_u32 s48, 5
s_cbranch_scc1 L_exit_w
v_add_u32 v12, 0, v9
v_mul_u32_u24 v13, 171, v12
v_lshrrev_b32 v13, 10, v13
v_mul_u32_u24 v13, 1056, v13
v_lshl_add_u32 v2, v12, 4, v13
v_add_u32 v12, 64, v9
v_mul_u32_u24 v13, 171, v12
v_lshrrev_b32 v13, 10, v13
v_mul_u32_u24 v13, 1056, v13
v_lshl_add_u32 v3, v12, 4, v13
v_add_u32 v12, 128, v9
v_mul_u32_u24 v13, 171, v12
v_lshrrev_b32 v13, 10, v13
v_mul_u32_u24 v13, 1056, v13
v_lshl_add_u32 v4, v12, 4, v13
v_lshrrev_b32 v12, 2, v10
v_lshl_add_u32 v12, v11, 2, v12
v_mul_u32_u24 v5, 96, v12
v_and_b32 v12, 3, v10
v_lshl_add_u32 v5, v12, 3, v5
v_lshrrev_b32 v12, 2, v10
v_lshl_add_u32 v12, v11, 3, v12
v_mul_u32_u24 v6, 96, v12
v_and_b32 v12, 3, v10
v_lshl_add_u32 v6, v12, 3, v6
s_lshl_b32 s50, s34, 15
v_add_u32 v5, s50, v5
v_add_u32 v6, s50, v6
v_add_u32 v7, s50, v1
s_mul_i32 s37, s49, 96
s_mul_i32 s51, s34, 1179648
s_add_u32 s51, s51, s37
s_mul_i32 s52, s34, 184320
s_add_u32 s52, s52, s37
v_mul_u32_u24 v15, 1152, v10
v_lshl_add_u32 v15, v11, 3, v15
s_lshl_b32 s38, s34, 5
s_add_u32 s37, s37, s38
s_mul_i32 s55, s48, 18432
s_add_u32 s54, s55, 83886080
s_add_u32 s55, s55, s37
s_lshl_b32 s53, s48, 17
s_add_u32 s53, s53, s50
s_add_u32 s53, s53, 67108864
s_lshl_b32 s56, s48, 6
s_add_u32 s56, s56, 87031808
v_lshlrev_b32 v9, 4, v9
v_lshlrev_b32 v10, 2, v10
v_add_u32 v14, 131072, v1
s_add_u32 s37, s52, 0
s_add_u32 m0, s50, 0
s_nop 0
buffer_load_dwordx4 v2, s[16:19], s37 offen lds
s_add_u32 m0, s50, 1024
s_nop 0
buffer_load_dwordx4 v3, s[16:19], s37 offen lds
s_add_u32 m0, s50, 2048
s_nop 0
buffer_load_dwordx4 v4, s[16:19], s37 offen lds
s_add_u32 s37, s52, 36864
s_add_u32 m0, s50, 3072
s_nop 0
buffer_load_dwordx4 v2, s[16:19], s37 offen lds
s_add_u32 m0, s50, 4096
s_nop 0
buffer_load_dwordx4 v3, s[16:19], s37 offen lds
s_add_u32 m0, s50, 5120
s_nop 0
buffer_load_dwordx4 v4, s[16:19], s37 offen lds
s_add_u32 s37, s52, 73728
s_add_u32 m0, s50, 6144
s_nop 0
buffer_load_dwordx4 v2, s[16:19], s37 offen lds
s_add_u32 m0, s50, 7168
s_nop 0
buffer_load_dwordx4 v3, s[16:19], s37 offen lds
s_add_u32 m0, s50, 8192
s_nop 0
buffer_load_dwordx4 v4, s[16:19], s37 offen lds
s_add_u32 s37, s52, 110592
s_add_u32 m0, s50, 9216
s_nop 0
buffer_load_dwordx4 v2, s[16:19], s37 offen lds
s_add_u32 m0, s50, 10240
s_nop 0
buffer_load_dwordx4 v3, s[16:19], s37 offen lds
s_add_u32 m0, s50, 11264
s_nop 0
buffer_load_dwordx4 v4, s[16:19], s37 offen lds
s_add_u32 s37, s52, 147456
s_add_u32 m0, s50, 12288
s_nop 0
buffer_load_dwordx4 v2, s[16:19], s37 offen lds
s_add_u32 m0, s50, 13312
s_nop 0
buffer_load_dwordx4 v3, s[16:19], s37 offen lds
s_add_u32 m0, s50, 14336
s_nop 0
buffer_load_dwordx4 v4, s[16:19], s37 offen lds
s_add_u32 s37, s51, 0
s_add_u32 m0, s50, 15360
s_nop 0
buffer_load_dwordx4 v2, s[20:23], s37 offen lds
s_add_u32 m0, s50, 16384
s_nop 0
buffer_load_dwordx4 v3, s[20:23], s37 offen lds
s_add_u32 m0, s50, 17408
s_nop 0
buffer_load_dwordx4 v4, s[20:23], s37 offen lds
s_add_u32 s37, s51, 36864
s_add_u32 m0, s50, 18432
s_nop 0
buffer_load_dwordx4 v2, s[20:23], s37 offen lds
s_add_u32 m0, s50, 19456
s_nop 0
buffer_load_dwordx4 v3, s[20:23], s37 offen lds
s_add_u32 m0, s50, 20480
s_nop 0
buffer_load_dwordx4 v4, s[20:23], s37 offen lds
s_add_u32 s37, s51, 73728
s_add_u32 m0, s50, 21504
s_nop 0
buffer_load_dwordx4 v2, s[20:23], s37 offen lds
s_add_u32 m0, s50, 22528
s_nop 0
buffer_load_dwordx4 v3, s[20:23], s37 offen lds
s_add_u32 m0, s50, 23552
s_nop 0
buffer_load_dwordx4 v4, s[20:23], s37 offen lds
s_add_u32 s37, s51, 110592
s_add_u32 m0, s50, 24576
s_nop 0
buffer_load_dwordx4 v2, s[20:23], s37 offen lds
s_add_u32 m0, s50, 25600
s_nop 0
buffer_load_dwordx4 v3, s[20:23], s37 offen lds
s_add_u32 m0, s50, 26624
s_nop 0
buffer_load_dwordx4 v4, s[20:23], s37 offen lds
s_waitcnt vmcnt(24)
ds_read_b64_tr_b16 v[68:69], v6 offset:0
ds_read_b64_tr_b16 v[70:71], v6 offset:384
ds_read_b64_tr_b16 v[72:73], v6 offset:32
ds_read_b64_tr_b16 v[74:75], v6 offset:416
ds_read_b64_tr_b16 v[76:77], v6 offset:64
ds_read_b64_tr_b16 v[78:79], v6 offset:448
s_waitcnt lgkmcnt(0)
s_add_u32 s37, s51, 147456
s_add_u32 m0, s50, 27648
s_nop 0
buffer_load_dwordx4 v2, s[20:23], s37 offen lds
s_add_u32 m0, s50, 28672
s_nop 0
buffer_load_dwordx4 v3, s[20:23], s37 offen lds
s_add_u32 m0, s50, 29696
s_nop 0
buffer_load_dwordx4 v4, s[20:23], s37 offen lds
s_waitcnt vmcnt(24)
ds_read_b64_tr_b16 v[80:81], v6 offset:3072
ds_read_b64_tr_b16 v[82:83], v6 offset:3456
ds_read_b64_tr_b16 v[84:85], v6 offset:3104
ds_read_b64_tr_b16 v[86:87], v6 offset:3488
ds_read_b64_tr_b16 v[88:89], v6 offset:3136
ds_read_b64_tr_b16 v[90:91], v6 offset:3520
s_waitcnt lgkmcnt(0)
s_add_u32 s37, s51, 184320
s_add_u32 m0, s50, 0
s_nop 0
buffer_load_dwordx4 v2, s[20:23], s37 offen lds
s_add_u32 m0, s50, 1024
s_nop 0
buffer_load_dwordx4 v3, s[20:23], s37 offen lds
s_add_u32 m0, s50, 2048
s_nop 0
buffer_load_dwordx4 v4, s[20:23], s37 offen lds
s_waitcnt vmcnt(24)
ds_read_b64_tr_b16 v[92:93], v6 offset:6144
ds_read_b64_tr_b16 v[94:95], v6 offset:6528
ds_read_b64_tr_b16 v[96:97], v6 offset:6176
ds_read_b64_tr_b16 v[98:99], v6 offset:6560
ds_read_b64_tr_b16 v[100:101], v6 offset:6208
ds_read_b64_tr_b16 v[102:103], v6 offset:6592
s_waitcnt lgkmcnt(0)
s_add_u32 s37, s51, 221184
s_add_u32 m0, s50, 3072
s_nop 0
buffer_load_dwordx4 v2, s[20:23], s37 offen lds
s_add_u32 m0, s50, 4096
s_nop 0
buffer_load_dwordx4 v3, s[20:23], s37 offen lds
s_add_u32 m0, s50, 5120
s_nop 0
buffer_load_dwordx4 v4, s[20:23], s37 offen lds
s_waitcnt vmcnt(24)
ds_read_b64_tr_b16 v[104:105], v6 offset:9216
ds_read_b64_tr_b16 v[106:107], v6 offset:9600
ds_read_b64_tr_b16 v[108:109], v6 offset:9248
ds_read_b64_tr_b16 v[110:111], v6 offset:9632
ds_read_b64_tr_b16 v[112:113], v6 offset:9280
ds_read_b64_tr_b16 v[114:115], v6 offset:9664
s_waitcnt lgkmcnt(0)
s_add_u32 s37, s51, 258048
s_add_u32 m0, s50, 6144
s_nop 0
buffer_load_dwordx4 v2, s[20:23], s37 offen lds
s_add_u32 m0, s50, 7168
s_nop 0
buffer_load_dwordx4 v3, s[20:23], s37 offen lds
s_add_u32 m0, s50, 8192
s_nop 0
buffer_load_dwordx4 v4, s[20:23], s37 offen lds
s_waitcnt vmcnt(24)
ds_read_b64_tr_b16 v[116:117], v6 offset:12288
ds_read_b64_tr_b16 v[118:119], v6 offset:12672
ds_read_b64_tr_b16 v[120:121], v6 offset:12320
ds_read_b64_tr_b16 v[122:123], v6 offset:12704
ds_read_b64_tr_b16 v[124:125], v6 offset:12352
ds_read_b64_tr_b16 v[126:127], v6 offset:12736
s_waitcnt lgkmcnt(0)
s_add_u32 s37, s51, 294912
s_add_u32 m0, s50, 9216
s_nop 0
buffer_load_dwordx4 v2, s[20:23], s37 offen lds
s_add_u32 m0, s50, 10240
s_nop 0
buffer_load_dwordx4 v3, s[20:23], s37 offen lds
s_add_u32 m0, s50, 11264
s_nop 0
buffer_load_dwordx4 v4, s[20:23], s37 offen lds
s_waitcnt vmcnt(24)
ds_read_b64_tr_b16 v[128:129], v5 offset:15360
ds_read_b64_tr_b16 v[130:131], v5 offset:16896
ds_read_b64_tr_b16 v[132:133], v5 offset:15392
ds_read_b64_tr_b16 v[134:135], v5 offset:16928
ds_read_b64_tr_b16 v[136:137], v5 offset:15424
ds_read_b64_tr_b16 v[138:139], v5 offset:16960
s_waitcnt lgkmcnt(0)
s_add_u32 s37, s51, 331776
s_add_u32 m0, s50, 12288
s_nop 0
buffer_load_dwordx4 v2, s[20:23], s37 offen lds
s_add_u32 m0, s50, 13312
s_nop 0
buffer_load_dwordx4 v3, s[20:23], s37 offen lds
s_add_u32 m0, s50, 14336
s_nop 0
buffer_load_dwordx4 v4, s[20:23], s37 offen lds
s_waitcnt vmcnt(24)
ds_read_b64_tr_b16 v[140:141], v5 offset:18432
ds_read_b64_tr_b16 v[142:143], v5 offset:19968
ds_read_b64_tr_b16 v[144:145], v5 offset:18464
ds_read_b64_tr_b16 v[146:147], v5 offset:20000
ds_read_b64_tr_b16 v[148:149], v5 offset:18496
ds_read_b64_tr_b16 v[150:151], v5 offset:20032
s_waitcnt lgkmcnt(0)
s_add_u32 s37, s51, 368640
s_add_u32 m0, s50, 15360
s_nop 0
buffer_load_dwordx4 v2, s[20:23], s37 offen lds
s_add_u32 m0, s50, 16384
s_nop 0
buffer_load_dwordx4 v3, s[20:23], s37 offen lds
s_add_u32 m0, s50, 17408
s_nop 0
buffer_load_dwordx4 v4, s[20:23], s37 offen lds
s_waitcnt vmcnt(24)
ds_read_b64_tr_b16 v[152:153], v5 offset:21504
ds_read_b64_tr_b16 v[154:155], v5 offset:23040
ds_read_b64_tr_b16 v[156:157], v5 offset:21536
ds_read_b64_tr_b16 v[158:159], v5 offset:23072
ds_read_b64_tr_b16 v[160:161], v5 offset:21568
ds_read_b64_tr_b16 v[162:163], v5 offset:23104
s_waitcnt lgkmcnt(0)
s_add_u32 s37, s51, 405504
s_add_u32 m0, s50, 18432
s_nop 0
buffer_load_dwordx4 v2, s[20:23], s37 offen lds
s_add_u32 m0, s50, 19456
s_nop 0
buffer_load_dwordx4 v3, s[20:23], s37 offen lds
s_add_u32 m0, s50, 20480
s_nop 0
buffer_load_dwordx4 v4, s[20:23], s37 offen lds
s_waitcnt vmcnt(24)
ds_read_b64_tr_b16 v[164:165], v5 offset:24576
ds_read_b64_tr_b16 v[166:167], v5 offset:26112
ds_read_b64_tr_b16 v[168:169], v5 offset:24608
ds_read_b64_tr_b16 v[170:171], v5 offset:26144
ds_read_b64_tr_b16 v[172:173], v5 offset:24640
ds_read_b64_tr_b16 v[174:175], v5 offset:26176
s_waitcnt lgkmcnt(0)
s_add_u32 s37, s51, 442368
s_add_u32 m0, s50, 21504
s_nop 0
buffer_load_dwordx4 v2, s[20:23], s37 offen lds
s_add_u32 m0, s50, 22528
s_nop 0
buffer_load_dwordx4 v3, s[20:23], s37 offen lds
s_add_u32 m0, s50, 23552
s_nop 0
buffer_load_dwordx4 v4, s[20:23], s37 offen lds
s_waitcnt vmcnt(24)
ds_read_b64_tr_b16 v[176:177], v5 offset:27648
ds_read_b64_tr_b16 v[178:179], v5 offset:29184
ds_read_b64_tr_b16 v[180:181], v5 offset:27680
ds_read_b64_tr_b16 v[182:183], v5 offset:29216
ds_read_b64_tr_b16 v[184:185], v5 offset:27712
ds_read_b64_tr_b16 v[186:187], v5 offset:29248
s_waitcnt lgkmcnt(0)
s_add_u32 s37, s51, 479232
s_add_u32 m0, s50, 24576
s_nop 0
buffer_load_dwordx4 v2, s[20:23], s37 offen lds
s_add_u32 m0, s50, 25600
s_nop 0
buffer_load_dwordx4 v3, s[20:23], s37 offen lds
s_add_u32 m0, s50, 26624
s_nop 0
buffer_load_dwordx4 v4, s[20:23], s37 offen lds
s_waitcnt vmcnt(24)
ds_read_b64_tr_b16 v[188:189], v5 offset:0
ds_read_b64_tr_b16 v[190:191], v5 offset:1536
ds_read_b64_tr_b16 v[192:193], v5 offset:32
ds_read_b64_tr_b16 v[194:195], v5 offset:1568
ds_read_b64_tr_b16 v[196:197], v5 offset:64
ds_read_b64_tr_b16 v[198:199], v5 offset:1600
s_waitcnt lgkmcnt(0)
s_add_u32 s37, s51, 516096
s_add_u32 m0, s50, 27648
s_nop 0
buffer_load_dwordx4 v2, s[20:23], s37 offen lds
s_add_u32 m0, s50, 28672
s_nop 0
buffer_load_dwordx4 v3, s[20:23], s37 offen lds
s_add_u32 m0, s50, 29696
s_nop 0
buffer_load_dwordx4 v4, s[20:23], s37 offen lds
s_waitcnt vmcnt(24)
ds_read_b64_tr_b16 v[200:201], v5 offset:3072
ds_read_b64_tr_b16 v[202:203], v5 offset:4608
ds_read_b64_tr_b16 v[204:205], v5 offset:3104
ds_read_b64_tr_b16 v[206:207], v5 offset:4640
ds_read_b64_tr_b16 v[208:209], v5 offset:3136
ds_read_b64_tr_b16 v[210:211], v5 offset:4672
s_waitcnt lgkmcnt(0)
s_add_u32 s37, s51, 552960
s_add_u32 m0, s50, 0
s_nop 0
buffer_load_dwordx4 v2, s[20:23], s37 offen lds
s_add_u32 m0, s50, 1024
s_nop 0
buffer_load_dwordx4 v3, s[20:23], s37 offen lds
s_add_u32 m0, s50, 2048
s_nop 0
buffer_load_dwordx4 v4, s[20:23], s37 offen lds
s_waitcnt vmcnt(24)
ds_read_b64_tr_b16 v[212:213], v5 offset:6144
ds_read_b64_tr_b16 v[214:215], v5 offset:7680
ds_read_b64_tr_b16 v[216:217], v5 offset:6176
ds_read_b64_tr_b16 v[218:219], v5 offset:7712
ds_read_b64_tr_b16 v[220:221], v5 offset:6208
ds_read_b64_tr_b16 v[222:223], v5 offset:7744
s_waitcnt lgkmcnt(0)
s_add_u32 s37, s51, 589824
s_add_u32 m0, s50, 3072
s_nop 0
buffer_load_dwordx4 v2, s[20:23], s37 offen lds
s_add_u32 m0, s50, 4096
s_nop 0
buffer_load_dwordx4 v3, s[20:23], s37 offen lds
s_add_u32 m0, s50, 5120
s_nop 0
buffer_load_dwordx4 v4, s[20:23], s37 offen lds
s_waitcnt vmcnt(24)
ds_read_b64_tr_b16 v[224:225], v5 offset:9216
ds_read_b64_tr_b16 v[226:227], v5 offset:10752
ds_read_b64_tr_b16 v[228:229], v5 offset:9248
ds_read_b64_tr_b16 v[230:231], v5 offset:10784
ds_read_b64_tr_b16 v[232:233], v5 offset:9280
ds_read_b64_tr_b16 v[234:235], v5 offset:10816
s_waitcnt lgkmcnt(0)
s_add_u32 s37, s51, 626688
s_add_u32 m0, s50, 6144
s_nop 0
buffer_load_dwordx4 v2, s[20:23], s37 offen lds
s_add_u32 m0, s50, 7168
s_nop 0
buffer_load_dwordx4 v3, s[20:23], s37 offen lds
s_add_u32 m0, s50, 8192
s_nop 0
buffer_load_dwordx4 v4, s[20:23], s37 offen lds
s_waitcnt vmcnt(24)
ds_read_b64_tr_b16 v[236:237], v5 offset:12288
ds_read_b64_tr_b16 v[238:239], v5 offset:13824
ds_read_b64_tr_b16 v[240:241], v5 offset:12320
ds_read_b64_tr_b16 v[242:243], v5 offset:13856
ds_read_b64_tr_b16 v[244:245], v5 offset:12352
ds_read_b64_tr_b16 v[246:247], v5 offset:13888
s_waitcnt lgkmcnt(0)
s_add_u32 s37, s51, 663552
s_add_u32 m0, s50, 9216
s_nop 0
buffer_load_dwordx4 v2, s[20:23], s37 offen lds
s_add_u32 m0, s50, 10240
s_nop 0
buffer_load_dwordx4 v3, s[20:23], s37 offen lds
s_add_u32 m0, s50, 11264
s_nop 0
buffer_load_dwordx4 v4, s[20:23], s37 offen lds
s_waitcnt vmcnt(24)
ds_read_b64_tr_b16 v[248:249], v5 offset:15360
ds_read_b64_tr_b16 v[250:251], v5 offset:16896
ds_read_b64_tr_b16 v[252:253], v5 offset:15392
ds_read_b64_tr_b16 v[254:255], v5 offset:16928
ds_read_b64_tr_b16 a[0:1], v5 offset:15424
ds_read_b64_tr_b16 a[2:3], v5 offset:16960
s_waitcnt lgkmcnt(0)
s_add_u32 s37, s51, 700416
s_add_u32 m0, s50, 12288
s_nop 0
buffer_load_dwordx4 v2, s[20:23], s37 offen lds
s_add_u32 m0, s50, 13312
s_nop 0
buffer_load_dwordx4 v3, s[20:23], s37 offen lds
s_add_u32 m0, s50, 14336
s_nop 0
buffer_load_dwordx4 v4, s[20:23], s37 offen lds
s_waitcnt vmcnt(24)
ds_read_b64_tr_b16 a[4:5], v5 offset:18432
ds_read_b64_tr_b16 a[6:7], v5 offset:19968
ds_read_b64_tr_b16 a[8:9], v5 offset:18464
ds_read_b64_tr_b16 a[10:11], v5 offset:20000
ds_read_b64_tr_b16 a[12:13], v5 offset:18496
ds_read_b64_tr_b16 a[14:15], v5 offset:20032
s_waitcnt lgkmcnt(0)
s_add_u32 s37, s51, 737280
s_add_u32 m0, s50, 15360
s_nop 0
buffer_load_dwordx4 v2, s[20:23], s37 offen lds
s_add_u32 m0, s50, 16384
s_nop 0
buffer_load_dwordx4 v3, s[20:23], s37 offen lds
s_add_u32 m0, s50, 17408
s_nop 0
buffer_load_dwordx4 v4, s[20:23], s37 offen lds
s_waitcnt vmcnt(24)
ds_read_b64_tr_b16 a[16:17], v5 offset:21504
ds_read_b64_tr_b16 a[18:19], v5 offset:23040
ds_read_b64_tr_b16 a[20:21], v5 offset:21536
ds_read_b64_tr_b16 a[22:23], v5 offset:23072
ds_read_b64_tr_b16 a[24:25], v5 offset:21568
ds_read_b64_tr_b16 a[26:27], v5 offset:23104
s_waitcnt lgkmcnt(0)
s_add_u32 s37, s51, 774144
s_add_u32 m0, s50, 18432
s_nop 0
buffer_load_dwordx4 v2, s[20:23], s37 offen lds
s_add_u32 m0, s50, 19456
s_nop 0
buffer_load_dwordx4 v3, s[20:23], s37 offen lds
s_add_u32 m0, s50, 20480
s_nop 0
buffer_load_dwordx4 v4, s[20:23], s37 offen lds
s_waitcnt vmcnt(24)
ds_read_b64_tr_b16 a[28:29], v5 offset:24576
ds_read_b64_tr_b16 a[30:31], v5 offset:26112
ds_read_b64_tr_b16 a[32:33], v5 offset:24608
ds_read_b64_tr_b16 a[34:35], v5 offset:26144
ds_read_b64_tr_b16 a[36:37], v5 offset:24640
ds_read_b64_tr_b16 a[38:39], v5 offset:26176
s_waitcnt lgkmcnt(0)
s_add_u32 s37, s51, 811008
s_add_u32 m0, s50, 21504
s_nop 0
buffer_load_dwordx4 v2, s[20:23], s37 offen lds
s_add_u32 m0, s50, 22528
s_nop 0
buffer_load_dwordx4 v3, s[20:23], s37 offen lds
s_add_u32 m0, s50, 23552
s_nop 0
buffer_load_dwordx4 v4, s[20:23], s37 offen lds
s_waitcnt vmcnt(24)
ds_read_b64_tr_b16 a[40:41], v5 offset:27648
ds_read_b64_tr_b16 a[42:43], v5 offset:29184
ds_read_b64_tr_b16 a[44:45], v5 offset:27680
ds_read_b64_tr_b16 a[46:47], v5 offset:29216
ds_read_b64_tr_b16 a[48:49], v5 offset:27712
ds_read_b64_tr_b16 a[50:51], v5 offset:29248
s_waitcnt lgkmcnt(0)
s_add_u32 s37, s51, 847872
s_add_u32 m0, s50, 24576
s_nop 0
buffer_load_dwordx4 v2, s[20:23], s37 offen lds
s_add_u32 m0, s50, 25600
s_nop 0
buffer_load_dwordx4 v3, s[20:23], s37 offen lds
s_add_u32 m0, s50, 26624
s_nop 0
buffer_load_dwordx4 v4, s[20:23], s37 offen lds
s_waitcnt vmcnt(24)
ds_read_b64_tr_b16 a[52:53], v5 offset:0
ds_read_b64_tr_b16 a[54:55], v5 offset:1536
ds_read_b64_tr_b16 a[56:57], v5 offset:32
ds_read_b64_tr_b16 a[58:59], v5 offset:1568
ds_read_b64_tr_b16 a[60:61], v5 offset:64
ds_read_b64_tr_b16 a[62:63], v5 offset:1600
s_waitcnt lgkmcnt(0)
s_add_u32 s37, s51, 884736
s_add_u32 m0, s50, 27648
s_nop 0
buffer_load_dwordx4 v2, s[20:23], s37 offen lds
s_add_u32 m0, s50, 28672
s_nop 0
buffer_load_dwordx4 v3, s[20:23], s37 offen lds
s_add_u32 m0, s50, 29696
s_nop 0
buffer_load_dwordx4 v4, s[20:23], s37 offen lds
s_waitcnt vmcnt(24)
ds_read_b64_tr_b16 a[64:65], v5 offset:3072
ds_read_b64_tr_b16 a[66:67], v5 offset:4608
ds_read_b64_tr_b16 a[68:69], v5 offset:3104
ds_read_b64_tr_b16 a[70:71], v5 offset:4640
ds_read_b64_tr_b16 a[72:73], v5 offset:3136
ds_read_b64_tr_b16 a[74:75], v5 offset:4672
s_waitcnt lgkmcnt(0)
s_add_u32 s37, s51, 921600
s_add_u32 m0, s50, 0
s_nop 0
buffer_load_dwordx4 v2, s[20:23], s37 offen lds
s_add_u32 m0, s50, 1024
s_nop 0
buffer_load_dwordx4 v3, s[20:23], s37 offen lds
s_add_u32 m0, s50, 2048
s_nop 0
buffer_load_dwordx4 v4, s[20:23], s37 offen lds
s_waitcnt vmcnt(24)
ds_read_b64_tr_b16 a[76:77], v5 offset:6144
ds_read_b64_tr_b16 a[78:79], v5 offset:7680
ds_read_b64_tr_b16 a[80:81], v5 offset:6176
ds_read_b64_tr_b16 a[82:83], v5 offset:7712
ds_read_b64_tr_b16 a[84:85], v5 offset:6208
ds_read_b64_tr_b16 a[86:87], v5 offset:7744
s_waitcnt lgkmcnt(0)
s_add_u32 s37, s51, 958464
s_add_u32 m0, s50, 3072
s_nop 0
buffer_load_dwordx4 v2, s[20:23], s37 offen lds
s_add_u32 m0, s50, 4096
s_nop 0
buffer_load_dwordx4 v3, s[20:23], s37 offen lds
s_add_u32 m0, s50, 5120
s_nop 0
buffer_load_dwordx4 v4, s[20:23], s37 offen lds
s_waitcnt vmcnt(24)
ds_read_b64_tr_b16 a[88:89], v5 offset:9216
ds_read_b64_tr_b16 a[90:91], v5 offset:10752
ds_read_b64_tr_b16 a[92:93], v5 offset:9248
ds_read_b64_tr_b16 a[94:95], v5 offset:10784
ds_read_b64_tr_b16 a[96:97], v5 offset:9280
ds_read_b64_tr_b16 a[98:99], v5 offset:10816
s_waitcnt lgkmcnt(0)
s_add_u32 s37, s51, 995328
s_add_u32 m0, s50, 6144
s_nop 0
buffer_load_dwordx4 v2, s[20:23], s37 offen lds
s_add_u32 m0, s50, 7168
s_nop 0
buffer_load_dwordx4 v3, s[20:23], s37 offen lds
s_add_u32 m0, s50, 8192
s_nop 0
buffer_load_dwordx4 v4, s[20:23], s37 offen lds
s_waitcnt vmcnt(24)
ds_read_b64_tr_b16 a[100:101], v5 offset:12288
ds_read_b64_tr_b16 a[102:103], v5 offset:13824
ds_read_b64_tr_b16 a[104:105], v5 offset:12320
ds_read_b64_tr_b16 a[106:107], v5 offset:13856
ds_read_b64_tr_b16 a[108:109], v5 offset:12352
ds_read_b64_tr_b16 a[110:111], v5 offset:13888
s_waitcnt lgkmcnt(0)
s_add_u32 s37, s51, 1032192
s_add_u32 m0, s50, 9216
s_nop 0
buffer_load_dwordx4 v2, s[20:23], s37 offen lds
s_add_u32 m0, s50, 10240
s_nop 0
buffer_load_dwordx4 v3, s[20:23], s37 offen lds
s_add_u32 m0, s50, 11264
s_nop 0
buffer_load_dwordx4 v4, s[20:23], s37 offen lds
s_waitcnt vmcnt(24)
ds_read_b64_tr_b16 a[112:113], v5 offset:15360
ds_read_b64_tr_b16 a[114:115], v5 offset:16896
ds_read_b64_tr_b16 a[116:117], v5 offset:15392
ds_read_b64_tr_b16 a[118:119], v5 offset:16928
ds_read_b64_tr_b16 a[120:121], v5 offset:15424
ds_read_b64_tr_b16 a[122:123], v5 offset:16960
s_waitcnt lgkmcnt(0)
s_add_u32 s37, s51, 1069056
s_add_u32 m0, s50, 12288
s_nop 0
buffer_load_dwordx4 v2, s[20:23], s37 offen lds
s_add_u32 m0, s50, 13312
s_nop 0
buffer_load_dwordx4 v3, s[20:23], s37 offen lds
s_add_u32 m0, s50, 14336
s_nop 0
buffer_load_dwordx4 v4, s[20:23], s37 offen lds
s_waitcnt vmcnt(24)
ds_read_b64_tr_b16 a[124:125], v5 offset:18432
ds_read_b64_tr_b16 a[126:127], v5 offset:19968
ds_read_b64_tr_b16 a[128:129], v5 offset:18464
ds_read_b64_tr_b16 a[130:131], v5 offset:20000
ds_read_b64_tr_b16 a[132:133], v5 offset:18496
ds_read_b64_tr_b16 a[134:135], v5 offset:20032
s_waitcnt lgkmcnt(0)
s_add_u32 s37, s51, 1105920
s_add_u32 m0, s50, 15360
s_nop 0
buffer_load_dwordx4 v2, s[20:23], s37 offen lds
s_add_u32 m0, s50, 16384
s_nop 0
buffer_load_dwordx4 v3, s[20:23], s37 offen lds
s_add_u32 m0, s50, 17408
s_nop 0
buffer_load_dwordx4 v4, s[20:23], s37 offen lds
s_waitcnt vmcnt(24)
ds_read_b64_tr_b16 a[136:137], v5 offset:21504
ds_read_b64_tr_b16 a[138:139], v5 offset:23040
ds_read_b64_tr_b16 a[140:141], v5 offset:21536
ds_read_b64_tr_b16 a[142:143], v5 offset:23072
ds_read_b64_tr_b16 a[144:145], v5 offset:21568
ds_read_b64_tr_b16 a[146:147], v5 offset:23104
s_waitcnt lgkmcnt(0)
s_add_u32 s37, s51, 1142784
s_add_u32 m0, s50, 18432
s_nop 0
buffer_load_dwordx4 v2, s[20:23], s37 offen lds
s_add_u32 m0, s50, 19456
s_nop 0
buffer_load_dwordx4 v3, s[20:23], s37 offen lds
s_add_u32 m0, s50, 20480
s_nop 0
buffer_load_dwordx4 v4, s[20:23], s37 offen lds
s_waitcnt vmcnt(24)
ds_read_b64_tr_b16 a[148:149], v5 offset:24576
ds_read_b64_tr_b16 a[150:151], v5 offset:26112
ds_read_b64_tr_b16 a[152:153], v5 offset:24608
ds_read_b64_tr_b16 a[154:155], v5 offset:26144
ds_read_b64_tr_b16 a[156:157], v5 offset:24640
ds_read_b64_tr_b16 a[158:159], v5 offset:26176
s_waitcnt lgkmcnt(0)
s_waitcnt vmcnt(21)
ds_read_b64_tr_b16 a[160:161], v5 offset:27648
ds_read_b64_tr_b16 a[162:163], v5 offset:29184
ds_read_b64_tr_b16 a[164:165], v5 offset:27680
ds_read_b64_tr_b16 a[166:167], v5 offset:29216
ds_read_b64_tr_b16 a[168:169], v5 offset:27712
ds_read_b64_tr_b16 a[170:171], v5 offset:29248
s_waitcnt lgkmcnt(0)
s_waitcnt vmcnt(18)
ds_read_b64_tr_b16 a[172:173], v5 offset:0
ds_read_b64_tr_b16 a[174:175], v5 offset:1536
ds_read_b64_tr_b16 a[176:177], v5 offset:32
ds_read_b64_tr_b16 a[178:179], v5 offset:1568
ds_read_b64_tr_b16 a[180:181], v5 offset:64
ds_read_b64_tr_b16 a[182:183], v5 offset:1600
s_waitcnt lgkmcnt(0)
s_waitcnt vmcnt(15)
ds_read_b64_tr_b16 a[184:185], v5 offset:3072
ds_read_b64_tr_b16 a[186:187], v5 offset:4608
ds_read_b64_tr_b16 a[188:189], v5 offset:3104
ds_read_b64_tr_b16 a[190:191], v5 offset:4640
ds_read_b64_tr_b16 a[192:193], v5 offset:3136
ds_read_b64_tr_b16 a[194:195], v5 offset:4672
s_waitcnt lgkmcnt(0)
s_waitcnt vmcnt(12)
ds_read_b64_tr_b16 a[196:197], v5 offset:6144
ds_read_b64_tr_b16 a[198:199], v5 offset:7680
ds_read_b64_tr_b16 a[200:201], v5 offset:6176
ds_read_b64_tr_b16 a[202:203], v5 offset:7712
ds_read_b64_tr_b16 a[204:205], v5 offset:6208
ds_read_b64_tr_b16 a[206:207], v5 offset:7744
s_waitcnt lgkmcnt(0)
s_waitcnt vmcnt(9)
ds_read_b64_tr_b16 a[208:209], v5 offset:9216
ds_read_b64_tr_b16 a[210:211], v5 offset:10752
ds_read_b64_tr_b16 a[212:213], v5 offset:9248
ds_read_b64_tr_b16 a[214:215], v5 offset:10784
ds_read_b64_tr_b16 a[216:217], v5 offset:9280
ds_read_b64_tr_b16 a[218:219], v5 offset:10816
s_waitcnt lgkmcnt(0)
s_waitcnt vmcnt(6)
ds_read_b64_tr_b16 a[220:221], v5 offset:12288
ds_read_b64_tr_b16 a[222:223], v5 offset:13824
ds_read_b64_tr_b16 a[224:225], v5 offset:12320
ds_read_b64_tr_b16 a[226:227], v5 offset:13856
ds_read_b64_tr_b16 a[228:229], v5 offset:12352
ds_read_b64_tr_b16 a[230:231], v5 offset:13888
s_waitcnt lgkmcnt(0)
s_waitcnt vmcnt(3)
ds_read_b64_tr_b16 a[232:233], v5 offset:15360
ds_read_b64_tr_b16 a[234:235], v5 offset:16896
ds_read_b64_tr_b16 a[236:237], v5 offset:15392
ds_read_b64_tr_b16 a[238:239], v5 offset:16928
ds_read_b64_tr_b16 a[240:241], v5 offset:15424
ds_read_b64_tr_b16 a[242:243], v5 offset:16960
s_waitcnt lgkmcnt(0)
s_waitcnt vmcnt(0)
ds_read_b64_tr_b16 a[244:245], v5 offset:18432
ds_read_b64_tr_b16 a[246:247], v5 offset:19968
ds_read_b64_tr_b16 a[248:249], v5 offset:18464
ds_read_b64_tr_b16 a[250:251], v5 offset:20000
ds_read_b64_tr_b16 a[252:253], v5 offset:18496
ds_read_b64_tr_b16 a[254:255], v5 offset:20032
s_waitcnt lgkmcnt(0)
s_branch L_w_adone_in
L_w_adone:
s_sleep 4
L_w_adone_in:
buffer_load_dword v12, v8, s[24:27], 0 offen offset:4 sc0 sc1
s_sub_u32 s36, s36, 1
s_cbranch_scc1 L_exit_w
s_waitcnt vmcnt(0)
v_readfirstlane_b32 s37, v12
s_nop 0
s_cmp_eq_u32 s37, 96
s_cbranch_scc0 L_w_adone
s_mov_b32 s35, 0
s_mul_i32 s52, s34, 5
s_mul_i32 s58, s34, 3072
v_add_u32 v2, s58, v14
s_lshl_b32 s37, s34, 10
v_add_u32 v14, s37, v14
s_cmp_eq_u32 s34, 3
s_cselect_b32 s37, 0x400000, 0
v_add_u32 v15, s37, v15
L_w_wait:
s_and_b32 s57, s48, 7
s_lshl_b32 s57, s57, 10
s_add_u32 s57, s57, 331776
s_lshr_b32 s35, s48, 3
s_add_u32 s37, s52, 0
s_min_u32 s37, s37, 17
s_lshl_b32 s37, s37, 10
s_add_u32 s37, s37, s54
buffer_load_dwordx4 v[40:43], v1, s[4:7], s37 offen sc1
s_add_u32 s37, s52, 1
s_min_u32 s37, s37, 17
s_lshl_b32 s37, s37, 10
s_add_u32 s37, s37, s54
buffer_load_dwordx4 v[44:47], v1, s[4:7], s37 offen sc1
s_add_u32 s37, s52, 2
s_min_u32 s37, s37, 17
s_lshl_b32 s37, s37, 10
s_add_u32 s37, s37, s54
buffer_load_dwordx4 v[48:51], v1, s[4:7], s37 offen sc1
s_add_u32 s37, s52, 3
s_min_u32 s37, s37, 17
s_lshl_b32 s37, s37, 10
s_add_u32 s37, s37, s54
buffer_load_dwordx4 v[52:55], v1, s[4:7], s37 offen sc1
s_add_u32 s37, s52, 4
s_min_u32 s37, s37, 17
s_lshl_b32 s37, s37, 10
s_add_u32 s37, s37, s54
buffer_load_dwordx4 v[56:59], v1, s[4:7], s37 offen sc1
buffer_load_dword v4, v10, s[4:7], s56 offen sc1
s_waitcnt vmcnt(5)
v_mfma_f32_16x16x32_bf16 v[28:31], v[68:71], v[40:43], 0
v_mfma_f32_16x16x32_bf16 v[32:35], v[72:75], v[40:43], 0
v_mfma_f32_16x16x32_bf16 v[36:39], v[76:79], v[40:43], 0
s_waitcnt vmcnt(4)
v_mfma_f32_16x16x32_bf16 v[28:31], v[80:83], v[44:47], v[28:31]
v_mfma_f32_16x16x32_bf16 v[32:35], v[84:87], v[44:47], v[32:35]
v_mfma_f32_16x16x32_bf16 v[36:39], v[88:91], v[44:47], v[36:39]
s_waitcnt vmcnt(3)
v_mfma_f32_16x16x32_bf16 v[28:31], v[92:95], v[48:51], v[28:31]
v_mfma_f32_16x16x32_bf16 v[32:35], v[96:99], v[48:51], v[32:35]
v_mfma_f32_16x16x32_bf16 v[36:39], v[100:103], v[48:51], v[36:39]
s_waitcnt vmcnt(2)
v_mfma_f32_16x16x32_bf16 v[28:31], v[104:107], v[52:55], v[28:31]
v_mfma_f32_16x16x32_bf16 v[32:35], v[108:111], v[52:55], v[32:35]
v_mfma_f32_16x16x32_bf16 v[36:39], v[112:115], v[52:55], v[36:39]
s_waitcnt vmcnt(1)
v_mfma_f32_16x16x32_bf16 v[28:31], v[116:119], v[56:59], v[28:31]
v_mfma_f32_16x16x32_bf16 v[32:35], v[120:123], v[56:59], v[32:35]
v_mfma_f32_16x16x32_bf16 v[36:39], v[124:127], v[56:59], v[36:39]
s_branch L_w_poll_in
L_w_poll:
s_sleep 2
L_w_poll_in:
buffer_load_dword v12, v9, s[4:7], s57 offen offset:0 sc0 sc1
s_sub_u32 s36, s36, 1
s_cbranch_scc1 L_exit_w
s_waitcnt vmcnt(0)
v_cmp_ge_u32 vcc, s35, v12
s_nop 1
s_cmp_eq_u64 vcc, 0
s_cbranch_scc0 L_w_poll
s_add_u32 s37, s53, 0
s_add_u32 m0, s50, 0
s_nop 0
buffer_load_dwordx4 v1, s[4:7], s37 offen offset:0 sc1 lds
buffer_load_dwordx4 v1, s[4:7], s37 offen offset:1024 sc1 lds
buffer_load_dwordx4 v1, s[4:7], s37 offen offset:2048 sc1 lds
buffer_load_dwordx4 v1, s[4:7], s37 offen offset:3072 sc1 lds
s_add_u32 s37, s53, 4096
s_add_u32 m0, s50, 4096
s_nop 0
buffer_load_dwordx4 v1, s[4:7], s37 offen offset:0 sc1 lds
buffer_load_dwordx4 v1, s[4:7], s37 offen offset:1024 sc1 lds
buffer_load_dwordx4 v1, s[4:7], s37 offen offset:2048 sc1 lds
buffer_load_dwordx4 v1, s[4:7], s37 offen offset:3072 sc1 lds
s_add_u32 s37, s53, 8192
s_add_u32 m0, s50, 8192
s_nop 0
buffer_load_dwordx4 v1, s[4:7], s37 offen offset:0 sc1 lds
buffer_load_dwordx4 v1, s[4:7], s37 offen offset:1024 sc1 lds
buffer_load_dwordx4 v1, s[4:7], s37 offen offset:2048 sc1 lds
buffer_load_dwordx4 v1, s[4:7], s37 offen offset:3072 sc1 lds
s_add_u32 s37, s53, 12288
s_add_u32 m0, s50, 12288
s_nop 0
buffer_load_dwordx4 v1, s[4:7], s37 offen offset:0 sc1 lds
buffer_load_dwordx4 v1, s[4:7], s37 offen offset:1024 sc1 lds
buffer_load_dwordx4 v1, s[4:7], s37 offen offset:2048 sc1 lds
buffer_load_dwordx4 v1, s[4:7], s37 offen offset:3072 sc1 lds
s_branch L_w_b
L_w_ready:
s_add_u32 s37, s52, 0
s_min_u32 s37, s37, 17
s_lshl_b32 s37, s37, 10
s_add_u32 s37, s37, s54
buffer_load_dwordx4 v[40:43], v1, s[4:7], s37 offen sc1
s_add_u32 s37, s52, 1
s_min_u32 s37, s37, 17
s_lshl_b32 s37, s37, 10
s_add_u32 s37, s37, s54
buffer_load_dwordx4 v[44:47], v1, s[4:7], s37 offen sc1
s_add_u32 s37, s52, 2
s_min_u32 s37, s37, 17
s_lshl_b32 s37, s37, 10
s_add_u32 s37, s37, s54
buffer_load_dwordx4 v[48:51], v1, s[4:7], s37 offen sc1
s_add_u32 s37, s52, 3
s_min_u32 s37, s37, 17
s_lshl_b32 s37, s37, 10
s_add_u32 s37, s37, s54
buffer_load_dwordx4 v[52:55], v1, s[4:7], s37 offen sc1
s_add_u32 s37, s52, 4
s_min_u32 s37, s37, 17
s_lshl_b32 s37, s37, 10
s_add_u32 s37, s37, s54
buffer_load_dwordx4 v[56:59], v1, s[4:7], s37 offen sc1
buffer_load_dword v4, v10, s[4:7], s56 offen sc1
s_add_u32 s37, s53, 0
s_add_u32 m0, s50, 0
s_nop 0
buffer_load_dwordx4 v1, s[4:7], s37 offen offset:0 sc1 lds
buffer_load_dwordx4 v1, s[4:7], s37 offen offset:1024 sc1 lds
buffer_load_dwordx4 v1, s[4:7], s37 offen offset:2048 sc1 lds
buffer_load_dwordx4 v1, s[4:7], s37 offen offset:3072 sc1 lds
s_add_u32 s37, s53, 4096
s_add_u32 m0, s50, 4096
s_nop 0
buffer_load_dwordx4 v1, s[4:7], s37 offen offset:0 sc1 lds
buffer_load_dwordx4 v1, s[4:7], s37 offen offset:1024 sc1 lds
buffer_load_dwordx4 v1, s[4:7], s37 offen offset:2048 sc1 lds
buffer_load_dwordx4 v1, s[4:7], s37 offen offset:3072 sc1 lds
s_add_u32 s37, s53, 8192
s_add_u32 m0, s50, 8192
s_nop 0
buffer_load_dwordx4 v1, s[4:7], s37 offen offset:0 sc1 lds
buffer_load_dwordx4 v1, s[4:7], s37 offen offset:1024 sc1 lds
buffer_load_dwordx4 v1, s[4:7], s37 offen offset:2048 sc1 lds
buffer_load_dwordx4 v1, s[4:7], s37 offen offset:3072 sc1 lds
s_add_u32 s37, s53, 12288
s_add_u32 m0, s50, 12288
s_nop 0
buffer_load_dwordx4 v1, s[4:7], s37 offen offset:0 sc1 lds
buffer_load_dwordx4 v1, s[4:7], s37 offen offset:1024 sc1 lds
buffer_load_dwordx4 v1, s[4:7], s37 offen offset:2048 sc1 lds
buffer_load_dwordx4 v1, s[4:7], s37 offen offset:3072 sc1 lds
s_waitcnt lgkmcnt(0)
s_barrier
ds_read_b128 v[16:19], v14 offset:0
ds_read_b128 v[20:23], v14 offset:3072
ds_read_b128 v[24:27], v14 offset:6144
ds_read_b128 v[28:31], v14 offset:9216
s_waitcnt lgkmcnt(0)
v_pk_add_f32 v[16:17], v[16:17], v[20:21]
v_pk_add_f32 v[18:19], v[18:19], v[22:23]
v_pk_add_f32 v[24:25], v[24:25], v[28:29]
v_pk_add_f32 v[26:27], v[26:27], v[30:31]
v_pk_add_f32 v[16:17], v[16:17], v[24:25]
v_pk_add_f32 v[18:19], v[18:19], v[26:27]
v_cvt_pk_bf16_f32 v60, v16, v17
v_cvt_pk_bf16_f32 v61, v18, v19
v_xor_b32 v14, 16384, v14
buffer_store_dwordx2 v[60:61], v15, s[28:31], s59 offen
s_waitcnt vmcnt(22)
v_mfma_f32_16x16x32_bf16 v[28:31], v[68:71], v[40:43], 0
v_mfma_f32_16x16x32_bf16 v[32:35], v[72:75], v[40:43], 0
v_mfma_f32_16x16x32_bf16 v[36:39], v[76:79], v[40:43], 0
s_waitcnt vmcnt(21)
v_mfma_f32_16x16x32_bf16 v[28:31], v[80:83], v[44:47], v[28:31]
v_mfma_f32_16x16x32_bf16 v[32:35], v[84:87], v[44:47], v[32:35]
v_mfma_f32_16x16x32_bf16 v[36:39], v[88:91], v[44:47], v[36:39]
s_waitcnt vmcnt(20)
v_mfma_f32_16x16x32_bf16 v[28:31], v[92:95], v[48:51], v[28:31]
v_mfma_f32_16x16x32_bf16 v[32:35], v[96:99], v[48:51], v[32:35]
v_mfma_f32_16x16x32_bf16 v[36:39], v[100:103], v[48:51], v[36:39]
s_waitcnt vmcnt(19)
v_mfma_f32_16x16x32_bf16 v[28:31], v[104:107], v[52:55], v[28:31]
v_mfma_f32_16x16x32_bf16 v[32:35], v[108:111], v[52:55], v[32:35]
v_mfma_f32_16x16x32_bf16 v[36:39], v[112:115], v[52:55], v[36:39]
s_waitcnt vmcnt(18)
v_mfma_f32_16x16x32_bf16 v[28:31], v[116:119], v[56:59], v[28:31]
v_mfma_f32_16x16x32_bf16 v[32:35], v[120:123], v[56:59], v[32:35]
v_mfma_f32_16x16x32_bf16 v[36:39], v[124:127], v[56:59], v[36:39]
L_w_b:
s_waitcnt vmcnt(15)
ds_read_b128 v[40:43], v7 offset:0
s_waitcnt vmcnt(14)
ds_read_b128 v[44:47], v7 offset:1024
s_add_u32 s37, s53, 16384
s_add_u32 m0, s50, 16384
s_nop 0
buffer_load_dwordx4 v1, s[4:7], s37 offen offset:0 sc1 lds
s_waitcnt vmcnt(14)
ds_read_b128 v[48:51], v7 offset:2048
s_waitcnt lgkmcnt(2)
v_mfma_f32_16x16x32_bf16 v[16:19], v[128:131], v[40:43], 0
v_mfma_f32_16x16x32_bf16 v[20:23], v[132:135], v[40:43], 0
v_mfma_f32_16x16x32_bf16 v[24:27], v[136:139], v[40:43], 0
buffer_load_dwordx4 v1, s[4:7], s37 offen offset:1024 sc1 lds
s_waitcnt vmcnt(14)
ds_read_b128 v[52:55], v7 offset:3072
s_waitcnt lgkmcnt(2)
v_mfma_f32_16x16x32_bf16 v[16:19], v[140:143], v[44:47], v[16:19]
v_mfma_f32_16x16x32_bf16 v[20:23], v[144:147], v[44:47], v[20:23]
v_mfma_f32_16x16x32_bf16 v[24:27], v[148:151], v[44:47], v[24:27]
buffer_load_dwordx4 v1, s[4:7], s37 offen offset:2048 sc1 lds
s_waitcnt vmcnt(14)
ds_read_b128 v[40:43], v7 offset:4096
s_waitcnt lgkmcnt(2)
v_mfma_f32_16x16x32_bf16 v[16:19], v[152:155], v[48:51], v[16:19]
v_mfma_f32_16x16x32_bf16 v[20:23], v[156:159], v[48:51], v[20:23]
v_mfma_f32_16x16x32_bf16 v[24:27], v[160:163], v[48:51], v[24:27]
buffer_load_dwordx4 v1, s[4:7], s37 offen offset:3072 sc1 lds
s_waitcnt vmcnt(14)
ds_read_b128 v[44:47], v7 offset:5120
s_waitcnt lgkmcnt(2)
v_mfma_f32_16x16x32_bf16 v[16:19], v[164:167], v[52:55], v[16:19]
v_mfma_f32_16x16x32_bf16 v[20:23], v[168:171], v[52:55], v[20:23]
v_mfma_f32_16x16x32_bf16 v[24:27], v[172:175], v[52:55], v[24:27]
s_add_u32 s37, s53, 20480
s_add_u32 m0, s50, 20480
s_nop 0
buffer_load_dwordx4 v1, s[4:7], s37 offen offset:0 sc1 lds
s_waitcnt vmcnt(14)
ds_read_b128 v[48:51], v7 offset:6144
s_waitcnt lgkmcnt(2)
v_mfma_f32_16x16x32_bf16 v[16:19], v[176:179], v[40:43], v[16:19]
v_mfma_f32_16x16x32_bf16 v[20:23], v[180:183], v[40:43], v[20:23]
v_mfma_f32_16x16x32_bf16 v[24:27], v[184:187], v[40:43], v[24:27]
buffer_load_dwordx4 v1, s[4:7], s37 offen offset:1024 sc1 lds
s_waitcnt vmcnt(14)
ds_read_b128 v[52:55], v7 offset:7168
s_waitcnt lgkmcnt(2)
v_mfma_f32_16x16x32_bf16 v[16:19], v[188:191], v[44:47], v[16:19]
v_mfma_f32_16x16x32_bf16 v[20:23], v[192:195], v[44:47], v[20:23]
v_mfma_f32_16x16x32_bf16 v[24:27], v[196:199], v[44:47], v[24:27]
buffer_load_dwordx4 v1, s[4:7], s37 offen offset:2048 sc1 lds
s_waitcnt vmcnt(14)
ds_read_b128 v[40:43], v7 offset:8192
s_waitcnt lgkmcnt(2)
v_mfma_f32_16x16x32_bf16 v[16:19], v[200:203], v[48:51], v[16:19]
v_mfma_f32_16x16x32_bf16 v[20:23], v[204:207], v[48:51], v[20:23]
v_mfma_f32_16x16x32_bf16 v[24:27], v[208:211], v[48:51], v[24:27]
buffer_load_dwordx4 v1, s[4:7], s37 offen offset:3072 sc1 lds
s_waitcnt vmcnt(14)
ds_read_b128 v[44:47], v7 offset:9216
s_waitcnt lgkmcnt(2)
v_mfma_f32_16x16x32_bf16 v[16:19], v[212:215], v[52:55], v[16:19]
v_mfma_f32_16x16x32_bf16 v[20:23], v[216:219], v[52:55], v[20:23]
v_mfma_f32_16x16x32_bf16 v[24:27], v[220:223], v[52:55], v[24:27]
s_add_u32 s37, s53, 24576
s_add_u32 m0, s50, 24576
s_nop 0
buffer_load_dwordx4 v1, s[4:7], s37 offen offset:0 sc1 lds
s_waitcnt vmcnt(14)
ds_read_b128 v[48:51], v7 offset:10240
s_waitcnt lgkmcnt(2)
v_mfma_f32_16x16x32_bf16 v[16:19], v[224:227], v[40:43], v[16:19]
v_mfma_f32_16x16x32_bf16 v[20:23], v[228:231], v[40:43], v[20:23]
v_mfma_f32_16x16x32_bf16 v[24:27], v[232:235], v[40:43], v[24:27]
buffer_load_dwordx4 v1, s[4:7], s37 offen offset:1024 sc1 lds
s_waitcnt vmcnt(14)
ds_read_b128 v[52:55], v7 offset:11264
s_waitcnt lgkmcnt(2)
v_mfma_f32_16x16x32_bf16 v[16:19], v[236:239], v[44:47], v[16:19]
v_mfma_f32_16x16x32_bf16 v[20:23], v[240:243], v[44:47], v[20:23]
v_mfma_f32_16x16x32_bf16 v[24:27], v[244:247], v[44:47], v[24:27]
buffer_load_dwordx4 v1, s[4:7], s37 offen offset:2048 sc1 lds
s_waitcnt vmcnt(14)
ds_read_b128 v[40:43], v7 offset:12288
s_waitcnt lgkmcnt(2)
v_mfma_f32_16x16x32_bf16 v[16:19], v[248:251], v[48:51], v[16:19]
v_mfma_f32_16x16x32_bf16 v[20:23], v[252:255], v[48:51], v[20:23]
v_mfma_f32_16x16x32_bf16 v[24:27], a[0:3], v[48:51], v[24:27]
buffer_load_dwordx4 v1, s[4:7], s37 offen offset:3072 sc1 lds
s_waitcnt vmcnt(14)
ds_read_b128 v[44:47], v7 offset:13312
s_waitcnt lgkmcnt(2)
v_mfma_f32_16x16x32_bf16 v[16:19], a[4:7], v[52:55], v[16:19]
v_mfma_f32_16x16x32_bf16 v[20:23], a[8:11], v[52:55], v[20:23]
v_mfma_f32_16x16x32_bf16 v[24:27], a[12:15], v[52:55], v[24:27]
s_add_u32 s37, s53, 28672
s_add_u32 m0, s50, 28672
s_nop 0
buffer_load_dwordx4 v1, s[4:7], s37 offen offset:0 sc1 lds
s_waitcnt vmcnt(14)
ds_read_b128 v[48:51], v7 offset:14336
s_waitcnt lgkmcnt(2)
v_mfma_f32_16x16x32_bf16 v[16:19], a[16:19], v[40:43], v[16:19]
v_mfma_f32_16x16x32_bf16 v[20:23], a[20:23], v[40:43], v[20:23]
v_mfma_f32_16x16x32_bf16 v[24:27], a[24:27], v[40:43], v[24:27]
buffer_load_dwordx4 v1, s[4:7], s37 offen offset:1024 sc1 lds
s_waitcnt vmcnt(14)
ds_read_b128 v[52:55], v7 offset:15360
s_waitcnt lgkmcnt(2)
v_mfma_f32_16x16x32_bf16 v[16:19], a[28:31], v[44:47], v[16:19]
v_mfma_f32_16x16x32_bf16 v[20:23], a[32:35], v[44:47], v[20:23]
v_mfma_f32_16x16x32_bf16 v[24:27], a[36:39], v[44:47], v[24:27]
buffer_load_dwordx4 v1, s[4:7], s37 offen offset:2048 sc1 lds
s_waitcnt vmcnt(14)
ds_read_b128 v[40:43], v7 offset:16384
s_waitcnt lgkmcnt(2)
v_mfma_f32_16x16x32_bf16 v[16:19], a[40:43], v[48:51], v[16:19]
v_mfma_f32_16x16x32_bf16 v[20:23], a[44:47], v[48:51], v[20:23]
v_mfma_f32_16x16x32_bf16 v[24:27], a[48:51], v[48:51], v[24:27]
buffer_load_dwordx4 v1, s[4:7], s37 offen offset:3072 sc1 lds
s_add_u32 s38, s48, 5
s_and_b32 s57, s38, 7
s_lshl_b32 s57, s57, 10
s_add_u32 s57, s57, 331776
s_lshr_b32 s35, s38, 3
buffer_load_dword v3, v9, s[4:7], s57 offen sc0 sc1
s_waitcnt vmcnt(15)
ds_read_b128 v[44:47], v7 offset:17408
s_waitcnt lgkmcnt(2)
v_mfma_f32_16x16x32_bf16 v[16:19], a[52:55], v[52:55], v[16:19]
v_mfma_f32_16x16x32_bf16 v[20:23], a[56:59], v[52:55], v[20:23]
v_mfma_f32_16x16x32_bf16 v[24:27], a[60:63], v[52:55], v[24:27]
s_waitcnt vmcnt(14)
ds_read_b128 v[48:51], v7 offset:18432
s_waitcnt lgkmcnt(2)
v_mfma_f32_16x16x32_bf16 v[16:19], a[64:67], v[40:43], v[16:19]
v_mfma_f32_16x16x32_bf16 v[20:23], a[68:71], v[40:43], v[20:23]
v_mfma_f32_16x16x32_bf16 v[24:27], a[72:75], v[40:43], v[24:27]
s_waitcnt vmcnt(13)
ds_read_b128 v[52:55], v7 offset:19456
s_waitcnt lgkmcnt(2)
v_mfma_f32_16x16x32_bf16 v[16:19], a[76:79], v[44:47], v[16:19]
v_mfma_f32_16x16x32_bf16 v[20:23], a[80:83], v[44:47], v[20:23]
v_mfma_f32_16x16x32_bf16 v[24:27], a[84:87], v[44:47], v[24:27]
s_waitcnt vmcnt(12)
ds_read_b128 v[40:43], v7 offset:20480
s_waitcnt lgkmcnt(2)
v_mfma_f32_16x16x32_bf16 v[16:19], a[88:91], v[48:51], v[16:19]
v_mfma_f32_16x16x32_bf16 v[20:23], a[92:95], v[48:51], v[20:23]
v_mfma_f32_16x16x32_bf16 v[24:27], a[96:99], v[48:51], v[24:27]
s_waitcnt vmcnt(11)
ds_read_b128 v[44:47], v7 offset:21504
s_waitcnt lgkmcnt(2)
v_mfma_f32_16x16x32_bf16 v[16:19], a[100:103], v[52:55], v[16:19]
v_mfma_f32_16x16x32_bf16 v[20:23], a[104:107], v[52:55], v[20:23]
v_mfma_f32_16x16x32_bf16 v[24:27], a[108:111], v[52:55], v[24:27]
s_waitcnt vmcnt(10)
ds_read_b128 v[48:51], v7 offset:22528
s_waitcnt lgkmcnt(2)
v_mfma_f32_16x16x32_bf16 v[16:19], a[112:115], v[40:43], v[16:19]
v_mfma_f32_16x16x32_bf16 v[20:23], a[116:119], v[40:43], v[20:23]
v_mfma_f32_16x16x32_bf16 v[24:27], a[120:123], v[40:43], v[24:27]
s_waitcnt vmcnt(9)
ds_read_b128 v[52:55], v7 offset:23552
s_waitcnt lgkmcnt(2)
v_mfma_f32_16x16x32_bf16 v[16:19], a[124:127], v[44:47], v[16:19]
v_mfma_f32_16x16x32_bf16 v[20:23], a[128:131], v[44:47], v[20:23]
v_mfma_f32_16x16x32_bf16 v[24:27], a[132:135], v[44:47], v[24:27]
s_waitcnt vmcnt(8)
ds_read_b128 v[40:43], v7 offset:24576
s_waitcnt lgkmcnt(2)
v_mfma_f32_16x16x32_bf16 v[16:19], a[136:139], v[48:51], v[16:19]
v_mfma_f32_16x16x32_bf16 v[20:23], a[140:143], v[48:51], v[20:23]
v_mfma_f32_16x16x32_bf16 v[24:27], a[144:147], v[48:51], v[24:27]
s_waitcnt vmcnt(7)
ds_read_b128 v[44:47], v7 offset:25600
s_waitcnt lgkmcnt(2)
v_mfma_f32_16x16x32_bf16 v[16:19], a[148:151], v[52:55], v[16:19]
v_mfma_f32_16x16x32_bf16 v[20:23], a[152:155], v[52:55], v[20:23]
v_mfma_f32_16x16x32_bf16 v[24:27], a[156:159], v[52:55], v[24:27]
s_waitcnt vmcnt(6)
ds_read_b128 v[48:51], v7 offset:26624
s_waitcnt lgkmcnt(2)
v_mfma_f32_16x16x32_bf16 v[16:19], a[160:163], v[40:43], v[16:19]
v_mfma_f32_16x16x32_bf16 v[20:23], a[164:167], v[40:43], v[20:23]
v_mfma_f32_16x16x32_bf16 v[24:27], a[168:171], v[40:43], v[24:27]
s_waitcnt vmcnt(5)
ds_read_b128 v[52:55], v7 offset:27648
s_waitcnt lgkmcnt(2)
v_mfma_f32_16x16x32_bf16 v[16:19], a[172:175], v[44:47], v[16:19]
v_mfma_f32_16x16x32_bf16 v[20:23], a[176:179], v[44:47], v[20:23]
v_mfma_f32_16x16x32_bf16 v[24:27], a[180:183], v[44:47], v[24:27]
s_waitcnt vmcnt(4)
ds_read_b128 v[40:43], v7 offset:28672
s_waitcnt lgkmcnt(2)
v_mfma_f32_16x16x32_bf16 v[16:19], a[184:187], v[48:51], v[16:19]
v_mfma_f32_16x16x32_bf16 v[20:23], a[188:191], v[48:51], v[20:23]
v_mfma_f32_16x16x32_bf16 v[24:27], a[192:195], v[48:51], v[24:27]
s_waitcnt vmcnt(3)
ds_read_b128 v[44:47], v7 offset:29696
s_waitcnt lgkmcnt(2)
v_mfma_f32_16x16x32_bf16 v[16:19], a[196:199], v[52:55], v[16:19]
v_mfma_f32_16x16x32_bf16 v[20:23], a[200:203], v[52:55], v[20:23]
v_mfma_f32_16x16x32_bf16 v[24:27], a[204:207], v[52:55], v[24:27]
s_waitcnt vmcnt(2)
ds_read_b128 v[48:51], v7 offset:30720
s_waitcnt lgkmcnt(2)
v_mfma_f32_16x16x32_bf16 v[16:19], a[208:211], v[40:43], v[16:19]
v_mfma_f32_16x16x32_bf16 v[20:23], a[212:215], v[40:43], v[20:23]
v_mfma_f32_16x16x32_bf16 v[24:27], a[216:219], v[40:43], v[24:27]
s_waitcnt vmcnt(1)
ds_read_b128 v[52:55], v7 offset:31744
s_waitcnt lgkmcnt(2)
v_mfma_f32_16x16x32_bf16 v[16:19], a[220:223], v[44:47], v[16:19]
v_mfma_f32_16x16x32_bf16 v[20:23], a[224:227], v[44:47], v[20:23]
v_mfma_f32_16x16x32_bf16 v[24:27], a[228:231], v[44:47], v[24:27]
s_waitcnt lgkmcnt(1)
v_mfma_f32_16x16x32_bf16 v[16:19], a[232:235], v[48:51], v[16:19]
v_mfma_f32_16x16x32_bf16 v[20:23], a[236:239], v[48:51], v[20:23]
v_mfma_f32_16x16x32_bf16 v[24:27], a[240:243], v[48:51], v[24:27]
s_waitcnt lgkmcnt(0)
v_mfma_f32_16x16x32_bf16 v[16:19], a[244:247], v[52:55], v[16:19]
v_mfma_f32_16x16x32_bf16 v[20:23], a[248:251], v[52:55], v[20:23]
v_mfma_f32_16x16x32_bf16 v[24:27], a[252:255], v[52:55], v[24:27]
s_mov_b32 s59, s55
s_add_u32 s55, s55, 92160
s_add_u32 s54, s54, 92160
s_add_u32 s53, s53, 655360
s_add_u32 s56, s56, 320
s_add_u32 s48, s48, 5
v_fma_f32 v16, v16, v4, v28
v_fma_f32 v17, v17, v4, v29
v_fma_f32 v18, v18, v4, v30
v_fma_f32 v19, v19, v4, v31
ds_write_b128 v2, v[16:19] offset:0
v_fma_f32 v20, v20, v4, v32
v_fma_f32 v21, v21, v4, v33
v_fma_f32 v22, v22, v4, v34
v_fma_f32 v23, v23, v4, v35
ds_write_b128 v2, v[20:23] offset:1024
v_fma_f32 v24, v24, v4, v36
v_fma_f32 v25, v25, v4, v37
v_fma_f32 v26, v26, v4, v38
v_fma_f32 v27, v27, v4, v39
ds_write_b128 v2, v[24:27] offset:2048
v_xor_b32 v2, 16384, v2
s_cmp_ge_u32 s48, 128
s_cbranch_scc1 L_w_now
s_waitcnt vmcnt(0)
v_cmp_ge_u32 vcc, s35, v3
s_cbranch_vccz L_w_ready
L_w_now:
s_waitcnt lgkmcnt(0)
s_barrier
ds_read_b128 v[16:19], v14 offset:0
ds_read_b128 v[20:23], v14 offset:3072
ds_read_b128 v[24:27], v14 offset:6144
ds_read_b128 v[28:31], v14 offset:9216
s_waitcnt lgkmcnt(0)
v_pk_add_f32 v[16:17], v[16:17], v[20:21]
v_pk_add_f32 v[18:19], v[18:19], v[22:23]
v_pk_add_f32 v[24:25], v[24:25], v[28:29]
v_pk_add_f32 v[26:27], v[26:27], v[30:31]
v_pk_add_f32 v[16:17], v[16:17], v[24:25]
v_pk_add_f32 v[18:19], v[18:19], v[26:27]
v_cvt_pk_bf16_f32 v60, v16, v17
v_cvt_pk_bf16_f32 v61, v18, v19
v_xor_b32 v14, 16384, v14
buffer_store_dwordx2 v[60:61], v15, s[28:31], s59 offen
s_cmp_lt_u32 s48, 128
s_cbranch_scc1 L_w_wait
s_waitcnt vmcnt(0)
s_endpgm
L_pro_w0:
v_and_b32 v20, 63, v0
v_lshlrev_b32 v1, 4, v20
v_add_u32 v2, 16384, v1
v_and_b32 v23, 1, v22
v_lshl_add_u32 v23, v24, 4, v23
v_mul_u32_u24 v23, 1152, v23
v_lshlrev_b32 v28, 2, v22
v_xor_b32 v28, v28, v21
v_lshl_add_u32 v28, v28, 4, v23
s_mul_i32 s55, s32, 147456
v_lshrrev_b32 v23, 2, v21
v_and_b32 v24, 1, v21
v_lshl_add_u32 v23, v23, 1, v24
v_mul_u32_u24 v23, 1152, v23
v_lshl_add_u32 v23, v22, 5, v23
v_bfe_u32 v24, v21, 1, 1
v_lshl_add_u32 v23, v24, 4, v23
s_lshl_b32 s56, s32, 7
s_waitcnt lgkmcnt(0)
buffer_load_dwordx4 v[12:15], v23, s[24:27], s56 offen
v_and_b32 v23, 1, v22
v_lshrrev_b32 v24, 2, v21
v_lshl_add_u32 v23, v23, 2, v24
v_lshlrev_b32 v23, 1, v23
v_bfe_u32 v44, v21, 1, 1
v_add_u32 v44, 0, v44
v_xor_b32 v44, v44, v23
v_lshlrev_b32 v44, 4, v44
v_lshl_add_u32 v44, v24, 8, v44
v_and_b32 v23, 1, v22
v_lshl_add_u32 v44, v23, 11, v44
v_and_b32 v23, 1, v21
v_lshl_add_u32 v44, v23, 3, v44
v_lshrrev_b32 v23, 1, v22
v_mul_u32_u24 v23, 40960, v23
v_add_u32 v23, 16384, v23
v_add_u32 v44, v44, v23
v_and_b32 v23, 1, v22
v_lshrrev_b32 v24, 2, v21
v_lshl_add_u32 v23, v23, 2, v24
v_lshlrev_b32 v23, 1, v23
v_bfe_u32 v45, v21, 1, 1
v_add_u32 v45, 2, v45
v_xor_b32 v45, v45, v23
v_lshlrev_b32 v45, 4, v45
v_lshl_add_u32 v45, v24, 8, v45
v_and_b32 v23, 1, v22
v_lshl_add_u32 v45, v23, 11, v45
v_and_b32 v23, 1, v21
v_lshl_add_u32 v45, v23, 3, v45
v_lshrrev_b32 v23, 1, v22
v_mul_u32_u24 v23, 40960, v23
v_add_u32 v23, 16384, v23
v_add_u32 v45, v45, v23
v_and_b32 v23, 1, v22
v_lshrrev_b32 v24, 2, v21
v_lshl_add_u32 v23, v23, 2, v24
v_lshlrev_b32 v23, 1, v23
v_bfe_u32 v46, v21, 1, 1
v_add_u32 v46, 0, v46
v_xor_b32 v46, v46, v23
v_lshlrev_b32 v46, 4, v46
v_lshl_add_u32 v46, v24, 8, v46
v_and_b32 v23, 1, v22
v_lshl_add_u32 v46, v23, 11, v46
v_and_b32 v23, 1, v21
v_lshl_add_u32 v46, v23, 3, v46
v_lshrrev_b32 v23, 1, v22
v_mul_u32_u24 v23, 32768, v23
v_add_u32 v23, 98304, v23
v_add_u32 v46, v46, v23
v_and_b32 v23, 1, v22
v_lshrrev_b32 v24, 2, v21
v_lshl_add_u32 v23, v23, 2, v24
v_lshlrev_b32 v23, 1, v23
v_bfe_u32 v47, v21, 1, 1
v_add_u32 v47, 2, v47
v_xor_b32 v47, v47, v23
v_lshlrev_b32 v47, 4, v47
v_lshl_add_u32 v47, v24, 8, v47
v_and_b32 v23, 1, v22
v_lshl_add_u32 v47, v23, 11, v47
v_and_b32 v23, 1, v21
v_lshl_add_u32 v47, v23, 3, v47
v_lshrrev_b32 v23, 1, v22
v_mul_u32_u24 v23, 32768, v23
v_add_u32 v23, 98304, v23
v_add_u32 v47, v47, v23
v_and_b32 v23, 1, v22
v_bfe_u32 v24, v21, 2, 1
v_lshl_add_u32 v23, v23, 1, v24
v_xor_b32 v24, 0, v23
v_lshlrev_b32 v24, 6, v24
v_lshl_add_u32 v48, v23, 8, v24
v_and_b32 v23, 3, v21
v_lshl_add_u32 v48, v23, 4, v48
v_and_b32 v23, 8, v21
v_add_u32 v48, v48, v23
v_lshrrev_b32 v23, 1, v22
v_mul_u32_u24 v23, 40960, v23
v_add_u32 v23, 16384, v23
v_add_u32 v48, v48, v23
v_and_b32 v23, 1, v22
v_bfe_u32 v24, v21, 2, 1
v_lshl_add_u32 v23, v23, 1, v24
v_xor_b32 v24, 0, v23
v_lshlrev_b32 v24, 6, v24
v_lshl_add_u32 v49, v23, 8, v24
v_and_b32 v23, 3, v21
v_lshl_add_u32 v49, v23, 4, v49
v_and_b32 v23, 8, v21
v_add_u32 v49, v49, v23
v_lshrrev_b32 v23, 1, v22
v_mul_u32_u24 v23, 32768, v23
v_add_u32 v23, 98304, v23
v_add_u32 v49, v49, v23
v_bfe_u32 v23, v21, 1, 1
v_mul_u32_u24 v23, 0xaaaa, v23
v_add_u32 v0, 0x4444, v23
v_lshlrev_b32 v3, 3, v20
v_lshrrev_b32 v25, 5, v20
v_lshlrev_b32 v25, 6, v25
v_xor_b32 v3, v3, v25
v_lshrrev_b32 v25, 2, v20
v_and_b32 v4, 3, v21
v_lshl_add_u32 v4, v4, 4, v25
v_lshlrev_b32 v4, 3, v4
v_bfe_u32 v25, v21, 1, 1
v_lshlrev_b32 v23, 6, v25
v_xor_b32 v4, v4, v23
v_lshlrev_b32 v5, 4, v21
v_lshl_add_u32 v5, v22, 2, v5
v_mul_u32_u24 v23, 1024, v25
v_add_u32 v5, v5, v23
v_lshlrev_b32 v9, 8, v22
v_lshl_add_u32 v9, v25, 6, v9
v_bfe_u32 v23, v21, 3, 1
v_lshl_add_u32 v9, v23, 7, v9
v_bfe_u32 v23, v21, 2, 1
v_lshl_add_u32 v9, v23, 5, v9
v_and_b32 v23, 1, v21
v_lshl_add_u32 v9, v23, 4, v9
v_lshrrev_b32 v23, 1, v22
v_and_b32 v24, 1, v22
v_and_b32 v25, 7, v21
v_lshrrev_b32 v7, 3, v21
v_lshl_add_u32 v8, v7, 1, v23
v_lshlrev_b32 v8, 12, v8
v_lshl_add_u32 v8, v24, 7, v8
v_and_b32 v25, 4, v21
v_lshl_add_u32 v8, v25, 3, v8
v_and_b32 v25, 1, v21
v_lshl_add_u32 v8, v25, 4, v8
v_bfe_u32 v25, v21, 1, 1
v_lshl_add_u32 v8, v25, 3, v8
s_lshr_b32 s56, s32, 1
s_lshl_b32 s56, s56, 8
s_and_b32 s57, s32, 1
s_lshl_b32 s57, s57, 6
s_add_u32 s56, s56, s57
s_add_u32 s56, s56, 0
v_add_u32 v8, s56, v8
v_and_b32 v7, 0x3d0, v1
s_mov_b32 s42, 0
s_mov_b32 s43, 65536
s_mov_b32 s44, 131072
s_mov_b32 s45, 196608
s_mov_b32 s46, 262144
s_mov_b32 s47, 294912
s_mov_b32 s48, 299008
s_mov_b32 s49, 303104
s_mov_b32 s50, 0x3e0293ee
s_mov_b32 s51, 0x3e0293ee
s_mov_b32 s52, 0x3f803f80
s_mov_b32 s53, 0x3f803f80
v_lshlrev_b32 v11, 2, v21
s_mov_b32 s34, 0
s_mov_b32 s35, -1
s_mov_b32 s36, 0
s_mov_b32 s41, 300000
s_lshl_b32 s37, s32, 14
s_add_u32 s39, s37, 17301504
s_add_u32 s37, s37, 16777216
s_mov_b32 s40, 8749056
v_mov_b64 v[36:37], 0
v_mov_b64 v[38:39], 0
ds_write_b128 v1, v[36:39] offset:14336
s_lshl_b32 s56, s32, 1
s_add_u32 s56, s56, 0
s_cmp_eq_u32 s56, 0
s_cselect_b32 s56, 64, s56
s_mul_i32 s56, s56, 10240
s_add_u32 s56, s56, 8388608
s_add_u32 s57, s56, 4096
v_mov_b32 v40, 0
v_mov_b32 v41, 0
v_mov_b32 v42, 0
v_mov_b32 v43, 0
buffer_store_dwordx4 v[40:43], v1, s[4:7], s56 offen offset:0 sc0 sc1
buffer_store_dwordx4 v[40:43], v1, s[4:7], s56 offen offset:1024 sc0 sc1
buffer_store_dwordx4 v[40:43], v1, s[4:7], s56 offen offset:2048 sc0 sc1
buffer_store_dwordx4 v[40:43], v1, s[4:7], s56 offen offset:3072 sc0 sc1
s_lshl_b32 s56, s32, 10
s_cmp_ge_u32 s32, 9
s_cselect_b32 s56, 268435456, s56
s_add_u32 s57, s56, 8388608
s_add_u32 s56, s56, 294912
s_waitcnt vmcnt(4)
v_or_b32 v12, 1, v12
buffer_store_dwordx4 v[12:15], v1, s[4:7], s56 offen sc0 sc1
buffer_store_dwordx4 v[12:15], v1, s[4:7], s57 offen sc0 sc1
s_getreg_b32 s56, hwreg(HW_REG_XCC_ID)
s_and_b32 s56, s56, 15
s_mul_i32 s57, s56, s56
s_lshl_b32 s57, s57, 18
s_lshl_b32 s56, s56, 8
s_add_u32 s57, s57, s56
s_add_u32 s58, s57, 1
s_lshl_b32 s101, s32, 7
s_add_u32 s101, s101, 327680
v_mov_b32 v24, 0
s_add_u32 s56, s54, 0
s_mov_b32 m0, 28672
s_nop 0
buffer_load_dwordx4 v26, s[12:15], s56 offen lds
s_add_u32 s56, s54, 16384
s_mov_b32 m0, 29696
s_nop 0
buffer_load_dwordx4 v26, s[12:15], s56 offen lds
s_add_u32 s56, s54, 32768
s_mov_b32 m0, 30720
s_nop 0
buffer_load_dwordx4 v27, s[12:15], s56 offen lds
s_add_u32 s56, s54, 49152
s_mov_b32 m0, 31744
s_nop 0
buffer_load_dwordx4 v27, s[12:15], s56 offen lds
s_add_u32 s56, s54, 524288
s_mov_b32 m0, 32768
s_nop 0
buffer_load_dwordx4 v26, s[12:15], s56 offen lds
s_add_u32 s56, s54, 540672
s_mov_b32 m0, 33792
s_nop 0
buffer_load_dwordx4 v26, s[12:15], s56 offen lds
s_add_u32 s56, s54, 557056
s_mov_b32 m0, 34816
s_nop 0
buffer_load_dwordx4 v27, s[12:15], s56 offen lds
s_add_u32 s56, s54, 573440
s_mov_b32 m0, 35840
s_nop 0
buffer_load_dwordx4 v27, s[12:15], s56 offen lds
v_and_b32 v23, 3, v20
v_lshrrev_b32 v24, 2, v20
v_mul_u32_u24 v29, 1152, v24
v_lshl_add_u32 v29, v23, 4, v29
v_lshrrev_b32 v24, 2, v21
v_and_b32 v25, 1, v22
v_lshlrev_b32 v31, 10, v25
v_lshrrev_b32 v25, 1, v22
v_lshl_add_u32 v31, v25, 8, v31
v_and_b32 v25, 1, v24
v_lshl_add_u32 v31, v25, 6, v31
v_lshrrev_b32 v25, 1, v24
v_lshl_add_u32 v31, v25, 3, v31
v_lshl_add_u32 v31, v23, 4, v31
v_add_u32 v31, 16384, v31
s_add_u32 s56, s55, 1024
s_mov_b32 m0, 49152
s_nop 0
buffer_load_dwordx4 v29, s[20:23], s56 offen lds
s_add_u32 s56, s55, 19456
s_mov_b32 m0, 50176
s_nop 0
buffer_load_dwordx4 v29, s[20:23], s56 offen lds
s_add_u32 s56, s55, 37888
s_mov_b32 m0, 51200
s_nop 0
buffer_load_dwordx4 v29, s[20:23], s56 offen lds
s_add_u32 s56, s55, 56320
s_mov_b32 m0, 52224
s_nop 0
buffer_load_dwordx4 v29, s[20:23], s56 offen lds
s_add_u32 s56, s55, 74752
s_mov_b32 m0, 53248
s_nop 0
buffer_load_dwordx4 v29, s[20:23], s56 offen lds
s_add_u32 s56, s55, 93184
s_mov_b32 m0, 54272
s_nop 0
buffer_load_dwordx4 v29, s[20:23], s56 offen lds
s_add_u32 s56, s55, 111616
s_mov_b32 m0, 55296
s_nop 0
buffer_load_dwordx4 v29, s[20:23], s56 offen lds
s_add_u32 s56, s55, 130048
s_mov_b32 m0, 56320
s_nop 0
buffer_load_dwordx4 v29, s[20:23], s56 offen lds
v_mov_b32 v24, 0
s_barrier
ds_read_b64_tr_b16 v[80:81], v44 offset:20480
ds_read_b64_tr_b16 v[82:83], v44 offset:21504
ds_read_b64_tr_b16 v[84:85], v46 offset:20480
ds_read_b64_tr_b16 v[86:87], v46 offset:21504
ds_read_b64_tr_b16 v[88:89], v45 offset:20480
ds_read_b64_tr_b16 v[90:91], v45 offset:21504
ds_read_b64_tr_b16 v[92:93], v47 offset:20480
ds_read_b64_tr_b16 v[94:95], v47 offset:21504
s_waitcnt lgkmcnt(0)
s_barrier
s_add_u32 s56, s54, 1048576
s_mov_b32 m0, 36864
s_nop 0
buffer_load_dwordx4 v26, s[12:15], s56 offen lds
s_add_u32 s56, s54, 1064960
s_mov_b32 m0, 37888
s_nop 0
buffer_load_dwordx4 v26, s[12:15], s56 offen lds
s_add_u32 s56, s54, 1081344
s_mov_b32 m0, 38912
s_nop 0
buffer_load_dwordx4 v27, s[12:15], s56 offen lds
s_add_u32 s56, s54, 1097728
s_mov_b32 m0, 39936
s_nop 0
buffer_load_dwordx4 v27, s[12:15], s56 offen lds
ds_read_b64_tr_b16 v[96:97], v44 offset:24576
ds_read_b64_tr_b16 v[98:99], v44 offset:25600
ds_read_b64_tr_b16 v[100:101], v46 offset:24576
ds_read_b64_tr_b16 v[102:103], v46 offset:25600
ds_read_b64_tr_b16 v[104:105], v45 offset:24576
ds_read_b64_tr_b16 v[106:107], v45 offset:25600
ds_read_b64_tr_b16 v[108:109], v47 offset:24576
ds_read_b64_tr_b16 v[110:111], v47 offset:25600
s_waitcnt lgkmcnt(0)
s_barrier
s_add_u32 s56, s54, 1572864
s_mov_b32 m0, 40960
s_nop 0
buffer_load_dwordx4 v26, s[12:15], s56 offen lds
s_add_u32 s56, s54, 1589248
s_mov_b32 m0, 41984
s_nop 0
buffer_load_dwordx4 v26, s[12:15], s56 offen lds
s_add_u32 s56, s54, 1605632
s_mov_b32 m0, 43008
s_nop 0
buffer_load_dwordx4 v27, s[12:15], s56 offen lds
s_add_u32 s56, s54, 1622016
s_mov_b32 m0, 44032
s_nop 0
buffer_load_dwordx4 v27, s[12:15], s56 offen lds
ds_read_b64_tr_b16 v[112:113], v44 offset:28672
ds_read_b64_tr_b16 v[114:115], v44 offset:29696
ds_read_b64_tr_b16 v[116:117], v46 offset:28672
ds_read_b64_tr_b16 v[118:119], v46 offset:29696
ds_read_b64_tr_b16 v[120:121], v45 offset:28672
ds_read_b64_tr_b16 v[122:123], v45 offset:29696
ds_read_b64_tr_b16 v[124:125], v47 offset:28672
ds_read_b64_tr_b16 v[126:127], v47 offset:29696
s_waitcnt lgkmcnt(0)
s_barrier
s_add_u32 s56, s54, 2097152
s_mov_b32 m0, 45056
s_nop 0
buffer_load_dwordx4 v26, s[12:15], s56 offen lds
s_add_u32 s56, s54, 2113536
s_mov_b32 m0, 46080
s_nop 0
buffer_load_dwordx4 v26, s[12:15], s56 offen lds
s_add_u32 s56, s54, 2129920
s_mov_b32 m0, 47104
s_nop 0
buffer_load_dwordx4 v27, s[12:15], s56 offen lds
s_add_u32 s56, s54, 2146304
s_mov_b32 m0, 48128
s_nop 0
buffer_load_dwordx4 v27, s[12:15], s56 offen lds
ds_read_b64_tr_b16 v[128:129], v44 offset:0
ds_read_b64_tr_b16 v[130:131], v44 offset:1024
ds_read_b64_tr_b16 v[132:133], v46 offset:0
ds_read_b64_tr_b16 v[134:135], v46 offset:1024
ds_read_b64_tr_b16 v[136:137], v45 offset:0
ds_read_b64_tr_b16 v[138:139], v45 offset:1024
ds_read_b64_tr_b16 v[140:141], v47 offset:0
ds_read_b64_tr_b16 v[142:143], v47 offset:1024
s_waitcnt lgkmcnt(0)
s_barrier
s_add_u32 s56, s54, 3145728
s_mov_b32 m0, 16384
s_nop 0
buffer_load_dwordx4 v26, s[12:15], s56 offen lds
s_add_u32 s56, s54, 3162112
s_mov_b32 m0, 17408
s_nop 0
buffer_load_dwordx4 v26, s[12:15], s56 offen lds
s_add_u32 s56, s54, 3178496
s_mov_b32 m0, 18432
s_nop 0
buffer_load_dwordx4 v27, s[12:15], s56 offen lds
s_add_u32 s56, s54, 3194880
s_mov_b32 m0, 19456
s_nop 0
buffer_load_dwordx4 v27, s[12:15], s56 offen lds
ds_read_b64_tr_b16 v[144:145], v44 offset:4096
ds_read_b64_tr_b16 v[146:147], v44 offset:5120
ds_read_b64_tr_b16 v[148:149], v46 offset:4096
ds_read_b64_tr_b16 v[150:151], v46 offset:5120
ds_read_b64_tr_b16 v[152:153], v45 offset:4096
ds_read_b64_tr_b16 v[154:155], v45 offset:5120
ds_read_b64_tr_b16 v[156:157], v47 offset:4096
ds_read_b64_tr_b16 v[158:159], v47 offset:5120
s_waitcnt lgkmcnt(0)
s_barrier
s_add_u32 s56, s54, 3670016
s_mov_b32 m0, 20480
s_nop 0
buffer_load_dwordx4 v26, s[12:15], s56 offen lds
s_add_u32 s56, s54, 3686400
s_mov_b32 m0, 21504
s_nop 0
buffer_load_dwordx4 v26, s[12:15], s56 offen lds
s_add_u32 s56, s54, 3702784
s_mov_b32 m0, 22528
s_nop 0
buffer_load_dwordx4 v27, s[12:15], s56 offen lds
s_add_u32 s56, s54, 3719168
s_mov_b32 m0, 23552
s_nop 0
buffer_load_dwordx4 v27, s[12:15], s56 offen lds
ds_read_b64_tr_b16 v[160:161], v44 offset:8192
ds_read_b64_tr_b16 v[162:163], v44 offset:9216
ds_read_b64_tr_b16 v[164:165], v46 offset:8192
ds_read_b64_tr_b16 v[166:167], v46 offset:9216
ds_read_b64_tr_b16 v[168:169], v45 offset:8192
ds_read_b64_tr_b16 v[170:171], v45 offset:9216
ds_read_b64_tr_b16 v[172:173], v47 offset:8192
ds_read_b64_tr_b16 v[174:175], v47 offset:9216
s_waitcnt lgkmcnt(0)
s_waitcnt vmcnt(32)
s_barrier
s_add_u32 s56, s54, 4194304
s_mov_b32 m0, 24576
s_nop 0
buffer_load_dwordx4 v26, s[12:15], s56 offen lds
s_add_u32 s56, s54, 4210688
s_mov_b32 m0, 25600
s_nop 0
buffer_load_dwordx4 v26, s[12:15], s56 offen lds
s_add_u32 s56, s54, 4227072
s_mov_b32 m0, 26624
s_nop 0
buffer_load_dwordx4 v27, s[12:15], s56 offen lds
s_add_u32 s56, s54, 4243456
s_mov_b32 m0, 27648
s_nop 0
buffer_load_dwordx4 v27, s[12:15], s56 offen lds
ds_read_b64_tr_b16 v[176:177], v44 offset:12288
ds_read_b64_tr_b16 v[178:179], v44 offset:13312
ds_read_b64_tr_b16 v[180:181], v46 offset:12288
ds_read_b64_tr_b16 v[182:183], v46 offset:13312
ds_read_b64_tr_b16 v[184:185], v45 offset:12288
ds_read_b64_tr_b16 v[186:187], v45 offset:13312
ds_read_b64_tr_b16 v[188:189], v47 offset:12288
ds_read_b64_tr_b16 v[190:191], v47 offset:13312
v_mov_b32 v23, s58
s_mov_b64 exec, 1
buffer_atomic_add v23, v24, s[28:31], 0 offen sc1
s_mov_b64 exec, -1
s_waitcnt lgkmcnt(0)
s_waitcnt vmcnt(33)
s_barrier
s_add_u32 s56, s54, 0
s_mov_b32 m0, 28672
s_nop 0
buffer_load_dwordx4 v26, s[16:19], s56 offen lds
s_add_u32 s56, s54, 16384
s_mov_b32 m0, 29696
s_nop 0
buffer_load_dwordx4 v26, s[16:19], s56 offen lds
s_add_u32 s56, s54, 32768
s_mov_b32 m0, 30720
s_nop 0
buffer_load_dwordx4 v27, s[16:19], s56 offen lds
s_add_u32 s56, s54, 49152
s_mov_b32 m0, 31744
s_nop 0
buffer_load_dwordx4 v27, s[16:19], s56 offen lds
ds_read_b64_tr_b16 v[192:193], v44 offset:16384
ds_read_b64_tr_b16 v[194:195], v44 offset:17408
ds_read_b64_tr_b16 v[196:197], v46 offset:16384
ds_read_b64_tr_b16 v[198:199], v46 offset:17408
ds_read_b64_tr_b16 v[200:201], v45 offset:16384
ds_read_b64_tr_b16 v[202:203], v45 offset:17408
ds_read_b64_tr_b16 v[204:205], v47 offset:16384
ds_read_b64_tr_b16 v[206:207], v47 offset:17408
s_waitcnt lgkmcnt(0)
s_waitcnt vmcnt(25)
s_barrier
s_add_u32 s56, s54, 524288
s_mov_b32 m0, 32768
s_nop 0
buffer_load_dwordx4 v26, s[16:19], s56 offen lds
s_add_u32 s56, s54, 540672
s_mov_b32 m0, 33792
s_nop 0
buffer_load_dwordx4 v26, s[16:19], s56 offen lds
s_add_u32 s56, s54, 557056
s_mov_b32 m0, 34816
s_nop 0
buffer_load_dwordx4 v27, s[16:19], s56 offen lds
s_add_u32 s56, s54, 573440
s_mov_b32 m0, 35840
s_nop 0
buffer_load_dwordx4 v27, s[16:19], s56 offen lds
ds_read_b64_tr_b16 v[208:209], v44 offset:20480
ds_read_b64_tr_b16 v[210:211], v44 offset:21504
ds_read_b64_tr_b16 v[212:213], v46 offset:20480
ds_read_b64_tr_b16 v[214:215], v46 offset:21504
ds_read_b64_tr_b16 v[216:217], v45 offset:20480
ds_read_b64_tr_b16 v[218:219], v45 offset:21504
ds_read_b64_tr_b16 v[220:221], v47 offset:20480
ds_read_b64_tr_b16 v[222:223], v47 offset:21504
s_waitcnt lgkmcnt(0)
s_waitcnt vmcnt(25)
s_barrier
s_add_u32 s56, s54, 1048576
s_mov_b32 m0, 36864
s_nop 0
buffer_load_dwordx4 v26, s[16:19], s56 offen lds
s_add_u32 s56, s54, 1064960
s_mov_b32 m0, 37888
s_nop 0
buffer_load_dwordx4 v26, s[16:19], s56 offen lds
s_add_u32 s56, s54, 1081344
s_mov_b32 m0, 38912
s_nop 0
buffer_load_dwordx4 v27, s[16:19], s56 offen lds
s_add_u32 s56, s54, 1097728
s_mov_b32 m0, 39936
s_nop 0
buffer_load_dwordx4 v27, s[16:19], s56 offen lds
ds_read_b64_tr_b16 v[224:225], v44 offset:24576
ds_read_b64_tr_b16 v[226:227], v44 offset:25600
ds_read_b64_tr_b16 v[228:229], v46 offset:24576
ds_read_b64_tr_b16 v[230:231], v46 offset:25600
ds_read_b64_tr_b16 v[232:233], v45 offset:24576
ds_read_b64_tr_b16 v[234:235], v45 offset:25600
ds_read_b64_tr_b16 v[236:237], v47 offset:24576
ds_read_b64_tr_b16 v[238:239], v47 offset:25600
ds_read_b64_tr_b16 v[60:61], v31 offset:32768
ds_read_b64_tr_b16 v[62:63], v31 offset:32896
ds_read_b64_tr_b16 v[64:65], v31 offset:33280
ds_read_b64_tr_b16 v[66:67], v31 offset:33408
ds_read_b64_tr_b16 v[68:69], v31 offset:34816
ds_read_b64_tr_b16 v[70:71], v31 offset:34944
ds_read_b64_tr_b16 v[72:73], v31 offset:35328
ds_read_b64_tr_b16 v[74:75], v31 offset:35456
s_waitcnt lgkmcnt(0)
ds_write_b128 v2, v[60:63] offset:32768
ds_write_b128 v2, v[64:67] offset:33792
ds_write_b128 v2, v[68:71] offset:34816
ds_write_b128 v2, v[72:75] offset:35840
s_waitcnt lgkmcnt(0)
s_waitcnt vmcnt(25)
s_barrier
s_add_u32 s56, s54, 1572864
s_mov_b32 m0, 40960
s_nop 0
buffer_load_dwordx4 v26, s[16:19], s56 offen lds
s_add_u32 s56, s54, 1589248
s_mov_b32 m0, 41984
s_nop 0
buffer_load_dwordx4 v26, s[16:19], s56 offen lds
s_add_u32 s56, s54, 1605632
s_mov_b32 m0, 43008
s_nop 0
buffer_load_dwordx4 v27, s[16:19], s56 offen lds
s_add_u32 s56, s54, 1622016
s_mov_b32 m0, 44032
s_nop 0
buffer_load_dwordx4 v27, s[16:19], s56 offen lds
ds_read_b64_tr_b16 v[240:241], v44 offset:28672
ds_read_b64_tr_b16 v[242:243], v44 offset:29696
ds_read_b64_tr_b16 v[244:245], v46 offset:28672
ds_read_b64_tr_b16 v[246:247], v46 offset:29696
ds_read_b64_tr_b16 v[248:249], v45 offset:28672
ds_read_b64_tr_b16 v[250:251], v45 offset:29696
ds_read_b64_tr_b16 v[252:253], v47 offset:28672
ds_read_b64_tr_b16 v[254:255], v47 offset:29696
ds_read_b64_tr_b16 v[60:61], v31 offset:36864
ds_read_b64_tr_b16 v[62:63], v31 offset:36992
ds_read_b64_tr_b16 v[64:65], v31 offset:37376
ds_read_b64_tr_b16 v[66:67], v31 offset:37504
ds_read_b64_tr_b16 v[68:69], v31 offset:38912
ds_read_b64_tr_b16 v[70:71], v31 offset:39040
ds_read_b64_tr_b16 v[72:73], v31 offset:39424
ds_read_b64_tr_b16 v[74:75], v31 offset:39552
s_waitcnt lgkmcnt(0)
ds_write_b128 v2, v[60:63] offset:36864
ds_write_b128 v2, v[64:67] offset:37888
ds_write_b128 v2, v[68:71] offset:38912
ds_write_b128 v2, v[72:75] offset:39936
s_waitcnt lgkmcnt(0)
s_waitcnt vmcnt(25)
s_barrier
s_add_u32 s56, s54, 2097152
s_mov_b32 m0, 45056
s_nop 0
buffer_load_dwordx4 v26, s[16:19], s56 offen lds
s_add_u32 s56, s54, 2113536
s_mov_b32 m0, 46080
s_nop 0
buffer_load_dwordx4 v26, s[16:19], s56 offen lds
s_add_u32 s56, s54, 2129920
s_mov_b32 m0, 47104
s_nop 0
buffer_load_dwordx4 v27, s[16:19], s56 offen lds
s_add_u32 s56, s54, 2146304
s_mov_b32 m0, 48128
s_nop 0
buffer_load_dwordx4 v27, s[16:19], s56 offen lds
ds_read_b64_tr_b16 a[0:1], v44 offset:0
ds_read_b64_tr_b16 a[2:3], v44 offset:1024
ds_read_b64_tr_b16 a[4:5], v46 offset:0
ds_read_b64_tr_b16 a[6:7], v46 offset:1024
ds_read_b64_tr_b16 a[8:9], v45 offset:0
ds_read_b64_tr_b16 a[10:11], v45 offset:1024
ds_read_b64_tr_b16 a[12:13], v47 offset:0
ds_read_b64_tr_b16 a[14:15], v47 offset:1024
s_waitcnt lgkmcnt(0)
s_waitcnt vmcnt(25)
s_barrier
s_add_u32 s56, s54, 2621440
s_mov_b32 m0, 16384
s_nop 0
buffer_load_dwordx4 v26, s[16:19], s56 offen lds
s_add_u32 s56, s54, 2637824
s_mov_b32 m0, 17408
s_nop 0
buffer_load_dwordx4 v26, s[16:19], s56 offen lds
s_add_u32 s56, s54, 2654208
s_mov_b32 m0, 18432
s_nop 0
buffer_load_dwordx4 v27, s[16:19], s56 offen lds
s_add_u32 s56, s54, 2670592
s_mov_b32 m0, 19456
s_nop 0
buffer_load_dwordx4 v27, s[16:19], s56 offen lds
ds_read_b64_tr_b16 a[16:17], v44 offset:4096
ds_read_b64_tr_b16 a[18:19], v44 offset:5120
ds_read_b64_tr_b16 a[20:21], v46 offset:4096
ds_read_b64_tr_b16 a[22:23], v46 offset:5120
ds_read_b64_tr_b16 a[24:25], v45 offset:4096
ds_read_b64_tr_b16 a[26:27], v45 offset:5120
ds_read_b64_tr_b16 a[28:29], v47 offset:4096
ds_read_b64_tr_b16 a[30:31], v47 offset:5120
s_waitcnt lgkmcnt(0)
s_waitcnt vmcnt(25)
s_barrier
s_add_u32 s56, s54, 3145728
s_mov_b32 m0, 20480
s_nop 0
buffer_load_dwordx4 v26, s[16:19], s56 offen lds
s_add_u32 s56, s54, 3162112
s_mov_b32 m0, 21504
s_nop 0
buffer_load_dwordx4 v26, s[16:19], s56 offen lds
s_add_u32 s56, s54, 3178496
s_mov_b32 m0, 22528
s_nop 0
buffer_load_dwordx4 v27, s[16:19], s56 offen lds
s_add_u32 s56, s54, 3194880
s_mov_b32 m0, 23552
s_nop 0
buffer_load_dwordx4 v27, s[16:19], s56 offen lds
ds_read_b64_tr_b16 a[32:33], v44 offset:8192
ds_read_b64_tr_b16 a[34:35], v44 offset:9216
ds_read_b64_tr_b16 a[36:37], v46 offset:8192
ds_read_b64_tr_b16 a[38:39], v46 offset:9216
ds_read_b64_tr_b16 a[40:41], v45 offset:8192
ds_read_b64_tr_b16 a[42:43], v45 offset:9216
ds_read_b64_tr_b16 a[44:45], v47 offset:8192
ds_read_b64_tr_b16 a[46:47], v47 offset:9216
s_waitcnt lgkmcnt(0)
s_waitcnt vmcnt(24)
s_barrier
s_add_u32 s56, s54, 3670016
s_mov_b32 m0, 24576
s_nop 0
buffer_load_dwordx4 v26, s[16:19], s56 offen lds
s_add_u32 s56, s54, 3686400
s_mov_b32 m0, 25600
s_nop 0
buffer_load_dwordx4 v26, s[16:19], s56 offen lds
s_add_u32 s56, s54, 3702784
s_mov_b32 m0, 26624
s_nop 0
buffer_load_dwordx4 v27, s[16:19], s56 offen lds
s_add_u32 s56, s54, 3719168
s_mov_b32 m0, 27648
s_nop 0
buffer_load_dwordx4 v27, s[16:19], s56 offen lds
ds_read_b64_tr_b16 a[48:49], v44 offset:12288
ds_read_b64_tr_b16 a[50:51], v44 offset:13312
ds_read_b64_tr_b16 a[52:53], v46 offset:12288
ds_read_b64_tr_b16 a[54:55], v46 offset:13312
ds_read_b64_tr_b16 a[56:57], v45 offset:12288
ds_read_b64_tr_b16 a[58:59], v45 offset:13312
ds_read_b64_tr_b16 a[60:61], v47 offset:12288
ds_read_b64_tr_b16 a[62:63], v47 offset:13312
s_waitcnt lgkmcnt(0)
s_waitcnt vmcnt(24)
s_barrier
s_add_u32 s56, s55, 73728
s_mov_b32 m0, 28672
s_nop 0
buffer_load_dwordx4 v28, s[20:23], s56 offen lds
s_add_u32 s56, s55, 76032
s_mov_b32 m0, 29696
s_nop 0
buffer_load_dwordx4 v28, s[20:23], s56 offen lds
s_add_u32 s56, s55, 82944
s_mov_b32 m0, 30720
s_nop 0
buffer_load_dwordx4 v28, s[20:23], s56 offen lds
s_add_u32 s56, s55, 85248
s_mov_b32 m0, 31744
s_nop 0
buffer_load_dwordx4 v28, s[20:23], s56 offen lds
ds_read_b64_tr_b16 a[64:65], v44 offset:16384
ds_read_b64_tr_b16 a[66:67], v44 offset:17408
ds_read_b64_tr_b16 a[68:69], v46 offset:16384
ds_read_b64_tr_b16 a[70:71], v46 offset:17408
ds_read_b64_tr_b16 a[72:73], v45 offset:16384
ds_read_b64_tr_b16 a[74:75], v45 offset:17408
ds_read_b64_tr_b16 a[76:77], v47 offset:16384
ds_read_b64_tr_b16 a[78:79], v47 offset:17408
s_waitcnt lgkmcnt(0)
s_waitcnt vmcnt(24)
s_barrier
s_add_u32 s56, s55, 73984
s_mov_b32 m0, 32768
s_nop 0
buffer_load_dwordx4 v28, s[20:23], s56 offen lds
s_add_u32 s56, s55, 76288
s_mov_b32 m0, 33792
s_nop 0
buffer_load_dwordx4 v28, s[20:23], s56 offen lds
s_add_u32 s56, s55, 83200
s_mov_b32 m0, 34816
s_nop 0
buffer_load_dwordx4 v28, s[20:23], s56 offen lds
s_add_u32 s56, s55, 85504
s_mov_b32 m0, 35840
s_nop 0
buffer_load_dwordx4 v28, s[20:23], s56 offen lds
ds_read_b64_tr_b16 a[80:81], v44 offset:20480
ds_read_b64_tr_b16 a[82:83], v44 offset:21504
ds_read_b64_tr_b16 a[84:85], v46 offset:20480
ds_read_b64_tr_b16 a[86:87], v46 offset:21504
ds_read_b64_tr_b16 a[88:89], v45 offset:20480
ds_read_b64_tr_b16 a[90:91], v45 offset:21504
ds_read_b64_tr_b16 a[92:93], v47 offset:20480
ds_read_b64_tr_b16 a[94:95], v47 offset:21504
s_waitcnt lgkmcnt(0)
s_waitcnt vmcnt(24)
s_barrier
s_add_u32 s56, s55, 74240
s_mov_b32 m0, 36864
s_nop 0
buffer_load_dwordx4 v28, s[20:23], s56 offen lds
s_add_u32 s56, s55, 76544
s_mov_b32 m0, 37888
s_nop 0
buffer_load_dwordx4 v28, s[20:23], s56 offen lds
s_add_u32 s56, s55, 83456
s_mov_b32 m0, 38912
s_nop 0
buffer_load_dwordx4 v28, s[20:23], s56 offen lds
s_add_u32 s56, s55, 85760
s_mov_b32 m0, 39936
s_nop 0
buffer_load_dwordx4 v28, s[20:23], s56 offen lds
ds_read_b64_tr_b16 a[96:97], v44 offset:24576
ds_read_b64_tr_b16 a[98:99], v44 offset:25600
ds_read_b64_tr_b16 a[100:101], v46 offset:24576
ds_read_b64_tr_b16 a[102:103], v46 offset:25600
ds_read_b64_tr_b16 a[104:105], v45 offset:24576
ds_read_b64_tr_b16 a[106:107], v45 offset:25600
ds_read_b64_tr_b16 a[108:109], v47 offset:24576
ds_read_b64_tr_b16 a[110:111], v47 offset:25600
s_waitcnt lgkmcnt(0)
s_waitcnt vmcnt(24)
s_barrier
s_add_u32 s56, s55, 74496
s_mov_b32 m0, 40960
s_nop 0
buffer_load_dwordx4 v28, s[20:23], s56 offen lds
s_add_u32 s56, s55, 76800
s_mov_b32 m0, 41984
s_nop 0
buffer_load_dwordx4 v28, s[20:23], s56 offen lds
s_add_u32 s56, s55, 83712
s_mov_b32 m0, 43008
s_nop 0
buffer_load_dwordx4 v28, s[20:23], s56 offen lds
s_add_u32 s56, s55, 86016
s_mov_b32 m0, 44032
s_nop 0
buffer_load_dwordx4 v28, s[20:23], s56 offen lds
ds_read_b64_tr_b16 a[112:113], v44 offset:28672
ds_read_b64_tr_b16 a[114:115], v44 offset:29696
ds_read_b64_tr_b16 a[116:117], v46 offset:28672
ds_read_b64_tr_b16 a[118:119], v46 offset:29696
ds_read_b64_tr_b16 a[120:121], v45 offset:28672
ds_read_b64_tr_b16 a[122:123], v45 offset:29696
ds_read_b64_tr_b16 a[124:125], v47 offset:28672
ds_read_b64_tr_b16 a[126:127], v47 offset:29696
s_waitcnt lgkmcnt(0)
s_waitcnt vmcnt(24)
s_barrier
s_add_u32 s56, s55, 0
s_mov_b32 m0, 45056
s_nop 0
buffer_load_dwordx4 v28, s[20:23], s56 offen lds
s_add_u32 s56, s55, 2304
s_mov_b32 m0, 46080
s_nop 0
buffer_load_dwordx4 v28, s[20:23], s56 offen lds
s_add_u32 s56, s55, 9216
s_mov_b32 m0, 47104
s_nop 0
buffer_load_dwordx4 v28, s[20:23], s56 offen lds
s_add_u32 s56, s55, 11520
s_mov_b32 m0, 48128
s_nop 0
buffer_load_dwordx4 v28, s[20:23], s56 offen lds
ds_read_b64_tr_b16 a[128:129], v44 offset:0
ds_read_b64_tr_b16 a[130:131], v44 offset:1024
ds_read_b64_tr_b16 a[132:133], v46 offset:0
ds_read_b64_tr_b16 a[134:135], v46 offset:1024
ds_read_b64_tr_b16 a[136:137], v45 offset:0
ds_read_b64_tr_b16 a[138:139], v45 offset:1024
ds_read_b64_tr_b16 a[140:141], v47 offset:0
ds_read_b64_tr_b16 a[142:143], v47 offset:1024
buffer_load_dword v32, v24, s[28:31], 0 offen sc0 sc1
s_waitcnt lgkmcnt(0)
s_waitcnt vmcnt(25)
s_barrier
s_add_u32 s56, s54, 0
s_mov_b32 m0, 16384
s_nop 0
buffer_load_dwordx4 v26, s[8:11], s56 offen lds
s_add_u32 s56, s54, 16384
s_mov_b32 m0, 17408
s_nop 0
buffer_load_dwordx4 v26, s[8:11], s56 offen lds
s_add_u32 s56, s54, 32768
s_mov_b32 m0, 18432
s_nop 0
buffer_load_dwordx4 v27, s[8:11], s56 offen lds
s_add_u32 s56, s54, 49152
s_mov_b32 m0, 19456
s_nop 0
buffer_load_dwordx4 v27, s[8:11], s56 offen lds
ds_read_b64_tr_b16 a[144:145], v44 offset:4096
ds_read_b64_tr_b16 a[146:147], v44 offset:5120
ds_read_b64_tr_b16 a[148:149], v46 offset:4096
ds_read_b64_tr_b16 a[150:151], v46 offset:5120
ds_read_b64_tr_b16 a[152:153], v45 offset:4096
ds_read_b64_tr_b16 a[154:155], v45 offset:5120
ds_read_b64_tr_b16 a[156:157], v47 offset:4096
ds_read_b64_tr_b16 a[158:159], v47 offset:5120
s_waitcnt lgkmcnt(0)
s_waitcnt vmcnt(25)
s_barrier
s_add_u32 s56, s54, 1572864
s_mov_b32 m0, 20480
s_nop 0
buffer_load_dwordx4 v26, s[8:11], s56 offen lds
s_add_u32 s56, s54, 1589248
s_mov_b32 m0, 21504
s_nop 0
buffer_load_dwordx4 v26, s[8:11], s56 offen lds
s_add_u32 s56, s54, 1605632
s_mov_b32 m0, 22528
s_nop 0
buffer_load_dwordx4 v27, s[8:11], s56 offen lds
s_add_u32 s56, s54, 1622016
s_mov_b32 m0, 23552
s_nop 0
buffer_load_dwordx4 v27, s[8:11], s56 offen lds
ds_read_b64_tr_b16 a[160:161], v44 offset:8192
ds_read_b64_tr_b16 a[162:163], v44 offset:9216
ds_read_b64_tr_b16 a[164:165], v46 offset:8192
ds_read_b64_tr_b16 a[166:167], v46 offset:9216
ds_read_b64_tr_b16 a[168:169], v45 offset:8192
ds_read_b64_tr_b16 a[170:171], v45 offset:9216
ds_read_b64_tr_b16 a[172:173], v47 offset:8192
ds_read_b64_tr_b16 a[174:175], v47 offset:9216
s_waitcnt lgkmcnt(0)
s_waitcnt vmcnt(25)
s_barrier
s_add_u32 s56, s54, 2097152
s_mov_b32 m0, 24576
s_nop 0
buffer_load_dwordx4 v26, s[8:11], s56 offen lds
s_add_u32 s56, s54, 2113536
s_mov_b32 m0, 25600
s_nop 0
buffer_load_dwordx4 v26, s[8:11], s56 offen lds
s_add_u32 s56, s54, 2129920
s_mov_b32 m0, 26624
s_nop 0
buffer_load_dwordx4 v27, s[8:11], s56 offen lds
s_add_u32 s56, s54, 2146304
s_mov_b32 m0, 27648
s_nop 0
buffer_load_dwordx4 v27, s[8:11], s56 offen lds
ds_read_b64_tr_b16 a[184:185], v48 offset:12288
ds_read_b64_tr_b16 a[186:187], v48 offset:13312
ds_read_b64_tr_b16 a[188:189], v48 offset:14336
ds_read_b64_tr_b16 a[190:191], v48 offset:15360
ds_read_b64_tr_b16 a[200:201], v49 offset:12288
ds_read_b64_tr_b16 a[202:203], v49 offset:13312
ds_read_b64_tr_b16 a[204:205], v49 offset:14336
ds_read_b64_tr_b16 a[206:207], v49 offset:15360
s_waitcnt lgkmcnt(0)
s_waitcnt vmcnt(25)
s_barrier
s_add_u32 s56, s54, 2621440
s_mov_b32 m0, 28672
s_nop 0
buffer_load_dwordx4 v26, s[12:15], s56 offen lds
s_add_u32 s56, s54, 2637824
s_mov_b32 m0, 29696
s_nop 0
buffer_load_dwordx4 v26, s[12:15], s56 offen lds
s_add_u32 s56, s54, 2654208
s_mov_b32 m0, 30720
s_nop 0
buffer_load_dwordx4 v27, s[12:15], s56 offen lds
s_add_u32 s56, s54, 2670592
s_mov_b32 m0, 31744
s_nop 0
buffer_load_dwordx4 v27, s[12:15], s56 offen lds
ds_read_b64_tr_b16 a[208:209], v48 offset:16384
ds_read_b64_tr_b16 a[210:211], v48 offset:17408
ds_read_b64_tr_b16 a[212:213], v48 offset:18432
ds_read_b64_tr_b16 a[214:215], v48 offset:19456
ds_read_b64_tr_b16 a[216:217], v49 offset:16384
ds_read_b64_tr_b16 a[218:219], v49 offset:17408
ds_read_b64_tr_b16 a[220:221], v49 offset:18432
ds_read_b64_tr_b16 a[222:223], v49 offset:19456
s_waitcnt lgkmcnt(0)
s_waitcnt vmcnt(25)
s_barrier
s_add_u32 s56, s54, 4194304
s_mov_b32 m0, 32768
s_nop 0
buffer_load_dwordx4 v26, s[16:19], s56 offen lds
s_add_u32 s56, s54, 4210688
s_mov_b32 m0, 33792
s_nop 0
buffer_load_dwordx4 v26, s[16:19], s56 offen lds
s_add_u32 s56, s54, 4227072
s_mov_b32 m0, 34816
s_nop 0
buffer_load_dwordx4 v27, s[16:19], s56 offen lds
s_add_u32 s56, s54, 4243456
s_mov_b32 m0, 35840
s_nop 0
buffer_load_dwordx4 v27, s[16:19], s56 offen lds
ds_read_b64_tr_b16 a[224:225], v48 offset:20480
ds_read_b64_tr_b16 a[226:227], v48 offset:21504
ds_read_b64_tr_b16 a[228:229], v48 offset:22528
ds_read_b64_tr_b16 a[230:231], v48 offset:23552
ds_read_b64_tr_b16 a[232:233], v49 offset:20480
ds_read_b64_tr_b16 a[234:235], v49 offset:21504
ds_read_b64_tr_b16 a[236:237], v49 offset:22528
ds_read_b64_tr_b16 a[238:239], v49 offset:23552
s_waitcnt lgkmcnt(0)
s_waitcnt vmcnt(25)
s_barrier
s_add_u32 s56, s55, 256
s_mov_b32 m0, 36864
s_nop 0
buffer_load_dwordx4 v28, s[20:23], s56 offen lds
s_add_u32 s56, s55, 2560
s_mov_b32 m0, 37888
s_nop 0
buffer_load_dwordx4 v28, s[20:23], s56 offen lds
s_add_u32 s56, s55, 9472
s_mov_b32 m0, 38912
s_nop 0
buffer_load_dwordx4 v28, s[20:23], s56 offen lds
s_add_u32 s56, s55, 11776
s_mov_b32 m0, 39936
s_nop 0
buffer_load_dwordx4 v28, s[20:23], s56 offen lds
ds_read_b64_tr_b16 a[240:241], v48 offset:24576
ds_read_b64_tr_b16 a[242:243], v48 offset:25600
ds_read_b64_tr_b16 a[244:245], v48 offset:26624
ds_read_b64_tr_b16 a[246:247], v48 offset:27648
ds_read_b64_tr_b16 a[248:249], v49 offset:24576
ds_read_b64_tr_b16 a[250:251], v49 offset:25600
ds_read_b64_tr_b16 a[252:253], v49 offset:26624
ds_read_b64_tr_b16 a[254:255], v49 offset:27648
s_waitcnt lgkmcnt(0)
s_waitcnt vmcnt(25)
s_barrier
s_add_u32 s56, s55, 512
s_mov_b32 m0, 40960
s_nop 0
buffer_load_dwordx4 v28, s[20:23], s56 offen lds
s_add_u32 s56, s55, 2816
s_mov_b32 m0, 41984
s_nop 0
buffer_load_dwordx4 v28, s[20:23], s56 offen lds
s_add_u32 s56, s55, 9728
s_mov_b32 m0, 43008
s_nop 0
buffer_load_dwordx4 v28, s[20:23], s56 offen lds
s_add_u32 s56, s55, 12032
s_mov_b32 m0, 44032
s_nop 0
buffer_load_dwordx4 v28, s[20:23], s56 offen lds
ds_read_b64_tr_b16 a[176:177], v48 offset:28672
ds_read_b64_tr_b16 a[178:179], v48 offset:29696
ds_read_b64_tr_b16 a[180:181], v48 offset:30720
ds_read_b64_tr_b16 a[182:183], v48 offset:31744
ds_read_b64_tr_b16 a[192:193], v49 offset:28672
ds_read_b64_tr_b16 a[194:195], v49 offset:29696
ds_read_b64_tr_b16 a[196:197], v49 offset:30720
ds_read_b64_tr_b16 a[198:199], v49 offset:31744
s_waitcnt lgkmcnt(0)
s_waitcnt vmcnt(24)
s_barrier
s_add_u32 s56, s55, 768
s_mov_b32 m0, 45056
s_nop 0
buffer_load_dwordx4 v28, s[20:23], s56 offen lds
s_add_u32 s56, s55, 3072
s_mov_b32 m0, 46080
s_nop 0
buffer_load_dwordx4 v28, s[20:23], s56 offen lds
s_add_u32 s56, s55, 9984
s_mov_b32 m0, 47104
s_nop 0
buffer_load_dwordx4 v28, s[20:23], s56 offen lds
s_add_u32 s56, s55, 12288
s_mov_b32 m0, 48128
s_nop 0
buffer_load_dwordx4 v28, s[20:23], s56 offen lds
ds_read_b64_tr_b16 v[60:61], v44 offset:0
ds_read_b64_tr_b16 v[62:63], v44 offset:1024
ds_read_b64_tr_b16 v[64:65], v46 offset:0
ds_read_b64_tr_b16 v[66:67], v46 offset:1024
ds_read_b64_tr_b16 v[68:69], v45 offset:0
ds_read_b64_tr_b16 v[70:71], v45 offset:1024
ds_read_b64_tr_b16 v[72:73], v47 offset:0
ds_read_b64_tr_b16 v[74:75], v47 offset:1024
s_waitcnt lgkmcnt(0)
s_waitcnt vmcnt(24)
s_barrier
ds_write_b128 v2, v[60:63] offset:0
ds_write_b128 v2, v[64:67] offset:1024
ds_write_b128 v2, v[68:71] offset:2048
ds_write_b128 v2, v[72:75] offset:3072
ds_read_b64_tr_b16 v[60:61], v44 offset:4096
ds_read_b64_tr_b16 v[62:63], v44 offset:5120
ds_read_b64_tr_b16 v[64:65], v46 offset:4096
ds_read_b64_tr_b16 v[66:67], v46 offset:5120
ds_read_b64_tr_b16 v[68:69], v45 offset:4096
ds_read_b64_tr_b16 v[70:71], v45 offset:5120
ds_read_b64_tr_b16 v[72:73], v47 offset:4096
ds_read_b64_tr_b16 v[74:75], v47 offset:5120
L_rdv_w0:
v_readfirstlane_b32 s38, v32
s_nop 0
s_and_b32 s57, s38, 0xff
s_cmp_lg_u32 s57, 32
s_cbranch_scc1 L_rdv2_w0
s_waitcnt lgkmcnt(0)
s_waitcnt vmcnt(20)
s_barrier
ds_write_b128 v2, v[60:63] offset:4096
ds_write_b128 v2, v[64:67] offset:5120
ds_write_b128 v2, v[68:71] offset:6144
ds_write_b128 v2, v[72:75] offset:7168
ds_read_b64_tr_b16 v[60:61], v44 offset:8192
ds_read_b64_tr_b16 v[62:63], v44 offset:9216
ds_read_b64_tr_b16 v[64:65], v46 offset:8192
ds_read_b64_tr_b16 v[66:67], v46 offset:9216
ds_read_b64_tr_b16 v[68:69], v45 offset:8192
ds_read_b64_tr_b16 v[70:71], v45 offset:9216
ds_read_b64_tr_b16 v[72:73], v47 offset:8192
ds_read_b64_tr_b16 v[74:75], v47 offset:9216
buffer_load_dwordx4 v[12:15], v9, s[4:7], s37 offen offset:0
buffer_load_dwordx4 v[16:19], v9, s[4:7], s37 offen offset:1024
buffer_load_dwordx4 v[52:55], v1, s[4:7], s37 offen offset:2048
buffer_load_dwordx4 v[56:59], v1, s[4:7], s37 offen offset:3072
s_mov_b32 m0, 1024
s_nop 0
buffer_load_dwordx4 v1, s[4:7], s47 offen offset:0 sc1 lds
s_waitcnt lgkmcnt(0)
s_waitcnt vmcnt(21)
s_barrier
ds_write_b128 v2, v[60:63] offset:8192
ds_write_b128 v2, v[64:67] offset:9216
ds_write_b128 v2, v[68:71] offset:10240
ds_write_b128 v2, v[72:75] offset:11264
ds_read_b64_tr_b16 v[60:61], v44 offset:12288
ds_read_b64_tr_b16 v[62:63], v44 offset:13312
ds_read_b64_tr_b16 v[64:65], v46 offset:12288
ds_read_b64_tr_b16 v[66:67], v46 offset:13312
ds_read_b64_tr_b16 v[68:69], v45 offset:12288
ds_read_b64_tr_b16 v[70:71], v45 offset:13312
ds_read_b64_tr_b16 v[72:73], v47 offset:12288
ds_read_b64_tr_b16 v[74:75], v47 offset:13312
s_waitcnt lgkmcnt(0)
s_waitcnt vmcnt(17)
s_barrier
ds_write_b128 v2, v[60:63] offset:12288
ds_write_b128 v2, v[64:67] offset:13312
ds_write_b128 v2, v[68:71] offset:14336
ds_write_b128 v2, v[72:75] offset:15360
ds_read_b64_tr_b16 v[60:61], v44 offset:16384
ds_read_b64_tr_b16 v[62:63], v44 offset:17408
ds_read_b64_tr_b16 v[64:65], v46 offset:16384
ds_read_b64_tr_b16 v[66:67], v46 offset:17408
ds_read_b64_tr_b16 v[68:69], v45 offset:16384
ds_read_b64_tr_b16 v[70:71], v45 offset:17408
ds_read_b64_tr_b16 v[72:73], v47 offset:16384
ds_read_b64_tr_b16 v[74:75], v47 offset:17408
s_waitcnt lgkmcnt(0)
s_waitcnt vmcnt(13)
s_barrier
ds_write_b128 v2, v[60:63] offset:16384
ds_write_b128 v2, v[64:67] offset:17408
ds_write_b128 v2, v[68:71] offset:18432
ds_write_b128 v2, v[72:75] offset:19456
ds_read_b64_tr_b16 v[60:61], v48 offset:20480
ds_read_b64_tr_b16 v[62:63], v48 offset:21504
ds_read_b64_tr_b16 v[64:65], v48 offset:22528
ds_read_b64_tr_b16 v[66:67], v48 offset:23552
ds_read_b64_tr_b16 v[68:69], v49 offset:20480
ds_read_b64_tr_b16 v[70:71], v49 offset:21504
ds_read_b64_tr_b16 v[72:73], v49 offset:22528
ds_read_b64_tr_b16 v[74:75], v49 offset:23552
s_waitcnt lgkmcnt(0)
s_waitcnt vmcnt(9)
s_barrier
ds_write_b128 v2, v[60:63] offset:20480
ds_write_b128 v2, v[64:67] offset:21504
ds_write_b128 v2, v[68:71] offset:22528
ds_write_b128 v2, v[72:75] offset:23552
ds_read_b64_tr_b16 v[60:61], v48 offset:24576
ds_read_b64_tr_b16 v[62:63], v48 offset:25600
ds_read_b64_tr_b16 v[64:65], v48 offset:26624
ds_read_b64_tr_b16 v[66:67], v48 offset:27648
ds_read_b64_tr_b16 v[68:69], v49 offset:24576
ds_read_b64_tr_b16 v[70:71], v49 offset:25600
ds_read_b64_tr_b16 v[72:73], v49 offset:26624
ds_read_b64_tr_b16 v[74:75], v49 offset:27648
s_waitcnt lgkmcnt(0)
s_waitcnt vmcnt(5)
s_barrier
ds_write_b128 v2, v[60:63] offset:24576
ds_write_b128 v2, v[64:67] offset:25600
ds_write_b128 v2, v[68:71] offset:26624
ds_write_b128 v2, v[72:75] offset:27648
ds_read_b64_tr_b16 v[60:61], v48 offset:28672
ds_read_b64_tr_b16 v[62:63], v48 offset:29696
ds_read_b64_tr_b16 v[64:65], v48 offset:30720
ds_read_b64_tr_b16 v[66:67], v48 offset:31744
ds_read_b64_tr_b16 v[68:69], v49 offset:28672
ds_read_b64_tr_b16 v[70:71], v49 offset:29696
ds_read_b64_tr_b16 v[72:73], v49 offset:30720
ds_read_b64_tr_b16 v[74:75], v49 offset:31744
s_waitcnt lgkmcnt(0)
s_barrier
ds_write_b128 v2, v[60:63] offset:28672
ds_write_b128 v2, v[64:67] offset:29696
ds_write_b128 v2, v[68:71] offset:30720
ds_write_b128 v2, v[72:75] offset:31744
s_lshl_b32 s57, s58, 5
s_mov_b32 s0, 0x3f003f00
s_mov_b32 s1, 0x3f003f00
s_mov_b32 s58, 304128
s_cmp_eq_u32 s38, s57
s_mov_b32 s56, 0x33333333
s_mov_b32 s57, 0x33333333
s_mov_b32 s2, 0x21800000
s_mov_b32 s55, -24
s_cbranch_scc0 L_slow_w0
v_mov_b64 v[20:21], 0
v_mov_b64 v[22:23], 0
v_mov_b64 v[24:25], 0
v_mov_b64 v[26:27], 0
v_mov_b64 v[28:29], 0
v_mov_b64 v[30:31], 0
v_mov_b64 v[32:33], 0
v_mov_b64 v[34:35], 0
v_mov_b64 v[36:37], 0
v_mov_b64 v[38:39], 0
v_mov_b64 v[40:41], 0
v_mov_b64 v[42:43], 0
ds_read_b128 v[44:47], v2 offset:0
ds_read_b128 v[48:51], v2 offset:1024
v_bfe_u32 v77, v1, 6, 1
v_lshl_add_u32 v77, v77, 3, v1
v_lshlrev_b32 v77, 1, v77
v_lshlrev_b32 v78, 3, v1
s_waitcnt vmcnt(0) lgkmcnt(0)
s_branch L_top_w0f
L_done_w0f:
s_waitcnt vmcnt(0) lgkmcnt(0)
s_endpgm
L_rdv2_w0:
buffer_load_dword v32, v24, s[28:31], 0 offen sc0 sc1
s_sub_u32 s41, s41, 1
s_cbranch_scc1 L_exit
s_waitcnt vmcnt(0)
s_branch L_rdv_w0
L_ra0_w0f:
s_mov_b32 m0, 1024
s_nop 0
buffer_load_dwordx4 v1, s[4:7], s47 offen offset:0 sc1 lds
buffer_load_dwordx4 v1, s[4:7], s47 offen offset:1024 sc1 lds
buffer_load_dwordx4 v1, s[4:7], s47 offen offset:2048 sc1 lds
buffer_load_dwordx4 v1, s[4:7], s47 offen offset:3072 sc1 lds
s_sub_u32 s41, s41, 1
s_cbranch_scc1 L_exit
ds_read_b128 v[44:47], v2 offset:0
ds_read_b128 v[48:51], v2 offset:1024
v_mov_b64 v[20:21], 0
v_mov_b64 v[22:23], 0
v_mov_b64 v[24:25], 0
v_mov_b64 v[26:27], 0
v_mov_b64 v[28:29], 0
v_mov_b64 v[30:31], 0
v_mov_b64 v[32:33], 0
v_mov_b64 v[34:35], 0
v_mov_b64 v[36:37], 0
v_mov_b64 v[38:39], 0
v_mov_b64 v[40:41], 0
v_mov_b64 v[42:43], 0
s_waitcnt vmcnt(0)
ds_read_b128 v[60:63], v1 offset:1024
ds_read_b128 v[64:67], v1 offset:2048
ds_read_b128 v[68:71], v1 offset:3072
ds_read_b128 v[72:75], v1 offset:4096
s_branch L_s0_w0f
L_ra1_w0f:
L_ra2_w0f:
s_waitcnt lgkmcnt(0)
s_barrier
s_mov_b32 m0, 5120
s_nop 0
buffer_load_dwordx4 v1, s[4:7], s48 offen offset:0 sc1 lds
s_mov_b32 m0, 9216
s_nop 0
buffer_load_dwordx4 v1, s[4:7], s49 offen offset:0 sc1 lds
s_sub_u32 s41, s41, 1
s_cbranch_scc1 L_exit
s_waitcnt vmcnt(0)
s_barrier
ds_read_b128 v[76:79], v1 offset:5120
ds_read_b128 v[60:63], v1 offset:6144
ds_read_b128 v[64:67], v1 offset:7168
ds_read_b128 v[68:71], v1 offset:8192
ds_read_b128 v[72:75], v1 offset:9216
s_waitcnt lgkmcnt(0)
v_bitop3_b32 v6, v76, v60, s35 bitop3:0x7e
v_bitop3_b32 v6, v6, v64, s35 bitop3:0xf6
v_bitop3_b32 v6, v6, v68, s35 bitop3:0xf6
v_bitop3_b32 v6, v6, v72, s35 bitop3:0xf6
v_and_b32 v6, 1, v6
v_cmp_ne_u32 vcc, 0, v6

s_cbranch_vccnz L_ra2_w0f
s_branch L_a1_w0f
L_mx_w0f:
s_waitcnt lgkmcnt(0)
v_max3_f32 v30, v12, v13, v28
v_max_f32 v30, v30, v29
v_mov_b32 v31, v30
s_nop 1
v_permlane16_swap_b32 v30, v31
v_max_f32 v30, v30, v31
v_mov_b32 v31, v30
s_nop 1
v_permlane32_swap_b32 v30, v31
v_max_f32 v30, v30, v31
ds_write_b32 v1, v30 offset:10240
s_waitcnt lgkmcnt(0)
s_barrier
ds_read_b128 v[32:35], v1 offset:10240
s_waitcnt lgkmcnt(0)
v_max3_f32 v32, v32, v33, v34
v_max_f32 v32, v32, v35
v_sub_f32 v14, v12, v32
v_sub_f32 v15, v13, v32
v_sub_f32 v30, v28, v32
v_sub_f32 v31, v29, v32
v_exp_f32 v14, v14
v_exp_f32 v15, v15
v_exp_f32 v30, v30
v_exp_f32 v31, v31
v_cvt_pk_bf16_f32 v14, v14, v15
v_cvt_pk_bf16_f32 v30, v30, v31
ds_write_b32 v5, v14 offset:14368
v_cndmask_b32_e64 v26, 0, v30, s[56:57]
v_cndmask_b32_e64 v27, 0, v30, s[56:57]
v_mov_b64 v[76:77], s[52:53]
v_mov_b64 v[78:79], s[52:53]
v_mov_b32_dpp v24, v26 quad_perm:[2,3,0,1] row_mask:0xf bank_mask:0xf
v_mov_b32_dpp v25, v26 quad_perm:[2,3,0,1] row_mask:0xf bank_mask:0xf
s_waitcnt lgkmcnt(0)
s_barrier
v_mov_b64 v[14:15], s[0:1]
ds_read_b128 v[16:19], v1 offset:14368
ds_read_b128 v[36:39], v1 offset:14336
s_waitcnt lgkmcnt(0)
v_mfma_f32_16x16x32_bf16 v[32:35], v[76:79], v[16:19], 0
v_mfma_f32_16x16x32_bf16 v[20:23], v[52:55], v[16:19], 0
v_mfma_f32_16x16x32_bf16 v[20:23], v[56:59], v[36:39], v[20:23]
v_mfma_f32_16x16x16_bf16 v[32:35], v[14:15], v[26:27], v[32:35]
v_mfma_f32_16x16x32_bf16 v[20:23], v[40:43], v[24:27], v[20:23]
s_nop 3
v_rcp_f32 v33, v32
s_nop 2
v_mul_f32_dpp v20, v33, v20 quad_perm:[0,1,0,1] row_mask:0xf bank_mask:0xf
v_mul_f32_dpp v21, v33, v21 quad_perm:[0,1,0,1] row_mask:0xf bank_mask:0xf
v_mul_f32_dpp v22, v33, v22 quad_perm:[0,1,0,1] row_mask:0xf bank_mask:0xf
v_mul_f32_dpp v23, v33, v23 quad_perm:[0,1,0,1] row_mask:0xf bank_mask:0xf
v_cvt_pk_bf16_f32 v20, v20, v21
v_cvt_pk_bf16_f32 v21, v22, v23
ds_write_b64 v6, v[20:21] offset:5120
v_mov_b32_dpp v16, v20 quad_perm:[0,1,0,1] row_mask:0xf bank_mask:0xf
v_mov_b32_dpp v17, v21 quad_perm:[0,1,0,1] row_mask:0xf bank_mask:0xf
v_mov_b32_dpp v18, v20 quad_perm:[2,3,2,3] row_mask:0xf bank_mask:0xf
v_mov_b32_dpp v19, v21 quad_perm:[2,3,2,3] row_mask:0xf bank_mask:0xf
v_mov_b64 v[76:77], 0
v_mov_b64 v[78:79], 0
v_mov_b64 v[36:37], 0
v_mov_b64 v[38:39], 0
v_mov_b64 v[24:25], 0
v_mov_b64 v[26:27], 0
v_mov_b64 v[32:33], 0
v_mov_b64 v[34:35], 0
s_waitcnt lgkmcnt(0)
s_branch L_mxb_w0f

L_slow_w0:
v_mov_b64 v[20:21], 0
v_mov_b64 v[22:23], 0
v_mov_b64 v[24:25], 0
v_mov_b64 v[26:27], 0
v_mov_b64 v[28:29], 0
v_mov_b64 v[30:31], 0
v_mov_b64 v[32:33], 0
v_mov_b64 v[34:35], 0
v_mov_b64 v[36:37], 0
v_mov_b64 v[38:39], 0
v_mov_b64 v[40:41], 0
v_mov_b64 v[42:43], 0
ds_read_b128 v[44:47], v2 offset:0
ds_read_b128 v[48:51], v2 offset:1024
v_bfe_u32 v77, v1, 6, 1
v_lshl_add_u32 v77, v77, 3, v1
v_lshlrev_b32 v77, 1, v77
v_lshlrev_b32 v78, 3, v1
s_waitcnt vmcnt(0) lgkmcnt(0)
s_branch L_top_w0s
L_done_w0s:
s_waitcnt vmcnt(0) lgkmcnt(0)
s_endpgm
L_ra0_w0s:
s_mov_b32 m0, 1024
s_nop 0
buffer_load_dwordx4 v1, s[4:7], s47 offen offset:0 sc0 sc1 lds
buffer_load_dwordx4 v1, s[4:7], s47 offen offset:1024 sc0 sc1 lds
buffer_load_dwordx4 v1, s[4:7], s47 offen offset:2048 sc0 sc1 lds
buffer_load_dwordx4 v1, s[4:7], s47 offen offset:3072 sc0 sc1 lds
s_sub_u32 s41, s41, 1
s_cbranch_scc1 L_exit
ds_read_b128 v[44:47], v2 offset:0
ds_read_b128 v[48:51], v2 offset:1024
v_mov_b64 v[20:21], 0
v_mov_b64 v[22:23], 0
v_mov_b64 v[24:25], 0
v_mov_b64 v[26:27], 0
v_mov_b64 v[28:29], 0
v_mov_b64 v[30:31], 0
v_mov_b64 v[32:33], 0
v_mov_b64 v[34:35], 0
v_mov_b64 v[36:37], 0
v_mov_b64 v[38:39], 0
v_mov_b64 v[40:41], 0
v_mov_b64 v[42:43], 0
s_waitcnt vmcnt(0)
ds_read_b128 v[60:63], v1 offset:1024
ds_read_b128 v[64:67], v1 offset:2048
ds_read_b128 v[68:71], v1 offset:3072
ds_read_b128 v[72:75], v1 offset:4096
s_branch L_s0_w0s
L_ra1_w0s:
L_ra2_w0s:
s_waitcnt lgkmcnt(0)
s_barrier
s_mov_b32 m0, 5120
s_nop 0
buffer_load_dwordx4 v1, s[4:7], s48 offen offset:0 sc0 sc1 lds
s_mov_b32 m0, 9216
s_nop 0
buffer_load_dwordx4 v1, s[4:7], s49 offen offset:0 sc0 sc1 lds
s_sub_u32 s41, s41, 1
s_cbranch_scc1 L_exit
s_waitcnt vmcnt(0)
s_barrier
ds_read_b128 v[76:79], v1 offset:5120
ds_read_b128 v[60:63], v1 offset:6144
ds_read_b128 v[64:67], v1 offset:7168
ds_read_b128 v[68:71], v1 offset:8192
ds_read_b128 v[72:75], v1 offset:9216
s_waitcnt lgkmcnt(0)
v_bitop3_b32 v6, v76, v60, s35 bitop3:0x7e
v_bitop3_b32 v6, v6, v64, s35 bitop3:0xf6
v_bitop3_b32 v6, v6, v68, s35 bitop3:0xf6
v_bitop3_b32 v6, v6, v72, s35 bitop3:0xf6
v_and_b32 v6, 1, v6
v_cmp_ne_u32 vcc, 0, v6

s_cbranch_vccnz L_ra2_w0s
s_branch L_a1_w0s
L_mx_w0s:
s_waitcnt lgkmcnt(0)
v_max3_f32 v30, v12, v13, v28
v_max_f32 v30, v30, v29
v_mov_b32 v31, v30
s_nop 1
v_permlane16_swap_b32 v30, v31
v_max_f32 v30, v30, v31
v_mov_b32 v31, v30
s_nop 1
v_permlane32_swap_b32 v30, v31
v_max_f32 v30, v30, v31
ds_write_b32 v1, v30 offset:10240
s_waitcnt lgkmcnt(0)
s_barrier
ds_read_b128 v[32:35], v1 offset:10240
s_waitcnt lgkmcnt(0)
v_max3_f32 v32, v32, v33, v34
v_max_f32 v32, v32, v35
v_sub_f32 v14, v12, v32
v_sub_f32 v15, v13, v32
v_sub_f32 v30, v28, v32
v_sub_f32 v31, v29, v32
v_exp_f32 v14, v14
v_exp_f32 v15, v15
v_exp_f32 v30, v30
v_exp_f32 v31, v31
v_cvt_pk_bf16_f32 v14, v14, v15
v_cvt_pk_bf16_f32 v30, v30, v31
ds_write_b32 v5, v14 offset:14368
v_cndmask_b32_e64 v26, 0, v30, s[56:57]
v_cndmask_b32_e64 v27, 0, v30, s[56:57]
v_mov_b64 v[76:77], s[52:53]
v_mov_b64 v[78:79], s[52:53]
v_mov_b32_dpp v24, v26 quad_perm:[2,3,0,1] row_mask:0xf bank_mask:0xf
v_mov_b32_dpp v25, v26 quad_perm:[2,3,0,1] row_mask:0xf bank_mask:0xf
s_waitcnt lgkmcnt(0)
s_barrier
v_mov_b64 v[14:15], s[0:1]
ds_read_b128 v[16:19], v1 offset:14368
ds_read_b128 v[36:39], v1 offset:14336
s_waitcnt lgkmcnt(0)
v_mfma_f32_16x16x32_bf16 v[32:35], v[76:79], v[16:19], 0
v_mfma_f32_16x16x32_bf16 v[20:23], v[52:55], v[16:19], 0
v_mfma_f32_16x16x32_bf16 v[20:23], v[56:59], v[36:39], v[20:23]
v_mfma_f32_16x16x16_bf16 v[32:35], v[14:15], v[26:27], v[32:35]
v_mfma_f32_16x16x32_bf16 v[20:23], v[40:43], v[24:27], v[20:23]
s_nop 3
v_rcp_f32 v33, v32
s_nop 2
v_mul_f32_dpp v20, v33, v20 quad_perm:[0,1,0,1] row_mask:0xf bank_mask:0xf
v_mul_f32_dpp v21, v33, v21 quad_perm:[0,1,0,1] row_mask:0xf bank_mask:0xf
v_mul_f32_dpp v22, v33, v22 quad_perm:[0,1,0,1] row_mask:0xf bank_mask:0xf
v_mul_f32_dpp v23, v33, v23 quad_perm:[0,1,0,1] row_mask:0xf bank_mask:0xf
v_cvt_pk_bf16_f32 v20, v20, v21
v_cvt_pk_bf16_f32 v21, v22, v23
ds_write_b64 v6, v[20:21] offset:5120
v_mov_b32_dpp v16, v20 quad_perm:[0,1,0,1] row_mask:0xf bank_mask:0xf
v_mov_b32_dpp v17, v21 quad_perm:[0,1,0,1] row_mask:0xf bank_mask:0xf
v_mov_b32_dpp v18, v20 quad_perm:[2,3,2,3] row_mask:0xf bank_mask:0xf
v_mov_b32_dpp v19, v21 quad_perm:[2,3,2,3] row_mask:0xf bank_mask:0xf
v_mov_b64 v[76:77], 0
v_mov_b64 v[78:79], 0
v_mov_b64 v[36:37], 0
v_mov_b64 v[38:39], 0
v_mov_b64 v[24:25], 0
v_mov_b64 v[26:27], 0
v_mov_b64 v[32:33], 0
v_mov_b64 v[34:35], 0
s_waitcnt lgkmcnt(0)
s_branch L_mxb_w0s

L_pro_w0r:
v_and_b32 v20, 63, v0
v_lshlrev_b32 v1, 4, v20
v_add_u32 v2, 16384, v1
v_and_b32 v23, 1, v22
v_lshl_add_u32 v23, v24, 4, v23
v_mul_u32_u24 v23, 1152, v23
v_lshlrev_b32 v28, 2, v22
v_xor_b32 v28, v28, v21
v_lshl_add_u32 v28, v28, 4, v23
s_mul_i32 s55, s32, 147456
v_lshrrev_b32 v23, 2, v21
v_and_b32 v24, 1, v21
v_lshl_add_u32 v23, v23, 1, v24
v_mul_u32_u24 v23, 1152, v23
v_lshl_add_u32 v23, v22, 5, v23
v_bfe_u32 v24, v21, 1, 1
v_lshl_add_u32 v23, v24, 4, v23
s_lshl_b32 s56, s32, 7
s_waitcnt lgkmcnt(0)
buffer_load_dwordx4 v[12:15], v23, s[24:27], s56 offen
v_and_b32 v23, 1, v22
v_lshrrev_b32 v24, 2, v21
v_lshl_add_u32 v23, v23, 2, v24
v_lshlrev_b32 v23, 1, v23
v_bfe_u32 v44, v21, 1, 1
v_add_u32 v44, 0, v44
v_xor_b32 v44, v44, v23
v_lshlrev_b32 v44, 4, v44
v_lshl_add_u32 v44, v24, 8, v44
v_and_b32 v23, 1, v22
v_lshl_add_u32 v44, v23, 11, v44
v_and_b32 v23, 1, v21
v_lshl_add_u32 v44, v23, 3, v44
v_lshrrev_b32 v23, 1, v22
v_mul_u32_u24 v23, 40960, v23
v_add_u32 v23, 16384, v23
v_add_u32 v44, v44, v23
v_and_b32 v23, 1, v22
v_lshrrev_b32 v24, 2, v21
v_lshl_add_u32 v23, v23, 2, v24
v_lshlrev_b32 v23, 1, v23
v_bfe_u32 v45, v21, 1, 1
v_add_u32 v45, 2, v45
v_xor_b32 v45, v45, v23
v_lshlrev_b32 v45, 4, v45
v_lshl_add_u32 v45, v24, 8, v45
v_and_b32 v23, 1, v22
v_lshl_add_u32 v45, v23, 11, v45
v_and_b32 v23, 1, v21
v_lshl_add_u32 v45, v23, 3, v45
v_lshrrev_b32 v23, 1, v22
v_mul_u32_u24 v23, 40960, v23
v_add_u32 v23, 16384, v23
v_add_u32 v45, v45, v23
v_and_b32 v23, 1, v22
v_lshrrev_b32 v24, 2, v21
v_lshl_add_u32 v23, v23, 2, v24
v_lshlrev_b32 v23, 1, v23
v_bfe_u32 v46, v21, 1, 1
v_add_u32 v46, 0, v46
v_xor_b32 v46, v46, v23
v_lshlrev_b32 v46, 4, v46
v_lshl_add_u32 v46, v24, 8, v46
v_and_b32 v23, 1, v22
v_lshl_add_u32 v46, v23, 11, v46
v_and_b32 v23, 1, v21
v_lshl_add_u32 v46, v23, 3, v46
v_lshrrev_b32 v23, 1, v22
v_mul_u32_u24 v23, 32768, v23
v_add_u32 v23, 98304, v23
v_add_u32 v46, v46, v23
v_and_b32 v23, 1, v22
v_lshrrev_b32 v24, 2, v21
v_lshl_add_u32 v23, v23, 2, v24
v_lshlrev_b32 v23, 1, v23
v_bfe_u32 v47, v21, 1, 1
v_add_u32 v47, 2, v47
v_xor_b32 v47, v47, v23
v_lshlrev_b32 v47, 4, v47
v_lshl_add_u32 v47, v24, 8, v47
v_and_b32 v23, 1, v22
v_lshl_add_u32 v47, v23, 11, v47
v_and_b32 v23, 1, v21
v_lshl_add_u32 v47, v23, 3, v47
v_lshrrev_b32 v23, 1, v22
v_mul_u32_u24 v23, 32768, v23
v_add_u32 v23, 98304, v23
v_add_u32 v47, v47, v23
v_and_b32 v23, 1, v22
v_bfe_u32 v24, v21, 2, 1
v_lshl_add_u32 v23, v23, 1, v24
v_xor_b32 v24, 0, v23
v_lshlrev_b32 v24, 6, v24
v_lshl_add_u32 v48, v23, 8, v24
v_and_b32 v23, 3, v21
v_lshl_add_u32 v48, v23, 4, v48
v_and_b32 v23, 8, v21
v_add_u32 v48, v48, v23
v_lshrrev_b32 v23, 1, v22
v_mul_u32_u24 v23, 40960, v23
v_add_u32 v23, 16384, v23
v_add_u32 v48, v48, v23
v_and_b32 v23, 1, v22
v_bfe_u32 v24, v21, 2, 1
v_lshl_add_u32 v23, v23, 1, v24
v_xor_b32 v24, 0, v23
v_lshlrev_b32 v24, 6, v24
v_lshl_add_u32 v49, v23, 8, v24
v_and_b32 v23, 3, v21
v_lshl_add_u32 v49, v23, 4, v49
v_and_b32 v23, 8, v21
v_add_u32 v49, v49, v23
v_lshrrev_b32 v23, 1, v22
v_mul_u32_u24 v23, 32768, v23
v_add_u32 v23, 98304, v23
v_add_u32 v49, v49, v23
v_bfe_u32 v23, v21, 1, 1
v_mul_u32_u24 v23, 0xaaaa, v23
v_add_u32 v0, 0x4444, v23
v_lshlrev_b32 v3, 3, v20
v_lshrrev_b32 v25, 5, v20
v_lshlrev_b32 v25, 6, v25
v_xor_b32 v3, v3, v25
v_lshrrev_b32 v25, 2, v20
v_and_b32 v4, 3, v21
v_lshl_add_u32 v4, v4, 4, v25
v_lshlrev_b32 v4, 3, v4
v_bfe_u32 v25, v21, 1, 1
v_lshlrev_b32 v23, 6, v25
v_xor_b32 v4, v4, v23
v_lshlrev_b32 v5, 4, v21
v_lshl_add_u32 v5, v22, 2, v5
v_mul_u32_u24 v23, 1024, v25
v_add_u32 v5, v5, v23
v_lshlrev_b32 v9, 8, v22
v_lshl_add_u32 v9, v25, 6, v9
v_bfe_u32 v23, v21, 3, 1
v_lshl_add_u32 v9, v23, 7, v9
v_bfe_u32 v23, v21, 2, 1
v_lshl_add_u32 v9, v23, 5, v9
v_and_b32 v23, 1, v21
v_lshl_add_u32 v9, v23, 4, v9
v_lshrrev_b32 v23, 1, v22
v_and_b32 v24, 1, v22
v_and_b32 v25, 7, v21
v_lshrrev_b32 v7, 3, v21
v_lshl_add_u32 v8, v7, 1, v23
v_lshlrev_b32 v8, 12, v8
v_lshl_add_u32 v8, v24, 7, v8
v_and_b32 v25, 4, v21
v_lshl_add_u32 v8, v25, 3, v8
v_and_b32 v25, 1, v21
v_lshl_add_u32 v8, v25, 4, v8
v_bfe_u32 v25, v21, 1, 1
v_lshl_add_u32 v8, v25, 3, v8
s_lshr_b32 s56, s32, 1
s_lshl_b32 s56, s56, 8
s_and_b32 s57, s32, 1
s_lshl_b32 s57, s57, 6
s_add_u32 s56, s56, s57
s_add_u32 s56, s56, 0
v_add_u32 v8, s56, v8
v_and_b32 v7, 0x3d0, v1
s_mov_b32 s42, 0
s_mov_b32 s43, 65536
s_mov_b32 s44, 131072
s_mov_b32 s45, 196608
s_mov_b32 s46, 262144
s_mov_b32 s47, 294912
s_mov_b32 s48, 299008
s_mov_b32 s49, 303104
s_mov_b32 s50, 0x3e0293ee
s_mov_b32 s51, 0x3e0293ee
s_mov_b32 s52, 0x3f803f80
s_mov_b32 s53, 0x3f803f80
v_lshlrev_b32 v11, 2, v21
s_mov_b32 s34, 0
s_mov_b32 s35, -1
s_mov_b32 s36, 0
s_mov_b32 s41, 300000
s_lshl_b32 s37, s32, 14
s_add_u32 s39, s37, 17301504
s_add_u32 s37, s37, 16777216
s_mov_b32 s40, 8749056
v_mov_b64 v[36:37], 0
v_mov_b64 v[38:39], 0
ds_write_b128 v1, v[36:39] offset:14336
s_lshl_b32 s56, s32, 1
s_add_u32 s56, s56, 0
s_cmp_eq_u32 s56, 0
s_cselect_b32 s56, 64, s56
s_mul_i32 s56, s56, 10240
s_add_u32 s56, s56, 8388608
s_add_u32 s57, s56, 4096
v_mov_b32 v40, 0
v_mov_b32 v41, 0
v_mov_b32 v42, 0
v_mov_b32 v43, 0
buffer_store_dwordx4 v[40:43], v1, s[4:7], s56 offen offset:0 sc0 sc1
buffer_store_dwordx4 v[40:43], v1, s[4:7], s56 offen offset:1024 sc0 sc1
buffer_store_dwordx4 v[40:43], v1, s[4:7], s56 offen offset:2048 sc0 sc1
buffer_store_dwordx4 v[40:43], v1, s[4:7], s56 offen offset:3072 sc0 sc1
s_add_u32 s56, s32, 64
s_lshl_b32 s3, s56, 12
v_and_b32 v23, 1, v21
v_bfe_u32 v24, v21, 2, 1
v_bfe_u32 v25, v21, 1, 1
s_lshl_b32 s57, s56, 7
s_add_u32 s57, s57, 294912
v_and_b32 v10, 7, v21
v_lshlrev_b32 v10, 2, v10
v_lshl_add_u32 v10, v22, 5, v10
v_add_u32 v10, s57, v10
s_lshl_b32 s33, s56, 2
s_add_u32 s33, s33, 304128
v_mov_b32 v30, -1
s_mov_b64 exec, 1
buffer_store_dword v30, v1, s[4:7], s33 offen sc0 sc1
s_mov_b64 exec, -1
v_lshl_add_u32 v23, v23, 1, v24
v_lshlrev_b32 v25, 4, v25
v_mov_b32 v24, 0x3f80
v_lshlrev_b32 v24, v25, v24
v_cmp_eq_u32 vcc, 0, v23
s_nop 1
v_cndmask_b32 v76, 0, v24, vcc
v_cmp_eq_u32 vcc, 1, v23
s_nop 1
v_cndmask_b32 v77, 0, v24, vcc
v_cmp_eq_u32 vcc, 2, v23
s_nop 1
v_cndmask_b32 v78, 0, v24, vcc
v_cmp_eq_u32 vcc, 3, v23
s_nop 1
v_cndmask_b32 v79, 0, v24, vcc
buffer_store_dwordx4 v[36:39], v9, s[4:7], s3 offen offset:0 sc0 sc1
buffer_store_dwordx4 v[36:39], v9, s[4:7], s3 offen offset:1024 sc0 sc1
buffer_store_dwordx4 v[36:39], v9, s[4:7], s3 offen offset:2048 sc0 sc1
buffer_store_dwordx4 v[36:39], v9, s[4:7], s3 offen offset:3072 sc0 sc1
s_lshl_b32 s56, s32, 10
s_cmp_ge_u32 s32, 9
s_cselect_b32 s56, 268435456, s56
s_add_u32 s57, s56, 8388608
s_add_u32 s56, s56, 294912
s_waitcnt vmcnt(9)
v_or_b32 v12, 1, v12
buffer_store_dwordx4 v[12:15], v1, s[4:7], s56 offen sc0 sc1
buffer_store_dwordx4 v[12:15], v1, s[4:7], s57 offen sc0 sc1
s_getreg_b32 s56, hwreg(HW_REG_XCC_ID)
s_and_b32 s56, s56, 15
s_mul_i32 s57, s56, s56
s_lshl_b32 s57, s57, 18
s_lshl_b32 s56, s56, 8
s_add_u32 s57, s57, s56
s_add_u32 s58, s57, 1
s_lshl_b32 s101, s32, 7
s_add_u32 s101, s101, 327680
v_mov_b32 v24, 0
s_add_u32 s56, s54, 0
s_mov_b32 m0, 28672
s_nop 0
buffer_load_dwordx4 v26, s[12:15], s56 offen lds
s_add_u32 s56, s54, 16384
s_mov_b32 m0, 29696
s_nop 0
buffer_load_dwordx4 v26, s[12:15], s56 offen lds
s_add_u32 s56, s54, 32768
s_mov_b32 m0, 30720
s_nop 0
buffer_load_dwordx4 v27, s[12:15], s56 offen lds
s_add_u32 s56, s54, 49152
s_mov_b32 m0, 31744
s_nop 0
buffer_load_dwordx4 v27, s[12:15], s56 offen lds
s_add_u32 s56, s54, 524288
s_mov_b32 m0, 32768
s_nop 0
buffer_load_dwordx4 v26, s[12:15], s56 offen lds
s_add_u32 s56, s54, 540672
s_mov_b32 m0, 33792
s_nop 0
buffer_load_dwordx4 v26, s[12:15], s56 offen lds
s_add_u32 s56, s54, 557056
s_mov_b32 m0, 34816
s_nop 0
buffer_load_dwordx4 v27, s[12:15], s56 offen lds
s_add_u32 s56, s54, 573440
s_mov_b32 m0, 35840
s_nop 0
buffer_load_dwordx4 v27, s[12:15], s56 offen lds
v_and_b32 v23, 3, v20
v_lshrrev_b32 v24, 2, v20
v_mul_u32_u24 v29, 1152, v24
v_lshl_add_u32 v29, v23, 4, v29
v_lshrrev_b32 v24, 2, v21
v_and_b32 v25, 1, v22
v_lshlrev_b32 v31, 10, v25
v_lshrrev_b32 v25, 1, v22
v_lshl_add_u32 v31, v25, 8, v31
v_and_b32 v25, 1, v24
v_lshl_add_u32 v31, v25, 6, v31
v_lshrrev_b32 v25, 1, v24
v_lshl_add_u32 v31, v25, 3, v31
v_lshl_add_u32 v31, v23, 4, v31
v_add_u32 v31, 16384, v31
s_add_u32 s56, s55, 1024
s_mov_b32 m0, 49152
s_nop 0
buffer_load_dwordx4 v29, s[20:23], s56 offen lds
s_add_u32 s56, s55, 19456
s_mov_b32 m0, 50176
s_nop 0
buffer_load_dwordx4 v29, s[20:23], s56 offen lds
s_add_u32 s56, s55, 37888
s_mov_b32 m0, 51200
s_nop 0
buffer_load_dwordx4 v29, s[20:23], s56 offen lds
s_add_u32 s56, s55, 56320
s_mov_b32 m0, 52224
s_nop 0
buffer_load_dwordx4 v29, s[20:23], s56 offen lds
s_add_u32 s56, s55, 74752
s_mov_b32 m0, 53248
s_nop 0
buffer_load_dwordx4 v29, s[20:23], s56 offen lds
s_add_u32 s56, s55, 93184
s_mov_b32 m0, 54272
s_nop 0
buffer_load_dwordx4 v29, s[20:23], s56 offen lds
s_add_u32 s56, s55, 111616
s_mov_b32 m0, 55296
s_nop 0
buffer_load_dwordx4 v29, s[20:23], s56 offen lds
s_add_u32 s56, s55, 130048
s_mov_b32 m0, 56320
s_nop 0
buffer_load_dwordx4 v29, s[20:23], s56 offen lds
v_mov_b32 v24, 0
s_barrier
ds_read_b64_tr_b16 v[80:81], v44 offset:20480
ds_read_b64_tr_b16 v[82:83], v44 offset:21504
ds_read_b64_tr_b16 v[84:85], v46 offset:20480
ds_read_b64_tr_b16 v[86:87], v46 offset:21504
ds_read_b64_tr_b16 v[88:89], v45 offset:20480
ds_read_b64_tr_b16 v[90:91], v45 offset:21504
ds_read_b64_tr_b16 v[92:93], v47 offset:20480
ds_read_b64_tr_b16 v[94:95], v47 offset:21504
s_waitcnt lgkmcnt(0)
s_barrier
s_add_u32 s56, s54, 1048576
s_mov_b32 m0, 36864
s_nop 0
buffer_load_dwordx4 v26, s[12:15], s56 offen lds
s_add_u32 s56, s54, 1064960
s_mov_b32 m0, 37888
s_nop 0
buffer_load_dwordx4 v26, s[12:15], s56 offen lds
s_add_u32 s56, s54, 1081344
s_mov_b32 m0, 38912
s_nop 0
buffer_load_dwordx4 v27, s[12:15], s56 offen lds
s_add_u32 s56, s54, 1097728
s_mov_b32 m0, 39936
s_nop 0
buffer_load_dwordx4 v27, s[12:15], s56 offen lds
ds_read_b64_tr_b16 v[96:97], v44 offset:24576
ds_read_b64_tr_b16 v[98:99], v44 offset:25600
ds_read_b64_tr_b16 v[100:101], v46 offset:24576
ds_read_b64_tr_b16 v[102:103], v46 offset:25600
ds_read_b64_tr_b16 v[104:105], v45 offset:24576
ds_read_b64_tr_b16 v[106:107], v45 offset:25600
ds_read_b64_tr_b16 v[108:109], v47 offset:24576
ds_read_b64_tr_b16 v[110:111], v47 offset:25600
s_waitcnt lgkmcnt(0)
s_barrier
s_add_u32 s56, s54, 1572864
s_mov_b32 m0, 40960
s_nop 0
buffer_load_dwordx4 v26, s[12:15], s56 offen lds
s_add_u32 s56, s54, 1589248
s_mov_b32 m0, 41984
s_nop 0
buffer_load_dwordx4 v26, s[12:15], s56 offen lds
s_add_u32 s56, s54, 1605632
s_mov_b32 m0, 43008
s_nop 0
buffer_load_dwordx4 v27, s[12:15], s56 offen lds
s_add_u32 s56, s54, 1622016
s_mov_b32 m0, 44032
s_nop 0
buffer_load_dwordx4 v27, s[12:15], s56 offen lds
ds_read_b64_tr_b16 v[112:113], v44 offset:28672
ds_read_b64_tr_b16 v[114:115], v44 offset:29696
ds_read_b64_tr_b16 v[116:117], v46 offset:28672
ds_read_b64_tr_b16 v[118:119], v46 offset:29696
ds_read_b64_tr_b16 v[120:121], v45 offset:28672
ds_read_b64_tr_b16 v[122:123], v45 offset:29696
ds_read_b64_tr_b16 v[124:125], v47 offset:28672
ds_read_b64_tr_b16 v[126:127], v47 offset:29696
s_waitcnt lgkmcnt(0)
s_barrier
s_add_u32 s56, s54, 2097152
s_mov_b32 m0, 45056
s_nop 0
buffer_load_dwordx4 v26, s[12:15], s56 offen lds
s_add_u32 s56, s54, 2113536
s_mov_b32 m0, 46080
s_nop 0
buffer_load_dwordx4 v26, s[12:15], s56 offen lds
s_add_u32 s56, s54, 2129920
s_mov_b32 m0, 47104
s_nop 0
buffer_load_dwordx4 v27, s[12:15], s56 offen lds
s_add_u32 s56, s54, 2146304
s_mov_b32 m0, 48128
s_nop 0
buffer_load_dwordx4 v27, s[12:15], s56 offen lds
ds_read_b64_tr_b16 v[128:129], v44 offset:0
ds_read_b64_tr_b16 v[130:131], v44 offset:1024
ds_read_b64_tr_b16 v[132:133], v46 offset:0
ds_read_b64_tr_b16 v[134:135], v46 offset:1024
ds_read_b64_tr_b16 v[136:137], v45 offset:0
ds_read_b64_tr_b16 v[138:139], v45 offset:1024
ds_read_b64_tr_b16 v[140:141], v47 offset:0
ds_read_b64_tr_b16 v[142:143], v47 offset:1024
s_waitcnt lgkmcnt(0)
s_barrier
s_add_u32 s56, s54, 3145728
s_mov_b32 m0, 16384
s_nop 0
buffer_load_dwordx4 v26, s[12:15], s56 offen lds
s_add_u32 s56, s54, 3162112
s_mov_b32 m0, 17408
s_nop 0
buffer_load_dwordx4 v26, s[12:15], s56 offen lds
s_add_u32 s56, s54, 3178496
s_mov_b32 m0, 18432
s_nop 0
buffer_load_dwordx4 v27, s[12:15], s56 offen lds
s_add_u32 s56, s54, 3194880
s_mov_b32 m0, 19456
s_nop 0
buffer_load_dwordx4 v27, s[12:15], s56 offen lds
ds_read_b64_tr_b16 v[144:145], v44 offset:4096
ds_read_b64_tr_b16 v[146:147], v44 offset:5120
ds_read_b64_tr_b16 v[148:149], v46 offset:4096
ds_read_b64_tr_b16 v[150:151], v46 offset:5120
ds_read_b64_tr_b16 v[152:153], v45 offset:4096
ds_read_b64_tr_b16 v[154:155], v45 offset:5120
ds_read_b64_tr_b16 v[156:157], v47 offset:4096
ds_read_b64_tr_b16 v[158:159], v47 offset:5120
s_waitcnt lgkmcnt(0)
s_barrier
s_add_u32 s56, s54, 3670016
s_mov_b32 m0, 20480
s_nop 0
buffer_load_dwordx4 v26, s[12:15], s56 offen lds
s_add_u32 s56, s54, 3686400
s_mov_b32 m0, 21504
s_nop 0
buffer_load_dwordx4 v26, s[12:15], s56 offen lds
s_add_u32 s56, s54, 3702784
s_mov_b32 m0, 22528
s_nop 0
buffer_load_dwordx4 v27, s[12:15], s56 offen lds
s_add_u32 s56, s54, 3719168
s_mov_b32 m0, 23552
s_nop 0
buffer_load_dwordx4 v27, s[12:15], s56 offen lds
ds_read_b64_tr_b16 v[160:161], v44 offset:8192
ds_read_b64_tr_b16 v[162:163], v44 offset:9216
ds_read_b64_tr_b16 v[164:165], v46 offset:8192
ds_read_b64_tr_b16 v[166:167], v46 offset:9216
ds_read_b64_tr_b16 v[168:169], v45 offset:8192
ds_read_b64_tr_b16 v[170:171], v45 offset:9216
ds_read_b64_tr_b16 v[172:173], v47 offset:8192
ds_read_b64_tr_b16 v[174:175], v47 offset:9216
s_waitcnt lgkmcnt(0)
s_waitcnt vmcnt(32)
s_barrier
s_add_u32 s56, s54, 4194304
s_mov_b32 m0, 24576
s_nop 0
buffer_load_dwordx4 v26, s[12:15], s56 offen lds
s_add_u32 s56, s54, 4210688
s_mov_b32 m0, 25600
s_nop 0
buffer_load_dwordx4 v26, s[12:15], s56 offen lds
s_add_u32 s56, s54, 4227072
s_mov_b32 m0, 26624
s_nop 0
buffer_load_dwordx4 v27, s[12:15], s56 offen lds
s_add_u32 s56, s54, 4243456
s_mov_b32 m0, 27648
s_nop 0
buffer_load_dwordx4 v27, s[12:15], s56 offen lds
ds_read_b64_tr_b16 v[176:177], v44 offset:12288
ds_read_b64_tr_b16 v[178:179], v44 offset:13312
ds_read_b64_tr_b16 v[180:181], v46 offset:12288
ds_read_b64_tr_b16 v[182:183], v46 offset:13312
ds_read_b64_tr_b16 v[184:185], v45 offset:12288
ds_read_b64_tr_b16 v[186:187], v45 offset:13312
ds_read_b64_tr_b16 v[188:189], v47 offset:12288
ds_read_b64_tr_b16 v[190:191], v47 offset:13312
v_mov_b32 v23, s58
s_mov_b64 exec, 1
buffer_atomic_add v23, v24, s[28:31], 0 offen sc1
s_mov_b64 exec, -1
s_waitcnt lgkmcnt(0)
s_waitcnt vmcnt(33)
s_barrier
s_add_u32 s56, s54, 0
s_mov_b32 m0, 28672
s_nop 0
buffer_load_dwordx4 v26, s[16:19], s56 offen lds
s_add_u32 s56, s54, 16384
s_mov_b32 m0, 29696
s_nop 0
buffer_load_dwordx4 v26, s[16:19], s56 offen lds
s_add_u32 s56, s54, 32768
s_mov_b32 m0, 30720
s_nop 0
buffer_load_dwordx4 v27, s[16:19], s56 offen lds
s_add_u32 s56, s54, 49152
s_mov_b32 m0, 31744
s_nop 0
buffer_load_dwordx4 v27, s[16:19], s56 offen lds
ds_read_b64_tr_b16 v[192:193], v44 offset:16384
ds_read_b64_tr_b16 v[194:195], v44 offset:17408
ds_read_b64_tr_b16 v[196:197], v46 offset:16384
ds_read_b64_tr_b16 v[198:199], v46 offset:17408
ds_read_b64_tr_b16 v[200:201], v45 offset:16384
ds_read_b64_tr_b16 v[202:203], v45 offset:17408
ds_read_b64_tr_b16 v[204:205], v47 offset:16384
ds_read_b64_tr_b16 v[206:207], v47 offset:17408
s_waitcnt lgkmcnt(0)
s_waitcnt vmcnt(25)
s_barrier
s_add_u32 s56, s54, 524288
s_mov_b32 m0, 32768
s_nop 0
buffer_load_dwordx4 v26, s[16:19], s56 offen lds
s_add_u32 s56, s54, 540672
s_mov_b32 m0, 33792
s_nop 0
buffer_load_dwordx4 v26, s[16:19], s56 offen lds
s_add_u32 s56, s54, 557056
s_mov_b32 m0, 34816
s_nop 0
buffer_load_dwordx4 v27, s[16:19], s56 offen lds
s_add_u32 s56, s54, 573440
s_mov_b32 m0, 35840
s_nop 0
buffer_load_dwordx4 v27, s[16:19], s56 offen lds
ds_read_b64_tr_b16 v[208:209], v44 offset:20480
ds_read_b64_tr_b16 v[210:211], v44 offset:21504
ds_read_b64_tr_b16 v[212:213], v46 offset:20480
ds_read_b64_tr_b16 v[214:215], v46 offset:21504
ds_read_b64_tr_b16 v[216:217], v45 offset:20480
ds_read_b64_tr_b16 v[218:219], v45 offset:21504
ds_read_b64_tr_b16 v[220:221], v47 offset:20480
ds_read_b64_tr_b16 v[222:223], v47 offset:21504
s_waitcnt lgkmcnt(0)
s_waitcnt vmcnt(25)
s_barrier
s_add_u32 s56, s54, 1048576
s_mov_b32 m0, 36864
s_nop 0
buffer_load_dwordx4 v26, s[16:19], s56 offen lds
s_add_u32 s56, s54, 1064960
s_mov_b32 m0, 37888
s_nop 0
buffer_load_dwordx4 v26, s[16:19], s56 offen lds
s_add_u32 s56, s54, 1081344
s_mov_b32 m0, 38912
s_nop 0
buffer_load_dwordx4 v27, s[16:19], s56 offen lds
s_add_u32 s56, s54, 1097728
s_mov_b32 m0, 39936
s_nop 0
buffer_load_dwordx4 v27, s[16:19], s56 offen lds
ds_read_b64_tr_b16 v[224:225], v44 offset:24576
ds_read_b64_tr_b16 v[226:227], v44 offset:25600
ds_read_b64_tr_b16 v[228:229], v46 offset:24576
ds_read_b64_tr_b16 v[230:231], v46 offset:25600
ds_read_b64_tr_b16 v[232:233], v45 offset:24576
ds_read_b64_tr_b16 v[234:235], v45 offset:25600
ds_read_b64_tr_b16 v[236:237], v47 offset:24576
ds_read_b64_tr_b16 v[238:239], v47 offset:25600
ds_read_b64_tr_b16 v[60:61], v31 offset:32768
ds_read_b64_tr_b16 v[62:63], v31 offset:32896
ds_read_b64_tr_b16 v[64:65], v31 offset:33280
ds_read_b64_tr_b16 v[66:67], v31 offset:33408
ds_read_b64_tr_b16 v[68:69], v31 offset:34816
ds_read_b64_tr_b16 v[70:71], v31 offset:34944
ds_read_b64_tr_b16 v[72:73], v31 offset:35328
ds_read_b64_tr_b16 v[74:75], v31 offset:35456
s_waitcnt lgkmcnt(0)
ds_write_b128 v2, v[60:63] offset:32768
ds_write_b128 v2, v[64:67] offset:33792
ds_write_b128 v2, v[68:71] offset:34816
ds_write_b128 v2, v[72:75] offset:35840
s_waitcnt lgkmcnt(0)
s_waitcnt vmcnt(25)
s_barrier
s_add_u32 s56, s54, 1572864
s_mov_b32 m0, 40960
s_nop 0
buffer_load_dwordx4 v26, s[16:19], s56 offen lds
s_add_u32 s56, s54, 1589248
s_mov_b32 m0, 41984
s_nop 0
buffer_load_dwordx4 v26, s[16:19], s56 offen lds
s_add_u32 s56, s54, 1605632
s_mov_b32 m0, 43008
s_nop 0
buffer_load_dwordx4 v27, s[16:19], s56 offen lds
s_add_u32 s56, s54, 1622016
s_mov_b32 m0, 44032
s_nop 0
buffer_load_dwordx4 v27, s[16:19], s56 offen lds
ds_read_b64_tr_b16 v[240:241], v44 offset:28672
ds_read_b64_tr_b16 v[242:243], v44 offset:29696
ds_read_b64_tr_b16 v[244:245], v46 offset:28672
ds_read_b64_tr_b16 v[246:247], v46 offset:29696
ds_read_b64_tr_b16 v[248:249], v45 offset:28672
ds_read_b64_tr_b16 v[250:251], v45 offset:29696
ds_read_b64_tr_b16 v[252:253], v47 offset:28672
ds_read_b64_tr_b16 v[254:255], v47 offset:29696
ds_read_b64_tr_b16 v[60:61], v31 offset:36864
ds_read_b64_tr_b16 v[62:63], v31 offset:36992
ds_read_b64_tr_b16 v[64:65], v31 offset:37376
ds_read_b64_tr_b16 v[66:67], v31 offset:37504
ds_read_b64_tr_b16 v[68:69], v31 offset:38912
ds_read_b64_tr_b16 v[70:71], v31 offset:39040
ds_read_b64_tr_b16 v[72:73], v31 offset:39424
ds_read_b64_tr_b16 v[74:75], v31 offset:39552
s_waitcnt lgkmcnt(0)
ds_write_b128 v2, v[60:63] offset:36864
ds_write_b128 v2, v[64:67] offset:37888
ds_write_b128 v2, v[68:71] offset:38912
ds_write_b128 v2, v[72:75] offset:39936
s_waitcnt lgkmcnt(0)
s_waitcnt vmcnt(25)
s_barrier
s_add_u32 s56, s54, 2097152
s_mov_b32 m0, 45056
s_nop 0
buffer_load_dwordx4 v26, s[16:19], s56 offen lds
s_add_u32 s56, s54, 2113536
s_mov_b32 m0, 46080
s_nop 0
buffer_load_dwordx4 v26, s[16:19], s56 offen lds
s_add_u32 s56, s54, 2129920
s_mov_b32 m0, 47104
s_nop 0
buffer_load_dwordx4 v27, s[16:19], s56 offen lds
s_add_u32 s56, s54, 2146304
s_mov_b32 m0, 48128
s_nop 0
buffer_load_dwordx4 v27, s[16:19], s56 offen lds
ds_read_b64_tr_b16 a[0:1], v44 offset:0
ds_read_b64_tr_b16 a[2:3], v44 offset:1024
ds_read_b64_tr_b16 a[4:5], v46 offset:0
ds_read_b64_tr_b16 a[6:7], v46 offset:1024
ds_read_b64_tr_b16 a[8:9], v45 offset:0
ds_read_b64_tr_b16 a[10:11], v45 offset:1024
ds_read_b64_tr_b16 a[12:13], v47 offset:0
ds_read_b64_tr_b16 a[14:15], v47 offset:1024
s_waitcnt lgkmcnt(0)
s_waitcnt vmcnt(25)
s_barrier
s_add_u32 s56, s54, 2621440
s_mov_b32 m0, 16384
s_nop 0
buffer_load_dwordx4 v26, s[16:19], s56 offen lds
s_add_u32 s56, s54, 2637824
s_mov_b32 m0, 17408
s_nop 0
buffer_load_dwordx4 v26, s[16:19], s56 offen lds
s_add_u32 s56, s54, 2654208
s_mov_b32 m0, 18432
s_nop 0
buffer_load_dwordx4 v27, s[16:19], s56 offen lds
s_add_u32 s56, s54, 2670592
s_mov_b32 m0, 19456
s_nop 0
buffer_load_dwordx4 v27, s[16:19], s56 offen lds
ds_read_b64_tr_b16 a[16:17], v44 offset:4096
ds_read_b64_tr_b16 a[18:19], v44 offset:5120
ds_read_b64_tr_b16 a[20:21], v46 offset:4096
ds_read_b64_tr_b16 a[22:23], v46 offset:5120
ds_read_b64_tr_b16 a[24:25], v45 offset:4096
ds_read_b64_tr_b16 a[26:27], v45 offset:5120
ds_read_b64_tr_b16 a[28:29], v47 offset:4096
ds_read_b64_tr_b16 a[30:31], v47 offset:5120
s_waitcnt lgkmcnt(0)
s_waitcnt vmcnt(25)
s_barrier
s_add_u32 s56, s54, 3145728
s_mov_b32 m0, 20480
s_nop 0
buffer_load_dwordx4 v26, s[16:19], s56 offen lds
s_add_u32 s56, s54, 3162112
s_mov_b32 m0, 21504
s_nop 0
buffer_load_dwordx4 v26, s[16:19], s56 offen lds
s_add_u32 s56, s54, 3178496
s_mov_b32 m0, 22528
s_nop 0
buffer_load_dwordx4 v27, s[16:19], s56 offen lds
s_add_u32 s56, s54, 3194880
s_mov_b32 m0, 23552
s_nop 0
buffer_load_dwordx4 v27, s[16:19], s56 offen lds
ds_read_b64_tr_b16 a[32:33], v44 offset:8192
ds_read_b64_tr_b16 a[34:35], v44 offset:9216
ds_read_b64_tr_b16 a[36:37], v46 offset:8192
ds_read_b64_tr_b16 a[38:39], v46 offset:9216
ds_read_b64_tr_b16 a[40:41], v45 offset:8192
ds_read_b64_tr_b16 a[42:43], v45 offset:9216
ds_read_b64_tr_b16 a[44:45], v47 offset:8192
ds_read_b64_tr_b16 a[46:47], v47 offset:9216
s_waitcnt lgkmcnt(0)
s_waitcnt vmcnt(24)
s_barrier
s_add_u32 s56, s54, 3670016
s_mov_b32 m0, 24576
s_nop 0
buffer_load_dwordx4 v26, s[16:19], s56 offen lds
s_add_u32 s56, s54, 3686400
s_mov_b32 m0, 25600
s_nop 0
buffer_load_dwordx4 v26, s[16:19], s56 offen lds
s_add_u32 s56, s54, 3702784
s_mov_b32 m0, 26624
s_nop 0
buffer_load_dwordx4 v27, s[16:19], s56 offen lds
s_add_u32 s56, s54, 3719168
s_mov_b32 m0, 27648
s_nop 0
buffer_load_dwordx4 v27, s[16:19], s56 offen lds
ds_read_b64_tr_b16 a[48:49], v44 offset:12288
ds_read_b64_tr_b16 a[50:51], v44 offset:13312
ds_read_b64_tr_b16 a[52:53], v46 offset:12288
ds_read_b64_tr_b16 a[54:55], v46 offset:13312
ds_read_b64_tr_b16 a[56:57], v45 offset:12288
ds_read_b64_tr_b16 a[58:59], v45 offset:13312
ds_read_b64_tr_b16 a[60:61], v47 offset:12288
ds_read_b64_tr_b16 a[62:63], v47 offset:13312
s_waitcnt lgkmcnt(0)
s_waitcnt vmcnt(24)
s_barrier
s_add_u32 s56, s55, 73728
s_mov_b32 m0, 28672
s_nop 0
buffer_load_dwordx4 v28, s[20:23], s56 offen lds
s_add_u32 s56, s55, 76032
s_mov_b32 m0, 29696
s_nop 0
buffer_load_dwordx4 v28, s[20:23], s56 offen lds
s_add_u32 s56, s55, 82944
s_mov_b32 m0, 30720
s_nop 0
buffer_load_dwordx4 v28, s[20:23], s56 offen lds
s_add_u32 s56, s55, 85248
s_mov_b32 m0, 31744
s_nop 0
buffer_load_dwordx4 v28, s[20:23], s56 offen lds
ds_read_b64_tr_b16 a[64:65], v44 offset:16384
ds_read_b64_tr_b16 a[66:67], v44 offset:17408
ds_read_b64_tr_b16 a[68:69], v46 offset:16384
ds_read_b64_tr_b16 a[70:71], v46 offset:17408
ds_read_b64_tr_b16 a[72:73], v45 offset:16384
ds_read_b64_tr_b16 a[74:75], v45 offset:17408
ds_read_b64_tr_b16 a[76:77], v47 offset:16384
ds_read_b64_tr_b16 a[78:79], v47 offset:17408
s_waitcnt lgkmcnt(0)
s_waitcnt vmcnt(24)
s_barrier
s_add_u32 s56, s55, 73984
s_mov_b32 m0, 32768
s_nop 0
buffer_load_dwordx4 v28, s[20:23], s56 offen lds
s_add_u32 s56, s55, 76288
s_mov_b32 m0, 33792
s_nop 0
buffer_load_dwordx4 v28, s[20:23], s56 offen lds
s_add_u32 s56, s55, 83200
s_mov_b32 m0, 34816
s_nop 0
buffer_load_dwordx4 v28, s[20:23], s56 offen lds
s_add_u32 s56, s55, 85504
s_mov_b32 m0, 35840
s_nop 0
buffer_load_dwordx4 v28, s[20:23], s56 offen lds
ds_read_b64_tr_b16 a[80:81], v44 offset:20480
ds_read_b64_tr_b16 a[82:83], v44 offset:21504
ds_read_b64_tr_b16 a[84:85], v46 offset:20480
ds_read_b64_tr_b16 a[86:87], v46 offset:21504
ds_read_b64_tr_b16 a[88:89], v45 offset:20480
ds_read_b64_tr_b16 a[90:91], v45 offset:21504
ds_read_b64_tr_b16 a[92:93], v47 offset:20480
ds_read_b64_tr_b16 a[94:95], v47 offset:21504
s_waitcnt lgkmcnt(0)
s_waitcnt vmcnt(24)
s_barrier
s_add_u32 s56, s55, 74240
s_mov_b32 m0, 36864
s_nop 0
buffer_load_dwordx4 v28, s[20:23], s56 offen lds
s_add_u32 s56, s55, 76544
s_mov_b32 m0, 37888
s_nop 0
buffer_load_dwordx4 v28, s[20:23], s56 offen lds
s_add_u32 s56, s55, 83456
s_mov_b32 m0, 38912
s_nop 0
buffer_load_dwordx4 v28, s[20:23], s56 offen lds
s_add_u32 s56, s55, 85760
s_mov_b32 m0, 39936
s_nop 0
buffer_load_dwordx4 v28, s[20:23], s56 offen lds
ds_read_b64_tr_b16 a[96:97], v44 offset:24576
ds_read_b64_tr_b16 a[98:99], v44 offset:25600
ds_read_b64_tr_b16 a[100:101], v46 offset:24576
ds_read_b64_tr_b16 a[102:103], v46 offset:25600
ds_read_b64_tr_b16 a[104:105], v45 offset:24576
ds_read_b64_tr_b16 a[106:107], v45 offset:25600
ds_read_b64_tr_b16 a[108:109], v47 offset:24576
ds_read_b64_tr_b16 a[110:111], v47 offset:25600
s_waitcnt lgkmcnt(0)
s_waitcnt vmcnt(24)
s_barrier
s_add_u32 s56, s55, 74496
s_mov_b32 m0, 40960
s_nop 0
buffer_load_dwordx4 v28, s[20:23], s56 offen lds
s_add_u32 s56, s55, 76800
s_mov_b32 m0, 41984
s_nop 0
buffer_load_dwordx4 v28, s[20:23], s56 offen lds
s_add_u32 s56, s55, 83712
s_mov_b32 m0, 43008
s_nop 0
buffer_load_dwordx4 v28, s[20:23], s56 offen lds
s_add_u32 s56, s55, 86016
s_mov_b32 m0, 44032
s_nop 0
buffer_load_dwordx4 v28, s[20:23], s56 offen lds
ds_read_b64_tr_b16 a[112:113], v44 offset:28672
ds_read_b64_tr_b16 a[114:115], v44 offset:29696
ds_read_b64_tr_b16 a[116:117], v46 offset:28672
ds_read_b64_tr_b16 a[118:119], v46 offset:29696
ds_read_b64_tr_b16 a[120:121], v45 offset:28672
ds_read_b64_tr_b16 a[122:123], v45 offset:29696
ds_read_b64_tr_b16 a[124:125], v47 offset:28672
ds_read_b64_tr_b16 a[126:127], v47 offset:29696
s_waitcnt lgkmcnt(0)
s_waitcnt vmcnt(24)
s_barrier
s_add_u32 s56, s55, 0
s_mov_b32 m0, 45056
s_nop 0
buffer_load_dwordx4 v28, s[20:23], s56 offen lds
s_add_u32 s56, s55, 2304
s_mov_b32 m0, 46080
s_nop 0
buffer_load_dwordx4 v28, s[20:23], s56 offen lds
s_add_u32 s56, s55, 9216
s_mov_b32 m0, 47104
s_nop 0
buffer_load_dwordx4 v28, s[20:23], s56 offen lds
s_add_u32 s56, s55, 11520
s_mov_b32 m0, 48128
s_nop 0
buffer_load_dwordx4 v28, s[20:23], s56 offen lds
ds_read_b64_tr_b16 a[128:129], v44 offset:0
ds_read_b64_tr_b16 a[130:131], v44 offset:1024
ds_read_b64_tr_b16 a[132:133], v46 offset:0
ds_read_b64_tr_b16 a[134:135], v46 offset:1024
ds_read_b64_tr_b16 a[136:137], v45 offset:0
ds_read_b64_tr_b16 a[138:139], v45 offset:1024
ds_read_b64_tr_b16 a[140:141], v47 offset:0
ds_read_b64_tr_b16 a[142:143], v47 offset:1024
buffer_load_dword v32, v24, s[28:31], 0 offen sc0 sc1
s_waitcnt lgkmcnt(0)
s_waitcnt vmcnt(25)
s_barrier
s_add_u32 s56, s54, 0
s_mov_b32 m0, 16384
s_nop 0
buffer_load_dwordx4 v26, s[8:11], s56 offen lds
s_add_u32 s56, s54, 16384
s_mov_b32 m0, 17408
s_nop 0
buffer_load_dwordx4 v26, s[8:11], s56 offen lds
s_add_u32 s56, s54, 32768
s_mov_b32 m0, 18432
s_nop 0
buffer_load_dwordx4 v27, s[8:11], s56 offen lds
s_add_u32 s56, s54, 49152
s_mov_b32 m0, 19456
s_nop 0
buffer_load_dwordx4 v27, s[8:11], s56 offen lds
ds_read_b64_tr_b16 a[144:145], v44 offset:4096
ds_read_b64_tr_b16 a[146:147], v44 offset:5120
ds_read_b64_tr_b16 a[148:149], v46 offset:4096
ds_read_b64_tr_b16 a[150:151], v46 offset:5120
ds_read_b64_tr_b16 a[152:153], v45 offset:4096
ds_read_b64_tr_b16 a[154:155], v45 offset:5120
ds_read_b64_tr_b16 a[156:157], v47 offset:4096
ds_read_b64_tr_b16 a[158:159], v47 offset:5120
s_waitcnt lgkmcnt(0)
s_waitcnt vmcnt(25)
s_barrier
s_add_u32 s56, s54, 1572864
s_mov_b32 m0, 20480
s_nop 0
buffer_load_dwordx4 v26, s[8:11], s56 offen lds
s_add_u32 s56, s54, 1589248
s_mov_b32 m0, 21504
s_nop 0
buffer_load_dwordx4 v26, s[8:11], s56 offen lds
s_add_u32 s56, s54, 1605632
s_mov_b32 m0, 22528
s_nop 0
buffer_load_dwordx4 v27, s[8:11], s56 offen lds
s_add_u32 s56, s54, 1622016
s_mov_b32 m0, 23552
s_nop 0
buffer_load_dwordx4 v27, s[8:11], s56 offen lds
ds_read_b64_tr_b16 a[160:161], v44 offset:8192
ds_read_b64_tr_b16 a[162:163], v44 offset:9216
ds_read_b64_tr_b16 a[164:165], v46 offset:8192
ds_read_b64_tr_b16 a[166:167], v46 offset:9216
ds_read_b64_tr_b16 a[168:169], v45 offset:8192
ds_read_b64_tr_b16 a[170:171], v45 offset:9216
ds_read_b64_tr_b16 a[172:173], v47 offset:8192
ds_read_b64_tr_b16 a[174:175], v47 offset:9216
s_waitcnt lgkmcnt(0)
s_waitcnt vmcnt(25)
s_barrier
s_add_u32 s56, s54, 2097152
s_mov_b32 m0, 24576
s_nop 0
buffer_load_dwordx4 v26, s[8:11], s56 offen lds
s_add_u32 s56, s54, 2113536
s_mov_b32 m0, 25600
s_nop 0
buffer_load_dwordx4 v26, s[8:11], s56 offen lds
s_add_u32 s56, s54, 2129920
s_mov_b32 m0, 26624
s_nop 0
buffer_load_dwordx4 v27, s[8:11], s56 offen lds
s_add_u32 s56, s54, 2146304
s_mov_b32 m0, 27648
s_nop 0
buffer_load_dwordx4 v27, s[8:11], s56 offen lds
ds_read_b64_tr_b16 a[184:185], v48 offset:12288
ds_read_b64_tr_b16 a[186:187], v48 offset:13312
ds_read_b64_tr_b16 a[188:189], v48 offset:14336
ds_read_b64_tr_b16 a[190:191], v48 offset:15360
ds_read_b64_tr_b16 a[200:201], v49 offset:12288
ds_read_b64_tr_b16 a[202:203], v49 offset:13312
ds_read_b64_tr_b16 a[204:205], v49 offset:14336
ds_read_b64_tr_b16 a[206:207], v49 offset:15360
s_waitcnt lgkmcnt(0)
s_waitcnt vmcnt(25)
s_barrier
s_add_u32 s56, s54, 2621440
s_mov_b32 m0, 28672
s_nop 0
buffer_load_dwordx4 v26, s[12:15], s56 offen lds
s_add_u32 s56, s54, 2637824
s_mov_b32 m0, 29696
s_nop 0
buffer_load_dwordx4 v26, s[12:15], s56 offen lds
s_add_u32 s56, s54, 2654208
s_mov_b32 m0, 30720
s_nop 0
buffer_load_dwordx4 v27, s[12:15], s56 offen lds
s_add_u32 s56, s54, 2670592
s_mov_b32 m0, 31744
s_nop 0
buffer_load_dwordx4 v27, s[12:15], s56 offen lds
ds_read_b64_tr_b16 a[208:209], v48 offset:16384
ds_read_b64_tr_b16 a[210:211], v48 offset:17408
ds_read_b64_tr_b16 a[212:213], v48 offset:18432
ds_read_b64_tr_b16 a[214:215], v48 offset:19456
ds_read_b64_tr_b16 a[216:217], v49 offset:16384
ds_read_b64_tr_b16 a[218:219], v49 offset:17408
ds_read_b64_tr_b16 a[220:221], v49 offset:18432
ds_read_b64_tr_b16 a[222:223], v49 offset:19456
s_waitcnt lgkmcnt(0)
s_waitcnt vmcnt(25)
s_barrier
s_add_u32 s56, s54, 4194304
s_mov_b32 m0, 32768
s_nop 0
buffer_load_dwordx4 v26, s[16:19], s56 offen lds
s_add_u32 s56, s54, 4210688
s_mov_b32 m0, 33792
s_nop 0
buffer_load_dwordx4 v26, s[16:19], s56 offen lds
s_add_u32 s56, s54, 4227072
s_mov_b32 m0, 34816
s_nop 0
buffer_load_dwordx4 v27, s[16:19], s56 offen lds
s_add_u32 s56, s54, 4243456
s_mov_b32 m0, 35840
s_nop 0
buffer_load_dwordx4 v27, s[16:19], s56 offen lds
ds_read_b64_tr_b16 a[224:225], v48 offset:20480
ds_read_b64_tr_b16 a[226:227], v48 offset:21504
ds_read_b64_tr_b16 a[228:229], v48 offset:22528
ds_read_b64_tr_b16 a[230:231], v48 offset:23552
ds_read_b64_tr_b16 a[232:233], v49 offset:20480
ds_read_b64_tr_b16 a[234:235], v49 offset:21504
ds_read_b64_tr_b16 a[236:237], v49 offset:22528
ds_read_b64_tr_b16 a[238:239], v49 offset:23552
s_waitcnt lgkmcnt(0)
s_waitcnt vmcnt(25)
s_barrier
s_add_u32 s56, s55, 256
s_mov_b32 m0, 36864
s_nop 0
buffer_load_dwordx4 v28, s[20:23], s56 offen lds
s_add_u32 s56, s55, 2560
s_mov_b32 m0, 37888
s_nop 0
buffer_load_dwordx4 v28, s[20:23], s56 offen lds
s_add_u32 s56, s55, 9472
s_mov_b32 m0, 38912
s_nop 0
buffer_load_dwordx4 v28, s[20:23], s56 offen lds
s_add_u32 s56, s55, 11776
s_mov_b32 m0, 39936
s_nop 0
buffer_load_dwordx4 v28, s[20:23], s56 offen lds
ds_read_b64_tr_b16 a[240:241], v48 offset:24576
ds_read_b64_tr_b16 a[242:243], v48 offset:25600
ds_read_b64_tr_b16 a[244:245], v48 offset:26624
ds_read_b64_tr_b16 a[246:247], v48 offset:27648
ds_read_b64_tr_b16 a[248:249], v49 offset:24576
ds_read_b64_tr_b16 a[250:251], v49 offset:25600
ds_read_b64_tr_b16 a[252:253], v49 offset:26624
ds_read_b64_tr_b16 a[254:255], v49 offset:27648
s_waitcnt lgkmcnt(0)
s_waitcnt vmcnt(25)
s_barrier
s_add_u32 s56, s55, 512
s_mov_b32 m0, 40960
s_nop 0
buffer_load_dwordx4 v28, s[20:23], s56 offen lds
s_add_u32 s56, s55, 2816
s_mov_b32 m0, 41984
s_nop 0
buffer_load_dwordx4 v28, s[20:23], s56 offen lds
s_add_u32 s56, s55, 9728
s_mov_b32 m0, 43008
s_nop 0
buffer_load_dwordx4 v28, s[20:23], s56 offen lds
s_add_u32 s56, s55, 12032
s_mov_b32 m0, 44032
s_nop 0
buffer_load_dwordx4 v28, s[20:23], s56 offen lds
ds_read_b64_tr_b16 a[176:177], v48 offset:28672
ds_read_b64_tr_b16 a[178:179], v48 offset:29696
ds_read_b64_tr_b16 a[180:181], v48 offset:30720
ds_read_b64_tr_b16 a[182:183], v48 offset:31744
ds_read_b64_tr_b16 a[192:193], v49 offset:28672
ds_read_b64_tr_b16 a[194:195], v49 offset:29696
ds_read_b64_tr_b16 a[196:197], v49 offset:30720
ds_read_b64_tr_b16 a[198:199], v49 offset:31744
s_waitcnt lgkmcnt(0)
s_waitcnt vmcnt(24)
s_barrier
s_add_u32 s56, s55, 768
s_mov_b32 m0, 45056
s_nop 0
buffer_load_dwordx4 v28, s[20:23], s56 offen lds
s_add_u32 s56, s55, 3072
s_mov_b32 m0, 46080
s_nop 0
buffer_load_dwordx4 v28, s[20:23], s56 offen lds
s_add_u32 s56, s55, 9984
s_mov_b32 m0, 47104
s_nop 0
buffer_load_dwordx4 v28, s[20:23], s56 offen lds
s_add_u32 s56, s55, 12288
s_mov_b32 m0, 48128
s_nop 0
buffer_load_dwordx4 v28, s[20:23], s56 offen lds
ds_read_b64_tr_b16 v[60:61], v44 offset:0
ds_read_b64_tr_b16 v[62:63], v44 offset:1024
ds_read_b64_tr_b16 v[64:65], v46 offset:0
ds_read_b64_tr_b16 v[66:67], v46 offset:1024
ds_read_b64_tr_b16 v[68:69], v45 offset:0
ds_read_b64_tr_b16 v[70:71], v45 offset:1024
ds_read_b64_tr_b16 v[72:73], v47 offset:0
ds_read_b64_tr_b16 v[74:75], v47 offset:1024
s_waitcnt lgkmcnt(0)
s_waitcnt vmcnt(24)
s_barrier
ds_write_b128 v2, v[60:63] offset:0
ds_write_b128 v2, v[64:67] offset:1024
ds_write_b128 v2, v[68:71] offset:2048
ds_write_b128 v2, v[72:75] offset:3072
ds_read_b64_tr_b16 v[60:61], v44 offset:4096
ds_read_b64_tr_b16 v[62:63], v44 offset:5120
ds_read_b64_tr_b16 v[64:65], v46 offset:4096
ds_read_b64_tr_b16 v[66:67], v46 offset:5120
ds_read_b64_tr_b16 v[68:69], v45 offset:4096
ds_read_b64_tr_b16 v[70:71], v45 offset:5120
ds_read_b64_tr_b16 v[72:73], v47 offset:4096
ds_read_b64_tr_b16 v[74:75], v47 offset:5120
L_rdv_w0r:
v_readfirstlane_b32 s38, v32
s_nop 0
s_and_b32 s57, s38, 0xff
s_cmp_lg_u32 s57, 32
s_cbranch_scc1 L_rdv2_w0r
s_waitcnt lgkmcnt(0)
s_waitcnt vmcnt(20)
s_barrier
ds_write_b128 v2, v[60:63] offset:4096
ds_write_b128 v2, v[64:67] offset:5120
ds_write_b128 v2, v[68:71] offset:6144
ds_write_b128 v2, v[72:75] offset:7168
ds_read_b64_tr_b16 v[60:61], v44 offset:8192
ds_read_b64_tr_b16 v[62:63], v44 offset:9216
ds_read_b64_tr_b16 v[64:65], v46 offset:8192
ds_read_b64_tr_b16 v[66:67], v46 offset:9216
ds_read_b64_tr_b16 v[68:69], v45 offset:8192
ds_read_b64_tr_b16 v[70:71], v45 offset:9216
ds_read_b64_tr_b16 v[72:73], v47 offset:8192
ds_read_b64_tr_b16 v[74:75], v47 offset:9216
buffer_load_dwordx4 v[12:15], v9, s[4:7], s37 offen offset:0
buffer_load_dwordx4 v[16:19], v9, s[4:7], s37 offen offset:1024
buffer_load_dwordx4 v[52:55], v1, s[4:7], s37 offen offset:2048
buffer_load_dwordx4 v[56:59], v1, s[4:7], s37 offen offset:3072
s_mov_b32 m0, 1024
s_nop 0
buffer_load_dwordx4 v1, s[4:7], s47 offen offset:0 sc1 lds
buffer_load_dword v33, v1, s[4:7], s3 offen offset:0 sc1
buffer_load_dword v33, v1, s[4:7], s3 offen offset:1024 sc1
buffer_load_dword v33, v1, s[4:7], s3 offen offset:2048 sc1
buffer_load_dword v33, v1, s[4:7], s3 offen offset:3072 sc1
s_waitcnt lgkmcnt(0)
s_waitcnt vmcnt(25)
s_barrier
ds_write_b128 v2, v[60:63] offset:8192
ds_write_b128 v2, v[64:67] offset:9216
ds_write_b128 v2, v[68:71] offset:10240
ds_write_b128 v2, v[72:75] offset:11264
ds_read_b64_tr_b16 v[60:61], v44 offset:12288
ds_read_b64_tr_b16 v[62:63], v44 offset:13312
ds_read_b64_tr_b16 v[64:65], v46 offset:12288
ds_read_b64_tr_b16 v[66:67], v46 offset:13312
ds_read_b64_tr_b16 v[68:69], v45 offset:12288
ds_read_b64_tr_b16 v[70:71], v45 offset:13312
ds_read_b64_tr_b16 v[72:73], v47 offset:12288
ds_read_b64_tr_b16 v[74:75], v47 offset:13312
s_waitcnt lgkmcnt(0)
s_waitcnt vmcnt(21)
s_barrier
ds_write_b128 v2, v[60:63] offset:12288
ds_write_b128 v2, v[64:67] offset:13312
ds_write_b128 v2, v[68:71] offset:14336
ds_write_b128 v2, v[72:75] offset:15360
ds_read_b64_tr_b16 v[60:61], v44 offset:16384
ds_read_b64_tr_b16 v[62:63], v44 offset:17408
ds_read_b64_tr_b16 v[64:65], v46 offset:16384
ds_read_b64_tr_b16 v[66:67], v46 offset:17408
ds_read_b64_tr_b16 v[68:69], v45 offset:16384
ds_read_b64_tr_b16 v[70:71], v45 offset:17408
ds_read_b64_tr_b16 v[72:73], v47 offset:16384
ds_read_b64_tr_b16 v[74:75], v47 offset:17408
s_waitcnt lgkmcnt(0)
s_waitcnt vmcnt(17)
s_barrier
ds_write_b128 v2, v[60:63] offset:16384
ds_write_b128 v2, v[64:67] offset:17408
ds_write_b128 v2, v[68:71] offset:18432
ds_write_b128 v2, v[72:75] offset:19456
ds_read_b64_tr_b16 v[60:61], v48 offset:20480
ds_read_b64_tr_b16 v[62:63], v48 offset:21504
ds_read_b64_tr_b16 v[64:65], v48 offset:22528
ds_read_b64_tr_b16 v[66:67], v48 offset:23552
ds_read_b64_tr_b16 v[68:69], v49 offset:20480
ds_read_b64_tr_b16 v[70:71], v49 offset:21504
ds_read_b64_tr_b16 v[72:73], v49 offset:22528
ds_read_b64_tr_b16 v[74:75], v49 offset:23552
s_waitcnt lgkmcnt(0)
s_waitcnt vmcnt(13)
s_barrier
ds_write_b128 v2, v[60:63] offset:20480
ds_write_b128 v2, v[64:67] offset:21504
ds_write_b128 v2, v[68:71] offset:22528
ds_write_b128 v2, v[72:75] offset:23552
ds_read_b64_tr_b16 v[60:61], v48 offset:24576
ds_read_b64_tr_b16 v[62:63], v48 offset:25600
ds_read_b64_tr_b16 v[64:65], v48 offset:26624
ds_read_b64_tr_b16 v[66:67], v48 offset:27648
ds_read_b64_tr_b16 v[68:69], v49 offset:24576
ds_read_b64_tr_b16 v[70:71], v49 offset:25600
ds_read_b64_tr_b16 v[72:73], v49 offset:26624
ds_read_b64_tr_b16 v[74:75], v49 offset:27648
s_waitcnt lgkmcnt(0)
s_waitcnt vmcnt(9)
s_barrier
ds_write_b128 v2, v[60:63] offset:24576
ds_write_b128 v2, v[64:67] offset:25600
ds_write_b128 v2, v[68:71] offset:26624
ds_write_b128 v2, v[72:75] offset:27648
ds_read_b64_tr_b16 v[60:61], v48 offset:28672
ds_read_b64_tr_b16 v[62:63], v48 offset:29696
ds_read_b64_tr_b16 v[64:65], v48 offset:30720
ds_read_b64_tr_b16 v[66:67], v48 offset:31744
ds_read_b64_tr_b16 v[68:69], v49 offset:28672
ds_read_b64_tr_b16 v[70:71], v49 offset:29696
ds_read_b64_tr_b16 v[72:73], v49 offset:30720
ds_read_b64_tr_b16 v[74:75], v49 offset:31744
s_waitcnt lgkmcnt(0)
s_barrier
ds_write_b128 v2, v[60:63] offset:28672
ds_write_b128 v2, v[64:67] offset:29696
ds_write_b128 v2, v[68:71] offset:30720
ds_write_b128 v2, v[72:75] offset:31744
s_lshl_b32 s57, s58, 5
s_mov_b32 s0, 0x3f003f00
s_mov_b32 s1, 0x3f003f00
s_mov_b32 s58, 304128
s_cmp_eq_u32 s38, s57
s_mov_b32 s56, 0x33333333
s_mov_b32 s57, 0x33333333
s_mov_b32 s2, 0x21800000
s_mov_b32 s55, -24
s_cbranch_scc0 L_slow_w0r
v_mov_b64 v[20:21], 0
v_mov_b64 v[22:23], 0
v_mov_b64 v[24:25], 0
v_mov_b64 v[26:27], 0
v_mov_b64 v[28:29], 0
v_mov_b64 v[30:31], 0
v_mov_b64 v[32:33], 0
v_mov_b64 v[34:35], 0
v_mov_b64 v[36:37], 0
v_mov_b64 v[38:39], 0
v_mov_b64 v[40:41], 0
v_mov_b64 v[42:43], 0
ds_read_b128 v[44:47], v2 offset:0
ds_read_b128 v[48:51], v2 offset:1024
v_bfe_u32 v77, v1, 6, 1
v_lshl_add_u32 v77, v77, 3, v1
v_lshlrev_b32 v77, 1, v77
v_lshlrev_b32 v78, 3, v1
s_waitcnt vmcnt(0) lgkmcnt(0)
s_branch L_top_w0rf
L_done_w0rf:
s_mul_i32 s40, s34, 10240
s_add_u32 s40, s40, 8093696
buffer_store_dword v11, v10, s[4:7], s40 offen sc0 sc1
s_waitcnt vmcnt(0) lgkmcnt(0)
s_endpgm
L_rdv2_w0r:
buffer_load_dword v32, v24, s[28:31], 0 offen sc0 sc1
s_sub_u32 s41, s41, 1
s_cbranch_scc1 L_exit
s_waitcnt vmcnt(0)
s_branch L_rdv_w0r
L_ra0_w0rf:
s_mov_b32 m0, 1024
s_nop 0
buffer_load_dwordx4 v1, s[4:7], s47 offen offset:0 sc1 lds
buffer_load_dwordx4 v1, s[4:7], s47 offen offset:1024 sc1 lds
buffer_load_dwordx4 v1, s[4:7], s47 offen offset:2048 sc1 lds
buffer_load_dwordx4 v1, s[4:7], s47 offen offset:3072 sc1 lds
s_sub_u32 s41, s41, 1
s_cbranch_scc1 L_exit
ds_read_b128 v[44:47], v2 offset:0
ds_read_b128 v[48:51], v2 offset:1024
v_mov_b64 v[20:21], 0
v_mov_b64 v[22:23], 0
v_mov_b64 v[24:25], 0
v_mov_b64 v[26:27], 0
v_mov_b64 v[28:29], 0
v_mov_b64 v[30:31], 0
v_mov_b64 v[32:33], 0
v_mov_b64 v[34:35], 0
v_mov_b64 v[36:37], 0
v_mov_b64 v[38:39], 0
v_mov_b64 v[40:41], 0
v_mov_b64 v[42:43], 0
s_waitcnt vmcnt(0)
ds_read_b128 v[60:63], v1 offset:1024
ds_read_b128 v[64:67], v1 offset:2048
ds_read_b128 v[68:71], v1 offset:3072
ds_read_b128 v[72:75], v1 offset:4096
s_branch L_s0_w0rf
L_ra1_w0rf:
L_ra2_w0rf:
s_waitcnt lgkmcnt(0)
s_barrier
s_mov_b32 m0, 5120
s_nop 0
buffer_load_dwordx4 v1, s[4:7], s48 offen offset:0 sc1 lds
s_mov_b32 m0, 9216
s_nop 0
buffer_load_dwordx4 v1, s[4:7], s49 offen offset:0 sc1 lds
s_sub_u32 s41, s41, 1
s_cbranch_scc1 L_exit
s_waitcnt vmcnt(0)
s_barrier
ds_read_b128 v[76:79], v1 offset:5120
ds_read_b128 v[60:63], v1 offset:6144
ds_read_b128 v[64:67], v1 offset:7168
ds_read_b128 v[68:71], v1 offset:8192
ds_read_b128 v[72:75], v1 offset:9216
s_waitcnt lgkmcnt(0)
v_bitop3_b32 v6, v76, v60, s35 bitop3:0x7e
v_bitop3_b32 v6, v6, v64, s35 bitop3:0xf6
v_bitop3_b32 v6, v6, v68, s35 bitop3:0xf6
v_bitop3_b32 v6, v6, v72, s35 bitop3:0xf6
v_and_b32 v6, 1, v6
v_cmp_ne_u32 vcc, 0, v6

s_cbranch_vccnz L_ra2_w0rf
s_branch L_a1_w0rf
L_mx_w0rf:
s_waitcnt lgkmcnt(0)
v_max3_f32 v30, v12, v13, v28
v_max_f32 v30, v30, v29
v_mov_b32 v31, v30
s_nop 1
v_permlane16_swap_b32 v30, v31
v_max_f32 v30, v30, v31
v_mov_b32 v31, v30
s_nop 1
v_permlane32_swap_b32 v30, v31
v_max_f32 v30, v30, v31
ds_write_b32 v1, v30 offset:10240
s_waitcnt lgkmcnt(0)
s_barrier
ds_read_b128 v[32:35], v1 offset:10240
s_waitcnt lgkmcnt(0)
v_max3_f32 v32, v32, v33, v34
v_max_f32 v32, v32, v35
v_sub_f32 v14, v12, v32
v_sub_f32 v15, v13, v32
v_sub_f32 v30, v28, v32
v_sub_f32 v31, v29, v32
v_exp_f32 v14, v14
v_exp_f32 v15, v15
v_exp_f32 v30, v30
v_exp_f32 v31, v31
v_cvt_pk_bf16_f32 v14, v14, v15
v_cvt_pk_bf16_f32 v30, v30, v31
ds_write_b32 v5, v14 offset:14368
v_cndmask_b32_e64 v26, 0, v30, s[56:57]
v_cndmask_b32_e64 v27, 0, v30, s[56:57]
v_mov_b64 v[76:77], s[52:53]
v_mov_b64 v[78:79], s[52:53]
v_mov_b32_dpp v24, v26 quad_perm:[2,3,0,1] row_mask:0xf bank_mask:0xf
v_mov_b32_dpp v25, v26 quad_perm:[2,3,0,1] row_mask:0xf bank_mask:0xf
s_waitcnt lgkmcnt(0)
s_barrier
v_mov_b64 v[14:15], s[0:1]
ds_read_b128 v[16:19], v1 offset:14368
ds_read_b128 v[36:39], v1 offset:14336
s_waitcnt lgkmcnt(0)
v_mfma_f32_16x16x32_bf16 v[32:35], v[76:79], v[16:19], 0
v_mfma_f32_16x16x32_bf16 v[20:23], v[52:55], v[16:19], 0
v_mfma_f32_16x16x32_bf16 v[20:23], v[56:59], v[36:39], v[20:23]
v_mfma_f32_16x16x16_bf16 v[32:35], v[14:15], v[26:27], v[32:35]
v_mfma_f32_16x16x32_bf16 v[20:23], v[40:43], v[24:27], v[20:23]
s_nop 3
v_rcp_f32 v33, v32
s_nop 2
v_mul_f32_dpp v20, v33, v20 quad_perm:[0,1,0,1] row_mask:0xf bank_mask:0xf
v_mul_f32_dpp v21, v33, v21 quad_perm:[0,1,0,1] row_mask:0xf bank_mask:0xf
v_mul_f32_dpp v22, v33, v22 quad_perm:[0,1,0,1] row_mask:0xf bank_mask:0xf
v_mul_f32_dpp v23, v33, v23 quad_perm:[0,1,0,1] row_mask:0xf bank_mask:0xf
v_cvt_pk_bf16_f32 v20, v20, v21
v_cvt_pk_bf16_f32 v21, v22, v23
ds_write_b64 v6, v[20:21] offset:5120
v_mov_b32_dpp v16, v20 quad_perm:[0,1,0,1] row_mask:0xf bank_mask:0xf
v_mov_b32_dpp v17, v21 quad_perm:[0,1,0,1] row_mask:0xf bank_mask:0xf
v_mov_b32_dpp v18, v20 quad_perm:[2,3,2,3] row_mask:0xf bank_mask:0xf
v_mov_b32_dpp v19, v21 quad_perm:[2,3,2,3] row_mask:0xf bank_mask:0xf
v_mov_b64 v[76:77], 0
v_mov_b64 v[78:79], 0
v_mov_b64 v[36:37], 0
v_mov_b64 v[38:39], 0
v_mov_b64 v[24:25], 0
v_mov_b64 v[26:27], 0
v_mov_b64 v[32:33], 0
v_mov_b64 v[34:35], 0
s_waitcnt lgkmcnt(0)
s_branch L_mxb_w0rf

L_rr_w0rf:
buffer_load_dwordx4 v[60:63], v9, s[4:7], s3 offen offset:0 sc1
buffer_load_dwordx4 v[64:67], v9, s[4:7], s3 offen offset:1024 sc1
buffer_load_dwordx4 v[68:71], v9, s[4:7], s3 offen offset:2048 sc1
buffer_load_dwordx4 v[72:75], v9, s[4:7], s3 offen offset:3072 sc1
s_sub_u32 s41, s41, 1
s_cbranch_scc1 L_exit
s_waitcnt vmcnt(0)
s_branch L_r_w0rf
L_slow_w0r:
v_mov_b64 v[20:21], 0
v_mov_b64 v[22:23], 0
v_mov_b64 v[24:25], 0
v_mov_b64 v[26:27], 0
v_mov_b64 v[28:29], 0
v_mov_b64 v[30:31], 0
v_mov_b64 v[32:33], 0
v_mov_b64 v[34:35], 0
v_mov_b64 v[36:37], 0
v_mov_b64 v[38:39], 0
v_mov_b64 v[40:41], 0
v_mov_b64 v[42:43], 0
ds_read_b128 v[44:47], v2 offset:0
ds_read_b128 v[48:51], v2 offset:1024
v_bfe_u32 v77, v1, 6, 1
v_lshl_add_u32 v77, v77, 3, v1
v_lshlrev_b32 v77, 1, v77
v_lshlrev_b32 v78, 3, v1
s_waitcnt vmcnt(0) lgkmcnt(0)
s_branch L_top_w0rs
L_done_w0rs:
s_mul_i32 s40, s34, 10240
s_add_u32 s40, s40, 8093696
buffer_store_dword v11, v10, s[4:7], s40 offen sc0 sc1
s_waitcnt vmcnt(0) lgkmcnt(0)
s_endpgm
L_ra0_w0rs:
s_mov_b32 m0, 1024
s_nop 0
buffer_load_dwordx4 v1, s[4:7], s47 offen offset:0 sc0 sc1 lds
buffer_load_dwordx4 v1, s[4:7], s47 offen offset:1024 sc0 sc1 lds
buffer_load_dwordx4 v1, s[4:7], s47 offen offset:2048 sc0 sc1 lds
buffer_load_dwordx4 v1, s[4:7], s47 offen offset:3072 sc0 sc1 lds
s_sub_u32 s41, s41, 1
s_cbranch_scc1 L_exit
ds_read_b128 v[44:47], v2 offset:0
ds_read_b128 v[48:51], v2 offset:1024
v_mov_b64 v[20:21], 0
v_mov_b64 v[22:23], 0
v_mov_b64 v[24:25], 0
v_mov_b64 v[26:27], 0
v_mov_b64 v[28:29], 0
v_mov_b64 v[30:31], 0
v_mov_b64 v[32:33], 0
v_mov_b64 v[34:35], 0
v_mov_b64 v[36:37], 0
v_mov_b64 v[38:39], 0
v_mov_b64 v[40:41], 0
v_mov_b64 v[42:43], 0
s_waitcnt vmcnt(0)
ds_read_b128 v[60:63], v1 offset:1024
ds_read_b128 v[64:67], v1 offset:2048
ds_read_b128 v[68:71], v1 offset:3072
ds_read_b128 v[72:75], v1 offset:4096
s_branch L_s0_w0rs
L_ra1_w0rs:
L_ra2_w0rs:
s_waitcnt lgkmcnt(0)
s_barrier
s_mov_b32 m0, 5120
s_nop 0
buffer_load_dwordx4 v1, s[4:7], s48 offen offset:0 sc0 sc1 lds
s_mov_b32 m0, 9216
s_nop 0
buffer_load_dwordx4 v1, s[4:7], s49 offen offset:0 sc0 sc1 lds
s_sub_u32 s41, s41, 1
s_cbranch_scc1 L_exit
s_waitcnt vmcnt(0)
s_barrier
ds_read_b128 v[76:79], v1 offset:5120
ds_read_b128 v[60:63], v1 offset:6144
ds_read_b128 v[64:67], v1 offset:7168
ds_read_b128 v[68:71], v1 offset:8192
ds_read_b128 v[72:75], v1 offset:9216
s_waitcnt lgkmcnt(0)
v_bitop3_b32 v6, v76, v60, s35 bitop3:0x7e
v_bitop3_b32 v6, v6, v64, s35 bitop3:0xf6
v_bitop3_b32 v6, v6, v68, s35 bitop3:0xf6
v_bitop3_b32 v6, v6, v72, s35 bitop3:0xf6
v_and_b32 v6, 1, v6
v_cmp_ne_u32 vcc, 0, v6

s_cbranch_vccnz L_ra2_w0rs
s_branch L_a1_w0rs
L_mx_w0rs:
s_waitcnt lgkmcnt(0)
v_max3_f32 v30, v12, v13, v28
v_max_f32 v30, v30, v29
v_mov_b32 v31, v30
s_nop 1
v_permlane16_swap_b32 v30, v31
v_max_f32 v30, v30, v31
v_mov_b32 v31, v30
s_nop 1
v_permlane32_swap_b32 v30, v31
v_max_f32 v30, v30, v31
ds_write_b32 v1, v30 offset:10240
s_waitcnt lgkmcnt(0)
s_barrier
ds_read_b128 v[32:35], v1 offset:10240
s_waitcnt lgkmcnt(0)
v_max3_f32 v32, v32, v33, v34
v_max_f32 v32, v32, v35
v_sub_f32 v14, v12, v32
v_sub_f32 v15, v13, v32
v_sub_f32 v30, v28, v32
v_sub_f32 v31, v29, v32
v_exp_f32 v14, v14
v_exp_f32 v15, v15
v_exp_f32 v30, v30
v_exp_f32 v31, v31
v_cvt_pk_bf16_f32 v14, v14, v15
v_cvt_pk_bf16_f32 v30, v30, v31
ds_write_b32 v5, v14 offset:14368
v_cndmask_b32_e64 v26, 0, v30, s[56:57]
v_cndmask_b32_e64 v27, 0, v30, s[56:57]
v_mov_b64 v[76:77], s[52:53]
v_mov_b64 v[78:79], s[52:53]
v_mov_b32_dpp v24, v26 quad_perm:[2,3,0,1] row_mask:0xf bank_mask:0xf
v_mov_b32_dpp v25, v26 quad_perm:[2,3,0,1] row_mask:0xf bank_mask:0xf
s_waitcnt lgkmcnt(0)
s_barrier
v_mov_b64 v[14:15], s[0:1]
ds_read_b128 v[16:19], v1 offset:14368
ds_read_b128 v[36:39], v1 offset:14336
s_waitcnt lgkmcnt(0)
v_mfma_f32_16x16x32_bf16 v[32:35], v[76:79], v[16:19], 0
v_mfma_f32_16x16x32_bf16 v[20:23], v[52:55], v[16:19], 0
v_mfma_f32_16x16x32_bf16 v[20:23], v[56:59], v[36:39], v[20:23]
v_mfma_f32_16x16x16_bf16 v[32:35], v[14:15], v[26:27], v[32:35]
v_mfma_f32_16x16x32_bf16 v[20:23], v[40:43], v[24:27], v[20:23]
s_nop 3
v_rcp_f32 v33, v32
s_nop 2
v_mul_f32_dpp v20, v33, v20 quad_perm:[0,1,0,1] row_mask:0xf bank_mask:0xf
v_mul_f32_dpp v21, v33, v21 quad_perm:[0,1,0,1] row_mask:0xf bank_mask:0xf
v_mul_f32_dpp v22, v33, v22 quad_perm:[0,1,0,1] row_mask:0xf bank_mask:0xf
v_mul_f32_dpp v23, v33, v23 quad_perm:[0,1,0,1] row_mask:0xf bank_mask:0xf
v_cvt_pk_bf16_f32 v20, v20, v21
v_cvt_pk_bf16_f32 v21, v22, v23
ds_write_b64 v6, v[20:21] offset:5120
v_mov_b32_dpp v16, v20 quad_perm:[0,1,0,1] row_mask:0xf bank_mask:0xf
v_mov_b32_dpp v17, v21 quad_perm:[0,1,0,1] row_mask:0xf bank_mask:0xf
v_mov_b32_dpp v18, v20 quad_perm:[2,3,2,3] row_mask:0xf bank_mask:0xf
v_mov_b32_dpp v19, v21 quad_perm:[2,3,2,3] row_mask:0xf bank_mask:0xf
v_mov_b64 v[76:77], 0
v_mov_b64 v[78:79], 0
v_mov_b64 v[36:37], 0
v_mov_b64 v[38:39], 0
v_mov_b64 v[24:25], 0
v_mov_b64 v[26:27], 0
v_mov_b64 v[32:33], 0
v_mov_b64 v[34:35], 0
s_waitcnt lgkmcnt(0)
s_branch L_mxb_w0rs

L_rr_w0rs:
buffer_load_dwordx4 v[60:63], v9, s[4:7], s3 offen offset:0 sc0 sc1
buffer_load_dwordx4 v[64:67], v9, s[4:7], s3 offen offset:1024 sc0 sc1
buffer_load_dwordx4 v[68:71], v9, s[4:7], s3 offen offset:2048 sc0 sc1
buffer_load_dwordx4 v[72:75], v9, s[4:7], s3 offen offset:3072 sc0 sc1
s_sub_u32 s41, s41, 1
s_cbranch_scc1 L_exit
s_waitcnt vmcnt(0)
s_branch L_r_w0rs
L_pro_w1r:
v_and_b32 v20, 63, v0
v_lshlrev_b32 v1, 4, v20
v_add_u32 v2, 57344, v1
v_and_b32 v23, 1, v22
v_lshl_add_u32 v23, v24, 4, v23
v_mul_u32_u24 v23, 1152, v23
v_lshlrev_b32 v28, 2, v22
v_xor_b32 v28, v28, v21
v_lshl_add_u32 v28, v28, 4, v23
s_mul_i32 s55, s32, 147456
s_waitcnt lgkmcnt(0)
v_and_b32 v23, 1, v22
v_lshrrev_b32 v24, 2, v21
v_lshl_add_u32 v23, v23, 2, v24
v_lshlrev_b32 v23, 1, v23
v_bfe_u32 v44, v21, 1, 1
v_add_u32 v44, 4, v44
v_xor_b32 v44, v44, v23
v_lshlrev_b32 v44, 4, v44
v_lshl_add_u32 v44, v24, 8, v44
v_and_b32 v23, 1, v22
v_lshl_add_u32 v44, v23, 11, v44
v_and_b32 v23, 1, v21
v_lshl_add_u32 v44, v23, 3, v44
v_lshrrev_b32 v23, 1, v22
v_mul_u32_u24 v23, 40960, v23
v_add_u32 v23, 16384, v23
v_add_u32 v44, v44, v23
v_and_b32 v23, 1, v22
v_lshrrev_b32 v24, 2, v21
v_lshl_add_u32 v23, v23, 2, v24
v_lshlrev_b32 v23, 1, v23
v_bfe_u32 v45, v21, 1, 1
v_add_u32 v45, 6, v45
v_xor_b32 v45, v45, v23
v_lshlrev_b32 v45, 4, v45
v_lshl_add_u32 v45, v24, 8, v45
v_and_b32 v23, 1, v22
v_lshl_add_u32 v45, v23, 11, v45
v_and_b32 v23, 1, v21
v_lshl_add_u32 v45, v23, 3, v45
v_lshrrev_b32 v23, 1, v22
v_mul_u32_u24 v23, 40960, v23
v_add_u32 v23, 16384, v23
v_add_u32 v45, v45, v23
v_and_b32 v23, 1, v22
v_lshrrev_b32 v24, 2, v21
v_lshl_add_u32 v23, v23, 2, v24
v_lshlrev_b32 v23, 1, v23
v_bfe_u32 v46, v21, 1, 1
v_add_u32 v46, 4, v46
v_xor_b32 v46, v46, v23
v_lshlrev_b32 v46, 4, v46
v_lshl_add_u32 v46, v24, 8, v46
v_and_b32 v23, 1, v22
v_lshl_add_u32 v46, v23, 11, v46
v_and_b32 v23, 1, v21
v_lshl_add_u32 v46, v23, 3, v46
v_lshrrev_b32 v23, 1, v22
v_mul_u32_u24 v23, 32768, v23
v_add_u32 v23, 98304, v23
v_add_u32 v46, v46, v23
v_and_b32 v23, 1, v22
v_lshrrev_b32 v24, 2, v21
v_lshl_add_u32 v23, v23, 2, v24
v_lshlrev_b32 v23, 1, v23
v_bfe_u32 v47, v21, 1, 1
v_add_u32 v47, 6, v47
v_xor_b32 v47, v47, v23
v_lshlrev_b32 v47, 4, v47
v_lshl_add_u32 v47, v24, 8, v47
v_and_b32 v23, 1, v22
v_lshl_add_u32 v47, v23, 11, v47
v_and_b32 v23, 1, v21
v_lshl_add_u32 v47, v23, 3, v47
v_lshrrev_b32 v23, 1, v22
v_mul_u32_u24 v23, 32768, v23
v_add_u32 v23, 98304, v23
v_add_u32 v47, v47, v23
v_and_b32 v23, 1, v22
v_bfe_u32 v24, v21, 2, 1
v_lshl_add_u32 v23, v23, 1, v24
v_xor_b32 v24, 1, v23
v_lshlrev_b32 v24, 6, v24
v_lshl_add_u32 v48, v23, 8, v24
v_and_b32 v23, 3, v21
v_lshl_add_u32 v48, v23, 4, v48
v_and_b32 v23, 8, v21
v_add_u32 v48, v48, v23
v_lshrrev_b32 v23, 1, v22
v_mul_u32_u24 v23, 40960, v23
v_add_u32 v23, 16384, v23
v_add_u32 v48, v48, v23
v_and_b32 v23, 1, v22
v_bfe_u32 v24, v21, 2, 1
v_lshl_add_u32 v23, v23, 1, v24
v_xor_b32 v24, 1, v23
v_lshlrev_b32 v24, 6, v24
v_lshl_add_u32 v49, v23, 8, v24
v_and_b32 v23, 3, v21
v_lshl_add_u32 v49, v23, 4, v49
v_and_b32 v23, 8, v21
v_add_u32 v49, v49, v23
v_lshrrev_b32 v23, 1, v22
v_mul_u32_u24 v23, 32768, v23
v_add_u32 v23, 98304, v23
v_add_u32 v49, v49, v23
v_bfe_u32 v23, v21, 1, 1
v_mul_u32_u24 v23, 0xaaaa, v23
v_add_u32 v0, 0x4444, v23
v_lshlrev_b32 v3, 3, v20
v_lshrrev_b32 v25, 5, v20
v_lshlrev_b32 v25, 6, v25
v_xor_b32 v3, v3, v25
v_lshrrev_b32 v25, 2, v20
v_and_b32 v4, 3, v21
v_lshl_add_u32 v4, v4, 4, v25
v_lshlrev_b32 v4, 3, v4
v_bfe_u32 v25, v21, 1, 1
v_lshlrev_b32 v23, 6, v25
v_xor_b32 v4, v4, v23
v_lshlrev_b32 v5, 4, v21
v_lshl_add_u32 v5, v22, 2, v5
v_mul_u32_u24 v23, 768, v25
v_add_u32 v5, v5, v23
v_lshlrev_b32 v9, 8, v22
v_lshl_add_u32 v9, v25, 6, v9
v_bfe_u32 v23, v21, 3, 1
v_lshl_add_u32 v9, v23, 7, v9
v_bfe_u32 v23, v21, 2, 1
v_lshl_add_u32 v9, v23, 5, v9
v_and_b32 v23, 1, v21
v_lshl_add_u32 v9, v23, 4, v9
v_lshrrev_b32 v23, 1, v22
v_and_b32 v24, 1, v22
v_and_b32 v25, 7, v21
v_lshrrev_b32 v7, 3, v21
v_lshl_add_u32 v8, v7, 1, v23
v_lshlrev_b32 v8, 12, v8
v_lshl_add_u32 v8, v24, 7, v8
v_and_b32 v25, 4, v21
v_lshl_add_u32 v8, v25, 3, v8
v_and_b32 v25, 1, v21
v_lshl_add_u32 v8, v25, 4, v8
v_bfe_u32 v25, v21, 1, 1
v_lshl_add_u32 v8, v25, 3, v8
s_lshr_b32 s56, s32, 1
s_lshl_b32 s56, s56, 8
s_and_b32 s57, s32, 1
s_lshl_b32 s57, s57, 6
s_add_u32 s56, s56, s57
s_add_u32 s56, s56, 16384
v_add_u32 v8, s56, v8
v_and_b32 v7, 0x3d0, v1
s_mov_b32 s42, 0
s_mov_b32 s43, 65536
s_mov_b32 s44, 131072
s_mov_b32 s45, 196608
s_mov_b32 s46, 262144
s_mov_b32 s47, 294912
s_mov_b32 s48, 299008
s_mov_b32 s49, 303104
s_mov_b32 s50, 0x3e0293ee
s_mov_b32 s51, 0x3e0293ee
s_mov_b32 s52, 0x3f803f80
s_mov_b32 s53, 0x3f803f80
v_lshlrev_b32 v11, 2, v21
s_mov_b32 s34, 0
s_mov_b32 s35, -1
s_mov_b32 s36, 0
s_mov_b32 s41, 300000
s_lshl_b32 s37, s32, 14
s_add_u32 s39, s37, 17309696
s_add_u32 s37, s37, 16781312
s_mov_b32 s40, 8749056
v_mov_b64 v[36:37], 0
v_mov_b64 v[38:39], 0
ds_write_b128 v1, v[36:39] offset:15360
s_lshl_b32 s56, s32, 1
s_add_u32 s56, s56, 0
s_cmp_eq_u32 s56, 0
s_cselect_b32 s56, 64, s56
s_mul_i32 s56, s56, 10240
s_add_u32 s56, s56, 8392704
s_add_u32 s57, s56, 4096
v_mov_b32 v40, 0
v_mov_b32 v41, 0
v_mov_b32 v42, 0
v_mov_b32 v43, 0
buffer_store_dwordx4 v[40:43], v1, s[4:7], s56 offen offset:0 sc0 sc1
buffer_store_dwordx4 v[40:43], v1, s[4:7], s56 offen offset:1024 sc0 sc1
buffer_store_dwordx4 v[40:43], v1, s[4:7], s56 offen offset:2048 sc0 sc1
buffer_store_dwordx4 v[40:43], v1, s[4:7], s56 offen offset:3072 sc0 sc1
buffer_store_dwordx4 v[40:43], v1, s[4:7], s57 offen offset:0 sc0 sc1
s_add_u32 s56, s32, 32
s_lshl_b32 s3, s56, 12
v_and_b32 v23, 1, v21
v_bfe_u32 v24, v21, 2, 1
v_bfe_u32 v25, v21, 1, 1
s_lshl_b32 s57, s56, 7
s_add_u32 s57, s57, 294912
v_and_b32 v10, 7, v21
v_lshlrev_b32 v10, 2, v10
v_lshl_add_u32 v10, v22, 5, v10
v_add_u32 v10, s57, v10
s_lshl_b32 s33, s56, 2
s_add_u32 s33, s33, 304128
v_mov_b32 v30, -1
s_mov_b64 exec, 1
buffer_store_dword v30, v1, s[4:7], s33 offen sc0 sc1
s_mov_b64 exec, -1
v_lshl_add_u32 v23, v23, 1, v24
v_lshlrev_b32 v25, 4, v25
v_mov_b32 v24, 0x3f80
v_lshlrev_b32 v24, v25, v24
v_cmp_eq_u32 vcc, 0, v23
s_nop 1
v_cndmask_b32 v76, 0, v24, vcc
v_cmp_eq_u32 vcc, 1, v23
s_nop 1
v_cndmask_b32 v77, 0, v24, vcc
v_cmp_eq_u32 vcc, 2, v23
s_nop 1
v_cndmask_b32 v78, 0, v24, vcc
v_cmp_eq_u32 vcc, 3, v23
s_nop 1
v_cndmask_b32 v79, 0, v24, vcc
buffer_store_dwordx4 v[36:39], v9, s[4:7], s3 offen offset:0 sc0 sc1
buffer_store_dwordx4 v[36:39], v9, s[4:7], s3 offen offset:1024 sc0 sc1
buffer_store_dwordx4 v[36:39], v9, s[4:7], s3 offen offset:2048 sc0 sc1
buffer_store_dwordx4 v[36:39], v9, s[4:7], s3 offen offset:3072 sc0 sc1
s_getreg_b32 s56, hwreg(HW_REG_XCC_ID)
s_and_b32 s56, s56, 15
s_mul_i32 s57, s56, s56
s_lshl_b32 s57, s57, 18
s_lshl_b32 s56, s56, 8
s_add_u32 s57, s57, s56
s_add_u32 s58, s57, 1
s_lshl_b32 s101, s32, 7
s_add_u32 s101, s101, 327680
v_mov_b32 v24, 0
s_add_u32 s56, s54, 131072
s_mov_b32 m0, 69632
s_nop 0
buffer_load_dwordx4 v26, s[12:15], s56 offen lds
s_add_u32 s56, s54, 147456
s_mov_b32 m0, 70656
s_nop 0
buffer_load_dwordx4 v26, s[12:15], s56 offen lds
s_add_u32 s56, s54, 163840
s_mov_b32 m0, 71680
s_nop 0
buffer_load_dwordx4 v27, s[12:15], s56 offen lds
s_add_u32 s56, s54, 180224
s_mov_b32 m0, 72704
s_nop 0
buffer_load_dwordx4 v27, s[12:15], s56 offen lds
s_add_u32 s56, s54, 655360
s_mov_b32 m0, 73728
s_nop 0
buffer_load_dwordx4 v26, s[12:15], s56 offen lds
s_add_u32 s56, s54, 671744
s_mov_b32 m0, 74752
s_nop 0
buffer_load_dwordx4 v26, s[12:15], s56 offen lds
s_add_u32 s56, s54, 688128
s_mov_b32 m0, 75776
s_nop 0
buffer_load_dwordx4 v27, s[12:15], s56 offen lds
s_add_u32 s56, s54, 704512
s_mov_b32 m0, 76800
s_nop 0
buffer_load_dwordx4 v27, s[12:15], s56 offen lds
v_and_b32 v23, 3, v20
v_lshrrev_b32 v24, 2, v20
v_mul_u32_u24 v29, 1152, v24
v_lshl_add_u32 v29, v23, 4, v29
v_lshrrev_b32 v24, 2, v21
v_and_b32 v25, 1, v22
v_lshlrev_b32 v31, 10, v25
v_lshrrev_b32 v25, 1, v22
v_lshl_add_u32 v31, v25, 8, v31
v_and_b32 v25, 1, v24
v_lshl_add_u32 v31, v25, 6, v31
v_lshrrev_b32 v25, 1, v24
v_lshl_add_u32 v31, v25, 3, v31
v_lshl_add_u32 v31, v23, 4, v31
v_add_u32 v31, 57344, v31
s_add_u32 s56, s55, 1088
s_mov_b32 m0, 90112
s_nop 0
buffer_load_dwordx4 v29, s[20:23], s56 offen lds
s_add_u32 s56, s55, 19520
s_mov_b32 m0, 91136
s_nop 0
buffer_load_dwordx4 v29, s[20:23], s56 offen lds
s_add_u32 s56, s55, 37952
s_mov_b32 m0, 92160
s_nop 0
buffer_load_dwordx4 v29, s[20:23], s56 offen lds
s_add_u32 s56, s55, 56384
s_mov_b32 m0, 93184
s_nop 0
buffer_load_dwordx4 v29, s[20:23], s56 offen lds
s_add_u32 s56, s55, 74816
s_mov_b32 m0, 94208
s_nop 0
buffer_load_dwordx4 v29, s[20:23], s56 offen lds
s_add_u32 s56, s55, 93248
s_mov_b32 m0, 95232
s_nop 0
buffer_load_dwordx4 v29, s[20:23], s56 offen lds
s_add_u32 s56, s55, 111680
s_mov_b32 m0, 96256
s_nop 0
buffer_load_dwordx4 v29, s[20:23], s56 offen lds
s_add_u32 s56, s55, 130112
s_mov_b32 m0, 97280
s_nop 0
buffer_load_dwordx4 v29, s[20:23], s56 offen lds
v_mov_b32 v24, 0
s_waitcnt vmcnt(46)
s_barrier
ds_read_b64_tr_b16 v[80:81], v44 offset:20480
ds_read_b64_tr_b16 v[82:83], v44 offset:21504
ds_read_b64_tr_b16 v[84:85], v46 offset:20480
ds_read_b64_tr_b16 v[86:87], v46 offset:21504
ds_read_b64_tr_b16 v[88:89], v45 offset:20480
ds_read_b64_tr_b16 v[90:91], v45 offset:21504
ds_read_b64_tr_b16 v[92:93], v47 offset:20480
ds_read_b64_tr_b16 v[94:95], v47 offset:21504
s_waitcnt lgkmcnt(0)
s_waitcnt vmcnt(42)
s_barrier
s_add_u32 s56, s54, 1179648
s_mov_b32 m0, 77824
s_nop 0
buffer_load_dwordx4 v26, s[12:15], s56 offen lds
s_add_u32 s56, s54, 1196032
s_mov_b32 m0, 78848
s_nop 0
buffer_load_dwordx4 v26, s[12:15], s56 offen lds
s_add_u32 s56, s54, 1212416
s_mov_b32 m0, 79872
s_nop 0
buffer_load_dwordx4 v27, s[12:15], s56 offen lds
s_add_u32 s56, s54, 1228800
s_mov_b32 m0, 80896
s_nop 0
buffer_load_dwordx4 v27, s[12:15], s56 offen lds
ds_read_b64_tr_b16 v[96:97], v44 offset:24576
ds_read_b64_tr_b16 v[98:99], v44 offset:25600
ds_read_b64_tr_b16 v[100:101], v46 offset:24576
ds_read_b64_tr_b16 v[102:103], v46 offset:25600
ds_read_b64_tr_b16 v[104:105], v45 offset:24576
ds_read_b64_tr_b16 v[106:107], v45 offset:25600
ds_read_b64_tr_b16 v[108:109], v47 offset:24576
ds_read_b64_tr_b16 v[110:111], v47 offset:25600
s_waitcnt lgkmcnt(0)
s_waitcnt vmcnt(42)
s_barrier
s_add_u32 s56, s54, 1703936
s_mov_b32 m0, 81920
s_nop 0
buffer_load_dwordx4 v26, s[12:15], s56 offen lds
s_add_u32 s56, s54, 1720320
s_mov_b32 m0, 82944
s_nop 0
buffer_load_dwordx4 v26, s[12:15], s56 offen lds
s_add_u32 s56, s54, 1736704
s_mov_b32 m0, 83968
s_nop 0
buffer_load_dwordx4 v27, s[12:15], s56 offen lds
s_add_u32 s56, s54, 1753088
s_mov_b32 m0, 84992
s_nop 0
buffer_load_dwordx4 v27, s[12:15], s56 offen lds
ds_read_b64_tr_b16 v[112:113], v44 offset:28672
ds_read_b64_tr_b16 v[114:115], v44 offset:29696
ds_read_b64_tr_b16 v[116:117], v46 offset:28672
ds_read_b64_tr_b16 v[118:119], v46 offset:29696
ds_read_b64_tr_b16 v[120:121], v45 offset:28672
ds_read_b64_tr_b16 v[122:123], v45 offset:29696
ds_read_b64_tr_b16 v[124:125], v47 offset:28672
ds_read_b64_tr_b16 v[126:127], v47 offset:29696
s_waitcnt lgkmcnt(0)
s_waitcnt vmcnt(42)
s_barrier
s_add_u32 s56, s54, 2228224
s_mov_b32 m0, 86016
s_nop 0
buffer_load_dwordx4 v26, s[12:15], s56 offen lds
s_add_u32 s56, s54, 2244608
s_mov_b32 m0, 87040
s_nop 0
buffer_load_dwordx4 v26, s[12:15], s56 offen lds
s_add_u32 s56, s54, 2260992
s_mov_b32 m0, 88064
s_nop 0
buffer_load_dwordx4 v27, s[12:15], s56 offen lds
s_add_u32 s56, s54, 2277376
s_mov_b32 m0, 89088
s_nop 0
buffer_load_dwordx4 v27, s[12:15], s56 offen lds
ds_read_b64_tr_b16 v[128:129], v44 offset:0
ds_read_b64_tr_b16 v[130:131], v44 offset:1024
ds_read_b64_tr_b16 v[132:133], v46 offset:0
ds_read_b64_tr_b16 v[134:135], v46 offset:1024
ds_read_b64_tr_b16 v[136:137], v45 offset:0
ds_read_b64_tr_b16 v[138:139], v45 offset:1024
ds_read_b64_tr_b16 v[140:141], v47 offset:0
ds_read_b64_tr_b16 v[142:143], v47 offset:1024
s_waitcnt lgkmcnt(0)
s_waitcnt vmcnt(42)
s_barrier
s_add_u32 s56, s54, 3276800
s_mov_b32 m0, 57344
s_nop 0
buffer_load_dwordx4 v26, s[12:15], s56 offen lds
s_add_u32 s56, s54, 3293184
s_mov_b32 m0, 58368
s_nop 0
buffer_load_dwordx4 v26, s[12:15], s56 offen lds
s_add_u32 s56, s54, 3309568
s_mov_b32 m0, 59392
s_nop 0
buffer_load_dwordx4 v27, s[12:15], s56 offen lds
s_add_u32 s56, s54, 3325952
s_mov_b32 m0, 60416
s_nop 0
buffer_load_dwordx4 v27, s[12:15], s56 offen lds
ds_read_b64_tr_b16 v[144:145], v44 offset:4096
ds_read_b64_tr_b16 v[146:147], v44 offset:5120
ds_read_b64_tr_b16 v[148:149], v46 offset:4096
ds_read_b64_tr_b16 v[150:151], v46 offset:5120
ds_read_b64_tr_b16 v[152:153], v45 offset:4096
ds_read_b64_tr_b16 v[154:155], v45 offset:5120
ds_read_b64_tr_b16 v[156:157], v47 offset:4096
ds_read_b64_tr_b16 v[158:159], v47 offset:5120
s_waitcnt lgkmcnt(0)
s_waitcnt vmcnt(42)
s_barrier
s_add_u32 s56, s54, 3801088
s_mov_b32 m0, 61440
s_nop 0
buffer_load_dwordx4 v26, s[12:15], s56 offen lds
s_add_u32 s56, s54, 3817472
s_mov_b32 m0, 62464
s_nop 0
buffer_load_dwordx4 v26, s[12:15], s56 offen lds
s_add_u32 s56, s54, 3833856
s_mov_b32 m0, 63488
s_nop 0
buffer_load_dwordx4 v27, s[12:15], s56 offen lds
s_add_u32 s56, s54, 3850240
s_mov_b32 m0, 64512
s_nop 0
buffer_load_dwordx4 v27, s[12:15], s56 offen lds
ds_read_b64_tr_b16 v[160:161], v44 offset:8192
ds_read_b64_tr_b16 v[162:163], v44 offset:9216
ds_read_b64_tr_b16 v[164:165], v46 offset:8192
ds_read_b64_tr_b16 v[166:167], v46 offset:9216
ds_read_b64_tr_b16 v[168:169], v45 offset:8192
ds_read_b64_tr_b16 v[170:171], v45 offset:9216
ds_read_b64_tr_b16 v[172:173], v47 offset:8192
ds_read_b64_tr_b16 v[174:175], v47 offset:9216
s_waitcnt lgkmcnt(0)
s_waitcnt vmcnt(32)
s_barrier
s_add_u32 s56, s54, 4325376
s_mov_b32 m0, 65536
s_nop 0
buffer_load_dwordx4 v26, s[12:15], s56 offen lds
s_add_u32 s56, s54, 4341760
s_mov_b32 m0, 66560
s_nop 0
buffer_load_dwordx4 v26, s[12:15], s56 offen lds
s_add_u32 s56, s54, 4358144
s_mov_b32 m0, 67584
s_nop 0
buffer_load_dwordx4 v27, s[12:15], s56 offen lds
s_add_u32 s56, s54, 4374528
s_mov_b32 m0, 68608
s_nop 0
buffer_load_dwordx4 v27, s[12:15], s56 offen lds
ds_read_b64_tr_b16 v[176:177], v44 offset:12288
ds_read_b64_tr_b16 v[178:179], v44 offset:13312
ds_read_b64_tr_b16 v[180:181], v46 offset:12288
ds_read_b64_tr_b16 v[182:183], v46 offset:13312
ds_read_b64_tr_b16 v[184:185], v45 offset:12288
ds_read_b64_tr_b16 v[186:187], v45 offset:13312
ds_read_b64_tr_b16 v[188:189], v47 offset:12288
ds_read_b64_tr_b16 v[190:191], v47 offset:13312
s_waitcnt lgkmcnt(0)
s_waitcnt vmcnt(32)
s_barrier
s_add_u32 s56, s54, 131072
s_mov_b32 m0, 69632
s_nop 0
buffer_load_dwordx4 v26, s[16:19], s56 offen lds
s_add_u32 s56, s54, 147456
s_mov_b32 m0, 70656
s_nop 0
buffer_load_dwordx4 v26, s[16:19], s56 offen lds
s_add_u32 s56, s54, 163840
s_mov_b32 m0, 71680
s_nop 0
buffer_load_dwordx4 v27, s[16:19], s56 offen lds
s_add_u32 s56, s54, 180224
s_mov_b32 m0, 72704
s_nop 0
buffer_load_dwordx4 v27, s[16:19], s56 offen lds
ds_read_b64_tr_b16 v[192:193], v44 offset:16384
ds_read_b64_tr_b16 v[194:195], v44 offset:17408
ds_read_b64_tr_b16 v[196:197], v46 offset:16384
ds_read_b64_tr_b16 v[198:199], v46 offset:17408
ds_read_b64_tr_b16 v[200:201], v45 offset:16384
ds_read_b64_tr_b16 v[202:203], v45 offset:17408
ds_read_b64_tr_b16 v[204:205], v47 offset:16384
ds_read_b64_tr_b16 v[206:207], v47 offset:17408
s_waitcnt lgkmcnt(0)
s_waitcnt vmcnt(24)
s_barrier
s_add_u32 s56, s54, 655360
s_mov_b32 m0, 73728
s_nop 0
buffer_load_dwordx4 v26, s[16:19], s56 offen lds
s_add_u32 s56, s54, 671744
s_mov_b32 m0, 74752
s_nop 0
buffer_load_dwordx4 v26, s[16:19], s56 offen lds
s_add_u32 s56, s54, 688128
s_mov_b32 m0, 75776
s_nop 0
buffer_load_dwordx4 v27, s[16:19], s56 offen lds
s_add_u32 s56, s54, 704512
s_mov_b32 m0, 76800
s_nop 0
buffer_load_dwordx4 v27, s[16:19], s56 offen lds
ds_read_b64_tr_b16 v[208:209], v44 offset:20480
ds_read_b64_tr_b16 v[210:211], v44 offset:21504
ds_read_b64_tr_b16 v[212:213], v46 offset:20480
ds_read_b64_tr_b16 v[214:215], v46 offset:21504
ds_read_b64_tr_b16 v[216:217], v45 offset:20480
ds_read_b64_tr_b16 v[218:219], v45 offset:21504
ds_read_b64_tr_b16 v[220:221], v47 offset:20480
ds_read_b64_tr_b16 v[222:223], v47 offset:21504
s_waitcnt lgkmcnt(0)
s_waitcnt vmcnt(24)
s_barrier
s_add_u32 s56, s54, 1179648
s_mov_b32 m0, 77824
s_nop 0
buffer_load_dwordx4 v26, s[16:19], s56 offen lds
s_add_u32 s56, s54, 1196032
s_mov_b32 m0, 78848
s_nop 0
buffer_load_dwordx4 v26, s[16:19], s56 offen lds
s_add_u32 s56, s54, 1212416
s_mov_b32 m0, 79872
s_nop 0
buffer_load_dwordx4 v27, s[16:19], s56 offen lds
s_add_u32 s56, s54, 1228800
s_mov_b32 m0, 80896
s_nop 0
buffer_load_dwordx4 v27, s[16:19], s56 offen lds
ds_read_b64_tr_b16 v[224:225], v44 offset:24576
ds_read_b64_tr_b16 v[226:227], v44 offset:25600
ds_read_b64_tr_b16 v[228:229], v46 offset:24576
ds_read_b64_tr_b16 v[230:231], v46 offset:25600
ds_read_b64_tr_b16 v[232:233], v45 offset:24576
ds_read_b64_tr_b16 v[234:235], v45 offset:25600
ds_read_b64_tr_b16 v[236:237], v47 offset:24576
ds_read_b64_tr_b16 v[238:239], v47 offset:25600
ds_read_b64_tr_b16 v[60:61], v31 offset:32768
ds_read_b64_tr_b16 v[62:63], v31 offset:32896
ds_read_b64_tr_b16 v[64:65], v31 offset:33280
ds_read_b64_tr_b16 v[66:67], v31 offset:33408
ds_read_b64_tr_b16 v[68:69], v31 offset:34816
ds_read_b64_tr_b16 v[70:71], v31 offset:34944
ds_read_b64_tr_b16 v[72:73], v31 offset:35328
ds_read_b64_tr_b16 v[74:75], v31 offset:35456
s_waitcnt lgkmcnt(0)
ds_write_b128 v2, v[60:63] offset:32768
ds_write_b128 v2, v[64:67] offset:33792
ds_write_b128 v2, v[68:71] offset:34816
ds_write_b128 v2, v[72:75] offset:35840
s_waitcnt lgkmcnt(0)
s_waitcnt vmcnt(24)
s_barrier
s_add_u32 s56, s54, 1703936
s_mov_b32 m0, 81920
s_nop 0
buffer_load_dwordx4 v26, s[16:19], s56 offen lds
s_add_u32 s56, s54, 1720320
s_mov_b32 m0, 82944
s_nop 0
buffer_load_dwordx4 v26, s[16:19], s56 offen lds
s_add_u32 s56, s54, 1736704
s_mov_b32 m0, 83968
s_nop 0
buffer_load_dwordx4 v27, s[16:19], s56 offen lds
s_add_u32 s56, s54, 1753088
s_mov_b32 m0, 84992
s_nop 0
buffer_load_dwordx4 v27, s[16:19], s56 offen lds
ds_read_b64_tr_b16 v[240:241], v44 offset:28672
ds_read_b64_tr_b16 v[242:243], v44 offset:29696
ds_read_b64_tr_b16 v[244:245], v46 offset:28672
ds_read_b64_tr_b16 v[246:247], v46 offset:29696
ds_read_b64_tr_b16 v[248:249], v45 offset:28672
ds_read_b64_tr_b16 v[250:251], v45 offset:29696
ds_read_b64_tr_b16 v[252:253], v47 offset:28672
ds_read_b64_tr_b16 v[254:255], v47 offset:29696
ds_read_b64_tr_b16 v[60:61], v31 offset:36864
ds_read_b64_tr_b16 v[62:63], v31 offset:36992
ds_read_b64_tr_b16 v[64:65], v31 offset:37376
ds_read_b64_tr_b16 v[66:67], v31 offset:37504
ds_read_b64_tr_b16 v[68:69], v31 offset:38912
ds_read_b64_tr_b16 v[70:71], v31 offset:39040
ds_read_b64_tr_b16 v[72:73], v31 offset:39424
ds_read_b64_tr_b16 v[74:75], v31 offset:39552
s_waitcnt lgkmcnt(0)
ds_write_b128 v2, v[60:63] offset:36864
ds_write_b128 v2, v[64:67] offset:37888
ds_write_b128 v2, v[68:71] offset:38912
ds_write_b128 v2, v[72:75] offset:39936
s_waitcnt lgkmcnt(0)
s_waitcnt vmcnt(24)
s_barrier
s_add_u32 s56, s54, 2228224
s_mov_b32 m0, 86016
s_nop 0
buffer_load_dwordx4 v26, s[16:19], s56 offen lds
s_add_u32 s56, s54, 2244608
s_mov_b32 m0, 87040
s_nop 0
buffer_load_dwordx4 v26, s[16:19], s56 offen lds
s_add_u32 s56, s54, 2260992
s_mov_b32 m0, 88064
s_nop 0
buffer_load_dwordx4 v27, s[16:19], s56 offen lds
s_add_u32 s56, s54, 2277376
s_mov_b32 m0, 89088
s_nop 0
buffer_load_dwordx4 v27, s[16:19], s56 offen lds
ds_read_b64_tr_b16 a[0:1], v44 offset:0
ds_read_b64_tr_b16 a[2:3], v44 offset:1024
ds_read_b64_tr_b16 a[4:5], v46 offset:0
ds_read_b64_tr_b16 a[6:7], v46 offset:1024
ds_read_b64_tr_b16 a[8:9], v45 offset:0
ds_read_b64_tr_b16 a[10:11], v45 offset:1024
ds_read_b64_tr_b16 a[12:13], v47 offset:0
ds_read_b64_tr_b16 a[14:15], v47 offset:1024
s_waitcnt lgkmcnt(0)
s_waitcnt vmcnt(24)
s_barrier
s_add_u32 s56, s54, 2752512
s_mov_b32 m0, 57344
s_nop 0
buffer_load_dwordx4 v26, s[16:19], s56 offen lds
s_add_u32 s56, s54, 2768896
s_mov_b32 m0, 58368
s_nop 0
buffer_load_dwordx4 v26, s[16:19], s56 offen lds
s_add_u32 s56, s54, 2785280
s_mov_b32 m0, 59392
s_nop 0
buffer_load_dwordx4 v27, s[16:19], s56 offen lds
s_add_u32 s56, s54, 2801664
s_mov_b32 m0, 60416
s_nop 0
buffer_load_dwordx4 v27, s[16:19], s56 offen lds
ds_read_b64_tr_b16 a[16:17], v44 offset:4096
ds_read_b64_tr_b16 a[18:19], v44 offset:5120
ds_read_b64_tr_b16 a[20:21], v46 offset:4096
ds_read_b64_tr_b16 a[22:23], v46 offset:5120
ds_read_b64_tr_b16 a[24:25], v45 offset:4096
ds_read_b64_tr_b16 a[26:27], v45 offset:5120
ds_read_b64_tr_b16 a[28:29], v47 offset:4096
ds_read_b64_tr_b16 a[30:31], v47 offset:5120
s_waitcnt lgkmcnt(0)
s_waitcnt vmcnt(24)
s_barrier
s_add_u32 s56, s54, 3276800
s_mov_b32 m0, 61440
s_nop 0
buffer_load_dwordx4 v26, s[16:19], s56 offen lds
s_add_u32 s56, s54, 3293184
s_mov_b32 m0, 62464
s_nop 0
buffer_load_dwordx4 v26, s[16:19], s56 offen lds
s_add_u32 s56, s54, 3309568
s_mov_b32 m0, 63488
s_nop 0
buffer_load_dwordx4 v27, s[16:19], s56 offen lds
s_add_u32 s56, s54, 3325952
s_mov_b32 m0, 64512
s_nop 0
buffer_load_dwordx4 v27, s[16:19], s56 offen lds
ds_read_b64_tr_b16 a[32:33], v44 offset:8192
ds_read_b64_tr_b16 a[34:35], v44 offset:9216
ds_read_b64_tr_b16 a[36:37], v46 offset:8192
ds_read_b64_tr_b16 a[38:39], v46 offset:9216
ds_read_b64_tr_b16 a[40:41], v45 offset:8192
ds_read_b64_tr_b16 a[42:43], v45 offset:9216
ds_read_b64_tr_b16 a[44:45], v47 offset:8192
ds_read_b64_tr_b16 a[46:47], v47 offset:9216
s_waitcnt lgkmcnt(0)
s_waitcnt vmcnt(24)
s_barrier
s_add_u32 s56, s54, 3801088
s_mov_b32 m0, 65536
s_nop 0
buffer_load_dwordx4 v26, s[16:19], s56 offen lds
s_add_u32 s56, s54, 3817472
s_mov_b32 m0, 66560
s_nop 0
buffer_load_dwordx4 v26, s[16:19], s56 offen lds
s_add_u32 s56, s54, 3833856
s_mov_b32 m0, 67584
s_nop 0
buffer_load_dwordx4 v27, s[16:19], s56 offen lds
s_add_u32 s56, s54, 3850240
s_mov_b32 m0, 68608
s_nop 0
buffer_load_dwordx4 v27, s[16:19], s56 offen lds
ds_read_b64_tr_b16 a[48:49], v44 offset:12288
ds_read_b64_tr_b16 a[50:51], v44 offset:13312
ds_read_b64_tr_b16 a[52:53], v46 offset:12288
ds_read_b64_tr_b16 a[54:55], v46 offset:13312
ds_read_b64_tr_b16 a[56:57], v45 offset:12288
ds_read_b64_tr_b16 a[58:59], v45 offset:13312
ds_read_b64_tr_b16 a[60:61], v47 offset:12288
ds_read_b64_tr_b16 a[62:63], v47 offset:13312
s_waitcnt lgkmcnt(0)
s_waitcnt vmcnt(24)
s_barrier
s_add_u32 s56, s55, 78336
s_mov_b32 m0, 69632
s_nop 0
buffer_load_dwordx4 v28, s[20:23], s56 offen lds
s_add_u32 s56, s55, 80640
s_mov_b32 m0, 70656
s_nop 0
buffer_load_dwordx4 v28, s[20:23], s56 offen lds
s_add_u32 s56, s55, 87552
s_mov_b32 m0, 71680
s_nop 0
buffer_load_dwordx4 v28, s[20:23], s56 offen lds
s_add_u32 s56, s55, 89856
s_mov_b32 m0, 72704
s_nop 0
buffer_load_dwordx4 v28, s[20:23], s56 offen lds
ds_read_b64_tr_b16 a[64:65], v44 offset:16384
ds_read_b64_tr_b16 a[66:67], v44 offset:17408
ds_read_b64_tr_b16 a[68:69], v46 offset:16384
ds_read_b64_tr_b16 a[70:71], v46 offset:17408
ds_read_b64_tr_b16 a[72:73], v45 offset:16384
ds_read_b64_tr_b16 a[74:75], v45 offset:17408
ds_read_b64_tr_b16 a[76:77], v47 offset:16384
ds_read_b64_tr_b16 a[78:79], v47 offset:17408
s_waitcnt lgkmcnt(0)
s_waitcnt vmcnt(24)
s_barrier
s_add_u32 s56, s55, 78592
s_mov_b32 m0, 73728
s_nop 0
buffer_load_dwordx4 v28, s[20:23], s56 offen lds
s_add_u32 s56, s55, 80896
s_mov_b32 m0, 74752
s_nop 0
buffer_load_dwordx4 v28, s[20:23], s56 offen lds
s_add_u32 s56, s55, 87808
s_mov_b32 m0, 75776
s_nop 0
buffer_load_dwordx4 v28, s[20:23], s56 offen lds
s_add_u32 s56, s55, 90112
s_mov_b32 m0, 76800
s_nop 0
buffer_load_dwordx4 v28, s[20:23], s56 offen lds
ds_read_b64_tr_b16 a[80:81], v44 offset:20480
ds_read_b64_tr_b16 a[82:83], v44 offset:21504
ds_read_b64_tr_b16 a[84:85], v46 offset:20480
ds_read_b64_tr_b16 a[86:87], v46 offset:21504
ds_read_b64_tr_b16 a[88:89], v45 offset:20480
ds_read_b64_tr_b16 a[90:91], v45 offset:21504
ds_read_b64_tr_b16 a[92:93], v47 offset:20480
ds_read_b64_tr_b16 a[94:95], v47 offset:21504
s_waitcnt lgkmcnt(0)
s_waitcnt vmcnt(24)
s_barrier
s_add_u32 s56, s55, 78848
s_mov_b32 m0, 77824
s_nop 0
buffer_load_dwordx4 v28, s[20:23], s56 offen lds
s_add_u32 s56, s55, 81152
s_mov_b32 m0, 78848
s_nop 0
buffer_load_dwordx4 v28, s[20:23], s56 offen lds
s_add_u32 s56, s55, 88064
s_mov_b32 m0, 79872
s_nop 0
buffer_load_dwordx4 v28, s[20:23], s56 offen lds
s_add_u32 s56, s55, 90368
s_mov_b32 m0, 80896
s_nop 0
buffer_load_dwordx4 v28, s[20:23], s56 offen lds
ds_read_b64_tr_b16 a[96:97], v44 offset:24576
ds_read_b64_tr_b16 a[98:99], v44 offset:25600
ds_read_b64_tr_b16 a[100:101], v46 offset:24576
ds_read_b64_tr_b16 a[102:103], v46 offset:25600
ds_read_b64_tr_b16 a[104:105], v45 offset:24576
ds_read_b64_tr_b16 a[106:107], v45 offset:25600
ds_read_b64_tr_b16 a[108:109], v47 offset:24576
ds_read_b64_tr_b16 a[110:111], v47 offset:25600
s_waitcnt lgkmcnt(0)
s_waitcnt vmcnt(24)
s_barrier
s_add_u32 s56, s55, 79104
s_mov_b32 m0, 81920
s_nop 0
buffer_load_dwordx4 v28, s[20:23], s56 offen lds
s_add_u32 s56, s55, 81408
s_mov_b32 m0, 82944
s_nop 0
buffer_load_dwordx4 v28, s[20:23], s56 offen lds
s_add_u32 s56, s55, 88320
s_mov_b32 m0, 83968
s_nop 0
buffer_load_dwordx4 v28, s[20:23], s56 offen lds
s_add_u32 s56, s55, 90624
s_mov_b32 m0, 84992
s_nop 0
buffer_load_dwordx4 v28, s[20:23], s56 offen lds
ds_read_b64_tr_b16 a[112:113], v44 offset:28672
ds_read_b64_tr_b16 a[114:115], v44 offset:29696
ds_read_b64_tr_b16 a[116:117], v46 offset:28672
ds_read_b64_tr_b16 a[118:119], v46 offset:29696
ds_read_b64_tr_b16 a[120:121], v45 offset:28672
ds_read_b64_tr_b16 a[122:123], v45 offset:29696
ds_read_b64_tr_b16 a[124:125], v47 offset:28672
ds_read_b64_tr_b16 a[126:127], v47 offset:29696
s_waitcnt lgkmcnt(0)
s_waitcnt vmcnt(24)
s_barrier
s_add_u32 s56, s55, 4608
s_mov_b32 m0, 86016
s_nop 0
buffer_load_dwordx4 v28, s[20:23], s56 offen lds
s_add_u32 s56, s55, 6912
s_mov_b32 m0, 87040
s_nop 0
buffer_load_dwordx4 v28, s[20:23], s56 offen lds
s_add_u32 s56, s55, 13824
s_mov_b32 m0, 88064
s_nop 0
buffer_load_dwordx4 v28, s[20:23], s56 offen lds
s_add_u32 s56, s55, 16128
s_mov_b32 m0, 89088
s_nop 0
buffer_load_dwordx4 v28, s[20:23], s56 offen lds
ds_read_b64_tr_b16 a[128:129], v44 offset:0
ds_read_b64_tr_b16 a[130:131], v44 offset:1024
ds_read_b64_tr_b16 a[132:133], v46 offset:0
ds_read_b64_tr_b16 a[134:135], v46 offset:1024
ds_read_b64_tr_b16 a[136:137], v45 offset:0
ds_read_b64_tr_b16 a[138:139], v45 offset:1024
ds_read_b64_tr_b16 a[140:141], v47 offset:0
ds_read_b64_tr_b16 a[142:143], v47 offset:1024
buffer_load_dword v32, v24, s[28:31], 0 offen sc0 sc1
s_waitcnt lgkmcnt(0)
s_waitcnt vmcnt(25)
s_barrier
s_add_u32 s56, s54, 131072
s_mov_b32 m0, 57344
s_nop 0
buffer_load_dwordx4 v26, s[8:11], s56 offen lds
s_add_u32 s56, s54, 147456
s_mov_b32 m0, 58368
s_nop 0
buffer_load_dwordx4 v26, s[8:11], s56 offen lds
s_add_u32 s56, s54, 163840
s_mov_b32 m0, 59392
s_nop 0
buffer_load_dwordx4 v27, s[8:11], s56 offen lds
s_add_u32 s56, s54, 180224
s_mov_b32 m0, 60416
s_nop 0
buffer_load_dwordx4 v27, s[8:11], s56 offen lds
ds_read_b64_tr_b16 a[144:145], v44 offset:4096
ds_read_b64_tr_b16 a[146:147], v44 offset:5120
ds_read_b64_tr_b16 a[148:149], v46 offset:4096
ds_read_b64_tr_b16 a[150:151], v46 offset:5120
ds_read_b64_tr_b16 a[152:153], v45 offset:4096
ds_read_b64_tr_b16 a[154:155], v45 offset:5120
ds_read_b64_tr_b16 a[156:157], v47 offset:4096
ds_read_b64_tr_b16 a[158:159], v47 offset:5120
s_waitcnt lgkmcnt(0)
s_waitcnt vmcnt(25)
s_barrier
s_add_u32 s56, s54, 1703936
s_mov_b32 m0, 61440
s_nop 0
buffer_load_dwordx4 v26, s[8:11], s56 offen lds
s_add_u32 s56, s54, 1720320
s_mov_b32 m0, 62464
s_nop 0
buffer_load_dwordx4 v26, s[8:11], s56 offen lds
s_add_u32 s56, s54, 1736704
s_mov_b32 m0, 63488
s_nop 0
buffer_load_dwordx4 v27, s[8:11], s56 offen lds
s_add_u32 s56, s54, 1753088
s_mov_b32 m0, 64512
s_nop 0
buffer_load_dwordx4 v27, s[8:11], s56 offen lds
ds_read_b64_tr_b16 a[160:161], v44 offset:8192
ds_read_b64_tr_b16 a[162:163], v44 offset:9216
ds_read_b64_tr_b16 a[164:165], v46 offset:8192
ds_read_b64_tr_b16 a[166:167], v46 offset:9216
ds_read_b64_tr_b16 a[168:169], v45 offset:8192
ds_read_b64_tr_b16 a[170:171], v45 offset:9216
ds_read_b64_tr_b16 a[172:173], v47 offset:8192
ds_read_b64_tr_b16 a[174:175], v47 offset:9216
s_waitcnt lgkmcnt(0)
s_waitcnt vmcnt(25)
s_barrier
s_add_u32 s56, s54, 2228224
s_mov_b32 m0, 65536
s_nop 0
buffer_load_dwordx4 v26, s[8:11], s56 offen lds
s_add_u32 s56, s54, 2244608
s_mov_b32 m0, 66560
s_nop 0
buffer_load_dwordx4 v26, s[8:11], s56 offen lds
s_add_u32 s56, s54, 2260992
s_mov_b32 m0, 67584
s_nop 0
buffer_load_dwordx4 v27, s[8:11], s56 offen lds
s_add_u32 s56, s54, 2277376
s_mov_b32 m0, 68608
s_nop 0
buffer_load_dwordx4 v27, s[8:11], s56 offen lds
ds_read_b64_tr_b16 a[200:201], v48 offset:12288
ds_read_b64_tr_b16 a[202:203], v48 offset:13312
ds_read_b64_tr_b16 a[204:205], v48 offset:14336
ds_read_b64_tr_b16 a[206:207], v48 offset:15360
ds_read_b64_tr_b16 a[184:185], v49 offset:12288
ds_read_b64_tr_b16 a[186:187], v49 offset:13312
ds_read_b64_tr_b16 a[188:189], v49 offset:14336
ds_read_b64_tr_b16 a[190:191], v49 offset:15360
s_waitcnt lgkmcnt(0)
s_waitcnt vmcnt(25)
s_barrier
s_add_u32 s56, s54, 2752512
s_mov_b32 m0, 69632
s_nop 0
buffer_load_dwordx4 v26, s[12:15], s56 offen lds
s_add_u32 s56, s54, 2768896
s_mov_b32 m0, 70656
s_nop 0
buffer_load_dwordx4 v26, s[12:15], s56 offen lds
s_add_u32 s56, s54, 2785280
s_mov_b32 m0, 71680
s_nop 0
buffer_load_dwordx4 v27, s[12:15], s56 offen lds
s_add_u32 s56, s54, 2801664
s_mov_b32 m0, 72704
s_nop 0
buffer_load_dwordx4 v27, s[12:15], s56 offen lds
ds_read_b64_tr_b16 a[216:217], v48 offset:16384
ds_read_b64_tr_b16 a[218:219], v48 offset:17408
ds_read_b64_tr_b16 a[220:221], v48 offset:18432
ds_read_b64_tr_b16 a[222:223], v48 offset:19456
ds_read_b64_tr_b16 a[208:209], v49 offset:16384
ds_read_b64_tr_b16 a[210:211], v49 offset:17408
ds_read_b64_tr_b16 a[212:213], v49 offset:18432
ds_read_b64_tr_b16 a[214:215], v49 offset:19456
s_waitcnt lgkmcnt(0)
s_waitcnt vmcnt(25)
s_barrier
s_add_u32 s56, s54, 4325376
s_mov_b32 m0, 73728
s_nop 0
buffer_load_dwordx4 v26, s[16:19], s56 offen lds
s_add_u32 s56, s54, 4341760
s_mov_b32 m0, 74752
s_nop 0
buffer_load_dwordx4 v26, s[16:19], s56 offen lds
s_add_u32 s56, s54, 4358144
s_mov_b32 m0, 75776
s_nop 0
buffer_load_dwordx4 v27, s[16:19], s56 offen lds
s_add_u32 s56, s54, 4374528
s_mov_b32 m0, 76800
s_nop 0
buffer_load_dwordx4 v27, s[16:19], s56 offen lds
ds_read_b64_tr_b16 a[232:233], v48 offset:20480
ds_read_b64_tr_b16 a[234:235], v48 offset:21504
ds_read_b64_tr_b16 a[236:237], v48 offset:22528
ds_read_b64_tr_b16 a[238:239], v48 offset:23552
ds_read_b64_tr_b16 a[224:225], v49 offset:20480
ds_read_b64_tr_b16 a[226:227], v49 offset:21504
ds_read_b64_tr_b16 a[228:229], v49 offset:22528
ds_read_b64_tr_b16 a[230:231], v49 offset:23552
s_waitcnt lgkmcnt(0)
s_waitcnt vmcnt(25)
s_barrier
s_add_u32 s56, s55, 4864
s_mov_b32 m0, 77824
s_nop 0
buffer_load_dwordx4 v28, s[20:23], s56 offen lds
s_add_u32 s56, s55, 7168
s_mov_b32 m0, 78848
s_nop 0
buffer_load_dwordx4 v28, s[20:23], s56 offen lds
s_add_u32 s56, s55, 14080
s_mov_b32 m0, 79872
s_nop 0
buffer_load_dwordx4 v28, s[20:23], s56 offen lds
s_add_u32 s56, s55, 16384
s_mov_b32 m0, 80896
s_nop 0
buffer_load_dwordx4 v28, s[20:23], s56 offen lds
ds_read_b64_tr_b16 a[248:249], v48 offset:24576
ds_read_b64_tr_b16 a[250:251], v48 offset:25600
ds_read_b64_tr_b16 a[252:253], v48 offset:26624
ds_read_b64_tr_b16 a[254:255], v48 offset:27648
ds_read_b64_tr_b16 a[240:241], v49 offset:24576
ds_read_b64_tr_b16 a[242:243], v49 offset:25600
ds_read_b64_tr_b16 a[244:245], v49 offset:26624
ds_read_b64_tr_b16 a[246:247], v49 offset:27648
s_waitcnt lgkmcnt(0)
s_waitcnt vmcnt(25)
s_barrier
s_add_u32 s56, s55, 5120
s_mov_b32 m0, 81920
s_nop 0
buffer_load_dwordx4 v28, s[20:23], s56 offen lds
s_add_u32 s56, s55, 7424
s_mov_b32 m0, 82944
s_nop 0
buffer_load_dwordx4 v28, s[20:23], s56 offen lds
s_add_u32 s56, s55, 14336
s_mov_b32 m0, 83968
s_nop 0
buffer_load_dwordx4 v28, s[20:23], s56 offen lds
s_add_u32 s56, s55, 16640
s_mov_b32 m0, 84992
s_nop 0
buffer_load_dwordx4 v28, s[20:23], s56 offen lds
ds_read_b64_tr_b16 a[192:193], v48 offset:28672
ds_read_b64_tr_b16 a[194:195], v48 offset:29696
ds_read_b64_tr_b16 a[196:197], v48 offset:30720
ds_read_b64_tr_b16 a[198:199], v48 offset:31744
ds_read_b64_tr_b16 a[176:177], v49 offset:28672
ds_read_b64_tr_b16 a[178:179], v49 offset:29696
ds_read_b64_tr_b16 a[180:181], v49 offset:30720
ds_read_b64_tr_b16 a[182:183], v49 offset:31744
s_waitcnt lgkmcnt(0)
s_waitcnt vmcnt(24)
s_barrier
s_add_u32 s56, s55, 5376
s_mov_b32 m0, 86016
s_nop 0
buffer_load_dwordx4 v28, s[20:23], s56 offen lds
s_add_u32 s56, s55, 7680
s_mov_b32 m0, 87040
s_nop 0
buffer_load_dwordx4 v28, s[20:23], s56 offen lds
s_add_u32 s56, s55, 14592
s_mov_b32 m0, 88064
s_nop 0
buffer_load_dwordx4 v28, s[20:23], s56 offen lds
s_add_u32 s56, s55, 16896
s_mov_b32 m0, 89088
s_nop 0
buffer_load_dwordx4 v28, s[20:23], s56 offen lds
ds_read_b64_tr_b16 v[60:61], v44 offset:0
ds_read_b64_tr_b16 v[62:63], v44 offset:1024
ds_read_b64_tr_b16 v[64:65], v46 offset:0
ds_read_b64_tr_b16 v[66:67], v46 offset:1024
ds_read_b64_tr_b16 v[68:69], v45 offset:0
ds_read_b64_tr_b16 v[70:71], v45 offset:1024
ds_read_b64_tr_b16 v[72:73], v47 offset:0
ds_read_b64_tr_b16 v[74:75], v47 offset:1024
s_waitcnt lgkmcnt(0)
s_waitcnt vmcnt(24)
s_barrier
ds_write_b128 v2, v[60:63] offset:0
ds_write_b128 v2, v[64:67] offset:1024
ds_write_b128 v2, v[68:71] offset:2048
ds_write_b128 v2, v[72:75] offset:3072
ds_read_b64_tr_b16 v[60:61], v44 offset:4096
ds_read_b64_tr_b16 v[62:63], v44 offset:5120
ds_read_b64_tr_b16 v[64:65], v46 offset:4096
ds_read_b64_tr_b16 v[66:67], v46 offset:5120
ds_read_b64_tr_b16 v[68:69], v45 offset:4096
ds_read_b64_tr_b16 v[70:71], v45 offset:5120
ds_read_b64_tr_b16 v[72:73], v47 offset:4096
ds_read_b64_tr_b16 v[74:75], v47 offset:5120
L_rdv_w1r:
v_readfirstlane_b32 s38, v32
s_nop 0
s_and_b32 s57, s38, 0xff
s_cmp_lg_u32 s57, 32
s_cbranch_scc1 L_rdv2_w1r
s_waitcnt lgkmcnt(0)
s_waitcnt vmcnt(20)
s_barrier
ds_write_b128 v2, v[60:63] offset:4096
ds_write_b128 v2, v[64:67] offset:5120
ds_write_b128 v2, v[68:71] offset:6144
ds_write_b128 v2, v[72:75] offset:7168
ds_read_b64_tr_b16 v[60:61], v44 offset:8192
ds_read_b64_tr_b16 v[62:63], v44 offset:9216
ds_read_b64_tr_b16 v[64:65], v46 offset:8192
ds_read_b64_tr_b16 v[66:67], v46 offset:9216
ds_read_b64_tr_b16 v[68:69], v45 offset:8192
ds_read_b64_tr_b16 v[70:71], v45 offset:9216
ds_read_b64_tr_b16 v[72:73], v47 offset:8192
ds_read_b64_tr_b16 v[74:75], v47 offset:9216
buffer_load_dwordx4 v[12:15], v9, s[4:7], s37 offen offset:0
buffer_load_dwordx4 v[16:19], v9, s[4:7], s37 offen offset:1024
buffer_load_dwordx4 v[52:55], v1, s[4:7], s37 offen offset:2048
buffer_load_dwordx4 v[56:59], v1, s[4:7], s37 offen offset:3072
s_mov_b32 m0, 1024
s_nop 0
buffer_load_dwordx4 v1, s[4:7], s47 offen offset:1024 sc1 lds
buffer_load_dword v33, v1, s[4:7], s3 offen offset:0 sc1
buffer_load_dword v33, v1, s[4:7], s3 offen offset:1024 sc1
buffer_load_dword v33, v1, s[4:7], s3 offen offset:2048 sc1
buffer_load_dword v33, v1, s[4:7], s3 offen offset:3072 sc1
s_waitcnt lgkmcnt(0)
s_waitcnt vmcnt(25)
s_barrier
ds_write_b128 v2, v[60:63] offset:8192
ds_write_b128 v2, v[64:67] offset:9216
ds_write_b128 v2, v[68:71] offset:10240
ds_write_b128 v2, v[72:75] offset:11264
ds_read_b64_tr_b16 v[60:61], v44 offset:12288
ds_read_b64_tr_b16 v[62:63], v44 offset:13312
ds_read_b64_tr_b16 v[64:65], v46 offset:12288
ds_read_b64_tr_b16 v[66:67], v46 offset:13312
ds_read_b64_tr_b16 v[68:69], v45 offset:12288
ds_read_b64_tr_b16 v[70:71], v45 offset:13312
ds_read_b64_tr_b16 v[72:73], v47 offset:12288
ds_read_b64_tr_b16 v[74:75], v47 offset:13312
s_waitcnt lgkmcnt(0)
s_waitcnt vmcnt(21)
s_barrier
ds_write_b128 v2, v[60:63] offset:12288
ds_write_b128 v2, v[64:67] offset:13312
ds_write_b128 v2, v[68:71] offset:14336
ds_write_b128 v2, v[72:75] offset:15360
ds_read_b64_tr_b16 v[60:61], v44 offset:16384
ds_read_b64_tr_b16 v[62:63], v44 offset:17408
ds_read_b64_tr_b16 v[64:65], v46 offset:16384
ds_read_b64_tr_b16 v[66:67], v46 offset:17408
ds_read_b64_tr_b16 v[68:69], v45 offset:16384
ds_read_b64_tr_b16 v[70:71], v45 offset:17408
ds_read_b64_tr_b16 v[72:73], v47 offset:16384
ds_read_b64_tr_b16 v[74:75], v47 offset:17408
s_waitcnt lgkmcnt(0)
s_waitcnt vmcnt(17)
s_barrier
ds_write_b128 v2, v[60:63] offset:16384
ds_write_b128 v2, v[64:67] offset:17408
ds_write_b128 v2, v[68:71] offset:18432
ds_write_b128 v2, v[72:75] offset:19456
ds_read_b64_tr_b16 v[60:61], v48 offset:20480
ds_read_b64_tr_b16 v[62:63], v48 offset:21504
ds_read_b64_tr_b16 v[64:65], v48 offset:22528
ds_read_b64_tr_b16 v[66:67], v48 offset:23552
ds_read_b64_tr_b16 v[68:69], v49 offset:20480
ds_read_b64_tr_b16 v[70:71], v49 offset:21504
ds_read_b64_tr_b16 v[72:73], v49 offset:22528
ds_read_b64_tr_b16 v[74:75], v49 offset:23552
s_waitcnt lgkmcnt(0)
s_waitcnt vmcnt(13)
s_barrier
ds_write_b128 v2, v[60:63] offset:20480
ds_write_b128 v2, v[64:67] offset:21504
ds_write_b128 v2, v[68:71] offset:22528
ds_write_b128 v2, v[72:75] offset:23552
ds_read_b64_tr_b16 v[60:61], v48 offset:24576
ds_read_b64_tr_b16 v[62:63], v48 offset:25600
ds_read_b64_tr_b16 v[64:65], v48 offset:26624
ds_read_b64_tr_b16 v[66:67], v48 offset:27648
ds_read_b64_tr_b16 v[68:69], v49 offset:24576
ds_read_b64_tr_b16 v[70:71], v49 offset:25600
ds_read_b64_tr_b16 v[72:73], v49 offset:26624
ds_read_b64_tr_b16 v[74:75], v49 offset:27648
s_waitcnt lgkmcnt(0)
s_waitcnt vmcnt(9)
s_barrier
ds_write_b128 v2, v[60:63] offset:24576
ds_write_b128 v2, v[64:67] offset:25600
ds_write_b128 v2, v[68:71] offset:26624
ds_write_b128 v2, v[72:75] offset:27648
ds_read_b64_tr_b16 v[60:61], v48 offset:28672
ds_read_b64_tr_b16 v[62:63], v48 offset:29696
ds_read_b64_tr_b16 v[64:65], v48 offset:30720
ds_read_b64_tr_b16 v[66:67], v48 offset:31744
ds_read_b64_tr_b16 v[68:69], v49 offset:28672
ds_read_b64_tr_b16 v[70:71], v49 offset:29696
ds_read_b64_tr_b16 v[72:73], v49 offset:30720
ds_read_b64_tr_b16 v[74:75], v49 offset:31744
s_waitcnt lgkmcnt(0)
s_barrier
ds_write_b128 v2, v[60:63] offset:28672
ds_write_b128 v2, v[64:67] offset:29696
ds_write_b128 v2, v[68:71] offset:30720
ds_write_b128 v2, v[72:75] offset:31744
s_lshl_b32 s57, s58, 5
s_mov_b32 s0, 0x3f003f00
s_mov_b32 s1, 0x3f003f00
s_mov_b32 s58, 304128
s_cmp_eq_u32 s38, s57
s_mov_b32 s56, 0x33333333
s_mov_b32 s57, 0x33333333
s_mov_b32 s2, 0x21800000
s_mov_b32 s55, -24
s_cbranch_scc0 L_slow_w1r
v_mov_b64 v[20:21], 0
v_mov_b64 v[22:23], 0
v_mov_b64 v[24:25], 0
v_mov_b64 v[26:27], 0
v_mov_b64 v[28:29], 0
v_mov_b64 v[30:31], 0
v_mov_b64 v[32:33], 0
v_mov_b64 v[34:35], 0
v_mov_b64 v[36:37], 0
v_mov_b64 v[38:39], 0
v_mov_b64 v[40:41], 0
v_mov_b64 v[42:43], 0
ds_read_b128 v[44:47], v2 offset:0
ds_read_b128 v[48:51], v2 offset:1024
v_bfe_u32 v77, v1, 6, 1
v_lshl_add_u32 v77, v77, 3, v1
v_lshlrev_b32 v77, 1, v77
v_lshlrev_b32 v78, 3, v1
s_waitcnt vmcnt(0) lgkmcnt(0)
s_branch L_top_w1rf
L_done_w1rf:
s_mul_i32 s40, s34, 10240
s_add_u32 s40, s40, 8093696
buffer_store_dword v11, v10, s[4:7], s40 offen sc0 sc1
s_waitcnt vmcnt(0) lgkmcnt(0)
s_endpgm
L_rdv2_w1r:
buffer_load_dword v32, v24, s[28:31], 0 offen sc0 sc1
s_sub_u32 s41, s41, 1
s_cbranch_scc1 L_exit
s_waitcnt vmcnt(0)
s_branch L_rdv_w1r
L_ra0_w1rf:
s_mov_b32 m0, 1024
s_nop 0
buffer_load_dwordx4 v1, s[4:7], s47 offen offset:0 sc1 lds
buffer_load_dwordx4 v1, s[4:7], s47 offen offset:1024 sc1 lds
buffer_load_dwordx4 v1, s[4:7], s47 offen offset:2048 sc1 lds
buffer_load_dwordx4 v1, s[4:7], s47 offen offset:3072 sc1 lds
s_sub_u32 s41, s41, 1
s_cbranch_scc1 L_exit
ds_read_b128 v[44:47], v2 offset:0
ds_read_b128 v[48:51], v2 offset:1024
v_mov_b64 v[20:21], 0
v_mov_b64 v[22:23], 0
v_mov_b64 v[24:25], 0
v_mov_b64 v[26:27], 0
v_mov_b64 v[28:29], 0
v_mov_b64 v[30:31], 0
v_mov_b64 v[32:33], 0
v_mov_b64 v[34:35], 0
v_mov_b64 v[36:37], 0
v_mov_b64 v[38:39], 0
v_mov_b64 v[40:41], 0
v_mov_b64 v[42:43], 0
s_waitcnt vmcnt(0)
ds_read_b128 v[60:63], v1 offset:1024
ds_read_b128 v[64:67], v1 offset:2048
ds_read_b128 v[68:71], v1 offset:3072
ds_read_b128 v[72:75], v1 offset:4096
s_branch L_s0_w1rf
L_ra1_w1rf:
L_ra2_w1rf:
s_waitcnt lgkmcnt(0)
s_barrier
s_mov_b32 m0, 5120
s_nop 0
buffer_load_dwordx4 v1, s[4:7], s48 offen offset:1024 sc1 lds
s_sub_u32 s41, s41, 1
s_cbranch_scc1 L_exit
s_waitcnt vmcnt(0)
s_barrier
ds_read_b128 v[76:79], v1 offset:5120
ds_read_b128 v[60:63], v1 offset:6144
ds_read_b128 v[64:67], v1 offset:7168
ds_read_b128 v[68:71], v1 offset:8192
ds_read_b128 v[72:75], v1 offset:9216
s_waitcnt lgkmcnt(0)
v_bitop3_b32 v6, v76, v60, s35 bitop3:0x7e
v_bitop3_b32 v6, v6, v64, s35 bitop3:0xf6
v_bitop3_b32 v6, v6, v68, s35 bitop3:0xf6
v_bitop3_b32 v6, v6, v72, s35 bitop3:0xf6
v_and_b32 v6, 1, v6
v_cmp_ne_u32 vcc, 0, v6

s_cbranch_vccnz L_ra2_w1rf
s_branch L_a1_w1rf
L_mx_w1rf:
s_waitcnt lgkmcnt(0)
v_max3_f32 v30, v12, v13, v28
v_max_f32 v30, v30, v29
v_mov_b32 v31, v30
s_nop 1
v_permlane16_swap_b32 v30, v31
v_max_f32 v30, v30, v31
v_mov_b32 v31, v30
s_nop 1
v_permlane32_swap_b32 v30, v31
v_max_f32 v30, v30, v31
ds_write_b32 v1, v30 offset:10244
s_waitcnt lgkmcnt(0)
s_barrier
ds_read_b128 v[32:35], v1 offset:10240
s_waitcnt lgkmcnt(0)
v_max3_f32 v32, v32, v33, v34
v_max_f32 v32, v32, v35
v_sub_f32 v14, v12, v32
v_sub_f32 v15, v13, v32
v_sub_f32 v30, v28, v32
v_sub_f32 v31, v29, v32
v_exp_f32 v14, v14
v_exp_f32 v15, v15
v_exp_f32 v30, v30
v_exp_f32 v31, v31
v_cvt_pk_bf16_f32 v14, v14, v15
v_cvt_pk_bf16_f32 v30, v30, v31
ds_write_b32 v5, v14 offset:14624
v_cndmask_b32_e64 v26, 0, v30, s[56:57]
v_cndmask_b32_e64 v27, 0, v30, s[56:57]
v_mov_b64 v[76:77], s[52:53]
v_mov_b64 v[78:79], s[52:53]
v_mov_b32_dpp v24, v26 quad_perm:[2,3,0,1] row_mask:0xf bank_mask:0xf
v_mov_b32_dpp v25, v26 quad_perm:[2,3,0,1] row_mask:0xf bank_mask:0xf
s_waitcnt lgkmcnt(0)
s_barrier
v_mov_b64 v[14:15], s[0:1]
ds_read_b128 v[16:19], v1 offset:14368
ds_read_b128 v[36:39], v1 offset:14336
s_waitcnt lgkmcnt(0)
v_mfma_f32_16x16x32_bf16 v[32:35], v[76:79], v[16:19], 0
v_mfma_f32_16x16x32_bf16 v[20:23], v[52:55], v[16:19], 0
v_mfma_f32_16x16x32_bf16 v[20:23], v[56:59], v[36:39], v[20:23]
v_mfma_f32_16x16x16_bf16 v[32:35], v[14:15], v[26:27], v[32:35]
v_mfma_f32_16x16x32_bf16 v[20:23], v[40:43], v[24:27], v[20:23]
s_nop 3
v_rcp_f32 v33, v32
s_nop 2
v_mul_f32_dpp v20, v33, v20 quad_perm:[0,1,0,1] row_mask:0xf bank_mask:0xf
v_mul_f32_dpp v21, v33, v21 quad_perm:[0,1,0,1] row_mask:0xf bank_mask:0xf
v_mul_f32_dpp v22, v33, v22 quad_perm:[0,1,0,1] row_mask:0xf bank_mask:0xf
v_mul_f32_dpp v23, v33, v23 quad_perm:[0,1,0,1] row_mask:0xf bank_mask:0xf
v_cvt_pk_bf16_f32 v20, v20, v21
v_cvt_pk_bf16_f32 v21, v22, v23
ds_write_b64 v6, v[20:21] offset:6144
v_mov_b32_dpp v16, v20 quad_perm:[0,1,0,1] row_mask:0xf bank_mask:0xf
v_mov_b32_dpp v17, v21 quad_perm:[0,1,0,1] row_mask:0xf bank_mask:0xf
v_mov_b32_dpp v18, v20 quad_perm:[2,3,2,3] row_mask:0xf bank_mask:0xf
v_mov_b32_dpp v19, v21 quad_perm:[2,3,2,3] row_mask:0xf bank_mask:0xf
v_mov_b64 v[76:77], 0
v_mov_b64 v[78:79], 0
v_mov_b64 v[36:37], 0
v_mov_b64 v[38:39], 0
v_mov_b64 v[24:25], 0
v_mov_b64 v[26:27], 0
v_mov_b64 v[32:33], 0
v_mov_b64 v[34:35], 0
s_waitcnt lgkmcnt(0)
s_branch L_mxb_w1rf

L_rr_w1rf:
buffer_load_dwordx4 v[60:63], v9, s[4:7], s3 offen offset:0 sc1
buffer_load_dwordx4 v[64:67], v9, s[4:7], s3 offen offset:1024 sc1
buffer_load_dwordx4 v[68:71], v9, s[4:7], s3 offen offset:2048 sc1
buffer_load_dwordx4 v[72:75], v9, s[4:7], s3 offen offset:3072 sc1
s_sub_u32 s41, s41, 1
s_cbranch_scc1 L_exit
s_waitcnt vmcnt(0)
s_branch L_r_w1rf
L_slow_w1r:
v_mov_b64 v[20:21], 0
v_mov_b64 v[22:23], 0
v_mov_b64 v[24:25], 0
v_mov_b64 v[26:27], 0
v_mov_b64 v[28:29], 0
v_mov_b64 v[30:31], 0
v_mov_b64 v[32:33], 0
v_mov_b64 v[34:35], 0
v_mov_b64 v[36:37], 0
v_mov_b64 v[38:39], 0
v_mov_b64 v[40:41], 0
v_mov_b64 v[42:43], 0
ds_read_b128 v[44:47], v2 offset:0
ds_read_b128 v[48:51], v2 offset:1024
v_bfe_u32 v77, v1, 6, 1
v_lshl_add_u32 v77, v77, 3, v1
v_lshlrev_b32 v77, 1, v77
v_lshlrev_b32 v78, 3, v1
s_waitcnt vmcnt(0) lgkmcnt(0)
s_branch L_top_w1rs
L_done_w1rs:
s_mul_i32 s40, s34, 10240
s_add_u32 s40, s40, 8093696
buffer_store_dword v11, v10, s[4:7], s40 offen sc0 sc1
s_waitcnt vmcnt(0) lgkmcnt(0)
s_endpgm
L_ra0_w1rs:
s_mov_b32 m0, 1024
s_nop 0
buffer_load_dwordx4 v1, s[4:7], s47 offen offset:0 sc0 sc1 lds
buffer_load_dwordx4 v1, s[4:7], s47 offen offset:1024 sc0 sc1 lds
buffer_load_dwordx4 v1, s[4:7], s47 offen offset:2048 sc0 sc1 lds
buffer_load_dwordx4 v1, s[4:7], s47 offen offset:3072 sc0 sc1 lds
s_sub_u32 s41, s41, 1
s_cbranch_scc1 L_exit
ds_read_b128 v[44:47], v2 offset:0
ds_read_b128 v[48:51], v2 offset:1024
v_mov_b64 v[20:21], 0
v_mov_b64 v[22:23], 0
v_mov_b64 v[24:25], 0
v_mov_b64 v[26:27], 0
v_mov_b64 v[28:29], 0
v_mov_b64 v[30:31], 0
v_mov_b64 v[32:33], 0
v_mov_b64 v[34:35], 0
v_mov_b64 v[36:37], 0
v_mov_b64 v[38:39], 0
v_mov_b64 v[40:41], 0
v_mov_b64 v[42:43], 0
s_waitcnt vmcnt(0)
ds_read_b128 v[60:63], v1 offset:1024
ds_read_b128 v[64:67], v1 offset:2048
ds_read_b128 v[68:71], v1 offset:3072
ds_read_b128 v[72:75], v1 offset:4096
s_branch L_s0_w1rs
L_ra1_w1rs:
L_ra2_w1rs:
s_waitcnt lgkmcnt(0)
s_barrier
s_mov_b32 m0, 5120
s_nop 0
buffer_load_dwordx4 v1, s[4:7], s48 offen offset:1024 sc0 sc1 lds
s_sub_u32 s41, s41, 1
s_cbranch_scc1 L_exit
s_waitcnt vmcnt(0)
s_barrier
ds_read_b128 v[76:79], v1 offset:5120
ds_read_b128 v[60:63], v1 offset:6144
ds_read_b128 v[64:67], v1 offset:7168
ds_read_b128 v[68:71], v1 offset:8192
ds_read_b128 v[72:75], v1 offset:9216
s_waitcnt lgkmcnt(0)
v_bitop3_b32 v6, v76, v60, s35 bitop3:0x7e
v_bitop3_b32 v6, v6, v64, s35 bitop3:0xf6
v_bitop3_b32 v6, v6, v68, s35 bitop3:0xf6
v_bitop3_b32 v6, v6, v72, s35 bitop3:0xf6
v_and_b32 v6, 1, v6
v_cmp_ne_u32 vcc, 0, v6

s_cbranch_vccnz L_ra2_w1rs
s_branch L_a1_w1rs
L_mx_w1rs:
s_waitcnt lgkmcnt(0)
v_max3_f32 v30, v12, v13, v28
v_max_f32 v30, v30, v29
v_mov_b32 v31, v30
s_nop 1
v_permlane16_swap_b32 v30, v31
v_max_f32 v30, v30, v31
v_mov_b32 v31, v30
s_nop 1
v_permlane32_swap_b32 v30, v31
v_max_f32 v30, v30, v31
ds_write_b32 v1, v30 offset:10244
s_waitcnt lgkmcnt(0)
s_barrier
ds_read_b128 v[32:35], v1 offset:10240
s_waitcnt lgkmcnt(0)
v_max3_f32 v32, v32, v33, v34
v_max_f32 v32, v32, v35
v_sub_f32 v14, v12, v32
v_sub_f32 v15, v13, v32
v_sub_f32 v30, v28, v32
v_sub_f32 v31, v29, v32
v_exp_f32 v14, v14
v_exp_f32 v15, v15
v_exp_f32 v30, v30
v_exp_f32 v31, v31
v_cvt_pk_bf16_f32 v14, v14, v15
v_cvt_pk_bf16_f32 v30, v30, v31
ds_write_b32 v5, v14 offset:14624
v_cndmask_b32_e64 v26, 0, v30, s[56:57]
v_cndmask_b32_e64 v27, 0, v30, s[56:57]
v_mov_b64 v[76:77], s[52:53]
v_mov_b64 v[78:79], s[52:53]
v_mov_b32_dpp v24, v26 quad_perm:[2,3,0,1] row_mask:0xf bank_mask:0xf
v_mov_b32_dpp v25, v26 quad_perm:[2,3,0,1] row_mask:0xf bank_mask:0xf
s_waitcnt lgkmcnt(0)
s_barrier
v_mov_b64 v[14:15], s[0:1]
ds_read_b128 v[16:19], v1 offset:14368
ds_read_b128 v[36:39], v1 offset:14336
s_waitcnt lgkmcnt(0)
v_mfma_f32_16x16x32_bf16 v[32:35], v[76:79], v[16:19], 0
v_mfma_f32_16x16x32_bf16 v[20:23], v[52:55], v[16:19], 0
v_mfma_f32_16x16x32_bf16 v[20:23], v[56:59], v[36:39], v[20:23]
v_mfma_f32_16x16x16_bf16 v[32:35], v[14:15], v[26:27], v[32:35]
v_mfma_f32_16x16x32_bf16 v[20:23], v[40:43], v[24:27], v[20:23]
s_nop 3
v_rcp_f32 v33, v32
s_nop 2
v_mul_f32_dpp v20, v33, v20 quad_perm:[0,1,0,1] row_mask:0xf bank_mask:0xf
v_mul_f32_dpp v21, v33, v21 quad_perm:[0,1,0,1] row_mask:0xf bank_mask:0xf
v_mul_f32_dpp v22, v33, v22 quad_perm:[0,1,0,1] row_mask:0xf bank_mask:0xf
v_mul_f32_dpp v23, v33, v23 quad_perm:[0,1,0,1] row_mask:0xf bank_mask:0xf
v_cvt_pk_bf16_f32 v20, v20, v21
v_cvt_pk_bf16_f32 v21, v22, v23
ds_write_b64 v6, v[20:21] offset:6144
v_mov_b32_dpp v16, v20 quad_perm:[0,1,0,1] row_mask:0xf bank_mask:0xf
v_mov_b32_dpp v17, v21 quad_perm:[0,1,0,1] row_mask:0xf bank_mask:0xf
v_mov_b32_dpp v18, v20 quad_perm:[2,3,2,3] row_mask:0xf bank_mask:0xf
v_mov_b32_dpp v19, v21 quad_perm:[2,3,2,3] row_mask:0xf bank_mask:0xf
v_mov_b64 v[76:77], 0
v_mov_b64 v[78:79], 0
v_mov_b64 v[36:37], 0
v_mov_b64 v[38:39], 0
v_mov_b64 v[24:25], 0
v_mov_b64 v[26:27], 0
v_mov_b64 v[32:33], 0
v_mov_b64 v[34:35], 0
s_waitcnt lgkmcnt(0)
s_branch L_mxb_w1rs

L_rr_w1rs:
buffer_load_dwordx4 v[60:63], v9, s[4:7], s3 offen offset:0 sc0 sc1
buffer_load_dwordx4 v[64:67], v9, s[4:7], s3 offen offset:1024 sc0 sc1
buffer_load_dwordx4 v[68:71], v9, s[4:7], s3 offen offset:2048 sc0 sc1
buffer_load_dwordx4 v[72:75], v9, s[4:7], s3 offen offset:3072 sc0 sc1
s_sub_u32 s41, s41, 1
s_cbranch_scc1 L_exit
s_waitcnt vmcnt(0)
s_branch L_r_w1rs
.p2align 6
L_ex_w0f:
s_add_u32 s34, s34, 1
s_not_b32 s35, s35
s_not_b32 s36, s36
s_add_u32 s37, s37, 524288
s_add_u32 s39, s39, 524288
v_mov_b64 v[20:21], 0
v_mov_b64 v[22:23], 0
v_mov_b64 v[24:25], 0
v_mov_b64 v[26:27], 0
v_mov_b64 v[28:29], 0
v_mov_b64 v[30:31], 0
v_mov_b64 v[32:33], 0
v_mov_b64 v[34:35], 0
v_mov_b64 v[36:37], 0
v_mov_b64 v[38:39], 0
v_mov_b64 v[40:41], 0
v_mov_b64 v[42:43], 0
ds_read_b128 v[44:47], v2 offset:0
ds_read_b128 v[48:51], v2 offset:1024
v_bfe_u32 v77, v1, 6, 1
v_lshl_add_u32 v77, v77, 3, v1
v_lshlrev_b32 v77, 1, v77
v_lshlrev_b32 v78, 3, v1
s_barrier
s_cmp_eq_u32 s34, 63
s_cbranch_scc1 L_done_w0f
L_top_w0f:
s_barrier
ds_read_b128 v[60:63], v1 offset:1024
s_mov_b32 m0, 5120
s_nop 0
buffer_load_dwordx4 v1, s[4:7], s48 offen offset:0 sc1 lds
s_barrier
ds_read_b128 v[64:67], v1 offset:2048
ds_read_b128 v[68:71], v1 offset:3072
ds_read_b128 v[72:75], v1 offset:4096
L_s0_w0f:
s_waitcnt lgkmcnt(3)
v_smfmac_f32_16x16x64_bf16 v[32:35], v[60:63], v[184:191], v0
v_smfmac_f32_16x16x64_bf16 v[20:23], v[60:63], v[44:51], v0
v_smfmac_f32_16x16x64_bf16 v[36:39], v[60:63], a[48:55], v0
buffer_load_dwordx4 v[12:15], v9, s[4:7], s37 offen offset:0
v_smfmac_f32_16x16x64_bf16 v[28:31], v[60:63], v[176:183], v0
buffer_load_dwordx4 v[16:19], v9, s[4:7], s37 offen offset:1024
v_smfmac_f32_16x16x64_bf16 v[40:43], v[60:63], a[56:63], v0
s_waitcnt lgkmcnt(2)
v_smfmac_f32_16x16x64_bf16 v[28:31], v[64:67], v[192:199], v0
ds_read_b128 v[48:51], v2 offset:3072
v_smfmac_f32_16x16x64_bf16 v[20:23], v[64:67], v[80:87], v0
ds_read_b128 v[44:47], v2 offset:2048
v_smfmac_f32_16x16x64_bf16 v[32:35], v[64:67], v[200:207], v0
buffer_load_dwordx4 v[52:55], v1, s[4:7], s37 offen offset:2048
v_bitop3_b32 v6, v60, v64, s35 bitop3:0x7e
s_waitcnt lgkmcnt(2)
v_bitop3_b32 v76, v68, v72, s35 bitop3:0x7e
v_bitop3_b32 v6, v6, v76, 1 bitop3:0xa8
v_smfmac_f32_16x16x64_bf16 v[24:27], v[64:67], v[88:95], v0
s_waitcnt lgkmcnt(0)
v_smfmac_f32_16x16x64_bf16 v[24:27], v[60:63], v[44:51], v0
buffer_load_dwordx4 v[56:59], v1, s[4:7], s37 offen offset:3072
v_smfmac_f32_16x16x64_bf16 v[40:43], v[64:67], a[72:79], v0
v_smfmac_f32_16x16x64_bf16 v[36:39], v[64:67], a[64:71], v0
ds_read_b128 v[44:47], v2 offset:4096
v_cmp_ne_u32 vcc, 0, v6
v_smfmac_f32_16x16x64_bf16 v[20:23], v[68:71], v[96:103], v0
ds_read_b128 v[48:51], v2 offset:5120
v_smfmac_f32_16x16x64_bf16 v[24:27], v[68:71], v[104:111], v0
s_cbranch_vccnz L_ra0_w0f
s_waitcnt vmcnt(4)
s_barrier
ds_read_b32 v6, v77 offset:8192
v_smfmac_f32_16x16x64_bf16 v[28:31], v[68:71], v[208:215], v0
s_mov_b32 m0, 0
ds_read_b128 v[60:63], v1 offset:6144
s_waitcnt lgkmcnt(2)
v_smfmac_f32_16x16x64_bf16 v[20:23], v[72:75], v[44:51], v0
buffer_load_dword v78, s[4:7], s39 offen lds
ds_read_b128 v[76:79], v1 offset:5120
v_smfmac_f32_16x16x64_bf16 v[28:31], v[72:75], v[224:231], v0
ds_read_b128 v[64:67], v1 offset:7168
ds_read_b128 v[44:47], v2 offset:6144
v_smfmac_f32_16x16x64_bf16 v[32:35], v[68:71], v[216:223], v0
v_smfmac_f32_16x16x64_bf16 v[36:39], v[68:71], a[80:87], v0
ds_read_b128 v[48:51], v2 offset:7168
s_waitcnt lgkmcnt(4)
v_bitop3_b32 v6, v6, v60, s35 bitop3:0x7e
v_smfmac_f32_16x16x64_bf16 v[40:43], v[68:71], a[88:95], v0
ds_read_b128 v[68:71], v1 offset:8192
v_smfmac_f32_16x16x64_bf16 v[32:35], v[72:75], v[232:239], v0
s_waitcnt lgkmcnt(3)
v_bitop3_b32 v6, v6, v64, s35 bitop3:0xf6
v_bitop3_b32 v6, v6, v76, s35 bitop3:0xf6
v_and_b32 v6, 1, v6
s_waitcnt lgkmcnt(1)
v_smfmac_f32_16x16x64_bf16 v[24:27], v[72:75], v[44:51], v0
ds_read_b128 v[44:47], v2 offset:8192
v_cmp_ne_u32 vcc, 0, v6
v_smfmac_f32_16x16x64_bf16 v[36:39], v[72:75], a[96:103], v0
ds_read_b128 v[48:51], v2 offset:9216
v_smfmac_f32_16x16x64_bf16 v[40:43], v[72:75], a[104:111], v0
ds_read_b128 v[72:75], v1 offset:9216
s_cbranch_vccnz L_ra1_w0f
L_a1_w0f:
v_smfmac_f32_16x16x64_bf16 v[20:23], v[60:63], v[112:119], v0
v_smfmac_f32_16x16x64_bf16 v[20:23], v[64:67], v[128:135], v0
s_waitcnt lgkmcnt(1)
v_smfmac_f32_16x16x64_bf16 v[20:23], v[76:79], v[44:51], v0
ds_read_b128 v[48:51], v2 offset:11264
v_bfe_u32 v6, v1, 5, 1
v_mad_i32_i24 v6, v6, s55, v1
v_smfmac_f32_16x16x64_bf16 v[20:23], v[68:71], v[144:151], v0
s_waitcnt lgkmcnt(1)
v_smfmac_f32_16x16x64_bf16 v[20:23], v[72:75], v[160:167], v0
ds_read_b128 v[44:47], v2 offset:10240
v_smfmac_f32_16x16x64_bf16 v[24:27], v[60:63], v[120:127], v0
v_smfmac_f32_16x16x64_bf16 v[24:27], v[64:67], v[136:143], v0
v_smfmac_f32_16x16x64_bf16 v[24:27], v[68:71], v[152:159], v0
v_add_f32 v21, v21, v23
v_smfmac_f32_16x16x64_bf16 v[24:27], v[72:75], v[168:175], v0
s_waitcnt lgkmcnt(0)
v_smfmac_f32_16x16x64_bf16 v[24:27], v[76:79], v[44:51], v0
ds_read_b128 v[44:47], v2 offset:12288
v_add_f32 v20, v20, v22
v_cvt_pk_bf16_f32 v22, v20, v21
v_smfmac_f32_16x16x64_bf16 v[28:31], v[76:79], v[240:247], v0
v_smfmac_f32_16x16x64_bf16 v[28:31], v[64:67], a[0:7], v0
ds_read_b128 v[48:51], v2 offset:13312
v_add_f32 v25, v25, v27
v_add_f32 v24, v24, v26
v_cvt_pk_bf16_f32 v23, v24, v25
v_smfmac_f32_16x16x64_bf16 v[28:31], v[72:75], a[32:39], v0
ds_write_b64 v3, v[22:23] offset:10240
v_smfmac_f32_16x16x64_bf16 v[28:31], v[68:71], a[16:23], v0
s_waitcnt vmcnt(1)
v_smfmac_f32_16x16x64_bf16 v[32:35], v[76:79], v[248:255], v0
s_waitcnt lgkmcnt(1)
v_smfmac_f32_16x16x64_bf16 v[28:31], v[60:63], v[44:51], v0
ds_read_b128 v[44:47], v2 offset:14336
ds_read_b128 v[48:51], v2 offset:15360
v_smfmac_f32_16x16x64_bf16 v[32:35], v[64:67], a[8:15], v0
s_waitcnt lgkmcnt(2)
s_barrier
ds_read_b64_tr_b16 v[20:21], v4 offset:10240
v_smfmac_f32_16x16x64_bf16 v[32:35], v[68:71], a[24:31], v0
ds_read_b64_tr_b16 v[22:23], v4 offset:10752
v_add_f32 v29, v29, v31
v_smfmac_f32_16x16x64_bf16 v[32:35], v[72:75], a[40:47], v0
ds_read_b64_tr_b16 v[24:25], v4 offset:11264
ds_read_b64_tr_b16 v[26:27], v4 offset:11776
s_waitcnt lgkmcnt(4)
v_smfmac_f32_16x16x64_bf16 v[32:35], v[60:63], v[44:51], v0
ds_read_b128 v[48:51], v2 offset:19456
s_waitcnt lgkmcnt(3)
v_mfma_f32_16x16x32_bf16 v[12:15], v[12:15], v[20:23], 0
ds_read_b128 v[44:47], v2 offset:18432
v_add_f32 v28, v28, v30
s_waitcnt lgkmcnt(2)
v_mfma_f32_16x16x32_bf16 v[12:15], v[16:19], v[24:27], v[12:15]
v_add_f32 v32, v32, v34
v_add_f32 v33, v33, v35
v_cvt_pk_bf16_f32 v31, v32, v33
v_cvt_pk_bf16_f32 v30, v28, v29
v_smfmac_f32_16x16x64_bf16 v[36:39], v[76:79], a[112:119], v0
ds_write_b64 v3, v[30:31] offset:12288
v_add_f32_dpp v12, v14, v12 quad_perm:[2,3,0,1] row_mask:0xf bank_mask:0xf
v_exp_f32 v14, v12
v_add_f32_dpp v13, v15, v13 quad_perm:[2,3,0,1] row_mask:0xf bank_mask:0xf
v_exp_f32 v15, v13
s_nop 0
v_cvt_pk_bf16_f32 v14, v14, v15
v_smfmac_f32_16x16x64_bf16 v[40:43], v[76:79], a[120:127], v0
ds_write_b32 v5, v14 offset:14368
s_waitcnt lgkmcnt(2)
v_smfmac_f32_16x16x64_bf16 v[40:43], v[72:75], v[44:51], v0
ds_read_b128 v[44:47], v2 offset:16384
s_waitcnt lgkmcnt(2)
s_barrier
ds_read_b64_tr_b16 v[28:29], v4 offset:12288
v_smfmac_f32_16x16x64_bf16 v[36:39], v[60:63], a[128:135], v0
ds_read_b64_tr_b16 v[30:31], v4 offset:12800
ds_read_b64_tr_b16 v[32:33], v4 offset:13312
v_smfmac_f32_16x16x64_bf16 v[40:43], v[60:63], a[136:143], v0
ds_read_b64_tr_b16 v[34:35], v4 offset:13824
v_mov_b64 v[76:77], s[52:53]
s_waitcnt lgkmcnt(2)
v_mfma_f32_16x16x32_bf16 v[28:31], v[28:31], v[20:23], 0
s_barrier
ds_read_b128 v[16:19], v1 offset:14368
s_waitcnt lgkmcnt(1)
v_mfma_f32_16x16x32_bf16 v[28:31], v[32:35], v[24:27], v[28:31]
ds_read_b128 v[60:63], v1 offset:14336
v_mov_b64 v[14:15], s[0:1]
v_smfmac_f32_16x16x64_bf16 v[40:43], v[64:67], a[152:159], v0
ds_read_b128 v[48:51], v2 offset:17408
v_mov_b64 v[78:79], s[52:53]
v_smfmac_f32_16x16x64_bf16 v[40:43], v[68:71], a[168:175], v0
v_add_f32_dpp v28, v30, v28 quad_perm:[2,3,0,1] row_mask:0xf bank_mask:0xf
v_smfmac_f32_16x16x64_bf16 v[36:39], v[64:67], a[144:151], v0
ds_read_b128 v[64:67], v2 offset:25600
v_add_f32_dpp v29, v31, v29 quad_perm:[2,3,0,1] row_mask:0xf bank_mask:0xf
s_waitcnt lgkmcnt(1)
v_smfmac_f32_16x16x64_bf16 v[36:39], v[72:75], v[44:51], v0
ds_read_b128 v[72:75], v2 offset:29696
v_mul_f32 v28, s50, v28
v_smfmac_f32_16x16x64_bf16 v[36:39], v[68:71], a[160:167], v0
ds_read_b128 v[68:71], v2 offset:28672
v_cvt_pk_bf16_f32 v40, v40, v41
v_mfma_f32_16x16x32_bf16 v[32:35], v[76:79], v[16:19], 0
v_exp_f32 v30, v28
ds_read_b128 v[44:47], v2 offset:20480
v_mfma_f32_16x16x32_bf16 v[20:23], v[52:55], v[16:19], 0
v_mul_f32 v29, s50, v29
v_cvt_pk_bf16_f32 v41, v42, v43
v_cvt_pk_bf16_f32 v43, v38, v39
v_mov_b64 v[76:77], 0
v_exp_f32 v31, v29
v_mfma_f32_16x16x32_bf16 v[20:23], v[56:59], v[60:63], v[20:23]
v_cvt_pk_bf16_f32 v30, v30, v31
v_cndmask_b32_e64 v26, 0, v30, s[56:57]
v_cndmask_b32_e64 v27, 0, v30, s[56:57]
s_nop 0
v_mov_b32_dpp v24, v26 quad_perm:[2,3,0,1] row_mask:0xf bank_mask:0xf
v_mfma_f32_16x16x16_bf16 v[32:35], v[14:15], v[26:27], v[32:35]
v_mov_b32_dpp v25, v26 quad_perm:[2,3,0,1] row_mask:0xf bank_mask:0xf
v_cvt_pk_bf16_f32 v42, v36, v37
s_nop 1
v_mfma_f32_16x16x32_bf16 v[20:23], v[40:43], v[24:27], v[20:23]
ds_read_b128 v[60:63], v2 offset:24576
ds_read_b128 v[48:51], v2 offset:21504
v_mov_b64 v[78:79], 0
v_rcp_f32 v33, v32
v_mov_b64 v[36:37], 0
v_min_f32 v32, v32, v33
v_cmp_nlt_f32 vcc, s2, v32
v_mul_f32_dpp v23, v33, v23 quad_perm:[0,1,0,1] row_mask:0xf bank_mask:0xf
v_mul_f32_dpp v21, v33, v21 quad_perm:[0,1,0,1] row_mask:0xf bank_mask:0xf
v_mul_f32_dpp v22, v33, v22 quad_perm:[0,1,0,1] row_mask:0xf bank_mask:0xf
v_mul_f32_dpp v20, v33, v20 quad_perm:[0,1,0,1] row_mask:0xf bank_mask:0xf
v_cvt_pk_bf16_f32 v20, v20, v21
v_cvt_pk_bf16_f32 v21, v22, v23
ds_write_b64 v6, v[20:21] offset:5120
s_and_b64 vcc, vcc, s[56:57]
s_cbranch_scc1 L_mx_w0f
L_mxb_w0f:
v_mov_b64 v[38:39], 0
v_mov_b32_dpp v19, v21 quad_perm:[2,3,2,3] row_mask:0xf bank_mask:0xf
v_mov_b32_dpp v16, v20 quad_perm:[0,1,0,1] row_mask:0xf bank_mask:0xf
v_mov_b32_dpp v18, v20 quad_perm:[2,3,2,3] row_mask:0xf bank_mask:0xf
v_mov_b32_dpp v17, v21 quad_perm:[0,1,0,1] row_mask:0xf bank_mask:0xf
v_mov_b64 v[24:25], 0
v_mov_b64 v[26:27], 0
v_smfmac_f32_16x16x64_bf16 v[76:79], v[16:19], a[176:183], v0
s_waitcnt lgkmcnt(0)
s_barrier
v_mov_b64 v[32:33], 0
ds_read_b128 v[12:15], v7 offset:7168
ds_read_b128 v[52:55], v7 offset:6144
v_smfmac_f32_16x16x64_bf16 v[36:39], v[16:19], v[44:51], v0
ds_read_b128 v[48:51], v2 offset:23552
ds_read_b128 v[56:59], v7 offset:8192
v_mov_b64 v[30:31], 0
v_mov_b64 v[34:35], 0
v_smfmac_f32_16x16x64_bf16 v[24:27], v[16:19], v[60:67], v0
ds_read_b128 v[44:47], v2 offset:22528
v_smfmac_f32_16x16x64_bf16 v[32:35], v[16:19], v[68:75], v0
ds_read_b128 v[68:71], v2 offset:30720
s_waitcnt lgkmcnt(5)
v_smfmac_f32_16x16x64_bf16 v[76:79], v[12:15], a[184:191], v0
ds_read_b128 v[60:63], v2 offset:26624
s_waitcnt lgkmcnt(5)
v_smfmac_f32_16x16x64_bf16 v[76:79], v[52:55], a[192:199], v0
ds_read_b128 v[64:67], v2 offset:27648
s_waitcnt lgkmcnt(4)
v_smfmac_f32_16x16x64_bf16 v[76:79], v[56:59], a[200:207], v0
v_mov_b64 v[28:29], 0
v_smfmac_f32_16x16x64_bf16 v[36:39], v[12:15], a[208:215], v0
ds_read_b128 v[72:75], v2 offset:31744
s_waitcnt lgkmcnt(4)
v_smfmac_f32_16x16x64_bf16 v[36:39], v[52:55], v[44:51], v0
ds_read_b128 v[44:47], v2 offset:32768
v_cvt_pk_bf16_f32 v77, v77, v79
v_cvt_pk_bf16_f32 v76, v76, v78
v_bfi_b32 v76, 1, s35, v76
v_smfmac_f32_16x16x64_bf16 v[36:39], v[56:59], a[216:223], v0
v_smfmac_f32_16x16x64_bf16 v[24:27], v[12:15], a[224:231], v0
buffer_store_dwordx2 v[76:77], v8, s[4:7], s42 offen
s_waitcnt lgkmcnt(2)
v_smfmac_f32_16x16x64_bf16 v[24:27], v[52:55], v[60:67], v0
ds_read_b128 v[48:51], v2 offset:33792
ds_read_b128 v[60:63], v2 offset:36864
v_cvt_pk_bf16_f32 v36, v36, v38
v_bfi_b32 v36, 1, s35, v36
v_cvt_pk_bf16_f32 v37, v37, v39
v_smfmac_f32_16x16x64_bf16 v[24:27], v[56:59], a[232:239], v0
buffer_store_dwordx2 v[36:37], v8, s[4:7], s43 offen
ds_read_b128 v[64:67], v2 offset:37888
v_smfmac_f32_16x16x64_bf16 v[32:35], v[12:15], a[240:247], v0
ds_read_b128 v[40:43], v2 offset:35840
s_waitcnt lgkmcnt(5)
v_smfmac_f32_16x16x64_bf16 v[32:35], v[52:55], v[68:75], v0
ds_read_b128 v[72:75], v2 offset:39936
ds_read_b128 v[36:39], v2 offset:34816
v_cvt_pk_bf16_f32 v25, v25, v27
v_cvt_pk_bf16_f32 v24, v24, v26
v_bfi_b32 v24, 1, s35, v24
buffer_store_dwordx2 v[24:25], v8, s[4:7], s44 offen
v_smfmac_f32_16x16x64_bf16 v[32:35], v[56:59], a[248:255], v0
ds_read_b128 v[68:71], v2 offset:38912
s_waitcnt lgkmcnt(6)
v_smfmac_f32_16x16x64_bf16 v[28:31], v[16:19], v[44:51], v0
s_nop 3
v_cvt_pk_bf16_f32 v33, v33, v35
v_cvt_pk_bf16_f32 v32, v32, v34
v_bfi_b32 v32, 1, s35, v32
buffer_store_dwordx2 v[32:33], v8, s[4:7], s45 offen
s_waitcnt lgkmcnt(1)
v_smfmac_f32_16x16x64_bf16 v[28:31], v[52:55], v[36:43], v0
v_smfmac_f32_16x16x64_bf16 v[28:31], v[12:15], v[60:67], v0
s_waitcnt lgkmcnt(0)
v_smfmac_f32_16x16x64_bf16 v[28:31], v[56:59], v[68:75], v0
s_nop 7
v_cvt_pk_bf16_f32 v28, v28, v30
v_bfi_b32 v28, 1, s35, v28
v_cvt_pk_bf16_f32 v29, v29, v31
buffer_store_dwordx2 v[28:29], v8, s[4:7], s46 offen
s_branch L_ex_w0f
.p2align 6
L_ex_w0rf:
v_and_b32 v6, 0x70, v1
ds_read_b128 v[76:79], v6 offset:256
v_bfe_u32 v11, v1, 4, 2
v_lshrrev_b32_e64 v11, v11, 1
v_mov_b64 v[20:21], 0
v_mov_b64 v[22:23], 0
v_mov_b64 v[24:25], 0
v_mov_b64 v[26:27], 0
v_mov_b64 v[28:29], 0
v_mov_b64 v[30:31], 0
v_mov_b64 v[32:33], 0
v_mov_b64 v[34:35], 0
ds_read_b128 v[44:47], v2 offset:0
ds_read_b128 v[48:51], v2 offset:1024
s_add_u32 s34, s34, 1
s_not_b32 s35, s35
s_not_b32 s36, s36
s_barrier
s_waitcnt vmcnt(0)
s_add_u32 s37, s37, 524288
s_add_u32 s39, s39, 524288
s_mul_i32 s40, s34, 10240
s_add_u32 s40, s40, 8093696
buffer_load_dwordx4 v[60:63], v9, s[4:7], s3 offen offset:0 sc1
buffer_load_dwordx4 v[64:67], v9, s[4:7], s3 offen offset:1024 sc1
buffer_load_dwordx4 v[68:71], v9, s[4:7], s3 offen offset:2048 sc1
buffer_load_dwordx4 v[72:75], v9, s[4:7], s3 offen offset:3072 sc1
s_waitcnt lgkmcnt(2)
s_waitcnt vmcnt(3)
L_r_w0rf:
v_mfma_f32_16x16x32_bf16 v[36:39], v[60:63], v[76:79], 0
s_waitcnt vmcnt(2)
v_mfma_f32_16x16x32_bf16 v[36:39], v[64:67], v[76:79], v[36:39]
v_bitop3_b32 v40, v60, v64, s36 bitop3:0x7e
s_waitcnt vmcnt(1)
v_mfma_f32_16x16x32_bf16 v[36:39], v[68:71], v[76:79], v[36:39]
s_waitcnt vmcnt(0)
v_mfma_f32_16x16x32_bf16 v[36:39], v[72:75], v[76:79], v[36:39]
v_bitop3_b32 v41, v68, v72, s36 bitop3:0x7e
v_bitop3_b32 v40, v40, v41, 1 bitop3:0xa8
v_cmp_ne_u32 vcc, 0, v40
v_nop
v_nop
v_nop
v_nop
v_nop
v_pk_add_f32 v[36:37], v[36:37], v[38:39]
v_cvt_pk_bf16_f32 v40, v36, v37
v_bfi_b32 v40, v11, s35, v40
s_cbranch_vccnz L_rr_w0rf
buffer_store_dword v40, v10, s[4:7], 0 offen
s_cmp_eq_u32 s34, 63
v_mov_b32 v11, v40
s_cbranch_scc1 L_done_w0rf
v_mov_b64 v[36:37], 0
v_mov_b64 v[38:39], 0
v_mov_b64 v[40:41], 0
v_mov_b64 v[42:43], 0
v_bfe_u32 v77, v1, 6, 1
v_lshl_add_u32 v77, v77, 3, v1
v_lshlrev_b32 v77, 1, v77
v_lshlrev_b32 v78, 3, v1
L_top_w0rf:
s_barrier
ds_read_b128 v[60:63], v1 offset:1024
s_mov_b32 m0, 5120
s_nop 0
buffer_load_dwordx4 v1, s[4:7], s48 offen offset:0 sc1 lds
s_barrier
ds_read_b128 v[64:67], v1 offset:2048
ds_read_b128 v[68:71], v1 offset:3072
ds_read_b128 v[72:75], v1 offset:4096
L_s0_w0rf:
s_waitcnt lgkmcnt(3)
v_smfmac_f32_16x16x64_bf16 v[32:35], v[60:63], v[184:191], v0
v_smfmac_f32_16x16x64_bf16 v[20:23], v[60:63], v[44:51], v0
v_smfmac_f32_16x16x64_bf16 v[36:39], v[60:63], a[48:55], v0
buffer_load_dwordx4 v[12:15], v9, s[4:7], s37 offen offset:0
v_smfmac_f32_16x16x64_bf16 v[28:31], v[60:63], v[176:183], v0
buffer_load_dwordx4 v[16:19], v9, s[4:7], s37 offen offset:1024
v_smfmac_f32_16x16x64_bf16 v[40:43], v[60:63], a[56:63], v0
s_waitcnt lgkmcnt(2)
v_smfmac_f32_16x16x64_bf16 v[28:31], v[64:67], v[192:199], v0
ds_read_b128 v[48:51], v2 offset:3072
v_smfmac_f32_16x16x64_bf16 v[20:23], v[64:67], v[80:87], v0
ds_read_b128 v[44:47], v2 offset:2048
v_smfmac_f32_16x16x64_bf16 v[32:35], v[64:67], v[200:207], v0
buffer_load_dwordx4 v[52:55], v1, s[4:7], s37 offen offset:2048
v_bitop3_b32 v6, v60, v64, s35 bitop3:0x7e
s_waitcnt lgkmcnt(2)
v_bitop3_b32 v76, v68, v72, s35 bitop3:0x7e
v_bitop3_b32 v6, v6, v76, 1 bitop3:0xa8
v_smfmac_f32_16x16x64_bf16 v[24:27], v[64:67], v[88:95], v0
s_waitcnt lgkmcnt(0)
v_smfmac_f32_16x16x64_bf16 v[24:27], v[60:63], v[44:51], v0
buffer_load_dwordx4 v[56:59], v1, s[4:7], s37 offen offset:3072
v_smfmac_f32_16x16x64_bf16 v[40:43], v[64:67], a[72:79], v0
v_smfmac_f32_16x16x64_bf16 v[36:39], v[64:67], a[64:71], v0
ds_read_b128 v[44:47], v2 offset:4096
v_cmp_ne_u32 vcc, 0, v6
v_smfmac_f32_16x16x64_bf16 v[20:23], v[68:71], v[96:103], v0
ds_read_b128 v[48:51], v2 offset:5120
v_smfmac_f32_16x16x64_bf16 v[24:27], v[68:71], v[104:111], v0
s_cbranch_vccnz L_ra0_w0rf
s_waitcnt vmcnt(4)
s_barrier
ds_read_b32 v6, v77 offset:8192
v_smfmac_f32_16x16x64_bf16 v[28:31], v[68:71], v[208:215], v0
s_mov_b32 m0, 0
ds_read_b128 v[60:63], v1 offset:6144
buffer_store_dword v11, v10, s[4:7], s40 offen sc0 sc1
s_waitcnt lgkmcnt(2)
v_smfmac_f32_16x16x64_bf16 v[20:23], v[72:75], v[44:51], v0
buffer_load_dword v78, s[4:7], s39 offen lds
ds_read_b128 v[76:79], v1 offset:5120
v_smfmac_f32_16x16x64_bf16 v[28:31], v[72:75], v[224:231], v0
ds_read_b128 v[64:67], v1 offset:7168
ds_read_b128 v[44:47], v2 offset:6144
v_smfmac_f32_16x16x64_bf16 v[32:35], v[68:71], v[216:223], v0
v_smfmac_f32_16x16x64_bf16 v[36:39], v[68:71], a[80:87], v0
ds_read_b128 v[48:51], v2 offset:7168
s_waitcnt lgkmcnt(4)
v_bitop3_b32 v6, v6, v60, s35 bitop3:0x7e
v_smfmac_f32_16x16x64_bf16 v[40:43], v[68:71], a[88:95], v0
ds_read_b128 v[68:71], v1 offset:8192
v_smfmac_f32_16x16x64_bf16 v[32:35], v[72:75], v[232:239], v0
s_waitcnt lgkmcnt(3)
v_bitop3_b32 v6, v6, v64, s35 bitop3:0xf6
v_bitop3_b32 v6, v6, v76, s35 bitop3:0xf6
v_and_b32 v6, 1, v6
s_waitcnt lgkmcnt(1)
v_smfmac_f32_16x16x64_bf16 v[24:27], v[72:75], v[44:51], v0
ds_read_b128 v[44:47], v2 offset:8192
v_cmp_ne_u32 vcc, 0, v6
v_smfmac_f32_16x16x64_bf16 v[36:39], v[72:75], a[96:103], v0
ds_read_b128 v[48:51], v2 offset:9216
v_smfmac_f32_16x16x64_bf16 v[40:43], v[72:75], a[104:111], v0
ds_read_b128 v[72:75], v1 offset:9216
s_cbranch_vccnz L_ra1_w0rf
L_a1_w0rf:
v_smfmac_f32_16x16x64_bf16 v[20:23], v[60:63], v[112:119], v0
v_smfmac_f32_16x16x64_bf16 v[20:23], v[64:67], v[128:135], v0
s_waitcnt lgkmcnt(1)
v_smfmac_f32_16x16x64_bf16 v[20:23], v[76:79], v[44:51], v0
ds_read_b128 v[48:51], v2 offset:11264
v_bfe_u32 v6, v1, 5, 1
v_mad_i32_i24 v6, v6, s55, v1
v_smfmac_f32_16x16x64_bf16 v[20:23], v[68:71], v[144:151], v0
s_waitcnt lgkmcnt(1)
v_smfmac_f32_16x16x64_bf16 v[20:23], v[72:75], v[160:167], v0
ds_read_b128 v[44:47], v2 offset:10240
v_smfmac_f32_16x16x64_bf16 v[24:27], v[60:63], v[120:127], v0
v_smfmac_f32_16x16x64_bf16 v[24:27], v[64:67], v[136:143], v0
v_smfmac_f32_16x16x64_bf16 v[24:27], v[68:71], v[152:159], v0
v_add_f32 v21, v21, v23
v_smfmac_f32_16x16x64_bf16 v[24:27], v[72:75], v[168:175], v0
s_waitcnt lgkmcnt(0)
v_smfmac_f32_16x16x64_bf16 v[24:27], v[76:79], v[44:51], v0
ds_read_b128 v[44:47], v2 offset:12288
v_add_f32 v20, v20, v22
v_cvt_pk_bf16_f32 v22, v20, v21
v_smfmac_f32_16x16x64_bf16 v[28:31], v[76:79], v[240:247], v0
v_smfmac_f32_16x16x64_bf16 v[28:31], v[64:67], a[0:7], v0
ds_read_b128 v[48:51], v2 offset:13312
v_add_f32 v25, v25, v27
v_add_f32 v24, v24, v26
v_cvt_pk_bf16_f32 v23, v24, v25
v_smfmac_f32_16x16x64_bf16 v[28:31], v[72:75], a[32:39], v0
ds_write_b64 v3, v[22:23] offset:10240
v_smfmac_f32_16x16x64_bf16 v[28:31], v[68:71], a[16:23], v0
s_waitcnt vmcnt(2)
v_smfmac_f32_16x16x64_bf16 v[32:35], v[76:79], v[248:255], v0
s_waitcnt lgkmcnt(1)
v_smfmac_f32_16x16x64_bf16 v[28:31], v[60:63], v[44:51], v0
ds_read_b128 v[44:47], v2 offset:14336
ds_read_b128 v[48:51], v2 offset:15360
v_smfmac_f32_16x16x64_bf16 v[32:35], v[64:67], a[8:15], v0
s_waitcnt lgkmcnt(2)
s_barrier
ds_read_b64_tr_b16 v[20:21], v4 offset:10240
v_smfmac_f32_16x16x64_bf16 v[32:35], v[68:71], a[24:31], v0
ds_read_b64_tr_b16 v[22:23], v4 offset:10752
v_add_f32 v29, v29, v31
v_smfmac_f32_16x16x64_bf16 v[32:35], v[72:75], a[40:47], v0
ds_read_b64_tr_b16 v[24:25], v4 offset:11264
ds_read_b64_tr_b16 v[26:27], v4 offset:11776
s_waitcnt lgkmcnt(4)
v_smfmac_f32_16x16x64_bf16 v[32:35], v[60:63], v[44:51], v0
ds_read_b128 v[48:51], v2 offset:19456
s_waitcnt lgkmcnt(3)
v_mfma_f32_16x16x32_bf16 v[12:15], v[12:15], v[20:23], 0
ds_read_b128 v[44:47], v2 offset:18432
v_add_f32 v28, v28, v30
s_waitcnt lgkmcnt(2)
v_mfma_f32_16x16x32_bf16 v[12:15], v[16:19], v[24:27], v[12:15]
v_add_f32 v32, v32, v34
v_add_f32 v33, v33, v35
v_cvt_pk_bf16_f32 v31, v32, v33
v_cvt_pk_bf16_f32 v30, v28, v29
v_smfmac_f32_16x16x64_bf16 v[36:39], v[76:79], a[112:119], v0
ds_write_b64 v3, v[30:31] offset:12288
v_add_f32_dpp v12, v14, v12 quad_perm:[2,3,0,1] row_mask:0xf bank_mask:0xf
v_exp_f32 v14, v12
v_add_f32_dpp v13, v15, v13 quad_perm:[2,3,0,1] row_mask:0xf bank_mask:0xf
v_exp_f32 v15, v13
s_nop 0
v_cvt_pk_bf16_f32 v14, v14, v15
v_smfmac_f32_16x16x64_bf16 v[40:43], v[76:79], a[120:127], v0
ds_write_b32 v5, v14 offset:14368
s_waitcnt lgkmcnt(2)
v_smfmac_f32_16x16x64_bf16 v[40:43], v[72:75], v[44:51], v0
ds_read_b128 v[44:47], v2 offset:16384
s_waitcnt lgkmcnt(2)
s_barrier
ds_read_b64_tr_b16 v[28:29], v4 offset:12288
v_smfmac_f32_16x16x64_bf16 v[36:39], v[60:63], a[128:135], v0
ds_read_b64_tr_b16 v[30:31], v4 offset:12800
ds_read_b64_tr_b16 v[32:33], v4 offset:13312
v_smfmac_f32_16x16x64_bf16 v[40:43], v[60:63], a[136:143], v0
ds_read_b64_tr_b16 v[34:35], v4 offset:13824
v_mov_b64 v[76:77], s[52:53]
s_waitcnt lgkmcnt(2)
v_mfma_f32_16x16x32_bf16 v[28:31], v[28:31], v[20:23], 0
s_barrier
ds_read_b128 v[16:19], v1 offset:14368
s_waitcnt lgkmcnt(1)
v_mfma_f32_16x16x32_bf16 v[28:31], v[32:35], v[24:27], v[28:31]
ds_read_b128 v[60:63], v1 offset:14336
v_mov_b64 v[14:15], s[0:1]
v_smfmac_f32_16x16x64_bf16 v[40:43], v[64:67], a[152:159], v0
ds_read_b128 v[48:51], v2 offset:17408
v_mov_b64 v[78:79], s[52:53]
v_smfmac_f32_16x16x64_bf16 v[40:43], v[68:71], a[168:175], v0
v_add_f32_dpp v28, v30, v28 quad_perm:[2,3,0,1] row_mask:0xf bank_mask:0xf
v_smfmac_f32_16x16x64_bf16 v[36:39], v[64:67], a[144:151], v0
ds_read_b128 v[64:67], v2 offset:25600
v_add_f32_dpp v29, v31, v29 quad_perm:[2,3,0,1] row_mask:0xf bank_mask:0xf
s_waitcnt lgkmcnt(1)
v_smfmac_f32_16x16x64_bf16 v[36:39], v[72:75], v[44:51], v0
ds_read_b128 v[72:75], v2 offset:29696
v_mul_f32 v28, s50, v28
v_smfmac_f32_16x16x64_bf16 v[36:39], v[68:71], a[160:167], v0
ds_read_b128 v[68:71], v2 offset:28672
v_cvt_pk_bf16_f32 v40, v40, v41
v_mfma_f32_16x16x32_bf16 v[32:35], v[76:79], v[16:19], 0
v_exp_f32 v30, v28
ds_read_b128 v[44:47], v2 offset:20480
v_mfma_f32_16x16x32_bf16 v[20:23], v[52:55], v[16:19], 0
v_mul_f32 v29, s50, v29
v_cvt_pk_bf16_f32 v41, v42, v43
v_cvt_pk_bf16_f32 v43, v38, v39
v_mov_b64 v[76:77], 0
v_exp_f32 v31, v29
v_mfma_f32_16x16x32_bf16 v[20:23], v[56:59], v[60:63], v[20:23]
v_cvt_pk_bf16_f32 v30, v30, v31
v_cndmask_b32_e64 v26, 0, v30, s[56:57]
v_cndmask_b32_e64 v27, 0, v30, s[56:57]
s_nop 0
v_mov_b32_dpp v24, v26 quad_perm:[2,3,0,1] row_mask:0xf bank_mask:0xf
v_mfma_f32_16x16x16_bf16 v[32:35], v[14:15], v[26:27], v[32:35]
v_mov_b32_dpp v25, v26 quad_perm:[2,3,0,1] row_mask:0xf bank_mask:0xf
v_cvt_pk_bf16_f32 v42, v36, v37
s_nop 1
v_mfma_f32_16x16x32_bf16 v[20:23], v[40:43], v[24:27], v[20:23]
ds_read_b128 v[60:63], v2 offset:24576
ds_read_b128 v[48:51], v2 offset:21504
v_mov_b64 v[78:79], 0
v_rcp_f32 v33, v32
v_mov_b64 v[36:37], 0
v_min_f32 v32, v32, v33
v_cmp_nlt_f32 vcc, s2, v32
v_mul_f32_dpp v23, v33, v23 quad_perm:[0,1,0,1] row_mask:0xf bank_mask:0xf
v_mul_f32_dpp v21, v33, v21 quad_perm:[0,1,0,1] row_mask:0xf bank_mask:0xf
v_mul_f32_dpp v22, v33, v22 quad_perm:[0,1,0,1] row_mask:0xf bank_mask:0xf
v_mul_f32_dpp v20, v33, v20 quad_perm:[0,1,0,1] row_mask:0xf bank_mask:0xf
v_cvt_pk_bf16_f32 v20, v20, v21
v_cvt_pk_bf16_f32 v21, v22, v23
ds_write_b64 v6, v[20:21] offset:5120
s_and_b64 vcc, vcc, s[56:57]
s_cbranch_scc1 L_mx_w0rf
L_mxb_w0rf:
v_mov_b64 v[38:39], 0
v_mov_b32_dpp v19, v21 quad_perm:[2,3,2,3] row_mask:0xf bank_mask:0xf
v_mov_b32_dpp v16, v20 quad_perm:[0,1,0,1] row_mask:0xf bank_mask:0xf
v_mov_b32_dpp v18, v20 quad_perm:[2,3,2,3] row_mask:0xf bank_mask:0xf
v_mov_b32_dpp v17, v21 quad_perm:[0,1,0,1] row_mask:0xf bank_mask:0xf
v_mov_b64 v[24:25], 0
v_mov_b64 v[26:27], 0
v_smfmac_f32_16x16x64_bf16 v[76:79], v[16:19], a[176:183], v0
s_waitcnt lgkmcnt(0)
s_barrier
v_mov_b64 v[32:33], 0
ds_read_b128 v[12:15], v7 offset:7168
ds_read_b128 v[52:55], v7 offset:6144
v_smfmac_f32_16x16x64_bf16 v[36:39], v[16:19], v[44:51], v0
ds_read_b128 v[48:51], v2 offset:23552
ds_read_b128 v[56:59], v7 offset:8192
v_mov_b64 v[30:31], 0
v_mov_b64 v[34:35], 0
v_smfmac_f32_16x16x64_bf16 v[24:27], v[16:19], v[60:67], v0
ds_read_b128 v[44:47], v2 offset:22528
v_smfmac_f32_16x16x64_bf16 v[32:35], v[16:19], v[68:75], v0
ds_read_b128 v[68:71], v2 offset:30720
s_waitcnt lgkmcnt(5)
v_smfmac_f32_16x16x64_bf16 v[76:79], v[12:15], a[184:191], v0
ds_read_b128 v[60:63], v2 offset:26624
s_waitcnt lgkmcnt(5)
v_smfmac_f32_16x16x64_bf16 v[76:79], v[52:55], a[192:199], v0
ds_read_b128 v[64:67], v2 offset:27648
s_waitcnt lgkmcnt(4)
v_smfmac_f32_16x16x64_bf16 v[76:79], v[56:59], a[200:207], v0
v_mov_b64 v[28:29], 0
v_smfmac_f32_16x16x64_bf16 v[36:39], v[12:15], a[208:215], v0
ds_read_b128 v[72:75], v2 offset:31744
s_waitcnt lgkmcnt(4)
v_smfmac_f32_16x16x64_bf16 v[36:39], v[52:55], v[44:51], v0
ds_read_b128 v[44:47], v2 offset:32768
v_cvt_pk_bf16_f32 v77, v77, v79
v_cvt_pk_bf16_f32 v76, v76, v78
v_bfi_b32 v76, 1, s35, v76
v_smfmac_f32_16x16x64_bf16 v[36:39], v[56:59], a[216:223], v0
v_smfmac_f32_16x16x64_bf16 v[24:27], v[12:15], a[224:231], v0
buffer_store_dwordx2 v[76:77], v8, s[4:7], s42 offen
s_waitcnt lgkmcnt(2)
v_smfmac_f32_16x16x64_bf16 v[24:27], v[52:55], v[60:67], v0
ds_read_b128 v[48:51], v2 offset:33792
ds_read_b128 v[60:63], v2 offset:36864
v_cvt_pk_bf16_f32 v36, v36, v38
v_bfi_b32 v36, 1, s35, v36
v_cvt_pk_bf16_f32 v37, v37, v39
v_smfmac_f32_16x16x64_bf16 v[24:27], v[56:59], a[232:239], v0
buffer_store_dwordx2 v[36:37], v8, s[4:7], s43 offen
ds_read_b128 v[64:67], v2 offset:37888
v_smfmac_f32_16x16x64_bf16 v[32:35], v[12:15], a[240:247], v0
ds_read_b128 v[40:43], v2 offset:35840
s_waitcnt lgkmcnt(5)
v_smfmac_f32_16x16x64_bf16 v[32:35], v[52:55], v[68:75], v0
ds_read_b128 v[72:75], v2 offset:39936
ds_read_b128 v[36:39], v2 offset:34816
v_cvt_pk_bf16_f32 v25, v25, v27
v_cvt_pk_bf16_f32 v24, v24, v26
v_bfi_b32 v24, 1, s35, v24
buffer_store_dwordx2 v[24:25], v8, s[4:7], s44 offen
v_smfmac_f32_16x16x64_bf16 v[32:35], v[56:59], a[248:255], v0
ds_read_b128 v[68:71], v2 offset:38912
s_waitcnt lgkmcnt(6)
v_smfmac_f32_16x16x64_bf16 v[28:31], v[16:19], v[44:51], v0
s_nop 3
v_cvt_pk_bf16_f32 v33, v33, v35
v_cvt_pk_bf16_f32 v32, v32, v34
v_bfi_b32 v32, 1, s35, v32
buffer_store_dwordx2 v[32:33], v8, s[4:7], s45 offen
s_waitcnt lgkmcnt(1)
v_smfmac_f32_16x16x64_bf16 v[28:31], v[52:55], v[36:43], v0
v_smfmac_f32_16x16x64_bf16 v[28:31], v[12:15], v[60:67], v0
s_waitcnt lgkmcnt(0)
v_smfmac_f32_16x16x64_bf16 v[28:31], v[56:59], v[68:75], v0
s_nop 7
v_cvt_pk_bf16_f32 v28, v28, v30
v_bfi_b32 v28, 1, s35, v28
v_cvt_pk_bf16_f32 v29, v29, v31
buffer_store_dwordx2 v[28:29], v8, s[4:7], s46 offen
s_branch L_ex_w0rf
.p2align 6
L_ex_w1rf:
v_and_b32 v6, 0x70, v1
ds_read_b128 v[76:79], v6 offset:256
v_bfe_u32 v11, v1, 4, 2
v_lshrrev_b32_e64 v11, v11, 1
v_mov_b64 v[20:21], 0
v_mov_b64 v[22:23], 0
v_mov_b64 v[24:25], 0
v_mov_b64 v[26:27], 0
v_mov_b64 v[28:29], 0
v_mov_b64 v[30:31], 0
v_mov_b64 v[32:33], 0
v_mov_b64 v[34:35], 0
ds_read_b128 v[44:47], v2 offset:0
ds_read_b128 v[48:51], v2 offset:1024
s_add_u32 s34, s34, 1
s_not_b32 s35, s35
s_not_b32 s36, s36
s_add_u32 s37, s37, 524288
s_mul_i32 s40, s34, 10240
s_add_u32 s40, s40, 8093696
s_barrier
s_waitcnt vmcnt(0)
buffer_load_dwordx4 v[60:63], v9, s[4:7], s3 offen offset:0 sc1
buffer_load_dwordx4 v[64:67], v9, s[4:7], s3 offen offset:1024 sc1
buffer_load_dwordx4 v[68:71], v9, s[4:7], s3 offen offset:2048 sc1
buffer_load_dwordx4 v[72:75], v9, s[4:7], s3 offen offset:3072 sc1
s_waitcnt lgkmcnt(2)
s_waitcnt vmcnt(3)
L_r_w1rf:
v_mfma_f32_16x16x32_bf16 v[36:39], v[60:63], v[76:79], 0
s_waitcnt vmcnt(2)
v_mfma_f32_16x16x32_bf16 v[36:39], v[64:67], v[76:79], v[36:39]
v_bitop3_b32 v40, v60, v64, s36 bitop3:0x7e
s_waitcnt vmcnt(1)
v_mfma_f32_16x16x32_bf16 v[36:39], v[68:71], v[76:79], v[36:39]
s_waitcnt vmcnt(0)
v_mfma_f32_16x16x32_bf16 v[36:39], v[72:75], v[76:79], v[36:39]
v_bitop3_b32 v41, v68, v72, s36 bitop3:0x7e
v_bitop3_b32 v40, v40, v41, 1 bitop3:0xa8
v_cmp_ne_u32 vcc, 0, v40
v_nop
v_nop
v_nop
v_nop
v_nop
v_pk_add_f32 v[36:37], v[36:37], v[38:39]
v_cvt_pk_bf16_f32 v40, v36, v37
v_bfi_b32 v40, v11, s35, v40
s_cbranch_vccnz L_rr_w1rf
buffer_store_dword v40, v10, s[4:7], 0 offen
s_cmp_eq_u32 s34, 63
v_mov_b32 v11, v40
s_cbranch_scc1 L_done_w1rf
v_mov_b64 v[36:37], 0
v_mov_b64 v[38:39], 0
v_mov_b64 v[40:41], 0
v_mov_b64 v[42:43], 0
v_bfe_u32 v77, v1, 6, 1
v_lshl_add_u32 v77, v77, 3, v1
v_lshlrev_b32 v77, 1, v77
v_lshlrev_b32 v78, 3, v1
L_top_w1rf:
s_barrier
ds_read_b128 v[60:63], v1 offset:1024
s_mov_b32 m0, 5120
s_nop 0
buffer_load_dwordx4 v1, s[4:7], s48 offen offset:1024 sc1 lds
s_barrier
ds_read_b128 v[64:67], v1 offset:2048
ds_read_b128 v[68:71], v1 offset:3072
ds_read_b128 v[72:75], v1 offset:4096
L_s0_w1rf:
s_waitcnt lgkmcnt(3)
v_smfmac_f32_16x16x64_bf16 v[32:35], v[60:63], v[184:191], v0
v_smfmac_f32_16x16x64_bf16 v[20:23], v[60:63], v[44:51], v0
v_smfmac_f32_16x16x64_bf16 v[36:39], v[60:63], a[48:55], v0
s_waitcnt lgkmcnt(2)
v_smfmac_f32_16x16x64_bf16 v[28:31], v[64:67], v[192:199], v0
v_smfmac_f32_16x16x64_bf16 v[28:31], v[60:63], v[176:183], v0
buffer_load_dwordx4 v[12:15], v9, s[4:7], s37 offen offset:0
ds_read_b128 v[48:51], v2 offset:3072
ds_read_b128 v[44:47], v2 offset:2048
v_smfmac_f32_16x16x64_bf16 v[20:23], v[64:67], v[80:87], v0
buffer_load_dwordx4 v[16:19], v9, s[4:7], s37 offen offset:1024
v_smfmac_f32_16x16x64_bf16 v[32:35], v[64:67], v[200:207], v0
v_smfmac_f32_16x16x64_bf16 v[40:43], v[60:63], a[56:63], v0
v_bitop3_b32 v6, v60, v64, s35 bitop3:0x7e
v_smfmac_f32_16x16x64_bf16 v[24:27], v[64:67], v[88:95], v0
buffer_load_dwordx4 v[52:55], v1, s[4:7], s37 offen offset:2048
s_waitcnt lgkmcnt(0)
v_smfmac_f32_16x16x64_bf16 v[24:27], v[60:63], v[44:51], v0
v_bitop3_b32 v76, v68, v72, s35 bitop3:0x7e
v_smfmac_f32_16x16x64_bf16 v[36:39], v[64:67], a[64:71], v0
v_bitop3_b32 v6, v6, v76, 1 bitop3:0xa8
v_smfmac_f32_16x16x64_bf16 v[40:43], v[64:67], a[72:79], v0
buffer_load_dwordx4 v[56:59], v1, s[4:7], s37 offen offset:3072
ds_read_b128 v[44:47], v2 offset:4096
v_cmp_ne_u32 vcc, 0, v6
v_smfmac_f32_16x16x64_bf16 v[20:23], v[68:71], v[96:103], v0
ds_read_b128 v[48:51], v2 offset:5120
v_smfmac_f32_16x16x64_bf16 v[24:27], v[68:71], v[104:111], v0
s_cbranch_vccnz L_ra0_w1rf
s_waitcnt vmcnt(4)
s_barrier
ds_read_b32 v6, v77 offset:8192
v_smfmac_f32_16x16x64_bf16 v[28:31], v[68:71], v[208:215], v0
ds_read_b128 v[60:63], v1 offset:6144
s_waitcnt lgkmcnt(2)
v_smfmac_f32_16x16x64_bf16 v[20:23], v[72:75], v[44:51], v0
ds_read_b128 v[76:79], v1 offset:5120
ds_read_b128 v[44:47], v2 offset:6144
buffer_store_dword v11, v10, s[4:7], s40 offen sc0 sc1
v_smfmac_f32_16x16x64_bf16 v[28:31], v[72:75], v[224:231], v0
ds_read_b128 v[64:67], v1 offset:7168
v_smfmac_f32_16x16x64_bf16 v[36:39], v[68:71], a[80:87], v0
v_smfmac_f32_16x16x64_bf16 v[32:35], v[68:71], v[216:223], v0
ds_read_b128 v[48:51], v2 offset:7168
s_waitcnt lgkmcnt(4)
v_bitop3_b32 v6, v6, v60, s35 bitop3:0x7e
v_smfmac_f32_16x16x64_bf16 v[40:43], v[68:71], a[88:95], v0
ds_read_b128 v[68:71], v1 offset:8192
v_smfmac_f32_16x16x64_bf16 v[32:35], v[72:75], v[232:239], v0
s_waitcnt lgkmcnt(2)
v_bitop3_b32 v6, v6, v64, s35 bitop3:0xf6
v_bitop3_b32 v6, v6, v76, s35 bitop3:0xf6
v_and_b32 v6, 1, v6
s_waitcnt lgkmcnt(1)
v_smfmac_f32_16x16x64_bf16 v[24:27], v[72:75], v[44:51], v0
ds_read_b128 v[44:47], v2 offset:8192
v_cmp_ne_u32 vcc, 0, v6
v_smfmac_f32_16x16x64_bf16 v[36:39], v[72:75], a[96:103], v0
ds_read_b128 v[48:51], v2 offset:9216
v_smfmac_f32_16x16x64_bf16 v[40:43], v[72:75], a[104:111], v0
ds_read_b128 v[72:75], v1 offset:9216
s_cbranch_vccnz L_ra1_w1rf
L_a1_w1rf:
v_smfmac_f32_16x16x64_bf16 v[20:23], v[60:63], v[112:119], v0
v_smfmac_f32_16x16x64_bf16 v[20:23], v[64:67], v[128:135], v0
s_waitcnt lgkmcnt(1)
v_smfmac_f32_16x16x64_bf16 v[20:23], v[76:79], v[44:51], v0
ds_read_b128 v[48:51], v2 offset:11264
s_waitcnt lgkmcnt(1)
v_smfmac_f32_16x16x64_bf16 v[20:23], v[72:75], v[160:167], v0
v_bfe_u32 v6, v1, 5, 1
v_mad_i32_i24 v6, v6, s55, v1
v_smfmac_f32_16x16x64_bf16 v[20:23], v[68:71], v[144:151], v0
ds_read_b128 v[44:47], v2 offset:10240
v_smfmac_f32_16x16x64_bf16 v[24:27], v[60:63], v[120:127], v0
v_smfmac_f32_16x16x64_bf16 v[24:27], v[64:67], v[136:143], v0
v_smfmac_f32_16x16x64_bf16 v[24:27], v[68:71], v[152:159], v0
v_add_f32 v21, v21, v23
v_smfmac_f32_16x16x64_bf16 v[24:27], v[72:75], v[168:175], v0
s_waitcnt lgkmcnt(0)
v_smfmac_f32_16x16x64_bf16 v[24:27], v[76:79], v[44:51], v0
ds_read_b128 v[44:47], v2 offset:12288
v_add_f32 v20, v20, v22
v_cvt_pk_bf16_f32 v22, v20, v21
v_smfmac_f32_16x16x64_bf16 v[28:31], v[76:79], v[240:247], v0
ds_read_b128 v[48:51], v2 offset:13312
v_smfmac_f32_16x16x64_bf16 v[28:31], v[64:67], a[0:7], v0
v_add_f32 v25, v25, v27
v_add_f32 v24, v24, v26
v_cvt_pk_bf16_f32 v23, v24, v25
v_smfmac_f32_16x16x64_bf16 v[28:31], v[72:75], a[32:39], v0
ds_write_b64 v3, v[22:23] offset:10752
v_smfmac_f32_16x16x64_bf16 v[28:31], v[68:71], a[16:23], v0
v_smfmac_f32_16x16x64_bf16 v[32:35], v[76:79], v[248:255], v0
s_waitcnt vmcnt(1)
s_waitcnt lgkmcnt(1)
v_smfmac_f32_16x16x64_bf16 v[28:31], v[60:63], v[44:51], v0
ds_read_b128 v[44:47], v2 offset:14336
ds_read_b128 v[48:51], v2 offset:15360
v_smfmac_f32_16x16x64_bf16 v[32:35], v[64:67], a[8:15], v0
s_waitcnt lgkmcnt(2)
s_barrier
v_smfmac_f32_16x16x64_bf16 v[32:35], v[68:71], a[24:31], v0
ds_read_b64_tr_b16 v[20:21], v4 offset:10240
ds_read_b64_tr_b16 v[22:23], v4 offset:10752
v_add_f32 v29, v29, v31
v_smfmac_f32_16x16x64_bf16 v[32:35], v[72:75], a[40:47], v0
ds_read_b64_tr_b16 v[24:25], v4 offset:11264
ds_read_b64_tr_b16 v[26:27], v4 offset:11776
s_waitcnt lgkmcnt(4)
v_smfmac_f32_16x16x64_bf16 v[32:35], v[60:63], v[44:51], v0
ds_read_b128 v[48:51], v2 offset:19456
s_waitcnt lgkmcnt(3)
v_mfma_f32_16x16x32_bf16 v[12:15], v[12:15], v[20:23], 0
ds_read_b128 v[44:47], v2 offset:18432
v_add_f32 v28, v28, v30
s_waitcnt lgkmcnt(2)
v_mfma_f32_16x16x32_bf16 v[12:15], v[16:19], v[24:27], v[12:15]
v_add_f32 v32, v32, v34
v_add_f32 v33, v33, v35
v_cvt_pk_bf16_f32 v30, v28, v29
v_cvt_pk_bf16_f32 v31, v32, v33
v_smfmac_f32_16x16x64_bf16 v[36:39], v[76:79], a[112:119], v0
ds_write_b64 v3, v[30:31] offset:12800
v_add_f32_dpp v12, v14, v12 quad_perm:[2,3,0,1] row_mask:0xf bank_mask:0xf
v_exp_f32 v14, v12
v_add_f32_dpp v13, v15, v13 quad_perm:[2,3,0,1] row_mask:0xf bank_mask:0xf
v_exp_f32 v15, v13
s_nop 0
v_cvt_pk_bf16_f32 v14, v14, v15
v_smfmac_f32_16x16x64_bf16 v[40:43], v[76:79], a[120:127], v0
ds_write_b32 v5, v14 offset:14624
s_waitcnt lgkmcnt(1)
s_barrier
ds_read_b64_tr_b16 v[28:29], v4 offset:12288
v_smfmac_f32_16x16x64_bf16 v[36:39], v[60:63], a[128:135], v0
ds_read_b64_tr_b16 v[30:31], v4 offset:12800
ds_read_b64_tr_b16 v[32:33], v4 offset:13312
v_smfmac_f32_16x16x64_bf16 v[40:43], v[60:63], a[136:143], v0
ds_read_b64_tr_b16 v[34:35], v4 offset:13824
v_mov_b64 v[76:77], s[52:53]
v_smfmac_f32_16x16x64_bf16 v[40:43], v[72:75], v[44:51], v0
ds_read_b128 v[44:47], v2 offset:16384
s_waitcnt lgkmcnt(3)
v_mfma_f32_16x16x32_bf16 v[28:31], v[28:31], v[20:23], 0
s_barrier
ds_read_b128 v[16:19], v1 offset:14368
s_waitcnt lgkmcnt(2)
v_mfma_f32_16x16x32_bf16 v[28:31], v[32:35], v[24:27], v[28:31]
ds_read_b128 v[60:63], v1 offset:14336
v_mov_b64 v[14:15], s[0:1]
v_smfmac_f32_16x16x64_bf16 v[40:43], v[64:67], a[152:159], v0
ds_read_b128 v[48:51], v2 offset:17408
v_mov_b64 v[78:79], s[52:53]
v_smfmac_f32_16x16x64_bf16 v[40:43], v[68:71], a[168:175], v0
v_add_f32_dpp v28, v30, v28 quad_perm:[2,3,0,1] row_mask:0xf bank_mask:0xf
v_smfmac_f32_16x16x64_bf16 v[36:39], v[64:67], a[144:151], v0
ds_read_b128 v[64:67], v2 offset:27648
v_mul_f32 v28, s50, v28
v_add_f32_dpp v29, v31, v29 quad_perm:[2,3,0,1] row_mask:0xf bank_mask:0xf
v_smfmac_f32_16x16x64_bf16 v[36:39], v[68:71], a[160:167], v0
ds_read_b128 v[68:71], v2 offset:30720
s_waitcnt lgkmcnt(2)
v_smfmac_f32_16x16x64_bf16 v[36:39], v[72:75], v[44:51], v0
ds_read_b128 v[72:75], v2 offset:31744
v_mul_f32 v29, s50, v29
v_cvt_pk_bf16_f32 v40, v40, v41
v_mfma_f32_16x16x32_bf16 v[32:35], v[76:79], v[16:19], 0
v_exp_f32 v30, v28
ds_read_b128 v[44:47], v2 offset:22528
v_mfma_f32_16x16x32_bf16 v[20:23], v[52:55], v[16:19], 0
v_exp_f32 v31, v29
v_mov_b64 v[76:77], 0
v_mfma_f32_16x16x32_bf16 v[20:23], v[56:59], v[60:63], v[20:23]
v_cvt_pk_bf16_f32 v41, v42, v43
v_cvt_pk_bf16_f32 v43, v38, v39
v_cvt_pk_bf16_f32 v30, v30, v31
v_cndmask_b32_e64 v26, 0, v30, s[56:57]
v_cndmask_b32_e64 v27, 0, v30, s[56:57]
s_nop 0
v_mov_b32_dpp v24, v26 quad_perm:[2,3,0,1] row_mask:0xf bank_mask:0xf
v_mfma_f32_16x16x16_bf16 v[32:35], v[14:15], v[26:27], v[32:35]
v_cvt_pk_bf16_f32 v42, v36, v37
v_mov_b32_dpp v25, v26 quad_perm:[2,3,0,1] row_mask:0xf bank_mask:0xf
s_nop 1
v_mfma_f32_16x16x32_bf16 v[20:23], v[40:43], v[24:27], v[20:23]
ds_read_b128 v[48:51], v2 offset:23552
ds_read_b128 v[60:63], v2 offset:26624
v_mov_b64 v[78:79], 0
v_rcp_f32 v33, v32
v_mov_b64 v[36:37], 0
v_min_f32 v32, v32, v33
v_cmp_nlt_f32 vcc, s2, v32
v_mul_f32_dpp v23, v33, v23 quad_perm:[0,1,0,1] row_mask:0xf bank_mask:0xf
v_mul_f32_dpp v21, v33, v21 quad_perm:[0,1,0,1] row_mask:0xf bank_mask:0xf
v_mul_f32_dpp v22, v33, v22 quad_perm:[0,1,0,1] row_mask:0xf bank_mask:0xf
v_mul_f32_dpp v20, v33, v20 quad_perm:[0,1,0,1] row_mask:0xf bank_mask:0xf
v_cvt_pk_bf16_f32 v20, v20, v21
v_cvt_pk_bf16_f32 v21, v22, v23
ds_write_b64 v6, v[20:21] offset:6144
s_and_b64 vcc, vcc, s[56:57]
v_mov_b32_dpp v19, v21 quad_perm:[2,3,2,3] row_mask:0xf bank_mask:0xf
s_cbranch_scc1 L_mx_w1rf
L_mxb_w1rf:
v_mov_b32_dpp v16, v20 quad_perm:[0,1,0,1] row_mask:0xf bank_mask:0xf
v_mov_b32_dpp v17, v21 quad_perm:[0,1,0,1] row_mask:0xf bank_mask:0xf
v_mov_b64 v[38:39], 0
v_mov_b32_dpp v18, v20 quad_perm:[2,3,2,3] row_mask:0xf bank_mask:0xf
v_mov_b64 v[26:27], 0
v_mov_b64 v[24:25], 0
v_smfmac_f32_16x16x64_bf16 v[76:79], v[16:19], a[176:183], v0
s_waitcnt lgkmcnt(0)
s_barrier
ds_read_b128 v[12:15], v7 offset:8192
v_mov_b64 v[32:33], 0
ds_read_b128 v[52:55], v7 offset:5120
v_smfmac_f32_16x16x64_bf16 v[36:39], v[16:19], v[44:51], v0
ds_read_b128 v[48:51], v2 offset:21504
ds_read_b128 v[44:47], v2 offset:20480
ds_read_b128 v[56:59], v7 offset:7168
v_mov_b64 v[30:31], 0
v_mov_b64 v[34:35], 0
v_smfmac_f32_16x16x64_bf16 v[24:27], v[16:19], v[60:67], v0
v_smfmac_f32_16x16x64_bf16 v[32:35], v[16:19], v[68:75], v0
ds_read_b128 v[68:71], v2 offset:28672
s_waitcnt lgkmcnt(5)
v_smfmac_f32_16x16x64_bf16 v[76:79], v[12:15], a[184:191], v0
ds_read_b128 v[60:63], v2 offset:24576
s_waitcnt lgkmcnt(5)
v_smfmac_f32_16x16x64_bf16 v[76:79], v[52:55], a[192:199], v0
ds_read_b128 v[64:67], v2 offset:25600
s_waitcnt lgkmcnt(3)
v_smfmac_f32_16x16x64_bf16 v[76:79], v[56:59], a[200:207], v0
v_mov_b64 v[28:29], 0
v_smfmac_f32_16x16x64_bf16 v[36:39], v[12:15], a[208:215], v0
ds_read_b128 v[72:75], v2 offset:29696
v_smfmac_f32_16x16x64_bf16 v[36:39], v[52:55], v[44:51], v0
ds_read_b128 v[44:47], v2 offset:34816
v_cvt_pk_bf16_f32 v77, v77, v79
v_cvt_pk_bf16_f32 v76, v76, v78
v_bfi_b32 v76, 1, s35, v76
v_smfmac_f32_16x16x64_bf16 v[36:39], v[56:59], a[216:223], v0
buffer_store_dwordx2 v[76:77], v8, s[4:7], s42 offen
ds_read_b128 v[48:51], v2 offset:35840
v_smfmac_f32_16x16x64_bf16 v[24:27], v[12:15], a[224:231], v0
s_waitcnt lgkmcnt(3)
v_smfmac_f32_16x16x64_bf16 v[24:27], v[52:55], v[60:67], v0
ds_read_b128 v[60:63], v2 offset:38912
v_cvt_pk_bf16_f32 v37, v37, v39
v_cvt_pk_bf16_f32 v36, v36, v38
v_bfi_b32 v36, 1, s35, v36
v_smfmac_f32_16x16x64_bf16 v[24:27], v[56:59], a[232:239], v0
buffer_store_dwordx2 v[36:37], v8, s[4:7], s43 offen
ds_read_b128 v[64:67], v2 offset:39936
ds_read_b128 v[40:43], v2 offset:33792
v_smfmac_f32_16x16x64_bf16 v[32:35], v[12:15], a[240:247], v0
s_waitcnt lgkmcnt(5)
v_smfmac_f32_16x16x64_bf16 v[32:35], v[52:55], v[68:75], v0
ds_read_b128 v[72:75], v2 offset:37888
ds_read_b128 v[36:39], v2 offset:32768
v_cvt_pk_bf16_f32 v25, v25, v27
v_cvt_pk_bf16_f32 v24, v24, v26
v_bfi_b32 v24, 1, s35, v24
buffer_store_dwordx2 v[24:25], v8, s[4:7], s44 offen
v_smfmac_f32_16x16x64_bf16 v[32:35], v[56:59], a[248:255], v0
ds_read_b128 v[68:71], v2 offset:36864
s_waitcnt lgkmcnt(6)
v_smfmac_f32_16x16x64_bf16 v[28:31], v[16:19], v[44:51], v0
s_nop 3
v_cvt_pk_bf16_f32 v33, v33, v35
v_cvt_pk_bf16_f32 v32, v32, v34
v_bfi_b32 v32, 1, s35, v32
buffer_store_dwordx2 v[32:33], v8, s[4:7], s45 offen
s_waitcnt lgkmcnt(1)
v_smfmac_f32_16x16x64_bf16 v[28:31], v[52:55], v[36:43], v0
v_smfmac_f32_16x16x64_bf16 v[28:31], v[12:15], v[60:67], v0
s_waitcnt lgkmcnt(0)
v_smfmac_f32_16x16x64_bf16 v[28:31], v[56:59], v[68:75], v0
s_nop 7
v_cvt_pk_bf16_f32 v28, v28, v30
v_bfi_b32 v28, 1, s35, v28
v_cvt_pk_bf16_f32 v29, v29, v31
buffer_store_dwordx2 v[28:29], v8, s[4:7], s46 offen
s_branch L_ex_w1rf
.p2align 6
L_ex_w2rf:
s_add_u32 s34, s34, 1
s_not_b32 s35, s35
s_not_b32 s36, s36
v_and_b32 v6, 0x70, v1
ds_read_b128 v[76:79], v6 offset:256
v_bfe_u32 v11, v1, 4, 2
v_lshrrev_b32_e64 v11, v11, 1
v_bfe_u32 v6, v1, 2, 7
s_mov_b32 m0, 1024
v_mov_b32 v42, s35
s_waitcnt vmcnt(1)
buffer_load_dwordx4 v[60:63], v9, s[4:7], s3 offen offset:0 sc1
buffer_load_dwordx4 v[64:67], v9, s[4:7], s3 offen offset:1024 sc1
buffer_load_dwordx4 v[68:71], v9, s[4:7], s3 offen offset:2048 sc1
buffer_load_dwordx4 v[72:75], v9, s[4:7], s3 offen offset:3072 sc1
s_barrier
s_waitcnt lgkmcnt(0)
s_waitcnt vmcnt(3)
L_r_w2rf:
v_mfma_f32_16x16x32_bf16 v[36:39], v[60:63], v[76:79], 0
s_waitcnt vmcnt(2)
v_mfma_f32_16x16x32_bf16 v[36:39], v[64:67], v[76:79], v[36:39]
v_bitop3_b32 v40, v60, v64, s36 bitop3:0x7e
s_waitcnt vmcnt(1)
v_mfma_f32_16x16x32_bf16 v[36:39], v[68:71], v[76:79], v[36:39]
s_waitcnt vmcnt(0)
v_mfma_f32_16x16x32_bf16 v[36:39], v[72:75], v[76:79], v[36:39]
v_bitop3_b32 v41, v68, v72, s36 bitop3:0x7e
v_bitop3_b32 v40, v40, v41, 1 bitop3:0xa8
v_cmp_ne_u32 vcc, 0, v40
v_nop
v_nop
v_nop
v_nop
v_nop
v_pk_add_f32 v[36:37], v[36:37], v[38:39]
v_cvt_pk_bf16_f32 v40, v36, v37
v_bfi_b32 v40, v11, s35, v40
s_cbranch_vccnz L_rr_w2rf
buffer_store_dword v40, v10, s[4:7], 0 offen
s_cmp_eq_u32 s34, 63
v_mov_b32 v11, v40
s_cbranch_scc1 L_done_w2rf
s_mov_b64 exec, 1
buffer_store_dword v42, v1, s[4:7], s33 offen
s_mov_b64 exec, -1
v_mov_b64 v[20:21], 0
v_mov_b64 v[22:23], 0
v_mov_b64 v[24:25], 0
v_mov_b64 v[26:27], 0
v_mov_b64 v[28:29], 0
v_mov_b64 v[30:31], 0
v_mov_b64 v[32:33], 0
v_mov_b64 v[34:35], 0
v_mov_b64 v[36:37], 0
v_mov_b64 v[38:39], 0
v_mov_b64 v[40:41], 0
v_mov_b64 v[42:43], 0
v_bfe_u32 v77, v1, 6, 1
v_lshl_add_u32 v77, v77, 3, v1
v_lshlrev_b32 v77, 1, v77
v_lshlrev_b32 v78, 3, v1
ds_read_b128 v[44:47], v2 offset:0
ds_read_b128 v[48:51], v2 offset:1024
s_add_u32 s37, s37, 524288
s_mul_i32 s40, s34, 10240
s_add_u32 s40, s40, 8093696
v_mov_b32 v79, s36
L_sp_w2rf:
buffer_load_dword v79, v6, s[4:7], s58 offen sc1
s_sub_u32 s41, s41, 1
s_cbranch_scc1 L_exit
buffer_load_dwordx4 v1, s[4:7], s47 offen offset:0 sc1 lds
buffer_load_dwordx4 v1, s[4:7], s47 offen offset:1024 sc1 lds
buffer_load_dwordx4 v1, s[4:7], s47 offen offset:2048 sc1 lds
buffer_load_dwordx4 v1, s[4:7], s47 offen offset:3072 sc1 lds
s_waitcnt vmcnt(9)
v_cmp_ne_u32 vcc, s35, v79
s_cbranch_vccnz L_sp_w2rf
L_top_w2rf:
s_waitcnt vmcnt(8)
s_barrier
ds_read_b128 v[60:63], v1 offset:1024
s_mov_b32 m0, 5120
s_nop 0
buffer_load_dwordx4 v1, s[4:7], s48 offen offset:2048 sc1 lds
s_waitcnt vmcnt(6)
s_barrier
ds_read_b128 v[64:67], v1 offset:2048
ds_read_b128 v[68:71], v1 offset:3072
ds_read_b128 v[72:75], v1 offset:4096
L_s0_w2rf:
s_waitcnt lgkmcnt(3)
v_smfmac_f32_16x16x64_bf16 v[32:35], v[60:63], v[184:191], v0
v_smfmac_f32_16x16x64_bf16 v[36:39], v[60:63], a[48:55], v0
v_smfmac_f32_16x16x64_bf16 v[20:23], v[60:63], v[44:51], v0
ds_read_b128 v[48:51], v2 offset:3072
v_smfmac_f32_16x16x64_bf16 v[28:31], v[60:63], v[176:183], v0
buffer_load_dwordx4 v[12:15], v9, s[4:7], s37 offen offset:0
v_smfmac_f32_16x16x64_bf16 v[40:43], v[60:63], a[56:63], v0
s_waitcnt lgkmcnt(3)
v_smfmac_f32_16x16x64_bf16 v[28:31], v[64:67], v[192:199], v0
ds_read_b128 v[44:47], v2 offset:2048
v_smfmac_f32_16x16x64_bf16 v[20:23], v[64:67], v[80:87], v0
buffer_load_dwordx4 v[16:19], v9, s[4:7], s37 offen offset:1024
v_smfmac_f32_16x16x64_bf16 v[32:35], v[64:67], v[200:207], v0
v_bitop3_b32 v6, v60, v64, s35 bitop3:0x7e
s_waitcnt lgkmcnt(2)
v_bitop3_b32 v76, v68, v72, s35 bitop3:0x7e
v_smfmac_f32_16x16x64_bf16 v[24:27], v[64:67], v[88:95], v0
buffer_load_dwordx4 v[52:55], v1, s[4:7], s37 offen offset:2048
s_waitcnt lgkmcnt(0)
v_smfmac_f32_16x16x64_bf16 v[24:27], v[60:63], v[44:51], v0
v_smfmac_f32_16x16x64_bf16 v[36:39], v[64:67], a[64:71], v0
v_bitop3_b32 v6, v6, v76, 1 bitop3:0xa8
v_smfmac_f32_16x16x64_bf16 v[40:43], v[64:67], a[72:79], v0
ds_read_b128 v[44:47], v2 offset:4096
v_cmp_ne_u32 vcc, 0, v6
v_smfmac_f32_16x16x64_bf16 v[20:23], v[68:71], v[96:103], v0
buffer_load_dwordx4 v[56:59], v1, s[4:7], s37 offen offset:3072
ds_read_b128 v[48:51], v2 offset:5120
v_smfmac_f32_16x16x64_bf16 v[24:27], v[68:71], v[104:111], v0
s_cbranch_vccnz L_ra0_w2rf
s_waitcnt vmcnt(4)
s_barrier
ds_read_b32 v6, v77 offset:8192
v_smfmac_f32_16x16x64_bf16 v[28:31], v[68:71], v[208:215], v0
ds_read_b128 v[60:63], v1 offset:6144
ds_read_b128 v[64:67], v1 offset:7168
s_waitcnt lgkmcnt(3)
v_smfmac_f32_16x16x64_bf16 v[20:23], v[72:75], v[44:51], v0
ds_read_b128 v[76:79], v1 offset:5120
ds_read_b128 v[44:47], v2 offset:6144
buffer_store_dword v11, v10, s[4:7], s40 offen sc0 sc1
v_smfmac_f32_16x16x64_bf16 v[28:31], v[72:75], v[224:231], v0
v_smfmac_f32_16x16x64_bf16 v[32:35], v[68:71], v[216:223], v0
v_smfmac_f32_16x16x64_bf16 v[36:39], v[68:71], a[80:87], v0
ds_read_b128 v[48:51], v2 offset:7168
s_waitcnt lgkmcnt(4)
v_bitop3_b32 v6, v6, v60, s35 bitop3:0x7e
v_smfmac_f32_16x16x64_bf16 v[40:43], v[68:71], a[88:95], v0
ds_read_b128 v[68:71], v1 offset:8192
v_smfmac_f32_16x16x64_bf16 v[32:35], v[72:75], v[232:239], v0
s_waitcnt lgkmcnt(4)
v_bitop3_b32 v6, v6, v64, s35 bitop3:0xf6
s_waitcnt lgkmcnt(3)
v_bitop3_b32 v6, v6, v76, s35 bitop3:0xf6
v_and_b32 v6, 1, v6
s_waitcnt lgkmcnt(1)
v_smfmac_f32_16x16x64_bf16 v[24:27], v[72:75], v[44:51], v0
ds_read_b128 v[44:47], v2 offset:8192
v_cmp_ne_u32 vcc, 0, v6
v_smfmac_f32_16x16x64_bf16 v[36:39], v[72:75], a[96:103], v0
ds_read_b128 v[48:51], v2 offset:9216
v_smfmac_f32_16x16x64_bf16 v[40:43], v[72:75], a[104:111], v0
ds_read_b128 v[72:75], v1 offset:9216
s_cbranch_vccnz L_ra1_w2rf
L_a1_w2rf:
v_smfmac_f32_16x16x64_bf16 v[20:23], v[60:63], v[112:119], v0
v_smfmac_f32_16x16x64_bf16 v[20:23], v[64:67], v[128:135], v0
s_waitcnt lgkmcnt(1)
v_smfmac_f32_16x16x64_bf16 v[20:23], v[76:79], v[44:51], v0
ds_read_b128 v[48:51], v2 offset:11264
v_bfe_u32 v6, v1, 5, 1
v_mad_i32_i24 v6, v6, s55, v1
v_smfmac_f32_16x16x64_bf16 v[20:23], v[68:71], v[144:151], v0
s_waitcnt lgkmcnt(1)
v_smfmac_f32_16x16x64_bf16 v[20:23], v[72:75], v[160:167], v0
ds_read_b128 v[44:47], v2 offset:10240
v_smfmac_f32_16x16x64_bf16 v[24:27], v[60:63], v[120:127], v0
v_smfmac_f32_16x16x64_bf16 v[24:27], v[64:67], v[136:143], v0
v_smfmac_f32_16x16x64_bf16 v[24:27], v[68:71], v[152:159], v0
v_add_f32 v21, v21, v23
v_smfmac_f32_16x16x64_bf16 v[24:27], v[72:75], v[168:175], v0
s_waitcnt lgkmcnt(0)
v_smfmac_f32_16x16x64_bf16 v[24:27], v[76:79], v[44:51], v0
ds_read_b128 v[44:47], v2 offset:12288
v_add_f32 v20, v20, v22
v_cvt_pk_bf16_f32 v22, v20, v21
v_smfmac_f32_16x16x64_bf16 v[28:31], v[76:79], v[240:247], v0
ds_read_b128 v[48:51], v2 offset:13312
v_smfmac_f32_16x16x64_bf16 v[28:31], v[64:67], a[0:7], v0
v_add_f32 v25, v25, v27
v_add_f32 v24, v24, v26
v_cvt_pk_bf16_f32 v23, v24, v25
v_smfmac_f32_16x16x64_bf16 v[28:31], v[72:75], a[32:39], v0
ds_write_b64 v3, v[22:23] offset:11264
v_smfmac_f32_16x16x64_bf16 v[32:35], v[76:79], v[248:255], v0
s_waitcnt lgkmcnt(1)
v_smfmac_f32_16x16x64_bf16 v[28:31], v[60:63], v[44:51], v0
ds_read_b128 v[48:51], v2 offset:15360
v_smfmac_f32_16x16x64_bf16 v[28:31], v[68:71], a[16:23], v0
ds_read_b128 v[44:47], v2 offset:14336
s_waitcnt vmcnt(1)
v_smfmac_f32_16x16x64_bf16 v[32:35], v[64:67], a[8:15], v0
s_waitcnt lgkmcnt(2)
s_barrier
ds_read_b64_tr_b16 v[20:21], v4 offset:10240
v_smfmac_f32_16x16x64_bf16 v[32:35], v[68:71], a[24:31], v0
ds_read_b64_tr_b16 v[22:23], v4 offset:10752
v_add_f32 v29, v29, v31
v_smfmac_f32_16x16x64_bf16 v[32:35], v[72:75], a[40:47], v0
ds_read_b64_tr_b16 v[24:25], v4 offset:11264
ds_read_b64_tr_b16 v[26:27], v4 offset:11776
s_waitcnt lgkmcnt(4)
v_smfmac_f32_16x16x64_bf16 v[32:35], v[60:63], v[44:51], v0
ds_read_b128 v[48:51], v2 offset:19456
s_waitcnt lgkmcnt(3)
v_mfma_f32_16x16x32_bf16 v[12:15], v[12:15], v[20:23], 0
ds_read_b128 v[44:47], v2 offset:18432
v_add_f32 v28, v28, v30
s_waitcnt lgkmcnt(2)
v_mfma_f32_16x16x32_bf16 v[12:15], v[16:19], v[24:27], v[12:15]
v_add_f32 v33, v33, v35
v_add_f32 v32, v32, v34
v_cvt_pk_bf16_f32 v30, v28, v29
v_cvt_pk_bf16_f32 v31, v32, v33
v_smfmac_f32_16x16x64_bf16 v[36:39], v[76:79], a[112:119], v0
ds_write_b64 v3, v[30:31] offset:13312
v_add_f32_dpp v12, v14, v12 quad_perm:[2,3,0,1] row_mask:0xf bank_mask:0xf
v_exp_f32 v14, v12
v_add_f32_dpp v13, v15, v13 quad_perm:[2,3,0,1] row_mask:0xf bank_mask:0xf
v_exp_f32 v15, v13
s_nop 0
v_cvt_pk_bf16_f32 v14, v14, v15
v_smfmac_f32_16x16x64_bf16 v[40:43], v[76:79], a[120:127], v0
ds_write_b32 v5, v14 offset:14880
s_waitcnt lgkmcnt(2)
v_smfmac_f32_16x16x64_bf16 v[40:43], v[72:75], v[44:51], v0
ds_read_b128 v[44:47], v2 offset:16384
s_waitcnt lgkmcnt(2)
s_barrier
ds_read_b64_tr_b16 v[28:29], v4 offset:12288
v_smfmac_f32_16x16x64_bf16 v[36:39], v[60:63], a[128:135], v0
ds_read_b64_tr_b16 v[30:31], v4 offset:12800
ds_read_b64_tr_b16 v[32:33], v4 offset:13312
v_smfmac_f32_16x16x64_bf16 v[40:43], v[60:63], a[136:143], v0
ds_read_b64_tr_b16 v[34:35], v4 offset:13824
v_mov_b64 v[76:77], s[52:53]
s_waitcnt lgkmcnt(2)
v_mfma_f32_16x16x32_bf16 v[28:31], v[28:31], v[20:23], 0
s_barrier
ds_read_b128 v[16:19], v1 offset:14368
s_waitcnt lgkmcnt(1)
v_mfma_f32_16x16x32_bf16 v[28:31], v[32:35], v[24:27], v[28:31]
ds_read_b128 v[60:63], v1 offset:14336
v_mov_b64 v[14:15], s[0:1]
v_smfmac_f32_16x16x64_bf16 v[40:43], v[64:67], a[152:159], v0
ds_read_b128 v[48:51], v2 offset:17408
v_mov_b64 v[78:79], s[52:53]
v_smfmac_f32_16x16x64_bf16 v[40:43], v[68:71], a[168:175], v0
v_add_f32_dpp v28, v30, v28 quad_perm:[2,3,0,1] row_mask:0xf bank_mask:0xf
v_mul_f32 v28, s50, v28
v_smfmac_f32_16x16x64_bf16 v[36:39], v[64:67], a[144:151], v0
ds_read_b128 v[64:67], v2 offset:23552
v_add_f32_dpp v29, v31, v29 quad_perm:[2,3,0,1] row_mask:0xf bank_mask:0xf
v_smfmac_f32_16x16x64_bf16 v[36:39], v[68:71], a[160:167], v0
ds_read_b128 v[68:71], v2 offset:24576
s_waitcnt lgkmcnt(2)
v_smfmac_f32_16x16x64_bf16 v[36:39], v[72:75], v[44:51], v0
ds_read_b128 v[72:75], v2 offset:25600
v_cvt_pk_bf16_f32 v40, v40, v41
v_mfma_f32_16x16x32_bf16 v[32:35], v[76:79], v[16:19], 0
ds_read_b128 v[44:47], v2 offset:20480
v_mul_f32 v29, s50, v29
v_exp_f32 v30, v28
v_mfma_f32_16x16x32_bf16 v[20:23], v[52:55], v[16:19], 0
v_exp_f32 v31, v29
v_cvt_pk_bf16_f32 v41, v42, v43
v_cvt_pk_bf16_f32 v43, v38, v39
v_mov_b64 v[76:77], 0
v_mfma_f32_16x16x32_bf16 v[20:23], v[56:59], v[60:63], v[20:23]
v_cvt_pk_bf16_f32 v30, v30, v31
v_cndmask_b32_e64 v26, 0, v30, s[56:57]
v_cndmask_b32_e64 v27, 0, v30, s[56:57]
s_nop 0
v_mov_b32_dpp v24, v26 quad_perm:[2,3,0,1] row_mask:0xf bank_mask:0xf
v_mfma_f32_16x16x16_bf16 v[32:35], v[14:15], v[26:27], v[32:35]
v_cvt_pk_bf16_f32 v42, v36, v37
v_mov_b32_dpp v25, v26 quad_perm:[2,3,0,1] row_mask:0xf bank_mask:0xf
s_nop 1
v_mfma_f32_16x16x32_bf16 v[20:23], v[40:43], v[24:27], v[20:23]
ds_read_b128 v[60:63], v2 offset:22528
ds_read_b128 v[48:51], v2 offset:21504
v_rcp_f32 v33, v32
v_mov_b64 v[36:37], 0
v_mov_b64 v[78:79], 0
v_min_f32 v32, v32, v33
v_cmp_nlt_f32 vcc, s2, v32
v_mul_f32_dpp v23, v33, v23 quad_perm:[0,1,0,1] row_mask:0xf bank_mask:0xf
v_mul_f32_dpp v21, v33, v21 quad_perm:[0,1,0,1] row_mask:0xf bank_mask:0xf
v_mul_f32_dpp v22, v33, v22 quad_perm:[0,1,0,1] row_mask:0xf bank_mask:0xf
v_mul_f32_dpp v20, v33, v20 quad_perm:[0,1,0,1] row_mask:0xf bank_mask:0xf
v_cvt_pk_bf16_f32 v20, v20, v21
v_cvt_pk_bf16_f32 v21, v22, v23
ds_write_b64 v6, v[20:21] offset:7168
s_and_b64 vcc, vcc, s[56:57]
v_mov_b32_dpp v16, v20 quad_perm:[0,1,0,1] row_mask:0xf bank_mask:0xf
v_mov_b32_dpp v19, v21 quad_perm:[2,3,2,3] row_mask:0xf bank_mask:0xf
s_cbranch_scc1 L_mx_w2rf
L_mxb_w2rf:
v_mov_b32_dpp v18, v20 quad_perm:[2,3,2,3] row_mask:0xf bank_mask:0xf
v_mov_b64 v[38:39], 0
v_mov_b32_dpp v17, v21 quad_perm:[0,1,0,1] row_mask:0xf bank_mask:0xf
v_mov_b64 v[26:27], 0
v_mov_b64 v[24:25], 0
v_mov_b64 v[32:33], 0
v_smfmac_f32_16x16x64_bf16 v[76:79], v[16:19], a[176:183], v0
s_waitcnt lgkmcnt(0)
s_barrier
ds_read_b128 v[12:15], v7 offset:5120
ds_read_b128 v[52:55], v7 offset:8192
v_smfmac_f32_16x16x64_bf16 v[36:39], v[16:19], a[184:191], v0
ds_read_b128 v[56:59], v7 offset:6144
v_mov_b64 v[34:35], 0
v_smfmac_f32_16x16x64_bf16 v[24:27], v[16:19], a[192:199], v0
v_smfmac_f32_16x16x64_bf16 v[32:35], v[16:19], a[200:207], v0
s_waitcnt lgkmcnt(2)
v_smfmac_f32_16x16x64_bf16 v[76:79], v[12:15], a[208:215], v0
s_waitcnt lgkmcnt(1)
v_smfmac_f32_16x16x64_bf16 v[76:79], v[52:55], a[216:223], v0
s_waitcnt lgkmcnt(0)
v_smfmac_f32_16x16x64_bf16 v[76:79], v[56:59], a[224:231], v0
v_smfmac_f32_16x16x64_bf16 v[36:39], v[12:15], v[44:51], v0
ds_read_b128 v[48:51], v2 offset:27648
ds_read_b128 v[44:47], v2 offset:26624
v_smfmac_f32_16x16x64_bf16 v[36:39], v[52:55], a[232:239], v0
v_cvt_pk_bf16_f32 v77, v77, v79
v_cvt_pk_bf16_f32 v76, v76, v78
v_bfi_b32 v76, 1, s35, v76
v_smfmac_f32_16x16x64_bf16 v[36:39], v[56:59], v[60:67], v0
buffer_store_dwordx2 v[76:77], v8, s[4:7], s42 offen
ds_read_b128 v[60:63], v2 offset:28672
v_smfmac_f32_16x16x64_bf16 v[24:27], v[12:15], v[68:75], v0
ds_read_b128 v[64:67], v2 offset:29696
v_smfmac_f32_16x16x64_bf16 v[24:27], v[52:55], a[240:247], v0
ds_read_b128 v[68:71], v2 offset:30720
v_cvt_pk_bf16_f32 v36, v36, v38
v_bfi_b32 v36, 1, s35, v36
v_cvt_pk_bf16_f32 v37, v37, v39
s_waitcnt lgkmcnt(3)
v_smfmac_f32_16x16x64_bf16 v[24:27], v[56:59], v[44:51], v0
buffer_store_dwordx2 v[36:37], v8, s[4:7], s43 offen
ds_read_b128 v[72:75], v2 offset:31744
v_smfmac_f32_16x16x64_bf16 v[32:35], v[52:55], a[248:255], v0
s_waitcnt lgkmcnt(2)
v_smfmac_f32_16x16x64_bf16 v[32:35], v[12:15], v[60:67], v0
v_cvt_pk_bf16_f32 v25, v25, v27
v_cvt_pk_bf16_f32 v24, v24, v26
v_bfi_b32 v24, 1, s35, v24
buffer_store_dwordx2 v[24:25], v8, s[4:7], s44 offen
s_waitcnt lgkmcnt(0)
v_smfmac_f32_16x16x64_bf16 v[32:35], v[56:59], v[68:75], v0
s_nop 7
v_cvt_pk_bf16_f32 v33, v33, v35
v_cvt_pk_bf16_f32 v32, v32, v34
v_bfi_b32 v32, 1, s35, v32
buffer_store_dwordx2 v[32:33], v8, s[4:7], s45 offen
s_branch L_ex_w2rf
.p2align 6
L_ex_w3f:
s_add_u32 s34, s34, 1
s_not_b32 s35, s35
s_not_b32 s36, s36
s_add_u32 s37, s37, 524288
s_add_u32 s39, s39, 524288
v_mov_b64 v[20:21], 0
v_mov_b64 v[22:23], 0
v_mov_b64 v[24:25], 0
v_mov_b64 v[26:27], 0
v_mov_b64 v[28:29], 0
v_mov_b64 v[30:31], 0
v_mov_b64 v[32:33], 0
v_mov_b64 v[34:35], 0
v_mov_b64 v[36:37], 0
v_mov_b64 v[38:39], 0
v_mov_b64 v[40:41], 0
v_mov_b64 v[42:43], 0
ds_read_b128 v[44:47], v2 offset:0
ds_read_b128 v[48:51], v2 offset:1024
v_bfe_u32 v77, v1, 6, 1
v_lshl_add_u32 v77, v77, 3, v1
v_lshlrev_b32 v77, 1, v77
v_lshlrev_b32 v78, 3, v1
s_barrier
s_cmp_eq_u32 s34, 63
s_cbranch_scc1 L_done_w3f
s_add_u32 s100, s34, 1
s_lshr_b32 s100, s100, 2
s_waitcnt vmcnt(4)
L_evb_w3f:
v_max_u32 v10, v10, v11
v_bfe_u32 v11, v1, 2, 6
v_cmp_ge_u32 vcc, s100, v10
s_cbranch_vccnz L_ev_w3f
s_add_u32 s100, s34, 4
s_lshr_b32 s100, s100, 2
s_min_u32 s100, s100, 15
v_cmp_ge_u32 vcc, s100, v10
s_nop 0
s_cmp_eq_u64 vcc, 0
s_cselect_b32 s3, 268435456, s101
L_top_w3f:
s_barrier
ds_read_b128 v[60:63], v1 offset:1024
s_mov_b32 m0, 5120
s_nop 0
buffer_load_dwordx4 v1, s[4:7], s48 offen offset:3072 sc1 lds
s_barrier
ds_read_b128 v[64:67], v1 offset:2048
ds_read_b128 v[68:71], v1 offset:3072
ds_read_b128 v[72:75], v1 offset:4096
L_s0_w3f:
s_waitcnt lgkmcnt(3)
v_smfmac_f32_16x16x64_bf16 v[32:35], v[60:63], v[184:191], v0
s_mov_b32 m0, 9216
s_nop 0
buffer_load_dwordx4 v1, s[4:7], s49 offen offset:0 sc1 lds
v_smfmac_f32_16x16x64_bf16 v[20:23], v[60:63], v[44:51], v0
v_smfmac_f32_16x16x64_bf16 v[28:31], v[60:63], v[176:183], v0
s_waitcnt lgkmcnt(2)
v_smfmac_f32_16x16x64_bf16 v[28:31], v[64:67], v[192:199], v0
ds_read_b128 v[48:51], v2 offset:3072
v_smfmac_f32_16x16x64_bf16 v[36:39], v[60:63], a[48:55], v0
ds_read_b128 v[44:47], v2 offset:2048
v_smfmac_f32_16x16x64_bf16 v[40:43], v[60:63], a[56:63], v0
buffer_load_dwordx4 v[12:15], v9, s[4:7], s37 offen offset:0
v_smfmac_f32_16x16x64_bf16 v[24:27], v[64:67], v[88:95], v0
v_smfmac_f32_16x16x64_bf16 v[20:23], v[64:67], v[80:87], v0
v_bitop3_b32 v6, v60, v64, s35 bitop3:0x7e
v_smfmac_f32_16x16x64_bf16 v[32:35], v[64:67], v[200:207], v0
buffer_load_dwordx4 v[16:19], v9, s[4:7], s37 offen offset:1024
s_waitcnt lgkmcnt(0)
v_smfmac_f32_16x16x64_bf16 v[24:27], v[60:63], v[44:51], v0
v_bitop3_b32 v76, v68, v72, s35 bitop3:0x7e
v_bitop3_b32 v6, v6, v76, 1 bitop3:0xa8
v_smfmac_f32_16x16x64_bf16 v[36:39], v[64:67], a[64:71], v0
v_cmp_ne_u32 vcc, 0, v6
v_smfmac_f32_16x16x64_bf16 v[40:43], v[64:67], a[72:79], v0
buffer_load_dwordx4 v[52:55], v1, s[4:7], s37 offen offset:2048
ds_read_b128 v[44:47], v2 offset:4096
v_smfmac_f32_16x16x64_bf16 v[20:23], v[68:71], v[96:103], v0
ds_read_b128 v[48:51], v2 offset:5120
buffer_load_dwordx4 v[56:59], v1, s[4:7], s37 offen offset:3072
s_mov_b32 m0, 0
v_smfmac_f32_16x16x64_bf16 v[24:27], v[68:71], v[104:111], v0
s_cbranch_vccnz L_ra0_w3f
s_waitcnt vmcnt(4)
s_barrier
ds_read_b32 v6, v77 offset:8192
v_smfmac_f32_16x16x64_bf16 v[28:31], v[68:71], v[208:215], v0
buffer_load_dword v78, s[4:7], s39 offen lds
buffer_load_dword v11, v11, s[4:7], s3 offen sc1
v_smfmac_f32_16x16x64_bf16 v[36:39], v[68:71], a[80:87], v0
ds_read_b128 v[60:63], v1 offset:6144
v_smfmac_f32_16x16x64_bf16 v[28:31], v[72:75], v[224:231], v0
ds_read_b128 v[76:79], v1 offset:5120
s_waitcnt lgkmcnt(3)
v_smfmac_f32_16x16x64_bf16 v[20:23], v[72:75], v[44:51], v0
ds_read_b128 v[64:67], v1 offset:7168
v_smfmac_f32_16x16x64_bf16 v[32:35], v[68:71], v[216:223], v0
ds_read_b128 v[44:47], v2 offset:6144
v_smfmac_f32_16x16x64_bf16 v[40:43], v[68:71], a[88:95], v0
ds_read_b128 v[48:51], v2 offset:7168
s_waitcnt lgkmcnt(4)
v_bitop3_b32 v6, v6, v60, s35 bitop3:0x7e
ds_read_b128 v[68:71], v1 offset:8192
v_smfmac_f32_16x16x64_bf16 v[32:35], v[72:75], v[232:239], v0
s_waitcnt lgkmcnt(3)
v_bitop3_b32 v6, v6, v64, s35 bitop3:0xf6
v_bitop3_b32 v6, v6, v76, s35 bitop3:0xf6
v_and_b32 v6, 1, v6
s_waitcnt lgkmcnt(1)
v_smfmac_f32_16x16x64_bf16 v[24:27], v[72:75], v[44:51], v0
ds_read_b128 v[44:47], v2 offset:8192
v_cmp_ne_u32 vcc, 0, v6
v_smfmac_f32_16x16x64_bf16 v[36:39], v[72:75], a[96:103], v0
ds_read_b128 v[48:51], v2 offset:9216
v_smfmac_f32_16x16x64_bf16 v[40:43], v[72:75], a[104:111], v0
ds_read_b128 v[72:75], v1 offset:9216
s_cbranch_vccnz L_ra1_w3f
L_a1_w3f:
v_smfmac_f32_16x16x64_bf16 v[20:23], v[60:63], v[112:119], v0
v_smfmac_f32_16x16x64_bf16 v[20:23], v[64:67], v[128:135], v0
s_waitcnt lgkmcnt(1)
v_smfmac_f32_16x16x64_bf16 v[20:23], v[76:79], v[44:51], v0
ds_read_b128 v[48:51], v2 offset:11264
v_bfe_u32 v6, v1, 5, 1
v_mad_i32_i24 v6, v6, s55, v1
v_smfmac_f32_16x16x64_bf16 v[20:23], v[68:71], v[144:151], v0
s_waitcnt lgkmcnt(1)
v_smfmac_f32_16x16x64_bf16 v[20:23], v[72:75], v[160:167], v0
v_smfmac_f32_16x16x64_bf16 v[24:27], v[60:63], v[120:127], v0
ds_read_b128 v[44:47], v2 offset:10240
v_smfmac_f32_16x16x64_bf16 v[24:27], v[64:67], v[136:143], v0
v_smfmac_f32_16x16x64_bf16 v[24:27], v[68:71], v[152:159], v0
v_add_f32 v21, v21, v23
v_smfmac_f32_16x16x64_bf16 v[24:27], v[72:75], v[168:175], v0
s_waitcnt lgkmcnt(0)
v_smfmac_f32_16x16x64_bf16 v[24:27], v[76:79], v[44:51], v0
ds_read_b128 v[44:47], v2 offset:12288
v_add_f32 v20, v20, v22
v_cvt_pk_bf16_f32 v22, v20, v21
v_smfmac_f32_16x16x64_bf16 v[28:31], v[76:79], v[240:247], v0
ds_read_b128 v[48:51], v2 offset:13312
v_smfmac_f32_16x16x64_bf16 v[28:31], v[64:67], a[0:7], v0
v_add_f32 v25, v25, v27
v_add_f32 v24, v24, v26
v_cvt_pk_bf16_f32 v23, v24, v25
v_smfmac_f32_16x16x64_bf16 v[28:31], v[72:75], a[32:39], v0
ds_write_b64 v3, v[22:23] offset:11776
v_smfmac_f32_16x16x64_bf16 v[32:35], v[76:79], v[248:255], v0
s_waitcnt lgkmcnt(1)
v_smfmac_f32_16x16x64_bf16 v[28:31], v[60:63], v[44:51], v0
ds_read_b128 v[48:51], v2 offset:15360
v_smfmac_f32_16x16x64_bf16 v[28:31], v[68:71], a[16:23], v0
ds_read_b128 v[44:47], v2 offset:14336
s_waitcnt vmcnt(2)
v_smfmac_f32_16x16x64_bf16 v[32:35], v[64:67], a[8:15], v0
s_waitcnt lgkmcnt(2)
s_barrier
v_smfmac_f32_16x16x64_bf16 v[32:35], v[68:71], a[24:31], v0
ds_read_b64_tr_b16 v[20:21], v4 offset:10240
ds_read_b64_tr_b16 v[22:23], v4 offset:10752
v_add_f32 v29, v29, v31
v_smfmac_f32_16x16x64_bf16 v[32:35], v[72:75], a[40:47], v0
ds_read_b64_tr_b16 v[24:25], v4 offset:11264
ds_read_b64_tr_b16 v[26:27], v4 offset:11776
s_waitcnt lgkmcnt(4)
v_smfmac_f32_16x16x64_bf16 v[32:35], v[60:63], v[44:51], v0
ds_read_b128 v[48:51], v2 offset:19456
s_waitcnt lgkmcnt(3)
v_mfma_f32_16x16x32_bf16 v[12:15], v[12:15], v[20:23], 0
ds_read_b128 v[44:47], v2 offset:18432
v_add_f32 v28, v28, v30
s_waitcnt lgkmcnt(2)
v_mfma_f32_16x16x32_bf16 v[12:15], v[16:19], v[24:27], v[12:15]
v_add_f32 v32, v32, v34
v_add_f32 v33, v33, v35
v_cvt_pk_bf16_f32 v30, v28, v29
v_cvt_pk_bf16_f32 v31, v32, v33
v_smfmac_f32_16x16x64_bf16 v[36:39], v[76:79], a[112:119], v0
ds_write_b64 v3, v[30:31] offset:13824
v_add_f32_dpp v12, v14, v12 quad_perm:[2,3,0,1] row_mask:0xf bank_mask:0xf
v_exp_f32 v14, v12
v_add_f32_dpp v13, v15, v13 quad_perm:[2,3,0,1] row_mask:0xf bank_mask:0xf
v_exp_f32 v15, v13
s_nop 0
v_cvt_pk_bf16_f32 v14, v14, v15
v_smfmac_f32_16x16x64_bf16 v[40:43], v[76:79], a[120:127], v0
ds_write_b32 v5, v14 offset:15136
s_waitcnt lgkmcnt(1)
s_barrier
ds_read_b64_tr_b16 v[28:29], v4 offset:12288
v_smfmac_f32_16x16x64_bf16 v[36:39], v[60:63], a[128:135], v0
ds_read_b64_tr_b16 v[30:31], v4 offset:12800
ds_read_b64_tr_b16 v[32:33], v4 offset:13312
v_smfmac_f32_16x16x64_bf16 v[40:43], v[60:63], a[136:143], v0
ds_read_b64_tr_b16 v[34:35], v4 offset:13824
v_mov_b64 v[76:77], s[52:53]
v_smfmac_f32_16x16x64_bf16 v[40:43], v[72:75], v[44:51], v0
ds_read_b128 v[44:47], v2 offset:16384
s_waitcnt lgkmcnt(3)
v_mfma_f32_16x16x32_bf16 v[28:31], v[28:31], v[20:23], 0
s_barrier
ds_read_b128 v[16:19], v1 offset:14368
s_waitcnt lgkmcnt(2)
v_mfma_f32_16x16x32_bf16 v[28:31], v[32:35], v[24:27], v[28:31]
ds_read_b128 v[60:63], v1 offset:14336
v_mov_b64 v[14:15], s[0:1]
v_smfmac_f32_16x16x64_bf16 v[40:43], v[64:67], a[152:159], v0
ds_read_b128 v[48:51], v2 offset:17408
v_mov_b64 v[78:79], s[52:53]
v_smfmac_f32_16x16x64_bf16 v[40:43], v[68:71], a[168:175], v0
v_add_f32_dpp v28, v30, v28 quad_perm:[2,3,0,1] row_mask:0xf bank_mask:0xf
v_mul_f32 v28, s50, v28
v_smfmac_f32_16x16x64_bf16 v[36:39], v[64:67], a[144:151], v0
ds_read_b128 v[64:67], v2 offset:21504
v_add_f32_dpp v29, v31, v29 quad_perm:[2,3,0,1] row_mask:0xf bank_mask:0xf
v_smfmac_f32_16x16x64_bf16 v[36:39], v[68:71], a[160:167], v0
ds_read_b128 v[68:71], v2 offset:26624
s_waitcnt lgkmcnt(2)
v_smfmac_f32_16x16x64_bf16 v[36:39], v[72:75], v[44:51], v0
ds_read_b128 v[72:75], v2 offset:27648
v_cvt_pk_bf16_f32 v40, v40, v41
v_exp_f32 v30, v28
v_mfma_f32_16x16x32_bf16 v[32:35], v[76:79], v[16:19], 0
ds_read_b128 v[44:47], v2 offset:22528
v_mul_f32 v29, s50, v29
v_mfma_f32_16x16x32_bf16 v[20:23], v[52:55], v[16:19], 0
v_exp_f32 v31, v29
v_mfma_f32_16x16x32_bf16 v[20:23], v[56:59], v[60:63], v[20:23]
v_cvt_pk_bf16_f32 v41, v42, v43
v_cvt_pk_bf16_f32 v30, v30, v31
v_cndmask_b32_e64 v26, 0, v30, s[56:57]
v_cvt_pk_bf16_f32 v43, v38, v39
v_cndmask_b32_e64 v27, 0, v30, s[56:57]
v_mov_b32_dpp v24, v26 quad_perm:[2,3,0,1] row_mask:0xf bank_mask:0xf
v_mov_b64 v[76:77], 0
v_mfma_f32_16x16x16_bf16 v[32:35], v[14:15], v[26:27], v[32:35]
v_cvt_pk_bf16_f32 v42, v36, v37
v_mov_b32_dpp v25, v26 quad_perm:[2,3,0,1] row_mask:0xf bank_mask:0xf
s_nop 1
v_mfma_f32_16x16x32_bf16 v[20:23], v[40:43], v[24:27], v[20:23]
ds_read_b128 v[48:51], v2 offset:23552
s_nop 0
v_rcp_f32 v33, v32
ds_read_b128 v[60:63], v2 offset:20480
v_mov_b64 v[36:37], 0
v_min_f32 v32, v32, v33
v_cmp_nlt_f32 vcc, s2, v32
v_mov_b64 v[78:79], 0
v_mul_f32_dpp v23, v33, v23 quad_perm:[0,1,0,1] row_mask:0xf bank_mask:0xf
v_mul_f32_dpp v21, v33, v21 quad_perm:[0,1,0,1] row_mask:0xf bank_mask:0xf
v_mul_f32_dpp v22, v33, v22 quad_perm:[0,1,0,1] row_mask:0xf bank_mask:0xf
v_mul_f32_dpp v20, v33, v20 quad_perm:[0,1,0,1] row_mask:0xf bank_mask:0xf
v_cvt_pk_bf16_f32 v20, v20, v21
v_cvt_pk_bf16_f32 v21, v22, v23
ds_write_b64 v6, v[20:21] offset:8192
s_and_b64 vcc, vcc, s[56:57]
v_mov_b64 v[38:39], 0
s_cbranch_scc1 L_mx_w3f
L_mxb_w3f:
v_mov_b32_dpp v16, v20 quad_perm:[0,1,0,1] row_mask:0xf bank_mask:0xf
v_mov_b32_dpp v19, v21 quad_perm:[2,3,2,3] row_mask:0xf bank_mask:0xf
v_mov_b64 v[24:25], 0
v_mov_b32_dpp v18, v20 quad_perm:[2,3,2,3] row_mask:0xf bank_mask:0xf
v_mov_b32_dpp v17, v21 quad_perm:[0,1,0,1] row_mask:0xf bank_mask:0xf
v_mov_b64 v[26:27], 0
v_mov_b64 v[32:33], 0
v_smfmac_f32_16x16x64_bf16 v[76:79], v[16:19], a[176:183], v0
s_waitcnt lgkmcnt(0)
s_barrier
ds_read_b128 v[12:15], v7 offset:6144
ds_read_b128 v[52:55], v7 offset:7168
v_smfmac_f32_16x16x64_bf16 v[36:39], v[16:19], a[184:191], v0
ds_read_b128 v[56:59], v7 offset:5120
v_mov_b64 v[34:35], 0
s_nop 1
v_smfmac_f32_16x16x64_bf16 v[32:35], v[16:19], a[200:207], v0
v_smfmac_f32_16x16x64_bf16 v[24:27], v[16:19], a[192:199], v0
s_waitcnt lgkmcnt(2)
v_smfmac_f32_16x16x64_bf16 v[76:79], v[12:15], a[208:215], v0
s_waitcnt lgkmcnt(1)
v_smfmac_f32_16x16x64_bf16 v[76:79], v[52:55], a[216:223], v0
s_waitcnt lgkmcnt(0)
v_smfmac_f32_16x16x64_bf16 v[76:79], v[56:59], a[224:231], v0
v_smfmac_f32_16x16x64_bf16 v[36:39], v[12:15], v[44:51], v0
ds_read_b128 v[48:51], v2 offset:25600
ds_read_b128 v[44:47], v2 offset:24576
v_smfmac_f32_16x16x64_bf16 v[36:39], v[52:55], a[232:239], v0
v_cvt_pk_bf16_f32 v77, v77, v79
v_cvt_pk_bf16_f32 v76, v76, v78
v_bfi_b32 v76, 1, s35, v76
v_smfmac_f32_16x16x64_bf16 v[36:39], v[56:59], v[60:67], v0
buffer_store_dwordx2 v[76:77], v8, s[4:7], s42 offen
ds_read_b128 v[60:63], v2 offset:30720
v_smfmac_f32_16x16x64_bf16 v[24:27], v[12:15], v[68:75], v0
ds_read_b128 v[64:67], v2 offset:31744
v_smfmac_f32_16x16x64_bf16 v[24:27], v[52:55], a[240:247], v0
ds_read_b128 v[68:71], v2 offset:28672
v_cvt_pk_bf16_f32 v36, v36, v38
v_bfi_b32 v36, 1, s35, v36
v_cvt_pk_bf16_f32 v37, v37, v39
s_waitcnt lgkmcnt(3)
v_smfmac_f32_16x16x64_bf16 v[24:27], v[56:59], v[44:51], v0
buffer_store_dwordx2 v[36:37], v8, s[4:7], s43 offen
ds_read_b128 v[72:75], v2 offset:29696
s_nop 5
v_cvt_pk_bf16_f32 v25, v25, v27
v_cvt_pk_bf16_f32 v24, v24, v26
v_bfi_b32 v24, 1, s35, v24
v_smfmac_f32_16x16x64_bf16 v[32:35], v[52:55], a[248:255], v0
s_waitcnt lgkmcnt(2)
v_smfmac_f32_16x16x64_bf16 v[32:35], v[12:15], v[60:67], v0
buffer_store_dwordx2 v[24:25], v8, s[4:7], s44 offen
s_waitcnt lgkmcnt(0)
v_smfmac_f32_16x16x64_bf16 v[32:35], v[56:59], v[68:75], v0
s_nop 7
v_cvt_pk_bf16_f32 v33, v33, v35
v_cvt_pk_bf16_f32 v32, v32, v34
v_bfi_b32 v32, 1, s35, v32
buffer_store_dwordx2 v[32:33], v8, s[4:7], s45 offen
s_branch L_ex_w3f
.p2align 6
L_ex_w0s:
s_add_u32 s34, s34, 1
s_not_b32 s35, s35
s_not_b32 s36, s36
s_add_u32 s37, s37, 524288
s_add_u32 s39, s39, 524288
v_mov_b64 v[20:21], 0
v_mov_b64 v[22:23], 0
v_mov_b64 v[24:25], 0
v_mov_b64 v[26:27], 0
v_mov_b64 v[28:29], 0
v_mov_b64 v[30:31], 0
v_mov_b64 v[32:33], 0
v_mov_b64 v[34:35], 0
v_mov_b64 v[36:37], 0
v_mov_b64 v[38:39], 0
v_mov_b64 v[40:41], 0
v_mov_b64 v[42:43], 0
ds_read_b128 v[44:47], v2 offset:0
ds_read_b128 v[48:51], v2 offset:1024
v_bfe_u32 v77, v1, 6, 1
v_lshl_add_u32 v77, v77, 3, v1
v_lshlrev_b32 v77, 1, v77
v_lshlrev_b32 v78, 3, v1
s_barrier
s_cmp_eq_u32 s34, 63
s_cbranch_scc1 L_done_w0s
L_top_w0s:
s_barrier
ds_read_b128 v[60:63], v1 offset:1024
s_mov_b32 m0, 5120
s_nop 0
buffer_load_dwordx4 v1, s[4:7], s48 offen offset:0 sc0 sc1 lds
s_barrier
ds_read_b128 v[64:67], v1 offset:2048
ds_read_b128 v[68:71], v1 offset:3072
ds_read_b128 v[72:75], v1 offset:4096
L_s0_w0s:
s_waitcnt lgkmcnt(3)
v_smfmac_f32_16x16x64_bf16 v[32:35], v[60:63], v[184:191], v0
v_smfmac_f32_16x16x64_bf16 v[20:23], v[60:63], v[44:51], v0
v_smfmac_f32_16x16x64_bf16 v[36:39], v[60:63], a[48:55], v0
buffer_load_dwordx4 v[12:15], v9, s[4:7], s37 offen offset:0
v_smfmac_f32_16x16x64_bf16 v[28:31], v[60:63], v[176:183], v0
buffer_load_dwordx4 v[16:19], v9, s[4:7], s37 offen offset:1024
v_smfmac_f32_16x16x64_bf16 v[40:43], v[60:63], a[56:63], v0
s_waitcnt lgkmcnt(2)
v_smfmac_f32_16x16x64_bf16 v[28:31], v[64:67], v[192:199], v0
ds_read_b128 v[48:51], v2 offset:3072
v_smfmac_f32_16x16x64_bf16 v[20:23], v[64:67], v[80:87], v0
ds_read_b128 v[44:47], v2 offset:2048
v_smfmac_f32_16x16x64_bf16 v[32:35], v[64:67], v[200:207], v0
buffer_load_dwordx4 v[52:55], v1, s[4:7], s37 offen offset:2048
v_bitop3_b32 v6, v60, v64, s35 bitop3:0x7e
s_waitcnt lgkmcnt(2)
v_bitop3_b32 v76, v68, v72, s35 bitop3:0x7e
v_bitop3_b32 v6, v6, v76, 1 bitop3:0xa8
v_smfmac_f32_16x16x64_bf16 v[24:27], v[64:67], v[88:95], v0
s_waitcnt lgkmcnt(0)
v_smfmac_f32_16x16x64_bf16 v[24:27], v[60:63], v[44:51], v0
buffer_load_dwordx4 v[56:59], v1, s[4:7], s37 offen offset:3072
v_smfmac_f32_16x16x64_bf16 v[40:43], v[64:67], a[72:79], v0
v_smfmac_f32_16x16x64_bf16 v[36:39], v[64:67], a[64:71], v0
ds_read_b128 v[44:47], v2 offset:4096
v_cmp_ne_u32 vcc, 0, v6
v_smfmac_f32_16x16x64_bf16 v[20:23], v[68:71], v[96:103], v0
ds_read_b128 v[48:51], v2 offset:5120
v_smfmac_f32_16x16x64_bf16 v[24:27], v[68:71], v[104:111], v0
s_cbranch_vccnz L_ra0_w0s
s_waitcnt vmcnt(4)
s_barrier
ds_read_b32 v6, v77 offset:8192
v_smfmac_f32_16x16x64_bf16 v[28:31], v[68:71], v[208:215], v0
s_mov_b32 m0, 0
ds_read_b128 v[60:63], v1 offset:6144
s_waitcnt lgkmcnt(2)
v_smfmac_f32_16x16x64_bf16 v[20:23], v[72:75], v[44:51], v0
buffer_load_dword v78, s[4:7], s39 offen lds
ds_read_b128 v[76:79], v1 offset:5120
v_smfmac_f32_16x16x64_bf16 v[28:31], v[72:75], v[224:231], v0
ds_read_b128 v[64:67], v1 offset:7168
ds_read_b128 v[44:47], v2 offset:6144
v_smfmac_f32_16x16x64_bf16 v[32:35], v[68:71], v[216:223], v0
v_smfmac_f32_16x16x64_bf16 v[36:39], v[68:71], a[80:87], v0
ds_read_b128 v[48:51], v2 offset:7168
s_waitcnt lgkmcnt(4)
v_bitop3_b32 v6, v6, v60, s35 bitop3:0x7e
v_smfmac_f32_16x16x64_bf16 v[40:43], v[68:71], a[88:95], v0
ds_read_b128 v[68:71], v1 offset:8192
v_smfmac_f32_16x16x64_bf16 v[32:35], v[72:75], v[232:239], v0
s_waitcnt lgkmcnt(3)
v_bitop3_b32 v6, v6, v64, s35 bitop3:0xf6
v_bitop3_b32 v6, v6, v76, s35 bitop3:0xf6
v_and_b32 v6, 1, v6
s_waitcnt lgkmcnt(1)
v_smfmac_f32_16x16x64_bf16 v[24:27], v[72:75], v[44:51], v0
ds_read_b128 v[44:47], v2 offset:8192
v_cmp_ne_u32 vcc, 0, v6
v_smfmac_f32_16x16x64_bf16 v[36:39], v[72:75], a[96:103], v0
ds_read_b128 v[48:51], v2 offset:9216
v_smfmac_f32_16x16x64_bf16 v[40:43], v[72:75], a[104:111], v0
ds_read_b128 v[72:75], v1 offset:9216
s_cbranch_vccnz L_ra1_w0s
L_a1_w0s:
v_smfmac_f32_16x16x64_bf16 v[20:23], v[60:63], v[112:119], v0
v_smfmac_f32_16x16x64_bf16 v[20:23], v[64:67], v[128:135], v0
s_waitcnt lgkmcnt(1)
v_smfmac_f32_16x16x64_bf16 v[20:23], v[76:79], v[44:51], v0
ds_read_b128 v[48:51], v2 offset:11264
v_bfe_u32 v6, v1, 5, 1
v_mad_i32_i24 v6, v6, s55, v1
v_smfmac_f32_16x16x64_bf16 v[20:23], v[68:71], v[144:151], v0
s_waitcnt lgkmcnt(1)
v_smfmac_f32_16x16x64_bf16 v[20:23], v[72:75], v[160:167], v0
ds_read_b128 v[44:47], v2 offset:10240
v_smfmac_f32_16x16x64_bf16 v[24:27], v[60:63], v[120:127], v0
v_smfmac_f32_16x16x64_bf16 v[24:27], v[64:67], v[136:143], v0
v_smfmac_f32_16x16x64_bf16 v[24:27], v[68:71], v[152:159], v0
v_add_f32 v21, v21, v23
v_smfmac_f32_16x16x64_bf16 v[24:27], v[72:75], v[168:175], v0
s_waitcnt lgkmcnt(0)
v_smfmac_f32_16x16x64_bf16 v[24:27], v[76:79], v[44:51], v0
ds_read_b128 v[44:47], v2 offset:12288
v_add_f32 v20, v20, v22
v_cvt_pk_bf16_f32 v22, v20, v21
v_smfmac_f32_16x16x64_bf16 v[28:31], v[76:79], v[240:247], v0
v_smfmac_f32_16x16x64_bf16 v[28:31], v[64:67], a[0:7], v0
ds_read_b128 v[48:51], v2 offset:13312
v_add_f32 v25, v25, v27
v_add_f32 v24, v24, v26
v_cvt_pk_bf16_f32 v23, v24, v25
v_smfmac_f32_16x16x64_bf16 v[28:31], v[72:75], a[32:39], v0
ds_write_b64 v3, v[22:23] offset:10240
v_smfmac_f32_16x16x64_bf16 v[28:31], v[68:71], a[16:23], v0
s_waitcnt vmcnt(1)
v_smfmac_f32_16x16x64_bf16 v[32:35], v[76:79], v[248:255], v0
s_waitcnt lgkmcnt(1)
v_smfmac_f32_16x16x64_bf16 v[28:31], v[60:63], v[44:51], v0
ds_read_b128 v[44:47], v2 offset:14336
ds_read_b128 v[48:51], v2 offset:15360
v_smfmac_f32_16x16x64_bf16 v[32:35], v[64:67], a[8:15], v0
s_waitcnt lgkmcnt(2)
s_barrier
ds_read_b64_tr_b16 v[20:21], v4 offset:10240
v_smfmac_f32_16x16x64_bf16 v[32:35], v[68:71], a[24:31], v0
ds_read_b64_tr_b16 v[22:23], v4 offset:10752
v_add_f32 v29, v29, v31
v_smfmac_f32_16x16x64_bf16 v[32:35], v[72:75], a[40:47], v0
ds_read_b64_tr_b16 v[24:25], v4 offset:11264
ds_read_b64_tr_b16 v[26:27], v4 offset:11776
s_waitcnt lgkmcnt(4)
v_smfmac_f32_16x16x64_bf16 v[32:35], v[60:63], v[44:51], v0
ds_read_b128 v[48:51], v2 offset:19456
s_waitcnt lgkmcnt(3)
v_mfma_f32_16x16x32_bf16 v[12:15], v[12:15], v[20:23], 0
ds_read_b128 v[44:47], v2 offset:18432
v_add_f32 v28, v28, v30
s_waitcnt lgkmcnt(2)
v_mfma_f32_16x16x32_bf16 v[12:15], v[16:19], v[24:27], v[12:15]
v_add_f32 v32, v32, v34
v_add_f32 v33, v33, v35
v_cvt_pk_bf16_f32 v31, v32, v33
v_cvt_pk_bf16_f32 v30, v28, v29
v_smfmac_f32_16x16x64_bf16 v[36:39], v[76:79], a[112:119], v0
ds_write_b64 v3, v[30:31] offset:12288
v_add_f32_dpp v12, v14, v12 quad_perm:[2,3,0,1] row_mask:0xf bank_mask:0xf
v_exp_f32 v14, v12
v_add_f32_dpp v13, v15, v13 quad_perm:[2,3,0,1] row_mask:0xf bank_mask:0xf
v_exp_f32 v15, v13
s_nop 0
v_cvt_pk_bf16_f32 v14, v14, v15
v_smfmac_f32_16x16x64_bf16 v[40:43], v[76:79], a[120:127], v0
ds_write_b32 v5, v14 offset:14368
s_waitcnt lgkmcnt(2)
v_smfmac_f32_16x16x64_bf16 v[40:43], v[72:75], v[44:51], v0
ds_read_b128 v[44:47], v2 offset:16384
s_waitcnt lgkmcnt(2)
s_barrier
ds_read_b64_tr_b16 v[28:29], v4 offset:12288
v_smfmac_f32_16x16x64_bf16 v[36:39], v[60:63], a[128:135], v0
ds_read_b64_tr_b16 v[30:31], v4 offset:12800
ds_read_b64_tr_b16 v[32:33], v4 offset:13312
v_smfmac_f32_16x16x64_bf16 v[40:43], v[60:63], a[136:143], v0
ds_read_b64_tr_b16 v[34:35], v4 offset:13824
v_mov_b64 v[76:77], s[52:53]
s_waitcnt lgkmcnt(2)
v_mfma_f32_16x16x32_bf16 v[28:31], v[28:31], v[20:23], 0
s_barrier
ds_read_b128 v[16:19], v1 offset:14368
s_waitcnt lgkmcnt(1)
v_mfma_f32_16x16x32_bf16 v[28:31], v[32:35], v[24:27], v[28:31]
ds_read_b128 v[60:63], v1 offset:14336
v_mov_b64 v[14:15], s[0:1]
v_smfmac_f32_16x16x64_bf16 v[40:43], v[64:67], a[152:159], v0
ds_read_b128 v[48:51], v2 offset:17408
v_mov_b64 v[78:79], s[52:53]
v_smfmac_f32_16x16x64_bf16 v[40:43], v[68:71], a[168:175], v0
v_add_f32_dpp v28, v30, v28 quad_perm:[2,3,0,1] row_mask:0xf bank_mask:0xf
v_smfmac_f32_16x16x64_bf16 v[36:39], v[64:67], a[144:151], v0
ds_read_b128 v[64:67], v2 offset:25600
v_add_f32_dpp v29, v31, v29 quad_perm:[2,3,0,1] row_mask:0xf bank_mask:0xf
s_waitcnt lgkmcnt(1)
v_smfmac_f32_16x16x64_bf16 v[36:39], v[72:75], v[44:51], v0
ds_read_b128 v[72:75], v2 offset:29696
v_mul_f32 v28, s50, v28
v_smfmac_f32_16x16x64_bf16 v[36:39], v[68:71], a[160:167], v0
ds_read_b128 v[68:71], v2 offset:28672
v_cvt_pk_bf16_f32 v40, v40, v41
v_mfma_f32_16x16x32_bf16 v[32:35], v[76:79], v[16:19], 0
v_exp_f32 v30, v28
ds_read_b128 v[44:47], v2 offset:20480
v_mfma_f32_16x16x32_bf16 v[20:23], v[52:55], v[16:19], 0
v_mul_f32 v29, s50, v29
v_cvt_pk_bf16_f32 v41, v42, v43
v_cvt_pk_bf16_f32 v43, v38, v39
v_mov_b64 v[76:77], 0
v_exp_f32 v31, v29
v_mfma_f32_16x16x32_bf16 v[20:23], v[56:59], v[60:63], v[20:23]
v_cvt_pk_bf16_f32 v30, v30, v31
v_cndmask_b32_e64 v26, 0, v30, s[56:57]
v_cndmask_b32_e64 v27, 0, v30, s[56:57]
s_nop 0
v_mov_b32_dpp v24, v26 quad_perm:[2,3,0,1] row_mask:0xf bank_mask:0xf
v_mfma_f32_16x16x16_bf16 v[32:35], v[14:15], v[26:27], v[32:35]
v_mov_b32_dpp v25, v26 quad_perm:[2,3,0,1] row_mask:0xf bank_mask:0xf
v_cvt_pk_bf16_f32 v42, v36, v37
s_nop 1
v_mfma_f32_16x16x32_bf16 v[20:23], v[40:43], v[24:27], v[20:23]
ds_read_b128 v[60:63], v2 offset:24576
ds_read_b128 v[48:51], v2 offset:21504
v_mov_b64 v[78:79], 0
v_rcp_f32 v33, v32
v_mov_b64 v[36:37], 0
v_min_f32 v32, v32, v33
v_cmp_nlt_f32 vcc, s2, v32
v_mul_f32_dpp v23, v33, v23 quad_perm:[0,1,0,1] row_mask:0xf bank_mask:0xf
v_mul_f32_dpp v21, v33, v21 quad_perm:[0,1,0,1] row_mask:0xf bank_mask:0xf
v_mul_f32_dpp v22, v33, v22 quad_perm:[0,1,0,1] row_mask:0xf bank_mask:0xf
v_mul_f32_dpp v20, v33, v20 quad_perm:[0,1,0,1] row_mask:0xf bank_mask:0xf
v_cvt_pk_bf16_f32 v20, v20, v21
v_cvt_pk_bf16_f32 v21, v22, v23
ds_write_b64 v6, v[20:21] offset:5120
s_and_b64 vcc, vcc, s[56:57]
s_cbranch_scc1 L_mx_w0s
L_mxb_w0s:
v_mov_b64 v[38:39], 0
v_mov_b32_dpp v19, v21 quad_perm:[2,3,2,3] row_mask:0xf bank_mask:0xf
v_mov_b32_dpp v16, v20 quad_perm:[0,1,0,1] row_mask:0xf bank_mask:0xf
v_mov_b32_dpp v18, v20 quad_perm:[2,3,2,3] row_mask:0xf bank_mask:0xf
v_mov_b32_dpp v17, v21 quad_perm:[0,1,0,1] row_mask:0xf bank_mask:0xf
v_mov_b64 v[24:25], 0
v_mov_b64 v[26:27], 0
v_smfmac_f32_16x16x64_bf16 v[76:79], v[16:19], a[176:183], v0
s_waitcnt lgkmcnt(0)
s_barrier
v_mov_b64 v[32:33], 0
ds_read_b128 v[12:15], v7 offset:7168
ds_read_b128 v[52:55], v7 offset:6144
v_smfmac_f32_16x16x64_bf16 v[36:39], v[16:19], v[44:51], v0
ds_read_b128 v[48:51], v2 offset:23552
ds_read_b128 v[56:59], v7 offset:8192
v_mov_b64 v[30:31], 0
v_mov_b64 v[34:35], 0
v_smfmac_f32_16x16x64_bf16 v[24:27], v[16:19], v[60:67], v0
ds_read_b128 v[44:47], v2 offset:22528
v_smfmac_f32_16x16x64_bf16 v[32:35], v[16:19], v[68:75], v0
ds_read_b128 v[68:71], v2 offset:30720
s_waitcnt lgkmcnt(5)
v_smfmac_f32_16x16x64_bf16 v[76:79], v[12:15], a[184:191], v0
ds_read_b128 v[60:63], v2 offset:26624
s_waitcnt lgkmcnt(5)
v_smfmac_f32_16x16x64_bf16 v[76:79], v[52:55], a[192:199], v0
ds_read_b128 v[64:67], v2 offset:27648
s_waitcnt lgkmcnt(4)
v_smfmac_f32_16x16x64_bf16 v[76:79], v[56:59], a[200:207], v0
v_mov_b64 v[28:29], 0
v_smfmac_f32_16x16x64_bf16 v[36:39], v[12:15], a[208:215], v0
ds_read_b128 v[72:75], v2 offset:31744
s_waitcnt lgkmcnt(4)
v_smfmac_f32_16x16x64_bf16 v[36:39], v[52:55], v[44:51], v0
ds_read_b128 v[44:47], v2 offset:32768
v_cvt_pk_bf16_f32 v77, v77, v79
v_cvt_pk_bf16_f32 v76, v76, v78
v_bfi_b32 v76, 1, s35, v76
v_smfmac_f32_16x16x64_bf16 v[36:39], v[56:59], a[216:223], v0
v_smfmac_f32_16x16x64_bf16 v[24:27], v[12:15], a[224:231], v0
buffer_store_dwordx2 v[76:77], v8, s[4:7], s42 offen sc0 sc1
s_waitcnt lgkmcnt(2)
v_smfmac_f32_16x16x64_bf16 v[24:27], v[52:55], v[60:67], v0
ds_read_b128 v[48:51], v2 offset:33792
ds_read_b128 v[60:63], v2 offset:36864
v_cvt_pk_bf16_f32 v36, v36, v38
v_bfi_b32 v36, 1, s35, v36
v_cvt_pk_bf16_f32 v37, v37, v39
v_smfmac_f32_16x16x64_bf16 v[24:27], v[56:59], a[232:239], v0
buffer_store_dwordx2 v[36:37], v8, s[4:7], s43 offen sc0 sc1
ds_read_b128 v[64:67], v2 offset:37888
v_smfmac_f32_16x16x64_bf16 v[32:35], v[12:15], a[240:247], v0
ds_read_b128 v[40:43], v2 offset:35840
s_waitcnt lgkmcnt(5)
v_smfmac_f32_16x16x64_bf16 v[32:35], v[52:55], v[68:75], v0
ds_read_b128 v[72:75], v2 offset:39936
ds_read_b128 v[36:39], v2 offset:34816
v_cvt_pk_bf16_f32 v25, v25, v27
v_cvt_pk_bf16_f32 v24, v24, v26
v_bfi_b32 v24, 1, s35, v24
buffer_store_dwordx2 v[24:25], v8, s[4:7], s44 offen sc0 sc1
v_smfmac_f32_16x16x64_bf16 v[32:35], v[56:59], a[248:255], v0
ds_read_b128 v[68:71], v2 offset:38912
s_waitcnt lgkmcnt(6)
v_smfmac_f32_16x16x64_bf16 v[28:31], v[16:19], v[44:51], v0
s_nop 3
v_cvt_pk_bf16_f32 v33, v33, v35
v_cvt_pk_bf16_f32 v32, v32, v34
v_bfi_b32 v32, 1, s35, v32
buffer_store_dwordx2 v[32:33], v8, s[4:7], s45 offen sc0 sc1
s_waitcnt lgkmcnt(1)
v_smfmac_f32_16x16x64_bf16 v[28:31], v[52:55], v[36:43], v0
v_smfmac_f32_16x16x64_bf16 v[28:31], v[12:15], v[60:67], v0
s_waitcnt lgkmcnt(0)
v_smfmac_f32_16x16x64_bf16 v[28:31], v[56:59], v[68:75], v0
s_nop 7
v_cvt_pk_bf16_f32 v28, v28, v30
v_bfi_b32 v28, 1, s35, v28
v_cvt_pk_bf16_f32 v29, v29, v31
buffer_store_dwordx2 v[28:29], v8, s[4:7], s46 offen sc0 sc1
s_branch L_ex_w0s
.p2align 6
L_ex_w0rs:
v_and_b32 v6, 0x70, v1
ds_read_b128 v[76:79], v6 offset:256
v_bfe_u32 v11, v1, 4, 2
v_lshrrev_b32_e64 v11, v11, 1
v_mov_b64 v[20:21], 0
v_mov_b64 v[22:23], 0
v_mov_b64 v[24:25], 0
v_mov_b64 v[26:27], 0
v_mov_b64 v[28:29], 0
v_mov_b64 v[30:31], 0
v_mov_b64 v[32:33], 0
v_mov_b64 v[34:35], 0
ds_read_b128 v[44:47], v2 offset:0
ds_read_b128 v[48:51], v2 offset:1024
s_add_u32 s34, s34, 1
s_not_b32 s35, s35
s_not_b32 s36, s36
s_barrier
s_waitcnt vmcnt(0)
s_add_u32 s37, s37, 524288
s_add_u32 s39, s39, 524288
s_mul_i32 s40, s34, 10240
s_add_u32 s40, s40, 8093696
buffer_load_dwordx4 v[60:63], v9, s[4:7], s3 offen offset:0 sc0 sc1
buffer_load_dwordx4 v[64:67], v9, s[4:7], s3 offen offset:1024 sc0 sc1
buffer_load_dwordx4 v[68:71], v9, s[4:7], s3 offen offset:2048 sc0 sc1
buffer_load_dwordx4 v[72:75], v9, s[4:7], s3 offen offset:3072 sc0 sc1
s_waitcnt lgkmcnt(2)
s_waitcnt vmcnt(3)
L_r_w0rs:
v_mfma_f32_16x16x32_bf16 v[36:39], v[60:63], v[76:79], 0
s_waitcnt vmcnt(2)
v_mfma_f32_16x16x32_bf16 v[36:39], v[64:67], v[76:79], v[36:39]
v_bitop3_b32 v40, v60, v64, s36 bitop3:0x7e
s_waitcnt vmcnt(1)
v_mfma_f32_16x16x32_bf16 v[36:39], v[68:71], v[76:79], v[36:39]
s_waitcnt vmcnt(0)
v_mfma_f32_16x16x32_bf16 v[36:39], v[72:75], v[76:79], v[36:39]
v_bitop3_b32 v41, v68, v72, s36 bitop3:0x7e
v_bitop3_b32 v40, v40, v41, 1 bitop3:0xa8
v_cmp_ne_u32 vcc, 0, v40
v_nop
v_nop
v_nop
v_nop
v_nop
v_pk_add_f32 v[36:37], v[36:37], v[38:39]
v_cvt_pk_bf16_f32 v40, v36, v37
v_bfi_b32 v40, v11, s35, v40
s_cbranch_vccnz L_rr_w0rs
buffer_store_dword v40, v10, s[4:7], 0 offen sc0 sc1
s_cmp_eq_u32 s34, 63
v_mov_b32 v11, v40
s_cbranch_scc1 L_done_w0rs
v_mov_b64 v[36:37], 0
v_mov_b64 v[38:39], 0
v_mov_b64 v[40:41], 0
v_mov_b64 v[42:43], 0
v_bfe_u32 v77, v1, 6, 1
v_lshl_add_u32 v77, v77, 3, v1
v_lshlrev_b32 v77, 1, v77
v_lshlrev_b32 v78, 3, v1
L_top_w0rs:
s_barrier
ds_read_b128 v[60:63], v1 offset:1024
s_mov_b32 m0, 5120
s_nop 0
buffer_load_dwordx4 v1, s[4:7], s48 offen offset:0 sc0 sc1 lds
s_barrier
ds_read_b128 v[64:67], v1 offset:2048
ds_read_b128 v[68:71], v1 offset:3072
ds_read_b128 v[72:75], v1 offset:4096
L_s0_w0rs:
s_waitcnt lgkmcnt(3)
v_smfmac_f32_16x16x64_bf16 v[32:35], v[60:63], v[184:191], v0
v_smfmac_f32_16x16x64_bf16 v[20:23], v[60:63], v[44:51], v0
v_smfmac_f32_16x16x64_bf16 v[36:39], v[60:63], a[48:55], v0
buffer_load_dwordx4 v[12:15], v9, s[4:7], s37 offen offset:0
v_smfmac_f32_16x16x64_bf16 v[28:31], v[60:63], v[176:183], v0
buffer_load_dwordx4 v[16:19], v9, s[4:7], s37 offen offset:1024
v_smfmac_f32_16x16x64_bf16 v[40:43], v[60:63], a[56:63], v0
s_waitcnt lgkmcnt(2)
v_smfmac_f32_16x16x64_bf16 v[28:31], v[64:67], v[192:199], v0
ds_read_b128 v[48:51], v2 offset:3072
v_smfmac_f32_16x16x64_bf16 v[20:23], v[64:67], v[80:87], v0
ds_read_b128 v[44:47], v2 offset:2048
v_smfmac_f32_16x16x64_bf16 v[32:35], v[64:67], v[200:207], v0
buffer_load_dwordx4 v[52:55], v1, s[4:7], s37 offen offset:2048
v_bitop3_b32 v6, v60, v64, s35 bitop3:0x7e
s_waitcnt lgkmcnt(2)
v_bitop3_b32 v76, v68, v72, s35 bitop3:0x7e
v_bitop3_b32 v6, v6, v76, 1 bitop3:0xa8
v_smfmac_f32_16x16x64_bf16 v[24:27], v[64:67], v[88:95], v0
s_waitcnt lgkmcnt(0)
v_smfmac_f32_16x16x64_bf16 v[24:27], v[60:63], v[44:51], v0
buffer_load_dwordx4 v[56:59], v1, s[4:7], s37 offen offset:3072
v_smfmac_f32_16x16x64_bf16 v[40:43], v[64:67], a[72:79], v0
v_smfmac_f32_16x16x64_bf16 v[36:39], v[64:67], a[64:71], v0
ds_read_b128 v[44:47], v2 offset:4096
v_cmp_ne_u32 vcc, 0, v6
v_smfmac_f32_16x16x64_bf16 v[20:23], v[68:71], v[96:103], v0
ds_read_b128 v[48:51], v2 offset:5120
v_smfmac_f32_16x16x64_bf16 v[24:27], v[68:71], v[104:111], v0
s_cbranch_vccnz L_ra0_w0rs
s_waitcnt vmcnt(4)
s_barrier
ds_read_b32 v6, v77 offset:8192
v_smfmac_f32_16x16x64_bf16 v[28:31], v[68:71], v[208:215], v0
s_mov_b32 m0, 0
ds_read_b128 v[60:63], v1 offset:6144
buffer_store_dword v11, v10, s[4:7], s40 offen sc0 sc1
s_waitcnt lgkmcnt(2)
v_smfmac_f32_16x16x64_bf16 v[20:23], v[72:75], v[44:51], v0
buffer_load_dword v78, s[4:7], s39 offen lds
ds_read_b128 v[76:79], v1 offset:5120
v_smfmac_f32_16x16x64_bf16 v[28:31], v[72:75], v[224:231], v0
ds_read_b128 v[64:67], v1 offset:7168
ds_read_b128 v[44:47], v2 offset:6144
v_smfmac_f32_16x16x64_bf16 v[32:35], v[68:71], v[216:223], v0
v_smfmac_f32_16x16x64_bf16 v[36:39], v[68:71], a[80:87], v0
ds_read_b128 v[48:51], v2 offset:7168
s_waitcnt lgkmcnt(4)
v_bitop3_b32 v6, v6, v60, s35 bitop3:0x7e
v_smfmac_f32_16x16x64_bf16 v[40:43], v[68:71], a[88:95], v0
ds_read_b128 v[68:71], v1 offset:8192
v_smfmac_f32_16x16x64_bf16 v[32:35], v[72:75], v[232:239], v0
s_waitcnt lgkmcnt(3)
v_bitop3_b32 v6, v6, v64, s35 bitop3:0xf6
v_bitop3_b32 v6, v6, v76, s35 bitop3:0xf6
v_and_b32 v6, 1, v6
s_waitcnt lgkmcnt(1)
v_smfmac_f32_16x16x64_bf16 v[24:27], v[72:75], v[44:51], v0
ds_read_b128 v[44:47], v2 offset:8192
v_cmp_ne_u32 vcc, 0, v6
v_smfmac_f32_16x16x64_bf16 v[36:39], v[72:75], a[96:103], v0
ds_read_b128 v[48:51], v2 offset:9216
v_smfmac_f32_16x16x64_bf16 v[40:43], v[72:75], a[104:111], v0
ds_read_b128 v[72:75], v1 offset:9216
s_cbranch_vccnz L_ra1_w0rs
L_a1_w0rs:
v_smfmac_f32_16x16x64_bf16 v[20:23], v[60:63], v[112:119], v0
v_smfmac_f32_16x16x64_bf16 v[20:23], v[64:67], v[128:135], v0
s_waitcnt lgkmcnt(1)
v_smfmac_f32_16x16x64_bf16 v[20:23], v[76:79], v[44:51], v0
ds_read_b128 v[48:51], v2 offset:11264
v_bfe_u32 v6, v1, 5, 1
v_mad_i32_i24 v6, v6, s55, v1
v_smfmac_f32_16x16x64_bf16 v[20:23], v[68:71], v[144:151], v0
s_waitcnt lgkmcnt(1)
v_smfmac_f32_16x16x64_bf16 v[20:23], v[72:75], v[160:167], v0
ds_read_b128 v[44:47], v2 offset:10240
v_smfmac_f32_16x16x64_bf16 v[24:27], v[60:63], v[120:127], v0
v_smfmac_f32_16x16x64_bf16 v[24:27], v[64:67], v[136:143], v0
v_smfmac_f32_16x16x64_bf16 v[24:27], v[68:71], v[152:159], v0
v_add_f32 v21, v21, v23
v_smfmac_f32_16x16x64_bf16 v[24:27], v[72:75], v[168:175], v0
s_waitcnt lgkmcnt(0)
v_smfmac_f32_16x16x64_bf16 v[24:27], v[76:79], v[44:51], v0
ds_read_b128 v[44:47], v2 offset:12288
v_add_f32 v20, v20, v22
v_cvt_pk_bf16_f32 v22, v20, v21
v_smfmac_f32_16x16x64_bf16 v[28:31], v[76:79], v[240:247], v0
v_smfmac_f32_16x16x64_bf16 v[28:31], v[64:67], a[0:7], v0
ds_read_b128 v[48:51], v2 offset:13312
v_add_f32 v25, v25, v27
v_add_f32 v24, v24, v26
v_cvt_pk_bf16_f32 v23, v24, v25
v_smfmac_f32_16x16x64_bf16 v[28:31], v[72:75], a[32:39], v0
ds_write_b64 v3, v[22:23] offset:10240
v_smfmac_f32_16x16x64_bf16 v[28:31], v[68:71], a[16:23], v0
s_waitcnt vmcnt(2)
v_smfmac_f32_16x16x64_bf16 v[32:35], v[76:79], v[248:255], v0
s_waitcnt lgkmcnt(1)
v_smfmac_f32_16x16x64_bf16 v[28:31], v[60:63], v[44:51], v0
ds_read_b128 v[44:47], v2 offset:14336
ds_read_b128 v[48:51], v2 offset:15360
v_smfmac_f32_16x16x64_bf16 v[32:35], v[64:67], a[8:15], v0
s_waitcnt lgkmcnt(2)
s_barrier
ds_read_b64_tr_b16 v[20:21], v4 offset:10240
v_smfmac_f32_16x16x64_bf16 v[32:35], v[68:71], a[24:31], v0
ds_read_b64_tr_b16 v[22:23], v4 offset:10752
v_add_f32 v29, v29, v31
v_smfmac_f32_16x16x64_bf16 v[32:35], v[72:75], a[40:47], v0
ds_read_b64_tr_b16 v[24:25], v4 offset:11264
ds_read_b64_tr_b16 v[26:27], v4 offset:11776
s_waitcnt lgkmcnt(4)
v_smfmac_f32_16x16x64_bf16 v[32:35], v[60:63], v[44:51], v0
ds_read_b128 v[48:51], v2 offset:19456
s_waitcnt lgkmcnt(3)
v_mfma_f32_16x16x32_bf16 v[12:15], v[12:15], v[20:23], 0
ds_read_b128 v[44:47], v2 offset:18432
v_add_f32 v28, v28, v30
s_waitcnt lgkmcnt(2)
v_mfma_f32_16x16x32_bf16 v[12:15], v[16:19], v[24:27], v[12:15]
v_add_f32 v32, v32, v34
v_add_f32 v33, v33, v35
v_cvt_pk_bf16_f32 v31, v32, v33
v_cvt_pk_bf16_f32 v30, v28, v29
v_smfmac_f32_16x16x64_bf16 v[36:39], v[76:79], a[112:119], v0
ds_write_b64 v3, v[30:31] offset:12288
v_add_f32_dpp v12, v14, v12 quad_perm:[2,3,0,1] row_mask:0xf bank_mask:0xf
v_exp_f32 v14, v12
v_add_f32_dpp v13, v15, v13 quad_perm:[2,3,0,1] row_mask:0xf bank_mask:0xf
v_exp_f32 v15, v13
s_nop 0
v_cvt_pk_bf16_f32 v14, v14, v15
v_smfmac_f32_16x16x64_bf16 v[40:43], v[76:79], a[120:127], v0
ds_write_b32 v5, v14 offset:14368
s_waitcnt lgkmcnt(2)
v_smfmac_f32_16x16x64_bf16 v[40:43], v[72:75], v[44:51], v0
ds_read_b128 v[44:47], v2 offset:16384
s_waitcnt lgkmcnt(2)
s_barrier
ds_read_b64_tr_b16 v[28:29], v4 offset:12288
v_smfmac_f32_16x16x64_bf16 v[36:39], v[60:63], a[128:135], v0
ds_read_b64_tr_b16 v[30:31], v4 offset:12800
ds_read_b64_tr_b16 v[32:33], v4 offset:13312
v_smfmac_f32_16x16x64_bf16 v[40:43], v[60:63], a[136:143], v0
ds_read_b64_tr_b16 v[34:35], v4 offset:13824
v_mov_b64 v[76:77], s[52:53]
s_waitcnt lgkmcnt(2)
v_mfma_f32_16x16x32_bf16 v[28:31], v[28:31], v[20:23], 0
s_barrier
ds_read_b128 v[16:19], v1 offset:14368
s_waitcnt lgkmcnt(1)
v_mfma_f32_16x16x32_bf16 v[28:31], v[32:35], v[24:27], v[28:31]
ds_read_b128 v[60:63], v1 offset:14336
v_mov_b64 v[14:15], s[0:1]
v_smfmac_f32_16x16x64_bf16 v[40:43], v[64:67], a[152:159], v0
ds_read_b128 v[48:51], v2 offset:17408
v_mov_b64 v[78:79], s[52:53]
v_smfmac_f32_16x16x64_bf16 v[40:43], v[68:71], a[168:175], v0
v_add_f32_dpp v28, v30, v28 quad_perm:[2,3,0,1] row_mask:0xf bank_mask:0xf
v_smfmac_f32_16x16x64_bf16 v[36:39], v[64:67], a[144:151], v0
ds_read_b128 v[64:67], v2 offset:25600
v_add_f32_dpp v29, v31, v29 quad_perm:[2,3,0,1] row_mask:0xf bank_mask:0xf
s_waitcnt lgkmcnt(1)
v_smfmac_f32_16x16x64_bf16 v[36:39], v[72:75], v[44:51], v0
ds_read_b128 v[72:75], v2 offset:29696
v_mul_f32 v28, s50, v28
v_smfmac_f32_16x16x64_bf16 v[36:39], v[68:71], a[160:167], v0
ds_read_b128 v[68:71], v2 offset:28672
v_cvt_pk_bf16_f32 v40, v40, v41
v_mfma_f32_16x16x32_bf16 v[32:35], v[76:79], v[16:19], 0
v_exp_f32 v30, v28
ds_read_b128 v[44:47], v2 offset:20480
v_mfma_f32_16x16x32_bf16 v[20:23], v[52:55], v[16:19], 0
v_mul_f32 v29, s50, v29
v_cvt_pk_bf16_f32 v41, v42, v43
v_cvt_pk_bf16_f32 v43, v38, v39
v_mov_b64 v[76:77], 0
v_exp_f32 v31, v29
v_mfma_f32_16x16x32_bf16 v[20:23], v[56:59], v[60:63], v[20:23]
v_cvt_pk_bf16_f32 v30, v30, v31
v_cndmask_b32_e64 v26, 0, v30, s[56:57]
v_cndmask_b32_e64 v27, 0, v30, s[56:57]
s_nop 0
v_mov_b32_dpp v24, v26 quad_perm:[2,3,0,1] row_mask:0xf bank_mask:0xf
v_mfma_f32_16x16x16_bf16 v[32:35], v[14:15], v[26:27], v[32:35]
v_mov_b32_dpp v25, v26 quad_perm:[2,3,0,1] row_mask:0xf bank_mask:0xf
v_cvt_pk_bf16_f32 v42, v36, v37
s_nop 1
v_mfma_f32_16x16x32_bf16 v[20:23], v[40:43], v[24:27], v[20:23]
ds_read_b128 v[60:63], v2 offset:24576
ds_read_b128 v[48:51], v2 offset:21504
v_mov_b64 v[78:79], 0
v_rcp_f32 v33, v32
v_mov_b64 v[36:37], 0
v_min_f32 v32, v32, v33
v_cmp_nlt_f32 vcc, s2, v32
v_mul_f32_dpp v23, v33, v23 quad_perm:[0,1,0,1] row_mask:0xf bank_mask:0xf
v_mul_f32_dpp v21, v33, v21 quad_perm:[0,1,0,1] row_mask:0xf bank_mask:0xf
v_mul_f32_dpp v22, v33, v22 quad_perm:[0,1,0,1] row_mask:0xf bank_mask:0xf
v_mul_f32_dpp v20, v33, v20 quad_perm:[0,1,0,1] row_mask:0xf bank_mask:0xf
v_cvt_pk_bf16_f32 v20, v20, v21
v_cvt_pk_bf16_f32 v21, v22, v23
ds_write_b64 v6, v[20:21] offset:5120
s_and_b64 vcc, vcc, s[56:57]
s_cbranch_scc1 L_mx_w0rs
L_mxb_w0rs:
v_mov_b64 v[38:39], 0
v_mov_b32_dpp v19, v21 quad_perm:[2,3,2,3] row_mask:0xf bank_mask:0xf
v_mov_b32_dpp v16, v20 quad_perm:[0,1,0,1] row_mask:0xf bank_mask:0xf
v_mov_b32_dpp v18, v20 quad_perm:[2,3,2,3] row_mask:0xf bank_mask:0xf
v_mov_b32_dpp v17, v21 quad_perm:[0,1,0,1] row_mask:0xf bank_mask:0xf
v_mov_b64 v[24:25], 0
v_mov_b64 v[26:27], 0
v_smfmac_f32_16x16x64_bf16 v[76:79], v[16:19], a[176:183], v0
s_waitcnt lgkmcnt(0)
s_barrier
v_mov_b64 v[32:33], 0
ds_read_b128 v[12:15], v7 offset:7168
ds_read_b128 v[52:55], v7 offset:6144
v_smfmac_f32_16x16x64_bf16 v[36:39], v[16:19], v[44:51], v0
ds_read_b128 v[48:51], v2 offset:23552
ds_read_b128 v[56:59], v7 offset:8192
v_mov_b64 v[30:31], 0
v_mov_b64 v[34:35], 0
v_smfmac_f32_16x16x64_bf16 v[24:27], v[16:19], v[60:67], v0
ds_read_b128 v[44:47], v2 offset:22528
v_smfmac_f32_16x16x64_bf16 v[32:35], v[16:19], v[68:75], v0
ds_read_b128 v[68:71], v2 offset:30720
s_waitcnt lgkmcnt(5)
v_smfmac_f32_16x16x64_bf16 v[76:79], v[12:15], a[184:191], v0
ds_read_b128 v[60:63], v2 offset:26624
s_waitcnt lgkmcnt(5)
v_smfmac_f32_16x16x64_bf16 v[76:79], v[52:55], a[192:199], v0
ds_read_b128 v[64:67], v2 offset:27648
s_waitcnt lgkmcnt(4)
v_smfmac_f32_16x16x64_bf16 v[76:79], v[56:59], a[200:207], v0
v_mov_b64 v[28:29], 0
v_smfmac_f32_16x16x64_bf16 v[36:39], v[12:15], a[208:215], v0
ds_read_b128 v[72:75], v2 offset:31744
s_waitcnt lgkmcnt(4)
v_smfmac_f32_16x16x64_bf16 v[36:39], v[52:55], v[44:51], v0
ds_read_b128 v[44:47], v2 offset:32768
v_cvt_pk_bf16_f32 v77, v77, v79
v_cvt_pk_bf16_f32 v76, v76, v78
v_bfi_b32 v76, 1, s35, v76
v_smfmac_f32_16x16x64_bf16 v[36:39], v[56:59], a[216:223], v0
v_smfmac_f32_16x16x64_bf16 v[24:27], v[12:15], a[224:231], v0
buffer_store_dwordx2 v[76:77], v8, s[4:7], s42 offen sc0 sc1
s_waitcnt lgkmcnt(2)
v_smfmac_f32_16x16x64_bf16 v[24:27], v[52:55], v[60:67], v0
ds_read_b128 v[48:51], v2 offset:33792
ds_read_b128 v[60:63], v2 offset:36864
v_cvt_pk_bf16_f32 v36, v36, v38
v_bfi_b32 v36, 1, s35, v36
v_cvt_pk_bf16_f32 v37, v37, v39
v_smfmac_f32_16x16x64_bf16 v[24:27], v[56:59], a[232:239], v0
buffer_store_dwordx2 v[36:37], v8, s[4:7], s43 offen sc0 sc1
ds_read_b128 v[64:67], v2 offset:37888
v_smfmac_f32_16x16x64_bf16 v[32:35], v[12:15], a[240:247], v0
ds_read_b128 v[40:43], v2 offset:35840
s_waitcnt lgkmcnt(5)
v_smfmac_f32_16x16x64_bf16 v[32:35], v[52:55], v[68:75], v0
ds_read_b128 v[72:75], v2 offset:39936
ds_read_b128 v[36:39], v2 offset:34816
v_cvt_pk_bf16_f32 v25, v25, v27
v_cvt_pk_bf16_f32 v24, v24, v26
v_bfi_b32 v24, 1, s35, v24
buffer_store_dwordx2 v[24:25], v8, s[4:7], s44 offen sc0 sc1
v_smfmac_f32_16x16x64_bf16 v[32:35], v[56:59], a[248:255], v0
ds_read_b128 v[68:71], v2 offset:38912
s_waitcnt lgkmcnt(6)
v_smfmac_f32_16x16x64_bf16 v[28:31], v[16:19], v[44:51], v0
s_nop 3
v_cvt_pk_bf16_f32 v33, v33, v35
v_cvt_pk_bf16_f32 v32, v32, v34
v_bfi_b32 v32, 1, s35, v32
buffer_store_dwordx2 v[32:33], v8, s[4:7], s45 offen sc0 sc1
s_waitcnt lgkmcnt(1)
v_smfmac_f32_16x16x64_bf16 v[28:31], v[52:55], v[36:43], v0
v_smfmac_f32_16x16x64_bf16 v[28:31], v[12:15], v[60:67], v0
s_waitcnt lgkmcnt(0)
v_smfmac_f32_16x16x64_bf16 v[28:31], v[56:59], v[68:75], v0
s_nop 7
v_cvt_pk_bf16_f32 v28, v28, v30
v_bfi_b32 v28, 1, s35, v28
v_cvt_pk_bf16_f32 v29, v29, v31
buffer_store_dwordx2 v[28:29], v8, s[4:7], s46 offen sc0 sc1
s_branch L_ex_w0rs
.p2align 6
L_ex_w1rs:
v_and_b32 v6, 0x70, v1
ds_read_b128 v[76:79], v6 offset:256
v_bfe_u32 v11, v1, 4, 2
v_lshrrev_b32_e64 v11, v11, 1
v_mov_b64 v[20:21], 0
v_mov_b64 v[22:23], 0
v_mov_b64 v[24:25], 0
v_mov_b64 v[26:27], 0
v_mov_b64 v[28:29], 0
v_mov_b64 v[30:31], 0
v_mov_b64 v[32:33], 0
v_mov_b64 v[34:35], 0
ds_read_b128 v[44:47], v2 offset:0
ds_read_b128 v[48:51], v2 offset:1024
s_add_u32 s34, s34, 1
s_not_b32 s35, s35
s_not_b32 s36, s36
s_add_u32 s37, s37, 524288
s_mul_i32 s40, s34, 10240
s_add_u32 s40, s40, 8093696
s_barrier
s_waitcnt vmcnt(0)
buffer_load_dwordx4 v[60:63], v9, s[4:7], s3 offen offset:0 sc0 sc1
buffer_load_dwordx4 v[64:67], v9, s[4:7], s3 offen offset:1024 sc0 sc1
buffer_load_dwordx4 v[68:71], v9, s[4:7], s3 offen offset:2048 sc0 sc1
buffer_load_dwordx4 v[72:75], v9, s[4:7], s3 offen offset:3072 sc0 sc1
s_waitcnt lgkmcnt(2)
s_waitcnt vmcnt(3)
L_r_w1rs:
v_mfma_f32_16x16x32_bf16 v[36:39], v[60:63], v[76:79], 0
s_waitcnt vmcnt(2)
v_mfma_f32_16x16x32_bf16 v[36:39], v[64:67], v[76:79], v[36:39]
v_bitop3_b32 v40, v60, v64, s36 bitop3:0x7e
s_waitcnt vmcnt(1)
v_mfma_f32_16x16x32_bf16 v[36:39], v[68:71], v[76:79], v[36:39]
s_waitcnt vmcnt(0)
v_mfma_f32_16x16x32_bf16 v[36:39], v[72:75], v[76:79], v[36:39]
v_bitop3_b32 v41, v68, v72, s36 bitop3:0x7e
v_bitop3_b32 v40, v40, v41, 1 bitop3:0xa8
v_cmp_ne_u32 vcc, 0, v40
v_nop
v_nop
v_nop
v_nop
v_nop
v_pk_add_f32 v[36:37], v[36:37], v[38:39]
v_cvt_pk_bf16_f32 v40, v36, v37
v_bfi_b32 v40, v11, s35, v40
s_cbranch_vccnz L_rr_w1rs
buffer_store_dword v40, v10, s[4:7], 0 offen sc0 sc1
s_cmp_eq_u32 s34, 63
v_mov_b32 v11, v40
s_cbranch_scc1 L_done_w1rs
v_mov_b64 v[36:37], 0
v_mov_b64 v[38:39], 0
v_mov_b64 v[40:41], 0
v_mov_b64 v[42:43], 0
v_bfe_u32 v77, v1, 6, 1
v_lshl_add_u32 v77, v77, 3, v1
v_lshlrev_b32 v77, 1, v77
v_lshlrev_b32 v78, 3, v1
L_top_w1rs:
s_barrier
ds_read_b128 v[60:63], v1 offset:1024
s_mov_b32 m0, 5120
s_nop 0
buffer_load_dwordx4 v1, s[4:7], s48 offen offset:1024 sc0 sc1 lds
s_barrier
ds_read_b128 v[64:67], v1 offset:2048
ds_read_b128 v[68:71], v1 offset:3072
ds_read_b128 v[72:75], v1 offset:4096
L_s0_w1rs:
s_waitcnt lgkmcnt(3)
v_smfmac_f32_16x16x64_bf16 v[32:35], v[60:63], v[184:191], v0
v_smfmac_f32_16x16x64_bf16 v[20:23], v[60:63], v[44:51], v0
v_smfmac_f32_16x16x64_bf16 v[36:39], v[60:63], a[48:55], v0
s_waitcnt lgkmcnt(2)
v_smfmac_f32_16x16x64_bf16 v[28:31], v[64:67], v[192:199], v0
v_smfmac_f32_16x16x64_bf16 v[28:31], v[60:63], v[176:183], v0
buffer_load_dwordx4 v[12:15], v9, s[4:7], s37 offen offset:0
ds_read_b128 v[48:51], v2 offset:3072
ds_read_b128 v[44:47], v2 offset:2048
v_smfmac_f32_16x16x64_bf16 v[20:23], v[64:67], v[80:87], v0
buffer_load_dwordx4 v[16:19], v9, s[4:7], s37 offen offset:1024
v_smfmac_f32_16x16x64_bf16 v[32:35], v[64:67], v[200:207], v0
v_smfmac_f32_16x16x64_bf16 v[40:43], v[60:63], a[56:63], v0
v_bitop3_b32 v6, v60, v64, s35 bitop3:0x7e
v_smfmac_f32_16x16x64_bf16 v[24:27], v[64:67], v[88:95], v0
buffer_load_dwordx4 v[52:55], v1, s[4:7], s37 offen offset:2048
s_waitcnt lgkmcnt(0)
v_smfmac_f32_16x16x64_bf16 v[24:27], v[60:63], v[44:51], v0
v_bitop3_b32 v76, v68, v72, s35 bitop3:0x7e
v_smfmac_f32_16x16x64_bf16 v[36:39], v[64:67], a[64:71], v0
v_bitop3_b32 v6, v6, v76, 1 bitop3:0xa8
v_smfmac_f32_16x16x64_bf16 v[40:43], v[64:67], a[72:79], v0
buffer_load_dwordx4 v[56:59], v1, s[4:7], s37 offen offset:3072
ds_read_b128 v[44:47], v2 offset:4096
v_cmp_ne_u32 vcc, 0, v6
v_smfmac_f32_16x16x64_bf16 v[20:23], v[68:71], v[96:103], v0
ds_read_b128 v[48:51], v2 offset:5120
v_smfmac_f32_16x16x64_bf16 v[24:27], v[68:71], v[104:111], v0
s_cbranch_vccnz L_ra0_w1rs
s_waitcnt vmcnt(4)
s_barrier
ds_read_b32 v6, v77 offset:8192
v_smfmac_f32_16x16x64_bf16 v[28:31], v[68:71], v[208:215], v0
ds_read_b128 v[60:63], v1 offset:6144
s_waitcnt lgkmcnt(2)
v_smfmac_f32_16x16x64_bf16 v[20:23], v[72:75], v[44:51], v0
ds_read_b128 v[76:79], v1 offset:5120
ds_read_b128 v[44:47], v2 offset:6144
buffer_store_dword v11, v10, s[4:7], s40 offen sc0 sc1
v_smfmac_f32_16x16x64_bf16 v[28:31], v[72:75], v[224:231], v0
ds_read_b128 v[64:67], v1 offset:7168
v_smfmac_f32_16x16x64_bf16 v[36:39], v[68:71], a[80:87], v0
v_smfmac_f32_16x16x64_bf16 v[32:35], v[68:71], v[216:223], v0
ds_read_b128 v[48:51], v2 offset:7168
s_waitcnt lgkmcnt(4)
v_bitop3_b32 v6, v6, v60, s35 bitop3:0x7e
v_smfmac_f32_16x16x64_bf16 v[40:43], v[68:71], a[88:95], v0
ds_read_b128 v[68:71], v1 offset:8192
v_smfmac_f32_16x16x64_bf16 v[32:35], v[72:75], v[232:239], v0
s_waitcnt lgkmcnt(2)
v_bitop3_b32 v6, v6, v64, s35 bitop3:0xf6
v_bitop3_b32 v6, v6, v76, s35 bitop3:0xf6
v_and_b32 v6, 1, v6
s_waitcnt lgkmcnt(1)
v_smfmac_f32_16x16x64_bf16 v[24:27], v[72:75], v[44:51], v0
ds_read_b128 v[44:47], v2 offset:8192
v_cmp_ne_u32 vcc, 0, v6
v_smfmac_f32_16x16x64_bf16 v[36:39], v[72:75], a[96:103], v0
ds_read_b128 v[48:51], v2 offset:9216
v_smfmac_f32_16x16x64_bf16 v[40:43], v[72:75], a[104:111], v0
ds_read_b128 v[72:75], v1 offset:9216
s_cbranch_vccnz L_ra1_w1rs
L_a1_w1rs:
v_smfmac_f32_16x16x64_bf16 v[20:23], v[60:63], v[112:119], v0
v_smfmac_f32_16x16x64_bf16 v[20:23], v[64:67], v[128:135], v0
s_waitcnt lgkmcnt(1)
v_smfmac_f32_16x16x64_bf16 v[20:23], v[76:79], v[44:51], v0
ds_read_b128 v[48:51], v2 offset:11264
s_waitcnt lgkmcnt(1)
v_smfmac_f32_16x16x64_bf16 v[20:23], v[72:75], v[160:167], v0
v_bfe_u32 v6, v1, 5, 1
v_mad_i32_i24 v6, v6, s55, v1
v_smfmac_f32_16x16x64_bf16 v[20:23], v[68:71], v[144:151], v0
ds_read_b128 v[44:47], v2 offset:10240
v_smfmac_f32_16x16x64_bf16 v[24:27], v[60:63], v[120:127], v0
v_smfmac_f32_16x16x64_bf16 v[24:27], v[64:67], v[136:143], v0
v_smfmac_f32_16x16x64_bf16 v[24:27], v[68:71], v[152:159], v0
v_add_f32 v21, v21, v23
v_smfmac_f32_16x16x64_bf16 v[24:27], v[72:75], v[168:175], v0
s_waitcnt lgkmcnt(0)
v_smfmac_f32_16x16x64_bf16 v[24:27], v[76:79], v[44:51], v0
ds_read_b128 v[44:47], v2 offset:12288
v_add_f32 v20, v20, v22
v_cvt_pk_bf16_f32 v22, v20, v21
v_smfmac_f32_16x16x64_bf16 v[28:31], v[76:79], v[240:247], v0
ds_read_b128 v[48:51], v2 offset:13312
v_smfmac_f32_16x16x64_bf16 v[28:31], v[64:67], a[0:7], v0
v_add_f32 v25, v25, v27
v_add_f32 v24, v24, v26
v_cvt_pk_bf16_f32 v23, v24, v25
v_smfmac_f32_16x16x64_bf16 v[28:31], v[72:75], a[32:39], v0
ds_write_b64 v3, v[22:23] offset:10752
v_smfmac_f32_16x16x64_bf16 v[28:31], v[68:71], a[16:23], v0
v_smfmac_f32_16x16x64_bf16 v[32:35], v[76:79], v[248:255], v0
s_waitcnt vmcnt(1)
s_waitcnt lgkmcnt(1)
v_smfmac_f32_16x16x64_bf16 v[28:31], v[60:63], v[44:51], v0
ds_read_b128 v[44:47], v2 offset:14336
ds_read_b128 v[48:51], v2 offset:15360
v_smfmac_f32_16x16x64_bf16 v[32:35], v[64:67], a[8:15], v0
s_waitcnt lgkmcnt(2)
s_barrier
v_smfmac_f32_16x16x64_bf16 v[32:35], v[68:71], a[24:31], v0
ds_read_b64_tr_b16 v[20:21], v4 offset:10240
ds_read_b64_tr_b16 v[22:23], v4 offset:10752
v_add_f32 v29, v29, v31
v_smfmac_f32_16x16x64_bf16 v[32:35], v[72:75], a[40:47], v0
ds_read_b64_tr_b16 v[24:25], v4 offset:11264
ds_read_b64_tr_b16 v[26:27], v4 offset:11776
s_waitcnt lgkmcnt(4)
v_smfmac_f32_16x16x64_bf16 v[32:35], v[60:63], v[44:51], v0
ds_read_b128 v[48:51], v2 offset:19456
s_waitcnt lgkmcnt(3)
v_mfma_f32_16x16x32_bf16 v[12:15], v[12:15], v[20:23], 0
ds_read_b128 v[44:47], v2 offset:18432
v_add_f32 v28, v28, v30
s_waitcnt lgkmcnt(2)
v_mfma_f32_16x16x32_bf16 v[12:15], v[16:19], v[24:27], v[12:15]
v_add_f32 v32, v32, v34
v_add_f32 v33, v33, v35
v_cvt_pk_bf16_f32 v30, v28, v29
v_cvt_pk_bf16_f32 v31, v32, v33
v_smfmac_f32_16x16x64_bf16 v[36:39], v[76:79], a[112:119], v0
ds_write_b64 v3, v[30:31] offset:12800
v_add_f32_dpp v12, v14, v12 quad_perm:[2,3,0,1] row_mask:0xf bank_mask:0xf
v_exp_f32 v14, v12
v_add_f32_dpp v13, v15, v13 quad_perm:[2,3,0,1] row_mask:0xf bank_mask:0xf
v_exp_f32 v15, v13
s_nop 0
v_cvt_pk_bf16_f32 v14, v14, v15
v_smfmac_f32_16x16x64_bf16 v[40:43], v[76:79], a[120:127], v0
ds_write_b32 v5, v14 offset:14624
s_waitcnt lgkmcnt(1)
s_barrier
ds_read_b64_tr_b16 v[28:29], v4 offset:12288
v_smfmac_f32_16x16x64_bf16 v[36:39], v[60:63], a[128:135], v0
ds_read_b64_tr_b16 v[30:31], v4 offset:12800
ds_read_b64_tr_b16 v[32:33], v4 offset:13312
v_smfmac_f32_16x16x64_bf16 v[40:43], v[60:63], a[136:143], v0
ds_read_b64_tr_b16 v[34:35], v4 offset:13824
v_mov_b64 v[76:77], s[52:53]
v_smfmac_f32_16x16x64_bf16 v[40:43], v[72:75], v[44:51], v0
ds_read_b128 v[44:47], v2 offset:16384
s_waitcnt lgkmcnt(3)
v_mfma_f32_16x16x32_bf16 v[28:31], v[28:31], v[20:23], 0
s_barrier
ds_read_b128 v[16:19], v1 offset:14368
s_waitcnt lgkmcnt(2)
v_mfma_f32_16x16x32_bf16 v[28:31], v[32:35], v[24:27], v[28:31]
ds_read_b128 v[60:63], v1 offset:14336
v_mov_b64 v[14:15], s[0:1]
v_smfmac_f32_16x16x64_bf16 v[40:43], v[64:67], a[152:159], v0
ds_read_b128 v[48:51], v2 offset:17408
v_mov_b64 v[78:79], s[52:53]
v_smfmac_f32_16x16x64_bf16 v[40:43], v[68:71], a[168:175], v0
v_add_f32_dpp v28, v30, v28 quad_perm:[2,3,0,1] row_mask:0xf bank_mask:0xf
v_smfmac_f32_16x16x64_bf16 v[36:39], v[64:67], a[144:151], v0
ds_read_b128 v[64:67], v2 offset:27648
v_mul_f32 v28, s50, v28
v_add_f32_dpp v29, v31, v29 quad_perm:[2,3,0,1] row_mask:0xf bank_mask:0xf
v_smfmac_f32_16x16x64_bf16 v[36:39], v[68:71], a[160:167], v0
ds_read_b128 v[68:71], v2 offset:30720
s_waitcnt lgkmcnt(2)
v_smfmac_f32_16x16x64_bf16 v[36:39], v[72:75], v[44:51], v0
ds_read_b128 v[72:75], v2 offset:31744
v_mul_f32 v29, s50, v29
v_cvt_pk_bf16_f32 v40, v40, v41
v_mfma_f32_16x16x32_bf16 v[32:35], v[76:79], v[16:19], 0
v_exp_f32 v30, v28
ds_read_b128 v[44:47], v2 offset:22528
v_mfma_f32_16x16x32_bf16 v[20:23], v[52:55], v[16:19], 0
v_exp_f32 v31, v29
v_mov_b64 v[76:77], 0
v_mfma_f32_16x16x32_bf16 v[20:23], v[56:59], v[60:63], v[20:23]
v_cvt_pk_bf16_f32 v41, v42, v43
v_cvt_pk_bf16_f32 v43, v38, v39
v_cvt_pk_bf16_f32 v30, v30, v31
v_cndmask_b32_e64 v26, 0, v30, s[56:57]
v_cndmask_b32_e64 v27, 0, v30, s[56:57]
s_nop 0
v_mov_b32_dpp v24, v26 quad_perm:[2,3,0,1] row_mask:0xf bank_mask:0xf
v_mfma_f32_16x16x16_bf16 v[32:35], v[14:15], v[26:27], v[32:35]
v_cvt_pk_bf16_f32 v42, v36, v37
v_mov_b32_dpp v25, v26 quad_perm:[2,3,0,1] row_mask:0xf bank_mask:0xf
s_nop 1
v_mfma_f32_16x16x32_bf16 v[20:23], v[40:43], v[24:27], v[20:23]
ds_read_b128 v[48:51], v2 offset:23552
ds_read_b128 v[60:63], v2 offset:26624
v_mov_b64 v[78:79], 0
v_rcp_f32 v33, v32
v_mov_b64 v[36:37], 0
v_min_f32 v32, v32, v33
v_cmp_nlt_f32 vcc, s2, v32
v_mul_f32_dpp v23, v33, v23 quad_perm:[0,1,0,1] row_mask:0xf bank_mask:0xf
v_mul_f32_dpp v21, v33, v21 quad_perm:[0,1,0,1] row_mask:0xf bank_mask:0xf
v_mul_f32_dpp v22, v33, v22 quad_perm:[0,1,0,1] row_mask:0xf bank_mask:0xf
v_mul_f32_dpp v20, v33, v20 quad_perm:[0,1,0,1] row_mask:0xf bank_mask:0xf
v_cvt_pk_bf16_f32 v20, v20, v21
v_cvt_pk_bf16_f32 v21, v22, v23
ds_write_b64 v6, v[20:21] offset:6144
s_and_b64 vcc, vcc, s[56:57]
v_mov_b32_dpp v19, v21 quad_perm:[2,3,2,3] row_mask:0xf bank_mask:0xf
s_cbranch_scc1 L_mx_w1rs
L_mxb_w1rs:
v_mov_b32_dpp v16, v20 quad_perm:[0,1,0,1] row_mask:0xf bank_mask:0xf
v_mov_b32_dpp v17, v21 quad_perm:[0,1,0,1] row_mask:0xf bank_mask:0xf
v_mov_b64 v[38:39], 0
v_mov_b32_dpp v18, v20 quad_perm:[2,3,2,3] row_mask:0xf bank_mask:0xf
v_mov_b64 v[26:27], 0
v_mov_b64 v[24:25], 0
v_smfmac_f32_16x16x64_bf16 v[76:79], v[16:19], a[176:183], v0
s_waitcnt lgkmcnt(0)
s_barrier
ds_read_b128 v[12:15], v7 offset:8192
v_mov_b64 v[32:33], 0
ds_read_b128 v[52:55], v7 offset:5120
v_smfmac_f32_16x16x64_bf16 v[36:39], v[16:19], v[44:51], v0
ds_read_b128 v[48:51], v2 offset:21504
ds_read_b128 v[44:47], v2 offset:20480
ds_read_b128 v[56:59], v7 offset:7168
v_mov_b64 v[30:31], 0
v_mov_b64 v[34:35], 0
v_smfmac_f32_16x16x64_bf16 v[24:27], v[16:19], v[60:67], v0
v_smfmac_f32_16x16x64_bf16 v[32:35], v[16:19], v[68:75], v0
ds_read_b128 v[68:71], v2 offset:28672
s_waitcnt lgkmcnt(5)
v_smfmac_f32_16x16x64_bf16 v[76:79], v[12:15], a[184:191], v0
ds_read_b128 v[60:63], v2 offset:24576
s_waitcnt lgkmcnt(5)
v_smfmac_f32_16x16x64_bf16 v[76:79], v[52:55], a[192:199], v0
ds_read_b128 v[64:67], v2 offset:25600
s_waitcnt lgkmcnt(3)
v_smfmac_f32_16x16x64_bf16 v[76:79], v[56:59], a[200:207], v0
v_mov_b64 v[28:29], 0
v_smfmac_f32_16x16x64_bf16 v[36:39], v[12:15], a[208:215], v0
ds_read_b128 v[72:75], v2 offset:29696
v_smfmac_f32_16x16x64_bf16 v[36:39], v[52:55], v[44:51], v0
ds_read_b128 v[44:47], v2 offset:34816
v_cvt_pk_bf16_f32 v77, v77, v79
v_cvt_pk_bf16_f32 v76, v76, v78
v_bfi_b32 v76, 1, s35, v76
v_smfmac_f32_16x16x64_bf16 v[36:39], v[56:59], a[216:223], v0
buffer_store_dwordx2 v[76:77], v8, s[4:7], s42 offen sc0 sc1
ds_read_b128 v[48:51], v2 offset:35840
v_smfmac_f32_16x16x64_bf16 v[24:27], v[12:15], a[224:231], v0
s_waitcnt lgkmcnt(3)
v_smfmac_f32_16x16x64_bf16 v[24:27], v[52:55], v[60:67], v0
ds_read_b128 v[60:63], v2 offset:38912
v_cvt_pk_bf16_f32 v37, v37, v39
v_cvt_pk_bf16_f32 v36, v36, v38
v_bfi_b32 v36, 1, s35, v36
v_smfmac_f32_16x16x64_bf16 v[24:27], v[56:59], a[232:239], v0
buffer_store_dwordx2 v[36:37], v8, s[4:7], s43 offen sc0 sc1
ds_read_b128 v[64:67], v2 offset:39936
ds_read_b128 v[40:43], v2 offset:33792
v_smfmac_f32_16x16x64_bf16 v[32:35], v[12:15], a[240:247], v0
s_waitcnt lgkmcnt(5)
v_smfmac_f32_16x16x64_bf16 v[32:35], v[52:55], v[68:75], v0
ds_read_b128 v[72:75], v2 offset:37888
ds_read_b128 v[36:39], v2 offset:32768
v_cvt_pk_bf16_f32 v25, v25, v27
v_cvt_pk_bf16_f32 v24, v24, v26
v_bfi_b32 v24, 1, s35, v24
buffer_store_dwordx2 v[24:25], v8, s[4:7], s44 offen sc0 sc1
v_smfmac_f32_16x16x64_bf16 v[32:35], v[56:59], a[248:255], v0
ds_read_b128 v[68:71], v2 offset:36864
s_waitcnt lgkmcnt(6)
v_smfmac_f32_16x16x64_bf16 v[28:31], v[16:19], v[44:51], v0
s_nop 3
v_cvt_pk_bf16_f32 v33, v33, v35
v_cvt_pk_bf16_f32 v32, v32, v34
v_bfi_b32 v32, 1, s35, v32
buffer_store_dwordx2 v[32:33], v8, s[4:7], s45 offen sc0 sc1
s_waitcnt lgkmcnt(1)
v_smfmac_f32_16x16x64_bf16 v[28:31], v[52:55], v[36:43], v0
v_smfmac_f32_16x16x64_bf16 v[28:31], v[12:15], v[60:67], v0
s_waitcnt lgkmcnt(0)
v_smfmac_f32_16x16x64_bf16 v[28:31], v[56:59], v[68:75], v0
s_nop 7
v_cvt_pk_bf16_f32 v28, v28, v30
v_bfi_b32 v28, 1, s35, v28
v_cvt_pk_bf16_f32 v29, v29, v31
buffer_store_dwordx2 v[28:29], v8, s[4:7], s46 offen sc0 sc1
s_branch L_ex_w1rs
.p2align 6
L_ex_w2rs:
s_add_u32 s34, s34, 1
s_not_b32 s35, s35
s_not_b32 s36, s36
v_and_b32 v6, 0x70, v1
ds_read_b128 v[76:79], v6 offset:256
v_bfe_u32 v11, v1, 4, 2
v_lshrrev_b32_e64 v11, v11, 1
v_bfe_u32 v6, v1, 2, 7
s_mov_b32 m0, 1024
v_mov_b32 v42, s35
s_waitcnt vmcnt(1)
buffer_load_dwordx4 v[60:63], v9, s[4:7], s3 offen offset:0 sc0 sc1
buffer_load_dwordx4 v[64:67], v9, s[4:7], s3 offen offset:1024 sc0 sc1
buffer_load_dwordx4 v[68:71], v9, s[4:7], s3 offen offset:2048 sc0 sc1
buffer_load_dwordx4 v[72:75], v9, s[4:7], s3 offen offset:3072 sc0 sc1
s_barrier
s_waitcnt lgkmcnt(0)
s_waitcnt vmcnt(3)
L_r_w2rs:
v_mfma_f32_16x16x32_bf16 v[36:39], v[60:63], v[76:79], 0
s_waitcnt vmcnt(2)
v_mfma_f32_16x16x32_bf16 v[36:39], v[64:67], v[76:79], v[36:39]
v_bitop3_b32 v40, v60, v64, s36 bitop3:0x7e
s_waitcnt vmcnt(1)
v_mfma_f32_16x16x32_bf16 v[36:39], v[68:71], v[76:79], v[36:39]
s_waitcnt vmcnt(0)
v_mfma_f32_16x16x32_bf16 v[36:39], v[72:75], v[76:79], v[36:39]
v_bitop3_b32 v41, v68, v72, s36 bitop3:0x7e
v_bitop3_b32 v40, v40, v41, 1 bitop3:0xa8
v_cmp_ne_u32 vcc, 0, v40
v_nop
v_nop
v_nop
v_nop
v_nop
v_pk_add_f32 v[36:37], v[36:37], v[38:39]
v_cvt_pk_bf16_f32 v40, v36, v37
v_bfi_b32 v40, v11, s35, v40
s_cbranch_vccnz L_rr_w2rs
buffer_store_dword v40, v10, s[4:7], 0 offen sc0 sc1
s_cmp_eq_u32 s34, 63
v_mov_b32 v11, v40
s_cbranch_scc1 L_done_w2rs
s_mov_b64 exec, 1
buffer_store_dword v42, v1, s[4:7], s33 offen sc0 sc1
s_mov_b64 exec, -1
v_mov_b64 v[20:21], 0
v_mov_b64 v[22:23], 0
v_mov_b64 v[24:25], 0
v_mov_b64 v[26:27], 0
v_mov_b64 v[28:29], 0
v_mov_b64 v[30:31], 0
v_mov_b64 v[32:33], 0
v_mov_b64 v[34:35], 0
v_mov_b64 v[36:37], 0
v_mov_b64 v[38:39], 0
v_mov_b64 v[40:41], 0
v_mov_b64 v[42:43], 0
v_bfe_u32 v77, v1, 6, 1
v_lshl_add_u32 v77, v77, 3, v1
v_lshlrev_b32 v77, 1, v77
v_lshlrev_b32 v78, 3, v1
ds_read_b128 v[44:47], v2 offset:0
ds_read_b128 v[48:51], v2 offset:1024
s_add_u32 s37, s37, 524288
s_mul_i32 s40, s34, 10240
s_add_u32 s40, s40, 8093696
v_mov_b32 v79, s36
L_sp_w2rs:
buffer_load_dword v79, v6, s[4:7], s58 offen sc0 sc1
s_sub_u32 s41, s41, 1
s_cbranch_scc1 L_exit
buffer_load_dwordx4 v1, s[4:7], s47 offen offset:0 sc0 sc1 lds
buffer_load_dwordx4 v1, s[4:7], s47 offen offset:1024 sc0 sc1 lds
buffer_load_dwordx4 v1, s[4:7], s47 offen offset:2048 sc0 sc1 lds
buffer_load_dwordx4 v1, s[4:7], s47 offen offset:3072 sc0 sc1 lds
s_waitcnt vmcnt(4)
v_cmp_ne_u32 vcc, s35, v79
s_cbranch_vccnz L_sp_w2rs
L_top_w2rs:
s_waitcnt vmcnt(3)
s_barrier
ds_read_b128 v[60:63], v1 offset:1024
s_mov_b32 m0, 5120
s_nop 0
buffer_load_dwordx4 v1, s[4:7], s48 offen offset:2048 sc0 sc1 lds
s_waitcnt vmcnt(1)
s_barrier
ds_read_b128 v[64:67], v1 offset:2048
ds_read_b128 v[68:71], v1 offset:3072
ds_read_b128 v[72:75], v1 offset:4096
L_s0_w2rs:
s_waitcnt lgkmcnt(3)
v_smfmac_f32_16x16x64_bf16 v[32:35], v[60:63], v[184:191], v0
v_smfmac_f32_16x16x64_bf16 v[36:39], v[60:63], a[48:55], v0
v_smfmac_f32_16x16x64_bf16 v[20:23], v[60:63], v[44:51], v0
ds_read_b128 v[48:51], v2 offset:3072
v_smfmac_f32_16x16x64_bf16 v[28:31], v[60:63], v[176:183], v0
buffer_load_dwordx4 v[12:15], v9, s[4:7], s37 offen offset:0
v_smfmac_f32_16x16x64_bf16 v[40:43], v[60:63], a[56:63], v0
s_waitcnt lgkmcnt(3)
v_smfmac_f32_16x16x64_bf16 v[28:31], v[64:67], v[192:199], v0
ds_read_b128 v[44:47], v2 offset:2048
v_smfmac_f32_16x16x64_bf16 v[20:23], v[64:67], v[80:87], v0
buffer_load_dwordx4 v[16:19], v9, s[4:7], s37 offen offset:1024
v_smfmac_f32_16x16x64_bf16 v[32:35], v[64:67], v[200:207], v0
v_bitop3_b32 v6, v60, v64, s35 bitop3:0x7e
s_waitcnt lgkmcnt(2)
v_bitop3_b32 v76, v68, v72, s35 bitop3:0x7e
v_smfmac_f32_16x16x64_bf16 v[24:27], v[64:67], v[88:95], v0
buffer_load_dwordx4 v[52:55], v1, s[4:7], s37 offen offset:2048
s_waitcnt lgkmcnt(0)
v_smfmac_f32_16x16x64_bf16 v[24:27], v[60:63], v[44:51], v0
v_smfmac_f32_16x16x64_bf16 v[36:39], v[64:67], a[64:71], v0
v_bitop3_b32 v6, v6, v76, 1 bitop3:0xa8
v_smfmac_f32_16x16x64_bf16 v[40:43], v[64:67], a[72:79], v0
ds_read_b128 v[44:47], v2 offset:4096
v_cmp_ne_u32 vcc, 0, v6
v_smfmac_f32_16x16x64_bf16 v[20:23], v[68:71], v[96:103], v0
buffer_load_dwordx4 v[56:59], v1, s[4:7], s37 offen offset:3072
ds_read_b128 v[48:51], v2 offset:5120
v_smfmac_f32_16x16x64_bf16 v[24:27], v[68:71], v[104:111], v0
s_cbranch_vccnz L_ra0_w2rs
s_waitcnt vmcnt(4)
s_barrier
ds_read_b32 v6, v77 offset:8192
v_smfmac_f32_16x16x64_bf16 v[28:31], v[68:71], v[208:215], v0
ds_read_b128 v[60:63], v1 offset:6144
ds_read_b128 v[64:67], v1 offset:7168
s_waitcnt lgkmcnt(3)
v_smfmac_f32_16x16x64_bf16 v[20:23], v[72:75], v[44:51], v0
ds_read_b128 v[76:79], v1 offset:5120
ds_read_b128 v[44:47], v2 offset:6144
buffer_store_dword v11, v10, s[4:7], s40 offen sc0 sc1
v_smfmac_f32_16x16x64_bf16 v[28:31], v[72:75], v[224:231], v0
v_smfmac_f32_16x16x64_bf16 v[32:35], v[68:71], v[216:223], v0
v_smfmac_f32_16x16x64_bf16 v[36:39], v[68:71], a[80:87], v0
ds_read_b128 v[48:51], v2 offset:7168
s_waitcnt lgkmcnt(4)
v_bitop3_b32 v6, v6, v60, s35 bitop3:0x7e
v_smfmac_f32_16x16x64_bf16 v[40:43], v[68:71], a[88:95], v0
ds_read_b128 v[68:71], v1 offset:8192
v_smfmac_f32_16x16x64_bf16 v[32:35], v[72:75], v[232:239], v0
s_waitcnt lgkmcnt(4)
v_bitop3_b32 v6, v6, v64, s35 bitop3:0xf6
s_waitcnt lgkmcnt(3)
v_bitop3_b32 v6, v6, v76, s35 bitop3:0xf6
v_and_b32 v6, 1, v6
s_waitcnt lgkmcnt(1)
v_smfmac_f32_16x16x64_bf16 v[24:27], v[72:75], v[44:51], v0
ds_read_b128 v[44:47], v2 offset:8192
v_cmp_ne_u32 vcc, 0, v6
v_smfmac_f32_16x16x64_bf16 v[36:39], v[72:75], a[96:103], v0
ds_read_b128 v[48:51], v2 offset:9216
v_smfmac_f32_16x16x64_bf16 v[40:43], v[72:75], a[104:111], v0
ds_read_b128 v[72:75], v1 offset:9216
s_cbranch_vccnz L_ra1_w2rs
L_a1_w2rs:
v_smfmac_f32_16x16x64_bf16 v[20:23], v[60:63], v[112:119], v0
v_smfmac_f32_16x16x64_bf16 v[20:23], v[64:67], v[128:135], v0
s_waitcnt lgkmcnt(1)
v_smfmac_f32_16x16x64_bf16 v[20:23], v[76:79], v[44:51], v0
ds_read_b128 v[48:51], v2 offset:11264
v_bfe_u32 v6, v1, 5, 1
v_mad_i32_i24 v6, v6, s55, v1
v_smfmac_f32_16x16x64_bf16 v[20:23], v[68:71], v[144:151], v0
s_waitcnt lgkmcnt(1)
v_smfmac_f32_16x16x64_bf16 v[20:23], v[72:75], v[160:167], v0
ds_read_b128 v[44:47], v2 offset:10240
v_smfmac_f32_16x16x64_bf16 v[24:27], v[60:63], v[120:127], v0
v_smfmac_f32_16x16x64_bf16 v[24:27], v[64:67], v[136:143], v0
v_smfmac_f32_16x16x64_bf16 v[24:27], v[68:71], v[152:159], v0
v_add_f32 v21, v21, v23
v_smfmac_f32_16x16x64_bf16 v[24:27], v[72:75], v[168:175], v0
s_waitcnt lgkmcnt(0)
v_smfmac_f32_16x16x64_bf16 v[24:27], v[76:79], v[44:51], v0
ds_read_b128 v[44:47], v2 offset:12288
v_add_f32 v20, v20, v22
v_cvt_pk_bf16_f32 v22, v20, v21
v_smfmac_f32_16x16x64_bf16 v[28:31], v[76:79], v[240:247], v0
ds_read_b128 v[48:51], v2 offset:13312
v_smfmac_f32_16x16x64_bf16 v[28:31], v[64:67], a[0:7], v0
v_add_f32 v25, v25, v27
v_add_f32 v24, v24, v26
v_cvt_pk_bf16_f32 v23, v24, v25
v_smfmac_f32_16x16x64_bf16 v[28:31], v[72:75], a[32:39], v0
ds_write_b64 v3, v[22:23] offset:11264
v_smfmac_f32_16x16x64_bf16 v[32:35], v[76:79], v[248:255], v0
s_waitcnt lgkmcnt(1)
v_smfmac_f32_16x16x64_bf16 v[28:31], v[60:63], v[44:51], v0
ds_read_b128 v[48:51], v2 offset:15360
v_smfmac_f32_16x16x64_bf16 v[28:31], v[68:71], a[16:23], v0
ds_read_b128 v[44:47], v2 offset:14336
s_waitcnt vmcnt(1)
v_smfmac_f32_16x16x64_bf16 v[32:35], v[64:67], a[8:15], v0
s_waitcnt lgkmcnt(2)
s_barrier
ds_read_b64_tr_b16 v[20:21], v4 offset:10240
v_smfmac_f32_16x16x64_bf16 v[32:35], v[68:71], a[24:31], v0
ds_read_b64_tr_b16 v[22:23], v4 offset:10752
v_add_f32 v29, v29, v31
v_smfmac_f32_16x16x64_bf16 v[32:35], v[72:75], a[40:47], v0
ds_read_b64_tr_b16 v[24:25], v4 offset:11264
ds_read_b64_tr_b16 v[26:27], v4 offset:11776
s_waitcnt lgkmcnt(4)
v_smfmac_f32_16x16x64_bf16 v[32:35], v[60:63], v[44:51], v0
ds_read_b128 v[48:51], v2 offset:19456
s_waitcnt lgkmcnt(3)
v_mfma_f32_16x16x32_bf16 v[12:15], v[12:15], v[20:23], 0
ds_read_b128 v[44:47], v2 offset:18432
v_add_f32 v28, v28, v30
s_waitcnt lgkmcnt(2)
v_mfma_f32_16x16x32_bf16 v[12:15], v[16:19], v[24:27], v[12:15]
v_add_f32 v33, v33, v35
v_add_f32 v32, v32, v34
v_cvt_pk_bf16_f32 v30, v28, v29
v_cvt_pk_bf16_f32 v31, v32, v33
v_smfmac_f32_16x16x64_bf16 v[36:39], v[76:79], a[112:119], v0
ds_write_b64 v3, v[30:31] offset:13312
v_add_f32_dpp v12, v14, v12 quad_perm:[2,3,0,1] row_mask:0xf bank_mask:0xf
v_exp_f32 v14, v12
v_add_f32_dpp v13, v15, v13 quad_perm:[2,3,0,1] row_mask:0xf bank_mask:0xf
v_exp_f32 v15, v13
s_nop 0
v_cvt_pk_bf16_f32 v14, v14, v15
v_smfmac_f32_16x16x64_bf16 v[40:43], v[76:79], a[120:127], v0
ds_write_b32 v5, v14 offset:14880
s_waitcnt lgkmcnt(2)
v_smfmac_f32_16x16x64_bf16 v[40:43], v[72:75], v[44:51], v0
ds_read_b128 v[44:47], v2 offset:16384
s_waitcnt lgkmcnt(2)
s_barrier
ds_read_b64_tr_b16 v[28:29], v4 offset:12288
v_smfmac_f32_16x16x64_bf16 v[36:39], v[60:63], a[128:135], v0
ds_read_b64_tr_b16 v[30:31], v4 offset:12800
ds_read_b64_tr_b16 v[32:33], v4 offset:13312
v_smfmac_f32_16x16x64_bf16 v[40:43], v[60:63], a[136:143], v0
ds_read_b64_tr_b16 v[34:35], v4 offset:13824
v_mov_b64 v[76:77], s[52:53]
s_waitcnt lgkmcnt(2)
v_mfma_f32_16x16x32_bf16 v[28:31], v[28:31], v[20:23], 0
s_barrier
ds_read_b128 v[16:19], v1 offset:14368
s_waitcnt lgkmcnt(1)
v_mfma_f32_16x16x32_bf16 v[28:31], v[32:35], v[24:27], v[28:31]
ds_read_b128 v[60:63], v1 offset:14336
v_mov_b64 v[14:15], s[0:1]
v_smfmac_f32_16x16x64_bf16 v[40:43], v[64:67], a[152:159], v0
ds_read_b128 v[48:51], v2 offset:17408
v_mov_b64 v[78:79], s[52:53]
v_smfmac_f32_16x16x64_bf16 v[40:43], v[68:71], a[168:175], v0
v_add_f32_dpp v28, v30, v28 quad_perm:[2,3,0,1] row_mask:0xf bank_mask:0xf
v_mul_f32 v28, s50, v28
v_smfmac_f32_16x16x64_bf16 v[36:39], v[64:67], a[144:151], v0
ds_read_b128 v[64:67], v2 offset:23552
v_add_f32_dpp v29, v31, v29 quad_perm:[2,3,0,1] row_mask:0xf bank_mask:0xf
v_smfmac_f32_16x16x64_bf16 v[36:39], v[68:71], a[160:167], v0
ds_read_b128 v[68:71], v2 offset:24576
s_waitcnt lgkmcnt(2)
v_smfmac_f32_16x16x64_bf16 v[36:39], v[72:75], v[44:51], v0
ds_read_b128 v[72:75], v2 offset:25600
v_cvt_pk_bf16_f32 v40, v40, v41
v_mfma_f32_16x16x32_bf16 v[32:35], v[76:79], v[16:19], 0
ds_read_b128 v[44:47], v2 offset:20480
v_mul_f32 v29, s50, v29
v_exp_f32 v30, v28
v_mfma_f32_16x16x32_bf16 v[20:23], v[52:55], v[16:19], 0
v_exp_f32 v31, v29
v_cvt_pk_bf16_f32 v41, v42, v43
v_cvt_pk_bf16_f32 v43, v38, v39
v_mov_b64 v[76:77], 0
v_mfma_f32_16x16x32_bf16 v[20:23], v[56:59], v[60:63], v[20:23]
v_cvt_pk_bf16_f32 v30, v30, v31
v_cndmask_b32_e64 v26, 0, v30, s[56:57]
v_cndmask_b32_e64 v27, 0, v30, s[56:57]
s_nop 0
v_mov_b32_dpp v24, v26 quad_perm:[2,3,0,1] row_mask:0xf bank_mask:0xf
v_mfma_f32_16x16x16_bf16 v[32:35], v[14:15], v[26:27], v[32:35]
v_cvt_pk_bf16_f32 v42, v36, v37
v_mov_b32_dpp v25, v26 quad_perm:[2,3,0,1] row_mask:0xf bank_mask:0xf
s_nop 1
v_mfma_f32_16x16x32_bf16 v[20:23], v[40:43], v[24:27], v[20:23]
ds_read_b128 v[60:63], v2 offset:22528
ds_read_b128 v[48:51], v2 offset:21504
v_rcp_f32 v33, v32
v_mov_b64 v[36:37], 0
v_mov_b64 v[78:79], 0
v_min_f32 v32, v32, v33
v_cmp_nlt_f32 vcc, s2, v32
v_mul_f32_dpp v23, v33, v23 quad_perm:[0,1,0,1] row_mask:0xf bank_mask:0xf
v_mul_f32_dpp v21, v33, v21 quad_perm:[0,1,0,1] row_mask:0xf bank_mask:0xf
v_mul_f32_dpp v22, v33, v22 quad_perm:[0,1,0,1] row_mask:0xf bank_mask:0xf
v_mul_f32_dpp v20, v33, v20 quad_perm:[0,1,0,1] row_mask:0xf bank_mask:0xf
v_cvt_pk_bf16_f32 v20, v20, v21
v_cvt_pk_bf16_f32 v21, v22, v23
ds_write_b64 v6, v[20:21] offset:7168
s_and_b64 vcc, vcc, s[56:57]
v_mov_b32_dpp v16, v20 quad_perm:[0,1,0,1] row_mask:0xf bank_mask:0xf
v_mov_b32_dpp v19, v21 quad_perm:[2,3,2,3] row_mask:0xf bank_mask:0xf
s_cbranch_scc1 L_mx_w2rs
L_mxb_w2rs:
v_mov_b32_dpp v18, v20 quad_perm:[2,3,2,3] row_mask:0xf bank_mask:0xf
v_mov_b64 v[38:39], 0
v_mov_b32_dpp v17, v21 quad_perm:[0,1,0,1] row_mask:0xf bank_mask:0xf
v_mov_b64 v[26:27], 0
v_mov_b64 v[24:25], 0
v_mov_b64 v[32:33], 0
v_smfmac_f32_16x16x64_bf16 v[76:79], v[16:19], a[176:183], v0
s_waitcnt lgkmcnt(0)
s_barrier
ds_read_b128 v[12:15], v7 offset:5120
ds_read_b128 v[52:55], v7 offset:8192
v_smfmac_f32_16x16x64_bf16 v[36:39], v[16:19], a[184:191], v0
ds_read_b128 v[56:59], v7 offset:6144
v_mov_b64 v[34:35], 0
v_smfmac_f32_16x16x64_bf16 v[24:27], v[16:19], a[192:199], v0
v_smfmac_f32_16x16x64_bf16 v[32:35], v[16:19], a[200:207], v0
s_waitcnt lgkmcnt(2)
v_smfmac_f32_16x16x64_bf16 v[76:79], v[12:15], a[208:215], v0
s_waitcnt lgkmcnt(1)
v_smfmac_f32_16x16x64_bf16 v[76:79], v[52:55], a[216:223], v0
s_waitcnt lgkmcnt(0)
v_smfmac_f32_16x16x64_bf16 v[76:79], v[56:59], a[224:231], v0
v_smfmac_f32_16x16x64_bf16 v[36:39], v[12:15], v[44:51], v0
ds_read_b128 v[48:51], v2 offset:27648
ds_read_b128 v[44:47], v2 offset:26624
v_smfmac_f32_16x16x64_bf16 v[36:39], v[52:55], a[232:239], v0
v_cvt_pk_bf16_f32 v77, v77, v79
v_cvt_pk_bf16_f32 v76, v76, v78
v_bfi_b32 v76, 1, s35, v76
v_smfmac_f32_16x16x64_bf16 v[36:39], v[56:59], v[60:67], v0
buffer_store_dwordx2 v[76:77], v8, s[4:7], s42 offen sc0 sc1
ds_read_b128 v[60:63], v2 offset:28672
v_smfmac_f32_16x16x64_bf16 v[24:27], v[12:15], v[68:75], v0
ds_read_b128 v[64:67], v2 offset:29696
v_smfmac_f32_16x16x64_bf16 v[24:27], v[52:55], a[240:247], v0
ds_read_b128 v[68:71], v2 offset:30720
v_cvt_pk_bf16_f32 v36, v36, v38
v_bfi_b32 v36, 1, s35, v36
v_cvt_pk_bf16_f32 v37, v37, v39
s_waitcnt lgkmcnt(3)
v_smfmac_f32_16x16x64_bf16 v[24:27], v[56:59], v[44:51], v0
buffer_store_dwordx2 v[36:37], v8, s[4:7], s43 offen sc0 sc1
ds_read_b128 v[72:75], v2 offset:31744
v_smfmac_f32_16x16x64_bf16 v[32:35], v[52:55], a[248:255], v0
s_waitcnt lgkmcnt(2)
v_smfmac_f32_16x16x64_bf16 v[32:35], v[12:15], v[60:67], v0
v_cvt_pk_bf16_f32 v25, v25, v27
v_cvt_pk_bf16_f32 v24, v24, v26
v_bfi_b32 v24, 1, s35, v24
buffer_store_dwordx2 v[24:25], v8, s[4:7], s44 offen sc0 sc1
s_waitcnt lgkmcnt(0)
v_smfmac_f32_16x16x64_bf16 v[32:35], v[56:59], v[68:75], v0
s_nop 7
v_cvt_pk_bf16_f32 v33, v33, v35
v_cvt_pk_bf16_f32 v32, v32, v34
v_bfi_b32 v32, 1, s35, v32
buffer_store_dwordx2 v[32:33], v8, s[4:7], s45 offen sc0 sc1
s_branch L_ex_w2rs
.p2align 6
L_ex_w3s:
s_add_u32 s34, s34, 1
s_not_b32 s35, s35
s_not_b32 s36, s36
s_add_u32 s37, s37, 524288
s_add_u32 s39, s39, 524288
v_mov_b64 v[20:21], 0
v_mov_b64 v[22:23], 0
v_mov_b64 v[24:25], 0
v_mov_b64 v[26:27], 0
v_mov_b64 v[28:29], 0
v_mov_b64 v[30:31], 0
v_mov_b64 v[32:33], 0
v_mov_b64 v[34:35], 0
v_mov_b64 v[36:37], 0
v_mov_b64 v[38:39], 0
v_mov_b64 v[40:41], 0
v_mov_b64 v[42:43], 0
ds_read_b128 v[44:47], v2 offset:0
ds_read_b128 v[48:51], v2 offset:1024
v_bfe_u32 v77, v1, 6, 1
v_lshl_add_u32 v77, v77, 3, v1
v_lshlrev_b32 v77, 1, v77
v_lshlrev_b32 v78, 3, v1
s_barrier
s_cmp_eq_u32 s34, 63
s_cbranch_scc1 L_done_w3s
s_add_u32 s100, s34, 1
s_lshr_b32 s100, s100, 2
s_waitcnt vmcnt(4)
L_evb_w3s:
v_max_u32 v10, v10, v11
v_bfe_u32 v11, v1, 2, 6
v_cmp_ge_u32 vcc, s100, v10
s_cbranch_vccnz L_ev_w3s
s_add_u32 s100, s34, 4
s_lshr_b32 s100, s100, 2
s_min_u32 s100, s100, 15
v_cmp_ge_u32 vcc, s100, v10
s_nop 0
s_cmp_eq_u64 vcc, 0
s_cselect_b32 s3, 268435456, s101
L_top_w3s:
s_barrier
ds_read_b128 v[60:63], v1 offset:1024
s_mov_b32 m0, 5120
s_nop 0
buffer_load_dwordx4 v1, s[4:7], s48 offen offset:3072 sc0 sc1 lds
s_barrier
ds_read_b128 v[64:67], v1 offset:2048
ds_read_b128 v[68:71], v1 offset:3072
ds_read_b128 v[72:75], v1 offset:4096
L_s0_w3s:
s_waitcnt lgkmcnt(3)
v_smfmac_f32_16x16x64_bf16 v[32:35], v[60:63], v[184:191], v0
s_mov_b32 m0, 9216
s_nop 0
buffer_load_dwordx4 v1, s[4:7], s49 offen offset:0 sc0 sc1 lds
v_smfmac_f32_16x16x64_bf16 v[20:23], v[60:63], v[44:51], v0
v_smfmac_f32_16x16x64_bf16 v[28:31], v[60:63], v[176:183], v0
s_waitcnt lgkmcnt(2)
v_smfmac_f32_16x16x64_bf16 v[28:31], v[64:67], v[192:199], v0
ds_read_b128 v[48:51], v2 offset:3072
v_smfmac_f32_16x16x64_bf16 v[36:39], v[60:63], a[48:55], v0
ds_read_b128 v[44:47], v2 offset:2048
v_smfmac_f32_16x16x64_bf16 v[40:43], v[60:63], a[56:63], v0
buffer_load_dwordx4 v[12:15], v9, s[4:7], s37 offen offset:0
v_smfmac_f32_16x16x64_bf16 v[24:27], v[64:67], v[88:95], v0
v_smfmac_f32_16x16x64_bf16 v[20:23], v[64:67], v[80:87], v0
v_bitop3_b32 v6, v60, v64, s35 bitop3:0x7e
v_smfmac_f32_16x16x64_bf16 v[32:35], v[64:67], v[200:207], v0
buffer_load_dwordx4 v[16:19], v9, s[4:7], s37 offen offset:1024
s_waitcnt lgkmcnt(0)
v_smfmac_f32_16x16x64_bf16 v[24:27], v[60:63], v[44:51], v0
v_bitop3_b32 v76, v68, v72, s35 bitop3:0x7e
v_bitop3_b32 v6, v6, v76, 1 bitop3:0xa8
v_smfmac_f32_16x16x64_bf16 v[36:39], v[64:67], a[64:71], v0
v_cmp_ne_u32 vcc, 0, v6
v_smfmac_f32_16x16x64_bf16 v[40:43], v[64:67], a[72:79], v0
buffer_load_dwordx4 v[52:55], v1, s[4:7], s37 offen offset:2048
ds_read_b128 v[44:47], v2 offset:4096
v_smfmac_f32_16x16x64_bf16 v[20:23], v[68:71], v[96:103], v0
ds_read_b128 v[48:51], v2 offset:5120
buffer_load_dwordx4 v[56:59], v1, s[4:7], s37 offen offset:3072
s_mov_b32 m0, 0
v_smfmac_f32_16x16x64_bf16 v[24:27], v[68:71], v[104:111], v0
s_cbranch_vccnz L_ra0_w3s
s_waitcnt vmcnt(4)
s_barrier
ds_read_b32 v6, v77 offset:8192
v_smfmac_f32_16x16x64_bf16 v[28:31], v[68:71], v[208:215], v0
buffer_load_dword v78, s[4:7], s39 offen lds
buffer_load_dword v11, v11, s[4:7], s3 offen sc1
v_smfmac_f32_16x16x64_bf16 v[36:39], v[68:71], a[80:87], v0
ds_read_b128 v[60:63], v1 offset:6144
v_smfmac_f32_16x16x64_bf16 v[28:31], v[72:75], v[224:231], v0
ds_read_b128 v[76:79], v1 offset:5120
s_waitcnt lgkmcnt(3)
v_smfmac_f32_16x16x64_bf16 v[20:23], v[72:75], v[44:51], v0
ds_read_b128 v[64:67], v1 offset:7168
v_smfmac_f32_16x16x64_bf16 v[32:35], v[68:71], v[216:223], v0
ds_read_b128 v[44:47], v2 offset:6144
v_smfmac_f32_16x16x64_bf16 v[40:43], v[68:71], a[88:95], v0
ds_read_b128 v[48:51], v2 offset:7168
s_waitcnt lgkmcnt(4)
v_bitop3_b32 v6, v6, v60, s35 bitop3:0x7e
ds_read_b128 v[68:71], v1 offset:8192
v_smfmac_f32_16x16x64_bf16 v[32:35], v[72:75], v[232:239], v0
s_waitcnt lgkmcnt(3)
v_bitop3_b32 v6, v6, v64, s35 bitop3:0xf6
v_bitop3_b32 v6, v6, v76, s35 bitop3:0xf6
v_and_b32 v6, 1, v6
s_waitcnt lgkmcnt(1)
v_smfmac_f32_16x16x64_bf16 v[24:27], v[72:75], v[44:51], v0
ds_read_b128 v[44:47], v2 offset:8192
v_cmp_ne_u32 vcc, 0, v6
v_smfmac_f32_16x16x64_bf16 v[36:39], v[72:75], a[96:103], v0
ds_read_b128 v[48:51], v2 offset:9216
v_smfmac_f32_16x16x64_bf16 v[40:43], v[72:75], a[104:111], v0
ds_read_b128 v[72:75], v1 offset:9216
s_cbranch_vccnz L_ra1_w3s
L_a1_w3s:
v_smfmac_f32_16x16x64_bf16 v[20:23], v[60:63], v[112:119], v0
v_smfmac_f32_16x16x64_bf16 v[20:23], v[64:67], v[128:135], v0
s_waitcnt lgkmcnt(1)
v_smfmac_f32_16x16x64_bf16 v[20:23], v[76:79], v[44:51], v0
ds_read_b128 v[48:51], v2 offset:11264
v_bfe_u32 v6, v1, 5, 1
v_mad_i32_i24 v6, v6, s55, v1
v_smfmac_f32_16x16x64_bf16 v[20:23], v[68:71], v[144:151], v0
s_waitcnt lgkmcnt(1)
v_smfmac_f32_16x16x64_bf16 v[20:23], v[72:75], v[160:167], v0
v_smfmac_f32_16x16x64_bf16 v[24:27], v[60:63], v[120:127], v0
ds_read_b128 v[44:47], v2 offset:10240
v_smfmac_f32_16x16x64_bf16 v[24:27], v[64:67], v[136:143], v0
v_smfmac_f32_16x16x64_bf16 v[24:27], v[68:71], v[152:159], v0
v_add_f32 v21, v21, v23
v_smfmac_f32_16x16x64_bf16 v[24:27], v[72:75], v[168:175], v0
s_waitcnt lgkmcnt(0)
v_smfmac_f32_16x16x64_bf16 v[24:27], v[76:79], v[44:51], v0
ds_read_b128 v[44:47], v2 offset:12288
v_add_f32 v20, v20, v22
v_cvt_pk_bf16_f32 v22, v20, v21
v_smfmac_f32_16x16x64_bf16 v[28:31], v[76:79], v[240:247], v0
ds_read_b128 v[48:51], v2 offset:13312
v_smfmac_f32_16x16x64_bf16 v[28:31], v[64:67], a[0:7], v0
v_add_f32 v25, v25, v27
v_add_f32 v24, v24, v26
v_cvt_pk_bf16_f32 v23, v24, v25
v_smfmac_f32_16x16x64_bf16 v[28:31], v[72:75], a[32:39], v0
ds_write_b64 v3, v[22:23] offset:11776
v_smfmac_f32_16x16x64_bf16 v[32:35], v[76:79], v[248:255], v0
s_waitcnt lgkmcnt(1)
v_smfmac_f32_16x16x64_bf16 v[28:31], v[60:63], v[44:51], v0
ds_read_b128 v[48:51], v2 offset:15360
v_smfmac_f32_16x16x64_bf16 v[28:31], v[68:71], a[16:23], v0
ds_read_b128 v[44:47], v2 offset:14336
s_waitcnt vmcnt(2)
v_smfmac_f32_16x16x64_bf16 v[32:35], v[64:67], a[8:15], v0
s_waitcnt lgkmcnt(2)
s_barrier
v_smfmac_f32_16x16x64_bf16 v[32:35], v[68:71], a[24:31], v0
ds_read_b64_tr_b16 v[20:21], v4 offset:10240
ds_read_b64_tr_b16 v[22:23], v4 offset:10752
v_add_f32 v29, v29, v31
v_smfmac_f32_16x16x64_bf16 v[32:35], v[72:75], a[40:47], v0
ds_read_b64_tr_b16 v[24:25], v4 offset:11264
ds_read_b64_tr_b16 v[26:27], v4 offset:11776
s_waitcnt lgkmcnt(4)
v_smfmac_f32_16x16x64_bf16 v[32:35], v[60:63], v[44:51], v0
ds_read_b128 v[48:51], v2 offset:19456
s_waitcnt lgkmcnt(3)
v_mfma_f32_16x16x32_bf16 v[12:15], v[12:15], v[20:23], 0
ds_read_b128 v[44:47], v2 offset:18432
v_add_f32 v28, v28, v30
s_waitcnt lgkmcnt(2)
v_mfma_f32_16x16x32_bf16 v[12:15], v[16:19], v[24:27], v[12:15]
v_add_f32 v32, v32, v34
v_add_f32 v33, v33, v35
v_cvt_pk_bf16_f32 v30, v28, v29
v_cvt_pk_bf16_f32 v31, v32, v33
v_smfmac_f32_16x16x64_bf16 v[36:39], v[76:79], a[112:119], v0
ds_write_b64 v3, v[30:31] offset:13824
v_add_f32_dpp v12, v14, v12 quad_perm:[2,3,0,1] row_mask:0xf bank_mask:0xf
v_exp_f32 v14, v12
v_add_f32_dpp v13, v15, v13 quad_perm:[2,3,0,1] row_mask:0xf bank_mask:0xf
v_exp_f32 v15, v13
s_nop 0
v_cvt_pk_bf16_f32 v14, v14, v15
v_smfmac_f32_16x16x64_bf16 v[40:43], v[76:79], a[120:127], v0
ds_write_b32 v5, v14 offset:15136
s_waitcnt lgkmcnt(1)
s_barrier
ds_read_b64_tr_b16 v[28:29], v4 offset:12288
v_smfmac_f32_16x16x64_bf16 v[36:39], v[60:63], a[128:135], v0
ds_read_b64_tr_b16 v[30:31], v4 offset:12800
ds_read_b64_tr_b16 v[32:33], v4 offset:13312
v_smfmac_f32_16x16x64_bf16 v[40:43], v[60:63], a[136:143], v0
ds_read_b64_tr_b16 v[34:35], v4 offset:13824
v_mov_b64 v[76:77], s[52:53]
v_smfmac_f32_16x16x64_bf16 v[40:43], v[72:75], v[44:51], v0
ds_read_b128 v[44:47], v2 offset:16384
s_waitcnt lgkmcnt(3)
v_mfma_f32_16x16x32_bf16 v[28:31], v[28:31], v[20:23], 0
s_barrier
ds_read_b128 v[16:19], v1 offset:14368
s_waitcnt lgkmcnt(2)
v_mfma_f32_16x16x32_bf16 v[28:31], v[32:35], v[24:27], v[28:31]
ds_read_b128 v[60:63], v1 offset:14336
v_mov_b64 v[14:15], s[0:1]
v_smfmac_f32_16x16x64_bf16 v[40:43], v[64:67], a[152:159], v0
ds_read_b128 v[48:51], v2 offset:17408
v_mov_b64 v[78:79], s[52:53]
v_smfmac_f32_16x16x64_bf16 v[40:43], v[68:71], a[168:175], v0
v_add_f32_dpp v28, v30, v28 quad_perm:[2,3,0,1] row_mask:0xf bank_mask:0xf
v_mul_f32 v28, s50, v28
v_smfmac_f32_16x16x64_bf16 v[36:39], v[64:67], a[144:151], v0
ds_read_b128 v[64:67], v2 offset:21504
v_add_f32_dpp v29, v31, v29 quad_perm:[2,3,0,1] row_mask:0xf bank_mask:0xf
v_smfmac_f32_16x16x64_bf16 v[36:39], v[68:71], a[160:167], v0
ds_read_b128 v[68:71], v2 offset:26624
s_waitcnt lgkmcnt(2)
v_smfmac_f32_16x16x64_bf16 v[36:39], v[72:75], v[44:51], v0
ds_read_b128 v[72:75], v2 offset:27648
v_cvt_pk_bf16_f32 v40, v40, v41
v_exp_f32 v30, v28
v_mfma_f32_16x16x32_bf16 v[32:35], v[76:79], v[16:19], 0
ds_read_b128 v[44:47], v2 offset:22528
v_mul_f32 v29, s50, v29
v_mfma_f32_16x16x32_bf16 v[20:23], v[52:55], v[16:19], 0
v_exp_f32 v31, v29
v_mfma_f32_16x16x32_bf16 v[20:23], v[56:59], v[60:63], v[20:23]
v_cvt_pk_bf16_f32 v41, v42, v43
v_cvt_pk_bf16_f32 v30, v30, v31
v_cndmask_b32_e64 v26, 0, v30, s[56:57]
v_cvt_pk_bf16_f32 v43, v38, v39
v_cndmask_b32_e64 v27, 0, v30, s[56:57]
v_mov_b32_dpp v24, v26 quad_perm:[2,3,0,1] row_mask:0xf bank_mask:0xf
v_mov_b64 v[76:77], 0
v_mfma_f32_16x16x16_bf16 v[32:35], v[14:15], v[26:27], v[32:35]
v_cvt_pk_bf16_f32 v42, v36, v37
v_mov_b32_dpp v25, v26 quad_perm:[2,3,0,1] row_mask:0xf bank_mask:0xf
s_nop 1
v_mfma_f32_16x16x32_bf16 v[20:23], v[40:43], v[24:27], v[20:23]
ds_read_b128 v[48:51], v2 offset:23552
s_nop 0
v_rcp_f32 v33, v32
ds_read_b128 v[60:63], v2 offset:20480
v_mov_b64 v[36:37], 0
v_min_f32 v32, v32, v33
v_cmp_nlt_f32 vcc, s2, v32
v_mov_b64 v[78:79], 0
v_mul_f32_dpp v23, v33, v23 quad_perm:[0,1,0,1] row_mask:0xf bank_mask:0xf
v_mul_f32_dpp v21, v33, v21 quad_perm:[0,1,0,1] row_mask:0xf bank_mask:0xf
v_mul_f32_dpp v22, v33, v22 quad_perm:[0,1,0,1] row_mask:0xf bank_mask:0xf
v_mul_f32_dpp v20, v33, v20 quad_perm:[0,1,0,1] row_mask:0xf bank_mask:0xf
v_cvt_pk_bf16_f32 v20, v20, v21
v_cvt_pk_bf16_f32 v21, v22, v23
ds_write_b64 v6, v[20:21] offset:8192
s_and_b64 vcc, vcc, s[56:57]
v_mov_b64 v[38:39], 0
s_cbranch_scc1 L_mx_w3s
L_mxb_w3s:
v_mov_b32_dpp v16, v20 quad_perm:[0,1,0,1] row_mask:0xf bank_mask:0xf
v_mov_b32_dpp v19, v21 quad_perm:[2,3,2,3] row_mask:0xf bank_mask:0xf
v_mov_b64 v[24:25], 0
v_mov_b32_dpp v18, v20 quad_perm:[2,3,2,3] row_mask:0xf bank_mask:0xf
v_mov_b32_dpp v17, v21 quad_perm:[0,1,0,1] row_mask:0xf bank_mask:0xf
v_mov_b64 v[26:27], 0
v_mov_b64 v[32:33], 0
v_smfmac_f32_16x16x64_bf16 v[76:79], v[16:19], a[176:183], v0
s_waitcnt lgkmcnt(0)
s_barrier
ds_read_b128 v[12:15], v7 offset:6144
ds_read_b128 v[52:55], v7 offset:7168
v_smfmac_f32_16x16x64_bf16 v[36:39], v[16:19], a[184:191], v0
ds_read_b128 v[56:59], v7 offset:5120
v_mov_b64 v[34:35], 0
s_nop 1
v_smfmac_f32_16x16x64_bf16 v[32:35], v[16:19], a[200:207], v0
v_smfmac_f32_16x16x64_bf16 v[24:27], v[16:19], a[192:199], v0
s_waitcnt lgkmcnt(2)
v_smfmac_f32_16x16x64_bf16 v[76:79], v[12:15], a[208:215], v0
s_waitcnt lgkmcnt(1)
v_smfmac_f32_16x16x64_bf16 v[76:79], v[52:55], a[216:223], v0
s_waitcnt lgkmcnt(0)
v_smfmac_f32_16x16x64_bf16 v[76:79], v[56:59], a[224:231], v0
v_smfmac_f32_16x16x64_bf16 v[36:39], v[12:15], v[44:51], v0
ds_read_b128 v[48:51], v2 offset:25600
ds_read_b128 v[44:47], v2 offset:24576
v_smfmac_f32_16x16x64_bf16 v[36:39], v[52:55], a[232:239], v0
v_cvt_pk_bf16_f32 v77, v77, v79
v_cvt_pk_bf16_f32 v76, v76, v78
v_bfi_b32 v76, 1, s35, v76
v_smfmac_f32_16x16x64_bf16 v[36:39], v[56:59], v[60:67], v0
buffer_store_dwordx2 v[76:77], v8, s[4:7], s42 offen sc0 sc1
ds_read_b128 v[60:63], v2 offset:30720
v_smfmac_f32_16x16x64_bf16 v[24:27], v[12:15], v[68:75], v0
ds_read_b128 v[64:67], v2 offset:31744
v_smfmac_f32_16x16x64_bf16 v[24:27], v[52:55], a[240:247], v0
ds_read_b128 v[68:71], v2 offset:28672
v_cvt_pk_bf16_f32 v36, v36, v38
v_bfi_b32 v36, 1, s35, v36
v_cvt_pk_bf16_f32 v37, v37, v39
s_waitcnt lgkmcnt(3)
v_smfmac_f32_16x16x64_bf16 v[24:27], v[56:59], v[44:51], v0
buffer_store_dwordx2 v[36:37], v8, s[4:7], s43 offen sc0 sc1
ds_read_b128 v[72:75], v2 offset:29696
s_nop 5
v_cvt_pk_bf16_f32 v25, v25, v27
v_cvt_pk_bf16_f32 v24, v24, v26
v_bfi_b32 v24, 1, s35, v24
v_smfmac_f32_16x16x64_bf16 v[32:35], v[52:55], a[248:255], v0
s_waitcnt lgkmcnt(2)
v_smfmac_f32_16x16x64_bf16 v[32:35], v[12:15], v[60:67], v0
buffer_store_dwordx2 v[24:25], v8, s[4:7], s44 offen sc0 sc1
s_waitcnt lgkmcnt(0)
v_smfmac_f32_16x16x64_bf16 v[32:35], v[56:59], v[68:75], v0
s_nop 7
v_cvt_pk_bf16_f32 v33, v33, v35
v_cvt_pk_bf16_f32 v32, v32, v34
v_bfi_b32 v32, 1, s35, v32
buffer_store_dwordx2 v[32:33], v8, s[4:7], s45 offen sc0 sc1
s_branch L_ex_w3s
L_pro_w2r:
v_and_b32 v20, 63, v0
v_lshlrev_b32 v1, 4, v20
v_add_u32 v2, 98304, v1
v_and_b32 v23, 1, v22
v_lshl_add_u32 v23, v24, 4, v23
v_mul_u32_u24 v23, 1152, v23
v_lshlrev_b32 v28, 2, v22
v_xor_b32 v28, v28, v21
v_lshl_add_u32 v28, v28, 4, v23
s_mul_i32 s55, s32, 147456
s_waitcnt lgkmcnt(0)
v_and_b32 v23, 1, v22
v_lshrrev_b32 v24, 2, v21
v_lshl_add_u32 v23, v23, 2, v24
v_lshlrev_b32 v23, 1, v23
v_bfe_u32 v44, v21, 1, 1
v_add_u32 v44, 8, v44
v_xor_b32 v44, v44, v23
v_lshlrev_b32 v44, 4, v44
v_lshl_add_u32 v44, v24, 8, v44
v_and_b32 v23, 1, v22
v_lshl_add_u32 v44, v23, 11, v44
v_and_b32 v23, 1, v21
v_lshl_add_u32 v44, v23, 3, v44
v_lshrrev_b32 v23, 1, v22
v_mul_u32_u24 v23, 40960, v23
v_add_u32 v23, 16384, v23
v_add_u32 v44, v44, v23
v_and_b32 v23, 1, v22
v_lshrrev_b32 v24, 2, v21
v_lshl_add_u32 v23, v23, 2, v24
v_lshlrev_b32 v23, 1, v23
v_bfe_u32 v45, v21, 1, 1
v_add_u32 v45, 10, v45
v_xor_b32 v45, v45, v23
v_lshlrev_b32 v45, 4, v45
v_lshl_add_u32 v45, v24, 8, v45
v_and_b32 v23, 1, v22
v_lshl_add_u32 v45, v23, 11, v45
v_and_b32 v23, 1, v21
v_lshl_add_u32 v45, v23, 3, v45
v_lshrrev_b32 v23, 1, v22
v_mul_u32_u24 v23, 40960, v23
v_add_u32 v23, 16384, v23
v_add_u32 v45, v45, v23
v_and_b32 v23, 1, v22
v_lshrrev_b32 v24, 2, v21
v_lshl_add_u32 v23, v23, 2, v24
v_lshlrev_b32 v23, 1, v23
v_bfe_u32 v46, v21, 1, 1
v_add_u32 v46, 8, v46
v_xor_b32 v46, v46, v23
v_lshlrev_b32 v46, 4, v46
v_lshl_add_u32 v46, v24, 8, v46
v_and_b32 v23, 1, v22
v_lshl_add_u32 v46, v23, 11, v46
v_and_b32 v23, 1, v21
v_lshl_add_u32 v46, v23, 3, v46
v_lshrrev_b32 v23, 1, v22
v_mul_u32_u24 v23, 32768, v23
v_add_u32 v23, 98304, v23
v_add_u32 v46, v46, v23
v_and_b32 v23, 1, v22
v_lshrrev_b32 v24, 2, v21
v_lshl_add_u32 v23, v23, 2, v24
v_lshlrev_b32 v23, 1, v23
v_bfe_u32 v47, v21, 1, 1
v_add_u32 v47, 10, v47
v_xor_b32 v47, v47, v23
v_lshlrev_b32 v47, 4, v47
v_lshl_add_u32 v47, v24, 8, v47
v_and_b32 v23, 1, v22
v_lshl_add_u32 v47, v23, 11, v47
v_and_b32 v23, 1, v21
v_lshl_add_u32 v47, v23, 3, v47
v_lshrrev_b32 v23, 1, v22
v_mul_u32_u24 v23, 32768, v23
v_add_u32 v23, 98304, v23
v_add_u32 v47, v47, v23
v_and_b32 v23, 1, v22
v_bfe_u32 v24, v21, 2, 1
v_lshl_add_u32 v23, v23, 1, v24
v_xor_b32 v24, 2, v23
v_lshlrev_b32 v24, 6, v24
v_lshl_add_u32 v48, v23, 8, v24
v_and_b32 v23, 3, v21
v_lshl_add_u32 v48, v23, 4, v48
v_and_b32 v23, 8, v21
v_add_u32 v48, v48, v23
v_lshrrev_b32 v23, 1, v22
v_mul_u32_u24 v23, 40960, v23
v_add_u32 v23, 16384, v23
v_add_u32 v48, v48, v23
v_and_b32 v23, 1, v22
v_bfe_u32 v24, v21, 2, 1
v_lshl_add_u32 v23, v23, 1, v24
v_xor_b32 v24, 2, v23
v_lshlrev_b32 v24, 6, v24
v_lshl_add_u32 v49, v23, 8, v24
v_and_b32 v23, 3, v21
v_lshl_add_u32 v49, v23, 4, v49
v_and_b32 v23, 8, v21
v_add_u32 v49, v49, v23
v_lshrrev_b32 v23, 1, v22
v_mul_u32_u24 v23, 32768, v23
v_add_u32 v23, 98304, v23
v_add_u32 v49, v49, v23
v_bfe_u32 v23, v21, 1, 1
v_mul_u32_u24 v23, 0xaaaa, v23
v_add_u32 v0, 0x4444, v23
v_lshlrev_b32 v3, 3, v20
v_lshrrev_b32 v25, 5, v20
v_lshlrev_b32 v25, 6, v25
v_xor_b32 v3, v3, v25
v_lshrrev_b32 v25, 2, v20
v_and_b32 v4, 3, v21
v_lshl_add_u32 v4, v4, 4, v25
v_lshlrev_b32 v4, 3, v4
v_bfe_u32 v25, v21, 1, 1
v_lshlrev_b32 v23, 6, v25
v_xor_b32 v4, v4, v23
v_lshlrev_b32 v5, 4, v21
v_lshl_add_u32 v5, v22, 2, v5
v_mul_u32_u24 v23, 512, v25
v_add_u32 v5, v5, v23
v_lshlrev_b32 v9, 8, v22
v_lshl_add_u32 v9, v25, 6, v9
v_bfe_u32 v23, v21, 3, 1
v_lshl_add_u32 v9, v23, 7, v9
v_bfe_u32 v23, v21, 2, 1
v_lshl_add_u32 v9, v23, 5, v9
v_and_b32 v23, 1, v21
v_lshl_add_u32 v9, v23, 4, v9
v_lshrrev_b32 v23, 1, v22
v_and_b32 v24, 1, v22
v_and_b32 v25, 7, v21
v_lshrrev_b32 v7, 3, v21
v_lshl_add_u32 v8, v7, 1, v23
v_lshlrev_b32 v8, 12, v8
v_lshl_add_u32 v8, v24, 7, v8
v_and_b32 v25, 4, v21
v_lshl_add_u32 v8, v25, 3, v8
v_and_b32 v25, 1, v21
v_lshl_add_u32 v8, v25, 4, v8
v_bfe_u32 v25, v21, 1, 1
v_lshl_add_u32 v8, v25, 3, v8
s_lshr_b32 s56, s32, 1
s_lshl_b32 s56, s56, 8
s_and_b32 s57, s32, 1
s_lshl_b32 s57, s57, 6
s_add_u32 s56, s56, s57
s_add_u32 s56, s56, 32768
v_add_u32 v8, s56, v8
v_and_b32 v7, 0x3d0, v1
s_mov_b32 s42, 0
s_mov_b32 s43, 65536
s_mov_b32 s44, 131072
s_mov_b32 s45, 196608
s_mov_b32 s46, 262144
s_mov_b32 s47, 294912
s_mov_b32 s48, 299008
s_mov_b32 s49, 303104
s_mov_b32 s50, 0x3e0293ee
s_mov_b32 s51, 0x3e0293ee
s_mov_b32 s52, 0x3f803f80
s_mov_b32 s53, 0x3f803f80
v_lshlrev_b32 v11, 2, v21
s_mov_b32 s34, 0
s_mov_b32 s35, -1
s_mov_b32 s36, 0
s_mov_b32 s41, 300000
s_lshl_b32 s37, s32, 14
s_add_u32 s39, s37, 17301504
s_add_u32 s37, s37, 16785408
s_mov_b32 s40, 8749056
v_mov_b64 v[36:37], 0
v_mov_b64 v[38:39], 0
s_lshl_b32 s56, s32, 1
s_add_u32 s56, s56, 1
s_cmp_eq_u32 s56, 0
s_cselect_b32 s56, 64, s56
s_mul_i32 s56, s56, 10240
s_add_u32 s56, s56, 8388608
s_add_u32 s57, s56, 4096
v_mov_b32 v40, 1
v_mov_b32 v41, 1
v_mov_b32 v42, 1
v_mov_b32 v43, 1
buffer_store_dwordx4 v[40:43], v1, s[4:7], s56 offen offset:0 sc0 sc1
buffer_store_dwordx4 v[40:43], v1, s[4:7], s56 offen offset:1024 sc0 sc1
buffer_store_dwordx4 v[40:43], v1, s[4:7], s56 offen offset:2048 sc0 sc1
buffer_store_dwordx4 v[40:43], v1, s[4:7], s56 offen offset:3072 sc0 sc1
s_add_u32 s56, s32, 0
s_lshl_b32 s3, s56, 12
v_and_b32 v23, 1, v21
v_bfe_u32 v24, v21, 2, 1
v_bfe_u32 v25, v21, 1, 1
s_lshl_b32 s57, s56, 7
s_add_u32 s57, s57, 294912
v_and_b32 v10, 7, v21
v_lshlrev_b32 v10, 2, v10
v_lshl_add_u32 v10, v22, 5, v10
v_add_u32 v10, s57, v10
s_lshl_b32 s33, s56, 2
s_add_u32 s33, s33, 304128
v_mov_b32 v30, -1
s_mov_b64 exec, 1
buffer_store_dword v30, v1, s[4:7], s33 offen sc0 sc1
s_mov_b64 exec, -1
v_lshl_add_u32 v23, v23, 1, v24
v_lshlrev_b32 v25, 4, v25
v_mov_b32 v24, 0x3f80
v_lshlrev_b32 v24, v25, v24
v_cmp_eq_u32 vcc, 0, v23
s_nop 1
v_cndmask_b32 v76, 0, v24, vcc
v_cmp_eq_u32 vcc, 1, v23
s_nop 1
v_cndmask_b32 v77, 0, v24, vcc
v_cmp_eq_u32 vcc, 2, v23
s_nop 1
v_cndmask_b32 v78, 0, v24, vcc
v_cmp_eq_u32 vcc, 3, v23
s_nop 1
v_cndmask_b32 v79, 0, v24, vcc
v_and_b32 v23, 0x70, v1
ds_write_b128 v23, v[76:79] offset:256
buffer_store_dwordx4 v[36:39], v9, s[4:7], s3 offen offset:0 sc0 sc1
buffer_store_dwordx4 v[36:39], v9, s[4:7], s3 offen offset:1024 sc0 sc1
buffer_store_dwordx4 v[36:39], v9, s[4:7], s3 offen offset:2048 sc0 sc1
buffer_store_dwordx4 v[36:39], v9, s[4:7], s3 offen offset:3072 sc0 sc1
s_getreg_b32 s56, hwreg(HW_REG_XCC_ID)
s_and_b32 s56, s56, 15
s_mul_i32 s57, s56, s56
s_lshl_b32 s57, s57, 18
s_lshl_b32 s56, s56, 8
s_add_u32 s57, s57, s56
s_add_u32 s58, s57, 1
s_lshl_b32 s101, s32, 7
s_add_u32 s101, s101, 327680
v_mov_b32 v24, 0
s_add_u32 s56, s54, 262144
s_mov_b32 m0, 110592
s_nop 0
buffer_load_dwordx4 v26, s[12:15], s56 offen lds
s_add_u32 s56, s54, 278528
s_mov_b32 m0, 111616
s_nop 0
buffer_load_dwordx4 v26, s[12:15], s56 offen lds
s_add_u32 s56, s54, 294912
s_mov_b32 m0, 112640
s_nop 0
buffer_load_dwordx4 v27, s[12:15], s56 offen lds
s_add_u32 s56, s54, 311296
s_mov_b32 m0, 113664
s_nop 0
buffer_load_dwordx4 v27, s[12:15], s56 offen lds
s_add_u32 s56, s54, 786432
s_mov_b32 m0, 114688
s_nop 0
buffer_load_dwordx4 v26, s[12:15], s56 offen lds
s_add_u32 s56, s54, 802816
s_mov_b32 m0, 115712
s_nop 0
buffer_load_dwordx4 v26, s[12:15], s56 offen lds
s_add_u32 s56, s54, 819200
s_mov_b32 m0, 116736
s_nop 0
buffer_load_dwordx4 v27, s[12:15], s56 offen lds
s_add_u32 s56, s54, 835584
s_mov_b32 m0, 117760
s_nop 0
buffer_load_dwordx4 v27, s[12:15], s56 offen lds
v_mov_b32 v24, 0
s_waitcnt vmcnt(37)
s_barrier
ds_read_b64_tr_b16 v[80:81], v44 offset:20480
ds_read_b64_tr_b16 v[82:83], v44 offset:21504
ds_read_b64_tr_b16 v[84:85], v46 offset:20480
ds_read_b64_tr_b16 v[86:87], v46 offset:21504
ds_read_b64_tr_b16 v[88:89], v45 offset:20480
ds_read_b64_tr_b16 v[90:91], v45 offset:21504
ds_read_b64_tr_b16 v[92:93], v47 offset:20480
ds_read_b64_tr_b16 v[94:95], v47 offset:21504
s_waitcnt lgkmcnt(0)
s_waitcnt vmcnt(33)
s_barrier
s_add_u32 s56, s54, 1310720
s_mov_b32 m0, 118784
s_nop 0
buffer_load_dwordx4 v26, s[12:15], s56 offen lds
s_add_u32 s56, s54, 1327104
s_mov_b32 m0, 119808
s_nop 0
buffer_load_dwordx4 v26, s[12:15], s56 offen lds
s_add_u32 s56, s54, 1343488
s_mov_b32 m0, 120832
s_nop 0
buffer_load_dwordx4 v27, s[12:15], s56 offen lds
s_add_u32 s56, s54, 1359872
s_mov_b32 m0, 121856
s_nop 0
buffer_load_dwordx4 v27, s[12:15], s56 offen lds
ds_read_b64_tr_b16 v[96:97], v44 offset:24576
ds_read_b64_tr_b16 v[98:99], v44 offset:25600
ds_read_b64_tr_b16 v[100:101], v46 offset:24576
ds_read_b64_tr_b16 v[102:103], v46 offset:25600
ds_read_b64_tr_b16 v[104:105], v45 offset:24576
ds_read_b64_tr_b16 v[106:107], v45 offset:25600
ds_read_b64_tr_b16 v[108:109], v47 offset:24576
ds_read_b64_tr_b16 v[110:111], v47 offset:25600
s_waitcnt lgkmcnt(0)
s_waitcnt vmcnt(33)
s_barrier
s_add_u32 s56, s54, 1835008
s_mov_b32 m0, 122880
s_nop 0
buffer_load_dwordx4 v26, s[12:15], s56 offen lds
s_add_u32 s56, s54, 1851392
s_mov_b32 m0, 123904
s_nop 0
buffer_load_dwordx4 v26, s[12:15], s56 offen lds
s_add_u32 s56, s54, 1867776
s_mov_b32 m0, 124928
s_nop 0
buffer_load_dwordx4 v27, s[12:15], s56 offen lds
s_add_u32 s56, s54, 1884160
s_mov_b32 m0, 125952
s_nop 0
buffer_load_dwordx4 v27, s[12:15], s56 offen lds
ds_read_b64_tr_b16 v[112:113], v44 offset:28672
ds_read_b64_tr_b16 v[114:115], v44 offset:29696
ds_read_b64_tr_b16 v[116:117], v46 offset:28672
ds_read_b64_tr_b16 v[118:119], v46 offset:29696
ds_read_b64_tr_b16 v[120:121], v45 offset:28672
ds_read_b64_tr_b16 v[122:123], v45 offset:29696
ds_read_b64_tr_b16 v[124:125], v47 offset:28672
ds_read_b64_tr_b16 v[126:127], v47 offset:29696
s_waitcnt lgkmcnt(0)
s_waitcnt vmcnt(33)
s_barrier
s_add_u32 s56, s54, 2359296
s_mov_b32 m0, 126976
s_nop 0
buffer_load_dwordx4 v26, s[12:15], s56 offen lds
s_add_u32 s56, s54, 2375680
s_mov_b32 m0, 128000
s_nop 0
buffer_load_dwordx4 v26, s[12:15], s56 offen lds
s_add_u32 s56, s54, 2392064
s_mov_b32 m0, 129024
s_nop 0
buffer_load_dwordx4 v27, s[12:15], s56 offen lds
s_add_u32 s56, s54, 2408448
s_mov_b32 m0, 130048
s_nop 0
buffer_load_dwordx4 v27, s[12:15], s56 offen lds
ds_read_b64_tr_b16 v[128:129], v44 offset:0
ds_read_b64_tr_b16 v[130:131], v44 offset:1024
ds_read_b64_tr_b16 v[132:133], v46 offset:0
ds_read_b64_tr_b16 v[134:135], v46 offset:1024
ds_read_b64_tr_b16 v[136:137], v45 offset:0
ds_read_b64_tr_b16 v[138:139], v45 offset:1024
ds_read_b64_tr_b16 v[140:141], v47 offset:0
ds_read_b64_tr_b16 v[142:143], v47 offset:1024
s_waitcnt lgkmcnt(0)
s_waitcnt vmcnt(33)
s_barrier
s_add_u32 s56, s54, 3407872
s_mov_b32 m0, 98304
s_nop 0
buffer_load_dwordx4 v26, s[12:15], s56 offen lds
s_add_u32 s56, s54, 3424256
s_mov_b32 m0, 99328
s_nop 0
buffer_load_dwordx4 v26, s[12:15], s56 offen lds
s_add_u32 s56, s54, 3440640
s_mov_b32 m0, 100352
s_nop 0
buffer_load_dwordx4 v27, s[12:15], s56 offen lds
s_add_u32 s56, s54, 3457024
s_mov_b32 m0, 101376
s_nop 0
buffer_load_dwordx4 v27, s[12:15], s56 offen lds
ds_read_b64_tr_b16 v[144:145], v44 offset:4096
ds_read_b64_tr_b16 v[146:147], v44 offset:5120
ds_read_b64_tr_b16 v[148:149], v46 offset:4096
ds_read_b64_tr_b16 v[150:151], v46 offset:5120
ds_read_b64_tr_b16 v[152:153], v45 offset:4096
ds_read_b64_tr_b16 v[154:155], v45 offset:5120
ds_read_b64_tr_b16 v[156:157], v47 offset:4096
ds_read_b64_tr_b16 v[158:159], v47 offset:5120
s_waitcnt lgkmcnt(0)
s_waitcnt vmcnt(33)
s_barrier
s_add_u32 s56, s54, 3932160
s_mov_b32 m0, 102400
s_nop 0
buffer_load_dwordx4 v26, s[12:15], s56 offen lds
s_add_u32 s56, s54, 3948544
s_mov_b32 m0, 103424
s_nop 0
buffer_load_dwordx4 v26, s[12:15], s56 offen lds
s_add_u32 s56, s54, 3964928
s_mov_b32 m0, 104448
s_nop 0
buffer_load_dwordx4 v27, s[12:15], s56 offen lds
s_add_u32 s56, s54, 3981312
s_mov_b32 m0, 105472
s_nop 0
buffer_load_dwordx4 v27, s[12:15], s56 offen lds
ds_read_b64_tr_b16 v[160:161], v44 offset:8192
ds_read_b64_tr_b16 v[162:163], v44 offset:9216
ds_read_b64_tr_b16 v[164:165], v46 offset:8192
ds_read_b64_tr_b16 v[166:167], v46 offset:9216
ds_read_b64_tr_b16 v[168:169], v45 offset:8192
ds_read_b64_tr_b16 v[170:171], v45 offset:9216
ds_read_b64_tr_b16 v[172:173], v47 offset:8192
ds_read_b64_tr_b16 v[174:175], v47 offset:9216
s_waitcnt lgkmcnt(0)
s_waitcnt vmcnt(24)
s_barrier
s_add_u32 s56, s54, 4456448
s_mov_b32 m0, 106496
s_nop 0
buffer_load_dwordx4 v26, s[12:15], s56 offen lds
s_add_u32 s56, s54, 4472832
s_mov_b32 m0, 107520
s_nop 0
buffer_load_dwordx4 v26, s[12:15], s56 offen lds
s_add_u32 s56, s54, 4489216
s_mov_b32 m0, 108544
s_nop 0
buffer_load_dwordx4 v27, s[12:15], s56 offen lds
s_add_u32 s56, s54, 4505600
s_mov_b32 m0, 109568
s_nop 0
buffer_load_dwordx4 v27, s[12:15], s56 offen lds
ds_read_b64_tr_b16 v[176:177], v44 offset:12288
ds_read_b64_tr_b16 v[178:179], v44 offset:13312
ds_read_b64_tr_b16 v[180:181], v46 offset:12288
ds_read_b64_tr_b16 v[182:183], v46 offset:13312
ds_read_b64_tr_b16 v[184:185], v45 offset:12288
ds_read_b64_tr_b16 v[186:187], v45 offset:13312
ds_read_b64_tr_b16 v[188:189], v47 offset:12288
ds_read_b64_tr_b16 v[190:191], v47 offset:13312
s_waitcnt lgkmcnt(0)
s_waitcnt vmcnt(24)
s_barrier
s_add_u32 s56, s54, 262144
s_mov_b32 m0, 110592
s_nop 0
buffer_load_dwordx4 v26, s[16:19], s56 offen lds
s_add_u32 s56, s54, 278528
s_mov_b32 m0, 111616
s_nop 0
buffer_load_dwordx4 v26, s[16:19], s56 offen lds
s_add_u32 s56, s54, 294912
s_mov_b32 m0, 112640
s_nop 0
buffer_load_dwordx4 v27, s[16:19], s56 offen lds
s_add_u32 s56, s54, 311296
s_mov_b32 m0, 113664
s_nop 0
buffer_load_dwordx4 v27, s[16:19], s56 offen lds
ds_read_b64_tr_b16 v[192:193], v44 offset:16384
ds_read_b64_tr_b16 v[194:195], v44 offset:17408
ds_read_b64_tr_b16 v[196:197], v46 offset:16384
ds_read_b64_tr_b16 v[198:199], v46 offset:17408
ds_read_b64_tr_b16 v[200:201], v45 offset:16384
ds_read_b64_tr_b16 v[202:203], v45 offset:17408
ds_read_b64_tr_b16 v[204:205], v47 offset:16384
ds_read_b64_tr_b16 v[206:207], v47 offset:17408
s_waitcnt lgkmcnt(0)
s_waitcnt vmcnt(24)
s_barrier
s_add_u32 s56, s54, 786432
s_mov_b32 m0, 114688
s_nop 0
buffer_load_dwordx4 v26, s[16:19], s56 offen lds
s_add_u32 s56, s54, 802816
s_mov_b32 m0, 115712
s_nop 0
buffer_load_dwordx4 v26, s[16:19], s56 offen lds
s_add_u32 s56, s54, 819200
s_mov_b32 m0, 116736
s_nop 0
buffer_load_dwordx4 v27, s[16:19], s56 offen lds
s_add_u32 s56, s54, 835584
s_mov_b32 m0, 117760
s_nop 0
buffer_load_dwordx4 v27, s[16:19], s56 offen lds
ds_read_b64_tr_b16 v[208:209], v44 offset:20480
ds_read_b64_tr_b16 v[210:211], v44 offset:21504
ds_read_b64_tr_b16 v[212:213], v46 offset:20480
ds_read_b64_tr_b16 v[214:215], v46 offset:21504
ds_read_b64_tr_b16 v[216:217], v45 offset:20480
ds_read_b64_tr_b16 v[218:219], v45 offset:21504
ds_read_b64_tr_b16 v[220:221], v47 offset:20480
ds_read_b64_tr_b16 v[222:223], v47 offset:21504
s_waitcnt lgkmcnt(0)
s_waitcnt vmcnt(24)
s_barrier
s_add_u32 s56, s54, 1310720
s_mov_b32 m0, 118784
s_nop 0
buffer_load_dwordx4 v26, s[16:19], s56 offen lds
s_add_u32 s56, s54, 1327104
s_mov_b32 m0, 119808
s_nop 0
buffer_load_dwordx4 v26, s[16:19], s56 offen lds
s_add_u32 s56, s54, 1343488
s_mov_b32 m0, 120832
s_nop 0
buffer_load_dwordx4 v27, s[16:19], s56 offen lds
s_add_u32 s56, s54, 1359872
s_mov_b32 m0, 121856
s_nop 0
buffer_load_dwordx4 v27, s[16:19], s56 offen lds
ds_read_b64_tr_b16 v[224:225], v44 offset:24576
ds_read_b64_tr_b16 v[226:227], v44 offset:25600
ds_read_b64_tr_b16 v[228:229], v46 offset:24576
ds_read_b64_tr_b16 v[230:231], v46 offset:25600
ds_read_b64_tr_b16 v[232:233], v45 offset:24576
ds_read_b64_tr_b16 v[234:235], v45 offset:25600
ds_read_b64_tr_b16 v[236:237], v47 offset:24576
ds_read_b64_tr_b16 v[238:239], v47 offset:25600
s_waitcnt lgkmcnt(0)
s_waitcnt vmcnt(24)
s_barrier
s_add_u32 s56, s54, 1835008
s_mov_b32 m0, 122880
s_nop 0
buffer_load_dwordx4 v26, s[16:19], s56 offen lds
s_add_u32 s56, s54, 1851392
s_mov_b32 m0, 123904
s_nop 0
buffer_load_dwordx4 v26, s[16:19], s56 offen lds
s_add_u32 s56, s54, 1867776
s_mov_b32 m0, 124928
s_nop 0
buffer_load_dwordx4 v27, s[16:19], s56 offen lds
s_add_u32 s56, s54, 1884160
s_mov_b32 m0, 125952
s_nop 0
buffer_load_dwordx4 v27, s[16:19], s56 offen lds
ds_read_b64_tr_b16 v[240:241], v44 offset:28672
ds_read_b64_tr_b16 v[242:243], v44 offset:29696
ds_read_b64_tr_b16 v[244:245], v46 offset:28672
ds_read_b64_tr_b16 v[246:247], v46 offset:29696
ds_read_b64_tr_b16 v[248:249], v45 offset:28672
ds_read_b64_tr_b16 v[250:251], v45 offset:29696
ds_read_b64_tr_b16 v[252:253], v47 offset:28672
ds_read_b64_tr_b16 v[254:255], v47 offset:29696
s_waitcnt lgkmcnt(0)
s_waitcnt vmcnt(24)
s_barrier
s_add_u32 s56, s54, 2359296
s_mov_b32 m0, 126976
s_nop 0
buffer_load_dwordx4 v26, s[16:19], s56 offen lds
s_add_u32 s56, s54, 2375680
s_mov_b32 m0, 128000
s_nop 0
buffer_load_dwordx4 v26, s[16:19], s56 offen lds
s_add_u32 s56, s54, 2392064
s_mov_b32 m0, 129024
s_nop 0
buffer_load_dwordx4 v27, s[16:19], s56 offen lds
s_add_u32 s56, s54, 2408448
s_mov_b32 m0, 130048
s_nop 0
buffer_load_dwordx4 v27, s[16:19], s56 offen lds
ds_read_b64_tr_b16 a[0:1], v44 offset:0
ds_read_b64_tr_b16 a[2:3], v44 offset:1024
ds_read_b64_tr_b16 a[4:5], v46 offset:0
ds_read_b64_tr_b16 a[6:7], v46 offset:1024
ds_read_b64_tr_b16 a[8:9], v45 offset:0
ds_read_b64_tr_b16 a[10:11], v45 offset:1024
ds_read_b64_tr_b16 a[12:13], v47 offset:0
ds_read_b64_tr_b16 a[14:15], v47 offset:1024
s_waitcnt lgkmcnt(0)
s_waitcnt vmcnt(24)
s_barrier
s_add_u32 s56, s54, 2883584
s_mov_b32 m0, 98304
s_nop 0
buffer_load_dwordx4 v26, s[16:19], s56 offen lds
s_add_u32 s56, s54, 2899968
s_mov_b32 m0, 99328
s_nop 0
buffer_load_dwordx4 v26, s[16:19], s56 offen lds
s_add_u32 s56, s54, 2916352
s_mov_b32 m0, 100352
s_nop 0
buffer_load_dwordx4 v27, s[16:19], s56 offen lds
s_add_u32 s56, s54, 2932736
s_mov_b32 m0, 101376
s_nop 0
buffer_load_dwordx4 v27, s[16:19], s56 offen lds
ds_read_b64_tr_b16 a[16:17], v44 offset:4096
ds_read_b64_tr_b16 a[18:19], v44 offset:5120
ds_read_b64_tr_b16 a[20:21], v46 offset:4096
ds_read_b64_tr_b16 a[22:23], v46 offset:5120
ds_read_b64_tr_b16 a[24:25], v45 offset:4096
ds_read_b64_tr_b16 a[26:27], v45 offset:5120
ds_read_b64_tr_b16 a[28:29], v47 offset:4096
ds_read_b64_tr_b16 a[30:31], v47 offset:5120
s_waitcnt lgkmcnt(0)
s_waitcnt vmcnt(24)
s_barrier
s_add_u32 s56, s54, 3407872
s_mov_b32 m0, 102400
s_nop 0
buffer_load_dwordx4 v26, s[16:19], s56 offen lds
s_add_u32 s56, s54, 3424256
s_mov_b32 m0, 103424
s_nop 0
buffer_load_dwordx4 v26, s[16:19], s56 offen lds
s_add_u32 s56, s54, 3440640
s_mov_b32 m0, 104448
s_nop 0
buffer_load_dwordx4 v27, s[16:19], s56 offen lds
s_add_u32 s56, s54, 3457024
s_mov_b32 m0, 105472
s_nop 0
buffer_load_dwordx4 v27, s[16:19], s56 offen lds
ds_read_b64_tr_b16 a[32:33], v44 offset:8192
ds_read_b64_tr_b16 a[34:35], v44 offset:9216
ds_read_b64_tr_b16 a[36:37], v46 offset:8192
ds_read_b64_tr_b16 a[38:39], v46 offset:9216
ds_read_b64_tr_b16 a[40:41], v45 offset:8192
ds_read_b64_tr_b16 a[42:43], v45 offset:9216
ds_read_b64_tr_b16 a[44:45], v47 offset:8192
ds_read_b64_tr_b16 a[46:47], v47 offset:9216
s_waitcnt lgkmcnt(0)
s_waitcnt vmcnt(24)
s_barrier
s_add_u32 s56, s54, 3932160
s_mov_b32 m0, 106496
s_nop 0
buffer_load_dwordx4 v26, s[16:19], s56 offen lds
s_add_u32 s56, s54, 3948544
s_mov_b32 m0, 107520
s_nop 0
buffer_load_dwordx4 v26, s[16:19], s56 offen lds
s_add_u32 s56, s54, 3964928
s_mov_b32 m0, 108544
s_nop 0
buffer_load_dwordx4 v27, s[16:19], s56 offen lds
s_add_u32 s56, s54, 3981312
s_mov_b32 m0, 109568
s_nop 0
buffer_load_dwordx4 v27, s[16:19], s56 offen lds
ds_read_b64_tr_b16 a[48:49], v44 offset:12288
ds_read_b64_tr_b16 a[50:51], v44 offset:13312
ds_read_b64_tr_b16 a[52:53], v46 offset:12288
ds_read_b64_tr_b16 a[54:55], v46 offset:13312
ds_read_b64_tr_b16 a[56:57], v45 offset:12288
ds_read_b64_tr_b16 a[58:59], v45 offset:13312
ds_read_b64_tr_b16 a[60:61], v47 offset:12288
ds_read_b64_tr_b16 a[62:63], v47 offset:13312
s_waitcnt lgkmcnt(0)
s_waitcnt vmcnt(24)
s_barrier
s_add_u32 s56, s55, 110592
s_mov_b32 m0, 110592
s_nop 0
buffer_load_dwordx4 v28, s[20:23], s56 offen lds
s_add_u32 s56, s55, 112896
s_mov_b32 m0, 111616
s_nop 0
buffer_load_dwordx4 v28, s[20:23], s56 offen lds
s_add_u32 s56, s55, 119808
s_mov_b32 m0, 112640
s_nop 0
buffer_load_dwordx4 v28, s[20:23], s56 offen lds
s_add_u32 s56, s55, 122112
s_mov_b32 m0, 113664
s_nop 0
buffer_load_dwordx4 v28, s[20:23], s56 offen lds
ds_read_b64_tr_b16 a[64:65], v44 offset:16384
ds_read_b64_tr_b16 a[66:67], v44 offset:17408
ds_read_b64_tr_b16 a[68:69], v46 offset:16384
ds_read_b64_tr_b16 a[70:71], v46 offset:17408
ds_read_b64_tr_b16 a[72:73], v45 offset:16384
ds_read_b64_tr_b16 a[74:75], v45 offset:17408
ds_read_b64_tr_b16 a[76:77], v47 offset:16384
ds_read_b64_tr_b16 a[78:79], v47 offset:17408
s_waitcnt lgkmcnt(0)
s_waitcnt vmcnt(24)
s_barrier
s_add_u32 s56, s55, 110848
s_mov_b32 m0, 114688
s_nop 0
buffer_load_dwordx4 v28, s[20:23], s56 offen lds
s_add_u32 s56, s55, 113152
s_mov_b32 m0, 115712
s_nop 0
buffer_load_dwordx4 v28, s[20:23], s56 offen lds
s_add_u32 s56, s55, 120064
s_mov_b32 m0, 116736
s_nop 0
buffer_load_dwordx4 v28, s[20:23], s56 offen lds
s_add_u32 s56, s55, 122368
s_mov_b32 m0, 117760
s_nop 0
buffer_load_dwordx4 v28, s[20:23], s56 offen lds
ds_read_b64_tr_b16 a[80:81], v44 offset:20480
ds_read_b64_tr_b16 a[82:83], v44 offset:21504
ds_read_b64_tr_b16 a[84:85], v46 offset:20480
ds_read_b64_tr_b16 a[86:87], v46 offset:21504
ds_read_b64_tr_b16 a[88:89], v45 offset:20480
ds_read_b64_tr_b16 a[90:91], v45 offset:21504
ds_read_b64_tr_b16 a[92:93], v47 offset:20480
ds_read_b64_tr_b16 a[94:95], v47 offset:21504
s_waitcnt lgkmcnt(0)
s_waitcnt vmcnt(24)
s_barrier
s_add_u32 s56, s55, 111104
s_mov_b32 m0, 118784
s_nop 0
buffer_load_dwordx4 v28, s[20:23], s56 offen lds
s_add_u32 s56, s55, 113408
s_mov_b32 m0, 119808
s_nop 0
buffer_load_dwordx4 v28, s[20:23], s56 offen lds
s_add_u32 s56, s55, 120320
s_mov_b32 m0, 120832
s_nop 0
buffer_load_dwordx4 v28, s[20:23], s56 offen lds
s_add_u32 s56, s55, 122624
s_mov_b32 m0, 121856
s_nop 0
buffer_load_dwordx4 v28, s[20:23], s56 offen lds
ds_read_b64_tr_b16 a[96:97], v44 offset:24576
ds_read_b64_tr_b16 a[98:99], v44 offset:25600
ds_read_b64_tr_b16 a[100:101], v46 offset:24576
ds_read_b64_tr_b16 a[102:103], v46 offset:25600
ds_read_b64_tr_b16 a[104:105], v45 offset:24576
ds_read_b64_tr_b16 a[106:107], v45 offset:25600
ds_read_b64_tr_b16 a[108:109], v47 offset:24576
ds_read_b64_tr_b16 a[110:111], v47 offset:25600
s_waitcnt lgkmcnt(0)
s_waitcnt vmcnt(24)
s_barrier
s_add_u32 s56, s55, 111360
s_mov_b32 m0, 122880
s_nop 0
buffer_load_dwordx4 v28, s[20:23], s56 offen lds
s_add_u32 s56, s55, 113664
s_mov_b32 m0, 123904
s_nop 0
buffer_load_dwordx4 v28, s[20:23], s56 offen lds
s_add_u32 s56, s55, 120576
s_mov_b32 m0, 124928
s_nop 0
buffer_load_dwordx4 v28, s[20:23], s56 offen lds
s_add_u32 s56, s55, 122880
s_mov_b32 m0, 125952
s_nop 0
buffer_load_dwordx4 v28, s[20:23], s56 offen lds
ds_read_b64_tr_b16 a[112:113], v44 offset:28672
ds_read_b64_tr_b16 a[114:115], v44 offset:29696
ds_read_b64_tr_b16 a[116:117], v46 offset:28672
ds_read_b64_tr_b16 a[118:119], v46 offset:29696
ds_read_b64_tr_b16 a[120:121], v45 offset:28672
ds_read_b64_tr_b16 a[122:123], v45 offset:29696
ds_read_b64_tr_b16 a[124:125], v47 offset:28672
ds_read_b64_tr_b16 a[126:127], v47 offset:29696
s_waitcnt lgkmcnt(0)
s_waitcnt vmcnt(24)
s_barrier
s_add_u32 s56, s55, 36864
s_mov_b32 m0, 126976
s_nop 0
buffer_load_dwordx4 v28, s[20:23], s56 offen lds
s_add_u32 s56, s55, 39168
s_mov_b32 m0, 128000
s_nop 0
buffer_load_dwordx4 v28, s[20:23], s56 offen lds
s_add_u32 s56, s55, 46080
s_mov_b32 m0, 129024
s_nop 0
buffer_load_dwordx4 v28, s[20:23], s56 offen lds
s_add_u32 s56, s55, 48384
s_mov_b32 m0, 130048
s_nop 0
buffer_load_dwordx4 v28, s[20:23], s56 offen lds
ds_read_b64_tr_b16 a[128:129], v44 offset:0
ds_read_b64_tr_b16 a[130:131], v44 offset:1024
ds_read_b64_tr_b16 a[132:133], v46 offset:0
ds_read_b64_tr_b16 a[134:135], v46 offset:1024
ds_read_b64_tr_b16 a[136:137], v45 offset:0
ds_read_b64_tr_b16 a[138:139], v45 offset:1024
ds_read_b64_tr_b16 a[140:141], v47 offset:0
ds_read_b64_tr_b16 a[142:143], v47 offset:1024
buffer_load_dword v32, v24, s[28:31], 0 offen sc0 sc1
s_waitcnt lgkmcnt(0)
s_waitcnt vmcnt(25)
s_barrier
s_add_u32 s56, s54, 262144
s_mov_b32 m0, 98304
s_nop 0
buffer_load_dwordx4 v26, s[8:11], s56 offen lds
s_add_u32 s56, s54, 278528
s_mov_b32 m0, 99328
s_nop 0
buffer_load_dwordx4 v26, s[8:11], s56 offen lds
s_add_u32 s56, s54, 294912
s_mov_b32 m0, 100352
s_nop 0
buffer_load_dwordx4 v27, s[8:11], s56 offen lds
s_add_u32 s56, s54, 311296
s_mov_b32 m0, 101376
s_nop 0
buffer_load_dwordx4 v27, s[8:11], s56 offen lds
ds_read_b64_tr_b16 a[144:145], v44 offset:4096
ds_read_b64_tr_b16 a[146:147], v44 offset:5120
ds_read_b64_tr_b16 a[148:149], v46 offset:4096
ds_read_b64_tr_b16 a[150:151], v46 offset:5120
ds_read_b64_tr_b16 a[152:153], v45 offset:4096
ds_read_b64_tr_b16 a[154:155], v45 offset:5120
ds_read_b64_tr_b16 a[156:157], v47 offset:4096
ds_read_b64_tr_b16 a[158:159], v47 offset:5120
s_waitcnt lgkmcnt(0)
s_waitcnt vmcnt(25)
s_barrier
s_add_u32 s56, s54, 1835008
s_mov_b32 m0, 102400
s_nop 0
buffer_load_dwordx4 v26, s[8:11], s56 offen lds
s_add_u32 s56, s54, 1851392
s_mov_b32 m0, 103424
s_nop 0
buffer_load_dwordx4 v26, s[8:11], s56 offen lds
s_add_u32 s56, s54, 1867776
s_mov_b32 m0, 104448
s_nop 0
buffer_load_dwordx4 v27, s[8:11], s56 offen lds
s_add_u32 s56, s54, 1884160
s_mov_b32 m0, 105472
s_nop 0
buffer_load_dwordx4 v27, s[8:11], s56 offen lds
ds_read_b64_tr_b16 a[160:161], v44 offset:8192
ds_read_b64_tr_b16 a[162:163], v44 offset:9216
ds_read_b64_tr_b16 a[164:165], v46 offset:8192
ds_read_b64_tr_b16 a[166:167], v46 offset:9216
ds_read_b64_tr_b16 a[168:169], v45 offset:8192
ds_read_b64_tr_b16 a[170:171], v45 offset:9216
ds_read_b64_tr_b16 a[172:173], v47 offset:8192
ds_read_b64_tr_b16 a[174:175], v47 offset:9216
s_waitcnt lgkmcnt(0)
s_waitcnt vmcnt(25)
s_barrier
s_add_u32 s56, s54, 2359296
s_mov_b32 m0, 106496
s_nop 0
buffer_load_dwordx4 v26, s[8:11], s56 offen lds
s_add_u32 s56, s54, 2375680
s_mov_b32 m0, 107520
s_nop 0
buffer_load_dwordx4 v26, s[8:11], s56 offen lds
s_add_u32 s56, s54, 2392064
s_mov_b32 m0, 108544
s_nop 0
buffer_load_dwordx4 v27, s[8:11], s56 offen lds
s_add_u32 s56, s54, 2408448
s_mov_b32 m0, 109568
s_nop 0
buffer_load_dwordx4 v27, s[8:11], s56 offen lds
ds_read_b64_tr_b16 a[176:177], v48 offset:12288
ds_read_b64_tr_b16 a[178:179], v48 offset:13312
ds_read_b64_tr_b16 a[180:181], v48 offset:14336
ds_read_b64_tr_b16 a[182:183], v48 offset:15360
ds_read_b64_tr_b16 a[216:217], v49 offset:12288
ds_read_b64_tr_b16 a[218:219], v49 offset:13312
ds_read_b64_tr_b16 a[220:221], v49 offset:14336
ds_read_b64_tr_b16 a[222:223], v49 offset:15360
s_waitcnt lgkmcnt(0)
s_waitcnt vmcnt(25)
s_barrier
s_add_u32 s56, s54, 2883584
s_mov_b32 m0, 110592
s_nop 0
buffer_load_dwordx4 v26, s[12:15], s56 offen lds
s_add_u32 s56, s54, 2899968
s_mov_b32 m0, 111616
s_nop 0
buffer_load_dwordx4 v26, s[12:15], s56 offen lds
s_add_u32 s56, s54, 2916352
s_mov_b32 m0, 112640
s_nop 0
buffer_load_dwordx4 v27, s[12:15], s56 offen lds
s_add_u32 s56, s54, 2932736
s_mov_b32 m0, 113664
s_nop 0
buffer_load_dwordx4 v27, s[12:15], s56 offen lds
ds_read_b64_tr_b16 a[184:185], v48 offset:16384
ds_read_b64_tr_b16 a[186:187], v48 offset:17408
ds_read_b64_tr_b16 a[188:189], v48 offset:18432
ds_read_b64_tr_b16 a[190:191], v48 offset:19456
ds_read_b64_tr_b16 a[232:233], v49 offset:16384
ds_read_b64_tr_b16 a[234:235], v49 offset:17408
ds_read_b64_tr_b16 a[236:237], v49 offset:18432
ds_read_b64_tr_b16 a[238:239], v49 offset:19456
s_waitcnt lgkmcnt(0)
s_waitcnt vmcnt(25)
s_barrier
s_add_u32 s56, s54, 4456448
s_mov_b32 m0, 114688
s_nop 0
buffer_load_dwordx4 v26, s[16:19], s56 offen lds
s_add_u32 s56, s54, 4472832
s_mov_b32 m0, 115712
s_nop 0
buffer_load_dwordx4 v26, s[16:19], s56 offen lds
s_add_u32 s56, s54, 4489216
s_mov_b32 m0, 116736
s_nop 0
buffer_load_dwordx4 v27, s[16:19], s56 offen lds
s_add_u32 s56, s54, 4505600
s_mov_b32 m0, 117760
s_nop 0
buffer_load_dwordx4 v27, s[16:19], s56 offen lds
ds_read_b64_tr_b16 a[192:193], v48 offset:20480
ds_read_b64_tr_b16 a[194:195], v48 offset:21504
ds_read_b64_tr_b16 a[196:197], v48 offset:22528
ds_read_b64_tr_b16 a[198:199], v48 offset:23552
ds_read_b64_tr_b16 a[240:241], v49 offset:20480
ds_read_b64_tr_b16 a[242:243], v49 offset:21504
ds_read_b64_tr_b16 a[244:245], v49 offset:22528
ds_read_b64_tr_b16 a[246:247], v49 offset:23552
s_waitcnt lgkmcnt(0)
s_waitcnt vmcnt(25)
s_barrier
s_add_u32 s56, s55, 37120
s_mov_b32 m0, 118784
s_nop 0
buffer_load_dwordx4 v28, s[20:23], s56 offen lds
s_add_u32 s56, s55, 39424
s_mov_b32 m0, 119808
s_nop 0
buffer_load_dwordx4 v28, s[20:23], s56 offen lds
s_add_u32 s56, s55, 46336
s_mov_b32 m0, 120832
s_nop 0
buffer_load_dwordx4 v28, s[20:23], s56 offen lds
s_add_u32 s56, s55, 48640
s_mov_b32 m0, 121856
s_nop 0
buffer_load_dwordx4 v28, s[20:23], s56 offen lds
ds_read_b64_tr_b16 a[200:201], v48 offset:24576
ds_read_b64_tr_b16 a[202:203], v48 offset:25600
ds_read_b64_tr_b16 a[204:205], v48 offset:26624
ds_read_b64_tr_b16 a[206:207], v48 offset:27648
ds_read_b64_tr_b16 a[248:249], v49 offset:24576
ds_read_b64_tr_b16 a[250:251], v49 offset:25600
ds_read_b64_tr_b16 a[252:253], v49 offset:26624
ds_read_b64_tr_b16 a[254:255], v49 offset:27648
s_waitcnt lgkmcnt(0)
s_waitcnt vmcnt(25)
s_barrier
s_add_u32 s56, s55, 37376
s_mov_b32 m0, 122880
s_nop 0
buffer_load_dwordx4 v28, s[20:23], s56 offen lds
s_add_u32 s56, s55, 39680
s_mov_b32 m0, 123904
s_nop 0
buffer_load_dwordx4 v28, s[20:23], s56 offen lds
s_add_u32 s56, s55, 46592
s_mov_b32 m0, 124928
s_nop 0
buffer_load_dwordx4 v28, s[20:23], s56 offen lds
s_add_u32 s56, s55, 48896
s_mov_b32 m0, 125952
s_nop 0
buffer_load_dwordx4 v28, s[20:23], s56 offen lds
ds_read_b64_tr_b16 a[208:209], v48 offset:28672
ds_read_b64_tr_b16 a[210:211], v48 offset:29696
ds_read_b64_tr_b16 a[212:213], v48 offset:30720
ds_read_b64_tr_b16 a[214:215], v48 offset:31744
ds_read_b64_tr_b16 a[224:225], v49 offset:28672
ds_read_b64_tr_b16 a[226:227], v49 offset:29696
ds_read_b64_tr_b16 a[228:229], v49 offset:30720
ds_read_b64_tr_b16 a[230:231], v49 offset:31744
s_waitcnt lgkmcnt(0)
s_waitcnt vmcnt(24)
s_barrier
s_add_u32 s56, s55, 37632
s_mov_b32 m0, 126976
s_nop 0
buffer_load_dwordx4 v28, s[20:23], s56 offen lds
s_add_u32 s56, s55, 39936
s_mov_b32 m0, 128000
s_nop 0
buffer_load_dwordx4 v28, s[20:23], s56 offen lds
s_add_u32 s56, s55, 46848
s_mov_b32 m0, 129024
s_nop 0
buffer_load_dwordx4 v28, s[20:23], s56 offen lds
s_add_u32 s56, s55, 49152
s_mov_b32 m0, 130048
s_nop 0
buffer_load_dwordx4 v28, s[20:23], s56 offen lds
ds_read_b64_tr_b16 v[60:61], v44 offset:0
ds_read_b64_tr_b16 v[62:63], v44 offset:1024
ds_read_b64_tr_b16 v[64:65], v46 offset:0
ds_read_b64_tr_b16 v[66:67], v46 offset:1024
ds_read_b64_tr_b16 v[68:69], v45 offset:0
ds_read_b64_tr_b16 v[70:71], v45 offset:1024
ds_read_b64_tr_b16 v[72:73], v47 offset:0
ds_read_b64_tr_b16 v[74:75], v47 offset:1024
s_waitcnt lgkmcnt(0)
s_waitcnt vmcnt(24)
s_barrier
ds_write_b128 v2, v[60:63] offset:0
ds_write_b128 v2, v[64:67] offset:1024
ds_write_b128 v2, v[68:71] offset:2048
ds_write_b128 v2, v[72:75] offset:3072
ds_read_b64_tr_b16 v[60:61], v44 offset:4096
ds_read_b64_tr_b16 v[62:63], v44 offset:5120
ds_read_b64_tr_b16 v[64:65], v46 offset:4096
ds_read_b64_tr_b16 v[66:67], v46 offset:5120
ds_read_b64_tr_b16 v[68:69], v45 offset:4096
ds_read_b64_tr_b16 v[70:71], v45 offset:5120
ds_read_b64_tr_b16 v[72:73], v47 offset:4096
ds_read_b64_tr_b16 v[74:75], v47 offset:5120
L_rdv_w2r:
v_readfirstlane_b32 s38, v32
s_nop 0
s_and_b32 s57, s38, 0xff
s_cmp_lg_u32 s57, 32
s_cbranch_scc1 L_rdv2_w2r
s_waitcnt lgkmcnt(0)
s_waitcnt vmcnt(20)
s_barrier
ds_write_b128 v2, v[60:63] offset:4096
ds_write_b128 v2, v[64:67] offset:5120
ds_write_b128 v2, v[68:71] offset:6144
ds_write_b128 v2, v[72:75] offset:7168
ds_read_b64_tr_b16 v[60:61], v44 offset:8192
ds_read_b64_tr_b16 v[62:63], v44 offset:9216
ds_read_b64_tr_b16 v[64:65], v46 offset:8192
ds_read_b64_tr_b16 v[66:67], v46 offset:9216
ds_read_b64_tr_b16 v[68:69], v45 offset:8192
ds_read_b64_tr_b16 v[70:71], v45 offset:9216
ds_read_b64_tr_b16 v[72:73], v47 offset:8192
ds_read_b64_tr_b16 v[74:75], v47 offset:9216
buffer_load_dwordx4 v[12:15], v9, s[4:7], s37 offen offset:0
buffer_load_dwordx4 v[16:19], v9, s[4:7], s37 offen offset:1024
buffer_load_dwordx4 v[52:55], v1, s[4:7], s37 offen offset:2048
buffer_load_dwordx4 v[56:59], v1, s[4:7], s37 offen offset:3072
s_mov_b32 m0, 1024
s_nop 0
buffer_load_dwordx4 v1, s[4:7], s47 offen offset:2048 sc1 lds
s_mov_b32 s56, 304128
buffer_load_dword v33, v24, s[4:7], s56 offen sc1
buffer_load_dword v33, v1, s[4:7], s3 offen offset:0 sc1
buffer_load_dword v33, v1, s[4:7], s3 offen offset:1024 sc1
buffer_load_dword v33, v1, s[4:7], s3 offen offset:2048 sc1
buffer_load_dword v33, v1, s[4:7], s3 offen offset:3072 sc1
s_waitcnt lgkmcnt(0)
s_waitcnt vmcnt(26)
s_barrier
ds_write_b128 v2, v[60:63] offset:8192
ds_write_b128 v2, v[64:67] offset:9216
ds_write_b128 v2, v[68:71] offset:10240
ds_write_b128 v2, v[72:75] offset:11264
ds_read_b64_tr_b16 v[60:61], v44 offset:12288
ds_read_b64_tr_b16 v[62:63], v44 offset:13312
ds_read_b64_tr_b16 v[64:65], v46 offset:12288
ds_read_b64_tr_b16 v[66:67], v46 offset:13312
ds_read_b64_tr_b16 v[68:69], v45 offset:12288
ds_read_b64_tr_b16 v[70:71], v45 offset:13312
ds_read_b64_tr_b16 v[72:73], v47 offset:12288
ds_read_b64_tr_b16 v[74:75], v47 offset:13312
s_waitcnt lgkmcnt(0)
s_waitcnt vmcnt(22)
s_barrier
ds_write_b128 v2, v[60:63] offset:12288
ds_write_b128 v2, v[64:67] offset:13312
ds_write_b128 v2, v[68:71] offset:14336
ds_write_b128 v2, v[72:75] offset:15360
ds_read_b64_tr_b16 v[60:61], v44 offset:16384
ds_read_b64_tr_b16 v[62:63], v44 offset:17408
ds_read_b64_tr_b16 v[64:65], v46 offset:16384
ds_read_b64_tr_b16 v[66:67], v46 offset:17408
ds_read_b64_tr_b16 v[68:69], v45 offset:16384
ds_read_b64_tr_b16 v[70:71], v45 offset:17408
ds_read_b64_tr_b16 v[72:73], v47 offset:16384
ds_read_b64_tr_b16 v[74:75], v47 offset:17408
s_waitcnt lgkmcnt(0)
s_waitcnt vmcnt(18)
s_barrier
ds_write_b128 v2, v[60:63] offset:16384
ds_write_b128 v2, v[64:67] offset:17408
ds_write_b128 v2, v[68:71] offset:18432
ds_write_b128 v2, v[72:75] offset:19456
ds_read_b64_tr_b16 v[60:61], v48 offset:20480
ds_read_b64_tr_b16 v[62:63], v48 offset:21504
ds_read_b64_tr_b16 v[64:65], v48 offset:22528
ds_read_b64_tr_b16 v[66:67], v48 offset:23552
ds_read_b64_tr_b16 v[68:69], v49 offset:20480
ds_read_b64_tr_b16 v[70:71], v49 offset:21504
ds_read_b64_tr_b16 v[72:73], v49 offset:22528
ds_read_b64_tr_b16 v[74:75], v49 offset:23552
s_waitcnt lgkmcnt(0)
s_waitcnt vmcnt(14)
s_barrier
ds_write_b128 v2, v[60:63] offset:20480
ds_write_b128 v2, v[64:67] offset:21504
ds_write_b128 v2, v[68:71] offset:22528
ds_write_b128 v2, v[72:75] offset:23552
ds_read_b64_tr_b16 v[60:61], v48 offset:24576
ds_read_b64_tr_b16 v[62:63], v48 offset:25600
ds_read_b64_tr_b16 v[64:65], v48 offset:26624
ds_read_b64_tr_b16 v[66:67], v48 offset:27648
ds_read_b64_tr_b16 v[68:69], v49 offset:24576
ds_read_b64_tr_b16 v[70:71], v49 offset:25600
ds_read_b64_tr_b16 v[72:73], v49 offset:26624
ds_read_b64_tr_b16 v[74:75], v49 offset:27648
s_waitcnt lgkmcnt(0)
s_waitcnt vmcnt(10)
s_barrier
ds_write_b128 v2, v[60:63] offset:24576
ds_write_b128 v2, v[64:67] offset:25600
ds_write_b128 v2, v[68:71] offset:26624
ds_write_b128 v2, v[72:75] offset:27648
ds_read_b64_tr_b16 v[60:61], v48 offset:28672
ds_read_b64_tr_b16 v[62:63], v48 offset:29696
ds_read_b64_tr_b16 v[64:65], v48 offset:30720
ds_read_b64_tr_b16 v[66:67], v48 offset:31744
ds_read_b64_tr_b16 v[68:69], v49 offset:28672
ds_read_b64_tr_b16 v[70:71], v49 offset:29696
ds_read_b64_tr_b16 v[72:73], v49 offset:30720
ds_read_b64_tr_b16 v[74:75], v49 offset:31744
s_waitcnt lgkmcnt(0)
s_barrier
ds_write_b128 v2, v[60:63] offset:28672
ds_write_b128 v2, v[64:67] offset:29696
ds_write_b128 v2, v[68:71] offset:30720
ds_write_b128 v2, v[72:75] offset:31744
s_lshl_b32 s57, s58, 5
s_mov_b32 s0, 0x3f003f00
s_mov_b32 s1, 0x3f003f00
s_mov_b32 s58, 304128
s_cmp_eq_u32 s38, s57
s_mov_b32 s56, 0x33333333
s_mov_b32 s57, 0x33333333
s_mov_b32 s2, 0x21800000
s_mov_b32 s55, -24
s_cbranch_scc0 L_slow_w2r
v_mov_b64 v[20:21], 0
v_mov_b64 v[22:23], 0
v_mov_b64 v[24:25], 0
v_mov_b64 v[26:27], 0
v_mov_b64 v[28:29], 0
v_mov_b64 v[30:31], 0
v_mov_b64 v[32:33], 0
v_mov_b64 v[34:35], 0
v_mov_b64 v[36:37], 0
v_mov_b64 v[38:39], 0
v_mov_b64 v[40:41], 0
v_mov_b64 v[42:43], 0
ds_read_b128 v[44:47], v2 offset:0
ds_read_b128 v[48:51], v2 offset:1024
v_bfe_u32 v77, v1, 6, 1
v_lshl_add_u32 v77, v77, 3, v1
v_lshlrev_b32 v77, 1, v77
v_lshlrev_b32 v78, 3, v1
s_waitcnt vmcnt(0) lgkmcnt(0)
s_branch L_top_w2rf
L_done_w2rf:
s_mul_i32 s40, s34, 10240
s_add_u32 s40, s40, 8093696
buffer_store_dword v11, v10, s[4:7], s40 offen sc0 sc1
s_waitcnt vmcnt(0) lgkmcnt(0)
s_endpgm
L_rdv2_w2r:
buffer_load_dword v32, v24, s[28:31], 0 offen sc0 sc1
s_sub_u32 s41, s41, 1
s_cbranch_scc1 L_exit
s_waitcnt vmcnt(0)
s_branch L_rdv_w2r
L_ra0_w2rf:
s_mov_b32 m0, 1024
s_nop 0
buffer_load_dwordx4 v1, s[4:7], s47 offen offset:0 sc1 lds
buffer_load_dwordx4 v1, s[4:7], s47 offen offset:1024 sc1 lds
buffer_load_dwordx4 v1, s[4:7], s47 offen offset:2048 sc1 lds
buffer_load_dwordx4 v1, s[4:7], s47 offen offset:3072 sc1 lds
s_sub_u32 s41, s41, 1
s_cbranch_scc1 L_exit
ds_read_b128 v[44:47], v2 offset:0
ds_read_b128 v[48:51], v2 offset:1024
v_mov_b64 v[20:21], 0
v_mov_b64 v[22:23], 0
v_mov_b64 v[24:25], 0
v_mov_b64 v[26:27], 0
v_mov_b64 v[28:29], 0
v_mov_b64 v[30:31], 0
v_mov_b64 v[32:33], 0
v_mov_b64 v[34:35], 0
v_mov_b64 v[36:37], 0
v_mov_b64 v[38:39], 0
v_mov_b64 v[40:41], 0
v_mov_b64 v[42:43], 0
s_waitcnt vmcnt(0)
ds_read_b128 v[60:63], v1 offset:1024
ds_read_b128 v[64:67], v1 offset:2048
ds_read_b128 v[68:71], v1 offset:3072
ds_read_b128 v[72:75], v1 offset:4096
s_branch L_s0_w2rf
L_ra1_w2rf:
L_ra2_w2rf:
s_waitcnt lgkmcnt(0)
s_barrier
s_mov_b32 m0, 5120
s_nop 0
buffer_load_dwordx4 v1, s[4:7], s48 offen offset:2048 sc1 lds
s_sub_u32 s41, s41, 1
s_cbranch_scc1 L_exit
s_waitcnt vmcnt(0)
s_barrier
ds_read_b128 v[76:79], v1 offset:5120
ds_read_b128 v[60:63], v1 offset:6144
ds_read_b128 v[64:67], v1 offset:7168
ds_read_b128 v[68:71], v1 offset:8192
ds_read_b128 v[72:75], v1 offset:9216
s_waitcnt lgkmcnt(0)
v_bitop3_b32 v6, v76, v60, s35 bitop3:0x7e
v_bitop3_b32 v6, v6, v64, s35 bitop3:0xf6
v_bitop3_b32 v6, v6, v68, s35 bitop3:0xf6
v_bitop3_b32 v6, v6, v72, s35 bitop3:0xf6
v_and_b32 v6, 1, v6
v_cmp_ne_u32 vcc, 0, v6

s_cbranch_vccnz L_ra2_w2rf
s_branch L_a1_w2rf
L_mx_w2rf:
s_waitcnt lgkmcnt(0)
v_max3_f32 v30, v12, v13, v28
v_max_f32 v30, v30, v29
v_mov_b32 v31, v30
s_nop 1
v_permlane16_swap_b32 v30, v31
v_max_f32 v30, v30, v31
v_mov_b32 v31, v30
s_nop 1
v_permlane32_swap_b32 v30, v31
v_max_f32 v30, v30, v31
ds_write_b32 v1, v30 offset:10248
s_waitcnt lgkmcnt(0)
s_barrier
ds_read_b128 v[32:35], v1 offset:10240
s_waitcnt lgkmcnt(0)
v_max3_f32 v32, v32, v33, v34
v_max_f32 v32, v32, v35
v_sub_f32 v14, v12, v32
v_sub_f32 v15, v13, v32
v_sub_f32 v30, v28, v32
v_sub_f32 v31, v29, v32
v_exp_f32 v14, v14
v_exp_f32 v15, v15
v_exp_f32 v30, v30
v_exp_f32 v31, v31
v_cvt_pk_bf16_f32 v14, v14, v15
v_cvt_pk_bf16_f32 v30, v30, v31
ds_write_b32 v5, v14 offset:14880
v_cndmask_b32_e64 v26, 0, v30, s[56:57]
v_cndmask_b32_e64 v27, 0, v30, s[56:57]
v_mov_b64 v[76:77], s[52:53]
v_mov_b64 v[78:79], s[52:53]
v_mov_b32_dpp v24, v26 quad_perm:[2,3,0,1] row_mask:0xf bank_mask:0xf
v_mov_b32_dpp v25, v26 quad_perm:[2,3,0,1] row_mask:0xf bank_mask:0xf
s_waitcnt lgkmcnt(0)
s_barrier
v_mov_b64 v[14:15], s[0:1]
ds_read_b128 v[16:19], v1 offset:14368
ds_read_b128 v[36:39], v1 offset:14336
s_waitcnt lgkmcnt(0)
v_mfma_f32_16x16x32_bf16 v[32:35], v[76:79], v[16:19], 0
v_mfma_f32_16x16x32_bf16 v[20:23], v[52:55], v[16:19], 0
v_mfma_f32_16x16x32_bf16 v[20:23], v[56:59], v[36:39], v[20:23]
v_mfma_f32_16x16x16_bf16 v[32:35], v[14:15], v[26:27], v[32:35]
v_mfma_f32_16x16x32_bf16 v[20:23], v[40:43], v[24:27], v[20:23]
s_nop 3
v_rcp_f32 v33, v32
s_nop 2
v_mul_f32_dpp v20, v33, v20 quad_perm:[0,1,0,1] row_mask:0xf bank_mask:0xf
v_mul_f32_dpp v21, v33, v21 quad_perm:[0,1,0,1] row_mask:0xf bank_mask:0xf
v_mul_f32_dpp v22, v33, v22 quad_perm:[0,1,0,1] row_mask:0xf bank_mask:0xf
v_mul_f32_dpp v23, v33, v23 quad_perm:[0,1,0,1] row_mask:0xf bank_mask:0xf
v_cvt_pk_bf16_f32 v20, v20, v21
v_cvt_pk_bf16_f32 v21, v22, v23
ds_write_b64 v6, v[20:21] offset:7168
v_mov_b32_dpp v16, v20 quad_perm:[0,1,0,1] row_mask:0xf bank_mask:0xf
v_mov_b32_dpp v17, v21 quad_perm:[0,1,0,1] row_mask:0xf bank_mask:0xf
v_mov_b32_dpp v18, v20 quad_perm:[2,3,2,3] row_mask:0xf bank_mask:0xf
v_mov_b32_dpp v19, v21 quad_perm:[2,3,2,3] row_mask:0xf bank_mask:0xf
v_mov_b64 v[76:77], 0
v_mov_b64 v[78:79], 0
v_mov_b64 v[36:37], 0
v_mov_b64 v[38:39], 0
v_mov_b64 v[24:25], 0
v_mov_b64 v[26:27], 0
v_mov_b64 v[32:33], 0
v_mov_b64 v[34:35], 0
s_waitcnt lgkmcnt(0)
s_branch L_mxb_w2rf

L_rr_w2rf:
buffer_load_dwordx4 v[60:63], v9, s[4:7], s3 offen offset:0 sc1
buffer_load_dwordx4 v[64:67], v9, s[4:7], s3 offen offset:1024 sc1
buffer_load_dwordx4 v[68:71], v9, s[4:7], s3 offen offset:2048 sc1
buffer_load_dwordx4 v[72:75], v9, s[4:7], s3 offen offset:3072 sc1
s_sub_u32 s41, s41, 1
s_cbranch_scc1 L_exit
s_waitcnt vmcnt(0)
s_branch L_r_w2rf
L_slow_w2r:
v_mov_b64 v[20:21], 0
v_mov_b64 v[22:23], 0
v_mov_b64 v[24:25], 0
v_mov_b64 v[26:27], 0
v_mov_b64 v[28:29], 0
v_mov_b64 v[30:31], 0
v_mov_b64 v[32:33], 0
v_mov_b64 v[34:35], 0
v_mov_b64 v[36:37], 0
v_mov_b64 v[38:39], 0
v_mov_b64 v[40:41], 0
v_mov_b64 v[42:43], 0
ds_read_b128 v[44:47], v2 offset:0
ds_read_b128 v[48:51], v2 offset:1024
v_bfe_u32 v77, v1, 6, 1
v_lshl_add_u32 v77, v77, 3, v1
v_lshlrev_b32 v77, 1, v77
v_lshlrev_b32 v78, 3, v1
s_waitcnt vmcnt(0) lgkmcnt(0)
s_branch L_top_w2rs
L_done_w2rs:
s_mul_i32 s40, s34, 10240
s_add_u32 s40, s40, 8093696
buffer_store_dword v11, v10, s[4:7], s40 offen sc0 sc1
s_waitcnt vmcnt(0) lgkmcnt(0)
s_endpgm
L_ra0_w2rs:
s_mov_b32 m0, 1024
s_nop 0
buffer_load_dwordx4 v1, s[4:7], s47 offen offset:0 sc0 sc1 lds
buffer_load_dwordx4 v1, s[4:7], s47 offen offset:1024 sc0 sc1 lds
buffer_load_dwordx4 v1, s[4:7], s47 offen offset:2048 sc0 sc1 lds
buffer_load_dwordx4 v1, s[4:7], s47 offen offset:3072 sc0 sc1 lds
s_sub_u32 s41, s41, 1
s_cbranch_scc1 L_exit
ds_read_b128 v[44:47], v2 offset:0
ds_read_b128 v[48:51], v2 offset:1024
v_mov_b64 v[20:21], 0
v_mov_b64 v[22:23], 0
v_mov_b64 v[24:25], 0
v_mov_b64 v[26:27], 0
v_mov_b64 v[28:29], 0
v_mov_b64 v[30:31], 0
v_mov_b64 v[32:33], 0
v_mov_b64 v[34:35], 0
v_mov_b64 v[36:37], 0
v_mov_b64 v[38:39], 0
v_mov_b64 v[40:41], 0
v_mov_b64 v[42:43], 0
s_waitcnt vmcnt(0)
ds_read_b128 v[60:63], v1 offset:1024
ds_read_b128 v[64:67], v1 offset:2048
ds_read_b128 v[68:71], v1 offset:3072
ds_read_b128 v[72:75], v1 offset:4096
s_branch L_s0_w2rs
L_ra1_w2rs:
L_ra2_w2rs:
s_waitcnt lgkmcnt(0)
s_barrier
s_mov_b32 m0, 5120
s_nop 0
buffer_load_dwordx4 v1, s[4:7], s48 offen offset:2048 sc0 sc1 lds
s_sub_u32 s41, s41, 1
s_cbranch_scc1 L_exit
s_waitcnt vmcnt(0)
s_barrier
ds_read_b128 v[76:79], v1 offset:5120
ds_read_b128 v[60:63], v1 offset:6144
ds_read_b128 v[64:67], v1 offset:7168
ds_read_b128 v[68:71], v1 offset:8192
ds_read_b128 v[72:75], v1 offset:9216
s_waitcnt lgkmcnt(0)
v_bitop3_b32 v6, v76, v60, s35 bitop3:0x7e
v_bitop3_b32 v6, v6, v64, s35 bitop3:0xf6
v_bitop3_b32 v6, v6, v68, s35 bitop3:0xf6
v_bitop3_b32 v6, v6, v72, s35 bitop3:0xf6
v_and_b32 v6, 1, v6
v_cmp_ne_u32 vcc, 0, v6

s_cbranch_vccnz L_ra2_w2rs
s_branch L_a1_w2rs
L_mx_w2rs:
s_waitcnt lgkmcnt(0)
v_max3_f32 v30, v12, v13, v28
v_max_f32 v30, v30, v29
v_mov_b32 v31, v30
s_nop 1
v_permlane16_swap_b32 v30, v31
v_max_f32 v30, v30, v31
v_mov_b32 v31, v30
s_nop 1
v_permlane32_swap_b32 v30, v31
v_max_f32 v30, v30, v31
ds_write_b32 v1, v30 offset:10248
s_waitcnt lgkmcnt(0)
s_barrier
ds_read_b128 v[32:35], v1 offset:10240
s_waitcnt lgkmcnt(0)
v_max3_f32 v32, v32, v33, v34
v_max_f32 v32, v32, v35
v_sub_f32 v14, v12, v32
v_sub_f32 v15, v13, v32
v_sub_f32 v30, v28, v32
v_sub_f32 v31, v29, v32
v_exp_f32 v14, v14
v_exp_f32 v15, v15
v_exp_f32 v30, v30
v_exp_f32 v31, v31
v_cvt_pk_bf16_f32 v14, v14, v15
v_cvt_pk_bf16_f32 v30, v30, v31
ds_write_b32 v5, v14 offset:14880
v_cndmask_b32_e64 v26, 0, v30, s[56:57]
v_cndmask_b32_e64 v27, 0, v30, s[56:57]
v_mov_b64 v[76:77], s[52:53]
v_mov_b64 v[78:79], s[52:53]
v_mov_b32_dpp v24, v26 quad_perm:[2,3,0,1] row_mask:0xf bank_mask:0xf
v_mov_b32_dpp v25, v26 quad_perm:[2,3,0,1] row_mask:0xf bank_mask:0xf
s_waitcnt lgkmcnt(0)
s_barrier
v_mov_b64 v[14:15], s[0:1]
ds_read_b128 v[16:19], v1 offset:14368
ds_read_b128 v[36:39], v1 offset:14336
s_waitcnt lgkmcnt(0)
v_mfma_f32_16x16x32_bf16 v[32:35], v[76:79], v[16:19], 0
v_mfma_f32_16x16x32_bf16 v[20:23], v[52:55], v[16:19], 0
v_mfma_f32_16x16x32_bf16 v[20:23], v[56:59], v[36:39], v[20:23]
v_mfma_f32_16x16x16_bf16 v[32:35], v[14:15], v[26:27], v[32:35]
v_mfma_f32_16x16x32_bf16 v[20:23], v[40:43], v[24:27], v[20:23]
s_nop 3
v_rcp_f32 v33, v32
s_nop 2
v_mul_f32_dpp v20, v33, v20 quad_perm:[0,1,0,1] row_mask:0xf bank_mask:0xf
v_mul_f32_dpp v21, v33, v21 quad_perm:[0,1,0,1] row_mask:0xf bank_mask:0xf
v_mul_f32_dpp v22, v33, v22 quad_perm:[0,1,0,1] row_mask:0xf bank_mask:0xf
v_mul_f32_dpp v23, v33, v23 quad_perm:[0,1,0,1] row_mask:0xf bank_mask:0xf
v_cvt_pk_bf16_f32 v20, v20, v21
v_cvt_pk_bf16_f32 v21, v22, v23
ds_write_b64 v6, v[20:21] offset:7168
v_mov_b32_dpp v16, v20 quad_perm:[0,1,0,1] row_mask:0xf bank_mask:0xf
v_mov_b32_dpp v17, v21 quad_perm:[0,1,0,1] row_mask:0xf bank_mask:0xf
v_mov_b32_dpp v18, v20 quad_perm:[2,3,2,3] row_mask:0xf bank_mask:0xf
v_mov_b32_dpp v19, v21 quad_perm:[2,3,2,3] row_mask:0xf bank_mask:0xf
v_mov_b64 v[76:77], 0
v_mov_b64 v[78:79], 0
v_mov_b64 v[36:37], 0
v_mov_b64 v[38:39], 0
v_mov_b64 v[24:25], 0
v_mov_b64 v[26:27], 0
v_mov_b64 v[32:33], 0
v_mov_b64 v[34:35], 0
s_waitcnt lgkmcnt(0)
s_branch L_mxb_w2rs

L_rr_w2rs:
buffer_load_dwordx4 v[60:63], v9, s[4:7], s3 offen offset:0 sc0 sc1
buffer_load_dwordx4 v[64:67], v9, s[4:7], s3 offen offset:1024 sc0 sc1
buffer_load_dwordx4 v[68:71], v9, s[4:7], s3 offen offset:2048 sc0 sc1
buffer_load_dwordx4 v[72:75], v9, s[4:7], s3 offen offset:3072 sc0 sc1
s_sub_u32 s41, s41, 1
s_cbranch_scc1 L_exit
s_waitcnt vmcnt(0)
s_branch L_r_w2rs
L_pro_w3:
v_and_b32 v20, 63, v0
v_lshlrev_b32 v1, 4, v20
v_add_u32 v2, 131072, v1
v_and_b32 v23, 1, v22
v_lshl_add_u32 v23, v24, 4, v23
v_mul_u32_u24 v23, 1152, v23
v_lshlrev_b32 v28, 2, v22
v_xor_b32 v28, v28, v21
v_lshl_add_u32 v28, v28, 4, v23
s_mul_i32 s55, s32, 147456
s_waitcnt lgkmcnt(0)
v_and_b32 v23, 1, v22
v_lshrrev_b32 v24, 2, v21
v_lshl_add_u32 v23, v23, 2, v24
v_lshlrev_b32 v23, 1, v23
v_bfe_u32 v44, v21, 1, 1
v_add_u32 v44, 12, v44
v_xor_b32 v44, v44, v23
v_lshlrev_b32 v44, 4, v44
v_lshl_add_u32 v44, v24, 8, v44
v_and_b32 v23, 1, v22
v_lshl_add_u32 v44, v23, 11, v44
v_and_b32 v23, 1, v21
v_lshl_add_u32 v44, v23, 3, v44
v_lshrrev_b32 v23, 1, v22
v_mul_u32_u24 v23, 40960, v23
v_add_u32 v23, 16384, v23
v_add_u32 v44, v44, v23
v_and_b32 v23, 1, v22
v_lshrrev_b32 v24, 2, v21
v_lshl_add_u32 v23, v23, 2, v24
v_lshlrev_b32 v23, 1, v23
v_bfe_u32 v45, v21, 1, 1
v_add_u32 v45, 14, v45
v_xor_b32 v45, v45, v23
v_lshlrev_b32 v45, 4, v45
v_lshl_add_u32 v45, v24, 8, v45
v_and_b32 v23, 1, v22
v_lshl_add_u32 v45, v23, 11, v45
v_and_b32 v23, 1, v21
v_lshl_add_u32 v45, v23, 3, v45
v_lshrrev_b32 v23, 1, v22
v_mul_u32_u24 v23, 40960, v23
v_add_u32 v23, 16384, v23
v_add_u32 v45, v45, v23
v_and_b32 v23, 1, v22
v_lshrrev_b32 v24, 2, v21
v_lshl_add_u32 v23, v23, 2, v24
v_lshlrev_b32 v23, 1, v23
v_bfe_u32 v46, v21, 1, 1
v_add_u32 v46, 12, v46
v_xor_b32 v46, v46, v23
v_lshlrev_b32 v46, 4, v46
v_lshl_add_u32 v46, v24, 8, v46
v_and_b32 v23, 1, v22
v_lshl_add_u32 v46, v23, 11, v46
v_and_b32 v23, 1, v21
v_lshl_add_u32 v46, v23, 3, v46
v_lshrrev_b32 v23, 1, v22
v_mul_u32_u24 v23, 32768, v23
v_add_u32 v23, 98304, v23
v_add_u32 v46, v46, v23
v_and_b32 v23, 1, v22
v_lshrrev_b32 v24, 2, v21
v_lshl_add_u32 v23, v23, 2, v24
v_lshlrev_b32 v23, 1, v23
v_bfe_u32 v47, v21, 1, 1
v_add_u32 v47, 14, v47
v_xor_b32 v47, v47, v23
v_lshlrev_b32 v47, 4, v47
v_lshl_add_u32 v47, v24, 8, v47
v_and_b32 v23, 1, v22
v_lshl_add_u32 v47, v23, 11, v47
v_and_b32 v23, 1, v21
v_lshl_add_u32 v47, v23, 3, v47
v_lshrrev_b32 v23, 1, v22
v_mul_u32_u24 v23, 32768, v23
v_add_u32 v23, 98304, v23
v_add_u32 v47, v47, v23
v_and_b32 v23, 1, v22
v_bfe_u32 v24, v21, 2, 1
v_lshl_add_u32 v23, v23, 1, v24
v_xor_b32 v24, 3, v23
v_lshlrev_b32 v24, 6, v24
v_lshl_add_u32 v48, v23, 8, v24
v_and_b32 v23, 3, v21
v_lshl_add_u32 v48, v23, 4, v48
v_and_b32 v23, 8, v21
v_add_u32 v48, v48, v23
v_lshrrev_b32 v23, 1, v22
v_mul_u32_u24 v23, 40960, v23
v_add_u32 v23, 16384, v23
v_add_u32 v48, v48, v23
v_and_b32 v23, 1, v22
v_bfe_u32 v24, v21, 2, 1
v_lshl_add_u32 v23, v23, 1, v24
v_xor_b32 v24, 3, v23
v_lshlrev_b32 v24, 6, v24
v_lshl_add_u32 v49, v23, 8, v24
v_and_b32 v23, 3, v21
v_lshl_add_u32 v49, v23, 4, v49
v_and_b32 v23, 8, v21
v_add_u32 v49, v49, v23
v_lshrrev_b32 v23, 1, v22
v_mul_u32_u24 v23, 32768, v23
v_add_u32 v23, 98304, v23
v_add_u32 v49, v49, v23
v_bfe_u32 v23, v21, 1, 1
v_mul_u32_u24 v23, 0xaaaa, v23
v_add_u32 v0, 0x4444, v23
v_lshlrev_b32 v3, 3, v20
v_lshrrev_b32 v25, 5, v20
v_lshlrev_b32 v25, 6, v25
v_xor_b32 v3, v3, v25
v_lshrrev_b32 v25, 2, v20
v_and_b32 v4, 3, v21
v_lshl_add_u32 v4, v4, 4, v25
v_lshlrev_b32 v4, 3, v4
v_bfe_u32 v25, v21, 1, 1
v_lshlrev_b32 v23, 6, v25
v_xor_b32 v4, v4, v23
v_lshlrev_b32 v5, 4, v21
v_lshl_add_u32 v5, v22, 2, v5
v_mul_u32_u24 v23, 256, v25
v_add_u32 v5, v5, v23
v_lshlrev_b32 v9, 8, v22
v_lshl_add_u32 v9, v25, 6, v9
v_bfe_u32 v23, v21, 3, 1
v_lshl_add_u32 v9, v23, 7, v9
v_bfe_u32 v23, v21, 2, 1
v_lshl_add_u32 v9, v23, 5, v9
v_and_b32 v23, 1, v21
v_lshl_add_u32 v9, v23, 4, v9
v_lshrrev_b32 v23, 1, v22
v_and_b32 v24, 1, v22
v_and_b32 v25, 7, v21
v_lshrrev_b32 v7, 3, v21
v_lshl_add_u32 v8, v7, 1, v23
v_lshlrev_b32 v8, 12, v8
v_lshl_add_u32 v8, v24, 7, v8
v_and_b32 v25, 4, v21
v_lshl_add_u32 v8, v25, 3, v8
v_and_b32 v25, 1, v21
v_lshl_add_u32 v8, v25, 4, v8
v_bfe_u32 v25, v21, 1, 1
v_lshl_add_u32 v8, v25, 3, v8
s_lshr_b32 s56, s32, 1
s_lshl_b32 s56, s56, 8
s_and_b32 s57, s32, 1
s_lshl_b32 s57, s57, 6
s_add_u32 s56, s56, s57
s_add_u32 s56, s56, 49152
v_add_u32 v8, s56, v8
v_and_b32 v7, 0x3d0, v1
s_mov_b32 s42, 0
s_mov_b32 s43, 65536
s_mov_b32 s44, 131072
s_mov_b32 s45, 196608
s_mov_b32 s46, 262144
s_mov_b32 s47, 294912
s_mov_b32 s48, 299008
s_mov_b32 s49, 303104
s_mov_b32 s50, 0x3e0293ee
s_mov_b32 s51, 0x3e0293ee
s_mov_b32 s52, 0x3f803f80
s_mov_b32 s53, 0x3f803f80
v_lshlrev_b32 v11, 2, v21
s_mov_b32 s34, 0
s_mov_b32 s35, -1
s_mov_b32 s36, 0
s_mov_b32 s41, 300000
s_lshl_b32 s37, s32, 14
s_add_u32 s39, s37, 17309696
s_add_u32 s37, s37, 16789504
s_mov_b32 s40, 8749056
v_mov_b64 v[36:37], 0
v_mov_b64 v[38:39], 0
s_lshl_b32 s56, s32, 1
s_add_u32 s56, s56, 1
s_cmp_eq_u32 s56, 0
s_cselect_b32 s56, 64, s56
s_mul_i32 s56, s56, 10240
s_add_u32 s56, s56, 8392704
s_add_u32 s57, s56, 4096
v_mov_b32 v40, 1
v_mov_b32 v41, 1
v_mov_b32 v42, 1
v_mov_b32 v43, 1
buffer_store_dwordx4 v[40:43], v1, s[4:7], s56 offen offset:0 sc0 sc1
buffer_store_dwordx4 v[40:43], v1, s[4:7], s56 offen offset:1024 sc0 sc1
buffer_store_dwordx4 v[40:43], v1, s[4:7], s56 offen offset:2048 sc0 sc1
buffer_store_dwordx4 v[40:43], v1, s[4:7], s56 offen offset:3072 sc0 sc1
buffer_store_dwordx4 v[40:43], v1, s[4:7], s57 offen offset:0 sc0 sc1
s_lshl_b32 s56, s32, 10
s_add_u32 s56, s56, 327680
buffer_store_dwordx4 v[36:39], v1, s[4:7], s56 offen sc0 sc1
s_getreg_b32 s56, hwreg(HW_REG_XCC_ID)
s_and_b32 s56, s56, 15
s_mul_i32 s57, s56, s56
s_lshl_b32 s57, s57, 18
s_lshl_b32 s56, s56, 8
s_add_u32 s57, s57, s56
s_add_u32 s58, s57, 1
s_lshl_b32 s101, s32, 7
s_add_u32 s101, s101, 327680
v_mov_b32 v24, 0
s_mov_b32 s3, s101
v_mov_b32 v10, 0
s_add_u32 s56, s54, 393216
s_mov_b32 m0, 143360
s_nop 0
buffer_load_dwordx4 v26, s[12:15], s56 offen lds
s_add_u32 s56, s54, 409600
s_mov_b32 m0, 144384
s_nop 0
buffer_load_dwordx4 v26, s[12:15], s56 offen lds
s_add_u32 s56, s54, 425984
s_mov_b32 m0, 145408
s_nop 0
buffer_load_dwordx4 v27, s[12:15], s56 offen lds
s_add_u32 s56, s54, 442368
s_mov_b32 m0, 146432
s_nop 0
buffer_load_dwordx4 v27, s[12:15], s56 offen lds
s_add_u32 s56, s54, 917504
s_mov_b32 m0, 147456
s_nop 0
buffer_load_dwordx4 v26, s[12:15], s56 offen lds
s_add_u32 s56, s54, 933888
s_mov_b32 m0, 148480
s_nop 0
buffer_load_dwordx4 v26, s[12:15], s56 offen lds
s_add_u32 s56, s54, 950272
s_mov_b32 m0, 149504
s_nop 0
buffer_load_dwordx4 v27, s[12:15], s56 offen lds
s_add_u32 s56, s54, 966656
s_mov_b32 m0, 150528
s_nop 0
buffer_load_dwordx4 v27, s[12:15], s56 offen lds
v_mov_b32 v24, 0
s_waitcnt vmcnt(34)
s_barrier
ds_read_b64_tr_b16 v[80:81], v44 offset:20480
ds_read_b64_tr_b16 v[82:83], v44 offset:21504
ds_read_b64_tr_b16 v[84:85], v46 offset:20480
ds_read_b64_tr_b16 v[86:87], v46 offset:21504
ds_read_b64_tr_b16 v[88:89], v45 offset:20480
ds_read_b64_tr_b16 v[90:91], v45 offset:21504
ds_read_b64_tr_b16 v[92:93], v47 offset:20480
ds_read_b64_tr_b16 v[94:95], v47 offset:21504
s_waitcnt lgkmcnt(0)
s_waitcnt vmcnt(30)
s_barrier
s_add_u32 s56, s54, 1441792
s_mov_b32 m0, 151552
s_nop 0
buffer_load_dwordx4 v26, s[12:15], s56 offen lds
s_add_u32 s56, s54, 1458176
s_mov_b32 m0, 152576
s_nop 0
buffer_load_dwordx4 v26, s[12:15], s56 offen lds
s_add_u32 s56, s54, 1474560
s_mov_b32 m0, 153600
s_nop 0
buffer_load_dwordx4 v27, s[12:15], s56 offen lds
s_add_u32 s56, s54, 1490944
s_mov_b32 m0, 154624
s_nop 0
buffer_load_dwordx4 v27, s[12:15], s56 offen lds
ds_read_b64_tr_b16 v[96:97], v44 offset:24576
ds_read_b64_tr_b16 v[98:99], v44 offset:25600
ds_read_b64_tr_b16 v[100:101], v46 offset:24576
ds_read_b64_tr_b16 v[102:103], v46 offset:25600
ds_read_b64_tr_b16 v[104:105], v45 offset:24576
ds_read_b64_tr_b16 v[106:107], v45 offset:25600
ds_read_b64_tr_b16 v[108:109], v47 offset:24576
ds_read_b64_tr_b16 v[110:111], v47 offset:25600
s_waitcnt lgkmcnt(0)
s_waitcnt vmcnt(30)
s_barrier
s_add_u32 s56, s54, 1966080
s_mov_b32 m0, 155648
s_nop 0
buffer_load_dwordx4 v26, s[12:15], s56 offen lds
s_add_u32 s56, s54, 1982464
s_mov_b32 m0, 156672
s_nop 0
buffer_load_dwordx4 v26, s[12:15], s56 offen lds
s_add_u32 s56, s54, 1998848
s_mov_b32 m0, 157696
s_nop 0
buffer_load_dwordx4 v27, s[12:15], s56 offen lds
s_add_u32 s56, s54, 2015232
s_mov_b32 m0, 158720
s_nop 0
buffer_load_dwordx4 v27, s[12:15], s56 offen lds
ds_read_b64_tr_b16 v[112:113], v44 offset:28672
ds_read_b64_tr_b16 v[114:115], v44 offset:29696
ds_read_b64_tr_b16 v[116:117], v46 offset:28672
ds_read_b64_tr_b16 v[118:119], v46 offset:29696
ds_read_b64_tr_b16 v[120:121], v45 offset:28672
ds_read_b64_tr_b16 v[122:123], v45 offset:29696
ds_read_b64_tr_b16 v[124:125], v47 offset:28672
ds_read_b64_tr_b16 v[126:127], v47 offset:29696
s_waitcnt lgkmcnt(0)
s_waitcnt vmcnt(30)
s_barrier
s_add_u32 s56, s54, 2490368
s_mov_b32 m0, 159744
s_nop 0
buffer_load_dwordx4 v26, s[12:15], s56 offen lds
s_add_u32 s56, s54, 2506752
s_mov_b32 m0, 160768
s_nop 0
buffer_load_dwordx4 v26, s[12:15], s56 offen lds
s_add_u32 s56, s54, 2523136
s_mov_b32 m0, 161792
s_nop 0
buffer_load_dwordx4 v27, s[12:15], s56 offen lds
s_add_u32 s56, s54, 2539520
s_mov_b32 m0, 162816
s_nop 0
buffer_load_dwordx4 v27, s[12:15], s56 offen lds
ds_read_b64_tr_b16 v[128:129], v44 offset:0
ds_read_b64_tr_b16 v[130:131], v44 offset:1024
ds_read_b64_tr_b16 v[132:133], v46 offset:0
ds_read_b64_tr_b16 v[134:135], v46 offset:1024
ds_read_b64_tr_b16 v[136:137], v45 offset:0
ds_read_b64_tr_b16 v[138:139], v45 offset:1024
ds_read_b64_tr_b16 v[140:141], v47 offset:0
ds_read_b64_tr_b16 v[142:143], v47 offset:1024
s_waitcnt lgkmcnt(0)
s_waitcnt vmcnt(30)
s_barrier
s_add_u32 s56, s54, 3538944
s_mov_b32 m0, 131072
s_nop 0
buffer_load_dwordx4 v26, s[12:15], s56 offen lds
s_add_u32 s56, s54, 3555328
s_mov_b32 m0, 132096
s_nop 0
buffer_load_dwordx4 v26, s[12:15], s56 offen lds
s_add_u32 s56, s54, 3571712
s_mov_b32 m0, 133120
s_nop 0
buffer_load_dwordx4 v27, s[12:15], s56 offen lds
s_add_u32 s56, s54, 3588096
s_mov_b32 m0, 134144
s_nop 0
buffer_load_dwordx4 v27, s[12:15], s56 offen lds
ds_read_b64_tr_b16 v[144:145], v44 offset:4096
ds_read_b64_tr_b16 v[146:147], v44 offset:5120
ds_read_b64_tr_b16 v[148:149], v46 offset:4096
ds_read_b64_tr_b16 v[150:151], v46 offset:5120
ds_read_b64_tr_b16 v[152:153], v45 offset:4096
ds_read_b64_tr_b16 v[154:155], v45 offset:5120
ds_read_b64_tr_b16 v[156:157], v47 offset:4096
ds_read_b64_tr_b16 v[158:159], v47 offset:5120
s_waitcnt lgkmcnt(0)
s_waitcnt vmcnt(30)
s_barrier
s_add_u32 s56, s54, 4063232
s_mov_b32 m0, 135168
s_nop 0
buffer_load_dwordx4 v26, s[12:15], s56 offen lds
s_add_u32 s56, s54, 4079616
s_mov_b32 m0, 136192
s_nop 0
buffer_load_dwordx4 v26, s[12:15], s56 offen lds
s_add_u32 s56, s54, 4096000
s_mov_b32 m0, 137216
s_nop 0
buffer_load_dwordx4 v27, s[12:15], s56 offen lds
s_add_u32 s56, s54, 4112384
s_mov_b32 m0, 138240
s_nop 0
buffer_load_dwordx4 v27, s[12:15], s56 offen lds
ds_read_b64_tr_b16 v[160:161], v44 offset:8192
ds_read_b64_tr_b16 v[162:163], v44 offset:9216
ds_read_b64_tr_b16 v[164:165], v46 offset:8192
ds_read_b64_tr_b16 v[166:167], v46 offset:9216
ds_read_b64_tr_b16 v[168:169], v45 offset:8192
ds_read_b64_tr_b16 v[170:171], v45 offset:9216
ds_read_b64_tr_b16 v[172:173], v47 offset:8192
ds_read_b64_tr_b16 v[174:175], v47 offset:9216
s_waitcnt lgkmcnt(0)
s_waitcnt vmcnt(24)
s_barrier
s_add_u32 s56, s54, 4587520
s_mov_b32 m0, 139264
s_nop 0
buffer_load_dwordx4 v26, s[12:15], s56 offen lds
s_add_u32 s56, s54, 4603904
s_mov_b32 m0, 140288
s_nop 0
buffer_load_dwordx4 v26, s[12:15], s56 offen lds
s_add_u32 s56, s54, 4620288
s_mov_b32 m0, 141312
s_nop 0
buffer_load_dwordx4 v27, s[12:15], s56 offen lds
s_add_u32 s56, s54, 4636672
s_mov_b32 m0, 142336
s_nop 0
buffer_load_dwordx4 v27, s[12:15], s56 offen lds
ds_read_b64_tr_b16 v[176:177], v44 offset:12288
ds_read_b64_tr_b16 v[178:179], v44 offset:13312
ds_read_b64_tr_b16 v[180:181], v46 offset:12288
ds_read_b64_tr_b16 v[182:183], v46 offset:13312
ds_read_b64_tr_b16 v[184:185], v45 offset:12288
ds_read_b64_tr_b16 v[186:187], v45 offset:13312
ds_read_b64_tr_b16 v[188:189], v47 offset:12288
ds_read_b64_tr_b16 v[190:191], v47 offset:13312
s_waitcnt lgkmcnt(0)
s_waitcnt vmcnt(24)
s_barrier
s_add_u32 s56, s54, 393216
s_mov_b32 m0, 143360
s_nop 0
buffer_load_dwordx4 v26, s[16:19], s56 offen lds
s_add_u32 s56, s54, 409600
s_mov_b32 m0, 144384
s_nop 0
buffer_load_dwordx4 v26, s[16:19], s56 offen lds
s_add_u32 s56, s54, 425984
s_mov_b32 m0, 145408
s_nop 0
buffer_load_dwordx4 v27, s[16:19], s56 offen lds
s_add_u32 s56, s54, 442368
s_mov_b32 m0, 146432
s_nop 0
buffer_load_dwordx4 v27, s[16:19], s56 offen lds
ds_read_b64_tr_b16 v[192:193], v44 offset:16384
ds_read_b64_tr_b16 v[194:195], v44 offset:17408
ds_read_b64_tr_b16 v[196:197], v46 offset:16384
ds_read_b64_tr_b16 v[198:199], v46 offset:17408
ds_read_b64_tr_b16 v[200:201], v45 offset:16384
ds_read_b64_tr_b16 v[202:203], v45 offset:17408
ds_read_b64_tr_b16 v[204:205], v47 offset:16384
ds_read_b64_tr_b16 v[206:207], v47 offset:17408
s_waitcnt lgkmcnt(0)
s_waitcnt vmcnt(24)
s_barrier
s_add_u32 s56, s54, 917504
s_mov_b32 m0, 147456
s_nop 0
buffer_load_dwordx4 v26, s[16:19], s56 offen lds
s_add_u32 s56, s54, 933888
s_mov_b32 m0, 148480
s_nop 0
buffer_load_dwordx4 v26, s[16:19], s56 offen lds
s_add_u32 s56, s54, 950272
s_mov_b32 m0, 149504
s_nop 0
buffer_load_dwordx4 v27, s[16:19], s56 offen lds
s_add_u32 s56, s54, 966656
s_mov_b32 m0, 150528
s_nop 0
buffer_load_dwordx4 v27, s[16:19], s56 offen lds
ds_read_b64_tr_b16 v[208:209], v44 offset:20480
ds_read_b64_tr_b16 v[210:211], v44 offset:21504
ds_read_b64_tr_b16 v[212:213], v46 offset:20480
ds_read_b64_tr_b16 v[214:215], v46 offset:21504
ds_read_b64_tr_b16 v[216:217], v45 offset:20480
ds_read_b64_tr_b16 v[218:219], v45 offset:21504
ds_read_b64_tr_b16 v[220:221], v47 offset:20480
ds_read_b64_tr_b16 v[222:223], v47 offset:21504
s_waitcnt lgkmcnt(0)
s_waitcnt vmcnt(24)
s_barrier
s_add_u32 s56, s54, 1441792
s_mov_b32 m0, 151552
s_nop 0
buffer_load_dwordx4 v26, s[16:19], s56 offen lds
s_add_u32 s56, s54, 1458176
s_mov_b32 m0, 152576
s_nop 0
buffer_load_dwordx4 v26, s[16:19], s56 offen lds
s_add_u32 s56, s54, 1474560
s_mov_b32 m0, 153600
s_nop 0
buffer_load_dwordx4 v27, s[16:19], s56 offen lds
s_add_u32 s56, s54, 1490944
s_mov_b32 m0, 154624
s_nop 0
buffer_load_dwordx4 v27, s[16:19], s56 offen lds
ds_read_b64_tr_b16 v[224:225], v44 offset:24576
ds_read_b64_tr_b16 v[226:227], v44 offset:25600
ds_read_b64_tr_b16 v[228:229], v46 offset:24576
ds_read_b64_tr_b16 v[230:231], v46 offset:25600
ds_read_b64_tr_b16 v[232:233], v45 offset:24576
ds_read_b64_tr_b16 v[234:235], v45 offset:25600
ds_read_b64_tr_b16 v[236:237], v47 offset:24576
ds_read_b64_tr_b16 v[238:239], v47 offset:25600
s_waitcnt lgkmcnt(0)
s_waitcnt vmcnt(24)
s_barrier
s_add_u32 s56, s54, 1966080
s_mov_b32 m0, 155648
s_nop 0
buffer_load_dwordx4 v26, s[16:19], s56 offen lds
s_add_u32 s56, s54, 1982464
s_mov_b32 m0, 156672
s_nop 0
buffer_load_dwordx4 v26, s[16:19], s56 offen lds
s_add_u32 s56, s54, 1998848
s_mov_b32 m0, 157696
s_nop 0
buffer_load_dwordx4 v27, s[16:19], s56 offen lds
s_add_u32 s56, s54, 2015232
s_mov_b32 m0, 158720
s_nop 0
buffer_load_dwordx4 v27, s[16:19], s56 offen lds
ds_read_b64_tr_b16 v[240:241], v44 offset:28672
ds_read_b64_tr_b16 v[242:243], v44 offset:29696
ds_read_b64_tr_b16 v[244:245], v46 offset:28672
ds_read_b64_tr_b16 v[246:247], v46 offset:29696
ds_read_b64_tr_b16 v[248:249], v45 offset:28672
ds_read_b64_tr_b16 v[250:251], v45 offset:29696
ds_read_b64_tr_b16 v[252:253], v47 offset:28672
ds_read_b64_tr_b16 v[254:255], v47 offset:29696
s_waitcnt lgkmcnt(0)
s_waitcnt vmcnt(24)
s_barrier
s_add_u32 s56, s54, 2490368
s_mov_b32 m0, 159744
s_nop 0
buffer_load_dwordx4 v26, s[16:19], s56 offen lds
s_add_u32 s56, s54, 2506752
s_mov_b32 m0, 160768
s_nop 0
buffer_load_dwordx4 v26, s[16:19], s56 offen lds
s_add_u32 s56, s54, 2523136
s_mov_b32 m0, 161792
s_nop 0
buffer_load_dwordx4 v27, s[16:19], s56 offen lds
s_add_u32 s56, s54, 2539520
s_mov_b32 m0, 162816
s_nop 0
buffer_load_dwordx4 v27, s[16:19], s56 offen lds
ds_read_b64_tr_b16 a[0:1], v44 offset:0
ds_read_b64_tr_b16 a[2:3], v44 offset:1024
ds_read_b64_tr_b16 a[4:5], v46 offset:0
ds_read_b64_tr_b16 a[6:7], v46 offset:1024
ds_read_b64_tr_b16 a[8:9], v45 offset:0
ds_read_b64_tr_b16 a[10:11], v45 offset:1024
ds_read_b64_tr_b16 a[12:13], v47 offset:0
ds_read_b64_tr_b16 a[14:15], v47 offset:1024
s_waitcnt lgkmcnt(0)
s_waitcnt vmcnt(24)
s_barrier
s_add_u32 s56, s54, 3014656
s_mov_b32 m0, 131072
s_nop 0
buffer_load_dwordx4 v26, s[16:19], s56 offen lds
s_add_u32 s56, s54, 3031040
s_mov_b32 m0, 132096
s_nop 0
buffer_load_dwordx4 v26, s[16:19], s56 offen lds
s_add_u32 s56, s54, 3047424
s_mov_b32 m0, 133120
s_nop 0
buffer_load_dwordx4 v27, s[16:19], s56 offen lds
s_add_u32 s56, s54, 3063808
s_mov_b32 m0, 134144
s_nop 0
buffer_load_dwordx4 v27, s[16:19], s56 offen lds
ds_read_b64_tr_b16 a[16:17], v44 offset:4096
ds_read_b64_tr_b16 a[18:19], v44 offset:5120
ds_read_b64_tr_b16 a[20:21], v46 offset:4096
ds_read_b64_tr_b16 a[22:23], v46 offset:5120
ds_read_b64_tr_b16 a[24:25], v45 offset:4096
ds_read_b64_tr_b16 a[26:27], v45 offset:5120
ds_read_b64_tr_b16 a[28:29], v47 offset:4096
ds_read_b64_tr_b16 a[30:31], v47 offset:5120
s_waitcnt lgkmcnt(0)
s_waitcnt vmcnt(24)
s_barrier
s_add_u32 s56, s54, 3538944
s_mov_b32 m0, 135168
s_nop 0
buffer_load_dwordx4 v26, s[16:19], s56 offen lds
s_add_u32 s56, s54, 3555328
s_mov_b32 m0, 136192
s_nop 0
buffer_load_dwordx4 v26, s[16:19], s56 offen lds
s_add_u32 s56, s54, 3571712
s_mov_b32 m0, 137216
s_nop 0
buffer_load_dwordx4 v27, s[16:19], s56 offen lds
s_add_u32 s56, s54, 3588096
s_mov_b32 m0, 138240
s_nop 0
buffer_load_dwordx4 v27, s[16:19], s56 offen lds
ds_read_b64_tr_b16 a[32:33], v44 offset:8192
ds_read_b64_tr_b16 a[34:35], v44 offset:9216
ds_read_b64_tr_b16 a[36:37], v46 offset:8192
ds_read_b64_tr_b16 a[38:39], v46 offset:9216
ds_read_b64_tr_b16 a[40:41], v45 offset:8192
ds_read_b64_tr_b16 a[42:43], v45 offset:9216
ds_read_b64_tr_b16 a[44:45], v47 offset:8192
ds_read_b64_tr_b16 a[46:47], v47 offset:9216
s_waitcnt lgkmcnt(0)
s_waitcnt vmcnt(24)
s_barrier
s_add_u32 s56, s54, 4063232
s_mov_b32 m0, 139264
s_nop 0
buffer_load_dwordx4 v26, s[16:19], s56 offen lds
s_add_u32 s56, s54, 4079616
s_mov_b32 m0, 140288
s_nop 0
buffer_load_dwordx4 v26, s[16:19], s56 offen lds
s_add_u32 s56, s54, 4096000
s_mov_b32 m0, 141312
s_nop 0
buffer_load_dwordx4 v27, s[16:19], s56 offen lds
s_add_u32 s56, s54, 4112384
s_mov_b32 m0, 142336
s_nop 0
buffer_load_dwordx4 v27, s[16:19], s56 offen lds
ds_read_b64_tr_b16 a[48:49], v44 offset:12288
ds_read_b64_tr_b16 a[50:51], v44 offset:13312
ds_read_b64_tr_b16 a[52:53], v46 offset:12288
ds_read_b64_tr_b16 a[54:55], v46 offset:13312
ds_read_b64_tr_b16 a[56:57], v45 offset:12288
ds_read_b64_tr_b16 a[58:59], v45 offset:13312
ds_read_b64_tr_b16 a[60:61], v47 offset:12288
ds_read_b64_tr_b16 a[62:63], v47 offset:13312
s_waitcnt lgkmcnt(0)
s_waitcnt vmcnt(24)
s_barrier
s_add_u32 s56, s55, 115200
s_mov_b32 m0, 143360
s_nop 0
buffer_load_dwordx4 v28, s[20:23], s56 offen lds
s_add_u32 s56, s55, 117504
s_mov_b32 m0, 144384
s_nop 0
buffer_load_dwordx4 v28, s[20:23], s56 offen lds
s_add_u32 s56, s55, 124416
s_mov_b32 m0, 145408
s_nop 0
buffer_load_dwordx4 v28, s[20:23], s56 offen lds
s_add_u32 s56, s55, 126720
s_mov_b32 m0, 146432
s_nop 0
buffer_load_dwordx4 v28, s[20:23], s56 offen lds
ds_read_b64_tr_b16 a[64:65], v44 offset:16384
ds_read_b64_tr_b16 a[66:67], v44 offset:17408
ds_read_b64_tr_b16 a[68:69], v46 offset:16384
ds_read_b64_tr_b16 a[70:71], v46 offset:17408
ds_read_b64_tr_b16 a[72:73], v45 offset:16384
ds_read_b64_tr_b16 a[74:75], v45 offset:17408
ds_read_b64_tr_b16 a[76:77], v47 offset:16384
ds_read_b64_tr_b16 a[78:79], v47 offset:17408
s_waitcnt lgkmcnt(0)
s_waitcnt vmcnt(24)
s_barrier
s_add_u32 s56, s55, 115456
s_mov_b32 m0, 147456
s_nop 0
buffer_load_dwordx4 v28, s[20:23], s56 offen lds
s_add_u32 s56, s55, 117760
s_mov_b32 m0, 148480
s_nop 0
buffer_load_dwordx4 v28, s[20:23], s56 offen lds
s_add_u32 s56, s55, 124672
s_mov_b32 m0, 149504
s_nop 0
buffer_load_dwordx4 v28, s[20:23], s56 offen lds
s_add_u32 s56, s55, 126976
s_mov_b32 m0, 150528
s_nop 0
buffer_load_dwordx4 v28, s[20:23], s56 offen lds
ds_read_b64_tr_b16 a[80:81], v44 offset:20480
ds_read_b64_tr_b16 a[82:83], v44 offset:21504
ds_read_b64_tr_b16 a[84:85], v46 offset:20480
ds_read_b64_tr_b16 a[86:87], v46 offset:21504
ds_read_b64_tr_b16 a[88:89], v45 offset:20480
ds_read_b64_tr_b16 a[90:91], v45 offset:21504
ds_read_b64_tr_b16 a[92:93], v47 offset:20480
ds_read_b64_tr_b16 a[94:95], v47 offset:21504
s_waitcnt lgkmcnt(0)
s_waitcnt vmcnt(24)
s_barrier
s_add_u32 s56, s55, 115712
s_mov_b32 m0, 151552
s_nop 0
buffer_load_dwordx4 v28, s[20:23], s56 offen lds
s_add_u32 s56, s55, 118016
s_mov_b32 m0, 152576
s_nop 0
buffer_load_dwordx4 v28, s[20:23], s56 offen lds
s_add_u32 s56, s55, 124928
s_mov_b32 m0, 153600
s_nop 0
buffer_load_dwordx4 v28, s[20:23], s56 offen lds
s_add_u32 s56, s55, 127232
s_mov_b32 m0, 154624
s_nop 0
buffer_load_dwordx4 v28, s[20:23], s56 offen lds
ds_read_b64_tr_b16 a[96:97], v44 offset:24576
ds_read_b64_tr_b16 a[98:99], v44 offset:25600
ds_read_b64_tr_b16 a[100:101], v46 offset:24576
ds_read_b64_tr_b16 a[102:103], v46 offset:25600
ds_read_b64_tr_b16 a[104:105], v45 offset:24576
ds_read_b64_tr_b16 a[106:107], v45 offset:25600
ds_read_b64_tr_b16 a[108:109], v47 offset:24576
ds_read_b64_tr_b16 a[110:111], v47 offset:25600
s_waitcnt lgkmcnt(0)
s_waitcnt vmcnt(24)
s_barrier
s_add_u32 s56, s55, 115968
s_mov_b32 m0, 155648
s_nop 0
buffer_load_dwordx4 v28, s[20:23], s56 offen lds
s_add_u32 s56, s55, 118272
s_mov_b32 m0, 156672
s_nop 0
buffer_load_dwordx4 v28, s[20:23], s56 offen lds
s_add_u32 s56, s55, 125184
s_mov_b32 m0, 157696
s_nop 0
buffer_load_dwordx4 v28, s[20:23], s56 offen lds
s_add_u32 s56, s55, 127488
s_mov_b32 m0, 158720
s_nop 0
buffer_load_dwordx4 v28, s[20:23], s56 offen lds
ds_read_b64_tr_b16 a[112:113], v44 offset:28672
ds_read_b64_tr_b16 a[114:115], v44 offset:29696
ds_read_b64_tr_b16 a[116:117], v46 offset:28672
ds_read_b64_tr_b16 a[118:119], v46 offset:29696
ds_read_b64_tr_b16 a[120:121], v45 offset:28672
ds_read_b64_tr_b16 a[122:123], v45 offset:29696
ds_read_b64_tr_b16 a[124:125], v47 offset:28672
ds_read_b64_tr_b16 a[126:127], v47 offset:29696
s_waitcnt lgkmcnt(0)
s_waitcnt vmcnt(24)
s_barrier
s_add_u32 s56, s55, 41472
s_mov_b32 m0, 159744
s_nop 0
buffer_load_dwordx4 v28, s[20:23], s56 offen lds
s_add_u32 s56, s55, 43776
s_mov_b32 m0, 160768
s_nop 0
buffer_load_dwordx4 v28, s[20:23], s56 offen lds
s_add_u32 s56, s55, 50688
s_mov_b32 m0, 161792
s_nop 0
buffer_load_dwordx4 v28, s[20:23], s56 offen lds
s_add_u32 s56, s55, 52992
s_mov_b32 m0, 162816
s_nop 0
buffer_load_dwordx4 v28, s[20:23], s56 offen lds
ds_read_b64_tr_b16 a[128:129], v44 offset:0
ds_read_b64_tr_b16 a[130:131], v44 offset:1024
ds_read_b64_tr_b16 a[132:133], v46 offset:0
ds_read_b64_tr_b16 a[134:135], v46 offset:1024
ds_read_b64_tr_b16 a[136:137], v45 offset:0
ds_read_b64_tr_b16 a[138:139], v45 offset:1024
ds_read_b64_tr_b16 a[140:141], v47 offset:0
ds_read_b64_tr_b16 a[142:143], v47 offset:1024
buffer_load_dword v32, v24, s[28:31], 0 offen sc0 sc1
s_waitcnt lgkmcnt(0)
s_waitcnt vmcnt(25)
s_barrier
s_add_u32 s56, s54, 393216
s_mov_b32 m0, 131072
s_nop 0
buffer_load_dwordx4 v26, s[8:11], s56 offen lds
s_add_u32 s56, s54, 409600
s_mov_b32 m0, 132096
s_nop 0
buffer_load_dwordx4 v26, s[8:11], s56 offen lds
s_add_u32 s56, s54, 425984
s_mov_b32 m0, 133120
s_nop 0
buffer_load_dwordx4 v27, s[8:11], s56 offen lds
s_add_u32 s56, s54, 442368
s_mov_b32 m0, 134144
s_nop 0
buffer_load_dwordx4 v27, s[8:11], s56 offen lds
ds_read_b64_tr_b16 a[144:145], v44 offset:4096
ds_read_b64_tr_b16 a[146:147], v44 offset:5120
ds_read_b64_tr_b16 a[148:149], v46 offset:4096
ds_read_b64_tr_b16 a[150:151], v46 offset:5120
ds_read_b64_tr_b16 a[152:153], v45 offset:4096
ds_read_b64_tr_b16 a[154:155], v45 offset:5120
ds_read_b64_tr_b16 a[156:157], v47 offset:4096
ds_read_b64_tr_b16 a[158:159], v47 offset:5120
s_waitcnt lgkmcnt(0)
s_waitcnt vmcnt(25)
s_barrier
s_add_u32 s56, s54, 1966080
s_mov_b32 m0, 135168
s_nop 0
buffer_load_dwordx4 v26, s[8:11], s56 offen lds
s_add_u32 s56, s54, 1982464
s_mov_b32 m0, 136192
s_nop 0
buffer_load_dwordx4 v26, s[8:11], s56 offen lds
s_add_u32 s56, s54, 1998848
s_mov_b32 m0, 137216
s_nop 0
buffer_load_dwordx4 v27, s[8:11], s56 offen lds
s_add_u32 s56, s54, 2015232
s_mov_b32 m0, 138240
s_nop 0
buffer_load_dwordx4 v27, s[8:11], s56 offen lds
ds_read_b64_tr_b16 a[160:161], v44 offset:8192
ds_read_b64_tr_b16 a[162:163], v44 offset:9216
ds_read_b64_tr_b16 a[164:165], v46 offset:8192
ds_read_b64_tr_b16 a[166:167], v46 offset:9216
ds_read_b64_tr_b16 a[168:169], v45 offset:8192
ds_read_b64_tr_b16 a[170:171], v45 offset:9216
ds_read_b64_tr_b16 a[172:173], v47 offset:8192
ds_read_b64_tr_b16 a[174:175], v47 offset:9216
s_waitcnt lgkmcnt(0)
s_waitcnt vmcnt(25)
s_barrier
s_add_u32 s56, s54, 2490368
s_mov_b32 m0, 139264
s_nop 0
buffer_load_dwordx4 v26, s[8:11], s56 offen lds
s_add_u32 s56, s54, 2506752
s_mov_b32 m0, 140288
s_nop 0
buffer_load_dwordx4 v26, s[8:11], s56 offen lds
s_add_u32 s56, s54, 2523136
s_mov_b32 m0, 141312
s_nop 0
buffer_load_dwordx4 v27, s[8:11], s56 offen lds
s_add_u32 s56, s54, 2539520
s_mov_b32 m0, 142336
s_nop 0
buffer_load_dwordx4 v27, s[8:11], s56 offen lds
ds_read_b64_tr_b16 a[216:217], v48 offset:12288
ds_read_b64_tr_b16 a[218:219], v48 offset:13312
ds_read_b64_tr_b16 a[220:221], v48 offset:14336
ds_read_b64_tr_b16 a[222:223], v48 offset:15360
ds_read_b64_tr_b16 a[176:177], v49 offset:12288
ds_read_b64_tr_b16 a[178:179], v49 offset:13312
ds_read_b64_tr_b16 a[180:181], v49 offset:14336
ds_read_b64_tr_b16 a[182:183], v49 offset:15360
s_waitcnt lgkmcnt(0)
s_waitcnt vmcnt(25)
s_barrier
s_add_u32 s56, s54, 3014656
s_mov_b32 m0, 143360
s_nop 0
buffer_load_dwordx4 v26, s[12:15], s56 offen lds
s_add_u32 s56, s54, 3031040
s_mov_b32 m0, 144384
s_nop 0
buffer_load_dwordx4 v26, s[12:15], s56 offen lds
s_add_u32 s56, s54, 3047424
s_mov_b32 m0, 145408
s_nop 0
buffer_load_dwordx4 v27, s[12:15], s56 offen lds
s_add_u32 s56, s54, 3063808
s_mov_b32 m0, 146432
s_nop 0
buffer_load_dwordx4 v27, s[12:15], s56 offen lds
ds_read_b64_tr_b16 a[232:233], v48 offset:16384
ds_read_b64_tr_b16 a[234:235], v48 offset:17408
ds_read_b64_tr_b16 a[236:237], v48 offset:18432
ds_read_b64_tr_b16 a[238:239], v48 offset:19456
ds_read_b64_tr_b16 a[184:185], v49 offset:16384
ds_read_b64_tr_b16 a[186:187], v49 offset:17408
ds_read_b64_tr_b16 a[188:189], v49 offset:18432
ds_read_b64_tr_b16 a[190:191], v49 offset:19456
s_waitcnt lgkmcnt(0)
s_waitcnt vmcnt(25)
s_barrier
s_add_u32 s56, s54, 4587520
s_mov_b32 m0, 147456
s_nop 0
buffer_load_dwordx4 v26, s[16:19], s56 offen lds
s_add_u32 s56, s54, 4603904
s_mov_b32 m0, 148480
s_nop 0
buffer_load_dwordx4 v26, s[16:19], s56 offen lds
s_add_u32 s56, s54, 4620288
s_mov_b32 m0, 149504
s_nop 0
buffer_load_dwordx4 v27, s[16:19], s56 offen lds
s_add_u32 s56, s54, 4636672
s_mov_b32 m0, 150528
s_nop 0
buffer_load_dwordx4 v27, s[16:19], s56 offen lds
ds_read_b64_tr_b16 a[240:241], v48 offset:20480
ds_read_b64_tr_b16 a[242:243], v48 offset:21504
ds_read_b64_tr_b16 a[244:245], v48 offset:22528
ds_read_b64_tr_b16 a[246:247], v48 offset:23552
ds_read_b64_tr_b16 a[192:193], v49 offset:20480
ds_read_b64_tr_b16 a[194:195], v49 offset:21504
ds_read_b64_tr_b16 a[196:197], v49 offset:22528
ds_read_b64_tr_b16 a[198:199], v49 offset:23552
s_waitcnt lgkmcnt(0)
s_waitcnt vmcnt(25)
s_barrier
s_add_u32 s56, s55, 41728
s_mov_b32 m0, 151552
s_nop 0
buffer_load_dwordx4 v28, s[20:23], s56 offen lds
s_add_u32 s56, s55, 44032
s_mov_b32 m0, 152576
s_nop 0
buffer_load_dwordx4 v28, s[20:23], s56 offen lds
s_add_u32 s56, s55, 50944
s_mov_b32 m0, 153600
s_nop 0
buffer_load_dwordx4 v28, s[20:23], s56 offen lds
s_add_u32 s56, s55, 53248
s_mov_b32 m0, 154624
s_nop 0
buffer_load_dwordx4 v28, s[20:23], s56 offen lds
ds_read_b64_tr_b16 a[248:249], v48 offset:24576
ds_read_b64_tr_b16 a[250:251], v48 offset:25600
ds_read_b64_tr_b16 a[252:253], v48 offset:26624
ds_read_b64_tr_b16 a[254:255], v48 offset:27648
ds_read_b64_tr_b16 a[200:201], v49 offset:24576
ds_read_b64_tr_b16 a[202:203], v49 offset:25600
ds_read_b64_tr_b16 a[204:205], v49 offset:26624
ds_read_b64_tr_b16 a[206:207], v49 offset:27648
s_waitcnt lgkmcnt(0)
s_waitcnt vmcnt(25)
s_barrier
s_add_u32 s56, s55, 41984
s_mov_b32 m0, 155648
s_nop 0
buffer_load_dwordx4 v28, s[20:23], s56 offen lds
s_add_u32 s56, s55, 44288
s_mov_b32 m0, 156672
s_nop 0
buffer_load_dwordx4 v28, s[20:23], s56 offen lds
s_add_u32 s56, s55, 51200
s_mov_b32 m0, 157696
s_nop 0
buffer_load_dwordx4 v28, s[20:23], s56 offen lds
s_add_u32 s56, s55, 53504
s_mov_b32 m0, 158720
s_nop 0
buffer_load_dwordx4 v28, s[20:23], s56 offen lds
ds_read_b64_tr_b16 a[224:225], v48 offset:28672
ds_read_b64_tr_b16 a[226:227], v48 offset:29696
ds_read_b64_tr_b16 a[228:229], v48 offset:30720
ds_read_b64_tr_b16 a[230:231], v48 offset:31744
ds_read_b64_tr_b16 a[208:209], v49 offset:28672
ds_read_b64_tr_b16 a[210:211], v49 offset:29696
ds_read_b64_tr_b16 a[212:213], v49 offset:30720
ds_read_b64_tr_b16 a[214:215], v49 offset:31744
s_waitcnt lgkmcnt(0)
s_waitcnt vmcnt(24)
s_barrier
s_add_u32 s56, s55, 42240
s_mov_b32 m0, 159744
s_nop 0
buffer_load_dwordx4 v28, s[20:23], s56 offen lds
s_add_u32 s56, s55, 44544
s_mov_b32 m0, 160768
s_nop 0
buffer_load_dwordx4 v28, s[20:23], s56 offen lds
s_add_u32 s56, s55, 51456
s_mov_b32 m0, 161792
s_nop 0
buffer_load_dwordx4 v28, s[20:23], s56 offen lds
s_add_u32 s56, s55, 53760
s_mov_b32 m0, 162816
s_nop 0
buffer_load_dwordx4 v28, s[20:23], s56 offen lds
ds_read_b64_tr_b16 v[60:61], v44 offset:0
ds_read_b64_tr_b16 v[62:63], v44 offset:1024
ds_read_b64_tr_b16 v[64:65], v46 offset:0
ds_read_b64_tr_b16 v[66:67], v46 offset:1024
ds_read_b64_tr_b16 v[68:69], v45 offset:0
ds_read_b64_tr_b16 v[70:71], v45 offset:1024
ds_read_b64_tr_b16 v[72:73], v47 offset:0
ds_read_b64_tr_b16 v[74:75], v47 offset:1024
s_waitcnt lgkmcnt(0)
s_waitcnt vmcnt(24)
s_barrier
ds_write_b128 v2, v[60:63] offset:0
ds_write_b128 v2, v[64:67] offset:1024
ds_write_b128 v2, v[68:71] offset:2048
ds_write_b128 v2, v[72:75] offset:3072
ds_read_b64_tr_b16 v[60:61], v44 offset:4096
ds_read_b64_tr_b16 v[62:63], v44 offset:5120
ds_read_b64_tr_b16 v[64:65], v46 offset:4096
ds_read_b64_tr_b16 v[66:67], v46 offset:5120
ds_read_b64_tr_b16 v[68:69], v45 offset:4096
ds_read_b64_tr_b16 v[70:71], v45 offset:5120
ds_read_b64_tr_b16 v[72:73], v47 offset:4096
ds_read_b64_tr_b16 v[74:75], v47 offset:5120
L_rdv_w3:
v_readfirstlane_b32 s38, v32
s_nop 0
s_and_b32 s57, s38, 0xff
s_cmp_lg_u32 s57, 32
s_cbranch_scc1 L_rdv2_w3
L_kvw_w3p:
s_load_dwordx16 s[64:79], s[4:5], s101 glc
s_sub_u32 s41, s41, 1
s_cbranch_scc1 L_exit
s_waitcnt lgkmcnt(0)
s_min_u32 s64, s64, s65
s_min_u32 s64, s64, s66
s_min_u32 s64, s64, s67
s_min_u32 s64, s64, s68
s_min_u32 s64, s64, s69
s_min_u32 s64, s64, s70
s_min_u32 s64, s64, s71
s_min_u32 s64, s64, s72
s_min_u32 s64, s64, s73
s_min_u32 s64, s64, s74
s_min_u32 s64, s64, s75
s_min_u32 s64, s64, s76
s_min_u32 s64, s64, s77
s_min_u32 s64, s64, s78
s_min_u32 s64, s64, s79
s_lshl_b32 s100, s64, 2
s_sub_u32 s100, s100, 1
s_cmp_ge_i32 s34, s100
s_cbranch_scc1 L_kvw_w3p
s_waitcnt lgkmcnt(0)
s_waitcnt vmcnt(20)
s_barrier
ds_write_b128 v2, v[60:63] offset:4096
ds_write_b128 v2, v[64:67] offset:5120
ds_write_b128 v2, v[68:71] offset:6144
ds_write_b128 v2, v[72:75] offset:7168
ds_read_b64_tr_b16 v[60:61], v44 offset:8192
ds_read_b64_tr_b16 v[62:63], v44 offset:9216
ds_read_b64_tr_b16 v[64:65], v46 offset:8192
ds_read_b64_tr_b16 v[66:67], v46 offset:9216
ds_read_b64_tr_b16 v[68:69], v45 offset:8192
ds_read_b64_tr_b16 v[70:71], v45 offset:9216
ds_read_b64_tr_b16 v[72:73], v47 offset:8192
ds_read_b64_tr_b16 v[74:75], v47 offset:9216
buffer_load_dwordx4 v[12:15], v9, s[4:7], s37 offen offset:0
buffer_load_dwordx4 v[16:19], v9, s[4:7], s37 offen offset:1024
buffer_load_dwordx4 v[52:55], v1, s[4:7], s37 offen offset:2048
buffer_load_dwordx4 v[56:59], v1, s[4:7], s37 offen offset:3072
s_mov_b32 m0, 1024
s_nop 0
buffer_load_dwordx4 v1, s[4:7], s47 offen offset:3072 sc1 lds
s_waitcnt lgkmcnt(0)
s_waitcnt vmcnt(21)
s_barrier
ds_write_b128 v2, v[60:63] offset:8192
ds_write_b128 v2, v[64:67] offset:9216
ds_write_b128 v2, v[68:71] offset:10240
ds_write_b128 v2, v[72:75] offset:11264
ds_read_b64_tr_b16 v[60:61], v44 offset:12288
ds_read_b64_tr_b16 v[62:63], v44 offset:13312
ds_read_b64_tr_b16 v[64:65], v46 offset:12288
ds_read_b64_tr_b16 v[66:67], v46 offset:13312
ds_read_b64_tr_b16 v[68:69], v45 offset:12288
ds_read_b64_tr_b16 v[70:71], v45 offset:13312
ds_read_b64_tr_b16 v[72:73], v47 offset:12288
ds_read_b64_tr_b16 v[74:75], v47 offset:13312
s_waitcnt lgkmcnt(0)
s_waitcnt vmcnt(17)
s_barrier
ds_write_b128 v2, v[60:63] offset:12288
ds_write_b128 v2, v[64:67] offset:13312
ds_write_b128 v2, v[68:71] offset:14336
ds_write_b128 v2, v[72:75] offset:15360
ds_read_b64_tr_b16 v[60:61], v44 offset:16384
ds_read_b64_tr_b16 v[62:63], v44 offset:17408
ds_read_b64_tr_b16 v[64:65], v46 offset:16384
ds_read_b64_tr_b16 v[66:67], v46 offset:17408
ds_read_b64_tr_b16 v[68:69], v45 offset:16384
ds_read_b64_tr_b16 v[70:71], v45 offset:17408
ds_read_b64_tr_b16 v[72:73], v47 offset:16384
ds_read_b64_tr_b16 v[74:75], v47 offset:17408
s_waitcnt lgkmcnt(0)
s_waitcnt vmcnt(13)
s_barrier
ds_write_b128 v2, v[60:63] offset:16384
ds_write_b128 v2, v[64:67] offset:17408
ds_write_b128 v2, v[68:71] offset:18432
ds_write_b128 v2, v[72:75] offset:19456
ds_read_b64_tr_b16 v[60:61], v48 offset:20480
ds_read_b64_tr_b16 v[62:63], v48 offset:21504
ds_read_b64_tr_b16 v[64:65], v48 offset:22528
ds_read_b64_tr_b16 v[66:67], v48 offset:23552
ds_read_b64_tr_b16 v[68:69], v49 offset:20480
ds_read_b64_tr_b16 v[70:71], v49 offset:21504
ds_read_b64_tr_b16 v[72:73], v49 offset:22528
ds_read_b64_tr_b16 v[74:75], v49 offset:23552
s_waitcnt lgkmcnt(0)
s_waitcnt vmcnt(9)
s_barrier
ds_write_b128 v2, v[60:63] offset:20480
ds_write_b128 v2, v[64:67] offset:21504
ds_write_b128 v2, v[68:71] offset:22528
ds_write_b128 v2, v[72:75] offset:23552
ds_read_b64_tr_b16 v[60:61], v48 offset:24576
ds_read_b64_tr_b16 v[62:63], v48 offset:25600
ds_read_b64_tr_b16 v[64:65], v48 offset:26624
ds_read_b64_tr_b16 v[66:67], v48 offset:27648
ds_read_b64_tr_b16 v[68:69], v49 offset:24576
ds_read_b64_tr_b16 v[70:71], v49 offset:25600
ds_read_b64_tr_b16 v[72:73], v49 offset:26624
ds_read_b64_tr_b16 v[74:75], v49 offset:27648
s_waitcnt lgkmcnt(0)
s_waitcnt vmcnt(5)
s_barrier
ds_write_b128 v2, v[60:63] offset:24576
ds_write_b128 v2, v[64:67] offset:25600
ds_write_b128 v2, v[68:71] offset:26624
ds_write_b128 v2, v[72:75] offset:27648
ds_read_b64_tr_b16 v[60:61], v48 offset:28672
ds_read_b64_tr_b16 v[62:63], v48 offset:29696
ds_read_b64_tr_b16 v[64:65], v48 offset:30720
ds_read_b64_tr_b16 v[66:67], v48 offset:31744
ds_read_b64_tr_b16 v[68:69], v49 offset:28672
ds_read_b64_tr_b16 v[70:71], v49 offset:29696
ds_read_b64_tr_b16 v[72:73], v49 offset:30720
ds_read_b64_tr_b16 v[74:75], v49 offset:31744
s_waitcnt lgkmcnt(0)
s_barrier
ds_write_b128 v2, v[60:63] offset:28672
ds_write_b128 v2, v[64:67] offset:29696
ds_write_b128 v2, v[68:71] offset:30720
ds_write_b128 v2, v[72:75] offset:31744
s_lshl_b32 s57, s58, 5
s_mov_b32 s0, 0x3f003f00
s_mov_b32 s1, 0x3f003f00
s_mov_b32 s58, 304128
s_cmp_eq_u32 s38, s57
s_mov_b32 s56, 0x33333333
s_mov_b32 s57, 0x33333333
s_mov_b32 s2, 0x21800000
s_mov_b32 s55, -24
s_cbranch_scc0 L_slow_w3
v_mov_b64 v[20:21], 0
v_mov_b64 v[22:23], 0
v_mov_b64 v[24:25], 0
v_mov_b64 v[26:27], 0
v_mov_b64 v[28:29], 0
v_mov_b64 v[30:31], 0
v_mov_b64 v[32:33], 0
v_mov_b64 v[34:35], 0
v_mov_b64 v[36:37], 0
v_mov_b64 v[38:39], 0
v_mov_b64 v[40:41], 0
v_mov_b64 v[42:43], 0
ds_read_b128 v[44:47], v2 offset:0
ds_read_b128 v[48:51], v2 offset:1024
v_bfe_u32 v77, v1, 6, 1
v_lshl_add_u32 v77, v77, 3, v1
v_lshlrev_b32 v77, 1, v77
v_lshlrev_b32 v78, 3, v1
s_waitcnt vmcnt(0) lgkmcnt(0)
s_branch L_top_w3f
L_done_w3f:
s_waitcnt vmcnt(0) lgkmcnt(0)
s_endpgm
L_rdv2_w3:
buffer_load_dword v32, v24, s[28:31], 0 offen sc0 sc1
s_sub_u32 s41, s41, 1
s_cbranch_scc1 L_exit
s_waitcnt vmcnt(0)
s_branch L_rdv_w3
L_ra0_w3f:
s_mov_b32 m0, 1024
s_nop 0
buffer_load_dwordx4 v1, s[4:7], s47 offen offset:0 sc1 lds
buffer_load_dwordx4 v1, s[4:7], s47 offen offset:1024 sc1 lds
buffer_load_dwordx4 v1, s[4:7], s47 offen offset:2048 sc1 lds
buffer_load_dwordx4 v1, s[4:7], s47 offen offset:3072 sc1 lds
s_sub_u32 s41, s41, 1
s_cbranch_scc1 L_exit
ds_read_b128 v[44:47], v2 offset:0
ds_read_b128 v[48:51], v2 offset:1024
v_mov_b64 v[20:21], 0
v_mov_b64 v[22:23], 0
v_mov_b64 v[24:25], 0
v_mov_b64 v[26:27], 0
v_mov_b64 v[28:29], 0
v_mov_b64 v[30:31], 0
v_mov_b64 v[32:33], 0
v_mov_b64 v[34:35], 0
v_mov_b64 v[36:37], 0
v_mov_b64 v[38:39], 0
v_mov_b64 v[40:41], 0
v_mov_b64 v[42:43], 0
s_waitcnt vmcnt(0)
ds_read_b128 v[60:63], v1 offset:1024
ds_read_b128 v[64:67], v1 offset:2048
ds_read_b128 v[68:71], v1 offset:3072
ds_read_b128 v[72:75], v1 offset:4096
s_branch L_s0_w3f
L_ra1_w3f:
L_ra2_w3f:
s_waitcnt lgkmcnt(0)
s_barrier
s_mov_b32 m0, 5120
s_nop 0
buffer_load_dwordx4 v1, s[4:7], s48 offen offset:3072 sc1 lds
s_sub_u32 s41, s41, 1
s_cbranch_scc1 L_exit
s_waitcnt vmcnt(0)
s_barrier
ds_read_b128 v[76:79], v1 offset:5120
ds_read_b128 v[60:63], v1 offset:6144
ds_read_b128 v[64:67], v1 offset:7168
ds_read_b128 v[68:71], v1 offset:8192
ds_read_b128 v[72:75], v1 offset:9216
s_waitcnt lgkmcnt(0)
v_bitop3_b32 v6, v76, v60, s35 bitop3:0x7e
v_bitop3_b32 v6, v6, v64, s35 bitop3:0xf6
v_bitop3_b32 v6, v6, v68, s35 bitop3:0xf6
v_bitop3_b32 v6, v6, v72, s35 bitop3:0xf6
v_and_b32 v6, 1, v6
v_cmp_ne_u32 vcc, 0, v6

s_cbranch_vccnz L_ra2_w3f
s_branch L_a1_w3f
L_mx_w3f:
s_waitcnt lgkmcnt(0)
v_max3_f32 v30, v12, v13, v28
v_max_f32 v30, v30, v29
v_mov_b32 v31, v30
s_nop 1
v_permlane16_swap_b32 v30, v31
v_max_f32 v30, v30, v31
v_mov_b32 v31, v30
s_nop 1
v_permlane32_swap_b32 v30, v31
v_max_f32 v30, v30, v31
ds_write_b32 v1, v30 offset:10252
s_waitcnt lgkmcnt(0)
s_barrier
ds_read_b128 v[32:35], v1 offset:10240
s_waitcnt lgkmcnt(0)
v_max3_f32 v32, v32, v33, v34
v_max_f32 v32, v32, v35
v_sub_f32 v14, v12, v32
v_sub_f32 v15, v13, v32
v_sub_f32 v30, v28, v32
v_sub_f32 v31, v29, v32
v_exp_f32 v14, v14
v_exp_f32 v15, v15
v_exp_f32 v30, v30
v_exp_f32 v31, v31
v_cvt_pk_bf16_f32 v14, v14, v15
v_cvt_pk_bf16_f32 v30, v30, v31
ds_write_b32 v5, v14 offset:15136
v_cndmask_b32_e64 v26, 0, v30, s[56:57]
v_cndmask_b32_e64 v27, 0, v30, s[56:57]
v_mov_b64 v[76:77], s[52:53]
v_mov_b64 v[78:79], s[52:53]
v_mov_b32_dpp v24, v26 quad_perm:[2,3,0,1] row_mask:0xf bank_mask:0xf
v_mov_b32_dpp v25, v26 quad_perm:[2,3,0,1] row_mask:0xf bank_mask:0xf
s_waitcnt lgkmcnt(0)
s_barrier
v_mov_b64 v[14:15], s[0:1]
ds_read_b128 v[16:19], v1 offset:14368
ds_read_b128 v[36:39], v1 offset:14336
s_waitcnt lgkmcnt(0)
v_mfma_f32_16x16x32_bf16 v[32:35], v[76:79], v[16:19], 0
v_mfma_f32_16x16x32_bf16 v[20:23], v[52:55], v[16:19], 0
v_mfma_f32_16x16x32_bf16 v[20:23], v[56:59], v[36:39], v[20:23]
v_mfma_f32_16x16x16_bf16 v[32:35], v[14:15], v[26:27], v[32:35]
v_mfma_f32_16x16x32_bf16 v[20:23], v[40:43], v[24:27], v[20:23]
s_nop 3
v_rcp_f32 v33, v32
s_nop 2
v_mul_f32_dpp v20, v33, v20 quad_perm:[0,1,0,1] row_mask:0xf bank_mask:0xf
v_mul_f32_dpp v21, v33, v21 quad_perm:[0,1,0,1] row_mask:0xf bank_mask:0xf
v_mul_f32_dpp v22, v33, v22 quad_perm:[0,1,0,1] row_mask:0xf bank_mask:0xf
v_mul_f32_dpp v23, v33, v23 quad_perm:[0,1,0,1] row_mask:0xf bank_mask:0xf
v_cvt_pk_bf16_f32 v20, v20, v21
v_cvt_pk_bf16_f32 v21, v22, v23
ds_write_b64 v6, v[20:21] offset:8192
v_mov_b32_dpp v16, v20 quad_perm:[0,1,0,1] row_mask:0xf bank_mask:0xf
v_mov_b32_dpp v17, v21 quad_perm:[0,1,0,1] row_mask:0xf bank_mask:0xf
v_mov_b32_dpp v18, v20 quad_perm:[2,3,2,3] row_mask:0xf bank_mask:0xf
v_mov_b32_dpp v19, v21 quad_perm:[2,3,2,3] row_mask:0xf bank_mask:0xf
v_mov_b64 v[76:77], 0
v_mov_b64 v[78:79], 0
v_mov_b64 v[36:37], 0
v_mov_b64 v[38:39], 0
v_mov_b64 v[24:25], 0
v_mov_b64 v[26:27], 0
v_mov_b64 v[32:33], 0
v_mov_b64 v[34:35], 0
s_waitcnt lgkmcnt(0)
s_branch L_mxb_w3f

L_ev_w3f:
buffer_load_dword v11, v11, s[4:7], s101 offen sc0 sc1
s_sub_u32 s41, s41, 1
s_cbranch_scc1 L_exit
s_waitcnt vmcnt(0)
s_branch L_evb_w3f
L_slow_w3:
v_mov_b64 v[20:21], 0
v_mov_b64 v[22:23], 0
v_mov_b64 v[24:25], 0
v_mov_b64 v[26:27], 0
v_mov_b64 v[28:29], 0
v_mov_b64 v[30:31], 0
v_mov_b64 v[32:33], 0
v_mov_b64 v[34:35], 0
v_mov_b64 v[36:37], 0
v_mov_b64 v[38:39], 0
v_mov_b64 v[40:41], 0
v_mov_b64 v[42:43], 0
ds_read_b128 v[44:47], v2 offset:0
ds_read_b128 v[48:51], v2 offset:1024
v_bfe_u32 v77, v1, 6, 1
v_lshl_add_u32 v77, v77, 3, v1
v_lshlrev_b32 v77, 1, v77
v_lshlrev_b32 v78, 3, v1
s_waitcnt vmcnt(0) lgkmcnt(0)
s_branch L_top_w3s
L_done_w3s:
s_waitcnt vmcnt(0) lgkmcnt(0)
s_endpgm
L_ra0_w3s:
s_mov_b32 m0, 1024
s_nop 0
buffer_load_dwordx4 v1, s[4:7], s47 offen offset:0 sc0 sc1 lds
buffer_load_dwordx4 v1, s[4:7], s47 offen offset:1024 sc0 sc1 lds
buffer_load_dwordx4 v1, s[4:7], s47 offen offset:2048 sc0 sc1 lds
buffer_load_dwordx4 v1, s[4:7], s47 offen offset:3072 sc0 sc1 lds
s_sub_u32 s41, s41, 1
s_cbranch_scc1 L_exit
ds_read_b128 v[44:47], v2 offset:0
ds_read_b128 v[48:51], v2 offset:1024
v_mov_b64 v[20:21], 0
v_mov_b64 v[22:23], 0
v_mov_b64 v[24:25], 0
v_mov_b64 v[26:27], 0
v_mov_b64 v[28:29], 0
v_mov_b64 v[30:31], 0
v_mov_b64 v[32:33], 0
v_mov_b64 v[34:35], 0
v_mov_b64 v[36:37], 0
v_mov_b64 v[38:39], 0
v_mov_b64 v[40:41], 0
v_mov_b64 v[42:43], 0
s_waitcnt vmcnt(0)
ds_read_b128 v[60:63], v1 offset:1024
ds_read_b128 v[64:67], v1 offset:2048
ds_read_b128 v[68:71], v1 offset:3072
ds_read_b128 v[72:75], v1 offset:4096
s_branch L_s0_w3s
L_ra1_w3s:
L_ra2_w3s:
s_waitcnt lgkmcnt(0)
s_barrier
s_mov_b32 m0, 5120
s_nop 0
buffer_load_dwordx4 v1, s[4:7], s48 offen offset:3072 sc0 sc1 lds
s_sub_u32 s41, s41, 1
s_cbranch_scc1 L_exit
s_waitcnt vmcnt(0)
s_barrier
ds_read_b128 v[76:79], v1 offset:5120
ds_read_b128 v[60:63], v1 offset:6144
ds_read_b128 v[64:67], v1 offset:7168
ds_read_b128 v[68:71], v1 offset:8192
ds_read_b128 v[72:75], v1 offset:9216
s_waitcnt lgkmcnt(0)
v_bitop3_b32 v6, v76, v60, s35 bitop3:0x7e
v_bitop3_b32 v6, v6, v64, s35 bitop3:0xf6
v_bitop3_b32 v6, v6, v68, s35 bitop3:0xf6
v_bitop3_b32 v6, v6, v72, s35 bitop3:0xf6
v_and_b32 v6, 1, v6
v_cmp_ne_u32 vcc, 0, v6

s_cbranch_vccnz L_ra2_w3s
s_branch L_a1_w3s
L_mx_w3s:
s_waitcnt lgkmcnt(0)
v_max3_f32 v30, v12, v13, v28
v_max_f32 v30, v30, v29
v_mov_b32 v31, v30
s_nop 1
v_permlane16_swap_b32 v30, v31
v_max_f32 v30, v30, v31
v_mov_b32 v31, v30
s_nop 1
v_permlane32_swap_b32 v30, v31
v_max_f32 v30, v30, v31
ds_write_b32 v1, v30 offset:10252
s_waitcnt lgkmcnt(0)
s_barrier
ds_read_b128 v[32:35], v1 offset:10240
s_waitcnt lgkmcnt(0)
v_max3_f32 v32, v32, v33, v34
v_max_f32 v32, v32, v35
v_sub_f32 v14, v12, v32
v_sub_f32 v15, v13, v32
v_sub_f32 v30, v28, v32
v_sub_f32 v31, v29, v32
v_exp_f32 v14, v14
v_exp_f32 v15, v15
v_exp_f32 v30, v30
v_exp_f32 v31, v31
v_cvt_pk_bf16_f32 v14, v14, v15
v_cvt_pk_bf16_f32 v30, v30, v31
ds_write_b32 v5, v14 offset:15136
v_cndmask_b32_e64 v26, 0, v30, s[56:57]
v_cndmask_b32_e64 v27, 0, v30, s[56:57]
v_mov_b64 v[76:77], s[52:53]
v_mov_b64 v[78:79], s[52:53]
v_mov_b32_dpp v24, v26 quad_perm:[2,3,0,1] row_mask:0xf bank_mask:0xf
v_mov_b32_dpp v25, v26 quad_perm:[2,3,0,1] row_mask:0xf bank_mask:0xf
s_waitcnt lgkmcnt(0)
s_barrier
v_mov_b64 v[14:15], s[0:1]
ds_read_b128 v[16:19], v1 offset:14368
ds_read_b128 v[36:39], v1 offset:14336
s_waitcnt lgkmcnt(0)
v_mfma_f32_16x16x32_bf16 v[32:35], v[76:79], v[16:19], 0
v_mfma_f32_16x16x32_bf16 v[20:23], v[52:55], v[16:19], 0
v_mfma_f32_16x16x32_bf16 v[20:23], v[56:59], v[36:39], v[20:23]
v_mfma_f32_16x16x16_bf16 v[32:35], v[14:15], v[26:27], v[32:35]
v_mfma_f32_16x16x32_bf16 v[20:23], v[40:43], v[24:27], v[20:23]
s_nop 3
v_rcp_f32 v33, v32
s_nop 2
v_mul_f32_dpp v20, v33, v20 quad_perm:[0,1,0,1] row_mask:0xf bank_mask:0xf
v_mul_f32_dpp v21, v33, v21 quad_perm:[0,1,0,1] row_mask:0xf bank_mask:0xf
v_mul_f32_dpp v22, v33, v22 quad_perm:[0,1,0,1] row_mask:0xf bank_mask:0xf
v_mul_f32_dpp v23, v33, v23 quad_perm:[0,1,0,1] row_mask:0xf bank_mask:0xf
v_cvt_pk_bf16_f32 v20, v20, v21
v_cvt_pk_bf16_f32 v21, v22, v23
ds_write_b64 v6, v[20:21] offset:8192
v_mov_b32_dpp v16, v20 quad_perm:[0,1,0,1] row_mask:0xf bank_mask:0xf
v_mov_b32_dpp v17, v21 quad_perm:[0,1,0,1] row_mask:0xf bank_mask:0xf
v_mov_b32_dpp v18, v20 quad_perm:[2,3,2,3] row_mask:0xf bank_mask:0xf
v_mov_b32_dpp v19, v21 quad_perm:[2,3,2,3] row_mask:0xf bank_mask:0xf
v_mov_b64 v[76:77], 0
v_mov_b64 v[78:79], 0
v_mov_b64 v[36:37], 0
v_mov_b64 v[38:39], 0
v_mov_b64 v[24:25], 0
v_mov_b64 v[26:27], 0
v_mov_b64 v[32:33], 0
v_mov_b64 v[34:35], 0
s_waitcnt lgkmcnt(0)
s_branch L_mxb_w3s

L_ev_w3s:
buffer_load_dword v11, v11, s[4:7], s101 offen sc0 sc1
s_sub_u32 s41, s41, 1
s_cbranch_scc1 L_exit
s_waitcnt vmcnt(0)
s_branch L_evb_w3s
s_endpgm

.section .rodata,"a"
.p2align 6
.amdhsa_kernel gated_mix__sliding_local_dilated__memory_aug_recurrent_mem_tr__prompt_kernel
  .amdhsa_next_free_vgpr 512
  .amdhsa_next_free_sgpr 102
  .amdhsa_accum_offset 256
  .amdhsa_group_segment_fixed_size 0
  .amdhsa_kernarg_size 112
  .amdhsa_user_sgpr_count 2
  .amdhsa_user_sgpr_kernarg_segment_ptr 1
  .amdhsa_system_sgpr_workgroup_id_x 1
  .amdhsa_float_denorm_mode_32 3
.end_amdhsa_kernel
```

```asm
; @launch grid=(256,1,1) block=(256,1,1) lds=163840
.amdgcn_target "amdgcn-amd-amdhsa--gfx950"
.text
.globl gated_mix__sliding_local_dilated__memory_aug_recurrent_mem_tr__prompt_kernel
.p2align 8
.type gated_mix__sliding_local_dilated__memory_aug_recurrent_mem_tr__prompt_kernel,@function
gated_mix__sliding_local_dilated__memory_aug_recurrent_mem_tr__prompt_kernel:

s_cmp_ge_u32 s2, 256
s_cbranch_scc1 L_exit_w
s_and_b32 s3, s2, 7
s_lshr_b32 s32, s2, 3
s_cmp_lg_u32 s3, 0
s_cbranch_scc1 L_other
s_load_dwordx2 s[24:25], s[0:1], 32
s_load_dwordx2 s[8:9], s[0:1], 40
s_load_dwordx2 s[12:13], s[0:1], 48
s_load_dwordx2 s[16:17], s[0:1], 56
s_load_dwordx2 s[20:21], s[0:1], 64
s_load_dwordx2 s[28:29], s[0:1], 96
s_load_dwordx2 s[4:5], s[0:1], 104
s_mov_b32 s26, 9216
s_mov_b32 s27, 0x20000
s_mov_b32 s10, 4718592
s_mov_b32 s11, 0x20000
s_mov_b32 s14, 4718592
s_mov_b32 s15, 0x20000
s_mov_b32 s18, 4718592
s_mov_b32 s19, 0x20000
s_mov_b32 s22, 4718592
s_mov_b32 s23, 0x20000
s_mov_b32 s30, 256
s_mov_b32 s31, 0x20000
s_mov_b32 s6, 268435456
s_mov_b32 s7, 0x20000
v_lshrrev_b32 v1, 6, v0
v_and_b32 v21, 15, v0
v_readfirstlane_b32 s33, v1
v_bfe_u32 v22, v0, 4, 2
v_lshrrev_b32 v24, 1, v22
v_and_b32 v23, 1, v22
v_lshl_add_u32 v23, v24, 3, v23
v_lshlrev_b32 v23, 13, v23
v_lshlrev_b32 v26, 1, v22
v_xor_b32 v26, v26, v21
v_lshl_add_u32 v26, v26, 4, v23
v_xor_b32 v27, 128, v26
s_lshl_b32 s54, s32, 8
s_lshl_b32 s55, s33, 17
s_add_u32 s55, s55, s54
s_mul_i32 s57, s33, 40960
s_min_u32 s57, s57, 114688
s_waitcnt lgkmcnt(0)
s_add_u32 s56, s55, 524288
s_add_u32 m0, s57, 36864
s_nop 0
buffer_load_dwordx4 v26, s[8:11], s56 offen lds
s_add_u32 s56, s55, 540672
s_add_u32 m0, s57, 37888
s_nop 0
buffer_load_dwordx4 v26, s[8:11], s56 offen lds
s_add_u32 s56, s55, 557056
s_add_u32 m0, s57, 38912
s_nop 0
buffer_load_dwordx4 v27, s[8:11], s56 offen lds
s_add_u32 s56, s55, 573440
s_add_u32 m0, s57, 39936
s_nop 0
buffer_load_dwordx4 v27, s[8:11], s56 offen lds
s_add_u32 s56, s55, 1048576
s_add_u32 m0, s57, 40960
s_nop 0
buffer_load_dwordx4 v26, s[8:11], s56 offen lds
s_add_u32 s56, s55, 1064960
s_add_u32 m0, s57, 41984
s_nop 0
buffer_load_dwordx4 v26, s[8:11], s56 offen lds
s_add_u32 s56, s55, 1081344
s_add_u32 m0, s57, 43008
s_nop 0
buffer_load_dwordx4 v27, s[8:11], s56 offen lds
s_add_u32 s56, s55, 1097728
s_add_u32 m0, s57, 44032
s_nop 0
buffer_load_dwordx4 v27, s[8:11], s56 offen lds
s_add_u32 s56, s55, 2621440
s_add_u32 m0, s57, 45056
s_nop 0
buffer_load_dwordx4 v26, s[8:11], s56 offen lds
s_add_u32 s56, s55, 2637824
s_add_u32 m0, s57, 46080
s_nop 0
buffer_load_dwordx4 v26, s[8:11], s56 offen lds
s_add_u32 s56, s55, 2654208
s_add_u32 m0, s57, 47104
s_nop 0
buffer_load_dwordx4 v27, s[8:11], s56 offen lds
s_add_u32 s56, s55, 2670592
s_add_u32 m0, s57, 48128
s_nop 0
buffer_load_dwordx4 v27, s[8:11], s56 offen lds
s_add_u32 s56, s55, 3145728
s_add_u32 m0, s57, 16384
s_nop 0
buffer_load_dwordx4 v26, s[8:11], s56 offen lds
s_add_u32 s56, s55, 3162112
s_add_u32 m0, s57, 17408
s_nop 0
buffer_load_dwordx4 v26, s[8:11], s56 offen lds
s_add_u32 s56, s55, 3178496
s_add_u32 m0, s57, 18432
s_nop 0
buffer_load_dwordx4 v27, s[8:11], s56 offen lds
s_add_u32 s56, s55, 3194880
s_add_u32 m0, s57, 19456
s_nop 0
buffer_load_dwordx4 v27, s[8:11], s56 offen lds
s_add_u32 s56, s55, 3670016
s_add_u32 m0, s57, 20480
s_nop 0
buffer_load_dwordx4 v26, s[8:11], s56 offen lds
s_add_u32 s56, s55, 3686400
s_add_u32 m0, s57, 21504
s_nop 0
buffer_load_dwordx4 v26, s[8:11], s56 offen lds
s_add_u32 s56, s55, 3702784
s_add_u32 m0, s57, 22528
s_nop 0
buffer_load_dwordx4 v27, s[8:11], s56 offen lds
s_add_u32 s56, s55, 3719168
s_add_u32 m0, s57, 23552
s_nop 0
buffer_load_dwordx4 v27, s[8:11], s56 offen lds
s_add_u32 s56, s55, 4194304
s_add_u32 m0, s57, 24576
s_nop 0
buffer_load_dwordx4 v26, s[8:11], s56 offen lds
s_add_u32 s56, s55, 4210688
s_add_u32 m0, s57, 25600
s_nop 0
buffer_load_dwordx4 v26, s[8:11], s56 offen lds
s_add_u32 s56, s55, 4227072
s_add_u32 m0, s57, 26624
s_nop 0
buffer_load_dwordx4 v27, s[8:11], s56 offen lds
s_add_u32 s56, s55, 4243456
s_add_u32 m0, s57, 27648
s_nop 0
buffer_load_dwordx4 v27, s[8:11], s56 offen lds
s_cmp_eq_u32 s33, 1
s_cbranch_scc1 L_pro_w1r
s_cmp_eq_u32 s33, 2
s_cbranch_scc1 L_pro_w2r
s_cmp_eq_u32 s33, 3
s_cbranch_scc1 L_pro_w3
s_cmp_lt_u32 s32, 8
s_cbranch_scc1 L_pro_w0r
s_branch L_pro_w0
L_exit:
s_endpgm

L_other:
s_lshl_b32 s3, s3, 2
s_lshr_b32 s3, 0x64352170, s3
s_and_b32 s3, s3, 7
s_cmp_ge_u32 s3, 5
s_cbranch_scc1 L_pre_aw
s_lshr_b32 s33, s32, 3
s_and_b32 s32, s32, 7
s_sub_u32 s3, s3, 1
s_lshl_b32 s3, s3, 3
s_add_u32 s32, s32, s3
s_branch L_role_q
L_pre_aw:
s_sub_u32 s3, s3, 5
s_lshl_b32 s49, s3, 5
s_add_u32 s49, s49, s32
s_lshr_b32 s33, s49, 3
s_and_b32 s32, s32, 7
s_branch L_role_aw
L_exit_w:
s_endpgm
L_role_q:
s_load_dwordx2 s[4:5], s[0:1], 104
s_mov_b32 s6, 268435456
s_mov_b32 s7, 0x20000
s_load_dwordx2 s[8:9], s[0:1], 0
s_mov_b32 s10, 2359296
s_mov_b32 s11, 0x20000
s_load_dwordx2 s[12:13], s[0:1], 40
s_mov_b32 s14, 4718592
s_mov_b32 s15, 0x20000
s_load_dwordx2 s[16:17], s[0:1], 48
s_mov_b32 s18, 4718592
s_mov_b32 s19, 0x20000
s_load_dwordx2 s[20:21], s[0:1], 56
s_mov_b32 s22, 4718592
s_mov_b32 s23, 0x20000
s_load_dwordx2 s[24:25], s[0:1], 96
s_mov_b32 s26, 256
s_mov_b32 s27, 0x20000
v_and_b32 v9, 63, v0
v_and_b32 v10, 15, v0
v_bfe_u32 v11, v0, 4, 2
v_lshrrev_b32 v1, 6, v0
s_nop 0
v_readfirstlane_b32 s34, v1
v_lshrrev_b32 v12, 2, v9
v_mul_u32_u24 v2, 1152, v12
v_lshrrev_b32 v12, 5, v9
v_lshlrev_b32 v12, 1, v12
v_and_b32 v13, 3, v9
v_xor_b32 v12, v12, v13
v_lshl_add_u32 v2, v12, 4, v2
v_lshrrev_b32 v12, 3, v10
v_lshlrev_b32 v12, 1, v12
v_xor_b32 v12, v12, v11
v_lshlrev_b32 v12, 4, v12
v_lshl_add_u32 v3, v10, 6, v12
v_lshlrev_b32 v12, 13, v11
v_lshlrev_b32 v5, 1, v11
v_xor_b32 v5, v5, v10
v_lshl_add_u32 v5, v5, 4, v12
v_xor_b32 v6, 128, v5
v_lshlrev_b32 v1, 4, v9
s_mul_i32 s38, s34, 20480
s_add_u32 s38, s38, 73728
s_lshl_b32 s39, s32, 8
s_lshl_b32 s40, s34, 17
s_add_u32 s39, s39, s40
s_lshl_b32 s43, s33, 1
s_and_b32 s41, s34, 1
s_add_u32 s43, s43, s41
s_mul_i32 s43, s43, 18432
s_lshr_b32 s41, s34, 1
s_lshl_b32 s41, s41, 6
s_add_u32 s43, s43, s41
s_lshl_b32 s44, s34, 10
s_mov_b32 s36, 400000
s_mov_b32 s46, 0x3e0293ee
s_mov_b32 s47, 0x3e0293ee
v_mov_b32 v8, 0
v_lshrrev_b32 v12, 2, v10
v_lshlrev_b32 v4, 12, v12
v_lshl_add_u32 v4, v11, 8, v4
v_and_b32 v12, 3, v10
v_lshl_add_u32 v4, v12, 4, v4
s_waitcnt lgkmcnt(0)
s_add_u32 s37, s39, 0
s_add_u32 m0, s38, 0
s_nop 0
buffer_load_dwordx4 v5, s[12:15], s37 offen lds
s_add_u32 s37, s39, 32768
s_add_u32 m0, s38, 1024
s_nop 0
buffer_load_dwordx4 v5, s[12:15], s37 offen lds
s_add_u32 s37, s39, 65536
s_add_u32 m0, s38, 2048
s_nop 0
buffer_load_dwordx4 v6, s[12:15], s37 offen lds
s_add_u32 s37, s39, 98304
s_add_u32 m0, s38, 3072
s_nop 0
buffer_load_dwordx4 v6, s[12:15], s37 offen lds
s_add_u32 s37, s39, 524288
s_add_u32 m0, s38, 4096
s_nop 0
buffer_load_dwordx4 v5, s[12:15], s37 offen lds
s_add_u32 s37, s39, 557056
s_add_u32 m0, s38, 5120
s_nop 0
buffer_load_dwordx4 v5, s[12:15], s37 offen lds
s_add_u32 s37, s39, 589824
s_add_u32 m0, s38, 6144
s_nop 0
buffer_load_dwordx4 v6, s[12:15], s37 offen lds
s_add_u32 s37, s39, 622592
s_add_u32 m0, s38, 7168
s_nop 0
buffer_load_dwordx4 v6, s[12:15], s37 offen lds
s_add_u32 s37, s39, 1048576
s_add_u32 m0, s38, 8192
s_nop 0
buffer_load_dwordx4 v5, s[12:15], s37 offen lds
s_add_u32 s37, s39, 1081344
s_add_u32 m0, s38, 9216
s_nop 0
buffer_load_dwordx4 v5, s[12:15], s37 offen lds
s_add_u32 s37, s39, 1114112
s_add_u32 m0, s38, 10240
s_nop 0
buffer_load_dwordx4 v6, s[12:15], s37 offen lds
s_add_u32 s37, s39, 1146880
s_add_u32 m0, s38, 11264
s_nop 0
buffer_load_dwordx4 v6, s[12:15], s37 offen lds
s_add_u32 s37, s39, 1572864
s_add_u32 m0, s38, 12288
s_nop 0
buffer_load_dwordx4 v5, s[12:15], s37 offen lds
s_add_u32 s37, s39, 1605632
s_add_u32 m0, s38, 13312
s_nop 0
buffer_load_dwordx4 v5, s[12:15], s37 offen lds
s_add_u32 s37, s39, 1638400
s_add_u32 m0, s38, 14336
s_nop 0
buffer_load_dwordx4 v6, s[12:15], s37 offen lds
s_add_u32 s37, s39, 1671168
s_add_u32 m0, s38, 15360
s_nop 0
buffer_load_dwordx4 v6, s[12:15], s37 offen lds
s_add_u32 s37, s39, 2097152
s_add_u32 m0, s38, 16384
s_nop 0
buffer_load_dwordx4 v5, s[12:15], s37 offen lds
s_add_u32 s37, s39, 2129920
s_add_u32 m0, s38, 17408
s_nop 0
buffer_load_dwordx4 v5, s[12:15], s37 offen lds
s_add_u32 s37, s39, 2162688
s_add_u32 m0, s38, 18432
s_nop 0
buffer_load_dwordx4 v6, s[12:15], s37 offen lds
s_add_u32 s37, s39, 2195456
s_add_u32 m0, s38, 19456
s_nop 0
buffer_load_dwordx4 v6, s[12:15], s37 offen lds
s_add_u32 s37, s43, 0
s_add_u32 m0, s44, 0
s_nop 0
buffer_load_dwordx4 v2, s[8:11], s37 offen lds
s_add_u32 s37, s43, 128
s_add_u32 m0, s44, 4096
s_nop 0
buffer_load_dwordx4 v2, s[8:11], s37 offen lds
s_add_u32 s37, s43, 256
s_add_u32 m0, s44, 8192
s_nop 0
buffer_load_dwordx4 v2, s[8:11], s37 offen lds
s_add_u32 s37, s43, 384
s_add_u32 m0, s44, 12288
s_nop 0
buffer_load_dwordx4 v2, s[8:11], s37 offen lds
s_add_u32 s37, s43, 512
s_add_u32 m0, s44, 16384
s_nop 0
buffer_load_dwordx4 v2, s[8:11], s37 offen lds
s_add_u32 s37, s43, 640
s_add_u32 m0, s44, 20480
s_nop 0
buffer_load_dwordx4 v2, s[8:11], s37 offen lds
s_add_u32 s37, s43, 768
s_add_u32 m0, s44, 24576
s_nop 0
buffer_load_dwordx4 v2, s[8:11], s37 offen lds
s_add_u32 s37, s43, 896
s_add_u32 m0, s44, 28672
s_nop 0
buffer_load_dwordx4 v2, s[8:11], s37 offen lds
s_add_u32 s37, s43, 1024
s_add_u32 m0, s44, 32768
s_nop 0
buffer_load_dwordx4 v2, s[8:11], s37 offen lds
s_lshr_b32 s40, s34, 1
s_lshl_b32 s40, s40, 3
s_and_b32 s41, s34, 1
s_lshl_b32 s41, s41, 1
s_add_u32 s40, s40, s41
s_add_u32 s40, s40, 0
s_lshl_b32 s41, s34, 2
s_add_u32 s41, s41, 0
v_and_b32 v12, 1, v11
v_lshrrev_b32 v13, 2, v10
v_lshl_add_u32 v12, v12, 2, v13
v_lshlrev_b32 v12, 1, v12
v_bfe_u32 v16, v10, 1, 1
v_add_u32 v16, s40, v16
v_xor_b32 v16, v16, v12
v_lshlrev_b32 v16, 4, v16
v_lshl_add_u32 v16, v13, 8, v16
v_and_b32 v12, 1, v11
v_lshl_add_u32 v16, v12, 11, v16
v_and_b32 v12, 1, v10
v_lshl_add_u32 v16, v12, 3, v16
v_lshrrev_b32 v12, 1, v11
v_mul_u32_u24 v12, 20480, v12
v_add_u32 v12, 73728, v12
v_add_u32 v16, v16, v12
v_and_b32 v12, 1, v11
v_lshrrev_b32 v13, 2, v10
v_lshl_add_u32 v12, v12, 2, v13
v_lshlrev_b32 v12, 1, v12
v_bfe_u32 v20, v10, 1, 1
v_add_u32 v20, s41, v20
v_xor_b32 v20, v20, v12
v_lshlrev_b32 v20, 4, v20
v_lshl_add_u32 v20, v13, 8, v20
v_and_b32 v12, 1, v11
v_lshl_add_u32 v20, v12, 11, v20
v_and_b32 v12, 1, v10
v_lshl_add_u32 v20, v12, 3, v20
v_lshrrev_b32 v12, 1, v11
v_mul_u32_u24 v12, 20480, v12
v_add_u32 v12, 73728, v12
v_add_u32 v20, v20, v12
v_and_b32 v12, 1, v11
v_lshrrev_b32 v13, 2, v10
v_lshl_add_u32 v12, v12, 2, v13
v_lshlrev_b32 v12, 1, v12
v_bfe_u32 v18, v10, 1, 1
v_add_u32 v18, s40, v18
v_xor_b32 v18, v18, v12
v_lshlrev_b32 v18, 4, v18
v_lshl_add_u32 v18, v13, 8, v18
v_and_b32 v12, 1, v11
v_lshl_add_u32 v18, v12, 11, v18
v_and_b32 v12, 1, v10
v_lshl_add_u32 v18, v12, 3, v18
v_lshrrev_b32 v12, 1, v11
v_mul_u32_u24 v12, 20480, v12
v_add_u32 v12, 114688, v12
v_add_u32 v18, v18, v12
v_and_b32 v12, 1, v11
v_lshrrev_b32 v13, 2, v10
v_lshl_add_u32 v12, v12, 2, v13
v_lshlrev_b32 v12, 1, v12
v_bfe_u32 v22, v10, 1, 1
v_add_u32 v22, s41, v22
v_xor_b32 v22, v22, v12
v_lshlrev_b32 v22, 4, v22
v_lshl_add_u32 v22, v13, 8, v22
v_and_b32 v12, 1, v11
v_lshl_add_u32 v22, v12, 11, v22
v_and_b32 v12, 1, v10
v_lshl_add_u32 v22, v12, 3, v22
v_lshrrev_b32 v12, 1, v11
v_mul_u32_u24 v12, 20480, v12
v_add_u32 v12, 114688, v12
v_add_u32 v22, v22, v12
s_lshr_b32 s40, s34, 1
s_lshl_b32 s40, s40, 3
s_and_b32 s41, s34, 1
s_lshl_b32 s41, s41, 1
s_add_u32 s40, s40, s41
s_add_u32 s40, s40, 4
s_lshl_b32 s41, s34, 2
s_add_u32 s41, s41, 2
v_and_b32 v12, 1, v11
v_lshrrev_b32 v13, 2, v10
v_lshl_add_u32 v12, v12, 2, v13
v_lshlrev_b32 v12, 1, v12
v_bfe_u32 v17, v10, 1, 1
v_add_u32 v17, s40, v17
v_xor_b32 v17, v17, v12
v_lshlrev_b32 v17, 4, v17
v_lshl_add_u32 v17, v13, 8, v17
v_and_b32 v12, 1, v11
v_lshl_add_u32 v17, v12, 11, v17
v_and_b32 v12, 1, v10
v_lshl_add_u32 v17, v12, 3, v17
v_lshrrev_b32 v12, 1, v11
v_mul_u32_u24 v12, 20480, v12
v_add_u32 v12, 73728, v12
v_add_u32 v17, v17, v12
v_and_b32 v12, 1, v11
v_lshrrev_b32 v13, 2, v10
v_lshl_add_u32 v12, v12, 2, v13
v_lshlrev_b32 v12, 1, v12
v_bfe_u32 v21, v10, 1, 1
v_add_u32 v21, s41, v21
v_xor_b32 v21, v21, v12
v_lshlrev_b32 v21, 4, v21
v_lshl_add_u32 v21, v13, 8, v21
v_and_b32 v12, 1, v11
v_lshl_add_u32 v21, v12, 11, v21
v_and_b32 v12, 1, v10
v_lshl_add_u32 v21, v12, 3, v21
v_lshrrev_b32 v12, 1, v11
v_mul_u32_u24 v12, 20480, v12
v_add_u32 v12, 73728, v12
v_add_u32 v21, v21, v12
v_and_b32 v12, 1, v11
v_lshrrev_b32 v13, 2, v10
v_lshl_add_u32 v12, v12, 2, v13
v_lshlrev_b32 v12, 1, v12
v_bfe_u32 v19, v10, 1, 1
v_add_u32 v19, s40, v19
v_xor_b32 v19, v19, v12
v_lshlrev_b32 v19, 4, v19
v_lshl_add_u32 v19, v13, 8, v19
v_and_b32 v12, 1, v11
v_lshl_add_u32 v19, v12, 11, v19
v_and_b32 v12, 1, v10
v_lshl_add_u32 v19, v12, 3, v19
v_lshrrev_b32 v12, 1, v11
v_mul_u32_u24 v12, 20480, v12
v_add_u32 v12, 114688, v12
v_add_u32 v19, v19, v12
v_and_b32 v12, 1, v11
v_lshrrev_b32 v13, 2, v10
v_lshl_add_u32 v12, v12, 2, v13
v_lshlrev_b32 v12, 1, v12
v_bfe_u32 v23, v10, 1, 1
v_add_u32 v23, s41, v23
v_xor_b32 v23, v23, v12
v_lshlrev_b32 v23, 4, v23
v_lshl_add_u32 v23, v13, 8, v23
v_and_b32 v12, 1, v11
v_lshl_add_u32 v23, v12, 11, v23
v_and_b32 v12, 1, v10
v_lshl_add_u32 v23, v12, 3, v23
v_lshrrev_b32 v12, 1, v11
v_mul_u32_u24 v12, 20480, v12
v_add_u32 v12, 114688, v12
v_add_u32 v23, v23, v12
s_waitcnt vmcnt(25)
s_barrier
ds_read_b64_tr_b16 v[80:81], v16 offset:0
ds_read_b64_tr_b16 v[82:83], v16 offset:1024
ds_read_b64_tr_b16 v[84:85], v18 offset:0
ds_read_b64_tr_b16 v[86:87], v18 offset:1024
ds_read_b64_tr_b16 v[152:153], v17 offset:0
ds_read_b64_tr_b16 v[154:155], v17 offset:1024
ds_read_b64_tr_b16 v[156:157], v19 offset:0
ds_read_b64_tr_b16 v[158:159], v19 offset:1024
s_waitcnt lgkmcnt(0)
s_waitcnt vmcnt(21)
s_barrier
s_add_u32 s37, s39, 2621440
s_add_u32 m0, s38, 0
s_nop 0
buffer_load_dwordx4 v5, s[12:15], s37 offen lds
s_add_u32 s37, s39, 2654208
s_add_u32 m0, s38, 1024
s_nop 0
buffer_load_dwordx4 v5, s[12:15], s37 offen lds
s_add_u32 s37, s39, 2686976
s_add_u32 m0, s38, 2048
s_nop 0
buffer_load_dwordx4 v6, s[12:15], s37 offen lds
s_add_u32 s37, s39, 2719744
s_add_u32 m0, s38, 3072
s_nop 0
buffer_load_dwordx4 v6, s[12:15], s37 offen lds
ds_read_b64_tr_b16 v[88:89], v16 offset:4096
ds_read_b64_tr_b16 v[90:91], v16 offset:5120
ds_read_b64_tr_b16 v[92:93], v18 offset:4096
ds_read_b64_tr_b16 v[94:95], v18 offset:5120
ds_read_b64_tr_b16 v[160:161], v17 offset:4096
ds_read_b64_tr_b16 v[162:163], v17 offset:5120
ds_read_b64_tr_b16 v[164:165], v19 offset:4096
ds_read_b64_tr_b16 v[166:167], v19 offset:5120
s_waitcnt lgkmcnt(0)
s_waitcnt vmcnt(21)
s_barrier
s_add_u32 s37, s39, 3145728
s_add_u32 m0, s38, 4096
s_nop 0
buffer_load_dwordx4 v5, s[12:15], s37 offen lds
s_add_u32 s37, s39, 3178496
s_add_u32 m0, s38, 5120
s_nop 0
buffer_load_dwordx4 v5, s[12:15], s37 offen lds
s_add_u32 s37, s39, 3211264
s_add_u32 m0, s38, 6144
s_nop 0
buffer_load_dwordx4 v6, s[12:15], s37 offen lds
s_add_u32 s37, s39, 3244032
s_add_u32 m0, s38, 7168
s_nop 0
buffer_load_dwordx4 v6, s[12:15], s37 offen lds
ds_read_b64_tr_b16 v[96:97], v16 offset:8192
ds_read_b64_tr_b16 v[98:99], v16 offset:9216
ds_read_b64_tr_b16 v[100:101], v18 offset:8192
ds_read_b64_tr_b16 v[102:103], v18 offset:9216
ds_read_b64_tr_b16 v[168:169], v17 offset:8192
ds_read_b64_tr_b16 v[170:171], v17 offset:9216
ds_read_b64_tr_b16 v[172:173], v19 offset:8192
ds_read_b64_tr_b16 v[174:175], v19 offset:9216
s_waitcnt lgkmcnt(0)
s_waitcnt vmcnt(21)
s_barrier
s_add_u32 s37, s39, 3670016
s_add_u32 m0, s38, 8192
s_nop 0
buffer_load_dwordx4 v5, s[12:15], s37 offen lds
s_add_u32 s37, s39, 3702784
s_add_u32 m0, s38, 9216
s_nop 0
buffer_load_dwordx4 v5, s[12:15], s37 offen lds
s_add_u32 s37, s39, 3735552
s_add_u32 m0, s38, 10240
s_nop 0
buffer_load_dwordx4 v6, s[12:15], s37 offen lds
s_add_u32 s37, s39, 3768320
s_add_u32 m0, s38, 11264
s_nop 0
buffer_load_dwordx4 v6, s[12:15], s37 offen lds
ds_read_b64_tr_b16 v[104:105], v16 offset:12288
ds_read_b64_tr_b16 v[106:107], v16 offset:13312
ds_read_b64_tr_b16 v[108:109], v18 offset:12288
ds_read_b64_tr_b16 v[110:111], v18 offset:13312
ds_read_b64_tr_b16 v[176:177], v17 offset:12288
ds_read_b64_tr_b16 v[178:179], v17 offset:13312
ds_read_b64_tr_b16 v[180:181], v19 offset:12288
ds_read_b64_tr_b16 v[182:183], v19 offset:13312
s_waitcnt lgkmcnt(0)
s_waitcnt vmcnt(21)
s_barrier
s_add_u32 s37, s39, 4194304
s_add_u32 m0, s38, 12288
s_nop 0
buffer_load_dwordx4 v5, s[12:15], s37 offen lds
s_add_u32 s37, s39, 4227072
s_add_u32 m0, s38, 13312
s_nop 0
buffer_load_dwordx4 v5, s[12:15], s37 offen lds
s_add_u32 s37, s39, 4259840
s_add_u32 m0, s38, 14336
s_nop 0
buffer_load_dwordx4 v6, s[12:15], s37 offen lds
s_add_u32 s37, s39, 4292608
s_add_u32 m0, s38, 15360
s_nop 0
buffer_load_dwordx4 v6, s[12:15], s37 offen lds
ds_read_b64_tr_b16 v[112:113], v16 offset:16384
ds_read_b64_tr_b16 v[114:115], v16 offset:17408
ds_read_b64_tr_b16 v[116:117], v18 offset:16384
ds_read_b64_tr_b16 v[118:119], v18 offset:17408
ds_read_b64_tr_b16 v[184:185], v17 offset:16384
ds_read_b64_tr_b16 v[186:187], v17 offset:17408
ds_read_b64_tr_b16 v[188:189], v19 offset:16384
ds_read_b64_tr_b16 v[190:191], v19 offset:17408
s_waitcnt lgkmcnt(0)
s_waitcnt vmcnt(12)
s_barrier
s_add_u32 s37, s39, 0
s_add_u32 m0, s38, 16384
s_nop 0
buffer_load_dwordx4 v5, s[16:19], s37 offen lds
s_add_u32 s37, s39, 32768
s_add_u32 m0, s38, 17408
s_nop 0
buffer_load_dwordx4 v5, s[16:19], s37 offen lds
s_add_u32 s37, s39, 65536
s_add_u32 m0, s38, 18432
s_nop 0
buffer_load_dwordx4 v6, s[16:19], s37 offen lds
s_add_u32 s37, s39, 98304
s_add_u32 m0, s38, 19456
s_nop 0
buffer_load_dwordx4 v6, s[16:19], s37 offen lds
ds_read_b64_tr_b16 v[120:121], v16 offset:0
ds_read_b64_tr_b16 v[122:123], v16 offset:1024
ds_read_b64_tr_b16 v[124:125], v18 offset:0
ds_read_b64_tr_b16 v[126:127], v18 offset:1024
ds_read_b64_tr_b16 v[192:193], v17 offset:0
ds_read_b64_tr_b16 v[194:195], v17 offset:1024
ds_read_b64_tr_b16 v[196:197], v19 offset:0
ds_read_b64_tr_b16 v[198:199], v19 offset:1024
s_waitcnt lgkmcnt(0)
s_waitcnt vmcnt(12)
s_barrier
s_add_u32 s37, s39, 524288
s_add_u32 m0, s38, 0
s_nop 0
buffer_load_dwordx4 v5, s[16:19], s37 offen lds
s_add_u32 s37, s39, 557056
s_add_u32 m0, s38, 1024
s_nop 0
buffer_load_dwordx4 v5, s[16:19], s37 offen lds
s_add_u32 s37, s39, 589824
s_add_u32 m0, s38, 2048
s_nop 0
buffer_load_dwordx4 v6, s[16:19], s37 offen lds
s_add_u32 s37, s39, 622592
s_add_u32 m0, s38, 3072
s_nop 0
buffer_load_dwordx4 v6, s[16:19], s37 offen lds
ds_read_b64_tr_b16 v[128:129], v16 offset:4096
ds_read_b64_tr_b16 v[130:131], v16 offset:5120
ds_read_b64_tr_b16 v[132:133], v18 offset:4096
ds_read_b64_tr_b16 v[134:135], v18 offset:5120
ds_read_b64_tr_b16 v[200:201], v17 offset:4096
ds_read_b64_tr_b16 v[202:203], v17 offset:5120
ds_read_b64_tr_b16 v[204:205], v19 offset:4096
ds_read_b64_tr_b16 v[206:207], v19 offset:5120
s_waitcnt lgkmcnt(0)
s_waitcnt vmcnt(12)
s_barrier
s_add_u32 s37, s39, 1048576
s_add_u32 m0, s38, 4096
s_nop 0
buffer_load_dwordx4 v5, s[16:19], s37 offen lds
s_add_u32 s37, s39, 1081344
s_add_u32 m0, s38, 5120
s_nop 0
buffer_load_dwordx4 v5, s[16:19], s37 offen lds
s_add_u32 s37, s39, 1114112
s_add_u32 m0, s38, 6144
s_nop 0
buffer_load_dwordx4 v6, s[16:19], s37 offen lds
s_add_u32 s37, s39, 1146880
s_add_u32 m0, s38, 7168
s_nop 0
buffer_load_dwordx4 v6, s[16:19], s37 offen lds
ds_read_b64_tr_b16 v[136:137], v16 offset:8192
ds_read_b64_tr_b16 v[138:139], v16 offset:9216
ds_read_b64_tr_b16 v[140:141], v18 offset:8192
ds_read_b64_tr_b16 v[142:143], v18 offset:9216
ds_read_b64_tr_b16 v[208:209], v17 offset:8192
ds_read_b64_tr_b16 v[210:211], v17 offset:9216
ds_read_b64_tr_b16 v[212:213], v19 offset:8192
ds_read_b64_tr_b16 v[214:215], v19 offset:9216
s_waitcnt lgkmcnt(0)
s_waitcnt vmcnt(12)
s_barrier
s_add_u32 s37, s39, 1572864
s_add_u32 m0, s38, 8192
s_nop 0
buffer_load_dwordx4 v5, s[16:19], s37 offen lds
s_add_u32 s37, s39, 1605632
s_add_u32 m0, s38, 9216
s_nop 0
buffer_load_dwordx4 v5, s[16:19], s37 offen lds
s_add_u32 s37, s39, 1638400
s_add_u32 m0, s38, 10240
s_nop 0
buffer_load_dwordx4 v6, s[16:19], s37 offen lds
s_add_u32 s37, s39, 1671168
s_add_u32 m0, s38, 11264
s_nop 0
buffer_load_dwordx4 v6, s[16:19], s37 offen lds
ds_read_b64_tr_b16 v[144:145], v16 offset:12288
ds_read_b64_tr_b16 v[146:147], v16 offset:13312
ds_read_b64_tr_b16 v[148:149], v18 offset:12288
ds_read_b64_tr_b16 v[150:151], v18 offset:13312
ds_read_b64_tr_b16 v[216:217], v17 offset:12288
ds_read_b64_tr_b16 v[218:219], v17 offset:13312
ds_read_b64_tr_b16 v[220:221], v19 offset:12288
ds_read_b64_tr_b16 v[222:223], v19 offset:13312
s_waitcnt lgkmcnt(0)
s_waitcnt vmcnt(12)
s_barrier
s_add_u32 s37, s39, 2097152
s_add_u32 m0, s38, 12288
s_nop 0
buffer_load_dwordx4 v5, s[16:19], s37 offen lds
s_add_u32 s37, s39, 2129920
s_add_u32 m0, s38, 13312
s_nop 0
buffer_load_dwordx4 v5, s[16:19], s37 offen lds
s_add_u32 s37, s39, 2162688
s_add_u32 m0, s38, 14336
s_nop 0
buffer_load_dwordx4 v6, s[16:19], s37 offen lds
s_add_u32 s37, s39, 2195456
s_add_u32 m0, s38, 15360
s_nop 0
buffer_load_dwordx4 v6, s[16:19], s37 offen lds
ds_read_b64_tr_b16 v[224:225], v16 offset:16384
ds_read_b64_tr_b16 v[226:227], v16 offset:17408
ds_read_b64_tr_b16 v[228:229], v18 offset:16384
ds_read_b64_tr_b16 v[230:231], v18 offset:17408
ds_read_b64_tr_b16 a[40:41], v17 offset:16384
ds_read_b64_tr_b16 a[42:43], v17 offset:17408
ds_read_b64_tr_b16 a[44:45], v19 offset:16384
ds_read_b64_tr_b16 a[46:47], v19 offset:17408
s_waitcnt lgkmcnt(0)
s_waitcnt vmcnt(12)
s_barrier
s_add_u32 s37, s39, 2621440
s_add_u32 m0, s38, 16384
s_nop 0
buffer_load_dwordx4 v5, s[16:19], s37 offen lds
s_add_u32 s37, s39, 2654208
s_add_u32 m0, s38, 17408
s_nop 0
buffer_load_dwordx4 v5, s[16:19], s37 offen lds
s_add_u32 s37, s39, 2686976
s_add_u32 m0, s38, 18432
s_nop 0
buffer_load_dwordx4 v6, s[16:19], s37 offen lds
s_add_u32 s37, s39, 2719744
s_add_u32 m0, s38, 19456
s_nop 0
buffer_load_dwordx4 v6, s[16:19], s37 offen lds
ds_read_b64_tr_b16 v[232:233], v16 offset:0
ds_read_b64_tr_b16 v[234:235], v16 offset:1024
ds_read_b64_tr_b16 v[236:237], v18 offset:0
ds_read_b64_tr_b16 v[238:239], v18 offset:1024
ds_read_b64_tr_b16 a[48:49], v17 offset:0
ds_read_b64_tr_b16 a[50:51], v17 offset:1024
ds_read_b64_tr_b16 a[52:53], v19 offset:0
ds_read_b64_tr_b16 a[54:55], v19 offset:1024
s_waitcnt lgkmcnt(0)
s_waitcnt vmcnt(12)
s_barrier
s_add_u32 s37, s39, 3145728
s_add_u32 m0, s38, 0
s_nop 0
buffer_load_dwordx4 v5, s[16:19], s37 offen lds
s_add_u32 s37, s39, 3178496
s_add_u32 m0, s38, 1024
s_nop 0
buffer_load_dwordx4 v5, s[16:19], s37 offen lds
s_add_u32 s37, s39, 3211264
s_add_u32 m0, s38, 2048
s_nop 0
buffer_load_dwordx4 v6, s[16:19], s37 offen lds
s_add_u32 s37, s39, 3244032
s_add_u32 m0, s38, 3072
s_nop 0
buffer_load_dwordx4 v6, s[16:19], s37 offen lds
ds_read_b64_tr_b16 v[240:241], v16 offset:4096
ds_read_b64_tr_b16 v[242:243], v16 offset:5120
ds_read_b64_tr_b16 v[244:245], v18 offset:4096
ds_read_b64_tr_b16 v[246:247], v18 offset:5120
ds_read_b64_tr_b16 a[56:57], v17 offset:4096
ds_read_b64_tr_b16 a[58:59], v17 offset:5120
ds_read_b64_tr_b16 a[60:61], v19 offset:4096
ds_read_b64_tr_b16 a[62:63], v19 offset:5120
s_waitcnt lgkmcnt(0)
s_waitcnt vmcnt(12)
s_barrier
s_add_u32 s37, s39, 3670016
s_add_u32 m0, s38, 4096
s_nop 0
buffer_load_dwordx4 v5, s[16:19], s37 offen lds
s_add_u32 s37, s39, 3702784
s_add_u32 m0, s38, 5120
s_nop 0
buffer_load_dwordx4 v5, s[16:19], s37 offen lds
s_add_u32 s37, s39, 3735552
s_add_u32 m0, s38, 6144
s_nop 0
buffer_load_dwordx4 v6, s[16:19], s37 offen lds
s_add_u32 s37, s39, 3768320
s_add_u32 m0, s38, 7168
s_nop 0
buffer_load_dwordx4 v6, s[16:19], s37 offen lds
ds_read_b64_tr_b16 v[248:249], v16 offset:8192
ds_read_b64_tr_b16 v[250:251], v16 offset:9216
ds_read_b64_tr_b16 v[252:253], v18 offset:8192
ds_read_b64_tr_b16 v[254:255], v18 offset:9216
ds_read_b64_tr_b16 a[64:65], v17 offset:8192
ds_read_b64_tr_b16 a[66:67], v17 offset:9216
ds_read_b64_tr_b16 a[68:69], v19 offset:8192
ds_read_b64_tr_b16 a[70:71], v19 offset:9216
s_waitcnt lgkmcnt(0)
s_waitcnt vmcnt(12)
s_barrier
s_add_u32 s37, s39, 4194304
s_add_u32 m0, s38, 8192
s_nop 0
buffer_load_dwordx4 v5, s[16:19], s37 offen lds
s_add_u32 s37, s39, 4227072
s_add_u32 m0, s38, 9216
s_nop 0
buffer_load_dwordx4 v5, s[16:19], s37 offen lds
s_add_u32 s37, s39, 4259840
s_add_u32 m0, s38, 10240
s_nop 0
buffer_load_dwordx4 v6, s[16:19], s37 offen lds
s_add_u32 s37, s39, 4292608
s_add_u32 m0, s38, 11264
s_nop 0
buffer_load_dwordx4 v6, s[16:19], s37 offen lds
ds_read_b64_tr_b16 a[0:1], v16 offset:12288
ds_read_b64_tr_b16 a[2:3], v16 offset:13312
ds_read_b64_tr_b16 a[4:5], v18 offset:12288
ds_read_b64_tr_b16 a[6:7], v18 offset:13312
ds_read_b64_tr_b16 a[72:73], v17 offset:12288
ds_read_b64_tr_b16 a[74:75], v17 offset:13312
ds_read_b64_tr_b16 a[76:77], v19 offset:12288
ds_read_b64_tr_b16 a[78:79], v19 offset:13312
s_waitcnt lgkmcnt(0)
s_waitcnt vmcnt(12)
s_barrier
s_add_u32 s37, s39, 0
s_add_u32 m0, s38, 12288
s_nop 0
buffer_load_dwordx4 v5, s[20:23], s37 offen lds
s_add_u32 s37, s39, 32768
s_add_u32 m0, s38, 13312
s_nop 0
buffer_load_dwordx4 v5, s[20:23], s37 offen lds
s_add_u32 s37, s39, 65536
s_add_u32 m0, s38, 14336
s_nop 0
buffer_load_dwordx4 v6, s[20:23], s37 offen lds
s_add_u32 s37, s39, 98304
s_add_u32 m0, s38, 15360
s_nop 0
buffer_load_dwordx4 v6, s[20:23], s37 offen lds
ds_read_b64_tr_b16 a[8:9], v16 offset:16384
ds_read_b64_tr_b16 a[10:11], v16 offset:17408
ds_read_b64_tr_b16 a[12:13], v18 offset:16384
ds_read_b64_tr_b16 a[14:15], v18 offset:17408
ds_read_b64_tr_b16 a[80:81], v17 offset:16384
ds_read_b64_tr_b16 a[82:83], v17 offset:17408
ds_read_b64_tr_b16 a[84:85], v19 offset:16384
ds_read_b64_tr_b16 a[86:87], v19 offset:17408
s_waitcnt lgkmcnt(0)
s_waitcnt vmcnt(12)
s_barrier
s_add_u32 s37, s39, 524288
s_add_u32 m0, s38, 16384
s_nop 0
buffer_load_dwordx4 v5, s[20:23], s37 offen lds
s_add_u32 s37, s39, 557056
s_add_u32 m0, s38, 17408
s_nop 0
buffer_load_dwordx4 v5, s[20:23], s37 offen lds
s_add_u32 s37, s39, 589824
s_add_u32 m0, s38, 18432
s_nop 0
buffer_load_dwordx4 v6, s[20:23], s37 offen lds
s_add_u32 s37, s39, 622592
s_add_u32 m0, s38, 19456
s_nop 0
buffer_load_dwordx4 v6, s[20:23], s37 offen lds
ds_read_b64_tr_b16 a[16:17], v16 offset:0
ds_read_b64_tr_b16 a[18:19], v16 offset:1024
ds_read_b64_tr_b16 a[20:21], v18 offset:0
ds_read_b64_tr_b16 a[22:23], v18 offset:1024
ds_read_b64_tr_b16 a[88:89], v17 offset:0
ds_read_b64_tr_b16 a[90:91], v17 offset:1024
ds_read_b64_tr_b16 a[92:93], v19 offset:0
ds_read_b64_tr_b16 a[94:95], v19 offset:1024
s_waitcnt lgkmcnt(0)
s_waitcnt vmcnt(12)
s_barrier
s_add_u32 s37, s39, 1048576
s_add_u32 m0, s38, 0
s_nop 0
buffer_load_dwordx4 v5, s[20:23], s37 offen lds
s_add_u32 s37, s39, 1081344
s_add_u32 m0, s38, 1024
s_nop 0
buffer_load_dwordx4 v5, s[20:23], s37 offen lds
s_add_u32 s37, s39, 1114112
s_add_u32 m0, s38, 2048
s_nop 0
buffer_load_dwordx4 v6, s[20:23], s37 offen lds
s_add_u32 s37, s39, 1146880
s_add_u32 m0, s38, 3072
s_nop 0
buffer_load_dwordx4 v6, s[20:23], s37 offen lds
ds_read_b64_tr_b16 a[24:25], v16 offset:4096
ds_read_b64_tr_b16 a[26:27], v16 offset:5120
ds_read_b64_tr_b16 a[28:29], v18 offset:4096
ds_read_b64_tr_b16 a[30:31], v18 offset:5120
ds_read_b64_tr_b16 a[96:97], v17 offset:4096
ds_read_b64_tr_b16 a[98:99], v17 offset:5120
ds_read_b64_tr_b16 a[100:101], v19 offset:4096
ds_read_b64_tr_b16 a[102:103], v19 offset:5120
s_waitcnt lgkmcnt(0)
s_waitcnt vmcnt(12)
s_barrier
s_add_u32 s37, s39, 1572864
s_add_u32 m0, s38, 4096
s_nop 0
buffer_load_dwordx4 v5, s[20:23], s37 offen lds
s_add_u32 s37, s39, 1605632
s_add_u32 m0, s38, 5120
s_nop 0
buffer_load_dwordx4 v5, s[20:23], s37 offen lds
s_add_u32 s37, s39, 1638400
s_add_u32 m0, s38, 6144
s_nop 0
buffer_load_dwordx4 v6, s[20:23], s37 offen lds
s_add_u32 s37, s39, 1671168
s_add_u32 m0, s38, 7168
s_nop 0
buffer_load_dwordx4 v6, s[20:23], s37 offen lds
ds_read_b64_tr_b16 a[32:33], v16 offset:8192
ds_read_b64_tr_b16 a[34:35], v16 offset:9216
ds_read_b64_tr_b16 a[36:37], v18 offset:8192
ds_read_b64_tr_b16 a[38:39], v18 offset:9216
ds_read_b64_tr_b16 a[104:105], v17 offset:8192
ds_read_b64_tr_b16 a[106:107], v17 offset:9216
ds_read_b64_tr_b16 a[108:109], v19 offset:8192
ds_read_b64_tr_b16 a[110:111], v19 offset:9216
s_waitcnt lgkmcnt(0)
s_waitcnt vmcnt(12)
s_barrier
s_add_u32 s37, s39, 2097152
s_add_u32 m0, s38, 8192
s_nop 0
buffer_load_dwordx4 v5, s[20:23], s37 offen lds
s_add_u32 s37, s39, 2129920
s_add_u32 m0, s38, 9216
s_nop 0
buffer_load_dwordx4 v5, s[20:23], s37 offen lds
s_add_u32 s37, s39, 2162688
s_add_u32 m0, s38, 10240
s_nop 0
buffer_load_dwordx4 v6, s[20:23], s37 offen lds
s_add_u32 s37, s39, 2195456
s_add_u32 m0, s38, 11264
s_nop 0
buffer_load_dwordx4 v6, s[20:23], s37 offen lds
ds_read_b64_tr_b16 a[112:113], v20 offset:12288
ds_read_b64_tr_b16 a[114:115], v20 offset:13312
ds_read_b64_tr_b16 a[116:117], v22 offset:12288
ds_read_b64_tr_b16 a[118:119], v22 offset:13312
ds_read_b64_tr_b16 a[184:185], v21 offset:12288
ds_read_b64_tr_b16 a[186:187], v21 offset:13312
ds_read_b64_tr_b16 a[188:189], v23 offset:12288
ds_read_b64_tr_b16 a[190:191], v23 offset:13312
s_waitcnt lgkmcnt(0)
s_waitcnt vmcnt(12)
s_barrier
s_add_u32 s37, s39, 2621440
s_add_u32 m0, s38, 12288
s_nop 0
buffer_load_dwordx4 v5, s[20:23], s37 offen lds
s_add_u32 s37, s39, 2654208
s_add_u32 m0, s38, 13312
s_nop 0
buffer_load_dwordx4 v5, s[20:23], s37 offen lds
s_add_u32 s37, s39, 2686976
s_add_u32 m0, s38, 14336
s_nop 0
buffer_load_dwordx4 v6, s[20:23], s37 offen lds
s_add_u32 s37, s39, 2719744
s_add_u32 m0, s38, 15360
s_nop 0
buffer_load_dwordx4 v6, s[20:23], s37 offen lds
ds_read_b64_tr_b16 a[120:121], v20 offset:16384
ds_read_b64_tr_b16 a[122:123], v20 offset:17408
ds_read_b64_tr_b16 a[124:125], v22 offset:16384
ds_read_b64_tr_b16 a[126:127], v22 offset:17408
ds_read_b64_tr_b16 a[192:193], v21 offset:16384
ds_read_b64_tr_b16 a[194:195], v21 offset:17408
ds_read_b64_tr_b16 a[196:197], v23 offset:16384
ds_read_b64_tr_b16 a[198:199], v23 offset:17408
s_waitcnt lgkmcnt(0)
s_waitcnt vmcnt(12)
s_barrier
s_add_u32 s37, s39, 3145728
s_add_u32 m0, s38, 16384
s_nop 0
buffer_load_dwordx4 v5, s[20:23], s37 offen lds
s_add_u32 s37, s39, 3178496
s_add_u32 m0, s38, 17408
s_nop 0
buffer_load_dwordx4 v5, s[20:23], s37 offen lds
s_add_u32 s37, s39, 3211264
s_add_u32 m0, s38, 18432
s_nop 0
buffer_load_dwordx4 v6, s[20:23], s37 offen lds
s_add_u32 s37, s39, 3244032
s_add_u32 m0, s38, 19456
s_nop 0
buffer_load_dwordx4 v6, s[20:23], s37 offen lds
ds_read_b64_tr_b16 a[128:129], v20 offset:0
ds_read_b64_tr_b16 a[130:131], v20 offset:1024
ds_read_b64_tr_b16 a[132:133], v22 offset:0
ds_read_b64_tr_b16 a[134:135], v22 offset:1024
ds_read_b64_tr_b16 a[200:201], v21 offset:0
ds_read_b64_tr_b16 a[202:203], v21 offset:1024
ds_read_b64_tr_b16 a[204:205], v23 offset:0
ds_read_b64_tr_b16 a[206:207], v23 offset:1024
s_waitcnt lgkmcnt(0)
s_waitcnt vmcnt(12)
s_barrier
s_add_u32 s37, s39, 3670016
s_add_u32 m0, s38, 0
s_nop 0
buffer_load_dwordx4 v5, s[20:23], s37 offen lds
s_add_u32 s37, s39, 3702784
s_add_u32 m0, s38, 1024
s_nop 0
buffer_load_dwordx4 v5, s[20:23], s37 offen lds
s_add_u32 s37, s39, 3735552
s_add_u32 m0, s38, 2048
s_nop 0
buffer_load_dwordx4 v6, s[20:23], s37 offen lds
s_add_u32 s37, s39, 3768320
s_add_u32 m0, s38, 3072
s_nop 0
buffer_load_dwordx4 v6, s[20:23], s37 offen lds
ds_read_b64_tr_b16 a[136:137], v20 offset:4096
ds_read_b64_tr_b16 a[138:139], v20 offset:5120
ds_read_b64_tr_b16 a[140:141], v22 offset:4096
ds_read_b64_tr_b16 a[142:143], v22 offset:5120
ds_read_b64_tr_b16 a[208:209], v21 offset:4096
ds_read_b64_tr_b16 a[210:211], v21 offset:5120
ds_read_b64_tr_b16 a[212:213], v23 offset:4096
ds_read_b64_tr_b16 a[214:215], v23 offset:5120
s_waitcnt lgkmcnt(0)
s_waitcnt vmcnt(12)
s_barrier
s_add_u32 s37, s39, 4194304
s_add_u32 m0, s38, 4096
s_nop 0
buffer_load_dwordx4 v5, s[20:23], s37 offen lds
s_add_u32 s37, s39, 4227072
s_add_u32 m0, s38, 5120
s_nop 0
buffer_load_dwordx4 v5, s[20:23], s37 offen lds
s_add_u32 s37, s39, 4259840
s_add_u32 m0, s38, 6144
s_nop 0
buffer_load_dwordx4 v6, s[20:23], s37 offen lds
s_add_u32 s37, s39, 4292608
s_add_u32 m0, s38, 7168
s_nop 0
buffer_load_dwordx4 v6, s[20:23], s37 offen lds
ds_read_b64_tr_b16 a[144:145], v20 offset:8192
ds_read_b64_tr_b16 a[146:147], v20 offset:9216
ds_read_b64_tr_b16 a[148:149], v22 offset:8192
ds_read_b64_tr_b16 a[150:151], v22 offset:9216
ds_read_b64_tr_b16 a[216:217], v21 offset:8192
ds_read_b64_tr_b16 a[218:219], v21 offset:9216
ds_read_b64_tr_b16 a[220:221], v23 offset:8192
ds_read_b64_tr_b16 a[222:223], v23 offset:9216
s_waitcnt lgkmcnt(0)
s_waitcnt vmcnt(12)
s_barrier
ds_read_b64_tr_b16 a[152:153], v20 offset:12288
ds_read_b64_tr_b16 a[154:155], v20 offset:13312
ds_read_b64_tr_b16 a[156:157], v22 offset:12288
ds_read_b64_tr_b16 a[158:159], v22 offset:13312
ds_read_b64_tr_b16 a[224:225], v21 offset:12288
ds_read_b64_tr_b16 a[226:227], v21 offset:13312
ds_read_b64_tr_b16 a[228:229], v23 offset:12288
ds_read_b64_tr_b16 a[230:231], v23 offset:13312
s_waitcnt lgkmcnt(0)
s_waitcnt vmcnt(8)
s_barrier
ds_read_b64_tr_b16 a[160:161], v20 offset:16384
ds_read_b64_tr_b16 a[162:163], v20 offset:17408
ds_read_b64_tr_b16 a[164:165], v22 offset:16384
ds_read_b64_tr_b16 a[166:167], v22 offset:17408
ds_read_b64_tr_b16 a[232:233], v21 offset:16384
ds_read_b64_tr_b16 a[234:235], v21 offset:17408
ds_read_b64_tr_b16 a[236:237], v23 offset:16384
ds_read_b64_tr_b16 a[238:239], v23 offset:17408
s_waitcnt lgkmcnt(0)
s_waitcnt vmcnt(4)
s_barrier
ds_read_b64_tr_b16 a[168:169], v20 offset:0
ds_read_b64_tr_b16 a[170:171], v20 offset:1024
ds_read_b64_tr_b16 a[172:173], v22 offset:0
ds_read_b64_tr_b16 a[174:175], v22 offset:1024
ds_read_b64_tr_b16 a[240:241], v21 offset:0
ds_read_b64_tr_b16 a[242:243], v21 offset:1024
ds_read_b64_tr_b16 a[244:245], v23 offset:0
ds_read_b64_tr_b16 a[246:247], v23 offset:1024
s_waitcnt lgkmcnt(0)
s_waitcnt vmcnt(0)
s_barrier
ds_read_b64_tr_b16 a[176:177], v20 offset:4096
ds_read_b64_tr_b16 a[178:179], v20 offset:5120
ds_read_b64_tr_b16 a[180:181], v22 offset:4096
ds_read_b64_tr_b16 a[182:183], v22 offset:5120
ds_read_b64_tr_b16 a[248:249], v21 offset:4096
ds_read_b64_tr_b16 a[250:251], v21 offset:5120
ds_read_b64_tr_b16 a[252:253], v23 offset:4096
ds_read_b64_tr_b16 a[254:255], v23 offset:5120
s_waitcnt lgkmcnt(0)
s_lshl_b32 s42, s33, 5
s_add_u32 s42, s42, s32
s_lshl_b32 s39, s42, 13
s_lshl_b32 s37, s34, 11
s_add_u32 s39, s39, s37
s_add_u32 s39, s39, 50331648
s_lshl_b32 s40, s42, 14
s_add_u32 s40, s40, 16777216
s_lshl_b32 s37, s34, 12
s_add_u32 s41, s40, s37
s_lshr_b32 s37, s34, 1
s_lshl_b32 s37, s37, 10
s_add_u32 s40, s40, s37
s_and_b32 s37, s34, 1
s_lshl_b32 s37, s37, 6
s_add_u32 s40, s40, s37
s_mov_b32 s35, 0
s_mov_b32 s48, 36864
s_lshl_b32 s49, s32, 5
s_lshl_b32 s37, s33, 2
s_add_u32 s49, s49, s37
s_add_u32 s49, s49, s34
s_lshl_b32 s49, s49, 2
s_add_u32 s49, s49, 327680
s_waitcnt vmcnt(0)
.p2align 6
L_q_loop:
s_waitcnt vmcnt(7)
s_barrier
s_add_u32 s43, s43, 147456
s_add_u32 s44, s44, s48
ds_read_b128 v[64:67], v3 offset:0
ds_read_b128 v[68:71], v3 offset:1024
ds_read_b128 v[72:75], v3 offset:2048
ds_read_b128 v[76:79], v3 offset:3072
s_waitcnt lgkmcnt(2)
v_mfma_f32_16x16x32_bf16 v[16:19], v[80:83], v[64:67], 0
v_mfma_f32_16x16x32_bf16 v[20:23], v[80:83], v[68:71], 0
v_mfma_f32_16x16x32_bf16 v[24:27], v[152:155], v[64:67], 0
v_mfma_f32_16x16x32_bf16 v[28:31], v[152:155], v[68:71], 0
s_add_u32 s37, s43, 0
s_add_u32 m0, s44, 0
s_nop 0
buffer_load_dwordx4 v2, s[8:11], s37 offen lds
v_mfma_f32_16x16x32_bf16 v[32:35], v[224:227], v[64:67], 0
v_mfma_f32_16x16x32_bf16 v[36:39], v[224:227], v[68:71], 0
v_mfma_f32_16x16x32_bf16 v[40:43], a[40:43], v[64:67], 0
v_mfma_f32_16x16x32_bf16 v[44:47], a[40:43], v[68:71], 0
v_mfma_f32_16x16x32_bf16 v[48:51], v[64:67], a[112:115], 0
v_mfma_f32_16x16x32_bf16 v[52:55], v[68:71], a[112:115], 0
v_mfma_f32_16x16x32_bf16 v[56:59], v[64:67], a[184:187], 0
v_mfma_f32_16x16x32_bf16 v[60:63], v[68:71], a[184:187], 0
ds_read_b128 v[64:67], v3 offset:4096
ds_read_b128 v[68:71], v3 offset:5120
s_waitcnt lgkmcnt(2)
v_mfma_f32_16x16x32_bf16 v[16:19], v[84:87], v[72:75], v[16:19]
v_mfma_f32_16x16x32_bf16 v[20:23], v[84:87], v[76:79], v[20:23]
v_mfma_f32_16x16x32_bf16 v[24:27], v[156:159], v[72:75], v[24:27]
v_mfma_f32_16x16x32_bf16 v[28:31], v[156:159], v[76:79], v[28:31]
s_add_u32 s37, s43, 128
s_add_u32 m0, s44, 4096
s_nop 0
buffer_load_dwordx4 v2, s[8:11], s37 offen lds
v_mfma_f32_16x16x32_bf16 v[32:35], v[228:231], v[72:75], v[32:35]
v_mfma_f32_16x16x32_bf16 v[36:39], v[228:231], v[76:79], v[36:39]
v_mfma_f32_16x16x32_bf16 v[40:43], a[44:47], v[72:75], v[40:43]
v_mfma_f32_16x16x32_bf16 v[44:47], a[44:47], v[76:79], v[44:47]
v_mfma_f32_16x16x32_bf16 v[48:51], v[72:75], a[116:119], v[48:51]
v_mfma_f32_16x16x32_bf16 v[52:55], v[76:79], a[116:119], v[52:55]
v_mfma_f32_16x16x32_bf16 v[56:59], v[72:75], a[188:191], v[56:59]
v_mfma_f32_16x16x32_bf16 v[60:63], v[76:79], a[188:191], v[60:63]
ds_read_b128 v[72:75], v3 offset:6144
ds_read_b128 v[76:79], v3 offset:7168
s_waitcnt lgkmcnt(2)
v_mfma_f32_16x16x32_bf16 v[16:19], v[88:91], v[64:67], v[16:19]
v_mfma_f32_16x16x32_bf16 v[20:23], v[88:91], v[68:71], v[20:23]
v_mfma_f32_16x16x32_bf16 v[24:27], v[160:163], v[64:67], v[24:27]
v_mfma_f32_16x16x32_bf16 v[28:31], v[160:163], v[68:71], v[28:31]
s_add_u32 s37, s43, 256
s_add_u32 m0, s44, 8192
s_nop 0
buffer_load_dwordx4 v2, s[8:11], s37 offen lds
v_mfma_f32_16x16x32_bf16 v[32:35], v[232:235], v[64:67], v[32:35]
v_mfma_f32_16x16x32_bf16 v[36:39], v[232:235], v[68:71], v[36:39]
v_mfma_f32_16x16x32_bf16 v[40:43], a[48:51], v[64:67], v[40:43]
v_mfma_f32_16x16x32_bf16 v[44:47], a[48:51], v[68:71], v[44:47]
v_mfma_f32_16x16x32_bf16 v[48:51], v[64:67], a[120:123], v[48:51]
v_mfma_f32_16x16x32_bf16 v[52:55], v[68:71], a[120:123], v[52:55]
v_mfma_f32_16x16x32_bf16 v[56:59], v[64:67], a[192:195], v[56:59]
v_mfma_f32_16x16x32_bf16 v[60:63], v[68:71], a[192:195], v[60:63]
ds_read_b128 v[64:67], v3 offset:8192
ds_read_b128 v[68:71], v3 offset:9216
s_waitcnt lgkmcnt(2)
v_mfma_f32_16x16x32_bf16 v[16:19], v[92:95], v[72:75], v[16:19]
v_mfma_f32_16x16x32_bf16 v[20:23], v[92:95], v[76:79], v[20:23]
v_mfma_f32_16x16x32_bf16 v[24:27], v[164:167], v[72:75], v[24:27]
v_mfma_f32_16x16x32_bf16 v[28:31], v[164:167], v[76:79], v[28:31]
s_add_u32 s37, s43, 384
s_add_u32 m0, s44, 12288
s_nop 0
buffer_load_dwordx4 v2, s[8:11], s37 offen lds
v_mfma_f32_16x16x32_bf16 v[32:35], v[236:239], v[72:75], v[32:35]
v_mfma_f32_16x16x32_bf16 v[36:39], v[236:239], v[76:79], v[36:39]
v_mfma_f32_16x16x32_bf16 v[40:43], a[52:55], v[72:75], v[40:43]
v_mfma_f32_16x16x32_bf16 v[44:47], a[52:55], v[76:79], v[44:47]
v_mfma_f32_16x16x32_bf16 v[48:51], v[72:75], a[124:127], v[48:51]
v_mfma_f32_16x16x32_bf16 v[52:55], v[76:79], a[124:127], v[52:55]
v_mfma_f32_16x16x32_bf16 v[56:59], v[72:75], a[196:199], v[56:59]
v_mfma_f32_16x16x32_bf16 v[60:63], v[76:79], a[196:199], v[60:63]
ds_read_b128 v[72:75], v3 offset:10240
ds_read_b128 v[76:79], v3 offset:11264
s_waitcnt lgkmcnt(2)
v_mfma_f32_16x16x32_bf16 v[16:19], v[96:99], v[64:67], v[16:19]
v_mfma_f32_16x16x32_bf16 v[20:23], v[96:99], v[68:71], v[20:23]
v_mfma_f32_16x16x32_bf16 v[24:27], v[168:171], v[64:67], v[24:27]
v_mfma_f32_16x16x32_bf16 v[28:31], v[168:171], v[68:71], v[28:31]
s_add_u32 s37, s43, 512
s_add_u32 m0, s44, 16384
s_nop 0
buffer_load_dwordx4 v2, s[8:11], s37 offen lds
v_mfma_f32_16x16x32_bf16 v[32:35], v[240:243], v[64:67], v[32:35]
v_mfma_f32_16x16x32_bf16 v[36:39], v[240:243], v[68:71], v[36:39]
v_mfma_f32_16x16x32_bf16 v[40:43], a[56:59], v[64:67], v[40:43]
v_mfma_f32_16x16x32_bf16 v[44:47], a[56:59], v[68:71], v[44:47]
v_mfma_f32_16x16x32_bf16 v[48:51], v[64:67], a[128:131], v[48:51]
v_mfma_f32_16x16x32_bf16 v[52:55], v[68:71], a[128:131], v[52:55]
v_mfma_f32_16x16x32_bf16 v[56:59], v[64:67], a[200:203], v[56:59]
v_mfma_f32_16x16x32_bf16 v[60:63], v[68:71], a[200:203], v[60:63]
ds_read_b128 v[64:67], v3 offset:12288
ds_read_b128 v[68:71], v3 offset:13312
s_waitcnt lgkmcnt(2)
v_mfma_f32_16x16x32_bf16 v[16:19], v[100:103], v[72:75], v[16:19]
v_mfma_f32_16x16x32_bf16 v[20:23], v[100:103], v[76:79], v[20:23]
v_mfma_f32_16x16x32_bf16 v[24:27], v[172:175], v[72:75], v[24:27]
v_mfma_f32_16x16x32_bf16 v[28:31], v[172:175], v[76:79], v[28:31]
s_add_u32 s37, s43, 640
s_add_u32 m0, s44, 20480
s_nop 0
buffer_load_dwordx4 v2, s[8:11], s37 offen lds
v_mfma_f32_16x16x32_bf16 v[32:35], v[244:247], v[72:75], v[32:35]
v_mfma_f32_16x16x32_bf16 v[36:39], v[244:247], v[76:79], v[36:39]
v_mfma_f32_16x16x32_bf16 v[40:43], a[60:63], v[72:75], v[40:43]
v_mfma_f32_16x16x32_bf16 v[44:47], a[60:63], v[76:79], v[44:47]
v_mfma_f32_16x16x32_bf16 v[48:51], v[72:75], a[132:135], v[48:51]
v_mfma_f32_16x16x32_bf16 v[52:55], v[76:79], a[132:135], v[52:55]
v_mfma_f32_16x16x32_bf16 v[56:59], v[72:75], a[204:207], v[56:59]
v_mfma_f32_16x16x32_bf16 v[60:63], v[76:79], a[204:207], v[60:63]
ds_read_b128 v[72:75], v3 offset:14336
ds_read_b128 v[76:79], v3 offset:15360
s_waitcnt lgkmcnt(2)
v_mfma_f32_16x16x32_bf16 v[16:19], v[104:107], v[64:67], v[16:19]
v_mfma_f32_16x16x32_bf16 v[20:23], v[104:107], v[68:71], v[20:23]
v_mfma_f32_16x16x32_bf16 v[24:27], v[176:179], v[64:67], v[24:27]
v_mfma_f32_16x16x32_bf16 v[28:31], v[176:179], v[68:71], v[28:31]
s_add_u32 s37, s43, 768
s_add_u32 m0, s44, 24576
s_nop 0
buffer_load_dwordx4 v2, s[8:11], s37 offen lds
v_mfma_f32_16x16x32_bf16 v[32:35], v[248:251], v[64:67], v[32:35]
v_mfma_f32_16x16x32_bf16 v[36:39], v[248:251], v[68:71], v[36:39]
v_mfma_f32_16x16x32_bf16 v[40:43], a[64:67], v[64:67], v[40:43]
v_mfma_f32_16x16x32_bf16 v[44:47], a[64:67], v[68:71], v[44:47]
v_mfma_f32_16x16x32_bf16 v[48:51], v[64:67], a[136:139], v[48:51]
v_mfma_f32_16x16x32_bf16 v[52:55], v[68:71], a[136:139], v[52:55]
v_mfma_f32_16x16x32_bf16 v[56:59], v[64:67], a[208:211], v[56:59]
v_mfma_f32_16x16x32_bf16 v[60:63], v[68:71], a[208:211], v[60:63]
ds_read_b128 v[64:67], v3 offset:16384
ds_read_b128 v[68:71], v3 offset:17408
s_waitcnt lgkmcnt(2)
v_mfma_f32_16x16x32_bf16 v[16:19], v[108:111], v[72:75], v[16:19]
v_mfma_f32_16x16x32_bf16 v[20:23], v[108:111], v[76:79], v[20:23]
v_mfma_f32_16x16x32_bf16 v[24:27], v[180:183], v[72:75], v[24:27]
v_mfma_f32_16x16x32_bf16 v[28:31], v[180:183], v[76:79], v[28:31]
s_add_u32 s37, s43, 896
s_add_u32 m0, s44, 28672
s_nop 0
buffer_load_dwordx4 v2, s[8:11], s37 offen lds
v_mfma_f32_16x16x32_bf16 v[32:35], v[252:255], v[72:75], v[32:35]
v_mfma_f32_16x16x32_bf16 v[36:39], v[252:255], v[76:79], v[36:39]
v_mfma_f32_16x16x32_bf16 v[40:43], a[68:71], v[72:75], v[40:43]
v_mfma_f32_16x16x32_bf16 v[44:47], a[68:71], v[76:79], v[44:47]
v_mfma_f32_16x16x32_bf16 v[48:51], v[72:75], a[140:143], v[48:51]
v_mfma_f32_16x16x32_bf16 v[52:55], v[76:79], a[140:143], v[52:55]
v_mfma_f32_16x16x32_bf16 v[56:59], v[72:75], a[212:215], v[56:59]
v_mfma_f32_16x16x32_bf16 v[60:63], v[76:79], a[212:215], v[60:63]
ds_read_b128 v[72:75], v3 offset:18432
ds_read_b128 v[76:79], v3 offset:19456
s_waitcnt lgkmcnt(2)
v_mfma_f32_16x16x32_bf16 v[16:19], v[112:115], v[64:67], v[16:19]
v_mfma_f32_16x16x32_bf16 v[20:23], v[112:115], v[68:71], v[20:23]
v_mfma_f32_16x16x32_bf16 v[24:27], v[184:187], v[64:67], v[24:27]
v_mfma_f32_16x16x32_bf16 v[28:31], v[184:187], v[68:71], v[28:31]
s_add_u32 s37, s43, 1024
s_add_u32 m0, s44, 32768
s_nop 0
buffer_load_dwordx4 v2, s[8:11], s37 offen lds
v_mfma_f32_16x16x32_bf16 v[32:35], a[0:3], v[64:67], v[32:35]
v_mfma_f32_16x16x32_bf16 v[36:39], a[0:3], v[68:71], v[36:39]
v_mfma_f32_16x16x32_bf16 v[40:43], a[72:75], v[64:67], v[40:43]
v_mfma_f32_16x16x32_bf16 v[44:47], a[72:75], v[68:71], v[44:47]
v_mfma_f32_16x16x32_bf16 v[48:51], v[64:67], a[144:147], v[48:51]
v_mfma_f32_16x16x32_bf16 v[52:55], v[68:71], a[144:147], v[52:55]
v_mfma_f32_16x16x32_bf16 v[56:59], v[64:67], a[216:219], v[56:59]
v_mfma_f32_16x16x32_bf16 v[60:63], v[68:71], a[216:219], v[60:63]
ds_read_b128 v[64:67], v3 offset:20480
ds_read_b128 v[68:71], v3 offset:21504
s_waitcnt lgkmcnt(2)
v_mfma_f32_16x16x32_bf16 v[16:19], v[116:119], v[72:75], v[16:19]
v_mfma_f32_16x16x32_bf16 v[20:23], v[116:119], v[76:79], v[20:23]
v_mfma_f32_16x16x32_bf16 v[24:27], v[188:191], v[72:75], v[24:27]
v_mfma_f32_16x16x32_bf16 v[28:31], v[188:191], v[76:79], v[28:31]
v_mfma_f32_16x16x32_bf16 v[32:35], a[4:7], v[72:75], v[32:35]
v_mfma_f32_16x16x32_bf16 v[36:39], a[4:7], v[76:79], v[36:39]
v_mfma_f32_16x16x32_bf16 v[40:43], a[76:79], v[72:75], v[40:43]
v_mfma_f32_16x16x32_bf16 v[44:47], a[76:79], v[76:79], v[44:47]
v_mfma_f32_16x16x32_bf16 v[48:51], v[72:75], a[148:151], v[48:51]
v_mfma_f32_16x16x32_bf16 v[52:55], v[76:79], a[148:151], v[52:55]
v_mfma_f32_16x16x32_bf16 v[56:59], v[72:75], a[220:223], v[56:59]
v_mfma_f32_16x16x32_bf16 v[60:63], v[76:79], a[220:223], v[60:63]
ds_read_b128 v[72:75], v3 offset:22528
ds_read_b128 v[76:79], v3 offset:23552
s_waitcnt lgkmcnt(2)
v_mfma_f32_16x16x32_bf16 v[16:19], v[120:123], v[64:67], v[16:19]
v_mfma_f32_16x16x32_bf16 v[20:23], v[120:123], v[68:71], v[20:23]
v_mfma_f32_16x16x32_bf16 v[24:27], v[192:195], v[64:67], v[24:27]
v_mfma_f32_16x16x32_bf16 v[28:31], v[192:195], v[68:71], v[28:31]
s_waitcnt vmcnt(9)
v_mov_b32 v12, s35
s_mov_b64 exec, 1
buffer_store_dword v12, v8, s[4:7], s49 offen sc0 sc1
s_mov_b64 exec, -1
v_mfma_f32_16x16x32_bf16 v[32:35], a[8:11], v[64:67], v[32:35]
v_mfma_f32_16x16x32_bf16 v[36:39], a[8:11], v[68:71], v[36:39]
v_mfma_f32_16x16x32_bf16 v[40:43], a[80:83], v[64:67], v[40:43]
v_mfma_f32_16x16x32_bf16 v[44:47], a[80:83], v[68:71], v[44:47]
v_mfma_f32_16x16x32_bf16 v[48:51], v[64:67], a[152:155], v[48:51]
v_mfma_f32_16x16x32_bf16 v[52:55], v[68:71], a[152:155], v[52:55]
v_mfma_f32_16x16x32_bf16 v[56:59], v[64:67], a[224:227], v[56:59]
v_mfma_f32_16x16x32_bf16 v[60:63], v[68:71], a[224:227], v[60:63]
ds_read_b128 v[64:67], v3 offset:24576
ds_read_b128 v[68:71], v3 offset:25600
s_waitcnt lgkmcnt(2)
v_mfma_f32_16x16x32_bf16 v[16:19], v[124:127], v[72:75], v[16:19]
v_mfma_f32_16x16x32_bf16 v[20:23], v[124:127], v[76:79], v[20:23]
v_mfma_f32_16x16x32_bf16 v[24:27], v[196:199], v[72:75], v[24:27]
v_mfma_f32_16x16x32_bf16 v[28:31], v[196:199], v[76:79], v[28:31]
v_mfma_f32_16x16x32_bf16 v[32:35], a[12:15], v[72:75], v[32:35]
v_mfma_f32_16x16x32_bf16 v[36:39], a[12:15], v[76:79], v[36:39]
v_mfma_f32_16x16x32_bf16 v[40:43], a[84:87], v[72:75], v[40:43]
v_mfma_f32_16x16x32_bf16 v[44:47], a[84:87], v[76:79], v[44:47]
v_mfma_f32_16x16x32_bf16 v[48:51], v[72:75], a[156:159], v[48:51]
v_mfma_f32_16x16x32_bf16 v[52:55], v[76:79], a[156:159], v[52:55]
v_mfma_f32_16x16x32_bf16 v[56:59], v[72:75], a[228:231], v[56:59]
v_mfma_f32_16x16x32_bf16 v[60:63], v[76:79], a[228:231], v[60:63]
ds_read_b128 v[72:75], v3 offset:26624
ds_read_b128 v[76:79], v3 offset:27648
s_waitcnt lgkmcnt(2)
v_mfma_f32_16x16x32_bf16 v[16:19], v[128:131], v[64:67], v[16:19]
v_mfma_f32_16x16x32_bf16 v[20:23], v[128:131], v[68:71], v[20:23]
v_mfma_f32_16x16x32_bf16 v[24:27], v[200:203], v[64:67], v[24:27]
v_mfma_f32_16x16x32_bf16 v[28:31], v[200:203], v[68:71], v[28:31]
v_mfma_f32_16x16x32_bf16 v[32:35], a[16:19], v[64:67], v[32:35]
v_mfma_f32_16x16x32_bf16 v[36:39], a[16:19], v[68:71], v[36:39]
v_mfma_f32_16x16x32_bf16 v[40:43], a[88:91], v[64:67], v[40:43]
v_mfma_f32_16x16x32_bf16 v[44:47], a[88:91], v[68:71], v[44:47]
v_mfma_f32_16x16x32_bf16 v[48:51], v[64:67], a[160:163], v[48:51]
v_mfma_f32_16x16x32_bf16 v[52:55], v[68:71], a[160:163], v[52:55]
v_mfma_f32_16x16x32_bf16 v[56:59], v[64:67], a[232:235], v[56:59]
v_mfma_f32_16x16x32_bf16 v[60:63], v[68:71], a[232:235], v[60:63]
ds_read_b128 v[64:67], v3 offset:28672
ds_read_b128 v[68:71], v3 offset:29696
s_waitcnt lgkmcnt(2)
v_mfma_f32_16x16x32_bf16 v[16:19], v[132:135], v[72:75], v[16:19]
v_mfma_f32_16x16x32_bf16 v[20:23], v[132:135], v[76:79], v[20:23]
v_mfma_f32_16x16x32_bf16 v[24:27], v[204:207], v[72:75], v[24:27]
v_mfma_f32_16x16x32_bf16 v[28:31], v[204:207], v[76:79], v[28:31]
v_mfma_f32_16x16x32_bf16 v[32:35], a[20:23], v[72:75], v[32:35]
v_mfma_f32_16x16x32_bf16 v[36:39], a[20:23], v[76:79], v[36:39]
v_mfma_f32_16x16x32_bf16 v[40:43], a[92:95], v[72:75], v[40:43]
v_mfma_f32_16x16x32_bf16 v[44:47], a[92:95], v[76:79], v[44:47]
v_mfma_f32_16x16x32_bf16 v[48:51], v[72:75], a[164:167], v[48:51]
v_mfma_f32_16x16x32_bf16 v[52:55], v[76:79], a[164:167], v[52:55]
v_mfma_f32_16x16x32_bf16 v[56:59], v[72:75], a[236:239], v[56:59]
v_mfma_f32_16x16x32_bf16 v[60:63], v[76:79], a[236:239], v[60:63]
ds_read_b128 v[72:75], v3 offset:30720
ds_read_b128 v[76:79], v3 offset:31744
s_waitcnt lgkmcnt(2)
v_mfma_f32_16x16x32_bf16 v[16:19], v[136:139], v[64:67], v[16:19]
v_mfma_f32_16x16x32_bf16 v[20:23], v[136:139], v[68:71], v[20:23]
v_mfma_f32_16x16x32_bf16 v[24:27], v[208:211], v[64:67], v[24:27]
v_mfma_f32_16x16x32_bf16 v[28:31], v[208:211], v[68:71], v[28:31]
v_mfma_f32_16x16x32_bf16 v[32:35], a[24:27], v[64:67], v[32:35]
v_mfma_f32_16x16x32_bf16 v[36:39], a[24:27], v[68:71], v[36:39]
v_mfma_f32_16x16x32_bf16 v[40:43], a[96:99], v[64:67], v[40:43]
v_mfma_f32_16x16x32_bf16 v[44:47], a[96:99], v[68:71], v[44:47]
v_mfma_f32_16x16x32_bf16 v[48:51], v[64:67], a[168:171], v[48:51]
v_mfma_f32_16x16x32_bf16 v[52:55], v[68:71], a[168:171], v[52:55]
v_mfma_f32_16x16x32_bf16 v[56:59], v[64:67], a[240:243], v[56:59]
v_mfma_f32_16x16x32_bf16 v[60:63], v[68:71], a[240:243], v[60:63]
ds_read_b128 v[64:67], v3 offset:32768
ds_read_b128 v[68:71], v3 offset:33792
s_waitcnt lgkmcnt(2)
v_mfma_f32_16x16x32_bf16 v[16:19], v[140:143], v[72:75], v[16:19]
v_mfma_f32_16x16x32_bf16 v[20:23], v[140:143], v[76:79], v[20:23]
v_mfma_f32_16x16x32_bf16 v[24:27], v[212:215], v[72:75], v[24:27]
v_mfma_f32_16x16x32_bf16 v[28:31], v[212:215], v[76:79], v[28:31]
v_mfma_f32_16x16x32_bf16 v[32:35], a[28:31], v[72:75], v[32:35]
v_mfma_f32_16x16x32_bf16 v[36:39], a[28:31], v[76:79], v[36:39]
v_mfma_f32_16x16x32_bf16 v[40:43], a[100:103], v[72:75], v[40:43]
v_mfma_f32_16x16x32_bf16 v[44:47], a[100:103], v[76:79], v[44:47]
v_mfma_f32_16x16x32_bf16 v[48:51], v[72:75], a[172:175], v[48:51]
v_mfma_f32_16x16x32_bf16 v[52:55], v[76:79], a[172:175], v[52:55]
v_mfma_f32_16x16x32_bf16 v[56:59], v[72:75], a[244:247], v[56:59]
v_mfma_f32_16x16x32_bf16 v[60:63], v[76:79], a[244:247], v[60:63]
ds_read_b128 v[72:75], v3 offset:34816
ds_read_b128 v[76:79], v3 offset:35840
s_waitcnt lgkmcnt(2)
v_mfma_f32_16x16x32_bf16 v[16:19], v[144:147], v[64:67], v[16:19]
v_mfma_f32_16x16x32_bf16 v[20:23], v[144:147], v[68:71], v[20:23]
v_mfma_f32_16x16x32_bf16 v[24:27], v[216:219], v[64:67], v[24:27]
v_mfma_f32_16x16x32_bf16 v[28:31], v[216:219], v[68:71], v[28:31]
v_mfma_f32_16x16x32_bf16 v[32:35], a[32:35], v[64:67], v[32:35]
v_mfma_f32_16x16x32_bf16 v[36:39], a[32:35], v[68:71], v[36:39]
v_mfma_f32_16x16x32_bf16 v[40:43], a[104:107], v[64:67], v[40:43]
v_mfma_f32_16x16x32_bf16 v[44:47], a[104:107], v[68:71], v[44:47]
v_mfma_f32_16x16x32_bf16 v[48:51], v[64:67], a[176:179], v[48:51]
v_mfma_f32_16x16x32_bf16 v[52:55], v[68:71], a[176:179], v[52:55]
v_mfma_f32_16x16x32_bf16 v[56:59], v[64:67], a[248:251], v[56:59]
v_mfma_f32_16x16x32_bf16 v[60:63], v[68:71], a[248:251], v[60:63]
s_waitcnt lgkmcnt(0)
v_mfma_f32_16x16x32_bf16 v[16:19], v[148:151], v[72:75], v[16:19]
v_mfma_f32_16x16x32_bf16 v[20:23], v[148:151], v[76:79], v[20:23]
v_mfma_f32_16x16x32_bf16 v[24:27], v[220:223], v[72:75], v[24:27]
v_mfma_f32_16x16x32_bf16 v[28:31], v[220:223], v[76:79], v[28:31]
v_mfma_f32_16x16x32_bf16 v[32:35], a[36:39], v[72:75], v[32:35]
v_mfma_f32_16x16x32_bf16 v[36:39], a[36:39], v[76:79], v[36:39]
v_mfma_f32_16x16x32_bf16 v[40:43], a[108:111], v[72:75], v[40:43]
v_mfma_f32_16x16x32_bf16 v[44:47], a[108:111], v[76:79], v[44:47]
v_mfma_f32_16x16x32_bf16 v[48:51], v[72:75], a[180:183], v[48:51]
v_mfma_f32_16x16x32_bf16 v[52:55], v[76:79], a[180:183], v[52:55]
v_mfma_f32_16x16x32_bf16 v[56:59], v[72:75], a[252:255], v[56:59]
v_mfma_f32_16x16x32_bf16 v[60:63], v[76:79], a[252:255], v[60:63]
v_add_u32 v3, s48, v3
s_sub_u32 s48, 0, s48
v_cvt_pk_bf16_f32 v64, v16, v17
v_cvt_pk_bf16_f32 v65, v18, v19
v_cvt_pk_bf16_f32 v66, v24, v25
v_cvt_pk_bf16_f32 v67, v26, v27
buffer_store_dwordx4 v[64:67], v1, s[4:7], s39 offen offset:0
v_cvt_pk_bf16_f32 v68, v20, v21
v_cvt_pk_bf16_f32 v69, v22, v23
v_cvt_pk_bf16_f32 v70, v28, v29
v_cvt_pk_bf16_f32 v71, v30, v31
buffer_store_dwordx4 v[68:71], v1, s[4:7], s39 offen offset:1024
v_pk_mul_f32 v[32:33], v[32:33], s[46:47]
v_pk_mul_f32 v[34:35], v[34:35], s[46:47]
v_pk_mul_f32 v[36:37], v[36:37], s[46:47]
v_pk_mul_f32 v[38:39], v[38:39], s[46:47]
v_pk_mul_f32 v[40:41], v[40:41], s[46:47]
v_pk_mul_f32 v[42:43], v[42:43], s[46:47]
v_pk_mul_f32 v[44:45], v[44:45], s[46:47]
v_pk_mul_f32 v[46:47], v[46:47], s[46:47]
v_cvt_pk_bf16_f32 v72, v32, v33
v_cvt_pk_bf16_f32 v73, v34, v35
v_cvt_pk_bf16_f32 v74, v40, v41
v_cvt_pk_bf16_f32 v75, v42, v43
buffer_store_dwordx4 v[72:75], v4, s[4:7], s40 offen offset:0 sc0 sc1
v_cvt_pk_bf16_f32 v76, v36, v37
v_cvt_pk_bf16_f32 v77, v38, v39
v_cvt_pk_bf16_f32 v78, v44, v45
v_cvt_pk_bf16_f32 v79, v46, v47
buffer_store_dwordx4 v[76:79], v4, s[4:7], s40 offen offset:128 sc0 sc1
v_cvt_pk_bf16_f32 v16, v48, v49
v_cvt_pk_bf16_f32 v17, v50, v51
v_cvt_pk_bf16_f32 v18, v52, v53
v_cvt_pk_bf16_f32 v19, v54, v55
buffer_store_dwordx4 v[16:19], v1, s[4:7], s41 offen offset:2048 sc0 sc1
v_cvt_pk_bf16_f32 v20, v56, v57
v_cvt_pk_bf16_f32 v21, v58, v59
v_cvt_pk_bf16_f32 v22, v60, v61
v_cvt_pk_bf16_f32 v23, v62, v63
buffer_store_dwordx4 v[20:23], v1, s[4:7], s41 offen offset:3072 sc0 sc1
s_add_u32 s39, s39, 1048576
s_add_u32 s40, s40, 2097152
s_add_u32 s41, s41, 2097152
s_add_u32 s35, s35, 1
s_cmp_lg_u32 s35, 1
s_cbranch_scc1 L_q_n1
s_branch L_q_init_in
L_q_init:
s_sleep 4
L_q_init_in:
buffer_load_dword v12, v8, s[24:27], 0 offen offset:0 sc0 sc1
s_sub_u32 s36, s36, 1
s_cbranch_scc1 L_exit_w
s_waitcnt vmcnt(0)
v_readfirstlane_b32 s37, v12
s_nop 0
s_and_b32 s37, s37, 0xff
s_cmp_eq_u32 s37, 32
s_cbranch_scc0 L_q_init
v_mov_b32 v12, s35
s_mov_b64 exec, 1
buffer_store_dword v12, v8, s[4:7], s49 offen sc0 sc1
s_mov_b64 exec, -1
s_waitcnt vmcnt(0)
L_q_n1:
s_cmp_lt_u32 s35, 16
s_cbranch_scc1 L_q_loop
s_waitcnt vmcnt(0)
v_mov_b32 v12, s35
s_mov_b64 exec, 1
buffer_store_dword v12, v8, s[4:7], s49 offen sc0 sc1
s_mov_b64 exec, -1
s_barrier
s_lshr_b32 s37, s34, 1
s_and_b32 s38, s34, 1
s_lshl_b32 s50, s42, 13
s_lshl_b32 s39, s37, 10
s_add_u32 s50, s50, s39
s_add_u32 s50, s50, 50331648
s_lshl_b32 s52, s42, 14
s_add_u32 s52, s52, 16777216
s_lshl_b32 s39, s38, 13
s_add_u32 s53, s52, s39
s_mul_i32 s55, s33, 10240
s_add_u32 s55, s55, 8388608
s_and_b32 s59, s33, 1
s_sub_u32 s59, s59, 1
s_lshl_b32 s39, s33, 1
s_add_u32 s39, s39, s37
s_lshl_b32 s56, s39, 6
s_lshl_b32 s40, s32, 1
s_add_u32 s40, s40, s38
s_add_u32 s56, s56, s40
s_lshl_b32 s58, s56, 4
s_add_u32 s58, s58, 331776
s_lshl_b32 s56, s56, 11
s_add_u32 s56, s56, 67108864
s_mov_b32 s35, 0
s_lshl_b32 s37, s37, 4
v_add_u32 v12, s37, v10
v_lshlrev_b32 v13, 2, v11
v_sub_u32 v12, v12, v13
v_mov_b32 v13, 0xf149f2ca
v_cmp_le_i32 vcc, 0, v12
s_nop 1
v_cndmask_b32 v80, v13, v8, vcc
v_cmp_le_i32 vcc, 1, v12
s_nop 1
v_cndmask_b32 v81, v13, v8, vcc
v_cmp_le_i32 vcc, 2, v12
s_nop 1
v_cndmask_b32 v82, v13, v8, vcc
v_cmp_le_i32 vcc, 3, v12
s_nop 1
v_cndmask_b32 v83, v13, v8, vcc
v_cmp_le_i32 vcc, 16, v12
s_nop 1
v_cndmask_b32 v84, v13, v8, vcc
v_cmp_le_i32 vcc, 17, v12
s_nop 1
v_cndmask_b32 v85, v13, v8, vcc
v_cmp_le_i32 vcc, 18, v12
s_nop 1
v_cndmask_b32 v86, v13, v8, vcc
v_cmp_le_i32 vcc, 19, v12
s_nop 1
v_cndmask_b32 v87, v13, v8, vcc
v_cmp_gt_u32 vcc, 2, v11
s_nop 1
v_cndmask_b32 v88, v13, v8, vcc
v_cndmask_b32 v89, v13, v8, vcc
v_cndmask_b32 v90, v13, v8, vcc
v_cndmask_b32 v91, v13, v8, vcc
v_mov_b32 v92, 0x3f803f80
v_mov_b32 v93, 0x3f803f80
v_mov_b32 v94, 0x3f803f80
v_mov_b32 v95, 0x3f803f80
v_lshrrev_b32 v12, 1, v11
v_lshlrev_b32 v14, 8, v12
v_and_b32 v12, 1, v11
v_lshl_add_u32 v14, v12, 5, v14
v_bfe_u32 v12, v10, 1, 2
v_lshl_add_u32 v14, v12, 6, v14
v_and_b32 v12, 1, v10
v_lshl_add_u32 v14, v12, 4, v14
s_lshl_b32 s37, s34, 8
v_lshl_add_u32 v15, v9, 2, s37
s_lshl_b32 s37, s34, 10
v_add_u32 v6, s37, v1
s_lshl_b32 s38, s38, 11
v_add_u32 v3, s38, v1
v_and_b32 v12, 3, v10
v_cmp_eq_u32 vcc, 0, v12
s_nop 1
v_cndmask_b32 v5, 0, 1, vcc
L_at_loop:
s_add_u32 s51, s50, 4096
s_add_u32 s54, s53, 4096
s_add_u32 s60, s55, 4096
s_add_u32 s57, s55, 8192
buffer_load_dwordx4 v[16:19], v1, s[4:7], s50 offen offset:0
buffer_load_dwordx4 v[32:35], v4, s[4:7], s52 offen offset:0 sc1
buffer_load_dwordx4 v[48:51], v4, s[4:7], s52 offen offset:128 sc1
buffer_load_dwordx4 v[20:23], v1, s[4:7], s50 offen offset:2048
buffer_load_dwordx4 v[36:39], v4, s[4:7], s52 offen offset:64 sc1
buffer_load_dwordx4 v[52:55], v4, s[4:7], s52 offen offset:192 sc1
buffer_load_dwordx4 v[24:27], v1, s[4:7], s51 offen offset:0
buffer_load_dwordx4 v[40:43], v4, s[4:7], s52 offen offset:1024 sc1
buffer_load_dwordx4 v[56:59], v4, s[4:7], s52 offen offset:1152 sc1
buffer_load_dwordx4 v[28:31], v1, s[4:7], s51 offen offset:2048
buffer_load_dwordx4 v[44:47], v4, s[4:7], s52 offen offset:1088 sc1
buffer_load_dwordx4 v[60:63], v4, s[4:7], s52 offen offset:1216 sc1
buffer_load_dwordx4 v[64:67], v1, s[4:7], s53 offen offset:2048 sc1
buffer_load_dwordx4 v[68:71], v1, s[4:7], s53 offen offset:3072 sc1
buffer_load_dwordx4 v[72:75], v1, s[4:7], s54 offen offset:2048 sc1
buffer_load_dwordx4 v[76:79], v1, s[4:7], s54 offen offset:3072 sc1
s_waitcnt vmcnt(13)
v_mfma_f32_16x16x32_bf16 v[96:99], v[32:35], v[16:19], v[80:83]
v_mfma_f32_16x16x32_bf16 v[100:103], v[48:51], v[16:19], v[84:87]
s_waitcnt vmcnt(10)
v_mfma_f32_16x16x32_bf16 v[96:99], v[36:39], v[20:23], v[96:99]
v_mfma_f32_16x16x32_bf16 v[100:103], v[52:55], v[20:23], v[100:103]
s_waitcnt vmcnt(7)
v_mfma_f32_16x16x32_bf16 v[96:99], v[40:43], v[24:27], v[96:99]
v_mfma_f32_16x16x32_bf16 v[100:103], v[56:59], v[24:27], v[100:103]
s_waitcnt vmcnt(4)
v_mfma_f32_16x16x32_bf16 v[96:99], v[44:47], v[28:31], v[96:99]
v_mfma_f32_16x16x32_bf16 v[100:103], v[60:63], v[28:31], v[100:103]
s_nop 3
v_max3_f32 v160, v96, v97, v98
s_nop 2
v_max3_f32 v160, v160, v99, v100
v_max3_f32 v160, v160, v101, v102
v_max_f32 v160, v160, v103
s_branch L_at_in
L_at_poll:
s_sleep 2
L_at_in:
buffer_load_dwordx4 v[164:167], v6, s[4:7], s55 offen sc0 sc1
buffer_load_dwordx4 v[168:171], v6, s[4:7], s60 offen sc0 sc1
buffer_load_dword v172, v15, s[4:7], s57 offen sc0 sc1
s_sub_u32 s36, s36, 1
s_cbranch_scc1 L_exit_w
s_waitcnt vmcnt(0)
v_bitop3_b32 v12, v164, v168, s59 bitop3:0x7e
v_bitop3_b32 v13, v172, s59, v5 bitop3:0x28
v_and_or_b32 v12, v12, 1, v13
v_cmp_ne_u32 vcc, 0, v12
s_cbranch_vccnz L_at_poll
ds_write_b128 v6, v[164:167]
ds_write_b128 v6, v[168:171] offset:4096
ds_write_b32 v15, v172 offset:8192
s_waitcnt lgkmcnt(0)
s_barrier
ds_read_b128 v[176:179], v14 offset:0
ds_read_b128 v[180:183], v14 offset:512
ds_read_b128 v[184:187], v14 offset:1024
ds_read_b128 v[188:191], v14 offset:1536
s_waitcnt lgkmcnt(3)
v_mfma_f32_16x16x32_bf16 v[192:195], v[224:227], v[176:179], 0
v_mfma_f32_16x16x32_bf16 v[196:199], a[40:43], v[176:179], 0
v_mfma_f32_16x16x32_bf16 v[200:203], v[176:179], a[112:115], 0
v_mfma_f32_16x16x32_bf16 v[204:207], v[176:179], a[184:187], 0
ds_read_b128 v[176:179], v14 offset:2048
s_waitcnt lgkmcnt(3)
v_mfma_f32_16x16x32_bf16 v[192:195], v[228:231], v[180:183], v[192:195]
v_mfma_f32_16x16x32_bf16 v[196:199], a[44:47], v[180:183], v[196:199]
v_mfma_f32_16x16x32_bf16 v[200:203], v[180:183], a[116:119], v[200:203]
v_mfma_f32_16x16x32_bf16 v[204:207], v[180:183], a[188:191], v[204:207]
ds_read_b128 v[180:183], v14 offset:2560
s_waitcnt lgkmcnt(3)
v_mfma_f32_16x16x32_bf16 v[192:195], v[232:235], v[184:187], v[192:195]
v_mfma_f32_16x16x32_bf16 v[196:199], a[48:51], v[184:187], v[196:199]
v_mfma_f32_16x16x32_bf16 v[200:203], v[184:187], a[120:123], v[200:203]
v_mfma_f32_16x16x32_bf16 v[204:207], v[184:187], a[192:195], v[204:207]
ds_read_b128 v[184:187], v14 offset:3072
s_waitcnt lgkmcnt(3)
v_mfma_f32_16x16x32_bf16 v[192:195], v[236:239], v[188:191], v[192:195]
v_mfma_f32_16x16x32_bf16 v[196:199], a[52:55], v[188:191], v[196:199]
v_mfma_f32_16x16x32_bf16 v[200:203], v[188:191], a[124:127], v[200:203]
v_mfma_f32_16x16x32_bf16 v[204:207], v[188:191], a[196:199], v[204:207]
ds_read_b128 v[188:191], v14 offset:3584
s_waitcnt lgkmcnt(3)
v_mfma_f32_16x16x32_bf16 v[192:195], v[240:243], v[176:179], v[192:195]
v_mfma_f32_16x16x32_bf16 v[196:199], a[56:59], v[176:179], v[196:199]
v_mfma_f32_16x16x32_bf16 v[200:203], v[176:179], a[128:131], v[200:203]
v_mfma_f32_16x16x32_bf16 v[204:207], v[176:179], a[200:203], v[204:207]
ds_read_b128 v[176:179], v14 offset:4096
s_waitcnt lgkmcnt(3)
v_mfma_f32_16x16x32_bf16 v[192:195], v[244:247], v[180:183], v[192:195]
v_mfma_f32_16x16x32_bf16 v[196:199], a[60:63], v[180:183], v[196:199]
v_mfma_f32_16x16x32_bf16 v[200:203], v[180:183], a[132:135], v[200:203]
v_mfma_f32_16x16x32_bf16 v[204:207], v[180:183], a[204:207], v[204:207]
ds_read_b128 v[180:183], v14 offset:4608
s_waitcnt lgkmcnt(3)
v_mfma_f32_16x16x32_bf16 v[192:195], v[248:251], v[184:187], v[192:195]
v_mfma_f32_16x16x32_bf16 v[196:199], a[64:67], v[184:187], v[196:199]
v_mfma_f32_16x16x32_bf16 v[200:203], v[184:187], a[136:139], v[200:203]
v_mfma_f32_16x16x32_bf16 v[204:207], v[184:187], a[208:211], v[204:207]
ds_read_b128 v[184:187], v14 offset:5120
s_waitcnt lgkmcnt(3)
v_mfma_f32_16x16x32_bf16 v[192:195], v[252:255], v[188:191], v[192:195]
v_mfma_f32_16x16x32_bf16 v[196:199], a[68:71], v[188:191], v[196:199]
v_mfma_f32_16x16x32_bf16 v[200:203], v[188:191], a[140:143], v[200:203]
v_mfma_f32_16x16x32_bf16 v[204:207], v[188:191], a[212:215], v[204:207]
ds_read_b128 v[188:191], v14 offset:5632
s_waitcnt lgkmcnt(3)
v_mfma_f32_16x16x32_bf16 v[192:195], a[0:3], v[176:179], v[192:195]
v_mfma_f32_16x16x32_bf16 v[196:199], a[72:75], v[176:179], v[196:199]
v_mfma_f32_16x16x32_bf16 v[200:203], v[176:179], a[144:147], v[200:203]
v_mfma_f32_16x16x32_bf16 v[204:207], v[176:179], a[216:219], v[204:207]
ds_read_b128 v[176:179], v14 offset:6144
s_waitcnt lgkmcnt(3)
v_mfma_f32_16x16x32_bf16 v[192:195], a[4:7], v[180:183], v[192:195]
v_mfma_f32_16x16x32_bf16 v[196:199], a[76:79], v[180:183], v[196:199]
v_mfma_f32_16x16x32_bf16 v[200:203], v[180:183], a[148:151], v[200:203]
v_mfma_f32_16x16x32_bf16 v[204:207], v[180:183], a[220:223], v[204:207]
ds_read_b128 v[180:183], v14 offset:6656
s_waitcnt lgkmcnt(3)
v_mfma_f32_16x16x32_bf16 v[192:195], a[8:11], v[184:187], v[192:195]
v_mfma_f32_16x16x32_bf16 v[196:199], a[80:83], v[184:187], v[196:199]
v_mfma_f32_16x16x32_bf16 v[200:203], v[184:187], a[152:155], v[200:203]
v_mfma_f32_16x16x32_bf16 v[204:207], v[184:187], a[224:227], v[204:207]
ds_read_b128 v[184:187], v14 offset:7168
s_waitcnt lgkmcnt(3)
v_mfma_f32_16x16x32_bf16 v[192:195], a[12:15], v[188:191], v[192:195]
v_mfma_f32_16x16x32_bf16 v[196:199], a[84:87], v[188:191], v[196:199]
v_mfma_f32_16x16x32_bf16 v[200:203], v[188:191], a[156:159], v[200:203]
v_mfma_f32_16x16x32_bf16 v[204:207], v[188:191], a[228:231], v[204:207]
ds_read_b128 v[188:191], v14 offset:7680
s_waitcnt lgkmcnt(3)
v_mfma_f32_16x16x32_bf16 v[192:195], a[16:19], v[176:179], v[192:195]
v_mfma_f32_16x16x32_bf16 v[196:199], a[88:91], v[176:179], v[196:199]
v_mfma_f32_16x16x32_bf16 v[200:203], v[176:179], a[160:163], v[200:203]
v_mfma_f32_16x16x32_bf16 v[204:207], v[176:179], a[232:235], v[204:207]
ds_read_b128 v[176:179], v14 offset:8192
s_waitcnt lgkmcnt(3)
v_mfma_f32_16x16x32_bf16 v[192:195], a[20:23], v[180:183], v[192:195]
v_mfma_f32_16x16x32_bf16 v[196:199], a[92:95], v[180:183], v[196:199]
v_mfma_f32_16x16x32_bf16 v[200:203], v[180:183], a[164:167], v[200:203]
v_mfma_f32_16x16x32_bf16 v[204:207], v[180:183], a[236:239], v[204:207]
ds_read_b128 v[180:183], v14 offset:8704
s_waitcnt lgkmcnt(3)
v_mfma_f32_16x16x32_bf16 v[192:195], a[24:27], v[184:187], v[192:195]
v_mfma_f32_16x16x32_bf16 v[196:199], a[96:99], v[184:187], v[196:199]
v_mfma_f32_16x16x32_bf16 v[200:203], v[184:187], a[168:171], v[200:203]
v_mfma_f32_16x16x32_bf16 v[204:207], v[184:187], a[240:243], v[204:207]
s_waitcnt lgkmcnt(2)
v_mfma_f32_16x16x32_bf16 v[192:195], a[28:31], v[188:191], v[192:195]
v_mfma_f32_16x16x32_bf16 v[196:199], a[100:103], v[188:191], v[196:199]
v_mfma_f32_16x16x32_bf16 v[200:203], v[188:191], a[172:175], v[200:203]
v_mfma_f32_16x16x32_bf16 v[204:207], v[188:191], a[244:247], v[204:207]
s_waitcnt lgkmcnt(1)
v_mfma_f32_16x16x32_bf16 v[192:195], a[32:35], v[176:179], v[192:195]
v_mfma_f32_16x16x32_bf16 v[196:199], a[104:107], v[176:179], v[196:199]
v_mfma_f32_16x16x32_bf16 v[200:203], v[176:179], a[176:179], v[200:203]
v_mfma_f32_16x16x32_bf16 v[204:207], v[176:179], a[248:251], v[204:207]
s_waitcnt lgkmcnt(0)
v_mfma_f32_16x16x32_bf16 v[192:195], a[36:39], v[180:183], v[192:195]
v_mfma_f32_16x16x32_bf16 v[196:199], a[108:111], v[180:183], v[196:199]
v_mfma_f32_16x16x32_bf16 v[200:203], v[180:183], a[180:183], v[200:203]
v_mfma_f32_16x16x32_bf16 v[204:207], v[180:183], a[252:255], v[204:207]
v_mul_f32 v192, s46, v192
v_mul_f32 v193, s46, v193
v_mul_f32 v194, s46, v194
v_mul_f32 v195, s46, v195
v_mul_f32 v196, s46, v196
v_mul_f32 v197, s46, v197
v_mul_f32 v198, s46, v198
v_mul_f32 v199, s46, v199
v_cvt_pk_bf16_f32 v208, v192, v193
v_cvt_pk_bf16_f32 v209, v194, v195
v_cvt_pk_bf16_f32 v210, v196, v197
v_cvt_pk_bf16_f32 v211, v198, v199
ds_write_b128 v6, v[208:211] offset:9216
v_cvt_pk_bf16_f32 v212, v200, v201
v_cvt_pk_bf16_f32 v213, v202, v203
v_cvt_pk_bf16_f32 v214, v204, v205
v_cvt_pk_bf16_f32 v215, v206, v207
ds_write_b128 v6, v[212:215] offset:13312
s_waitcnt lgkmcnt(0)
s_barrier
ds_read_b128 v[108:111], v1 offset:9216
ds_read_b128 v[112:115], v1 offset:10240
ds_read_b128 v[116:119], v1 offset:11264
ds_read_b128 v[120:123], v1 offset:12288
ds_read_b128 v[124:127], v3 offset:13312
ds_read_b128 v[128:131], v3 offset:14336
s_waitcnt lgkmcnt(5)
v_mfma_f32_16x16x32_bf16 v[104:107], v[108:111], v[16:19], v[88:91]
s_waitcnt lgkmcnt(4)
v_mfma_f32_16x16x32_bf16 v[104:107], v[112:115], v[20:23], v[104:107]
s_waitcnt lgkmcnt(3)
v_mfma_f32_16x16x32_bf16 v[104:107], v[116:119], v[24:27], v[104:107]
s_waitcnt lgkmcnt(2)
v_mfma_f32_16x16x32_bf16 v[104:107], v[120:123], v[28:31], v[104:107]
s_nop 7
v_max3_f32 v160, v160, v104, v105
v_max3_f32 v161, v160, v106, v107
v_max3_f32 v160, v160, v106, v107
s_nop 1
v_permlane16_swap_b32 v160, v161
v_max_f32 v162, v160, v161
v_max_f32 v163, v160, v161
s_nop 1
v_permlane32_swap_b32 v162, v163
v_max_f32 v160, v162, v163
v_pk_add_f32 v[96:97], v[96:97], v[160:161] op_sel_hi:[1,0] neg_lo:[0,1] neg_hi:[0,1]
v_pk_add_f32 v[98:99], v[98:99], v[160:161] op_sel_hi:[1,0] neg_lo:[0,1] neg_hi:[0,1]
v_pk_add_f32 v[100:101], v[100:101], v[160:161] op_sel_hi:[1,0] neg_lo:[0,1] neg_hi:[0,1]
v_pk_add_f32 v[102:103], v[102:103], v[160:161] op_sel_hi:[1,0] neg_lo:[0,1] neg_hi:[0,1]
v_pk_add_f32 v[104:105], v[104:105], v[160:161] op_sel_hi:[1,0] neg_lo:[0,1] neg_hi:[0,1]
v_pk_add_f32 v[106:107], v[106:107], v[160:161] op_sel_hi:[1,0] neg_lo:[0,1] neg_hi:[0,1]
v_exp_f32 v96, v96
v_exp_f32 v97, v97
v_exp_f32 v98, v98
v_exp_f32 v99, v99
v_exp_f32 v100, v100
v_exp_f32 v101, v101
v_exp_f32 v102, v102
v_exp_f32 v103, v103
v_exp_f32 v104, v104
v_exp_f32 v105, v105
v_exp_f32 v106, v106
v_exp_f32 v107, v107
v_cvt_pk_bf16_f32 v132, v96, v97
v_cvt_pk_bf16_f32 v133, v98, v99
v_cvt_pk_bf16_f32 v134, v100, v101
v_cvt_pk_bf16_f32 v135, v102, v103
v_cvt_pk_bf16_f32 v136, v104, v105
v_cvt_pk_bf16_f32 v137, v106, v107
v_mfma_f32_16x16x32_bf16 v[156:159], v[92:95], v[132:135], 0
v_mfma_f32_16x16x32_bf16 v[140:143], v[64:67], v[132:135], 0
v_mfma_f32_16x16x32_bf16 v[144:147], v[68:71], v[132:135], 0
v_mfma_f32_16x16x32_bf16 v[148:151], v[72:75], v[132:135], 0
v_mfma_f32_16x16x32_bf16 v[152:155], v[76:79], v[132:135], 0
s_waitcnt lgkmcnt(0)
v_mfma_f32_16x16x16_bf16 v[156:159], v[92:93], v[136:137], v[156:159]
v_mfma_f32_16x16x16_bf16 v[140:143], v[124:125], v[136:137], v[140:143]
v_mfma_f32_16x16x16_bf16 v[144:147], v[126:127], v[136:137], v[144:147]
v_mfma_f32_16x16x16_bf16 v[148:151], v[128:129], v[136:137], v[148:151]
v_mfma_f32_16x16x16_bf16 v[152:155], v[130:131], v[136:137], v[152:155]
v_rcp_f32 v156, v156
s_nop 0
v_mul_f32 v140, v140, v156
v_mul_f32 v141, v141, v156
v_mul_f32 v142, v142, v156
v_mul_f32 v143, v143, v156
v_mul_f32 v144, v144, v156
v_mul_f32 v145, v145, v156
v_mul_f32 v146, v146, v156
v_mul_f32 v147, v147, v156
v_cvt_pk_bf16_f32 v140, v140, v141
v_cvt_pk_bf16_f32 v141, v142, v143
v_cvt_pk_bf16_f32 v142, v144, v145
v_cvt_pk_bf16_f32 v143, v146, v147
buffer_store_dwordx4 v[140:143], v1, s[4:7], s56 offen offset:0 sc0 sc1
v_mul_f32 v148, v148, v156
v_mul_f32 v149, v149, v156
v_mul_f32 v150, v150, v156
v_mul_f32 v151, v151, v156
v_mul_f32 v152, v152, v156
v_mul_f32 v153, v153, v156
v_mul_f32 v154, v154, v156
v_mul_f32 v155, v155, v156
v_cvt_pk_bf16_f32 v148, v148, v149
v_cvt_pk_bf16_f32 v149, v150, v151
v_cvt_pk_bf16_f32 v150, v152, v153
v_cvt_pk_bf16_f32 v151, v154, v155
buffer_store_dwordx4 v[148:151], v1, s[4:7], s56 offen offset:1024 sc0 sc1
s_add_u32 s35, s35, 1
v_mov_b32 v13, s35
s_add_u32 s50, s50, 1048576
s_add_u32 s52, s52, 2097152
s_add_u32 s53, s53, 2097152
s_add_u32 s55, s55, 40960
s_add_u32 s56, s56, 1048576
s_waitcnt vmcnt(0)
s_mov_b64 exec, 1
buffer_store_dword v13, v8, s[4:7], s58 offen sc0 sc1
s_mov_b64 exec, -1
s_cmp_lt_u32 s35, 16
s_cbranch_scc1 L_at_loop
s_waitcnt vmcnt(0)
s_endpgm
L_role_aw:
s_load_dwordx2 s[4:5], s[0:1], 104
s_mov_b32 s6, 268435456
s_mov_b32 s7, 0x20000
s_load_dwordx2 s[8:9], s[0:1], 0
s_mov_b32 s10, 2359296
s_mov_b32 s11, 0x20000
s_load_dwordx2 s[12:13], s[0:1], 8
s_mov_b32 s14, 1990656
s_mov_b32 s15, 0x20000
s_load_dwordx2 s[16:17], s[0:1], 16
s_mov_b32 s18, 663552
s_mov_b32 s19, 0x20000
s_load_dwordx2 s[20:21], s[0:1], 64
s_mov_b32 s22, 4718592
s_mov_b32 s23, 0x20000
s_load_dwordx2 s[24:25], s[0:1], 96
s_mov_b32 s26, 256
s_mov_b32 s27, 0x20000
s_load_dwordx2 s[28:29], s[0:1], 88
s_mov_b32 s30, 2359296
s_mov_b32 s31, 0x20000
s_load_dwordx2 s[64:65], s[0:1], 80
s_mov_b32 s66, 1152
s_mov_b32 s67, 0x20000
v_and_b32 v9, 63, v0
v_and_b32 v10, 15, v0
v_bfe_u32 v11, v0, 4, 2
v_lshrrev_b32 v1, 6, v0
s_nop 0
v_readfirstlane_b32 s34, v1
v_lshrrev_b32 v12, 2, v9
v_mul_u32_u24 v2, 1152, v12
v_lshrrev_b32 v12, 5, v9
v_lshlrev_b32 v12, 1, v12
v_and_b32 v13, 3, v9
v_xor_b32 v12, v12, v13
v_lshl_add_u32 v2, v12, 4, v2
v_lshrrev_b32 v12, 3, v10
v_lshlrev_b32 v12, 1, v12
v_xor_b32 v12, v12, v11
v_lshlrev_b32 v12, 4, v12
v_lshl_add_u32 v3, v10, 6, v12
v_lshrrev_b32 v12, 2, v10
v_lshl_add_u32 v12, v11, 3, v12
v_mul_u32_u24 v7, 64, v12
v_and_b32 v12, 3, v10
v_lshl_add_u32 v7, v12, 3, v7
v_lshlrev_b32 v1, 4, v9
s_mul_i32 s38, s34, 20480
s_add_u32 s38, s38, 73728
v_add_u32 v7, s38, v7
v_mov_b32 v8, 0
s_lshl_b32 s37, s34, 3
s_add_u32 s37, s37, 0
v_and_b32 v12, 3, v9
v_add_u32 v12, s37, v12
v_min_u32 v12, 26, v12
v_mul_u32_u24 v13, 57, v12
v_lshrrev_b32 v13, 9, v13
v_mul_u32_u24 v13, 1008, v13
v_lshl_add_u32 v13, v12, 4, v13
v_lshrrev_b32 v12, 2, v9
v_mul_u32_u24 v12, 3456, v12
v_add_u32 v5, v12, v13
s_lshl_b32 s37, s34, 3
s_add_u32 s37, s37, 4
v_and_b32 v12, 3, v9
v_add_u32 v12, s37, v12
v_min_u32 v12, 26, v12
v_mul_u32_u24 v13, 57, v12
v_lshrrev_b32 v13, 9, v13
v_mul_u32_u24 v13, 1008, v13
v_lshl_add_u32 v13, v12, 4, v13
v_lshrrev_b32 v12, 2, v9
v_mul_u32_u24 v12, 3456, v12
v_add_u32 v6, v12, v13
s_mul_i32 s39, s32, 144
s_mul_i32 s40, s33, 11
s_and_b32 s41, s34, 1
s_add_u32 s40, s40, s41
s_sub_u32 s40, s40, 1
s_max_i32 s41, s40, 0
s_lshr_b32 s42, s34, 1
s_lshl_b32 s42, s42, 6
s_mul_i32 s43, s41, 18432
s_add_u32 s43, s43, s42
s_mul_i32 s40, s40, 18432
s_add_u32 s40, s40, s42
s_lshl_b32 s44, s34, 10
s_mov_b32 s36, 400000
v_mul_u32_u24 v4, 456, v10
v_lshl_add_u32 v4, v11, 3, v4
s_lshl_b32 s37, s34, 7
s_add_u32 s37, s37, 73728
v_add_u32 v4, s37, v4
v_lshlrev_b32 v14, 2, v10
v_add_u32 v14, 161280, v14
s_waitcnt lgkmcnt(0)
s_add_u32 s37, s39, 0
s_add_u32 m0, s38, 0
s_nop 0
buffer_load_dwordx4 v5, s[12:15], s37 offen lds
s_add_u32 s37, s39, 55296
s_add_u32 m0, s38, 1024
s_nop 0
buffer_load_dwordx4 v5, s[12:15], s37 offen lds
s_add_u32 s37, s39, 110592
s_add_u32 m0, s38, 2048
s_nop 0
buffer_load_dwordx4 v5, s[12:15], s37 offen lds
s_add_u32 s37, s39, 165888
s_add_u32 m0, s38, 3072
s_nop 0
buffer_load_dwordx4 v5, s[12:15], s37 offen lds
s_add_u32 s37, s39, 221184
s_add_u32 m0, s38, 4096
s_nop 0
buffer_load_dwordx4 v5, s[12:15], s37 offen lds
s_add_u32 s37, s39, 276480
s_add_u32 m0, s38, 5120
s_nop 0
buffer_load_dwordx4 v5, s[12:15], s37 offen lds
s_add_u32 s37, s39, 331776
s_add_u32 m0, s38, 6144
s_nop 0
buffer_load_dwordx4 v5, s[12:15], s37 offen lds
s_add_u32 s37, s39, 387072
s_add_u32 m0, s38, 7168
s_nop 0
buffer_load_dwordx4 v5, s[12:15], s37 offen lds
s_add_u32 s37, s39, 442368
s_add_u32 m0, s38, 8192
s_nop 0
buffer_load_dwordx4 v5, s[12:15], s37 offen lds
s_add_u32 s37, s39, 497664
s_add_u32 m0, s38, 9216
s_nop 0
buffer_load_dwordx4 v5, s[12:15], s37 offen lds
s_add_u32 s37, s39, 552960
s_add_u32 m0, s38, 10240
s_nop 0
buffer_load_dwordx4 v5, s[12:15], s37 offen lds
s_add_u32 s37, s39, 608256
s_add_u32 m0, s38, 11264
s_nop 0
buffer_load_dwordx4 v5, s[12:15], s37 offen lds
s_add_u32 s37, s39, 663552
s_add_u32 m0, s38, 12288
s_nop 0
buffer_load_dwordx4 v5, s[12:15], s37 offen lds
s_add_u32 s37, s39, 718848
s_add_u32 m0, s38, 13312
s_nop 0
buffer_load_dwordx4 v5, s[12:15], s37 offen lds
s_add_u32 s37, s39, 774144
s_add_u32 m0, s38, 14336
s_nop 0
buffer_load_dwordx4 v5, s[12:15], s37 offen lds
s_add_u32 s37, s39, 829440
s_add_u32 m0, s38, 15360
s_nop 0
buffer_load_dwordx4 v5, s[12:15], s37 offen lds
s_add_u32 s37, s43, 0
s_add_u32 m0, s44, 0
s_nop 0
buffer_load_dwordx4 v2, s[8:11], s37 offen lds
s_add_u32 s37, s43, 128
s_add_u32 m0, s44, 4096
s_nop 0
buffer_load_dwordx4 v2, s[8:11], s37 offen lds
s_add_u32 s37, s43, 256
s_add_u32 m0, s44, 8192
s_nop 0
buffer_load_dwordx4 v2, s[8:11], s37 offen lds
s_add_u32 s37, s43, 384
s_add_u32 m0, s44, 12288
s_nop 0
buffer_load_dwordx4 v2, s[8:11], s37 offen lds
s_add_u32 s37, s43, 512
s_add_u32 m0, s44, 16384
s_nop 0
buffer_load_dwordx4 v2, s[8:11], s37 offen lds
s_add_u32 s37, s43, 640
s_add_u32 m0, s44, 20480
s_nop 0
buffer_load_dwordx4 v2, s[8:11], s37 offen lds
s_add_u32 s37, s43, 768
s_add_u32 m0, s44, 24576
s_nop 0
buffer_load_dwordx4 v2, s[8:11], s37 offen lds
s_add_u32 s37, s43, 896
s_add_u32 m0, s44, 28672
s_nop 0
buffer_load_dwordx4 v2, s[8:11], s37 offen lds
s_add_u32 s37, s43, 1024
s_add_u32 m0, s44, 32768
s_nop 0
buffer_load_dwordx4 v2, s[8:11], s37 offen lds
s_waitcnt vmcnt(21)
ds_read_b64_tr_b16 v[80:81], v7 offset:0
ds_read_b64_tr_b16 v[82:83], v7 offset:256
ds_read_b64_tr_b16 v[84:85], v7 offset:2048
ds_read_b64_tr_b16 v[86:87], v7 offset:2304
ds_read_b64_tr_b16 v[152:153], v7 offset:32
ds_read_b64_tr_b16 v[154:155], v7 offset:288
ds_read_b64_tr_b16 v[156:157], v7 offset:2080
ds_read_b64_tr_b16 v[158:159], v7 offset:2336
s_waitcnt lgkmcnt(0)
s_add_u32 s37, s39, 884736
s_add_u32 m0, s38, 16384
s_nop 0
buffer_load_dwordx4 v5, s[12:15], s37 offen lds
s_add_u32 s37, s39, 940032
s_add_u32 m0, s38, 17408
s_nop 0
buffer_load_dwordx4 v5, s[12:15], s37 offen lds
s_add_u32 s37, s39, 995328
s_add_u32 m0, s38, 18432
s_nop 0
buffer_load_dwordx4 v5, s[12:15], s37 offen lds
s_add_u32 s37, s39, 1050624
s_add_u32 m0, s38, 19456
s_nop 0
buffer_load_dwordx4 v5, s[12:15], s37 offen lds
s_waitcnt vmcnt(21)
ds_read_b64_tr_b16 v[88:89], v7 offset:4096
ds_read_b64_tr_b16 v[90:91], v7 offset:4352
ds_read_b64_tr_b16 v[92:93], v7 offset:6144
ds_read_b64_tr_b16 v[94:95], v7 offset:6400
ds_read_b64_tr_b16 v[160:161], v7 offset:4128
ds_read_b64_tr_b16 v[162:163], v7 offset:4384
ds_read_b64_tr_b16 v[164:165], v7 offset:6176
ds_read_b64_tr_b16 v[166:167], v7 offset:6432
s_waitcnt lgkmcnt(0)
s_add_u32 s37, s39, 1105920
s_add_u32 m0, s38, 0
s_nop 0
buffer_load_dwordx4 v5, s[12:15], s37 offen lds
s_add_u32 s37, s39, 1161216
s_add_u32 m0, s38, 1024
s_nop 0
buffer_load_dwordx4 v5, s[12:15], s37 offen lds
s_add_u32 s37, s39, 1216512
s_add_u32 m0, s38, 2048
s_nop 0
buffer_load_dwordx4 v5, s[12:15], s37 offen lds
s_add_u32 s37, s39, 1271808
s_add_u32 m0, s38, 3072
s_nop 0
buffer_load_dwordx4 v5, s[12:15], s37 offen lds
s_waitcnt vmcnt(21)
ds_read_b64_tr_b16 v[96:97], v7 offset:8192
ds_read_b64_tr_b16 v[98:99], v7 offset:8448
ds_read_b64_tr_b16 v[100:101], v7 offset:10240
ds_read_b64_tr_b16 v[102:103], v7 offset:10496
ds_read_b64_tr_b16 v[168:169], v7 offset:8224
ds_read_b64_tr_b16 v[170:171], v7 offset:8480
ds_read_b64_tr_b16 v[172:173], v7 offset:10272
ds_read_b64_tr_b16 v[174:175], v7 offset:10528
s_waitcnt lgkmcnt(0)
s_add_u32 s37, s39, 1327104
s_add_u32 m0, s38, 4096
s_nop 0
buffer_load_dwordx4 v5, s[12:15], s37 offen lds
s_add_u32 s37, s39, 1382400
s_add_u32 m0, s38, 5120
s_nop 0
buffer_load_dwordx4 v5, s[12:15], s37 offen lds
s_add_u32 s37, s39, 1437696
s_add_u32 m0, s38, 6144
s_nop 0
buffer_load_dwordx4 v5, s[12:15], s37 offen lds
s_add_u32 s37, s39, 1492992
s_add_u32 m0, s38, 7168
s_nop 0
buffer_load_dwordx4 v5, s[12:15], s37 offen lds
s_waitcnt vmcnt(21)
ds_read_b64_tr_b16 v[104:105], v7 offset:12288
ds_read_b64_tr_b16 v[106:107], v7 offset:12544
ds_read_b64_tr_b16 v[108:109], v7 offset:14336
ds_read_b64_tr_b16 v[110:111], v7 offset:14592
ds_read_b64_tr_b16 v[176:177], v7 offset:12320
ds_read_b64_tr_b16 v[178:179], v7 offset:12576
ds_read_b64_tr_b16 v[180:181], v7 offset:14368
ds_read_b64_tr_b16 v[182:183], v7 offset:14624
s_waitcnt lgkmcnt(0)
s_add_u32 s37, s39, 1548288
s_add_u32 m0, s38, 8192
s_nop 0
buffer_load_dwordx4 v5, s[12:15], s37 offen lds
s_add_u32 s37, s39, 1603584
s_add_u32 m0, s38, 9216
s_nop 0
buffer_load_dwordx4 v5, s[12:15], s37 offen lds
s_add_u32 s37, s39, 1658880
s_add_u32 m0, s38, 10240
s_nop 0
buffer_load_dwordx4 v5, s[12:15], s37 offen lds
s_add_u32 s37, s39, 1714176
s_add_u32 m0, s38, 11264
s_nop 0
buffer_load_dwordx4 v5, s[12:15], s37 offen lds
s_waitcnt vmcnt(12)
ds_read_b64_tr_b16 v[112:113], v7 offset:16384
ds_read_b64_tr_b16 v[114:115], v7 offset:16640
ds_read_b64_tr_b16 v[116:117], v7 offset:18432
ds_read_b64_tr_b16 v[118:119], v7 offset:18688
ds_read_b64_tr_b16 v[184:185], v7 offset:16416
ds_read_b64_tr_b16 v[186:187], v7 offset:16672
ds_read_b64_tr_b16 v[188:189], v7 offset:18464
ds_read_b64_tr_b16 v[190:191], v7 offset:18720
s_waitcnt lgkmcnt(0)
s_add_u32 s37, s39, 1769472
s_add_u32 m0, s38, 12288
s_nop 0
buffer_load_dwordx4 v5, s[12:15], s37 offen lds
s_add_u32 s37, s39, 1824768
s_add_u32 m0, s38, 13312
s_nop 0
buffer_load_dwordx4 v5, s[12:15], s37 offen lds
s_add_u32 s37, s39, 1880064
s_add_u32 m0, s38, 14336
s_nop 0
buffer_load_dwordx4 v5, s[12:15], s37 offen lds
s_add_u32 s37, s39, 1935360
s_add_u32 m0, s38, 15360
s_nop 0
buffer_load_dwordx4 v5, s[12:15], s37 offen lds
s_waitcnt vmcnt(12)
ds_read_b64_tr_b16 v[120:121], v7 offset:0
ds_read_b64_tr_b16 v[122:123], v7 offset:256
ds_read_b64_tr_b16 v[124:125], v7 offset:2048
ds_read_b64_tr_b16 v[126:127], v7 offset:2304
ds_read_b64_tr_b16 v[192:193], v7 offset:32
ds_read_b64_tr_b16 v[194:195], v7 offset:288
ds_read_b64_tr_b16 v[196:197], v7 offset:2080
ds_read_b64_tr_b16 v[198:199], v7 offset:2336
s_waitcnt lgkmcnt(0)
s_add_u32 s37, s39, 0
s_add_u32 m0, s38, 16384
s_nop 0
buffer_load_dwordx4 v6, s[12:15], s37 offen lds
s_add_u32 s37, s39, 55296
s_add_u32 m0, s38, 17408
s_nop 0
buffer_load_dwordx4 v6, s[12:15], s37 offen lds
s_add_u32 s37, s39, 110592
s_add_u32 m0, s38, 18432
s_nop 0
buffer_load_dwordx4 v6, s[12:15], s37 offen lds
s_add_u32 s37, s39, 165888
s_add_u32 m0, s38, 19456
s_nop 0
buffer_load_dwordx4 v6, s[12:15], s37 offen lds
s_waitcnt vmcnt(12)
ds_read_b64_tr_b16 v[128:129], v7 offset:4096
ds_read_b64_tr_b16 v[130:131], v7 offset:4352
ds_read_b64_tr_b16 v[132:133], v7 offset:6144
ds_read_b64_tr_b16 v[134:135], v7 offset:6400
ds_read_b64_tr_b16 v[200:201], v7 offset:4128
ds_read_b64_tr_b16 v[202:203], v7 offset:4384
ds_read_b64_tr_b16 v[204:205], v7 offset:6176
ds_read_b64_tr_b16 v[206:207], v7 offset:6432
s_waitcnt lgkmcnt(0)
s_add_u32 s37, s39, 221184
s_add_u32 m0, s38, 0
s_nop 0
buffer_load_dwordx4 v6, s[12:15], s37 offen lds
s_add_u32 s37, s39, 276480
s_add_u32 m0, s38, 1024
s_nop 0
buffer_load_dwordx4 v6, s[12:15], s37 offen lds
s_add_u32 s37, s39, 331776
s_add_u32 m0, s38, 2048
s_nop 0
buffer_load_dwordx4 v6, s[12:15], s37 offen lds
s_add_u32 s37, s39, 387072
s_add_u32 m0, s38, 3072
s_nop 0
buffer_load_dwordx4 v6, s[12:15], s37 offen lds
s_waitcnt vmcnt(12)
ds_read_b64_tr_b16 v[136:137], v7 offset:8192
ds_read_b64_tr_b16 v[138:139], v7 offset:8448
ds_read_b64_tr_b16 v[140:141], v7 offset:10240
ds_read_b64_tr_b16 v[142:143], v7 offset:10496
ds_read_b64_tr_b16 v[208:209], v7 offset:8224
ds_read_b64_tr_b16 v[210:211], v7 offset:8480
ds_read_b64_tr_b16 v[212:213], v7 offset:10272
ds_read_b64_tr_b16 v[214:215], v7 offset:10528
s_waitcnt lgkmcnt(0)
s_add_u32 s37, s39, 442368
s_add_u32 m0, s38, 4096
s_nop 0
buffer_load_dwordx4 v6, s[12:15], s37 offen lds
s_add_u32 s37, s39, 497664
s_add_u32 m0, s38, 5120
s_nop 0
buffer_load_dwordx4 v6, s[12:15], s37 offen lds
s_add_u32 s37, s39, 552960
s_add_u32 m0, s38, 6144
s_nop 0
buffer_load_dwordx4 v6, s[12:15], s37 offen lds
s_add_u32 s37, s39, 608256
s_add_u32 m0, s38, 7168
s_nop 0
buffer_load_dwordx4 v6, s[12:15], s37 offen lds
s_waitcnt vmcnt(12)
ds_read_b64_tr_b16 v[144:145], v7 offset:12288
ds_read_b64_tr_b16 v[146:147], v7 offset:12544
ds_read_b64_tr_b16 v[148:149], v7 offset:14336
ds_read_b64_tr_b16 v[150:151], v7 offset:14592
ds_read_b64_tr_b16 v[216:217], v7 offset:12320
ds_read_b64_tr_b16 v[218:219], v7 offset:12576
ds_read_b64_tr_b16 v[220:221], v7 offset:14368
ds_read_b64_tr_b16 v[222:223], v7 offset:14624
s_waitcnt lgkmcnt(0)
s_add_u32 s37, s39, 663552
s_add_u32 m0, s38, 8192
s_nop 0
buffer_load_dwordx4 v6, s[12:15], s37 offen lds
s_add_u32 s37, s39, 718848
s_add_u32 m0, s38, 9216
s_nop 0
buffer_load_dwordx4 v6, s[12:15], s37 offen lds
s_add_u32 s37, s39, 774144
s_add_u32 m0, s38, 10240
s_nop 0
buffer_load_dwordx4 v6, s[12:15], s37 offen lds
s_add_u32 s37, s39, 829440
s_add_u32 m0, s38, 11264
s_nop 0
buffer_load_dwordx4 v6, s[12:15], s37 offen lds
s_waitcnt vmcnt(12)
ds_read_b64_tr_b16 v[224:225], v7 offset:16384
ds_read_b64_tr_b16 v[226:227], v7 offset:16640
ds_read_b64_tr_b16 v[228:229], v7 offset:18432
ds_read_b64_tr_b16 v[230:231], v7 offset:18688
ds_read_b64_tr_b16 a[40:41], v7 offset:16416
ds_read_b64_tr_b16 a[42:43], v7 offset:16672
ds_read_b64_tr_b16 a[44:45], v7 offset:18464
ds_read_b64_tr_b16 a[46:47], v7 offset:18720
s_waitcnt lgkmcnt(0)
s_add_u32 s37, s39, 884736
s_add_u32 m0, s38, 12288
s_nop 0
buffer_load_dwordx4 v6, s[12:15], s37 offen lds
s_add_u32 s37, s39, 940032
s_add_u32 m0, s38, 13312
s_nop 0
buffer_load_dwordx4 v6, s[12:15], s37 offen lds
s_add_u32 s37, s39, 995328
s_add_u32 m0, s38, 14336
s_nop 0
buffer_load_dwordx4 v6, s[12:15], s37 offen lds
s_add_u32 s37, s39, 1050624
s_add_u32 m0, s38, 15360
s_nop 0
buffer_load_dwordx4 v6, s[12:15], s37 offen lds
s_waitcnt vmcnt(12)
ds_read_b64_tr_b16 v[232:233], v7 offset:0
ds_read_b64_tr_b16 v[234:235], v7 offset:256
ds_read_b64_tr_b16 v[236:237], v7 offset:2048
ds_read_b64_tr_b16 v[238:239], v7 offset:2304
ds_read_b64_tr_b16 a[48:49], v7 offset:32
ds_read_b64_tr_b16 a[50:51], v7 offset:288
ds_read_b64_tr_b16 a[52:53], v7 offset:2080
ds_read_b64_tr_b16 a[54:55], v7 offset:2336
s_waitcnt lgkmcnt(0)
s_add_u32 s37, s39, 1105920
s_add_u32 m0, s38, 16384
s_nop 0
buffer_load_dwordx4 v6, s[12:15], s37 offen lds
s_add_u32 s37, s39, 1161216
s_add_u32 m0, s38, 17408
s_nop 0
buffer_load_dwordx4 v6, s[12:15], s37 offen lds
s_add_u32 s37, s39, 1216512
s_add_u32 m0, s38, 18432
s_nop 0
buffer_load_dwordx4 v6, s[12:15], s37 offen lds
s_add_u32 s37, s39, 1271808
s_add_u32 m0, s38, 19456
s_nop 0
buffer_load_dwordx4 v6, s[12:15], s37 offen lds
s_waitcnt vmcnt(12)
ds_read_b64_tr_b16 v[240:241], v7 offset:4096
ds_read_b64_tr_b16 v[242:243], v7 offset:4352
ds_read_b64_tr_b16 v[244:245], v7 offset:6144
ds_read_b64_tr_b16 v[246:247], v7 offset:6400
ds_read_b64_tr_b16 a[56:57], v7 offset:4128
ds_read_b64_tr_b16 a[58:59], v7 offset:4384
ds_read_b64_tr_b16 a[60:61], v7 offset:6176
ds_read_b64_tr_b16 a[62:63], v7 offset:6432
s_waitcnt lgkmcnt(0)
s_add_u32 s37, s39, 1327104
s_add_u32 m0, s38, 0
s_nop 0
buffer_load_dwordx4 v6, s[12:15], s37 offen lds
s_add_u32 s37, s39, 1382400
s_add_u32 m0, s38, 1024
s_nop 0
buffer_load_dwordx4 v6, s[12:15], s37 offen lds
s_add_u32 s37, s39, 1437696
s_add_u32 m0, s38, 2048
s_nop 0
buffer_load_dwordx4 v6, s[12:15], s37 offen lds
s_add_u32 s37, s39, 1492992
s_add_u32 m0, s38, 3072
s_nop 0
buffer_load_dwordx4 v6, s[12:15], s37 offen lds
s_waitcnt vmcnt(12)
ds_read_b64_tr_b16 v[248:249], v7 offset:8192
ds_read_b64_tr_b16 v[250:251], v7 offset:8448
ds_read_b64_tr_b16 v[252:253], v7 offset:10240
ds_read_b64_tr_b16 v[254:255], v7 offset:10496
ds_read_b64_tr_b16 a[64:65], v7 offset:8224
ds_read_b64_tr_b16 a[66:67], v7 offset:8480
ds_read_b64_tr_b16 a[68:69], v7 offset:10272
ds_read_b64_tr_b16 a[70:71], v7 offset:10528
s_waitcnt lgkmcnt(0)
s_add_u32 s37, s39, 1548288
s_add_u32 m0, s38, 4096
s_nop 0
buffer_load_dwordx4 v6, s[12:15], s37 offen lds
s_add_u32 s37, s39, 1603584
s_add_u32 m0, s38, 5120
s_nop 0
buffer_load_dwordx4 v6, s[12:15], s37 offen lds
s_add_u32 s37, s39, 1658880
s_add_u32 m0, s38, 6144
s_nop 0
buffer_load_dwordx4 v6, s[12:15], s37 offen lds
s_add_u32 s37, s39, 1714176
s_add_u32 m0, s38, 7168
s_nop 0
buffer_load_dwordx4 v6, s[12:15], s37 offen lds
s_waitcnt vmcnt(12)
ds_read_b64_tr_b16 a[0:1], v7 offset:12288
ds_read_b64_tr_b16 a[2:3], v7 offset:12544
ds_read_b64_tr_b16 a[4:5], v7 offset:14336
ds_read_b64_tr_b16 a[6:7], v7 offset:14592
ds_read_b64_tr_b16 a[72:73], v7 offset:12320
ds_read_b64_tr_b16 a[74:75], v7 offset:12576
ds_read_b64_tr_b16 a[76:77], v7 offset:14368
ds_read_b64_tr_b16 a[78:79], v7 offset:14624
s_waitcnt lgkmcnt(0)
s_add_u32 s37, s39, 1769472
s_add_u32 m0, s38, 8192
s_nop 0
buffer_load_dwordx4 v6, s[12:15], s37 offen lds
s_add_u32 s37, s39, 1824768
s_add_u32 m0, s38, 9216
s_nop 0
buffer_load_dwordx4 v6, s[12:15], s37 offen lds
s_add_u32 s37, s39, 1880064
s_add_u32 m0, s38, 10240
s_nop 0
buffer_load_dwordx4 v6, s[12:15], s37 offen lds
s_add_u32 s37, s39, 1935360
s_add_u32 m0, s38, 11264
s_nop 0
buffer_load_dwordx4 v6, s[12:15], s37 offen lds
s_waitcnt vmcnt(12)
ds_read_b64_tr_b16 a[8:9], v7 offset:16384
ds_read_b64_tr_b16 a[10:11], v7 offset:16640
ds_read_b64_tr_b16 a[12:13], v7 offset:18432
ds_read_b64_tr_b16 a[14:15], v7 offset:18688
ds_read_b64_tr_b16 a[80:81], v7 offset:16416
ds_read_b64_tr_b16 a[82:83], v7 offset:16672
ds_read_b64_tr_b16 a[84:85], v7 offset:18464
ds_read_b64_tr_b16 a[86:87], v7 offset:18720
s_waitcnt lgkmcnt(0)
s_waitcnt vmcnt(8)
ds_read_b64_tr_b16 a[16:17], v7 offset:0
ds_read_b64_tr_b16 a[18:19], v7 offset:256
ds_read_b64_tr_b16 a[20:21], v7 offset:2048
ds_read_b64_tr_b16 a[22:23], v7 offset:2304
ds_read_b64_tr_b16 a[88:89], v7 offset:32
ds_read_b64_tr_b16 a[90:91], v7 offset:288
ds_read_b64_tr_b16 a[92:93], v7 offset:2080
ds_read_b64_tr_b16 a[94:95], v7 offset:2336
s_waitcnt lgkmcnt(0)
s_waitcnt vmcnt(4)
ds_read_b64_tr_b16 a[24:25], v7 offset:4096
ds_read_b64_tr_b16 a[26:27], v7 offset:4352
ds_read_b64_tr_b16 a[28:29], v7 offset:6144
ds_read_b64_tr_b16 a[30:31], v7 offset:6400
ds_read_b64_tr_b16 a[96:97], v7 offset:4128
ds_read_b64_tr_b16 a[98:99], v7 offset:4384
ds_read_b64_tr_b16 a[100:101], v7 offset:6176
ds_read_b64_tr_b16 a[102:103], v7 offset:6432
s_waitcnt lgkmcnt(0)
s_waitcnt vmcnt(0)
ds_read_b64_tr_b16 a[32:33], v7 offset:8192
ds_read_b64_tr_b16 a[34:35], v7 offset:8448
ds_read_b64_tr_b16 a[36:37], v7 offset:10240
ds_read_b64_tr_b16 a[38:39], v7 offset:10496
ds_read_b64_tr_b16 a[104:105], v7 offset:8224
ds_read_b64_tr_b16 a[106:107], v7 offset:8480
ds_read_b64_tr_b16 a[108:109], v7 offset:10272
ds_read_b64_tr_b16 a[110:111], v7 offset:10528
s_waitcnt lgkmcnt(0)
s_cmp_lg_u32 s34, 3
s_cbranch_scc1 L_a_nogate
v_lshlrev_b32 v12, 4, v11
buffer_load_dwordx4 v[224:227], v12, s[64:67], 0 offen offset:0
buffer_load_dwordx4 v[228:231], v12, s[64:67], 0 offen offset:64
buffer_load_dwordx4 v[232:235], v12, s[64:67], 0 offen offset:128
buffer_load_dwordx4 v[236:239], v12, s[64:67], 0 offen offset:192
buffer_load_dwordx4 v[240:243], v12, s[64:67], 0 offen offset:256
buffer_load_dwordx4 v[244:247], v12, s[64:67], 0 offen offset:320
buffer_load_dwordx4 v[248:251], v12, s[64:67], 0 offen offset:384
buffer_load_dwordx4 v[252:255], v12, s[64:67], 0 offen offset:448
buffer_load_dwordx4 a[0:3], v12, s[64:67], 0 offen offset:512
buffer_load_dwordx4 a[4:7], v12, s[64:67], 0 offen offset:576
buffer_load_dwordx4 a[8:11], v12, s[64:67], 0 offen offset:640
buffer_load_dwordx4 a[12:15], v12, s[64:67], 0 offen offset:704
buffer_load_dwordx4 a[16:19], v12, s[64:67], 0 offen offset:768
buffer_load_dwordx4 a[20:23], v12, s[64:67], 0 offen offset:832
buffer_load_dwordx4 a[24:27], v12, s[64:67], 0 offen offset:896
buffer_load_dwordx4 a[28:31], v12, s[64:67], 0 offen offset:960
buffer_load_dwordx4 a[32:35], v12, s[64:67], 0 offen offset:1024
buffer_load_dwordx4 a[36:39], v12, s[64:67], 0 offen offset:1088
L_a_nogate:
s_mov_b32 s43, s40
s_mov_b32 s35, 0
s_mov_b32 s50, 36864
.p2align 6
L_a_loop:
s_waitcnt vmcnt(0)
s_barrier
s_add_u32 s43, s43, 36864
s_add_u32 s44, s44, s50
ds_read_b128 v[64:67], v3 offset:0
ds_read_b128 v[68:71], v3 offset:1024
ds_read_b128 v[72:75], v3 offset:2048
ds_read_b128 v[76:79], v3 offset:3072
s_waitcnt lgkmcnt(2)
v_mfma_f32_16x16x32_bf16 v[16:19], v[80:83], v[64:67], 0
v_mfma_f32_16x16x32_bf16 v[20:23], v[80:83], v[68:71], 0
v_mfma_f32_16x16x32_bf16 v[24:27], v[152:155], v[64:67], 0
v_mfma_f32_16x16x32_bf16 v[28:31], v[152:155], v[68:71], 0
s_add_u32 s37, s43, 0
s_add_u32 m0, s44, 0
s_nop 0
buffer_load_dwordx4 v2, s[8:11], s37 offen lds
v_mfma_f32_16x16x32_bf16 v[32:35], v[224:227], v[64:67], 0
v_mfma_f32_16x16x32_bf16 v[36:39], v[224:227], v[68:71], 0
v_mfma_f32_16x16x32_bf16 v[40:43], a[40:43], v[64:67], 0
v_mfma_f32_16x16x32_bf16 v[44:47], a[40:43], v[68:71], 0
ds_read_b128 v[64:67], v3 offset:4096
ds_read_b128 v[68:71], v3 offset:5120
s_waitcnt lgkmcnt(2)
v_mfma_f32_16x16x32_bf16 v[16:19], v[84:87], v[72:75], v[16:19]
v_mfma_f32_16x16x32_bf16 v[20:23], v[84:87], v[76:79], v[20:23]
v_mfma_f32_16x16x32_bf16 v[24:27], v[156:159], v[72:75], v[24:27]
v_mfma_f32_16x16x32_bf16 v[28:31], v[156:159], v[76:79], v[28:31]
s_add_u32 s37, s43, 128
s_add_u32 m0, s44, 4096
s_nop 0
buffer_load_dwordx4 v2, s[8:11], s37 offen lds
v_mfma_f32_16x16x32_bf16 v[32:35], v[228:231], v[72:75], v[32:35]
v_mfma_f32_16x16x32_bf16 v[36:39], v[228:231], v[76:79], v[36:39]
v_mfma_f32_16x16x32_bf16 v[40:43], a[44:47], v[72:75], v[40:43]
v_mfma_f32_16x16x32_bf16 v[44:47], a[44:47], v[76:79], v[44:47]
ds_read_b128 v[72:75], v3 offset:6144
ds_read_b128 v[76:79], v3 offset:7168
s_waitcnt lgkmcnt(2)
v_mfma_f32_16x16x32_bf16 v[16:19], v[88:91], v[64:67], v[16:19]
v_mfma_f32_16x16x32_bf16 v[20:23], v[88:91], v[68:71], v[20:23]
v_mfma_f32_16x16x32_bf16 v[24:27], v[160:163], v[64:67], v[24:27]
v_mfma_f32_16x16x32_bf16 v[28:31], v[160:163], v[68:71], v[28:31]
s_add_u32 s37, s43, 256
s_add_u32 m0, s44, 8192
s_nop 0
buffer_load_dwordx4 v2, s[8:11], s37 offen lds
v_mfma_f32_16x16x32_bf16 v[32:35], v[232:235], v[64:67], v[32:35]
v_mfma_f32_16x16x32_bf16 v[36:39], v[232:235], v[68:71], v[36:39]
v_mfma_f32_16x16x32_bf16 v[40:43], a[48:51], v[64:67], v[40:43]
v_mfma_f32_16x16x32_bf16 v[44:47], a[48:51], v[68:71], v[44:47]
ds_read_b128 v[64:67], v3 offset:8192
ds_read_b128 v[68:71], v3 offset:9216
s_waitcnt lgkmcnt(2)
v_mfma_f32_16x16x32_bf16 v[16:19], v[92:95], v[72:75], v[16:19]
v_mfma_f32_16x16x32_bf16 v[20:23], v[92:95], v[76:79], v[20:23]
v_mfma_f32_16x16x32_bf16 v[24:27], v[164:167], v[72:75], v[24:27]
v_mfma_f32_16x16x32_bf16 v[28:31], v[164:167], v[76:79], v[28:31]
s_add_u32 s37, s43, 384
s_add_u32 m0, s44, 12288
s_nop 0
buffer_load_dwordx4 v2, s[8:11], s37 offen lds
v_mfma_f32_16x16x32_bf16 v[32:35], v[236:239], v[72:75], v[32:35]
v_mfma_f32_16x16x32_bf16 v[36:39], v[236:239], v[76:79], v[36:39]
v_mfma_f32_16x16x32_bf16 v[40:43], a[52:55], v[72:75], v[40:43]
v_mfma_f32_16x16x32_bf16 v[44:47], a[52:55], v[76:79], v[44:47]
ds_read_b128 v[72:75], v3 offset:10240
ds_read_b128 v[76:79], v3 offset:11264
s_waitcnt lgkmcnt(2)
v_mfma_f32_16x16x32_bf16 v[16:19], v[96:99], v[64:67], v[16:19]
v_mfma_f32_16x16x32_bf16 v[20:23], v[96:99], v[68:71], v[20:23]
v_mfma_f32_16x16x32_bf16 v[24:27], v[168:171], v[64:67], v[24:27]
v_mfma_f32_16x16x32_bf16 v[28:31], v[168:171], v[68:71], v[28:31]
s_add_u32 s37, s43, 512
s_add_u32 m0, s44, 16384
s_nop 0
buffer_load_dwordx4 v2, s[8:11], s37 offen lds
v_mfma_f32_16x16x32_bf16 v[32:35], v[240:243], v[64:67], v[32:35]
v_mfma_f32_16x16x32_bf16 v[36:39], v[240:243], v[68:71], v[36:39]
v_mfma_f32_16x16x32_bf16 v[40:43], a[56:59], v[64:67], v[40:43]
v_mfma_f32_16x16x32_bf16 v[44:47], a[56:59], v[68:71], v[44:47]
ds_read_b128 v[64:67], v3 offset:12288
ds_read_b128 v[68:71], v3 offset:13312
s_waitcnt lgkmcnt(2)
v_mfma_f32_16x16x32_bf16 v[16:19], v[100:103], v[72:75], v[16:19]
v_mfma_f32_16x16x32_bf16 v[20:23], v[100:103], v[76:79], v[20:23]
v_mfma_f32_16x16x32_bf16 v[24:27], v[172:175], v[72:75], v[24:27]
v_mfma_f32_16x16x32_bf16 v[28:31], v[172:175], v[76:79], v[28:31]
s_add_u32 s37, s43, 640
s_add_u32 m0, s44, 20480
s_nop 0
buffer_load_dwordx4 v2, s[8:11], s37 offen lds
v_mfma_f32_16x16x32_bf16 v[32:35], v[244:247], v[72:75], v[32:35]
v_mfma_f32_16x16x32_bf16 v[36:39], v[244:247], v[76:79], v[36:39]
v_mfma_f32_16x16x32_bf16 v[40:43], a[60:63], v[72:75], v[40:43]
v_mfma_f32_16x16x32_bf16 v[44:47], a[60:63], v[76:79], v[44:47]
ds_read_b128 v[72:75], v3 offset:14336
ds_read_b128 v[76:79], v3 offset:15360
s_waitcnt lgkmcnt(2)
v_mfma_f32_16x16x32_bf16 v[16:19], v[104:107], v[64:67], v[16:19]
v_mfma_f32_16x16x32_bf16 v[20:23], v[104:107], v[68:71], v[20:23]
v_mfma_f32_16x16x32_bf16 v[24:27], v[176:179], v[64:67], v[24:27]
v_mfma_f32_16x16x32_bf16 v[28:31], v[176:179], v[68:71], v[28:31]
s_add_u32 s37, s43, 768
s_add_u32 m0, s44, 24576
s_nop 0
buffer_load_dwordx4 v2, s[8:11], s37 offen lds
v_mfma_f32_16x16x32_bf16 v[32:35], v[248:251], v[64:67], v[32:35]
v_mfma_f32_16x16x32_bf16 v[36:39], v[248:251], v[68:71], v[36:39]
v_mfma_f32_16x16x32_bf16 v[40:43], a[64:67], v[64:67], v[40:43]
v_mfma_f32_16x16x32_bf16 v[44:47], a[64:67], v[68:71], v[44:47]
ds_read_b128 v[64:67], v3 offset:16384
ds_read_b128 v[68:71], v3 offset:17408
s_waitcnt lgkmcnt(2)
v_mfma_f32_16x16x32_bf16 v[16:19], v[108:111], v[72:75], v[16:19]
v_mfma_f32_16x16x32_bf16 v[20:23], v[108:111], v[76:79], v[20:23]
v_mfma_f32_16x16x32_bf16 v[24:27], v[180:183], v[72:75], v[24:27]
v_mfma_f32_16x16x32_bf16 v[28:31], v[180:183], v[76:79], v[28:31]
s_add_u32 s37, s43, 896
s_add_u32 m0, s44, 28672
s_nop 0
buffer_load_dwordx4 v2, s[8:11], s37 offen lds
v_mfma_f32_16x16x32_bf16 v[32:35], v[252:255], v[72:75], v[32:35]
v_mfma_f32_16x16x32_bf16 v[36:39], v[252:255], v[76:79], v[36:39]
v_mfma_f32_16x16x32_bf16 v[40:43], a[68:71], v[72:75], v[40:43]
v_mfma_f32_16x16x32_bf16 v[44:47], a[68:71], v[76:79], v[44:47]
ds_read_b128 v[72:75], v3 offset:18432
ds_read_b128 v[76:79], v3 offset:19456
s_waitcnt lgkmcnt(2)
v_mfma_f32_16x16x32_bf16 v[16:19], v[112:115], v[64:67], v[16:19]
v_mfma_f32_16x16x32_bf16 v[20:23], v[112:115], v[68:71], v[20:23]
v_mfma_f32_16x16x32_bf16 v[24:27], v[184:187], v[64:67], v[24:27]
v_mfma_f32_16x16x32_bf16 v[28:31], v[184:187], v[68:71], v[28:31]
s_add_u32 s37, s43, 1024
s_add_u32 m0, s44, 32768
s_nop 0
buffer_load_dwordx4 v2, s[8:11], s37 offen lds
v_mfma_f32_16x16x32_bf16 v[32:35], a[0:3], v[64:67], v[32:35]
v_mfma_f32_16x16x32_bf16 v[36:39], a[0:3], v[68:71], v[36:39]
v_mfma_f32_16x16x32_bf16 v[40:43], a[72:75], v[64:67], v[40:43]
v_mfma_f32_16x16x32_bf16 v[44:47], a[72:75], v[68:71], v[44:47]
ds_read_b128 v[64:67], v3 offset:20480
ds_read_b128 v[68:71], v3 offset:21504
s_waitcnt lgkmcnt(2)
v_mfma_f32_16x16x32_bf16 v[16:19], v[116:119], v[72:75], v[16:19]
v_mfma_f32_16x16x32_bf16 v[20:23], v[116:119], v[76:79], v[20:23]
v_mfma_f32_16x16x32_bf16 v[24:27], v[188:191], v[72:75], v[24:27]
v_mfma_f32_16x16x32_bf16 v[28:31], v[188:191], v[76:79], v[28:31]
v_mfma_f32_16x16x32_bf16 v[32:35], a[4:7], v[72:75], v[32:35]
v_mfma_f32_16x16x32_bf16 v[36:39], a[4:7], v[76:79], v[36:39]
v_mfma_f32_16x16x32_bf16 v[40:43], a[76:79], v[72:75], v[40:43]
v_mfma_f32_16x16x32_bf16 v[44:47], a[76:79], v[76:79], v[44:47]
ds_read_b128 v[72:75], v3 offset:22528
ds_read_b128 v[76:79], v3 offset:23552
s_waitcnt lgkmcnt(2)
v_mfma_f32_16x16x32_bf16 v[16:19], v[120:123], v[64:67], v[16:19]
v_mfma_f32_16x16x32_bf16 v[20:23], v[120:123], v[68:71], v[20:23]
v_mfma_f32_16x16x32_bf16 v[24:27], v[192:195], v[64:67], v[24:27]
v_mfma_f32_16x16x32_bf16 v[28:31], v[192:195], v[68:71], v[28:31]
v_mfma_f32_16x16x32_bf16 v[32:35], a[8:11], v[64:67], v[32:35]
v_mfma_f32_16x16x32_bf16 v[36:39], a[8:11], v[68:71], v[36:39]
v_mfma_f32_16x16x32_bf16 v[40:43], a[80:83], v[64:67], v[40:43]
v_mfma_f32_16x16x32_bf16 v[44:47], a[80:83], v[68:71], v[44:47]
ds_read_b128 v[64:67], v3 offset:24576
ds_read_b128 v[68:71], v3 offset:25600
s_waitcnt lgkmcnt(2)
v_mfma_f32_16x16x32_bf16 v[16:19], v[124:127], v[72:75], v[16:19]
v_mfma_f32_16x16x32_bf16 v[20:23], v[124:127], v[76:79], v[20:23]
v_mfma_f32_16x16x32_bf16 v[24:27], v[196:199], v[72:75], v[24:27]
v_mfma_f32_16x16x32_bf16 v[28:31], v[196:199], v[76:79], v[28:31]
v_mfma_f32_16x16x32_bf16 v[32:35], a[12:15], v[72:75], v[32:35]
v_mfma_f32_16x16x32_bf16 v[36:39], a[12:15], v[76:79], v[36:39]
v_mfma_f32_16x16x32_bf16 v[40:43], a[84:87], v[72:75], v[40:43]
v_mfma_f32_16x16x32_bf16 v[44:47], a[84:87], v[76:79], v[44:47]
ds_read_b128 v[72:75], v3 offset:26624
ds_read_b128 v[76:79], v3 offset:27648
s_waitcnt lgkmcnt(2)
v_mfma_f32_16x16x32_bf16 v[16:19], v[128:131], v[64:67], v[16:19]
v_mfma_f32_16x16x32_bf16 v[20:23], v[128:131], v[68:71], v[20:23]
v_mfma_f32_16x16x32_bf16 v[24:27], v[200:203], v[64:67], v[24:27]
v_mfma_f32_16x16x32_bf16 v[28:31], v[200:203], v[68:71], v[28:31]
v_mfma_f32_16x16x32_bf16 v[32:35], a[16:19], v[64:67], v[32:35]
v_mfma_f32_16x16x32_bf16 v[36:39], a[16:19], v[68:71], v[36:39]
v_mfma_f32_16x16x32_bf16 v[40:43], a[88:91], v[64:67], v[40:43]
v_mfma_f32_16x16x32_bf16 v[44:47], a[88:91], v[68:71], v[44:47]
ds_read_b128 v[64:67], v3 offset:28672
ds_read_b128 v[68:71], v3 offset:29696
s_waitcnt lgkmcnt(2)
v_mfma_f32_16x16x32_bf16 v[16:19], v[132:135], v[72:75], v[16:19]
v_mfma_f32_16x16x32_bf16 v[20:23], v[132:135], v[76:79], v[20:23]
v_mfma_f32_16x16x32_bf16 v[24:27], v[204:207], v[72:75], v[24:27]
v_mfma_f32_16x16x32_bf16 v[28:31], v[204:207], v[76:79], v[28:31]
v_mfma_f32_16x16x32_bf16 v[32:35], a[20:23], v[72:75], v[32:35]
v_mfma_f32_16x16x32_bf16 v[36:39], a[20:23], v[76:79], v[36:39]
v_mfma_f32_16x16x32_bf16 v[40:43], a[92:95], v[72:75], v[40:43]
v_mfma_f32_16x16x32_bf16 v[44:47], a[92:95], v[76:79], v[44:47]
ds_read_b128 v[72:75], v3 offset:30720
ds_read_b128 v[76:79], v3 offset:31744
s_waitcnt lgkmcnt(2)
v_mfma_f32_16x16x32_bf16 v[16:19], v[136:139], v[64:67], v[16:19]
v_mfma_f32_16x16x32_bf16 v[20:23], v[136:139], v[68:71], v[20:23]
v_mfma_f32_16x16x32_bf16 v[24:27], v[208:211], v[64:67], v[24:27]
v_mfma_f32_16x16x32_bf16 v[28:31], v[208:211], v[68:71], v[28:31]
v_mfma_f32_16x16x32_bf16 v[32:35], a[24:27], v[64:67], v[32:35]
v_mfma_f32_16x16x32_bf16 v[36:39], a[24:27], v[68:71], v[36:39]
v_mfma_f32_16x16x32_bf16 v[40:43], a[96:99], v[64:67], v[40:43]
v_mfma_f32_16x16x32_bf16 v[44:47], a[96:99], v[68:71], v[44:47]
ds_read_b128 v[64:67], v3 offset:32768
ds_read_b128 v[68:71], v3 offset:33792
s_waitcnt lgkmcnt(2)
v_mfma_f32_16x16x32_bf16 v[16:19], v[140:143], v[72:75], v[16:19]
v_mfma_f32_16x16x32_bf16 v[20:23], v[140:143], v[76:79], v[20:23]
v_mfma_f32_16x16x32_bf16 v[24:27], v[212:215], v[72:75], v[24:27]
v_mfma_f32_16x16x32_bf16 v[28:31], v[212:215], v[76:79], v[28:31]
v_mfma_f32_16x16x32_bf16 v[32:35], a[28:31], v[72:75], v[32:35]
v_mfma_f32_16x16x32_bf16 v[36:39], a[28:31], v[76:79], v[36:39]
v_mfma_f32_16x16x32_bf16 v[40:43], a[100:103], v[72:75], v[40:43]
v_mfma_f32_16x16x32_bf16 v[44:47], a[100:103], v[76:79], v[44:47]
ds_read_b128 v[72:75], v3 offset:34816
ds_read_b128 v[76:79], v3 offset:35840
s_waitcnt lgkmcnt(2)
v_mfma_f32_16x16x32_bf16 v[16:19], v[144:147], v[64:67], v[16:19]
v_mfma_f32_16x16x32_bf16 v[20:23], v[144:147], v[68:71], v[20:23]
v_mfma_f32_16x16x32_bf16 v[24:27], v[216:219], v[64:67], v[24:27]
v_mfma_f32_16x16x32_bf16 v[28:31], v[216:219], v[68:71], v[28:31]
v_mfma_f32_16x16x32_bf16 v[32:35], a[32:35], v[64:67], v[32:35]
v_mfma_f32_16x16x32_bf16 v[36:39], a[32:35], v[68:71], v[36:39]
v_mfma_f32_16x16x32_bf16 v[40:43], a[104:107], v[64:67], v[40:43]
v_mfma_f32_16x16x32_bf16 v[44:47], a[104:107], v[68:71], v[44:47]
s_waitcnt lgkmcnt(0)
v_mfma_f32_16x16x32_bf16 v[16:19], v[148:151], v[72:75], v[16:19]
v_mfma_f32_16x16x32_bf16 v[20:23], v[148:151], v[76:79], v[20:23]
v_mfma_f32_16x16x32_bf16 v[24:27], v[220:223], v[72:75], v[24:27]
v_mfma_f32_16x16x32_bf16 v[28:31], v[220:223], v[76:79], v[28:31]
v_mfma_f32_16x16x32_bf16 v[32:35], a[36:39], v[72:75], v[32:35]
v_mfma_f32_16x16x32_bf16 v[36:39], a[36:39], v[76:79], v[36:39]
v_mfma_f32_16x16x32_bf16 v[40:43], a[108:111], v[72:75], v[40:43]
v_mfma_f32_16x16x32_bf16 v[44:47], a[108:111], v[76:79], v[44:47]
v_add_u32 v3, s50, v3
s_sub_u32 s50, 0, s50
v_cvt_pk_bf16_f32 v16, v16, v17
v_cvt_pk_bf16_f32 v17, v18, v19
ds_write_b64 v4, v[16:17] offset:0
v_cvt_pk_bf16_f32 v20, v20, v21
v_cvt_pk_bf16_f32 v21, v22, v23
ds_write_b64 v4, v[20:21] offset:7296
v_cvt_pk_bf16_f32 v24, v24, v25
v_cvt_pk_bf16_f32 v25, v26, v27
ds_write_b64 v4, v[24:25] offset:32
v_cvt_pk_bf16_f32 v28, v28, v29
v_cvt_pk_bf16_f32 v29, v30, v31
ds_write_b64 v4, v[28:29] offset:7328
s_cmp_eq_u32 s34, 3
s_cbranch_scc1 L_a_gate
v_cvt_pk_bf16_f32 v32, v32, v33
v_cvt_pk_bf16_f32 v33, v34, v35
ds_write_b64 v4, v[32:33] offset:64
v_cvt_pk_bf16_f32 v36, v36, v37
v_cvt_pk_bf16_f32 v37, v38, v39
ds_write_b64 v4, v[36:37] offset:7360
v_cvt_pk_bf16_f32 v40, v40, v41
v_cvt_pk_bf16_f32 v41, v42, v43
ds_write_b64 v4, v[40:41] offset:96
v_cvt_pk_bf16_f32 v44, v44, v45
v_cvt_pk_bf16_f32 v45, v46, v47
ds_write_b64 v4, v[44:45] offset:7392
s_branch L_a_nog2
L_a_gate:
ds_write_b32 v14, v32
ds_write_b32 v14, v36 offset:64
L_a_nog2:
v_add_u32 v4, 14592, v4
v_add_u32 v14, 128, v14
s_add_u32 s35, s35, 1
s_cmp_lt_u32 s35, 6
s_cbranch_scc1 L_a_loop
s_waitcnt vmcnt(0) lgkmcnt(0)
s_barrier
s_mov_b32 s35, 0
s_mul_i32 s39, s34, 36
s_add_u32 s39, s39, 73728
s_mul_i32 s40, s33, 176
s_mov_b32 s41, 0x3eae1a93
s_mov_b32 s42, 0xbfb8aa3b
L_la_loop:
v_add_u32 v12, s35, v9
v_min_u32 v12, 175, v12
v_add_u32 v2, s40, v12
v_add_u32 v12, 16, v12
v_mul_u32_u24 v14, 456, v12
v_add_u32 v14, s39, v14
v_lshlrev_b32 v12, 2, v12
v_add_u32 v12, 161280, v12
ds_read_b32 v3, v12
ds_read2_b32 v[16:17], v14 offset0:0 offset1:1
ds_read2_b32 v[18:19], v14 offset0:2 offset1:3
ds_read2_b32 v[20:21], v14 offset0:4 offset1:5
ds_read2_b32 v[22:23], v14 offset0:6 offset1:7
ds_read_b32 v24, v14 offset:32
v_subrev_u32 v15, 0, v14
ds_read2_b32 v[26:27], v15 offset0:36 offset1:37
ds_read2_b32 v[28:29], v15 offset0:38 offset1:39
ds_read2_b32 v[30:31], v15 offset0:40 offset1:41
ds_read2_b32 v[32:33], v15 offset0:42 offset1:43
ds_read_b32 v34, v15 offset:176
v_subrev_u32 v15, 912, v14
ds_read2_b32 v[36:37], v15 offset0:36 offset1:37
ds_read2_b32 v[38:39], v15 offset0:38 offset1:39
ds_read2_b32 v[40:41], v15 offset0:40 offset1:41
ds_read2_b32 v[42:43], v15 offset0:42 offset1:43
ds_read_b32 v44, v15 offset:176
s_waitcnt lgkmcnt(5)
v_dot2_f32_bf16 v176, v16, v26, 0
v_dot2_f32_bf16 v176, v17, v27, v176
v_dot2_f32_bf16 v176, v18, v28, v176
v_dot2_f32_bf16 v176, v19, v29, v176
v_dot2_f32_bf16 v176, v20, v30, v176
v_dot2_f32_bf16 v176, v21, v31, v176
v_dot2_f32_bf16 v176, v22, v32, v176
v_dot2_f32_bf16 v176, v23, v33, v176
v_dot2_f32_bf16 v176, v24, v34, v176
v_subrev_u32 v15, 1824, v14
ds_read2_b32 v[46:47], v15 offset0:36 offset1:37
ds_read2_b32 v[48:49], v15 offset0:38 offset1:39
ds_read2_b32 v[50:51], v15 offset0:40 offset1:41
ds_read2_b32 v[52:53], v15 offset0:42 offset1:43
ds_read_b32 v54, v15 offset:176
s_waitcnt lgkmcnt(5)
v_dot2_f32_bf16 v177, v16, v36, 0
v_dot2_f32_bf16 v177, v17, v37, v177
v_dot2_f32_bf16 v177, v18, v38, v177
v_dot2_f32_bf16 v177, v19, v39, v177
v_dot2_f32_bf16 v177, v20, v40, v177
v_dot2_f32_bf16 v177, v21, v41, v177
v_dot2_f32_bf16 v177, v22, v42, v177
v_dot2_f32_bf16 v177, v23, v43, v177
v_dot2_f32_bf16 v177, v24, v44, v177
v_subrev_u32 v15, 2736, v14
ds_read2_b32 v[56:57], v15 offset0:36 offset1:37
ds_read2_b32 v[58:59], v15 offset0:38 offset1:39
ds_read2_b32 v[60:61], v15 offset0:40 offset1:41
ds_read2_b32 v[62:63], v15 offset0:42 offset1:43
ds_read_b32 v64, v15 offset:176
s_waitcnt lgkmcnt(5)
v_dot2_f32_bf16 v178, v16, v46, 0
v_dot2_f32_bf16 v178, v17, v47, v178
v_dot2_f32_bf16 v178, v18, v48, v178
v_dot2_f32_bf16 v178, v19, v49, v178
v_dot2_f32_bf16 v178, v20, v50, v178
v_dot2_f32_bf16 v178, v21, v51, v178
v_dot2_f32_bf16 v178, v22, v52, v178
v_dot2_f32_bf16 v178, v23, v53, v178
v_dot2_f32_bf16 v178, v24, v54, v178
v_subrev_u32 v15, 3648, v14
ds_read2_b32 v[26:27], v15 offset0:36 offset1:37
ds_read2_b32 v[28:29], v15 offset0:38 offset1:39
ds_read2_b32 v[30:31], v15 offset0:40 offset1:41
ds_read2_b32 v[32:33], v15 offset0:42 offset1:43
ds_read_b32 v34, v15 offset:176
s_waitcnt lgkmcnt(5)
v_dot2_f32_bf16 v179, v16, v56, 0
v_dot2_f32_bf16 v179, v17, v57, v179
v_dot2_f32_bf16 v179, v18, v58, v179
v_dot2_f32_bf16 v179, v19, v59, v179
v_dot2_f32_bf16 v179, v20, v60, v179
v_dot2_f32_bf16 v179, v21, v61, v179
v_dot2_f32_bf16 v179, v22, v62, v179
v_dot2_f32_bf16 v179, v23, v63, v179
v_dot2_f32_bf16 v179, v24, v64, v179
v_subrev_u32 v15, 4560, v14
ds_read2_b32 v[36:37], v15 offset0:36 offset1:37
ds_read2_b32 v[38:39], v15 offset0:38 offset1:39
ds_read2_b32 v[40:41], v15 offset0:40 offset1:41
ds_read2_b32 v[42:43], v15 offset0:42 offset1:43
ds_read_b32 v44, v15 offset:176
s_waitcnt lgkmcnt(5)
v_dot2_f32_bf16 v180, v16, v26, 0
v_dot2_f32_bf16 v180, v17, v27, v180
v_dot2_f32_bf16 v180, v18, v28, v180
v_dot2_f32_bf16 v180, v19, v29, v180
v_dot2_f32_bf16 v180, v20, v30, v180
v_dot2_f32_bf16 v180, v21, v31, v180
v_dot2_f32_bf16 v180, v22, v32, v180
v_dot2_f32_bf16 v180, v23, v33, v180
v_dot2_f32_bf16 v180, v24, v34, v180
v_subrev_u32 v15, 5472, v14
ds_read2_b32 v[46:47], v15 offset0:36 offset1:37
ds_read2_b32 v[48:49], v15 offset0:38 offset1:39
ds_read2_b32 v[50:51], v15 offset0:40 offset1:41
ds_read2_b32 v[52:53], v15 offset0:42 offset1:43
ds_read_b32 v54, v15 offset:176
s_waitcnt lgkmcnt(5)
v_dot2_f32_bf16 v181, v16, v36, 0
v_dot2_f32_bf16 v181, v17, v37, v181
v_dot2_f32_bf16 v181, v18, v38, v181
v_dot2_f32_bf16 v181, v19, v39, v181
v_dot2_f32_bf16 v181, v20, v40, v181
v_dot2_f32_bf16 v181, v21, v41, v181
v_dot2_f32_bf16 v181, v22, v42, v181
v_dot2_f32_bf16 v181, v23, v43, v181
v_dot2_f32_bf16 v181, v24, v44, v181
v_subrev_u32 v15, 6384, v14
ds_read2_b32 v[56:57], v15 offset0:36 offset1:37
ds_read2_b32 v[58:59], v15 offset0:38 offset1:39
ds_read2_b32 v[60:61], v15 offset0:40 offset1:41
ds_read2_b32 v[62:63], v15 offset0:42 offset1:43
ds_read_b32 v64, v15 offset:176
s_waitcnt lgkmcnt(5)
v_dot2_f32_bf16 v182, v16, v46, 0
v_dot2_f32_bf16 v182, v17, v47, v182
v_dot2_f32_bf16 v182, v18, v48, v182
v_dot2_f32_bf16 v182, v19, v49, v182
v_dot2_f32_bf16 v182, v20, v50, v182
v_dot2_f32_bf16 v182, v21, v51, v182
v_dot2_f32_bf16 v182, v22, v52, v182
v_dot2_f32_bf16 v182, v23, v53, v182
v_dot2_f32_bf16 v182, v24, v54, v182
s_waitcnt lgkmcnt(0)
v_dot2_f32_bf16 v183, v16, v56, 0
v_dot2_f32_bf16 v183, v17, v57, v183
v_dot2_f32_bf16 v183, v18, v58, v183
v_dot2_f32_bf16 v183, v19, v59, v183
v_dot2_f32_bf16 v183, v20, v60, v183
v_dot2_f32_bf16 v183, v21, v61, v183
v_dot2_f32_bf16 v183, v22, v62, v183
v_dot2_f32_bf16 v183, v23, v63, v183
v_dot2_f32_bf16 v183, v24, v64, v183
v_subrev_u32 v15, 0, v14
ds_read2_b32 v[100:101], v15 offset0:72 offset1:73
ds_read2_b32 v[102:103], v15 offset0:74 offset1:75
ds_read2_b32 v[104:105], v15 offset0:76 offset1:77
ds_read2_b32 v[106:107], v15 offset0:78 offset1:79
ds_read_b32 v108, v15 offset:320
v_subrev_u32 v15, 912, v14
ds_read2_b32 v[110:111], v15 offset0:72 offset1:73
ds_read2_b32 v[112:113], v15 offset0:74 offset1:75
ds_read2_b32 v[114:115], v15 offset0:76 offset1:77
ds_read2_b32 v[116:117], v15 offset0:78 offset1:79
ds_read_b32 v118, v15 offset:320
v_mov_b32 v13, 0xf149f2ca
v_mul_f32 v176, s41, v176
v_mul_f32 v177, s41, v177
v_mul_f32 v178, s41, v178
v_mul_f32 v179, s41, v179
v_mul_f32 v180, s41, v180
v_mul_f32 v181, s41, v181
v_mul_f32 v182, s41, v182
v_mul_f32 v183, s41, v183
v_cmp_le_u32 vcc, 2, v2
s_nop 1
v_cndmask_b32 v177, v13, v177, vcc
v_cmp_le_u32 vcc, 4, v2
s_nop 1
v_cndmask_b32 v178, v13, v178, vcc
v_cmp_le_u32 vcc, 6, v2
s_nop 1
v_cndmask_b32 v179, v13, v179, vcc
v_cmp_le_u32 vcc, 8, v2
s_nop 1
v_cndmask_b32 v180, v13, v180, vcc
v_cmp_le_u32 vcc, 10, v2
s_nop 1
v_cndmask_b32 v181, v13, v181, vcc
v_cmp_le_u32 vcc, 12, v2
s_nop 1
v_cndmask_b32 v182, v13, v182, vcc
v_cmp_le_u32 vcc, 14, v2
s_nop 1
v_cndmask_b32 v183, v13, v183, vcc
v_max3_f32 v12, v176, v177, v178
v_max3_f32 v12, v12, v179, v180
v_max3_f32 v12, v12, v181, v182
v_max_f32 v12, v12, v183
v_sub_f32 v176, v176, v12
v_sub_f32 v177, v177, v12
v_sub_f32 v178, v178, v12
v_sub_f32 v179, v179, v12
v_sub_f32 v180, v180, v12
v_sub_f32 v181, v181, v12
v_sub_f32 v182, v182, v12
v_sub_f32 v183, v183, v12
v_exp_f32 v176, v176
v_exp_f32 v177, v177
v_exp_f32 v178, v178
v_exp_f32 v179, v179
v_exp_f32 v180, v180
v_exp_f32 v181, v181
v_exp_f32 v182, v182
v_exp_f32 v183, v183
v_cvt_pk_bf16_f32 v204, v176, v8
v_cvt_pk_bf16_f32 v205, v177, v8
v_cvt_pk_bf16_f32 v206, v178, v8
v_cvt_pk_bf16_f32 v207, v179, v8
v_cvt_pk_bf16_f32 v208, v180, v8
v_cvt_pk_bf16_f32 v209, v181, v8
v_cvt_pk_bf16_f32 v210, v182, v8
v_cvt_pk_bf16_f32 v211, v183, v8
v_lshlrev_b32 v212, 16, v204
v_lshlrev_b32 v213, 16, v205
v_lshlrev_b32 v214, 16, v206
v_lshlrev_b32 v215, 16, v207
v_lshlrev_b32 v216, 16, v208
v_lshlrev_b32 v217, 16, v209
v_lshlrev_b32 v218, 16, v210
v_lshlrev_b32 v219, 16, v211
v_add_f32 v12, v212, v213
v_add_f32 v13, v214, v215
v_add_f32 v12, v12, v216
v_add_f32 v13, v13, v217
v_add_f32 v12, v12, v218
v_add_f32 v13, v13, v219
v_add_f32 v12, v12, v13
v_mul_f32 v13, s42, v3
v_exp_f32 v3, v13
v_exp_f32 v13, -v13
v_add_f32 v3, 1.0, v3
v_add_f32 v13, 1.0, v13
v_mul_f32 v12, v12, v3
v_rcp_f32 v12, v12
v_rcp_f32 v13, v13
v_subrev_u32 v15, 1824, v14
ds_read2_b32 v[120:121], v15 offset0:72 offset1:73
ds_read2_b32 v[122:123], v15 offset0:74 offset1:75
ds_read2_b32 v[124:125], v15 offset0:76 offset1:77
ds_read2_b32 v[126:127], v15 offset0:78 offset1:79
ds_read_b32 v128, v15 offset:320
s_waitcnt lgkmcnt(10)
v_dot2_f32_bf16 v184, v100, v204, 0
v_dot2_f32_bf16 v185, v100, v212, 0
v_dot2_f32_bf16 v186, v101, v204, 0
v_dot2_f32_bf16 v187, v101, v212, 0
v_dot2_f32_bf16 v188, v102, v204, 0
v_dot2_f32_bf16 v189, v102, v212, 0
v_dot2_f32_bf16 v190, v103, v204, 0
v_dot2_f32_bf16 v191, v103, v212, 0
v_dot2_f32_bf16 v192, v104, v204, 0
v_dot2_f32_bf16 v193, v104, v212, 0
v_dot2_f32_bf16 v194, v105, v204, 0
v_dot2_f32_bf16 v195, v105, v212, 0
v_dot2_f32_bf16 v196, v106, v204, 0
v_dot2_f32_bf16 v197, v106, v212, 0
v_dot2_f32_bf16 v198, v107, v204, 0
v_dot2_f32_bf16 v199, v107, v212, 0
v_dot2_f32_bf16 v200, v108, v204, 0
v_dot2_f32_bf16 v201, v108, v212, 0
v_subrev_u32 v15, 2736, v14
ds_read2_b32 v[130:131], v15 offset0:72 offset1:73
ds_read2_b32 v[132:133], v15 offset0:74 offset1:75
ds_read2_b32 v[134:135], v15 offset0:76 offset1:77
ds_read2_b32 v[136:137], v15 offset0:78 offset1:79
ds_read_b32 v138, v15 offset:320
s_waitcnt lgkmcnt(10)
v_dot2_f32_bf16 v184, v110, v205, v184
v_dot2_f32_bf16 v185, v110, v213, v185
v_dot2_f32_bf16 v186, v111, v205, v186
v_dot2_f32_bf16 v187, v111, v213, v187
v_dot2_f32_bf16 v188, v112, v205, v188
v_dot2_f32_bf16 v189, v112, v213, v189
v_dot2_f32_bf16 v190, v113, v205, v190
v_dot2_f32_bf16 v191, v113, v213, v191
v_dot2_f32_bf16 v192, v114, v205, v192
v_dot2_f32_bf16 v193, v114, v213, v193
v_dot2_f32_bf16 v194, v115, v205, v194
v_dot2_f32_bf16 v195, v115, v213, v195
v_dot2_f32_bf16 v196, v116, v205, v196
v_dot2_f32_bf16 v197, v116, v213, v197
v_dot2_f32_bf16 v198, v117, v205, v198
v_dot2_f32_bf16 v199, v117, v213, v199
v_dot2_f32_bf16 v200, v118, v205, v200
v_dot2_f32_bf16 v201, v118, v213, v201
v_subrev_u32 v15, 3648, v14
ds_read2_b32 v[100:101], v15 offset0:72 offset1:73
ds_read2_b32 v[102:103], v15 offset0:74 offset1:75
ds_read2_b32 v[104:105], v15 offset0:76 offset1:77
ds_read2_b32 v[106:107], v15 offset0:78 offset1:79
ds_read_b32 v108, v15 offset:320
s_waitcnt lgkmcnt(10)
v_dot2_f32_bf16 v184, v120, v206, v184
v_dot2_f32_bf16 v185, v120, v214, v185
v_dot2_f32_bf16 v186, v121, v206, v186
v_dot2_f32_bf16 v187, v121, v214, v187
v_dot2_f32_bf16 v188, v122, v206, v188
v_dot2_f32_bf16 v189, v122, v214, v189
v_dot2_f32_bf16 v190, v123, v206, v190
v_dot2_f32_bf16 v191, v123, v214, v191
v_dot2_f32_bf16 v192, v124, v206, v192
v_dot2_f32_bf16 v193, v124, v214, v193
v_dot2_f32_bf16 v194, v125, v206, v194
v_dot2_f32_bf16 v195, v125, v214, v195
v_dot2_f32_bf16 v196, v126, v206, v196
v_dot2_f32_bf16 v197, v126, v214, v197
v_dot2_f32_bf16 v198, v127, v206, v198
v_dot2_f32_bf16 v199, v127, v214, v199
v_dot2_f32_bf16 v200, v128, v206, v200
v_dot2_f32_bf16 v201, v128, v214, v201
v_subrev_u32 v15, 4560, v14
ds_read2_b32 v[110:111], v15 offset0:72 offset1:73
ds_read2_b32 v[112:113], v15 offset0:74 offset1:75
ds_read2_b32 v[114:115], v15 offset0:76 offset1:77
ds_read2_b32 v[116:117], v15 offset0:78 offset1:79
ds_read_b32 v118, v15 offset:320
s_waitcnt lgkmcnt(10)
v_dot2_f32_bf16 v184, v130, v207, v184
v_dot2_f32_bf16 v185, v130, v215, v185
v_dot2_f32_bf16 v186, v131, v207, v186
v_dot2_f32_bf16 v187, v131, v215, v187
v_dot2_f32_bf16 v188, v132, v207, v188
v_dot2_f32_bf16 v189, v132, v215, v189
v_dot2_f32_bf16 v190, v133, v207, v190
v_dot2_f32_bf16 v191, v133, v215, v191
v_dot2_f32_bf16 v192, v134, v207, v192
v_dot2_f32_bf16 v193, v134, v215, v193
v_dot2_f32_bf16 v194, v135, v207, v194
v_dot2_f32_bf16 v195, v135, v215, v195
v_dot2_f32_bf16 v196, v136, v207, v196
v_dot2_f32_bf16 v197, v136, v215, v197
v_dot2_f32_bf16 v198, v137, v207, v198
v_dot2_f32_bf16 v199, v137, v215, v199
v_dot2_f32_bf16 v200, v138, v207, v200
v_dot2_f32_bf16 v201, v138, v215, v201
v_subrev_u32 v15, 5472, v14
ds_read2_b32 v[120:121], v15 offset0:72 offset1:73
ds_read2_b32 v[122:123], v15 offset0:74 offset1:75
ds_read2_b32 v[124:125], v15 offset0:76 offset1:77
ds_read2_b32 v[126:127], v15 offset0:78 offset1:79
ds_read_b32 v128, v15 offset:320
s_waitcnt lgkmcnt(10)
v_dot2_f32_bf16 v184, v100, v208, v184
v_dot2_f32_bf16 v185, v100, v216, v185
v_dot2_f32_bf16 v186, v101, v208, v186
v_dot2_f32_bf16 v187, v101, v216, v187
v_dot2_f32_bf16 v188, v102, v208, v188
v_dot2_f32_bf16 v189, v102, v216, v189
v_dot2_f32_bf16 v190, v103, v208, v190
v_dot2_f32_bf16 v191, v103, v216, v191
v_dot2_f32_bf16 v192, v104, v208, v192
v_dot2_f32_bf16 v193, v104, v216, v193
v_dot2_f32_bf16 v194, v105, v208, v194
v_dot2_f32_bf16 v195, v105, v216, v195
v_dot2_f32_bf16 v196, v106, v208, v196
v_dot2_f32_bf16 v197, v106, v216, v197
v_dot2_f32_bf16 v198, v107, v208, v198
v_dot2_f32_bf16 v199, v107, v216, v199
v_dot2_f32_bf16 v200, v108, v208, v200
v_dot2_f32_bf16 v201, v108, v216, v201
v_subrev_u32 v15, 6384, v14
ds_read2_b32 v[130:131], v15 offset0:72 offset1:73
ds_read2_b32 v[132:133], v15 offset0:74 offset1:75
ds_read2_b32 v[134:135], v15 offset0:76 offset1:77
ds_read2_b32 v[136:137], v15 offset0:78 offset1:79
ds_read_b32 v138, v15 offset:320
s_waitcnt lgkmcnt(10)
v_dot2_f32_bf16 v184, v110, v209, v184
v_dot2_f32_bf16 v185, v110, v217, v185
v_dot2_f32_bf16 v186, v111, v209, v186
v_dot2_f32_bf16 v187, v111, v217, v187
v_dot2_f32_bf16 v188, v112, v209, v188
v_dot2_f32_bf16 v189, v112, v217, v189
v_dot2_f32_bf16 v190, v113, v209, v190
v_dot2_f32_bf16 v191, v113, v217, v191
v_dot2_f32_bf16 v192, v114, v209, v192
v_dot2_f32_bf16 v193, v114, v217, v193
v_dot2_f32_bf16 v194, v115, v209, v194
v_dot2_f32_bf16 v195, v115, v217, v195
v_dot2_f32_bf16 v196, v116, v209, v196
v_dot2_f32_bf16 v197, v116, v217, v197
v_dot2_f32_bf16 v198, v117, v209, v198
v_dot2_f32_bf16 v199, v117, v217, v199
v_dot2_f32_bf16 v200, v118, v209, v200
v_dot2_f32_bf16 v201, v118, v217, v201
s_waitcnt lgkmcnt(5)
v_dot2_f32_bf16 v184, v120, v210, v184
v_dot2_f32_bf16 v185, v120, v218, v185
v_dot2_f32_bf16 v186, v121, v210, v186
v_dot2_f32_bf16 v187, v121, v218, v187
v_dot2_f32_bf16 v188, v122, v210, v188
v_dot2_f32_bf16 v189, v122, v218, v189
v_dot2_f32_bf16 v190, v123, v210, v190
v_dot2_f32_bf16 v191, v123, v218, v191
v_dot2_f32_bf16 v192, v124, v210, v192
v_dot2_f32_bf16 v193, v124, v218, v193
v_dot2_f32_bf16 v194, v125, v210, v194
v_dot2_f32_bf16 v195, v125, v218, v195
v_dot2_f32_bf16 v196, v126, v210, v196
v_dot2_f32_bf16 v197, v126, v218, v197
v_dot2_f32_bf16 v198, v127, v210, v198
v_dot2_f32_bf16 v199, v127, v218, v199
v_dot2_f32_bf16 v200, v128, v210, v200
v_dot2_f32_bf16 v201, v128, v218, v201
s_waitcnt lgkmcnt(0)
v_dot2_f32_bf16 v184, v130, v211, v184
v_dot2_f32_bf16 v185, v130, v219, v185
v_dot2_f32_bf16 v186, v131, v211, v186
v_dot2_f32_bf16 v187, v131, v219, v187
v_dot2_f32_bf16 v188, v132, v211, v188
v_dot2_f32_bf16 v189, v132, v219, v189
v_dot2_f32_bf16 v190, v133, v211, v190
v_dot2_f32_bf16 v191, v133, v219, v191
v_dot2_f32_bf16 v192, v134, v211, v192
v_dot2_f32_bf16 v193, v134, v219, v193
v_dot2_f32_bf16 v194, v135, v211, v194
v_dot2_f32_bf16 v195, v135, v219, v195
v_dot2_f32_bf16 v196, v136, v211, v196
v_dot2_f32_bf16 v197, v136, v219, v197
v_dot2_f32_bf16 v198, v137, v211, v198
v_dot2_f32_bf16 v199, v137, v219, v199
v_dot2_f32_bf16 v200, v138, v211, v200
v_dot2_f32_bf16 v201, v138, v219, v201
s_or_b32 s37, s32, s34
s_cmp_lg_u32 s37, 0
s_cbranch_scc1 L_la_noomg
v_lshlrev_b32 v15, 2, v2
v_min_u32 v15, 8192, v15
s_mov_b32 s37, 87031808
buffer_store_dword v13, v15, s[4:7], s37 offen sc0 sc1
L_la_noomg:
v_mul_f32 v184, v184, v12
v_mul_f32 v185, v185, v12
v_mul_f32 v186, v186, v12
v_mul_f32 v187, v187, v12
v_mul_f32 v188, v188, v12
v_mul_f32 v189, v189, v12
v_mul_f32 v190, v190, v12
v_mul_f32 v191, v191, v12
v_mul_f32 v192, v192, v12
v_mul_f32 v193, v193, v12
v_mul_f32 v194, v194, v12
v_mul_f32 v195, v195, v12
v_mul_f32 v196, v196, v12
v_mul_f32 v197, v197, v12
v_mul_f32 v198, v198, v12
v_mul_f32 v199, v199, v12
v_mul_f32 v200, v200, v12
v_mul_f32 v201, v201, v12
v_cvt_pk_bf16_f32 v184, v184, v185
v_cvt_pk_bf16_f32 v185, v186, v187
v_cvt_pk_bf16_f32 v186, v188, v189
v_cvt_pk_bf16_f32 v187, v190, v191
v_cvt_pk_bf16_f32 v188, v192, v193
v_cvt_pk_bf16_f32 v189, v194, v195
v_cvt_pk_bf16_f32 v190, v196, v197
v_cvt_pk_bf16_f32 v191, v198, v199
v_cvt_pk_bf16_f32 v192, v200, v201
ds_write2_b32 v14, v184, v185 offset0:0 offset1:1
ds_write2_b32 v14, v186, v187 offset0:2 offset1:3
ds_write2_b32 v14, v188, v189 offset0:4 offset1:5
ds_write2_b32 v14, v190, v191 offset0:6 offset1:7
ds_write_b32 v14, v192 offset:32
s_add_u32 s35, s35, 64
s_cmp_lt_u32 s35, 192
s_cbranch_scc1 L_la_loop
s_waitcnt lgkmcnt(0)
s_barrier
v_mul_u32_u24 v14, 456, v10
v_lshl_add_u32 v14, v11, 4, v14
s_add_u32 s37, s34, 1
s_mul_i32 s37, s37, 7296
s_add_u32 s37, s37, 73728
v_add_u32 v14, s37, v14
s_mul_i32 s40, s33, 11
s_add_u32 s40, s40, s34
s_mov_b32 s35, s34
s_mul_i32 s41, s32, 2304
s_add_u32 s41, s41, 83886080
L_oa_loop:
s_cmp_ge_u32 s40, 128
s_cbranch_scc1 L_oa_done
ds_read2_b64 v[16:19], v14 offset0:0 offset1:1
ds_read2_b64 v[20:23], v14 offset0:8 offset1:9
ds_read2_b64 v[24:27], v14 offset0:16 offset1:17
s_mul_i32 s37, s40, 18432
s_add_u32 s37, s37, s41
s_waitcnt lgkmcnt(2)
buffer_store_dwordx4 v[16:19], v1, s[4:7], s37 offen offset:0 sc0 sc1
s_waitcnt lgkmcnt(1)
buffer_store_dwordx4 v[20:23], v1, s[4:7], s37 offen offset:1024 sc0 sc1
s_waitcnt lgkmcnt(0)
s_mov_b64 exec, 0xffff
buffer_store_dwordx4 v[24:27], v1, s[4:7], s37 offen offset:2048 sc0 sc1
s_mov_b64 exec, -1
v_add_u32 v14, 29184, v14
s_add_u32 s40, s40, 4
s_add_u32 s35, s35, 4
s_cmp_lt_u32 s35, 11
s_cbranch_scc1 L_oa_loop
L_oa_done:
s_waitcnt vmcnt(0)
s_barrier
s_cmp_lg_u32 s34, 0
s_cbranch_scc1 L_a_sig
v_mov_b32 v12, 1
s_mov_b64 exec, 1
buffer_atomic_add v12, v8, s[24:27], 0 offen offset:4 sc1
s_mov_b64 exec, -1
L_a_sig:
s_branch L_w_init_in
L_w_init:
s_sleep 4
L_w_init_in:
buffer_load_dword v12, v8, s[24:27], 0 offen offset:0 sc0 sc1
s_sub_u32 s36, s36, 1
s_cbranch_scc1 L_exit_w
s_waitcnt vmcnt(0)
v_readfirstlane_b32 s38, v12
s_nop 0
s_and_b32 s37, s38, 0xff
s_cmp_eq_u32 s37, 32
s_cbranch_scc0 L_w_init
s_xor_b32 s37, s49, 96
s_cmp_ge_u32 s49, 32
s_cselect_b32 s37, s37, s49
s_bitcmp1_b32 s38, 13
s_cselect_b32 s49, s37, s49
s_mul_i32 s48, s49, 43
s_lshr_b32 s48, s48, 9
s_mul_i32 s37, s48, 12
s_sub_u32 s49, s49, s37
s_cmp_ge_u32 s48, 5
s_cbranch_scc1 L_exit_w
v_add_u32 v12, 0, v9
v_mul_u32_u24 v13, 171, v12
v_lshrrev_b32 v13, 10, v13
v_mul_u32_u24 v13, 1056, v13
v_lshl_add_u32 v2, v12, 4, v13
v_add_u32 v12, 64, v9
v_mul_u32_u24 v13, 171, v12
v_lshrrev_b32 v13, 10, v13
v_mul_u32_u24 v13, 1056, v13
v_lshl_add_u32 v3, v12, 4, v13
v_add_u32 v12, 128, v9
v_mul_u32_u24 v13, 171, v12
v_lshrrev_b32 v13, 10, v13
v_mul_u32_u24 v13, 1056, v13
v_lshl_add_u32 v4, v12, 4, v13
v_lshrrev_b32 v12, 2, v10
v_lshl_add_u32 v12, v11, 2, v12
v_mul_u32_u24 v5, 96, v12
v_and_b32 v12, 3, v10
v_lshl_add_u32 v5, v12, 3, v5
v_lshrrev_b32 v12, 2, v10
v_lshl_add_u32 v12, v11, 3, v12
v_mul_u32_u24 v6, 96, v12
v_and_b32 v12, 3, v10
v_lshl_add_u32 v6, v12, 3, v6
s_lshl_b32 s50, s34, 15
v_add_u32 v5, s50, v5
v_add_u32 v6, s50, v6
v_add_u32 v7, s50, v1
s_mul_i32 s37, s49, 96
s_mul_i32 s51, s34, 1179648
s_add_u32 s51, s51, s37
s_mul_i32 s52, s34, 184320
s_add_u32 s52, s52, s37
v_mul_u32_u24 v15, 1152, v10
v_lshl_add_u32 v15, v11, 3, v15
s_lshl_b32 s38, s34, 5
s_add_u32 s37, s37, s38
s_mul_i32 s55, s48, 18432
s_add_u32 s54, s55, 83886080
s_add_u32 s55, s55, s37
s_lshl_b32 s53, s48, 17
s_add_u32 s53, s53, s50
s_add_u32 s53, s53, 67108864
s_lshl_b32 s56, s48, 6
s_add_u32 s56, s56, 87031808
v_lshlrev_b32 v9, 4, v9
v_lshlrev_b32 v10, 2, v10
v_add_u32 v14, 131072, v1
s_add_u32 s37, s52, 0
s_add_u32 m0, s50, 0
s_nop 0
buffer_load_dwordx4 v2, s[16:19], s37 offen lds
s_add_u32 m0, s50, 1024
s_nop 0
buffer_load_dwordx4 v3, s[16:19], s37 offen lds
s_add_u32 m0, s50, 2048
s_nop 0
buffer_load_dwordx4 v4, s[16:19], s37 offen lds
s_add_u32 s37, s52, 36864
s_add_u32 m0, s50, 3072
s_nop 0
buffer_load_dwordx4 v2, s[16:19], s37 offen lds
s_add_u32 m0, s50, 4096
s_nop 0
buffer_load_dwordx4 v3, s[16:19], s37 offen lds
s_add_u32 m0, s50, 5120
s_nop 0
buffer_load_dwordx4 v4, s[16:19], s37 offen lds
s_add_u32 s37, s52, 73728
s_add_u32 m0, s50, 6144
s_nop 0
buffer_load_dwordx4 v2, s[16:19], s37 offen lds
s_add_u32 m0, s50, 7168
s_nop 0
buffer_load_dwordx4 v3, s[16:19], s37 offen lds
s_add_u32 m0, s50, 8192
s_nop 0
buffer_load_dwordx4 v4, s[16:19], s37 offen lds
s_add_u32 s37, s52, 110592
s_add_u32 m0, s50, 9216
s_nop 0
buffer_load_dwordx4 v2, s[16:19], s37 offen lds
s_add_u32 m0, s50, 10240
s_nop 0
buffer_load_dwordx4 v3, s[16:19], s37 offen lds
s_add_u32 m0, s50, 11264
s_nop 0
buffer_load_dwordx4 v4, s[16:19], s37 offen lds
s_add_u32 s37, s52, 147456
s_add_u32 m0, s50, 12288
s_nop 0
buffer_load_dwordx4 v2, s[16:19], s37 offen lds
s_add_u32 m0, s50, 13312
s_nop 0
buffer_load_dwordx4 v3, s[16:19], s37 offen lds
s_add_u32 m0, s50, 14336
s_nop 0
buffer_load_dwordx4 v4, s[16:19], s37 offen lds
s_add_u32 s37, s51, 0
s_add_u32 m0, s50, 15360
s_nop 0
buffer_load_dwordx4 v2, s[20:23], s37 offen lds
s_add_u32 m0, s50, 16384
s_nop 0
buffer_load_dwordx4 v3, s[20:23], s37 offen lds
s_add_u32 m0, s50, 17408
s_nop 0
buffer_load_dwordx4 v4, s[20:23], s37 offen lds
s_add_u32 s37, s51, 36864
s_add_u32 m0, s50, 18432
s_nop 0
buffer_load_dwordx4 v2, s[20:23], s37 offen lds
s_add_u32 m0, s50, 19456
s_nop 0
buffer_load_dwordx4 v3, s[20:23], s37 offen lds
s_add_u32 m0, s50, 20480
s_nop 0
buffer_load_dwordx4 v4, s[20:23], s37 offen lds
s_add_u32 s37, s51, 73728
s_add_u32 m0, s50, 21504
s_nop 0
buffer_load_dwordx4 v2, s[20:23], s37 offen lds
s_add_u32 m0, s50, 22528
s_nop 0
buffer_load_dwordx4 v3, s[20:23], s37 offen lds
s_add_u32 m0, s50, 23552
s_nop 0
buffer_load_dwordx4 v4, s[20:23], s37 offen lds
s_add_u32 s37, s51, 110592
s_add_u32 m0, s50, 24576
s_nop 0
buffer_load_dwordx4 v2, s[20:23], s37 offen lds
s_add_u32 m0, s50, 25600
s_nop 0
buffer_load_dwordx4 v3, s[20:23], s37 offen lds
s_add_u32 m0, s50, 26624
s_nop 0
buffer_load_dwordx4 v4, s[20:23], s37 offen lds
s_waitcnt vmcnt(24)
ds_read_b64_tr_b16 v[68:69], v6 offset:0
ds_read_b64_tr_b16 v[70:71], v6 offset:384
ds_read_b64_tr_b16 v[72:73], v6 offset:32
ds_read_b64_tr_b16 v[74:75], v6 offset:416
ds_read_b64_tr_b16 v[76:77], v6 offset:64
ds_read_b64_tr_b16 v[78:79], v6 offset:448
s_waitcnt lgkmcnt(0)
s_add_u32 s37, s51, 147456
s_add_u32 m0, s50, 27648
s_nop 0
buffer_load_dwordx4 v2, s[20:23], s37 offen lds
s_add_u32 m0, s50, 28672
s_nop 0
buffer_load_dwordx4 v3, s[20:23], s37 offen lds
s_add_u32 m0, s50, 29696
s_nop 0
buffer_load_dwordx4 v4, s[20:23], s37 offen lds
s_waitcnt vmcnt(24)
ds_read_b64_tr_b16 v[80:81], v6 offset:3072
ds_read_b64_tr_b16 v[82:83], v6 offset:3456
ds_read_b64_tr_b16 v[84:85], v6 offset:3104
ds_read_b64_tr_b16 v[86:87], v6 offset:3488
ds_read_b64_tr_b16 v[88:89], v6 offset:3136
ds_read_b64_tr_b16 v[90:91], v6 offset:3520
s_waitcnt lgkmcnt(0)
s_add_u32 s37, s51, 184320
s_add_u32 m0, s50, 0
s_nop 0
buffer_load_dwordx4 v2, s[20:23], s37 offen lds
s_add_u32 m0, s50, 1024
s_nop 0
buffer_load_dwordx4 v3, s[20:23], s37 offen lds
s_add_u32 m0, s50, 2048
s_nop 0
buffer_load_dwordx4 v4, s[20:23], s37 offen lds
s_waitcnt vmcnt(24)
ds_read_b64_tr_b16 v[92:93], v6 offset:6144
ds_read_b64_tr_b16 v[94:95], v6 offset:6528
ds_read_b64_tr_b16 v[96:97], v6 offset:6176
ds_read_b64_tr_b16 v[98:99], v6 offset:6560
ds_read_b64_tr_b16 v[100:101], v6 offset:6208
ds_read_b64_tr_b16 v[102:103], v6 offset:6592
s_waitcnt lgkmcnt(0)
s_add_u32 s37, s51, 221184
s_add_u32 m0, s50, 3072
s_nop 0
buffer_load_dwordx4 v2, s[20:23], s37 offen lds
s_add_u32 m0, s50, 4096
s_nop 0
buffer_load_dwordx4 v3, s[20:23], s37 offen lds
s_add_u32 m0, s50, 5120
s_nop 0
buffer_load_dwordx4 v4, s[20:23], s37 offen lds
s_waitcnt vmcnt(24)
ds_read_b64_tr_b16 v[104:105], v6 offset:9216
ds_read_b64_tr_b16 v[106:107], v6 offset:9600
ds_read_b64_tr_b16 v[108:109], v6 offset:9248
ds_read_b64_tr_b16 v[110:111], v6 offset:9632
ds_read_b64_tr_b16 v[112:113], v6 offset:9280
ds_read_b64_tr_b16 v[114:115], v6 offset:9664
s_waitcnt lgkmcnt(0)
s_add_u32 s37, s51, 258048
s_add_u32 m0, s50, 6144
s_nop 0
buffer_load_dwordx4 v2, s[20:23], s37 offen lds
s_add_u32 m0, s50, 7168
s_nop 0
buffer_load_dwordx4 v3, s[20:23], s37 offen lds
s_add_u32 m0, s50, 8192
s_nop 0
buffer_load_dwordx4 v4, s[20:23], s37 offen lds
s_waitcnt vmcnt(24)
ds_read_b64_tr_b16 v[116:117], v6 offset:12288
ds_read_b64_tr_b16 v[118:119], v6 offset:12672
ds_read_b64_tr_b16 v[120:121], v6 offset:12320
ds_read_b64_tr_b16 v[122:123], v6 offset:12704
ds_read_b64_tr_b16 v[124:125], v6 offset:12352
ds_read_b64_tr_b16 v[126:127], v6 offset:12736
s_waitcnt lgkmcnt(0)
s_add_u32 s37, s51, 294912
s_add_u32 m0, s50, 9216
s_nop 0
buffer_load_dwordx4 v2, s[20:23], s37 offen lds
s_add_u32 m0, s50, 10240
s_nop 0
buffer_load_dwordx4 v3, s[20:23], s37 offen lds
s_add_u32 m0, s50, 11264
s_nop 0
buffer_load_dwordx4 v4, s[20:23], s37 offen lds
s_waitcnt vmcnt(24)
ds_read_b64_tr_b16 v[128:129], v5 offset:15360
ds_read_b64_tr_b16 v[130:131], v5 offset:16896
ds_read_b64_tr_b16 v[132:133], v5 offset:15392
ds_read_b64_tr_b16 v[134:135], v5 offset:16928
ds_read_b64_tr_b16 v[136:137], v5 offset:15424
ds_read_b64_tr_b16 v[138:139], v5 offset:16960
s_waitcnt lgkmcnt(0)
s_add_u32 s37, s51, 331776
s_add_u32 m0, s50, 12288
s_nop 0
buffer_load_dwordx4 v2, s[20:23], s37 offen lds
s_add_u32 m0, s50, 13312
s_nop 0
buffer_load_dwordx4 v3, s[20:23], s37 offen lds
s_add_u32 m0, s50, 14336
s_nop 0
buffer_load_dwordx4 v4, s[20:23], s37 offen lds
s_waitcnt vmcnt(24)
ds_read_b64_tr_b16 v[140:141], v5 offset:18432
ds_read_b64_tr_b16 v[142:143], v5 offset:19968
ds_read_b64_tr_b16 v[144:145], v5 offset:18464
ds_read_b64_tr_b16 v[146:147], v5 offset:20000
ds_read_b64_tr_b16 v[148:149], v5 offset:18496
ds_read_b64_tr_b16 v[150:151], v5 offset:20032
s_waitcnt lgkmcnt(0)
s_add_u32 s37, s51, 368640
s_add_u32 m0, s50, 15360
s_nop 0
buffer_load_dwordx4 v2, s[20:23], s37 offen lds
s_add_u32 m0, s50, 16384
s_nop 0
buffer_load_dwordx4 v3, s[20:23], s37 offen lds
s_add_u32 m0, s50, 17408
s_nop 0
buffer_load_dwordx4 v4, s[20:23], s37 offen lds
s_waitcnt vmcnt(24)
ds_read_b64_tr_b16 v[152:153], v5 offset:21504
ds_read_b64_tr_b16 v[154:155], v5 offset:23040
ds_read_b64_tr_b16 v[156:157], v5 offset:21536
ds_read_b64_tr_b16 v[158:159], v5 offset:23072
ds_read_b64_tr_b16 v[160:161], v5 offset:21568
ds_read_b64_tr_b16 v[162:163], v5 offset:23104
s_waitcnt lgkmcnt(0)
s_add_u32 s37, s51, 405504
s_add_u32 m0, s50, 18432
s_nop 0
buffer_load_dwordx4 v2, s[20:23], s37 offen lds
s_add_u32 m0, s50, 19456
s_nop 0
buffer_load_dwordx4 v3, s[20:23], s37 offen lds
s_add_u32 m0, s50, 20480
s_nop 0
buffer_load_dwordx4 v4, s[20:23], s37 offen lds
s_waitcnt vmcnt(24)
ds_read_b64_tr_b16 v[164:165], v5 offset:24576
ds_read_b64_tr_b16 v[166:167], v5 offset:26112
ds_read_b64_tr_b16 v[168:169], v5 offset:24608
ds_read_b64_tr_b16 v[170:171], v5 offset:26144
ds_read_b64_tr_b16 v[172:173], v5 offset:24640
ds_read_b64_tr_b16 v[174:175], v5 offset:26176
s_waitcnt lgkmcnt(0)
s_add_u32 s37, s51, 442368
s_add_u32 m0, s50, 21504
s_nop 0
buffer_load_dwordx4 v2, s[20:23], s37 offen lds
s_add_u32 m0, s50, 22528
s_nop 0
buffer_load_dwordx4 v3, s[20:23], s37 offen lds
s_add_u32 m0, s50, 23552
s_nop 0
buffer_load_dwordx4 v4, s[20:23], s37 offen lds
s_waitcnt vmcnt(24)
ds_read_b64_tr_b16 v[176:177], v5 offset:27648
ds_read_b64_tr_b16 v[178:179], v5 offset:29184
ds_read_b64_tr_b16 v[180:181], v5 offset:27680
ds_read_b64_tr_b16 v[182:183], v5 offset:29216
ds_read_b64_tr_b16 v[184:185], v5 offset:27712
ds_read_b64_tr_b16 v[186:187], v5 offset:29248
s_waitcnt lgkmcnt(0)
s_add_u32 s37, s51, 479232
s_add_u32 m0, s50, 24576
s_nop 0
buffer_load_dwordx4 v2, s[20:23], s37 offen lds
s_add_u32 m0, s50, 25600
s_nop 0
buffer_load_dwordx4 v3, s[20:23], s37 offen lds
s_add_u32 m0, s50, 26624
s_nop 0
buffer_load_dwordx4 v4, s[20:23], s37 offen lds
s_waitcnt vmcnt(24)
ds_read_b64_tr_b16 v[188:189], v5 offset:0
ds_read_b64_tr_b16 v[190:191], v5 offset:1536
ds_read_b64_tr_b16 v[192:193], v5 offset:32
ds_read_b64_tr_b16 v[194:195], v5 offset:1568
ds_read_b64_tr_b16 v[196:197], v5 offset:64
ds_read_b64_tr_b16 v[198:199], v5 offset:1600
s_waitcnt lgkmcnt(0)
s_add_u32 s37, s51, 516096
s_add_u32 m0, s50, 27648
s_nop 0
buffer_load_dwordx4 v2, s[20:23], s37 offen lds
s_add_u32 m0, s50, 28672
s_nop 0
buffer_load_dwordx4 v3, s[20:23], s37 offen lds
s_add_u32 m0, s50, 29696
s_nop 0
buffer_load_dwordx4 v4, s[20:23], s37 offen lds
s_waitcnt vmcnt(24)
ds_read_b64_tr_b16 v[200:201], v5 offset:3072
ds_read_b64_tr_b16 v[202:203], v5 offset:4608
ds_read_b64_tr_b16 v[204:205], v5 offset:3104
ds_read_b64_tr_b16 v[206:207], v5 offset:4640
ds_read_b64_tr_b16 v[208:209], v5 offset:3136
ds_read_b64_tr_b16 v[210:211], v5 offset:4672
s_waitcnt lgkmcnt(0)
s_add_u32 s37, s51, 552960
s_add_u32 m0, s50, 0
s_nop 0
buffer_load_dwordx4 v2, s[20:23], s37 offen lds
s_add_u32 m0, s50, 1024
s_nop 0
buffer_load_dwordx4 v3, s[20:23], s37 offen lds
s_add_u32 m0, s50, 2048
s_nop 0
buffer_load_dwordx4 v4, s[20:23], s37 offen lds
s_waitcnt vmcnt(24)
ds_read_b64_tr_b16 v[212:213], v5 offset:6144
ds_read_b64_tr_b16 v[214:215], v5 offset:7680
ds_read_b64_tr_b16 v[216:217], v5 offset:6176
ds_read_b64_tr_b16 v[218:219], v5 offset:7712
ds_read_b64_tr_b16 v[220:221], v5 offset:6208
ds_read_b64_tr_b16 v[222:223], v5 offset:7744
s_waitcnt lgkmcnt(0)
s_add_u32 s37, s51, 589824
s_add_u32 m0, s50, 3072
s_nop 0
buffer_load_dwordx4 v2, s[20:23], s37 offen lds
s_add_u32 m0, s50, 4096
s_nop 0
buffer_load_dwordx4 v3, s[20:23], s37 offen lds
s_add_u32 m0, s50, 5120
s_nop 0
buffer_load_dwordx4 v4, s[20:23], s37 offen lds
s_waitcnt vmcnt(24)
ds_read_b64_tr_b16 v[224:225], v5 offset:9216
ds_read_b64_tr_b16 v[226:227], v5 offset:10752
ds_read_b64_tr_b16 v[228:229], v5 offset:9248
ds_read_b64_tr_b16 v[230:231], v5 offset:10784
ds_read_b64_tr_b16 v[232:233], v5 offset:9280
ds_read_b64_tr_b16 v[234:235], v5 offset:10816
s_waitcnt lgkmcnt(0)
s_add_u32 s37, s51, 626688
s_add_u32 m0, s50, 6144
s_nop 0
buffer_load_dwordx4 v2, s[20:23], s37 offen lds
s_add_u32 m0, s50, 7168
s_nop 0
buffer_load_dwordx4 v3, s[20:23], s37 offen lds
s_add_u32 m0, s50, 8192
s_nop 0
buffer_load_dwordx4 v4, s[20:23], s37 offen lds
s_waitcnt vmcnt(24)
ds_read_b64_tr_b16 v[236:237], v5 offset:12288
ds_read_b64_tr_b16 v[238:239], v5 offset:13824
ds_read_b64_tr_b16 v[240:241], v5 offset:12320
ds_read_b64_tr_b16 v[242:243], v5 offset:13856
ds_read_b64_tr_b16 v[244:245], v5 offset:12352
ds_read_b64_tr_b16 v[246:247], v5 offset:13888
s_waitcnt lgkmcnt(0)
s_add_u32 s37, s51, 663552
s_add_u32 m0, s50, 9216
s_nop 0
buffer_load_dwordx4 v2, s[20:23], s37 offen lds
s_add_u32 m0, s50, 10240
s_nop 0
buffer_load_dwordx4 v3, s[20:23], s37 offen lds
s_add_u32 m0, s50, 11264
s_nop 0
buffer_load_dwordx4 v4, s[20:23], s37 offen lds
s_waitcnt vmcnt(24)
ds_read_b64_tr_b16 v[248:249], v5 offset:15360
ds_read_b64_tr_b16 v[250:251], v5 offset:16896
ds_read_b64_tr_b16 v[252:253], v5 offset:15392
ds_read_b64_tr_b16 v[254:255], v5 offset:16928
ds_read_b64_tr_b16 a[0:1], v5 offset:15424
ds_read_b64_tr_b16 a[2:3], v5 offset:16960
s_waitcnt lgkmcnt(0)
s_add_u32 s37, s51, 700416
s_add_u32 m0, s50, 12288
s_nop 0
buffer_load_dwordx4 v2, s[20:23], s37 offen lds
s_add_u32 m0, s50, 13312
s_nop 0
buffer_load_dwordx4 v3, s[20:23], s37 offen lds
s_add_u32 m0, s50, 14336
s_nop 0
buffer_load_dwordx4 v4, s[20:23], s37 offen lds
s_waitcnt vmcnt(24)
ds_read_b64_tr_b16 a[4:5], v5 offset:18432
ds_read_b64_tr_b16 a[6:7], v5 offset:19968
ds_read_b64_tr_b16 a[8:9], v5 offset:18464
ds_read_b64_tr_b16 a[10:11], v5 offset:20000
ds_read_b64_tr_b16 a[12:13], v5 offset:18496
ds_read_b64_tr_b16 a[14:15], v5 offset:20032
s_waitcnt lgkmcnt(0)
s_add_u32 s37, s51, 737280
s_add_u32 m0, s50, 15360
s_nop 0
buffer_load_dwordx4 v2, s[20:23], s37 offen lds
s_add_u32 m0, s50, 16384
s_nop 0
buffer_load_dwordx4 v3, s[20:23], s37 offen lds
s_add_u32 m0, s50, 17408
s_nop 0
buffer_load_dwordx4 v4, s[20:23], s37 offen lds
s_waitcnt vmcnt(24)
ds_read_b64_tr_b16 a[16:17], v5 offset:21504
ds_read_b64_tr_b16 a[18:19], v5 offset:23040
ds_read_b64_tr_b16 a[20:21], v5 offset:21536
ds_read_b64_tr_b16 a[22:23], v5 offset:23072
ds_read_b64_tr_b16 a[24:25], v5 offset:21568
ds_read_b64_tr_b16 a[26:27], v5 offset:23104
s_waitcnt lgkmcnt(0)
s_add_u32 s37, s51, 774144
s_add_u32 m0, s50, 18432
s_nop 0
buffer_load_dwordx4 v2, s[20:23], s37 offen lds
s_add_u32 m0, s50, 19456
s_nop 0
buffer_load_dwordx4 v3, s[20:23], s37 offen lds
s_add_u32 m0, s50, 20480
s_nop 0
buffer_load_dwordx4 v4, s[20:23], s37 offen lds
s_waitcnt vmcnt(24)
ds_read_b64_tr_b16 a[28:29], v5 offset:24576
ds_read_b64_tr_b16 a[30:31], v5 offset:26112
ds_read_b64_tr_b16 a[32:33], v5 offset:24608
ds_read_b64_tr_b16 a[34:35], v5 offset:26144
ds_read_b64_tr_b16 a[36:37], v5 offset:24640
ds_read_b64_tr_b16 a[38:39], v5 offset:26176
s_waitcnt lgkmcnt(0)
s_add_u32 s37, s51, 811008
s_add_u32 m0, s50, 21504
s_nop 0
buffer_load_dwordx4 v2, s[20:23], s37 offen lds
s_add_u32 m0, s50, 22528
s_nop 0
buffer_load_dwordx4 v3, s[20:23], s37 offen lds
s_add_u32 m0, s50, 23552
s_nop 0
buffer_load_dwordx4 v4, s[20:23], s37 offen lds
s_waitcnt vmcnt(24)
ds_read_b64_tr_b16 a[40:41], v5 offset:27648
ds_read_b64_tr_b16 a[42:43], v5 offset:29184
ds_read_b64_tr_b16 a[44:45], v5 offset:27680
ds_read_b64_tr_b16 a[46:47], v5 offset:29216
ds_read_b64_tr_b16 a[48:49], v5 offset:27712
ds_read_b64_tr_b16 a[50:51], v5 offset:29248
s_waitcnt lgkmcnt(0)
s_add_u32 s37, s51, 847872
s_add_u32 m0, s50, 24576
s_nop 0
buffer_load_dwordx4 v2, s[20:23], s37 offen lds
s_add_u32 m0, s50, 25600
s_nop 0
buffer_load_dwordx4 v3, s[20:23], s37 offen lds
s_add_u32 m0, s50, 26624
s_nop 0
buffer_load_dwordx4 v4, s[20:23], s37 offen lds
s_waitcnt vmcnt(24)
ds_read_b64_tr_b16 a[52:53], v5 offset:0
ds_read_b64_tr_b16 a[54:55], v5 offset:1536
ds_read_b64_tr_b16 a[56:57], v5 offset:32
ds_read_b64_tr_b16 a[58:59], v5 offset:1568
ds_read_b64_tr_b16 a[60:61], v5 offset:64
ds_read_b64_tr_b16 a[62:63], v5 offset:1600
s_waitcnt lgkmcnt(0)
s_add_u32 s37, s51, 884736
s_add_u32 m0, s50, 27648
s_nop 0
buffer_load_dwordx4 v2, s[20:23], s37 offen lds
s_add_u32 m0, s50, 28672
s_nop 0
buffer_load_dwordx4 v3, s[20:23], s37 offen lds
s_add_u32 m0, s50, 29696
s_nop 0
buffer_load_dwordx4 v4, s[20:23], s37 offen lds
s_waitcnt vmcnt(24)
ds_read_b64_tr_b16 a[64:65], v5 offset:3072
ds_read_b64_tr_b16 a[66:67], v5 offset:4608
ds_read_b64_tr_b16 a[68:69], v5 offset:3104
ds_read_b64_tr_b16 a[70:71], v5 offset:4640
ds_read_b64_tr_b16 a[72:73], v5 offset:3136
ds_read_b64_tr_b16 a[74:75], v5 offset:4672
s_waitcnt lgkmcnt(0)
s_add_u32 s37, s51, 921600
s_add_u32 m0, s50, 0
s_nop 0
buffer_load_dwordx4 v2, s[20:23], s37 offen lds
s_add_u32 m0, s50, 1024
s_nop 0
buffer_load_dwordx4 v3, s[20:23], s37 offen lds
s_add_u32 m0, s50, 2048
s_nop 0
buffer_load_dwordx4 v4, s[20:23], s37 offen lds
s_waitcnt vmcnt(24)
ds_read_b64_tr_b16 a[76:77], v5 offset:6144
ds_read_b64_tr_b16 a[78:79], v5 offset:7680
ds_read_b64_tr_b16 a[80:81], v5 offset:6176
ds_read_b64_tr_b16 a[82:83], v5 offset:7712
ds_read_b64_tr_b16 a[84:85], v5 offset:6208
ds_read_b64_tr_b16 a[86:87], v5 offset:7744
s_waitcnt lgkmcnt(0)
s_add_u32 s37, s51, 958464
s_add_u32 m0, s50, 3072
s_nop 0
buffer_load_dwordx4 v2, s[20:23], s37 offen lds
s_add_u32 m0, s50, 4096
s_nop 0
buffer_load_dwordx4 v3, s[20:23], s37 offen lds
s_add_u32 m0, s50, 5120
s_nop 0
buffer_load_dwordx4 v4, s[20:23], s37 offen lds
s_waitcnt vmcnt(24)
ds_read_b64_tr_b16 a[88:89], v5 offset:9216
ds_read_b64_tr_b16 a[90:91], v5 offset:10752
ds_read_b64_tr_b16 a[92:93], v5 offset:9248
ds_read_b64_tr_b16 a[94:95], v5 offset:10784
ds_read_b64_tr_b16 a[96:97], v5 offset:9280
ds_read_b64_tr_b16 a[98:99], v5 offset:10816
s_waitcnt lgkmcnt(0)
s_add_u32 s37, s51, 995328
s_add_u32 m0, s50, 6144
s_nop 0
buffer_load_dwordx4 v2, s[20:23], s37 offen lds
s_add_u32 m0, s50, 7168
s_nop 0
buffer_load_dwordx4 v3, s[20:23], s37 offen lds
s_add_u32 m0, s50, 8192
s_nop 0
buffer_load_dwordx4 v4, s[20:23], s37 offen lds
s_waitcnt vmcnt(24)
ds_read_b64_tr_b16 a[100:101], v5 offset:12288
ds_read_b64_tr_b16 a[102:103], v5 offset:13824
ds_read_b64_tr_b16 a[104:105], v5 offset:12320
ds_read_b64_tr_b16 a[106:107], v5 offset:13856
ds_read_b64_tr_b16 a[108:109], v5 offset:12352
ds_read_b64_tr_b16 a[110:111], v5 offset:13888
s_waitcnt lgkmcnt(0)
s_add_u32 s37, s51, 1032192
s_add_u32 m0, s50, 9216
s_nop 0
buffer_load_dwordx4 v2, s[20:23], s37 offen lds
s_add_u32 m0, s50, 10240
s_nop 0
buffer_load_dwordx4 v3, s[20:23], s37 offen lds
s_add_u32 m0, s50, 11264
s_nop 0
buffer_load_dwordx4 v4, s[20:23], s37 offen lds
s_waitcnt vmcnt(24)
ds_read_b64_tr_b16 a[112:113], v5 offset:15360
ds_read_b64_tr_b16 a[114:115], v5 offset:16896
ds_read_b64_tr_b16 a[116:117], v5 offset:15392
ds_read_b64_tr_b16 a[118:119], v5 offset:16928
ds_read_b64_tr_b16 a[120:121], v5 offset:15424
ds_read_b64_tr_b16 a[122:123], v5 offset:16960
s_waitcnt lgkmcnt(0)
s_add_u32 s37, s51, 1069056
s_add_u32 m0, s50, 12288
s_nop 0
buffer_load_dwordx4 v2, s[20:23], s37 offen lds
s_add_u32 m0, s50, 13312
s_nop 0
buffer_load_dwordx4 v3, s[20:23], s37 offen lds
s_add_u32 m0, s50, 14336
s_nop 0
buffer_load_dwordx4 v4, s[20:23], s37 offen lds
s_waitcnt vmcnt(24)
ds_read_b64_tr_b16 a[124:125], v5 offset:18432
ds_read_b64_tr_b16 a[126:127], v5 offset:19968
ds_read_b64_tr_b16 a[128:129], v5 offset:18464
ds_read_b64_tr_b16 a[130:131], v5 offset:20000
ds_read_b64_tr_b16 a[132:133], v5 offset:18496
ds_read_b64_tr_b16 a[134:135], v5 offset:20032
s_waitcnt lgkmcnt(0)
s_add_u32 s37, s51, 1105920
s_add_u32 m0, s50, 15360
s_nop 0
buffer_load_dwordx4 v2, s[20:23], s37 offen lds
s_add_u32 m0, s50, 16384
s_nop 0
buffer_load_dwordx4 v3, s[20:23], s37 offen lds
s_add_u32 m0, s50, 17408
s_nop 0
buffer_load_dwordx4 v4, s[20:23], s37 offen lds
s_waitcnt vmcnt(24)
ds_read_b64_tr_b16 a[136:137], v5 offset:21504
ds_read_b64_tr_b16 a[138:139], v5 offset:23040
ds_read_b64_tr_b16 a[140:141], v5 offset:21536
ds_read_b64_tr_b16 a[142:143], v5 offset:23072
ds_read_b64_tr_b16 a[144:145], v5 offset:21568
ds_read_b64_tr_b16 a[146:147], v5 offset:23104
s_waitcnt lgkmcnt(0)
s_add_u32 s37, s51, 1142784
s_add_u32 m0, s50, 18432
s_nop 0
buffer_load_dwordx4 v2, s[20:23], s37 offen lds
s_add_u32 m0, s50, 19456
s_nop 0
buffer_load_dwordx4 v3, s[20:23], s37 offen lds
s_add_u32 m0, s50, 20480
s_nop 0
buffer_load_dwordx4 v4, s[20:23], s37 offen lds
s_waitcnt vmcnt(24)
ds_read_b64_tr_b16 a[148:149], v5 offset:24576
ds_read_b64_tr_b16 a[150:151], v5 offset:26112
ds_read_b64_tr_b16 a[152:153], v5 offset:24608
ds_read_b64_tr_b16 a[154:155], v5 offset:26144
ds_read_b64_tr_b16 a[156:157], v5 offset:24640
ds_read_b64_tr_b16 a[158:159], v5 offset:26176
s_waitcnt lgkmcnt(0)
s_waitcnt vmcnt(21)
ds_read_b64_tr_b16 a[160:161], v5 offset:27648
ds_read_b64_tr_b16 a[162:163], v5 offset:29184
ds_read_b64_tr_b16 a[164:165], v5 offset:27680
ds_read_b64_tr_b16 a[166:167], v5 offset:29216
ds_read_b64_tr_b16 a[168:169], v5 offset:27712
ds_read_b64_tr_b16 a[170:171], v5 offset:29248
s_waitcnt lgkmcnt(0)
s_waitcnt vmcnt(18)
ds_read_b64_tr_b16 a[172:173], v5 offset:0
ds_read_b64_tr_b16 a[174:175], v5 offset:1536
ds_read_b64_tr_b16 a[176:177], v5 offset:32
ds_read_b64_tr_b16 a[178:179], v5 offset:1568
ds_read_b64_tr_b16 a[180:181], v5 offset:64
ds_read_b64_tr_b16 a[182:183], v5 offset:1600
s_waitcnt lgkmcnt(0)
s_waitcnt vmcnt(15)
ds_read_b64_tr_b16 a[184:185], v5 offset:3072
ds_read_b64_tr_b16 a[186:187], v5 offset:4608
ds_read_b64_tr_b16 a[188:189], v5 offset:3104
ds_read_b64_tr_b16 a[190:191], v5 offset:4640
ds_read_b64_tr_b16 a[192:193], v5 offset:3136
ds_read_b64_tr_b16 a[194:195], v5 offset:4672
s_waitcnt lgkmcnt(0)
s_waitcnt vmcnt(12)
ds_read_b64_tr_b16 a[196:197], v5 offset:6144
ds_read_b64_tr_b16 a[198:199], v5 offset:7680
ds_read_b64_tr_b16 a[200:201], v5 offset:6176
ds_read_b64_tr_b16 a[202:203], v5 offset:7712
ds_read_b64_tr_b16 a[204:205], v5 offset:6208
ds_read_b64_tr_b16 a[206:207], v5 offset:7744
s_waitcnt lgkmcnt(0)
s_waitcnt vmcnt(9)
ds_read_b64_tr_b16 a[208:209], v5 offset:9216
ds_read_b64_tr_b16 a[210:211], v5 offset:10752
ds_read_b64_tr_b16 a[212:213], v5 offset:9248
ds_read_b64_tr_b16 a[214:215], v5 offset:10784
ds_read_b64_tr_b16 a[216:217], v5 offset:9280
ds_read_b64_tr_b16 a[218:219], v5 offset:10816
s_waitcnt lgkmcnt(0)
s_waitcnt vmcnt(6)
ds_read_b64_tr_b16 a[220:221], v5 offset:12288
ds_read_b64_tr_b16 a[222:223], v5 offset:13824
ds_read_b64_tr_b16 a[224:225], v5 offset:12320
ds_read_b64_tr_b16 a[226:227], v5 offset:13856
ds_read_b64_tr_b16 a[228:229], v5 offset:12352
ds_read_b64_tr_b16 a[230:231], v5 offset:13888
s_waitcnt lgkmcnt(0)
s_waitcnt vmcnt(3)
ds_read_b64_tr_b16 a[232:233], v5 offset:15360
ds_read_b64_tr_b16 a[234:235], v5 offset:16896
ds_read_b64_tr_b16 a[236:237], v5 offset:15392
ds_read_b64_tr_b16 a[238:239], v5 offset:16928
ds_read_b64_tr_b16 a[240:241], v5 offset:15424
ds_read_b64_tr_b16 a[242:243], v5 offset:16960
s_waitcnt lgkmcnt(0)
s_waitcnt vmcnt(0)
ds_read_b64_tr_b16 a[244:245], v5 offset:18432
ds_read_b64_tr_b16 a[246:247], v5 offset:19968
ds_read_b64_tr_b16 a[248:249], v5 offset:18464
ds_read_b64_tr_b16 a[250:251], v5 offset:20000
ds_read_b64_tr_b16 a[252:253], v5 offset:18496
ds_read_b64_tr_b16 a[254:255], v5 offset:20032
s_waitcnt lgkmcnt(0)
s_branch L_w_adone_in
L_w_adone:
s_sleep 4
L_w_adone_in:
buffer_load_dword v12, v8, s[24:27], 0 offen offset:4 sc0 sc1
s_sub_u32 s36, s36, 1
s_cbranch_scc1 L_exit_w
s_waitcnt vmcnt(0)
v_readfirstlane_b32 s37, v12
s_nop 0
s_cmp_eq_u32 s37, 96
s_cbranch_scc0 L_w_adone
s_mov_b32 s35, 0
s_mul_i32 s52, s34, 5
s_mul_i32 s58, s34, 3072
v_add_u32 v2, s58, v14
s_lshl_b32 s37, s34, 10
v_add_u32 v14, s37, v14
s_cmp_eq_u32 s34, 3
s_cselect_b32 s37, 0x400000, 0
v_add_u32 v15, s37, v15
L_w_wait:
s_and_b32 s57, s48, 7
s_lshl_b32 s57, s57, 10
s_add_u32 s57, s57, 331776
s_lshr_b32 s35, s48, 3
s_add_u32 s37, s52, 0
s_min_u32 s37, s37, 17
s_lshl_b32 s37, s37, 10
s_add_u32 s37, s37, s54
buffer_load_dwordx4 v[40:43], v1, s[4:7], s37 offen sc1
s_add_u32 s37, s52, 1
s_min_u32 s37, s37, 17
s_lshl_b32 s37, s37, 10
s_add_u32 s37, s37, s54
buffer_load_dwordx4 v[44:47], v1, s[4:7], s37 offen sc1
s_add_u32 s37, s52, 2
s_min_u32 s37, s37, 17
s_lshl_b32 s37, s37, 10
s_add_u32 s37, s37, s54
buffer_load_dwordx4 v[48:51], v1, s[4:7], s37 offen sc1
s_add_u32 s37, s52, 3
s_min_u32 s37, s37, 17
s_lshl_b32 s37, s37, 10
s_add_u32 s37, s37, s54
buffer_load_dwordx4 v[52:55], v1, s[4:7], s37 offen sc1
s_add_u32 s37, s52, 4
s_min_u32 s37, s37, 17
s_lshl_b32 s37, s37, 10
s_add_u32 s37, s37, s54
buffer_load_dwordx4 v[56:59], v1, s[4:7], s37 offen sc1
buffer_load_dword v4, v10, s[4:7], s56 offen sc1
s_waitcnt vmcnt(5)
v_mfma_f32_16x16x32_bf16 v[28:31], v[68:71], v[40:43], 0
v_mfma_f32_16x16x32_bf16 v[32:35], v[72:75], v[40:43], 0
v_mfma_f32_16x16x32_bf16 v[36:39], v[76:79], v[40:43], 0
s_waitcnt vmcnt(4)
v_mfma_f32_16x16x32_bf16 v[28:31], v[80:83], v[44:47], v[28:31]
v_mfma_f32_16x16x32_bf16 v[32:35], v[84:87], v[44:47], v[32:35]
v_mfma_f32_16x16x32_bf16 v[36:39], v[88:91], v[44:47], v[36:39]
s_waitcnt vmcnt(3)
v_mfma_f32_16x16x32_bf16 v[28:31], v[92:95], v[48:51], v[28:31]
v_mfma_f32_16x16x32_bf16 v[32:35], v[96:99], v[48:51], v[32:35]
v_mfma_f32_16x16x32_bf16 v[36:39], v[100:103], v[48:51], v[36:39]
s_waitcnt vmcnt(2)
v_mfma_f32_16x16x32_bf16 v[28:31], v[104:107], v[52:55], v[28:31]
v_mfma_f32_16x16x32_bf16 v[32:35], v[108:111], v[52:55], v[32:35]
v_mfma_f32_16x16x32_bf16 v[36:39], v[112:115], v[52:55], v[36:39]
s_waitcnt vmcnt(1)
v_mfma_f32_16x16x32_bf16 v[28:31], v[116:119], v[56:59], v[28:31]
v_mfma_f32_16x16x32_bf16 v[32:35], v[120:123], v[56:59], v[32:35]
v_mfma_f32_16x16x32_bf16 v[36:39], v[124:127], v[56:59], v[36:39]
s_branch L_w_poll_in
L_w_poll:
s_sleep 2
L_w_poll_in:
buffer_load_dword v12, v9, s[4:7], s57 offen offset:0 sc0 sc1
s_sub_u32 s36, s36, 1
s_cbranch_scc1 L_exit_w
s_waitcnt vmcnt(0)
v_cmp_ge_u32 vcc, s35, v12
s_nop 1
s_cmp_eq_u64 vcc, 0
s_cbranch_scc0 L_w_poll
s_add_u32 s37, s53, 0
s_add_u32 m0, s50, 0
s_nop 0
buffer_load_dwordx4 v1, s[4:7], s37 offen offset:0 sc1 lds
buffer_load_dwordx4 v1, s[4:7], s37 offen offset:1024 sc1 lds
buffer_load_dwordx4 v1, s[4:7], s37 offen offset:2048 sc1 lds
buffer_load_dwordx4 v1, s[4:7], s37 offen offset:3072 sc1 lds
s_add_u32 s37, s53, 4096
s_add_u32 m0, s50, 4096
s_nop 0
buffer_load_dwordx4 v1, s[4:7], s37 offen offset:0 sc1 lds
buffer_load_dwordx4 v1, s[4:7], s37 offen offset:1024 sc1 lds
buffer_load_dwordx4 v1, s[4:7], s37 offen offset:2048 sc1 lds
buffer_load_dwordx4 v1, s[4:7], s37 offen offset:3072 sc1 lds
s_add_u32 s37, s53, 8192
s_add_u32 m0, s50, 8192
s_nop 0
buffer_load_dwordx4 v1, s[4:7], s37 offen offset:0 sc1 lds
buffer_load_dwordx4 v1, s[4:7], s37 offen offset:1024 sc1 lds
buffer_load_dwordx4 v1, s[4:7], s37 offen offset:2048 sc1 lds
buffer_load_dwordx4 v1, s[4:7], s37 offen offset:3072 sc1 lds
s_add_u32 s37, s53, 12288
s_add_u32 m0, s50, 12288
s_nop 0
buffer_load_dwordx4 v1, s[4:7], s37 offen offset:0 sc1 lds
buffer_load_dwordx4 v1, s[4:7], s37 offen offset:1024 sc1 lds
buffer_load_dwordx4 v1, s[4:7], s37 offen offset:2048 sc1 lds
buffer_load_dwordx4 v1, s[4:7], s37 offen offset:3072 sc1 lds
s_branch L_w_b
L_w_ready:
s_add_u32 s37, s52, 0
s_min_u32 s37, s37, 17
s_lshl_b32 s37, s37, 10
s_add_u32 s37, s37, s54
buffer_load_dwordx4 v[40:43], v1, s[4:7], s37 offen sc1
s_add_u32 s37, s52, 1
s_min_u32 s37, s37, 17
s_lshl_b32 s37, s37, 10
s_add_u32 s37, s37, s54
buffer_load_dwordx4 v[44:47], v1, s[4:7], s37 offen sc1
s_add_u32 s37, s52, 2
s_min_u32 s37, s37, 17
s_lshl_b32 s37, s37, 10
s_add_u32 s37, s37, s54
buffer_load_dwordx4 v[48:51], v1, s[4:7], s37 offen sc1
s_add_u32 s37, s52, 3
s_min_u32 s37, s37, 17
s_lshl_b32 s37, s37, 10
s_add_u32 s37, s37, s54
buffer_load_dwordx4 v[52:55], v1, s[4:7], s37 offen sc1
s_add_u32 s37, s52, 4
s_min_u32 s37, s37, 17
s_lshl_b32 s37, s37, 10
s_add_u32 s37, s37, s54
buffer_load_dwordx4 v[56:59], v1, s[4:7], s37 offen sc1
buffer_load_dword v4, v10, s[4:7], s56 offen sc1
s_add_u32 s37, s53, 0
s_add_u32 m0, s50, 0
s_nop 0
buffer_load_dwordx4 v1, s[4:7], s37 offen offset:0 sc1 lds
buffer_load_dwordx4 v1, s[4:7], s37 offen offset:1024 sc1 lds
buffer_load_dwordx4 v1, s[4:7], s37 offen offset:2048 sc1 lds
buffer_load_dwordx4 v1, s[4:7], s37 offen offset:3072 sc1 lds
s_add_u32 s37, s53, 4096
s_add_u32 m0, s50, 4096
s_nop 0
buffer_load_dwordx4 v1, s[4:7], s37 offen offset:0 sc1 lds
buffer_load_dwordx4 v1, s[4:7], s37 offen offset:1024 sc1 lds
buffer_load_dwordx4 v1, s[4:7], s37 offen offset:2048 sc1 lds
buffer_load_dwordx4 v1, s[4:7], s37 offen offset:3072 sc1 lds
s_add_u32 s37, s53, 8192
s_add_u32 m0, s50, 8192
s_nop 0
buffer_load_dwordx4 v1, s[4:7], s37 offen offset:0 sc1 lds
buffer_load_dwordx4 v1, s[4:7], s37 offen offset:1024 sc1 lds
buffer_load_dwordx4 v1, s[4:7], s37 offen offset:2048 sc1 lds
buffer_load_dwordx4 v1, s[4:7], s37 offen offset:3072 sc1 lds
s_add_u32 s37, s53, 12288
s_add_u32 m0, s50, 12288
s_nop 0
buffer_load_dwordx4 v1, s[4:7], s37 offen offset:0 sc1 lds
buffer_load_dwordx4 v1, s[4:7], s37 offen offset:1024 sc1 lds
buffer_load_dwordx4 v1, s[4:7], s37 offen offset:2048 sc1 lds
buffer_load_dwordx4 v1, s[4:7], s37 offen offset:3072 sc1 lds
s_waitcnt lgkmcnt(0)
s_barrier
ds_read_b128 v[16:19], v14 offset:0
ds_read_b128 v[20:23], v14 offset:3072
ds_read_b128 v[24:27], v14 offset:6144
ds_read_b128 v[28:31], v14 offset:9216
s_waitcnt lgkmcnt(0)
v_pk_add_f32 v[16:17], v[16:17], v[20:21]
v_pk_add_f32 v[18:19], v[18:19], v[22:23]
v_pk_add_f32 v[24:25], v[24:25], v[28:29]
v_pk_add_f32 v[26:27], v[26:27], v[30:31]
v_pk_add_f32 v[16:17], v[16:17], v[24:25]
v_pk_add_f32 v[18:19], v[18:19], v[26:27]
v_cvt_pk_bf16_f32 v60, v16, v17
v_cvt_pk_bf16_f32 v61, v18, v19
v_xor_b32 v14, 16384, v14
buffer_store_dwordx2 v[60:61], v15, s[28:31], s59 offen
s_waitcnt vmcnt(22)
v_mfma_f32_16x16x32_bf16 v[28:31], v[68:71], v[40:43], 0
v_mfma_f32_16x16x32_bf16 v[32:35], v[72:75], v[40:43], 0
v_mfma_f32_16x16x32_bf16 v[36:39], v[76:79], v[40:43], 0
s_waitcnt vmcnt(21)
v_mfma_f32_16x16x32_bf16 v[28:31], v[80:83], v[44:47], v[28:31]
v_mfma_f32_16x16x32_bf16 v[32:35], v[84:87], v[44:47], v[32:35]
v_mfma_f32_16x16x32_bf16 v[36:39], v[88:91], v[44:47], v[36:39]
s_waitcnt vmcnt(20)
v_mfma_f32_16x16x32_bf16 v[28:31], v[92:95], v[48:51], v[28:31]
v_mfma_f32_16x16x32_bf16 v[32:35], v[96:99], v[48:51], v[32:35]
v_mfma_f32_16x16x32_bf16 v[36:39], v[100:103], v[48:51], v[36:39]
s_waitcnt vmcnt(19)
v_mfma_f32_16x16x32_bf16 v[28:31], v[104:107], v[52:55], v[28:31]
v_mfma_f32_16x16x32_bf16 v[32:35], v[108:111], v[52:55], v[32:35]
v_mfma_f32_16x16x32_bf16 v[36:39], v[112:115], v[52:55], v[36:39]
s_waitcnt vmcnt(18)
v_mfma_f32_16x16x32_bf16 v[28:31], v[116:119], v[56:59], v[28:31]
v_mfma_f32_16x16x32_bf16 v[32:35], v[120:123], v[56:59], v[32:35]
v_mfma_f32_16x16x32_bf16 v[36:39], v[124:127], v[56:59], v[36:39]
L_w_b:
s_waitcnt vmcnt(15)
ds_read_b128 v[40:43], v7 offset:0
s_waitcnt vmcnt(14)
ds_read_b128 v[44:47], v7 offset:1024
s_add_u32 s37, s53, 16384
s_add_u32 m0, s50, 16384
s_nop 0
buffer_load_dwordx4 v1, s[4:7], s37 offen offset:0 sc1 lds
s_waitcnt vmcnt(14)
ds_read_b128 v[48:51], v7 offset:2048
s_waitcnt lgkmcnt(2)
v_mfma_f32_16x16x32_bf16 v[16:19], v[128:131], v[40:43], 0
v_mfma_f32_16x16x32_bf16 v[20:23], v[132:135], v[40:43], 0
v_mfma_f32_16x16x32_bf16 v[24:27], v[136:139], v[40:43], 0
buffer_load_dwordx4 v1, s[4:7], s37 offen offset:1024 sc1 lds
s_waitcnt vmcnt(14)
ds_read_b128 v[52:55], v7 offset:3072
s_waitcnt lgkmcnt(2)
v_mfma_f32_16x16x32_bf16 v[16:19], v[140:143], v[44:47], v[16:19]
v_mfma_f32_16x16x32_bf16 v[20:23], v[144:147], v[44:47], v[20:23]
v_mfma_f32_16x16x32_bf16 v[24:27], v[148:151], v[44:47], v[24:27]
buffer_load_dwordx4 v1, s[4:7], s37 offen offset:2048 sc1 lds
s_waitcnt vmcnt(14)
ds_read_b128 v[40:43], v7 offset:4096
s_waitcnt lgkmcnt(2)
v_mfma_f32_16x16x32_bf16 v[16:19], v[152:155], v[48:51], v[16:19]
v_mfma_f32_16x16x32_bf16 v[20:23], v[156:159], v[48:51], v[20:23]
v_mfma_f32_16x16x32_bf16 v[24:27], v[160:163], v[48:51], v[24:27]
buffer_load_dwordx4 v1, s[4:7], s37 offen offset:3072 sc1 lds
s_waitcnt vmcnt(14)
ds_read_b128 v[44:47], v7 offset:5120
s_waitcnt lgkmcnt(2)
v_mfma_f32_16x16x32_bf16 v[16:19], v[164:167], v[52:55], v[16:19]
v_mfma_f32_16x16x32_bf16 v[20:23], v[168:171], v[52:55], v[20:23]
v_mfma_f32_16x16x32_bf16 v[24:27], v[172:175], v[52:55], v[24:27]
s_add_u32 s37, s53, 20480
s_add_u32 m0, s50, 20480
s_nop 0
buffer_load_dwordx4 v1, s[4:7], s37 offen offset:0 sc1 lds
s_waitcnt vmcnt(14)
ds_read_b128 v[48:51], v7 offset:6144
s_waitcnt lgkmcnt(2)
v_mfma_f32_16x16x32_bf16 v[16:19], v[176:179], v[40:43], v[16:19]
v_mfma_f32_16x16x32_bf16 v[20:23], v[180:183], v[40:43], v[20:23]
v_mfma_f32_16x16x32_bf16 v[24:27], v[184:187], v[40:43], v[24:27]
buffer_load_dwordx4 v1, s[4:7], s37 offen offset:1024 sc1 lds
s_waitcnt vmcnt(14)
ds_read_b128 v[52:55], v7 offset:7168
s_waitcnt lgkmcnt(2)
v_mfma_f32_16x16x32_bf16 v[16:19], v[188:191], v[44:47], v[16:19]
v_mfma_f32_16x16x32_bf16 v[20:23], v[192:195], v[44:47], v[20:23]
v_mfma_f32_16x16x32_bf16 v[24:27], v[196:199], v[44:47], v[24:27]
buffer_load_dwordx4 v1, s[4:7], s37 offen offset:2048 sc1 lds
s_waitcnt vmcnt(14)
ds_read_b128 v[40:43], v7 offset:8192
s_waitcnt lgkmcnt(2)
v_mfma_f32_16x16x32_bf16 v[16:19], v[200:203], v[48:51], v[16:19]
v_mfma_f32_16x16x32_bf16 v[20:23], v[204:207], v[48:51], v[20:23]
v_mfma_f32_16x16x32_bf16 v[24:27], v[208:211], v[48:51], v[24:27]
buffer_load_dwordx4 v1, s[4:7], s37 offen offset:3072 sc1 lds
s_waitcnt vmcnt(14)
ds_read_b128 v[44:47], v7 offset:9216
s_waitcnt lgkmcnt(2)
v_mfma_f32_16x16x32_bf16 v[16:19], v[212:215], v[52:55], v[16:19]
v_mfma_f32_16x16x32_bf16 v[20:23], v[216:219], v[52:55], v[20:23]
v_mfma_f32_16x16x32_bf16 v[24:27], v[220:223], v[52:55], v[24:27]
s_add_u32 s37, s53, 24576
s_add_u32 m0, s50, 24576
s_nop 0
buffer_load_dwordx4 v1, s[4:7], s37 offen offset:0 sc1 lds
s_waitcnt vmcnt(14)
ds_read_b128 v[48:51], v7 offset:10240
s_waitcnt lgkmcnt(2)
v_mfma_f32_16x16x32_bf16 v[16:19], v[224:227], v[40:43], v[16:19]
v_mfma_f32_16x16x32_bf16 v[20:23], v[228:231], v[40:43], v[20:23]
v_mfma_f32_16x16x32_bf16 v[24:27], v[232:235], v[40:43], v[24:27]
buffer_load_dwordx4 v1, s[4:7], s37 offen offset:1024 sc1 lds
s_waitcnt vmcnt(14)
ds_read_b128 v[52:55], v7 offset:11264
s_waitcnt lgkmcnt(2)
v_mfma_f32_16x16x32_bf16 v[16:19], v[236:239], v[44:47], v[16:19]
v_mfma_f32_16x16x32_bf16 v[20:23], v[240:243], v[44:47], v[20:23]
v_mfma_f32_16x16x32_bf16 v[24:27], v[244:247], v[44:47], v[24:27]
buffer_load_dwordx4 v1, s[4:7], s37 offen offset:2048 sc1 lds
s_waitcnt vmcnt(14)
ds_read_b128 v[40:43], v7 offset:12288
s_waitcnt lgkmcnt(2)
v_mfma_f32_16x16x32_bf16 v[16:19], v[248:251], v[48:51], v[16:19]
v_mfma_f32_16x16x32_bf16 v[20:23], v[252:255], v[48:51], v[20:23]
v_mfma_f32_16x16x32_bf16 v[24:27], a[0:3], v[48:51], v[24:27]
buffer_load_dwordx4 v1, s[4:7], s37 offen offset:3072 sc1 lds
s_waitcnt vmcnt(14)
ds_read_b128 v[44:47], v7 offset:13312
s_waitcnt lgkmcnt(2)
v_mfma_f32_16x16x32_bf16 v[16:19], a[4:7], v[52:55], v[16:19]
v_mfma_f32_16x16x32_bf16 v[20:23], a[8:11], v[52:55], v[20:23]
v_mfma_f32_16x16x32_bf16 v[24:27], a[12:15], v[52:55], v[24:27]
s_add_u32 s37, s53, 28672
s_add_u32 m0, s50, 28672
s_nop 0
buffer_load_dwordx4 v1, s[4:7], s37 offen offset:0 sc1 lds
s_waitcnt vmcnt(14)
ds_read_b128 v[48:51], v7 offset:14336
s_waitcnt lgkmcnt(2)
v_mfma_f32_16x16x32_bf16 v[16:19], a[16:19], v[40:43], v[16:19]
v_mfma_f32_16x16x32_bf16 v[20:23], a[20:23], v[40:43], v[20:23]
v_mfma_f32_16x16x32_bf16 v[24:27], a[24:27], v[40:43], v[24:27]
buffer_load_dwordx4 v1, s[4:7], s37 offen offset:1024 sc1 lds
s_waitcnt vmcnt(14)
ds_read_b128 v[52:55], v7 offset:15360
s_waitcnt lgkmcnt(2)
v_mfma_f32_16x16x32_bf16 v[16:19], a[28:31], v[44:47], v[16:19]
v_mfma_f32_16x16x32_bf16 v[20:23], a[32:35], v[44:47], v[20:23]
v_mfma_f32_16x16x32_bf16 v[24:27], a[36:39], v[44:47], v[24:27]
buffer_load_dwordx4 v1, s[4:7], s37 offen offset:2048 sc1 lds
s_waitcnt vmcnt(14)
ds_read_b128 v[40:43], v7 offset:16384
s_waitcnt lgkmcnt(2)
v_mfma_f32_16x16x32_bf16 v[16:19], a[40:43], v[48:51], v[16:19]
v_mfma_f32_16x16x32_bf16 v[20:23], a[44:47], v[48:51], v[20:23]
v_mfma_f32_16x16x32_bf16 v[24:27], a[48:51], v[48:51], v[24:27]
buffer_load_dwordx4 v1, s[4:7], s37 offen offset:3072 sc1 lds
s_add_u32 s38, s48, 5
s_and_b32 s57, s38, 7
s_lshl_b32 s57, s57, 10
s_add_u32 s57, s57, 331776
s_lshr_b32 s35, s38, 3
buffer_load_dword v3, v9, s[4:7], s57 offen sc0 sc1
s_waitcnt vmcnt(15)
ds_read_b128 v[44:47], v7 offset:17408
s_waitcnt lgkmcnt(2)
v_mfma_f32_16x16x32_bf16 v[16:19], a[52:55], v[52:55], v[16:19]
v_mfma_f32_16x16x32_bf16 v[20:23], a[56:59], v[52:55], v[20:23]
v_mfma_f32_16x16x32_bf16 v[24:27], a[60:63], v[52:55], v[24:27]
s_waitcnt vmcnt(14)
ds_read_b128 v[48:51], v7 offset:18432
s_waitcnt lgkmcnt(2)
v_mfma_f32_16x16x32_bf16 v[16:19], a[64:67], v[40:43], v[16:19]
v_mfma_f32_16x16x32_bf16 v[20:23], a[68:71], v[40:43], v[20:23]
v_mfma_f32_16x16x32_bf16 v[24:27], a[72:75], v[40:43], v[24:27]
s_waitcnt vmcnt(13)
ds_read_b128 v[52:55], v7 offset:19456
s_waitcnt lgkmcnt(2)
v_mfma_f32_16x16x32_bf16 v[16:19], a[76:79], v[44:47], v[16:19]
v_mfma_f32_16x16x32_bf16 v[20:23], a[80:83], v[44:47], v[20:23]
v_mfma_f32_16x16x32_bf16 v[24:27], a[84:87], v[44:47], v[24:27]
s_waitcnt vmcnt(12)
ds_read_b128 v[40:43], v7 offset:20480
s_waitcnt lgkmcnt(2)
v_mfma_f32_16x16x32_bf16 v[16:19], a[88:91], v[48:51], v[16:19]
v_mfma_f32_16x16x32_bf16 v[20:23], a[92:95], v[48:51], v[20:23]
v_mfma_f32_16x16x32_bf16 v[24:27], a[96:99], v[48:51], v[24:27]
s_waitcnt vmcnt(11)
ds_read_b128 v[44:47], v7 offset:21504
s_waitcnt lgkmcnt(2)
v_mfma_f32_16x16x32_bf16 v[16:19], a[100:103], v[52:55], v[16:19]
v_mfma_f32_16x16x32_bf16 v[20:23], a[104:107], v[52:55], v[20:23]
v_mfma_f32_16x16x32_bf16 v[24:27], a[108:111], v[52:55], v[24:27]
s_waitcnt vmcnt(10)
ds_read_b128 v[48:51], v7 offset:22528
s_waitcnt lgkmcnt(2)
v_mfma_f32_16x16x32_bf16 v[16:19], a[112:115], v[40:43], v[16:19]
v_mfma_f32_16x16x32_bf16 v[20:23], a[116:119], v[40:43], v[20:23]
v_mfma_f32_16x16x32_bf16 v[24:27], a[120:123], v[40:43], v[24:27]
s_waitcnt vmcnt(9)
ds_read_b128 v[52:55], v7 offset:23552
s_waitcnt lgkmcnt(2)
v_mfma_f32_16x16x32_bf16 v[16:19], a[124:127], v[44:47], v[16:19]
v_mfma_f32_16x16x32_bf16 v[20:23], a[128:131], v[44:47], v[20:23]
v_mfma_f32_16x16x32_bf16 v[24:27], a[132:135], v[44:47], v[24:27]
s_waitcnt vmcnt(8)
ds_read_b128 v[40:43], v7 offset:24576
s_waitcnt lgkmcnt(2)
v_mfma_f32_16x16x32_bf16 v[16:19], a[136:139], v[48:51], v[16:19]
v_mfma_f32_16x16x32_bf16 v[20:23], a[140:143], v[48:51], v[20:23]
v_mfma_f32_16x16x32_bf16 v[24:27], a[144:147], v[48:51], v[24:27]
s_waitcnt vmcnt(7)
ds_read_b128 v[44:47], v7 offset:25600
s_waitcnt lgkmcnt(2)
v_mfma_f32_16x16x32_bf16 v[16:19], a[148:151], v[52:55], v[16:19]
v_mfma_f32_16x16x32_bf16 v[20:23], a[152:155], v[52:55], v[20:23]
v_mfma_f32_16x16x32_bf16 v[24:27], a[156:159], v[52:55], v[24:27]
s_waitcnt vmcnt(6)
ds_read_b128 v[48:51], v7 offset:26624
s_waitcnt lgkmcnt(2)
v_mfma_f32_16x16x32_bf16 v[16:19], a[160:163], v[40:43], v[16:19]
v_mfma_f32_16x16x32_bf16 v[20:23], a[164:167], v[40:43], v[20:23]
v_mfma_f32_16x16x32_bf16 v[24:27], a[168:171], v[40:43], v[24:27]
s_waitcnt vmcnt(5)
ds_read_b128 v[52:55], v7 offset:27648
s_waitcnt lgkmcnt(2)
v_mfma_f32_16x16x32_bf16 v[16:19], a[172:175], v[44:47], v[16:19]
v_mfma_f32_16x16x32_bf16 v[20:23], a[176:179], v[44:47], v[20:23]
v_mfma_f32_16x16x32_bf16 v[24:27], a[180:183], v[44:47], v[24:27]
s_waitcnt vmcnt(4)
ds_read_b128 v[40:43], v7 offset:28672
s_waitcnt lgkmcnt(2)
v_mfma_f32_16x16x32_bf16 v[16:19], a[184:187], v[48:51], v[16:19]
v_mfma_f32_16x16x32_bf16 v[20:23], a[188:191], v[48:51], v[20:23]
v_mfma_f32_16x16x32_bf16 v[24:27], a[192:195], v[48:51], v[24:27]
s_waitcnt vmcnt(3)
ds_read_b128 v[44:47], v7 offset:29696
s_waitcnt lgkmcnt(2)
v_mfma_f32_16x16x32_bf16 v[16:19], a[196:199], v[52:55], v[16:19]
v_mfma_f32_16x16x32_bf16 v[20:23], a[200:203], v[52:55], v[20:23]
v_mfma_f32_16x16x32_bf16 v[24:27], a[204:207], v[52:55], v[24:27]
s_waitcnt vmcnt(2)
ds_read_b128 v[48:51], v7 offset:30720
s_waitcnt lgkmcnt(2)
v_mfma_f32_16x16x32_bf16 v[16:19], a[208:211], v[40:43], v[16:19]
v_mfma_f32_16x16x32_bf16 v[20:23], a[212:215], v[40:43], v[20:23]
v_mfma_f32_16x16x32_bf16 v[24:27], a[216:219], v[40:43], v[24:27]
s_waitcnt vmcnt(1)
ds_read_b128 v[52:55], v7 offset:31744
s_waitcnt lgkmcnt(2)
v_mfma_f32_16x16x32_bf16 v[16:19], a[220:223], v[44:47], v[16:19]
v_mfma_f32_16x16x32_bf16 v[20:23], a[224:227], v[44:47], v[20:23]
v_mfma_f32_16x16x32_bf16 v[24:27], a[228:231], v[44:47], v[24:27]
s_waitcnt lgkmcnt(1)
v_mfma_f32_16x16x32_bf16 v[16:19], a[232:235], v[48:51], v[16:19]
v_mfma_f32_16x16x32_bf16 v[20:23], a[236:239], v[48:51], v[20:23]
v_mfma_f32_16x16x32_bf16 v[24:27], a[240:243], v[48:51], v[24:27]
s_waitcnt lgkmcnt(0)
v_mfma_f32_16x16x32_bf16 v[16:19], a[244:247], v[52:55], v[16:19]
v_mfma_f32_16x16x32_bf16 v[20:23], a[248:251], v[52:55], v[20:23]
v_mfma_f32_16x16x32_bf16 v[24:27], a[252:255], v[52:55], v[24:27]
s_mov_b32 s59, s55
s_add_u32 s55, s55, 92160
s_add_u32 s54, s54, 92160
s_add_u32 s53, s53, 655360
s_add_u32 s56, s56, 320
s_add_u32 s48, s48, 5
v_fma_f32 v16, v16, v4, v28
v_fma_f32 v17, v17, v4, v29
v_fma_f32 v18, v18, v4, v30
v_fma_f32 v19, v19, v4, v31
ds_write_b128 v2, v[16:19] offset:0
v_fma_f32 v20, v20, v4, v32
v_fma_f32 v21, v21, v4, v33
v_fma_f32 v22, v22, v4, v34
v_fma_f32 v23, v23, v4, v35
ds_write_b128 v2, v[20:23] offset:1024
v_fma_f32 v24, v24, v4, v36
v_fma_f32 v25, v25, v4, v37
v_fma_f32 v26, v26, v4, v38
v_fma_f32 v27, v27, v4, v39
ds_write_b128 v2, v[24:27] offset:2048
v_xor_b32 v2, 16384, v2
s_cmp_ge_u32 s48, 128
s_cbranch_scc1 L_w_now
s_waitcnt vmcnt(0)
v_cmp_ge_u32 vcc, s35, v3
s_cbranch_vccz L_w_ready
L_w_now:
s_waitcnt lgkmcnt(0)
s_barrier
ds_read_b128 v[16:19], v14 offset:0
ds_read_b128 v[20:23], v14 offset:3072
ds_read_b128 v[24:27], v14 offset:6144
ds_read_b128 v[28:31], v14 offset:9216
s_waitcnt lgkmcnt(0)
v_pk_add_f32 v[16:17], v[16:17], v[20:21]
v_pk_add_f32 v[18:19], v[18:19], v[22:23]
v_pk_add_f32 v[24:25], v[24:25], v[28:29]
v_pk_add_f32 v[26:27], v[26:27], v[30:31]
v_pk_add_f32 v[16:17], v[16:17], v[24:25]
v_pk_add_f32 v[18:19], v[18:19], v[26:27]
v_cvt_pk_bf16_f32 v60, v16, v17
v_cvt_pk_bf16_f32 v61, v18, v19
v_xor_b32 v14, 16384, v14
buffer_store_dwordx2 v[60:61], v15, s[28:31], s59 offen
s_cmp_lt_u32 s48, 128
s_cbranch_scc1 L_w_wait
s_waitcnt vmcnt(0)
s_endpgm
L_pro_w0:
v_and_b32 v20, 63, v0
v_lshlrev_b32 v1, 4, v20
v_add_u32 v2, 16384, v1
v_and_b32 v23, 1, v22
v_lshl_add_u32 v23, v24, 4, v23
v_mul_u32_u24 v23, 1152, v23
v_lshlrev_b32 v28, 2, v22
v_xor_b32 v28, v28, v21
v_lshl_add_u32 v28, v28, 4, v23
s_mul_i32 s55, s32, 147456
v_lshrrev_b32 v23, 2, v21
v_and_b32 v24, 1, v21
v_lshl_add_u32 v23, v23, 1, v24
v_mul_u32_u24 v23, 1152, v23
v_lshl_add_u32 v23, v22, 5, v23
v_bfe_u32 v24, v21, 1, 1
v_lshl_add_u32 v23, v24, 4, v23
s_lshl_b32 s56, s32, 7
s_waitcnt lgkmcnt(0)
buffer_load_dwordx4 v[12:15], v23, s[24:27], s56 offen
v_and_b32 v23, 1, v22
v_lshrrev_b32 v24, 2, v21
v_lshl_add_u32 v23, v23, 2, v24
v_lshlrev_b32 v23, 1, v23
v_bfe_u32 v44, v21, 1, 1
v_add_u32 v44, 0, v44
v_xor_b32 v44, v44, v23
v_lshlrev_b32 v44, 4, v44
v_lshl_add_u32 v44, v24, 8, v44
v_and_b32 v23, 1, v22
v_lshl_add_u32 v44, v23, 11, v44
v_and_b32 v23, 1, v21
v_lshl_add_u32 v44, v23, 3, v44
v_lshrrev_b32 v23, 1, v22
v_mul_u32_u24 v23, 40960, v23
v_add_u32 v23, 16384, v23
v_add_u32 v44, v44, v23
v_and_b32 v23, 1, v22
v_lshrrev_b32 v24, 2, v21
v_lshl_add_u32 v23, v23, 2, v24
v_lshlrev_b32 v23, 1, v23
v_bfe_u32 v45, v21, 1, 1
v_add_u32 v45, 2, v45
v_xor_b32 v45, v45, v23
v_lshlrev_b32 v45, 4, v45
v_lshl_add_u32 v45, v24, 8, v45
v_and_b32 v23, 1, v22
v_lshl_add_u32 v45, v23, 11, v45
v_and_b32 v23, 1, v21
v_lshl_add_u32 v45, v23, 3, v45
v_lshrrev_b32 v23, 1, v22
v_mul_u32_u24 v23, 40960, v23
v_add_u32 v23, 16384, v23
v_add_u32 v45, v45, v23
v_and_b32 v23, 1, v22
v_lshrrev_b32 v24, 2, v21
v_lshl_add_u32 v23, v23, 2, v24
v_lshlrev_b32 v23, 1, v23
v_bfe_u32 v46, v21, 1, 1
v_add_u32 v46, 0, v46
v_xor_b32 v46, v46, v23
v_lshlrev_b32 v46, 4, v46
v_lshl_add_u32 v46, v24, 8, v46
v_and_b32 v23, 1, v22
v_lshl_add_u32 v46, v23, 11, v46
v_and_b32 v23, 1, v21
v_lshl_add_u32 v46, v23, 3, v46
v_lshrrev_b32 v23, 1, v22
v_mul_u32_u24 v23, 32768, v23
v_add_u32 v23, 98304, v23
v_add_u32 v46, v46, v23
v_and_b32 v23, 1, v22
v_lshrrev_b32 v24, 2, v21
v_lshl_add_u32 v23, v23, 2, v24
v_lshlrev_b32 v23, 1, v23
v_bfe_u32 v47, v21, 1, 1
v_add_u32 v47, 2, v47
v_xor_b32 v47, v47, v23
v_lshlrev_b32 v47, 4, v47
v_lshl_add_u32 v47, v24, 8, v47
v_and_b32 v23, 1, v22
v_lshl_add_u32 v47, v23, 11, v47
v_and_b32 v23, 1, v21
v_lshl_add_u32 v47, v23, 3, v47
v_lshrrev_b32 v23, 1, v22
v_mul_u32_u24 v23, 32768, v23
v_add_u32 v23, 98304, v23
v_add_u32 v47, v47, v23
v_and_b32 v23, 1, v22
v_bfe_u32 v24, v21, 2, 1
v_lshl_add_u32 v23, v23, 1, v24
v_xor_b32 v24, 0, v23
v_lshlrev_b32 v24, 6, v24
v_lshl_add_u32 v48, v23, 8, v24
v_and_b32 v23, 3, v21
v_lshl_add_u32 v48, v23, 4, v48
v_and_b32 v23, 8, v21
v_add_u32 v48, v48, v23
v_lshrrev_b32 v23, 1, v22
v_mul_u32_u24 v23, 40960, v23
v_add_u32 v23, 16384, v23
v_add_u32 v48, v48, v23
v_and_b32 v23, 1, v22
v_bfe_u32 v24, v21, 2, 1
v_lshl_add_u32 v23, v23, 1, v24
v_xor_b32 v24, 0, v23
v_lshlrev_b32 v24, 6, v24
v_lshl_add_u32 v49, v23, 8, v24
v_and_b32 v23, 3, v21
v_lshl_add_u32 v49, v23, 4, v49
v_and_b32 v23, 8, v21
v_add_u32 v49, v49, v23
v_lshrrev_b32 v23, 1, v22
v_mul_u32_u24 v23, 32768, v23
v_add_u32 v23, 98304, v23
v_add_u32 v49, v49, v23
v_bfe_u32 v23, v21, 1, 1
v_mul_u32_u24 v23, 0xaaaa, v23
v_add_u32 v0, 0x4444, v23
v_lshlrev_b32 v3, 3, v20
v_lshrrev_b32 v25, 5, v20
v_lshlrev_b32 v25, 6, v25
v_xor_b32 v3, v3, v25
v_lshrrev_b32 v25, 2, v20
v_and_b32 v4, 3, v21
v_lshl_add_u32 v4, v4, 4, v25
v_lshlrev_b32 v4, 3, v4
v_bfe_u32 v25, v21, 1, 1
v_lshlrev_b32 v23, 6, v25
v_xor_b32 v4, v4, v23
v_lshlrev_b32 v5, 4, v21
v_lshl_add_u32 v5, v22, 2, v5
v_mul_u32_u24 v23, 1024, v25
v_add_u32 v5, v5, v23
v_lshlrev_b32 v9, 8, v22
v_lshl_add_u32 v9, v25, 6, v9
v_bfe_u32 v23, v21, 3, 1
v_lshl_add_u32 v9, v23, 7, v9
v_bfe_u32 v23, v21, 2, 1
v_lshl_add_u32 v9, v23, 5, v9
v_and_b32 v23, 1, v21
v_lshl_add_u32 v9, v23, 4, v9
v_lshrrev_b32 v23, 1, v22
v_and_b32 v24, 1, v22
v_and_b32 v25, 7, v21
v_lshrrev_b32 v7, 3, v21
v_lshl_add_u32 v8, v7, 1, v23
v_lshlrev_b32 v8, 12, v8
v_lshl_add_u32 v8, v24, 7, v8
v_and_b32 v25, 4, v21
v_lshl_add_u32 v8, v25, 3, v8
v_and_b32 v25, 1, v21
v_lshl_add_u32 v8, v25, 4, v8
v_bfe_u32 v25, v21, 1, 1
v_lshl_add_u32 v8, v25, 3, v8
s_lshr_b32 s56, s32, 1
s_lshl_b32 s56, s56, 8
s_and_b32 s57, s32, 1
s_lshl_b32 s57, s57, 6
s_add_u32 s56, s56, s57
s_add_u32 s56, s56, 0
v_add_u32 v8, s56, v8
v_and_b32 v7, 0x3d0, v1
s_mov_b32 s42, 0
s_mov_b32 s43, 65536
s_mov_b32 s44, 131072
s_mov_b32 s45, 196608
s_mov_b32 s46, 262144
s_mov_b32 s47, 294912
s_mov_b32 s48, 299008
s_mov_b32 s49, 303104
s_mov_b32 s50, 0x3e0293ee
s_mov_b32 s51, 0x3e0293ee
s_mov_b32 s52, 0x3f803f80
s_mov_b32 s53, 0x3f803f80
v_lshlrev_b32 v11, 2, v21
s_mov_b32 s34, 0
s_mov_b32 s35, -1
s_mov_b32 s36, 0
s_mov_b32 s41, 300000
s_lshl_b32 s37, s32, 14
s_add_u32 s39, s37, 17301504
s_add_u32 s37, s37, 16777216
s_mov_b32 s40, 8749056
v_mov_b64 v[36:37], 0
v_mov_b64 v[38:39], 0
ds_write_b128 v1, v[36:39] offset:14336
s_lshl_b32 s56, s32, 1
s_add_u32 s56, s56, 0
s_cmp_eq_u32 s56, 0
s_cselect_b32 s56, 64, s56
s_mul_i32 s56, s56, 10240
s_add_u32 s56, s56, 8388608
s_add_u32 s57, s56, 4096
v_mov_b32 v40, 0
v_mov_b32 v41, 0
v_mov_b32 v42, 0
v_mov_b32 v43, 0
buffer_store_dwordx4 v[40:43], v1, s[4:7], s56 offen offset:0 sc0 sc1
buffer_store_dwordx4 v[40:43], v1, s[4:7], s56 offen offset:1024 sc0 sc1
buffer_store_dwordx4 v[40:43], v1, s[4:7], s56 offen offset:2048 sc0 sc1
buffer_store_dwordx4 v[40:43], v1, s[4:7], s56 offen offset:3072 sc0 sc1
s_lshl_b32 s56, s32, 10
s_cmp_ge_u32 s32, 9
s_cselect_b32 s56, 268435456, s56
s_add_u32 s57, s56, 8388608
s_add_u32 s56, s56, 294912
s_waitcnt vmcnt(4)
v_or_b32 v12, 1, v12
buffer_store_dwordx4 v[12:15], v1, s[4:7], s56 offen sc0 sc1
buffer_store_dwordx4 v[12:15], v1, s[4:7], s57 offen sc0 sc1
s_getreg_b32 s56, hwreg(HW_REG_XCC_ID)
s_and_b32 s56, s56, 15
s_mul_i32 s57, s56, s56
s_lshl_b32 s57, s57, 18
s_lshl_b32 s56, s56, 8
s_add_u32 s57, s57, s56
s_add_u32 s58, s57, 1
s_lshl_b32 s101, s32, 7
s_add_u32 s101, s101, 327680
v_mov_b32 v24, 0
s_add_u32 s56, s54, 0
s_mov_b32 m0, 28672
s_nop 0
buffer_load_dwordx4 v26, s[12:15], s56 offen lds
s_add_u32 s56, s54, 16384
s_mov_b32 m0, 29696
s_nop 0
buffer_load_dwordx4 v26, s[12:15], s56 offen lds
s_add_u32 s56, s54, 32768
s_mov_b32 m0, 30720
s_nop 0
buffer_load_dwordx4 v27, s[12:15], s56 offen lds
s_add_u32 s56, s54, 49152
s_mov_b32 m0, 31744
s_nop 0
buffer_load_dwordx4 v27, s[12:15], s56 offen lds
s_add_u32 s56, s54, 524288
s_mov_b32 m0, 32768
s_nop 0
buffer_load_dwordx4 v26, s[12:15], s56 offen lds
s_add_u32 s56, s54, 540672
s_mov_b32 m0, 33792
s_nop 0
buffer_load_dwordx4 v26, s[12:15], s56 offen lds
s_add_u32 s56, s54, 557056
s_mov_b32 m0, 34816
s_nop 0
buffer_load_dwordx4 v27, s[12:15], s56 offen lds
s_add_u32 s56, s54, 573440
s_mov_b32 m0, 35840
s_nop 0
buffer_load_dwordx4 v27, s[12:15], s56 offen lds
v_and_b32 v23, 3, v20
v_lshrrev_b32 v24, 2, v20
v_mul_u32_u24 v29, 1152, v24
v_lshl_add_u32 v29, v23, 4, v29
v_lshrrev_b32 v24, 2, v21
v_and_b32 v25, 1, v22
v_lshlrev_b32 v31, 10, v25
v_lshrrev_b32 v25, 1, v22
v_lshl_add_u32 v31, v25, 8, v31
v_and_b32 v25, 1, v24
v_lshl_add_u32 v31, v25, 6, v31
v_lshrrev_b32 v25, 1, v24
v_lshl_add_u32 v31, v25, 3, v31
v_lshl_add_u32 v31, v23, 4, v31
v_add_u32 v31, 16384, v31
s_add_u32 s56, s55, 1024
s_mov_b32 m0, 49152
s_nop 0
buffer_load_dwordx4 v29, s[20:23], s56 offen lds
s_add_u32 s56, s55, 19456
s_mov_b32 m0, 50176
s_nop 0
buffer_load_dwordx4 v29, s[20:23], s56 offen lds
s_add_u32 s56, s55, 37888
s_mov_b32 m0, 51200
s_nop 0
buffer_load_dwordx4 v29, s[20:23], s56 offen lds
s_add_u32 s56, s55, 56320
s_mov_b32 m0, 52224
s_nop 0
buffer_load_dwordx4 v29, s[20:23], s56 offen lds
s_add_u32 s56, s55, 74752
s_mov_b32 m0, 53248
s_nop 0
buffer_load_dwordx4 v29, s[20:23], s56 offen lds
s_add_u32 s56, s55, 93184
s_mov_b32 m0, 54272
s_nop 0
buffer_load_dwordx4 v29, s[20:23], s56 offen lds
s_add_u32 s56, s55, 111616
s_mov_b32 m0, 55296
s_nop 0
buffer_load_dwordx4 v29, s[20:23], s56 offen lds
s_add_u32 s56, s55, 130048
s_mov_b32 m0, 56320
s_nop 0
buffer_load_dwordx4 v29, s[20:23], s56 offen lds
v_mov_b32 v24, 0
s_barrier
ds_read_b64_tr_b16 v[80:81], v44 offset:20480
ds_read_b64_tr_b16 v[82:83], v44 offset:21504
ds_read_b64_tr_b16 v[84:85], v46 offset:20480
ds_read_b64_tr_b16 v[86:87], v46 offset:21504
ds_read_b64_tr_b16 v[88:89], v45 offset:20480
ds_read_b64_tr_b16 v[90:91], v45 offset:21504
ds_read_b64_tr_b16 v[92:93], v47 offset:20480
ds_read_b64_tr_b16 v[94:95], v47 offset:21504
s_waitcnt lgkmcnt(0)
s_barrier
s_add_u32 s56, s54, 1048576
s_mov_b32 m0, 36864
s_nop 0
buffer_load_dwordx4 v26, s[12:15], s56 offen lds
s_add_u32 s56, s54, 1064960
s_mov_b32 m0, 37888
s_nop 0
buffer_load_dwordx4 v26, s[12:15], s56 offen lds
s_add_u32 s56, s54, 1081344
s_mov_b32 m0, 38912
s_nop 0
buffer_load_dwordx4 v27, s[12:15], s56 offen lds
s_add_u32 s56, s54, 1097728
s_mov_b32 m0, 39936
s_nop 0
buffer_load_dwordx4 v27, s[12:15], s56 offen lds
ds_read_b64_tr_b16 v[96:97], v44 offset:24576
ds_read_b64_tr_b16 v[98:99], v44 offset:25600
ds_read_b64_tr_b16 v[100:101], v46 offset:24576
ds_read_b64_tr_b16 v[102:103], v46 offset:25600
ds_read_b64_tr_b16 v[104:105], v45 offset:24576
ds_read_b64_tr_b16 v[106:107], v45 offset:25600
ds_read_b64_tr_b16 v[108:109], v47 offset:24576
ds_read_b64_tr_b16 v[110:111], v47 offset:25600
s_waitcnt lgkmcnt(0)
s_barrier
s_add_u32 s56, s54, 1572864
s_mov_b32 m0, 40960
s_nop 0
buffer_load_dwordx4 v26, s[12:15], s56 offen lds
s_add_u32 s56, s54, 1589248
s_mov_b32 m0, 41984
s_nop 0
buffer_load_dwordx4 v26, s[12:15], s56 offen lds
s_add_u32 s56, s54, 1605632
s_mov_b32 m0, 43008
s_nop 0
buffer_load_dwordx4 v27, s[12:15], s56 offen lds
s_add_u32 s56, s54, 1622016
s_mov_b32 m0, 44032
s_nop 0
buffer_load_dwordx4 v27, s[12:15], s56 offen lds
ds_read_b64_tr_b16 v[112:113], v44 offset:28672
ds_read_b64_tr_b16 v[114:115], v44 offset:29696
ds_read_b64_tr_b16 v[116:117], v46 offset:28672
ds_read_b64_tr_b16 v[118:119], v46 offset:29696
ds_read_b64_tr_b16 v[120:121], v45 offset:28672
ds_read_b64_tr_b16 v[122:123], v45 offset:29696
ds_read_b64_tr_b16 v[124:125], v47 offset:28672
ds_read_b64_tr_b16 v[126:127], v47 offset:29696
s_waitcnt lgkmcnt(0)
s_barrier
s_add_u32 s56, s54, 2097152
s_mov_b32 m0, 45056
s_nop 0
buffer_load_dwordx4 v26, s[12:15], s56 offen lds
s_add_u32 s56, s54, 2113536
s_mov_b32 m0, 46080
s_nop 0
buffer_load_dwordx4 v26, s[12:15], s56 offen lds
s_add_u32 s56, s54, 2129920
s_mov_b32 m0, 47104
s_nop 0
buffer_load_dwordx4 v27, s[12:15], s56 offen lds
s_add_u32 s56, s54, 2146304
s_mov_b32 m0, 48128
s_nop 0
buffer_load_dwordx4 v27, s[12:15], s56 offen lds
ds_read_b64_tr_b16 v[128:129], v44 offset:0
ds_read_b64_tr_b16 v[130:131], v44 offset:1024
ds_read_b64_tr_b16 v[132:133], v46 offset:0
ds_read_b64_tr_b16 v[134:135], v46 offset:1024
ds_read_b64_tr_b16 v[136:137], v45 offset:0
ds_read_b64_tr_b16 v[138:139], v45 offset:1024
ds_read_b64_tr_b16 v[140:141], v47 offset:0
ds_read_b64_tr_b16 v[142:143], v47 offset:1024
s_waitcnt lgkmcnt(0)
s_barrier
s_add_u32 s56, s54, 3145728
s_mov_b32 m0, 16384
s_nop 0
buffer_load_dwordx4 v26, s[12:15], s56 offen lds
s_add_u32 s56, s54, 3162112
s_mov_b32 m0, 17408
s_nop 0
buffer_load_dwordx4 v26, s[12:15], s56 offen lds
s_add_u32 s56, s54, 3178496
s_mov_b32 m0, 18432
s_nop 0
buffer_load_dwordx4 v27, s[12:15], s56 offen lds
s_add_u32 s56, s54, 3194880
s_mov_b32 m0, 19456
s_nop 0
buffer_load_dwordx4 v27, s[12:15], s56 offen lds
ds_read_b64_tr_b16 v[144:145], v44 offset:4096
ds_read_b64_tr_b16 v[146:147], v44 offset:5120
ds_read_b64_tr_b16 v[148:149], v46 offset:4096
ds_read_b64_tr_b16 v[150:151], v46 offset:5120
ds_read_b64_tr_b16 v[152:153], v45 offset:4096
ds_read_b64_tr_b16 v[154:155], v45 offset:5120
ds_read_b64_tr_b16 v[156:157], v47 offset:4096
ds_read_b64_tr_b16 v[158:159], v47 offset:5120
s_waitcnt lgkmcnt(0)
s_barrier
s_add_u32 s56, s54, 3670016
s_mov_b32 m0, 20480
s_nop 0
buffer_load_dwordx4 v26, s[12:15], s56 offen lds
s_add_u32 s56, s54, 3686400
s_mov_b32 m0, 21504
s_nop 0
buffer_load_dwordx4 v26, s[12:15], s56 offen lds
s_add_u32 s56, s54, 3702784
s_mov_b32 m0, 22528
s_nop 0
buffer_load_dwordx4 v27, s[12:15], s56 offen lds
s_add_u32 s56, s54, 3719168
s_mov_b32 m0, 23552
s_nop 0
buffer_load_dwordx4 v27, s[12:15], s56 offen lds
ds_read_b64_tr_b16 v[160:161], v44 offset:8192
ds_read_b64_tr_b16 v[162:163], v44 offset:9216
ds_read_b64_tr_b16 v[164:165], v46 offset:8192
ds_read_b64_tr_b16 v[166:167], v46 offset:9216
ds_read_b64_tr_b16 v[168:169], v45 offset:8192
ds_read_b64_tr_b16 v[170:171], v45 offset:9216
ds_read_b64_tr_b16 v[172:173], v47 offset:8192
ds_read_b64_tr_b16 v[174:175], v47 offset:9216
s_waitcnt lgkmcnt(0)
s_waitcnt vmcnt(32)
s_barrier
s_add_u32 s56, s54, 4194304
s_mov_b32 m0, 24576
s_nop 0
buffer_load_dwordx4 v26, s[12:15], s56 offen lds
s_add_u32 s56, s54, 4210688
s_mov_b32 m0, 25600
s_nop 0
buffer_load_dwordx4 v26, s[12:15], s56 offen lds
s_add_u32 s56, s54, 4227072
s_mov_b32 m0, 26624
s_nop 0
buffer_load_dwordx4 v27, s[12:15], s56 offen lds
s_add_u32 s56, s54, 4243456
s_mov_b32 m0, 27648
s_nop 0
buffer_load_dwordx4 v27, s[12:15], s56 offen lds
ds_read_b64_tr_b16 v[176:177], v44 offset:12288
ds_read_b64_tr_b16 v[178:179], v44 offset:13312
ds_read_b64_tr_b16 v[180:181], v46 offset:12288
ds_read_b64_tr_b16 v[182:183], v46 offset:13312
ds_read_b64_tr_b16 v[184:185], v45 offset:12288
ds_read_b64_tr_b16 v[186:187], v45 offset:13312
ds_read_b64_tr_b16 v[188:189], v47 offset:12288
ds_read_b64_tr_b16 v[190:191], v47 offset:13312
v_mov_b32 v23, s58
s_mov_b64 exec, 1
buffer_atomic_add v23, v24, s[28:31], 0 offen sc1
s_mov_b64 exec, -1
s_waitcnt lgkmcnt(0)
s_waitcnt vmcnt(33)
s_barrier
s_add_u32 s56, s54, 0
s_mov_b32 m0, 28672
s_nop 0
buffer_load_dwordx4 v26, s[16:19], s56 offen lds
s_add_u32 s56, s54, 16384
s_mov_b32 m0, 29696
s_nop 0
buffer_load_dwordx4 v26, s[16:19], s56 offen lds
s_add_u32 s56, s54, 32768
s_mov_b32 m0, 30720
s_nop 0
buffer_load_dwordx4 v27, s[16:19], s56 offen lds
s_add_u32 s56, s54, 49152
s_mov_b32 m0, 31744
s_nop 0
buffer_load_dwordx4 v27, s[16:19], s56 offen lds
ds_read_b64_tr_b16 v[192:193], v44 offset:16384
ds_read_b64_tr_b16 v[194:195], v44 offset:17408
ds_read_b64_tr_b16 v[196:197], v46 offset:16384
ds_read_b64_tr_b16 v[198:199], v46 offset:17408
ds_read_b64_tr_b16 v[200:201], v45 offset:16384
ds_read_b64_tr_b16 v[202:203], v45 offset:17408
ds_read_b64_tr_b16 v[204:205], v47 offset:16384
ds_read_b64_tr_b16 v[206:207], v47 offset:17408
s_waitcnt lgkmcnt(0)
s_waitcnt vmcnt(25)
s_barrier
s_add_u32 s56, s54, 524288
s_mov_b32 m0, 32768
s_nop 0
buffer_load_dwordx4 v26, s[16:19], s56 offen lds
s_add_u32 s56, s54, 540672
s_mov_b32 m0, 33792
s_nop 0
buffer_load_dwordx4 v26, s[16:19], s56 offen lds
s_add_u32 s56, s54, 557056
s_mov_b32 m0, 34816
s_nop 0
buffer_load_dwordx4 v27, s[16:19], s56 offen lds
s_add_u32 s56, s54, 573440
s_mov_b32 m0, 35840
s_nop 0
buffer_load_dwordx4 v27, s[16:19], s56 offen lds
ds_read_b64_tr_b16 v[208:209], v44 offset:20480
ds_read_b64_tr_b16 v[210:211], v44 offset:21504
ds_read_b64_tr_b16 v[212:213], v46 offset:20480
ds_read_b64_tr_b16 v[214:215], v46 offset:21504
ds_read_b64_tr_b16 v[216:217], v45 offset:20480
ds_read_b64_tr_b16 v[218:219], v45 offset:21504
ds_read_b64_tr_b16 v[220:221], v47 offset:20480
ds_read_b64_tr_b16 v[222:223], v47 offset:21504
s_waitcnt lgkmcnt(0)
s_waitcnt vmcnt(25)
s_barrier
s_add_u32 s56, s54, 1048576
s_mov_b32 m0, 36864
s_nop 0
buffer_load_dwordx4 v26, s[16:19], s56 offen lds
s_add_u32 s56, s54, 1064960
s_mov_b32 m0, 37888
s_nop 0
buffer_load_dwordx4 v26, s[16:19], s56 offen lds
s_add_u32 s56, s54, 1081344
s_mov_b32 m0, 38912
s_nop 0
buffer_load_dwordx4 v27, s[16:19], s56 offen lds
s_add_u32 s56, s54, 1097728
s_mov_b32 m0, 39936
s_nop 0
buffer_load_dwordx4 v27, s[16:19], s56 offen lds
ds_read_b64_tr_b16 v[224:225], v44 offset:24576
ds_read_b64_tr_b16 v[226:227], v44 offset:25600
ds_read_b64_tr_b16 v[228:229], v46 offset:24576
ds_read_b64_tr_b16 v[230:231], v46 offset:25600
ds_read_b64_tr_b16 v[232:233], v45 offset:24576
ds_read_b64_tr_b16 v[234:235], v45 offset:25600
ds_read_b64_tr_b16 v[236:237], v47 offset:24576
ds_read_b64_tr_b16 v[238:239], v47 offset:25600
ds_read_b64_tr_b16 v[60:61], v31 offset:32768
ds_read_b64_tr_b16 v[62:63], v31 offset:32896
ds_read_b64_tr_b16 v[64:65], v31 offset:33280
ds_read_b64_tr_b16 v[66:67], v31 offset:33408
ds_read_b64_tr_b16 v[68:69], v31 offset:34816
ds_read_b64_tr_b16 v[70:71], v31 offset:34944
ds_read_b64_tr_b16 v[72:73], v31 offset:35328
ds_read_b64_tr_b16 v[74:75], v31 offset:35456
s_waitcnt lgkmcnt(0)
ds_write_b128 v2, v[60:63] offset:32768
ds_write_b128 v2, v[64:67] offset:33792
ds_write_b128 v2, v[68:71] offset:34816
ds_write_b128 v2, v[72:75] offset:35840
s_waitcnt lgkmcnt(0)
s_waitcnt vmcnt(25)
s_barrier
s_add_u32 s56, s54, 1572864
s_mov_b32 m0, 40960
s_nop 0
buffer_load_dwordx4 v26, s[16:19], s56 offen lds
s_add_u32 s56, s54, 1589248
s_mov_b32 m0, 41984
s_nop 0
buffer_load_dwordx4 v26, s[16:19], s56 offen lds
s_add_u32 s56, s54, 1605632
s_mov_b32 m0, 43008
s_nop 0
buffer_load_dwordx4 v27, s[16:19], s56 offen lds
s_add_u32 s56, s54, 1622016
s_mov_b32 m0, 44032
s_nop 0
buffer_load_dwordx4 v27, s[16:19], s56 offen lds
ds_read_b64_tr_b16 v[240:241], v44 offset:28672
ds_read_b64_tr_b16 v[242:243], v44 offset:29696
ds_read_b64_tr_b16 v[244:245], v46 offset:28672
ds_read_b64_tr_b16 v[246:247], v46 offset:29696
ds_read_b64_tr_b16 v[248:249], v45 offset:28672
ds_read_b64_tr_b16 v[250:251], v45 offset:29696
ds_read_b64_tr_b16 v[252:253], v47 offset:28672
ds_read_b64_tr_b16 v[254:255], v47 offset:29696
ds_read_b64_tr_b16 v[60:61], v31 offset:36864
ds_read_b64_tr_b16 v[62:63], v31 offset:36992
ds_read_b64_tr_b16 v[64:65], v31 offset:37376
ds_read_b64_tr_b16 v[66:67], v31 offset:37504
ds_read_b64_tr_b16 v[68:69], v31 offset:38912
ds_read_b64_tr_b16 v[70:71], v31 offset:39040
ds_read_b64_tr_b16 v[72:73], v31 offset:39424
ds_read_b64_tr_b16 v[74:75], v31 offset:39552
s_waitcnt lgkmcnt(0)
ds_write_b128 v2, v[60:63] offset:36864
ds_write_b128 v2, v[64:67] offset:37888
ds_write_b128 v2, v[68:71] offset:38912
ds_write_b128 v2, v[72:75] offset:39936
s_waitcnt lgkmcnt(0)
s_waitcnt vmcnt(25)
s_barrier
s_add_u32 s56, s54, 2097152
s_mov_b32 m0, 45056
s_nop 0
buffer_load_dwordx4 v26, s[16:19], s56 offen lds
s_add_u32 s56, s54, 2113536
s_mov_b32 m0, 46080
s_nop 0
buffer_load_dwordx4 v26, s[16:19], s56 offen lds
s_add_u32 s56, s54, 2129920
s_mov_b32 m0, 47104
s_nop 0
buffer_load_dwordx4 v27, s[16:19], s56 offen lds
s_add_u32 s56, s54, 2146304
s_mov_b32 m0, 48128
s_nop 0
buffer_load_dwordx4 v27, s[16:19], s56 offen lds
ds_read_b64_tr_b16 a[0:1], v44 offset:0
ds_read_b64_tr_b16 a[2:3], v44 offset:1024
ds_read_b64_tr_b16 a[4:5], v46 offset:0
ds_read_b64_tr_b16 a[6:7], v46 offset:1024
ds_read_b64_tr_b16 a[8:9], v45 offset:0
ds_read_b64_tr_b16 a[10:11], v45 offset:1024
ds_read_b64_tr_b16 a[12:13], v47 offset:0
ds_read_b64_tr_b16 a[14:15], v47 offset:1024
s_waitcnt lgkmcnt(0)
s_waitcnt vmcnt(25)
s_barrier
s_add_u32 s56, s54, 2621440
s_mov_b32 m0, 16384
s_nop 0
buffer_load_dwordx4 v26, s[16:19], s56 offen lds
s_add_u32 s56, s54, 2637824
s_mov_b32 m0, 17408
s_nop 0
buffer_load_dwordx4 v26, s[16:19], s56 offen lds
s_add_u32 s56, s54, 2654208
s_mov_b32 m0, 18432
s_nop 0
buffer_load_dwordx4 v27, s[16:19], s56 offen lds
s_add_u32 s56, s54, 2670592
s_mov_b32 m0, 19456
s_nop 0
buffer_load_dwordx4 v27, s[16:19], s56 offen lds
ds_read_b64_tr_b16 a[16:17], v44 offset:4096
ds_read_b64_tr_b16 a[18:19], v44 offset:5120
ds_read_b64_tr_b16 a[20:21], v46 offset:4096
ds_read_b64_tr_b16 a[22:23], v46 offset:5120
ds_read_b64_tr_b16 a[24:25], v45 offset:4096
ds_read_b64_tr_b16 a[26:27], v45 offset:5120
ds_read_b64_tr_b16 a[28:29], v47 offset:4096
ds_read_b64_tr_b16 a[30:31], v47 offset:5120
s_waitcnt lgkmcnt(0)
s_waitcnt vmcnt(25)
s_barrier
s_add_u32 s56, s54, 3145728
s_mov_b32 m0, 20480
s_nop 0
buffer_load_dwordx4 v26, s[16:19], s56 offen lds
s_add_u32 s56, s54, 3162112
s_mov_b32 m0, 21504
s_nop 0
buffer_load_dwordx4 v26, s[16:19], s56 offen lds
s_add_u32 s56, s54, 3178496
s_mov_b32 m0, 22528
s_nop 0
buffer_load_dwordx4 v27, s[16:19], s56 offen lds
s_add_u32 s56, s54, 3194880
s_mov_b32 m0, 23552
s_nop 0
buffer_load_dwordx4 v27, s[16:19], s56 offen lds
ds_read_b64_tr_b16 a[32:33], v44 offset:8192
ds_read_b64_tr_b16 a[34:35], v44 offset:9216
ds_read_b64_tr_b16 a[36:37], v46 offset:8192
ds_read_b64_tr_b16 a[38:39], v46 offset:9216
ds_read_b64_tr_b16 a[40:41], v45 offset:8192
ds_read_b64_tr_b16 a[42:43], v45 offset:9216
ds_read_b64_tr_b16 a[44:45], v47 offset:8192
ds_read_b64_tr_b16 a[46:47], v47 offset:9216
s_waitcnt lgkmcnt(0)
s_waitcnt vmcnt(24)
s_barrier
s_add_u32 s56, s54, 3670016
s_mov_b32 m0, 24576
s_nop 0
buffer_load_dwordx4 v26, s[16:19], s56 offen lds
s_add_u32 s56, s54, 3686400
s_mov_b32 m0, 25600
s_nop 0
buffer_load_dwordx4 v26, s[16:19], s56 offen lds
s_add_u32 s56, s54, 3702784
s_mov_b32 m0, 26624
s_nop 0
buffer_load_dwordx4 v27, s[16:19], s56 offen lds
s_add_u32 s56, s54, 3719168
s_mov_b32 m0, 27648
s_nop 0
buffer_load_dwordx4 v27, s[16:19], s56 offen lds
ds_read_b64_tr_b16 a[48:49], v44 offset:12288
ds_read_b64_tr_b16 a[50:51], v44 offset:13312
ds_read_b64_tr_b16 a[52:53], v46 offset:12288
ds_read_b64_tr_b16 a[54:55], v46 offset:13312
ds_read_b64_tr_b16 a[56:57], v45 offset:12288
ds_read_b64_tr_b16 a[58:59], v45 offset:13312
ds_read_b64_tr_b16 a[60:61], v47 offset:12288
ds_read_b64_tr_b16 a[62:63], v47 offset:13312
s_waitcnt lgkmcnt(0)
s_waitcnt vmcnt(24)
s_barrier
s_add_u32 s56, s55, 73728
s_mov_b32 m0, 28672
s_nop 0
buffer_load_dwordx4 v28, s[20:23], s56 offen lds
s_add_u32 s56, s55, 76032
s_mov_b32 m0, 29696
s_nop 0
buffer_load_dwordx4 v28, s[20:23], s56 offen lds
s_add_u32 s56, s55, 82944
s_mov_b32 m0, 30720
s_nop 0
buffer_load_dwordx4 v28, s[20:23], s56 offen lds
s_add_u32 s56, s55, 85248
s_mov_b32 m0, 31744
s_nop 0
buffer_load_dwordx4 v28, s[20:23], s56 offen lds
ds_read_b64_tr_b16 a[64:65], v44 offset:16384
ds_read_b64_tr_b16 a[66:67], v44 offset:17408
ds_read_b64_tr_b16 a[68:69], v46 offset:16384
ds_read_b64_tr_b16 a[70:71], v46 offset:17408
ds_read_b64_tr_b16 a[72:73], v45 offset:16384
ds_read_b64_tr_b16 a[74:75], v45 offset:17408
ds_read_b64_tr_b16 a[76:77], v47 offset:16384
ds_read_b64_tr_b16 a[78:79], v47 offset:17408
s_waitcnt lgkmcnt(0)
s_waitcnt vmcnt(24)
s_barrier
s_add_u32 s56, s55, 73984
s_mov_b32 m0, 32768
s_nop 0
buffer_load_dwordx4 v28, s[20:23], s56 offen lds
s_add_u32 s56, s55, 76288
s_mov_b32 m0, 33792
s_nop 0
buffer_load_dwordx4 v28, s[20:23], s56 offen lds
s_add_u32 s56, s55, 83200
s_mov_b32 m0, 34816
s_nop 0
buffer_load_dwordx4 v28, s[20:23], s56 offen lds
s_add_u32 s56, s55, 85504
s_mov_b32 m0, 35840
s_nop 0
buffer_load_dwordx4 v28, s[20:23], s56 offen lds
ds_read_b64_tr_b16 a[80:81], v44 offset:20480
ds_read_b64_tr_b16 a[82:83], v44 offset:21504
ds_read_b64_tr_b16 a[84:85], v46 offset:20480
ds_read_b64_tr_b16 a[86:87], v46 offset:21504
ds_read_b64_tr_b16 a[88:89], v45 offset:20480
ds_read_b64_tr_b16 a[90:91], v45 offset:21504
ds_read_b64_tr_b16 a[92:93], v47 offset:20480
ds_read_b64_tr_b16 a[94:95], v47 offset:21504
s_waitcnt lgkmcnt(0)
s_waitcnt vmcnt(24)
s_barrier
s_add_u32 s56, s55, 74240
s_mov_b32 m0, 36864
s_nop 0
buffer_load_dwordx4 v28, s[20:23], s56 offen lds
s_add_u32 s56, s55, 76544
s_mov_b32 m0, 37888
s_nop 0
buffer_load_dwordx4 v28, s[20:23], s56 offen lds
s_add_u32 s56, s55, 83456
s_mov_b32 m0, 38912
s_nop 0
buffer_load_dwordx4 v28, s[20:23], s56 offen lds
s_add_u32 s56, s55, 85760
s_mov_b32 m0, 39936
s_nop 0
buffer_load_dwordx4 v28, s[20:23], s56 offen lds
ds_read_b64_tr_b16 a[96:97], v44 offset:24576
ds_read_b64_tr_b16 a[98:99], v44 offset:25600
ds_read_b64_tr_b16 a[100:101], v46 offset:24576
ds_read_b64_tr_b16 a[102:103], v46 offset:25600
ds_read_b64_tr_b16 a[104:105], v45 offset:24576
ds_read_b64_tr_b16 a[106:107], v45 offset:25600
ds_read_b64_tr_b16 a[108:109], v47 offset:24576
ds_read_b64_tr_b16 a[110:111], v47 offset:25600
s_waitcnt lgkmcnt(0)
s_waitcnt vmcnt(24)
s_barrier
s_add_u32 s56, s55, 74496
s_mov_b32 m0, 40960
s_nop 0
buffer_load_dwordx4 v28, s[20:23], s56 offen lds
s_add_u32 s56, s55, 76800
s_mov_b32 m0, 41984
s_nop 0
buffer_load_dwordx4 v28, s[20:23], s56 offen lds
s_add_u32 s56, s55, 83712
s_mov_b32 m0, 43008
s_nop 0
buffer_load_dwordx4 v28, s[20:23], s56 offen lds
s_add_u32 s56, s55, 86016
s_mov_b32 m0, 44032
s_nop 0
buffer_load_dwordx4 v28, s[20:23], s56 offen lds
ds_read_b64_tr_b16 a[112:113], v44 offset:28672
ds_read_b64_tr_b16 a[114:115], v44 offset:29696
ds_read_b64_tr_b16 a[116:117], v46 offset:28672
ds_read_b64_tr_b16 a[118:119], v46 offset:29696
ds_read_b64_tr_b16 a[120:121], v45 offset:28672
ds_read_b64_tr_b16 a[122:123], v45 offset:29696
ds_read_b64_tr_b16 a[124:125], v47 offset:28672
ds_read_b64_tr_b16 a[126:127], v47 offset:29696
s_waitcnt lgkmcnt(0)
s_waitcnt vmcnt(24)
s_barrier
s_add_u32 s56, s55, 0
s_mov_b32 m0, 45056
s_nop 0
buffer_load_dwordx4 v28, s[20:23], s56 offen lds
s_add_u32 s56, s55, 2304
s_mov_b32 m0, 46080
s_nop 0
buffer_load_dwordx4 v28, s[20:23], s56 offen lds
s_add_u32 s56, s55, 9216
s_mov_b32 m0, 47104
s_nop 0
buffer_load_dwordx4 v28, s[20:23], s56 offen lds
s_add_u32 s56, s55, 11520
s_mov_b32 m0, 48128
s_nop 0
buffer_load_dwordx4 v28, s[20:23], s56 offen lds
ds_read_b64_tr_b16 a[128:129], v44 offset:0
ds_read_b64_tr_b16 a[130:131], v44 offset:1024
ds_read_b64_tr_b16 a[132:133], v46 offset:0
ds_read_b64_tr_b16 a[134:135], v46 offset:1024
ds_read_b64_tr_b16 a[136:137], v45 offset:0
ds_read_b64_tr_b16 a[138:139], v45 offset:1024
ds_read_b64_tr_b16 a[140:141], v47 offset:0
ds_read_b64_tr_b16 a[142:143], v47 offset:1024
buffer_load_dword v32, v24, s[28:31], 0 offen sc0 sc1
s_waitcnt lgkmcnt(0)
s_waitcnt vmcnt(25)
s_barrier
s_add_u32 s56, s54, 0
s_mov_b32 m0, 16384
s_nop 0
buffer_load_dwordx4 v26, s[8:11], s56 offen lds
s_add_u32 s56, s54, 16384
s_mov_b32 m0, 17408
s_nop 0
buffer_load_dwordx4 v26, s[8:11], s56 offen lds
s_add_u32 s56, s54, 32768
s_mov_b32 m0, 18432
s_nop 0
buffer_load_dwordx4 v27, s[8:11], s56 offen lds
s_add_u32 s56, s54, 49152
s_mov_b32 m0, 19456
s_nop 0
buffer_load_dwordx4 v27, s[8:11], s56 offen lds
ds_read_b64_tr_b16 a[144:145], v44 offset:4096
ds_read_b64_tr_b16 a[146:147], v44 offset:5120
ds_read_b64_tr_b16 a[148:149], v46 offset:4096
ds_read_b64_tr_b16 a[150:151], v46 offset:5120
ds_read_b64_tr_b16 a[152:153], v45 offset:4096
ds_read_b64_tr_b16 a[154:155], v45 offset:5120
ds_read_b64_tr_b16 a[156:157], v47 offset:4096
ds_read_b64_tr_b16 a[158:159], v47 offset:5120
s_waitcnt lgkmcnt(0)
s_waitcnt vmcnt(25)
s_barrier
s_add_u32 s56, s54, 1572864
s_mov_b32 m0, 20480
s_nop 0
buffer_load_dwordx4 v26, s[8:11], s56 offen lds
s_add_u32 s56, s54, 1589248
s_mov_b32 m0, 21504
s_nop 0
buffer_load_dwordx4 v26, s[8:11], s56 offen lds
s_add_u32 s56, s54, 1605632
s_mov_b32 m0, 22528
s_nop 0
buffer_load_dwordx4 v27, s[8:11], s56 offen lds
s_add_u32 s56, s54, 1622016
s_mov_b32 m0, 23552
s_nop 0
buffer_load_dwordx4 v27, s[8:11], s56 offen lds
ds_read_b64_tr_b16 a[160:161], v44 offset:8192
ds_read_b64_tr_b16 a[162:163], v44 offset:9216
ds_read_b64_tr_b16 a[164:165], v46 offset:8192
ds_read_b64_tr_b16 a[166:167], v46 offset:9216
ds_read_b64_tr_b16 a[168:169], v45 offset:8192
ds_read_b64_tr_b16 a[170:171], v45 offset:9216
ds_read_b64_tr_b16 a[172:173], v47 offset:8192
ds_read_b64_tr_b16 a[174:175], v47 offset:9216
s_waitcnt lgkmcnt(0)
s_waitcnt vmcnt(25)
s_barrier
s_add_u32 s56, s54, 2097152
s_mov_b32 m0, 24576
s_nop 0
buffer_load_dwordx4 v26, s[8:11], s56 offen lds
s_add_u32 s56, s54, 2113536
s_mov_b32 m0, 25600
s_nop 0
buffer_load_dwordx4 v26, s[8:11], s56 offen lds
s_add_u32 s56, s54, 2129920
s_mov_b32 m0, 26624
s_nop 0
buffer_load_dwordx4 v27, s[8:11], s56 offen lds
s_add_u32 s56, s54, 2146304
s_mov_b32 m0, 27648
s_nop 0
buffer_load_dwordx4 v27, s[8:11], s56 offen lds
ds_read_b64_tr_b16 a[184:185], v48 offset:12288
ds_read_b64_tr_b16 a[186:187], v48 offset:13312
ds_read_b64_tr_b16 a[188:189], v48 offset:14336
ds_read_b64_tr_b16 a[190:191], v48 offset:15360
ds_read_b64_tr_b16 a[200:201], v49 offset:12288
ds_read_b64_tr_b16 a[202:203], v49 offset:13312
ds_read_b64_tr_b16 a[204:205], v49 offset:14336
ds_read_b64_tr_b16 a[206:207], v49 offset:15360
s_waitcnt lgkmcnt(0)
s_waitcnt vmcnt(25)
s_barrier
s_add_u32 s56, s54, 2621440
s_mov_b32 m0, 28672
s_nop 0
buffer_load_dwordx4 v26, s[12:15], s56 offen lds
s_add_u32 s56, s54, 2637824
s_mov_b32 m0, 29696
s_nop 0
buffer_load_dwordx4 v26, s[12:15], s56 offen lds
s_add_u32 s56, s54, 2654208
s_mov_b32 m0, 30720
s_nop 0
buffer_load_dwordx4 v27, s[12:15], s56 offen lds
s_add_u32 s56, s54, 2670592
s_mov_b32 m0, 31744
s_nop 0
buffer_load_dwordx4 v27, s[12:15], s56 offen lds
ds_read_b64_tr_b16 a[208:209], v48 offset:16384
ds_read_b64_tr_b16 a[210:211], v48 offset:17408
ds_read_b64_tr_b16 a[212:213], v48 offset:18432
ds_read_b64_tr_b16 a[214:215], v48 offset:19456
ds_read_b64_tr_b16 a[216:217], v49 offset:16384
ds_read_b64_tr_b16 a[218:219], v49 offset:17408
ds_read_b64_tr_b16 a[220:221], v49 offset:18432
ds_read_b64_tr_b16 a[222:223], v49 offset:19456
s_waitcnt lgkmcnt(0)
s_waitcnt vmcnt(25)
s_barrier
s_add_u32 s56, s54, 4194304
s_mov_b32 m0, 32768
s_nop 0
buffer_load_dwordx4 v26, s[16:19], s56 offen lds
s_add_u32 s56, s54, 4210688
s_mov_b32 m0, 33792
s_nop 0
buffer_load_dwordx4 v26, s[16:19], s56 offen lds
s_add_u32 s56, s54, 4227072
s_mov_b32 m0, 34816
s_nop 0
buffer_load_dwordx4 v27, s[16:19], s56 offen lds
s_add_u32 s56, s54, 4243456
s_mov_b32 m0, 35840
s_nop 0
buffer_load_dwordx4 v27, s[16:19], s56 offen lds
ds_read_b64_tr_b16 a[224:225], v48 offset:20480
ds_read_b64_tr_b16 a[226:227], v48 offset:21504
ds_read_b64_tr_b16 a[228:229], v48 offset:22528
ds_read_b64_tr_b16 a[230:231], v48 offset:23552
ds_read_b64_tr_b16 a[232:233], v49 offset:20480
ds_read_b64_tr_b16 a[234:235], v49 offset:21504
ds_read_b64_tr_b16 a[236:237], v49 offset:22528
ds_read_b64_tr_b16 a[238:239], v49 offset:23552
s_waitcnt lgkmcnt(0)
s_waitcnt vmcnt(25)
s_barrier
s_add_u32 s56, s55, 256
s_mov_b32 m0, 36864
s_nop 0
buffer_load_dwordx4 v28, s[20:23], s56 offen lds
s_add_u32 s56, s55, 2560
s_mov_b32 m0, 37888
s_nop 0
buffer_load_dwordx4 v28, s[20:23], s56 offen lds
s_add_u32 s56, s55, 9472
s_mov_b32 m0, 38912
s_nop 0
buffer_load_dwordx4 v28, s[20:23], s56 offen lds
s_add_u32 s56, s55, 11776
s_mov_b32 m0, 39936
s_nop 0
buffer_load_dwordx4 v28, s[20:23], s56 offen lds
ds_read_b64_tr_b16 a[240:241], v48 offset:24576
ds_read_b64_tr_b16 a[242:243], v48 offset:25600
ds_read_b64_tr_b16 a[244:245], v48 offset:26624
ds_read_b64_tr_b16 a[246:247], v48 offset:27648
ds_read_b64_tr_b16 a[248:249], v49 offset:24576
ds_read_b64_tr_b16 a[250:251], v49 offset:25600
ds_read_b64_tr_b16 a[252:253], v49 offset:26624
ds_read_b64_tr_b16 a[254:255], v49 offset:27648
s_waitcnt lgkmcnt(0)
s_waitcnt vmcnt(25)
s_barrier
s_add_u32 s56, s55, 512
s_mov_b32 m0, 40960
s_nop 0
buffer_load_dwordx4 v28, s[20:23], s56 offen lds
s_add_u32 s56, s55, 2816
s_mov_b32 m0, 41984
s_nop 0
buffer_load_dwordx4 v28, s[20:23], s56 offen lds
s_add_u32 s56, s55, 9728
s_mov_b32 m0, 43008
s_nop 0
buffer_load_dwordx4 v28, s[20:23], s56 offen lds
s_add_u32 s56, s55, 12032
s_mov_b32 m0, 44032
s_nop 0
buffer_load_dwordx4 v28, s[20:23], s56 offen lds
ds_read_b64_tr_b16 a[176:177], v48 offset:28672
ds_read_b64_tr_b16 a[178:179], v48 offset:29696
ds_read_b64_tr_b16 a[180:181], v48 offset:30720
ds_read_b64_tr_b16 a[182:183], v48 offset:31744
ds_read_b64_tr_b16 a[192:193], v49 offset:28672
ds_read_b64_tr_b16 a[194:195], v49 offset:29696
ds_read_b64_tr_b16 a[196:197], v49 offset:30720
ds_read_b64_tr_b16 a[198:199], v49 offset:31744
s_waitcnt lgkmcnt(0)
s_waitcnt vmcnt(24)
s_barrier
s_add_u32 s56, s55, 768
s_mov_b32 m0, 45056
s_nop 0
buffer_load_dwordx4 v28, s[20:23], s56 offen lds
s_add_u32 s56, s55, 3072
s_mov_b32 m0, 46080
s_nop 0
buffer_load_dwordx4 v28, s[20:23], s56 offen lds
s_add_u32 s56, s55, 9984
s_mov_b32 m0, 47104
s_nop 0
buffer_load_dwordx4 v28, s[20:23], s56 offen lds
s_add_u32 s56, s55, 12288
s_mov_b32 m0, 48128
s_nop 0
buffer_load_dwordx4 v28, s[20:23], s56 offen lds
ds_read_b64_tr_b16 v[60:61], v44 offset:0
ds_read_b64_tr_b16 v[62:63], v44 offset:1024
ds_read_b64_tr_b16 v[64:65], v46 offset:0
ds_read_b64_tr_b16 v[66:67], v46 offset:1024
ds_read_b64_tr_b16 v[68:69], v45 offset:0
ds_read_b64_tr_b16 v[70:71], v45 offset:1024
ds_read_b64_tr_b16 v[72:73], v47 offset:0
ds_read_b64_tr_b16 v[74:75], v47 offset:1024
s_waitcnt lgkmcnt(0)
s_waitcnt vmcnt(24)
s_barrier
ds_write_b128 v2, v[60:63] offset:0
ds_write_b128 v2, v[64:67] offset:1024
ds_write_b128 v2, v[68:71] offset:2048
ds_write_b128 v2, v[72:75] offset:3072
ds_read_b64_tr_b16 v[60:61], v44 offset:4096
ds_read_b64_tr_b16 v[62:63], v44 offset:5120
ds_read_b64_tr_b16 v[64:65], v46 offset:4096
ds_read_b64_tr_b16 v[66:67], v46 offset:5120
ds_read_b64_tr_b16 v[68:69], v45 offset:4096
ds_read_b64_tr_b16 v[70:71], v45 offset:5120
ds_read_b64_tr_b16 v[72:73], v47 offset:4096
ds_read_b64_tr_b16 v[74:75], v47 offset:5120
L_rdv_w0:
v_readfirstlane_b32 s38, v32
s_nop 0
s_and_b32 s57, s38, 0xff
s_cmp_lg_u32 s57, 32
s_cbranch_scc1 L_rdv2_w0
s_waitcnt lgkmcnt(0)
s_waitcnt vmcnt(20)
s_barrier
ds_write_b128 v2, v[60:63] offset:4096
ds_write_b128 v2, v[64:67] offset:5120
ds_write_b128 v2, v[68:71] offset:6144
ds_write_b128 v2, v[72:75] offset:7168
ds_read_b64_tr_b16 v[60:61], v44 offset:8192
ds_read_b64_tr_b16 v[62:63], v44 offset:9216
ds_read_b64_tr_b16 v[64:65], v46 offset:8192
ds_read_b64_tr_b16 v[66:67], v46 offset:9216
ds_read_b64_tr_b16 v[68:69], v45 offset:8192
ds_read_b64_tr_b16 v[70:71], v45 offset:9216
ds_read_b64_tr_b16 v[72:73], v47 offset:8192
ds_read_b64_tr_b16 v[74:75], v47 offset:9216
buffer_load_dwordx4 v[12:15], v9, s[4:7], s37 offen offset:0
buffer_load_dwordx4 v[16:19], v9, s[4:7], s37 offen offset:1024
buffer_load_dwordx4 v[52:55], v1, s[4:7], s37 offen offset:2048
buffer_load_dwordx4 v[56:59], v1, s[4:7], s37 offen offset:3072
s_mov_b32 m0, 1024
s_nop 0
buffer_load_dwordx4 v1, s[4:7], s47 offen offset:0 sc1 lds
s_waitcnt lgkmcnt(0)
s_waitcnt vmcnt(21)
s_barrier
ds_write_b128 v2, v[60:63] offset:8192
ds_write_b128 v2, v[64:67] offset:9216
ds_write_b128 v2, v[68:71] offset:10240
ds_write_b128 v2, v[72:75] offset:11264
ds_read_b64_tr_b16 v[60:61], v44 offset:12288
ds_read_b64_tr_b16 v[62:63], v44 offset:13312
ds_read_b64_tr_b16 v[64:65], v46 offset:12288
ds_read_b64_tr_b16 v[66:67], v46 offset:13312
ds_read_b64_tr_b16 v[68:69], v45 offset:12288
ds_read_b64_tr_b16 v[70:71], v45 offset:13312
ds_read_b64_tr_b16 v[72:73], v47 offset:12288
ds_read_b64_tr_b16 v[74:75], v47 offset:13312
s_waitcnt lgkmcnt(0)
s_waitcnt vmcnt(17)
s_barrier
ds_write_b128 v2, v[60:63] offset:12288
ds_write_b128 v2, v[64:67] offset:13312
ds_write_b128 v2, v[68:71] offset:14336
ds_write_b128 v2, v[72:75] offset:15360
ds_read_b64_tr_b16 v[60:61], v44 offset:16384
ds_read_b64_tr_b16 v[62:63], v44 offset:17408
ds_read_b64_tr_b16 v[64:65], v46 offset:16384
ds_read_b64_tr_b16 v[66:67], v46 offset:17408
ds_read_b64_tr_b16 v[68:69], v45 offset:16384
ds_read_b64_tr_b16 v[70:71], v45 offset:17408
ds_read_b64_tr_b16 v[72:73], v47 offset:16384
ds_read_b64_tr_b16 v[74:75], v47 offset:17408
s_waitcnt lgkmcnt(0)
s_waitcnt vmcnt(13)
s_barrier
ds_write_b128 v2, v[60:63] offset:16384
ds_write_b128 v2, v[64:67] offset:17408
ds_write_b128 v2, v[68:71] offset:18432
ds_write_b128 v2, v[72:75] offset:19456
ds_read_b64_tr_b16 v[60:61], v48 offset:20480
ds_read_b64_tr_b16 v[62:63], v48 offset:21504
ds_read_b64_tr_b16 v[64:65], v48 offset:22528
ds_read_b64_tr_b16 v[66:67], v48 offset:23552
ds_read_b64_tr_b16 v[68:69], v49 offset:20480
ds_read_b64_tr_b16 v[70:71], v49 offset:21504
ds_read_b64_tr_b16 v[72:73], v49 offset:22528
ds_read_b64_tr_b16 v[74:75], v49 offset:23552
s_waitcnt lgkmcnt(0)
s_waitcnt vmcnt(9)
s_barrier
ds_write_b128 v2, v[60:63] offset:20480
ds_write_b128 v2, v[64:67] offset:21504
ds_write_b128 v2, v[68:71] offset:22528
ds_write_b128 v2, v[72:75] offset:23552
ds_read_b64_tr_b16 v[60:61], v48 offset:24576
ds_read_b64_tr_b16 v[62:63], v48 offset:25600
ds_read_b64_tr_b16 v[64:65], v48 offset:26624
ds_read_b64_tr_b16 v[66:67], v48 offset:27648
ds_read_b64_tr_b16 v[68:69], v49 offset:24576
ds_read_b64_tr_b16 v[70:71], v49 offset:25600
ds_read_b64_tr_b16 v[72:73], v49 offset:26624
ds_read_b64_tr_b16 v[74:75], v49 offset:27648
s_waitcnt lgkmcnt(0)
s_waitcnt vmcnt(5)
s_barrier
ds_write_b128 v2, v[60:63] offset:24576
ds_write_b128 v2, v[64:67] offset:25600
ds_write_b128 v2, v[68:71] offset:26624
ds_write_b128 v2, v[72:75] offset:27648
ds_read_b64_tr_b16 v[60:61], v48 offset:28672
ds_read_b64_tr_b16 v[62:63], v48 offset:29696
ds_read_b64_tr_b16 v[64:65], v48 offset:30720
ds_read_b64_tr_b16 v[66:67], v48 offset:31744
ds_read_b64_tr_b16 v[68:69], v49 offset:28672
ds_read_b64_tr_b16 v[70:71], v49 offset:29696
ds_read_b64_tr_b16 v[72:73], v49 offset:30720
ds_read_b64_tr_b16 v[74:75], v49 offset:31744
s_waitcnt lgkmcnt(0)
s_barrier
ds_write_b128 v2, v[60:63] offset:28672
ds_write_b128 v2, v[64:67] offset:29696
ds_write_b128 v2, v[68:71] offset:30720
ds_write_b128 v2, v[72:75] offset:31744
s_lshl_b32 s57, s58, 5
s_mov_b32 s0, 0x3f003f00
s_mov_b32 s1, 0x3f003f00
s_mov_b32 s58, 304128
s_cmp_eq_u32 s38, s57
s_mov_b32 s56, 0x33333333
s_mov_b32 s57, 0x33333333
s_mov_b32 s2, 0x21800000
s_mov_b32 s55, -24
s_cbranch_scc0 L_slow_w0
v_mov_b64 v[20:21], 0
v_mov_b64 v[22:23], 0
v_mov_b64 v[24:25], 0
v_mov_b64 v[26:27], 0
v_mov_b64 v[28:29], 0
v_mov_b64 v[30:31], 0
v_mov_b64 v[32:33], 0
v_mov_b64 v[34:35], 0
v_mov_b64 v[36:37], 0
v_mov_b64 v[38:39], 0
v_mov_b64 v[40:41], 0
v_mov_b64 v[42:43], 0
ds_read_b128 v[44:47], v2 offset:0
ds_read_b128 v[48:51], v2 offset:1024
v_bfe_u32 v77, v1, 6, 1
v_lshl_add_u32 v77, v77, 3, v1
v_lshlrev_b32 v77, 1, v77
v_lshlrev_b32 v78, 3, v1
s_mov_b32 s38, 0
v_and_b32 v6, 0x70, v1
ds_write_b32 v6, v20 offset:512
s_waitcnt vmcnt(0) lgkmcnt(0)
s_branch L_top_w0f
L_done_w0f:
s_waitcnt vmcnt(0) lgkmcnt(0)
s_endpgm
L_rdv2_w0:
buffer_load_dword v32, v24, s[28:31], 0 offen sc0 sc1
s_sub_u32 s41, s41, 1
s_cbranch_scc1 L_exit
s_waitcnt vmcnt(0)
s_branch L_rdv_w0
L_ra0_w0f:
s_mov_b32 m0, 1024
s_nop 0
buffer_load_dwordx4 v1, s[4:7], s47 offen offset:0 sc1 lds
buffer_load_dwordx4 v1, s[4:7], s47 offen offset:1024 sc1 lds
buffer_load_dwordx4 v1, s[4:7], s47 offen offset:2048 sc1 lds
buffer_load_dwordx4 v1, s[4:7], s47 offen offset:3072 sc1 lds
s_sub_u32 s41, s41, 1
s_cbranch_scc1 L_exit
ds_read_b128 v[44:47], v2 offset:0
ds_read_b128 v[48:51], v2 offset:1024
v_mov_b64 v[20:21], 0
v_mov_b64 v[22:23], 0
v_mov_b64 v[24:25], 0
v_mov_b64 v[26:27], 0
v_mov_b64 v[28:29], 0
v_mov_b64 v[30:31], 0
v_mov_b64 v[32:33], 0
v_mov_b64 v[34:35], 0
v_mov_b64 v[36:37], 0
v_mov_b64 v[38:39], 0
v_mov_b64 v[40:41], 0
v_mov_b64 v[42:43], 0
s_waitcnt vmcnt(0)
ds_read_b128 v[60:63], v1 offset:1024
ds_read_b128 v[64:67], v1 offset:2048
ds_read_b128 v[68:71], v1 offset:3072
ds_read_b128 v[72:75], v1 offset:4096
s_branch L_s0_w0f
L_ra1_w0f:
L_ra2_w0f:
s_waitcnt lgkmcnt(0)
s_barrier
s_mov_b32 m0, 5120
s_nop 0
buffer_load_dwordx4 v1, s[4:7], s48 offen offset:0 sc1 lds
s_mov_b32 m0, 9216
s_nop 0
buffer_load_dwordx4 v1, s[4:7], s49 offen offset:0 sc1 lds
s_sub_u32 s41, s41, 1
s_cbranch_scc1 L_exit
s_waitcnt vmcnt(0)
s_barrier
ds_read_b128 v[76:79], v1 offset:5120
ds_read_b128 v[60:63], v1 offset:6144
ds_read_b128 v[64:67], v1 offset:7168
ds_read_b128 v[68:71], v1 offset:8192
ds_read_b128 v[72:75], v1 offset:9216
s_waitcnt lgkmcnt(0)
v_bitop3_b32 v6, v76, v60, s35 bitop3:0x7e
v_bitop3_b32 v6, v6, v64, s35 bitop3:0xf6
v_bitop3_b32 v6, v6, v68, s35 bitop3:0xf6
v_bitop3_b32 v6, v6, v72, s35 bitop3:0xf6
v_and_b32 v6, 1, v6
v_cmp_ne_u32 vcc, 0, v6

s_cbranch_vccnz L_ra2_w0f
s_branch L_a1_w0f
L_mx_w0f:
s_waitcnt lgkmcnt(0)
v_max3_f32 v30, v12, v13, v28
v_max_f32 v30, v30, v29
v_mov_b32 v31, v30
s_nop 1
v_permlane16_swap_b32 v30, v31
v_max_f32 v30, v30, v31
v_mov_b32 v31, v30
s_nop 1
v_permlane32_swap_b32 v30, v31
v_max_f32 v30, v30, v31
ds_write_b32 v1, v30 offset:10240
s_waitcnt lgkmcnt(0)
s_barrier
ds_read_b128 v[32:35], v1 offset:10240
s_waitcnt lgkmcnt(0)
v_max3_f32 v32, v32, v33, v34
v_max_f32 v32, v32, v35
v_sub_f32 v14, v12, v32
v_sub_f32 v15, v13, v32
v_sub_f32 v30, v28, v32
v_sub_f32 v31, v29, v32
v_exp_f32 v14, v14
v_exp_f32 v15, v15
v_exp_f32 v30, v30
v_exp_f32 v31, v31
v_cvt_pk_bf16_f32 v14, v14, v15
v_cvt_pk_bf16_f32 v30, v30, v31
ds_write_b32 v5, v14 offset:14368
v_cndmask_b32_e64 v26, 0, v30, s[56:57]
v_cndmask_b32_e64 v27, 0, v30, s[56:57]
v_mov_b64 v[76:77], s[52:53]
v_mov_b64 v[78:79], s[52:53]
v_mov_b32_dpp v24, v26 quad_perm:[2,3,0,1] row_mask:0xf bank_mask:0xf
v_mov_b32_dpp v25, v26 quad_perm:[2,3,0,1] row_mask:0xf bank_mask:0xf
s_waitcnt lgkmcnt(0)
s_barrier
v_mov_b64 v[14:15], s[0:1]
ds_read_b128 v[16:19], v1 offset:14368
ds_read_b128 v[36:39], v1 offset:14336
s_waitcnt lgkmcnt(0)
v_mfma_f32_16x16x32_bf16 v[32:35], v[76:79], v[16:19], 0
v_mfma_f32_16x16x32_bf16 v[20:23], v[52:55], v[16:19], 0
v_mfma_f32_16x16x32_bf16 v[20:23], v[56:59], v[36:39], v[20:23]
v_mfma_f32_16x16x16_bf16 v[32:35], v[14:15], v[26:27], v[32:35]
v_mfma_f32_16x16x32_bf16 v[20:23], v[40:43], v[24:27], v[20:23]
s_nop 3
v_rcp_f32 v33, v32
s_nop 2
v_mul_f32_dpp v20, v33, v20 quad_perm:[0,1,0,1] row_mask:0xf bank_mask:0xf
v_mul_f32_dpp v21, v33, v21 quad_perm:[0,1,0,1] row_mask:0xf bank_mask:0xf
v_mul_f32_dpp v22, v33, v22 quad_perm:[0,1,0,1] row_mask:0xf bank_mask:0xf
v_mul_f32_dpp v23, v33, v23 quad_perm:[0,1,0,1] row_mask:0xf bank_mask:0xf
v_cvt_pk_bf16_f32 v20, v20, v21
v_cvt_pk_bf16_f32 v21, v22, v23
ds_write_b64 v6, v[20:21] offset:5120
v_mov_b32_dpp v16, v20 quad_perm:[0,1,0,1] row_mask:0xf bank_mask:0xf
v_mov_b32_dpp v17, v21 quad_perm:[0,1,0,1] row_mask:0xf bank_mask:0xf
v_mov_b32_dpp v18, v20 quad_perm:[2,3,2,3] row_mask:0xf bank_mask:0xf
v_mov_b32_dpp v19, v21 quad_perm:[2,3,2,3] row_mask:0xf bank_mask:0xf
v_mov_b64 v[76:77], 0
v_mov_b64 v[78:79], 0
v_mov_b64 v[36:37], 0
v_mov_b64 v[38:39], 0
v_mov_b64 v[24:25], 0
v_mov_b64 v[26:27], 0
v_mov_b64 v[32:33], 0
v_mov_b64 v[34:35], 0
s_waitcnt lgkmcnt(0)
s_branch L_mxb_w0f

L_slow_w0:
v_mov_b64 v[20:21], 0
v_mov_b64 v[22:23], 0
v_mov_b64 v[24:25], 0
v_mov_b64 v[26:27], 0
v_mov_b64 v[28:29], 0
v_mov_b64 v[30:31], 0
v_mov_b64 v[32:33], 0
v_mov_b64 v[34:35], 0
v_mov_b64 v[36:37], 0
v_mov_b64 v[38:39], 0
v_mov_b64 v[40:41], 0
v_mov_b64 v[42:43], 0
ds_read_b128 v[44:47], v2 offset:0
ds_read_b128 v[48:51], v2 offset:1024
v_bfe_u32 v77, v1, 6, 1
v_lshl_add_u32 v77, v77, 3, v1
v_lshlrev_b32 v77, 1, v77
v_lshlrev_b32 v78, 3, v1
s_mov_b32 s38, 0
v_and_b32 v6, 0x70, v1
ds_write_b32 v6, v20 offset:512
s_waitcnt vmcnt(0) lgkmcnt(0)
s_branch L_top_w0s
L_done_w0s:
s_waitcnt vmcnt(0) lgkmcnt(0)
s_endpgm
L_ra0_w0s:
s_mov_b32 m0, 1024
s_nop 0
buffer_load_dwordx4 v1, s[4:7], s47 offen offset:0 sc0 sc1 lds
buffer_load_dwordx4 v1, s[4:7], s47 offen offset:1024 sc0 sc1 lds
buffer_load_dwordx4 v1, s[4:7], s47 offen offset:2048 sc0 sc1 lds
buffer_load_dwordx4 v1, s[4:7], s47 offen offset:3072 sc0 sc1 lds
s_sub_u32 s41, s41, 1
s_cbranch_scc1 L_exit
ds_read_b128 v[44:47], v2 offset:0
ds_read_b128 v[48:51], v2 offset:1024
v_mov_b64 v[20:21], 0
v_mov_b64 v[22:23], 0
v_mov_b64 v[24:25], 0
v_mov_b64 v[26:27], 0
v_mov_b64 v[28:29], 0
v_mov_b64 v[30:31], 0
v_mov_b64 v[32:33], 0
v_mov_b64 v[34:35], 0
v_mov_b64 v[36:37], 0
v_mov_b64 v[38:39], 0
v_mov_b64 v[40:41], 0
v_mov_b64 v[42:43], 0
s_waitcnt vmcnt(0)
ds_read_b128 v[60:63], v1 offset:1024
ds_read_b128 v[64:67], v1 offset:2048
ds_read_b128 v[68:71], v1 offset:3072
ds_read_b128 v[72:75], v1 offset:4096
s_branch L_s0_w0s
L_ra1_w0s:
L_ra2_w0s:
s_waitcnt lgkmcnt(0)
s_barrier
s_mov_b32 m0, 5120
s_nop 0
buffer_load_dwordx4 v1, s[4:7], s48 offen offset:0 sc0 sc1 lds
s_mov_b32 m0, 9216
s_nop 0
buffer_load_dwordx4 v1, s[4:7], s49 offen offset:0 sc0 sc1 lds
s_sub_u32 s41, s41, 1
s_cbranch_scc1 L_exit
s_waitcnt vmcnt(0)
s_barrier
ds_read_b128 v[76:79], v1 offset:5120
ds_read_b128 v[60:63], v1 offset:6144
ds_read_b128 v[64:67], v1 offset:7168
ds_read_b128 v[68:71], v1 offset:8192
ds_read_b128 v[72:75], v1 offset:9216
s_waitcnt lgkmcnt(0)
v_bitop3_b32 v6, v76, v60, s35 bitop3:0x7e
v_bitop3_b32 v6, v6, v64, s35 bitop3:0xf6
v_bitop3_b32 v6, v6, v68, s35 bitop3:0xf6
v_bitop3_b32 v6, v6, v72, s35 bitop3:0xf6
v_and_b32 v6, 1, v6
v_cmp_ne_u32 vcc, 0, v6

s_cbranch_vccnz L_ra2_w0s
s_branch L_a1_w0s
L_mx_w0s:
s_waitcnt lgkmcnt(0)
v_max3_f32 v30, v12, v13, v28
v_max_f32 v30, v30, v29
v_mov_b32 v31, v30
s_nop 1
v_permlane16_swap_b32 v30, v31
v_max_f32 v30, v30, v31
v_mov_b32 v31, v30
s_nop 1
v_permlane32_swap_b32 v30, v31
v_max_f32 v30, v30, v31
ds_write_b32 v1, v30 offset:10240
s_waitcnt lgkmcnt(0)
s_barrier
ds_read_b128 v[32:35], v1 offset:10240
s_waitcnt lgkmcnt(0)
v_max3_f32 v32, v32, v33, v34
v_max_f32 v32, v32, v35
v_sub_f32 v14, v12, v32
v_sub_f32 v15, v13, v32
v_sub_f32 v30, v28, v32
v_sub_f32 v31, v29, v32
v_exp_f32 v14, v14
v_exp_f32 v15, v15
v_exp_f32 v30, v30
v_exp_f32 v31, v31
v_cvt_pk_bf16_f32 v14, v14, v15
v_cvt_pk_bf16_f32 v30, v30, v31
ds_write_b32 v5, v14 offset:14368
v_cndmask_b32_e64 v26, 0, v30, s[56:57]
v_cndmask_b32_e64 v27, 0, v30, s[56:57]
v_mov_b64 v[76:77], s[52:53]
v_mov_b64 v[78:79], s[52:53]
v_mov_b32_dpp v24, v26 quad_perm:[2,3,0,1] row_mask:0xf bank_mask:0xf
v_mov_b32_dpp v25, v26 quad_perm:[2,3,0,1] row_mask:0xf bank_mask:0xf
s_waitcnt lgkmcnt(0)
s_barrier
v_mov_b64 v[14:15], s[0:1]
ds_read_b128 v[16:19], v1 offset:14368
ds_read_b128 v[36:39], v1 offset:14336
s_waitcnt lgkmcnt(0)
v_mfma_f32_16x16x32_bf16 v[32:35], v[76:79], v[16:19], 0
v_mfma_f32_16x16x32_bf16 v[20:23], v[52:55], v[16:19], 0
v_mfma_f32_16x16x32_bf16 v[20:23], v[56:59], v[36:39], v[20:23]
v_mfma_f32_16x16x16_bf16 v[32:35], v[14:15], v[26:27], v[32:35]
v_mfma_f32_16x16x32_bf16 v[20:23], v[40:43], v[24:27], v[20:23]
s_nop 3
v_rcp_f32 v33, v32
s_nop 2
v_mul_f32_dpp v20, v33, v20 quad_perm:[0,1,0,1] row_mask:0xf bank_mask:0xf
v_mul_f32_dpp v21, v33, v21 quad_perm:[0,1,0,1] row_mask:0xf bank_mask:0xf
v_mul_f32_dpp v22, v33, v22 quad_perm:[0,1,0,1] row_mask:0xf bank_mask:0xf
v_mul_f32_dpp v23, v33, v23 quad_perm:[0,1,0,1] row_mask:0xf bank_mask:0xf
v_cvt_pk_bf16_f32 v20, v20, v21
v_cvt_pk_bf16_f32 v21, v22, v23
ds_write_b64 v6, v[20:21] offset:5120
v_mov_b32_dpp v16, v20 quad_perm:[0,1,0,1] row_mask:0xf bank_mask:0xf
v_mov_b32_dpp v17, v21 quad_perm:[0,1,0,1] row_mask:0xf bank_mask:0xf
v_mov_b32_dpp v18, v20 quad_perm:[2,3,2,3] row_mask:0xf bank_mask:0xf
v_mov_b32_dpp v19, v21 quad_perm:[2,3,2,3] row_mask:0xf bank_mask:0xf
v_mov_b64 v[76:77], 0
v_mov_b64 v[78:79], 0
v_mov_b64 v[36:37], 0
v_mov_b64 v[38:39], 0
v_mov_b64 v[24:25], 0
v_mov_b64 v[26:27], 0
v_mov_b64 v[32:33], 0
v_mov_b64 v[34:35], 0
s_waitcnt lgkmcnt(0)
s_branch L_mxb_w0s

L_pro_w0r:
v_and_b32 v20, 63, v0
v_lshlrev_b32 v1, 4, v20
v_add_u32 v2, 16384, v1
v_and_b32 v23, 1, v22
v_lshl_add_u32 v23, v24, 4, v23
v_mul_u32_u24 v23, 1152, v23
v_lshlrev_b32 v28, 2, v22
v_xor_b32 v28, v28, v21
v_lshl_add_u32 v28, v28, 4, v23
s_mul_i32 s55, s32, 147456
v_lshrrev_b32 v23, 2, v21
v_and_b32 v24, 1, v21
v_lshl_add_u32 v23, v23, 1, v24
v_mul_u32_u24 v23, 1152, v23
v_lshl_add_u32 v23, v22, 5, v23
v_bfe_u32 v24, v21, 1, 1
v_lshl_add_u32 v23, v24, 4, v23
s_lshl_b32 s56, s32, 7
s_waitcnt lgkmcnt(0)
buffer_load_dwordx4 v[12:15], v23, s[24:27], s56 offen
v_and_b32 v23, 1, v22
v_lshrrev_b32 v24, 2, v21
v_lshl_add_u32 v23, v23, 2, v24
v_lshlrev_b32 v23, 1, v23
v_bfe_u32 v44, v21, 1, 1
v_add_u32 v44, 0, v44
v_xor_b32 v44, v44, v23
v_lshlrev_b32 v44, 4, v44
v_lshl_add_u32 v44, v24, 8, v44
v_and_b32 v23, 1, v22
v_lshl_add_u32 v44, v23, 11, v44
v_and_b32 v23, 1, v21
v_lshl_add_u32 v44, v23, 3, v44
v_lshrrev_b32 v23, 1, v22
v_mul_u32_u24 v23, 40960, v23
v_add_u32 v23, 16384, v23
v_add_u32 v44, v44, v23
v_and_b32 v23, 1, v22
v_lshrrev_b32 v24, 2, v21
v_lshl_add_u32 v23, v23, 2, v24
v_lshlrev_b32 v23, 1, v23
v_bfe_u32 v45, v21, 1, 1
v_add_u32 v45, 2, v45
v_xor_b32 v45, v45, v23
v_lshlrev_b32 v45, 4, v45
v_lshl_add_u32 v45, v24, 8, v45
v_and_b32 v23, 1, v22
v_lshl_add_u32 v45, v23, 11, v45
v_and_b32 v23, 1, v21
v_lshl_add_u32 v45, v23, 3, v45
v_lshrrev_b32 v23, 1, v22
v_mul_u32_u24 v23, 40960, v23
v_add_u32 v23, 16384, v23
v_add_u32 v45, v45, v23
v_and_b32 v23, 1, v22
v_lshrrev_b32 v24, 2, v21
v_lshl_add_u32 v23, v23, 2, v24
v_lshlrev_b32 v23, 1, v23
v_bfe_u32 v46, v21, 1, 1
v_add_u32 v46, 0, v46
v_xor_b32 v46, v46, v23
v_lshlrev_b32 v46, 4, v46
v_lshl_add_u32 v46, v24, 8, v46
v_and_b32 v23, 1, v22
v_lshl_add_u32 v46, v23, 11, v46
v_and_b32 v23, 1, v21
v_lshl_add_u32 v46, v23, 3, v46
v_lshrrev_b32 v23, 1, v22
v_mul_u32_u24 v23, 32768, v23
v_add_u32 v23, 98304, v23
v_add_u32 v46, v46, v23
v_and_b32 v23, 1, v22
v_lshrrev_b32 v24, 2, v21
v_lshl_add_u32 v23, v23, 2, v24
v_lshlrev_b32 v23, 1, v23
v_bfe_u32 v47, v21, 1, 1
v_add_u32 v47, 2, v47
v_xor_b32 v47, v47, v23
v_lshlrev_b32 v47, 4, v47
v_lshl_add_u32 v47, v24, 8, v47
v_and_b32 v23, 1, v22
v_lshl_add_u32 v47, v23, 11, v47
v_and_b32 v23, 1, v21
v_lshl_add_u32 v47, v23, 3, v47
v_lshrrev_b32 v23, 1, v22
v_mul_u32_u24 v23, 32768, v23
v_add_u32 v23, 98304, v23
v_add_u32 v47, v47, v23
v_and_b32 v23, 1, v22
v_bfe_u32 v24, v21, 2, 1
v_lshl_add_u32 v23, v23, 1, v24
v_xor_b32 v24, 0, v23
v_lshlrev_b32 v24, 6, v24
v_lshl_add_u32 v48, v23, 8, v24
v_and_b32 v23, 3, v21
v_lshl_add_u32 v48, v23, 4, v48
v_and_b32 v23, 8, v21
v_add_u32 v48, v48, v23
v_lshrrev_b32 v23, 1, v22
v_mul_u32_u24 v23, 40960, v23
v_add_u32 v23, 16384, v23
v_add_u32 v48, v48, v23
v_and_b32 v23, 1, v22
v_bfe_u32 v24, v21, 2, 1
v_lshl_add_u32 v23, v23, 1, v24
v_xor_b32 v24, 0, v23
v_lshlrev_b32 v24, 6, v24
v_lshl_add_u32 v49, v23, 8, v24
v_and_b32 v23, 3, v21
v_lshl_add_u32 v49, v23, 4, v49
v_and_b32 v23, 8, v21
v_add_u32 v49, v49, v23
v_lshrrev_b32 v23, 1, v22
v_mul_u32_u24 v23, 32768, v23
v_add_u32 v23, 98304, v23
v_add_u32 v49, v49, v23
v_bfe_u32 v23, v21, 1, 1
v_mul_u32_u24 v23, 0xaaaa, v23
v_add_u32 v0, 0x4444, v23
v_lshlrev_b32 v3, 3, v20
v_lshrrev_b32 v25, 5, v20
v_lshlrev_b32 v25, 6, v25
v_xor_b32 v3, v3, v25
v_lshrrev_b32 v25, 2, v20
v_and_b32 v4, 3, v21
v_lshl_add_u32 v4, v4, 4, v25
v_lshlrev_b32 v4, 3, v4
v_bfe_u32 v25, v21, 1, 1
v_lshlrev_b32 v23, 6, v25
v_xor_b32 v4, v4, v23
v_lshlrev_b32 v5, 4, v21
v_lshl_add_u32 v5, v22, 2, v5
v_mul_u32_u24 v23, 1024, v25
v_add_u32 v5, v5, v23
v_lshlrev_b32 v9, 8, v22
v_lshl_add_u32 v9, v25, 6, v9
v_bfe_u32 v23, v21, 3, 1
v_lshl_add_u32 v9, v23, 7, v9
v_bfe_u32 v23, v21, 2, 1
v_lshl_add_u32 v9, v23, 5, v9
v_and_b32 v23, 1, v21
v_lshl_add_u32 v9, v23, 4, v9
v_lshrrev_b32 v23, 1, v22
v_and_b32 v24, 1, v22
v_and_b32 v25, 7, v21
v_lshrrev_b32 v7, 3, v21
v_lshl_add_u32 v8, v7, 1, v23
v_lshlrev_b32 v8, 12, v8
v_lshl_add_u32 v8, v24, 7, v8
v_and_b32 v25, 4, v21
v_lshl_add_u32 v8, v25, 3, v8
v_and_b32 v25, 1, v21
v_lshl_add_u32 v8, v25, 4, v8
v_bfe_u32 v25, v21, 1, 1
v_lshl_add_u32 v8, v25, 3, v8
s_lshr_b32 s56, s32, 1
s_lshl_b32 s56, s56, 8
s_and_b32 s57, s32, 1
s_lshl_b32 s57, s57, 6
s_add_u32 s56, s56, s57
s_add_u32 s56, s56, 0
v_add_u32 v8, s56, v8
v_and_b32 v7, 0x3d0, v1
s_mov_b32 s42, 0
s_mov_b32 s43, 65536
s_mov_b32 s44, 131072
s_mov_b32 s45, 196608
s_mov_b32 s46, 262144
s_mov_b32 s47, 294912
s_mov_b32 s48, 299008
s_mov_b32 s49, 303104
s_mov_b32 s50, 0x3e0293ee
s_mov_b32 s51, 0x3e0293ee
s_mov_b32 s52, 0x3f803f80
s_mov_b32 s53, 0x3f803f80
v_lshlrev_b32 v11, 2, v21
s_mov_b32 s34, 0
s_mov_b32 s35, -1
s_mov_b32 s36, 0
s_mov_b32 s41, 300000
s_lshl_b32 s37, s32, 14
s_add_u32 s39, s37, 17301504
s_add_u32 s37, s37, 16777216
s_mov_b32 s40, 8749056
v_mov_b64 v[36:37], 0
v_mov_b64 v[38:39], 0
ds_write_b128 v1, v[36:39] offset:14336
s_lshl_b32 s56, s32, 1
s_add_u32 s56, s56, 0
s_cmp_eq_u32 s56, 0
s_cselect_b32 s56, 64, s56
s_mul_i32 s56, s56, 10240
s_add_u32 s56, s56, 8388608
s_add_u32 s57, s56, 4096
v_mov_b32 v40, 0
v_mov_b32 v41, 0
v_mov_b32 v42, 0
v_mov_b32 v43, 0
buffer_store_dwordx4 v[40:43], v1, s[4:7], s56 offen offset:0 sc0 sc1
buffer_store_dwordx4 v[40:43], v1, s[4:7], s56 offen offset:1024 sc0 sc1
buffer_store_dwordx4 v[40:43], v1, s[4:7], s56 offen offset:2048 sc0 sc1
buffer_store_dwordx4 v[40:43], v1, s[4:7], s56 offen offset:3072 sc0 sc1
s_add_u32 s56, s32, 64
s_lshl_b32 s3, s56, 12
v_and_b32 v23, 1, v21
v_bfe_u32 v24, v21, 2, 1
v_bfe_u32 v25, v21, 1, 1
s_lshl_b32 s57, s56, 7
s_add_u32 s57, s57, 294912
v_and_b32 v10, 7, v21
v_lshlrev_b32 v10, 2, v10
v_lshl_add_u32 v10, v22, 5, v10
v_add_u32 v10, s57, v10
s_lshl_b32 s33, s56, 2
s_add_u32 s33, s33, 304128
v_mov_b32 v30, -1
s_mov_b64 exec, 1
buffer_store_dword v30, v1, s[4:7], s33 offen sc0 sc1
s_mov_b64 exec, -1
v_lshl_add_u32 v23, v23, 1, v24
v_lshlrev_b32 v25, 4, v25
v_mov_b32 v24, 0x3f80
v_lshlrev_b32 v24, v25, v24
v_cmp_eq_u32 vcc, 0, v23
s_nop 1
v_cndmask_b32 v76, 0, v24, vcc
v_cmp_eq_u32 vcc, 1, v23
s_nop 1
v_cndmask_b32 v77, 0, v24, vcc
v_cmp_eq_u32 vcc, 2, v23
s_nop 1
v_cndmask_b32 v78, 0, v24, vcc
v_cmp_eq_u32 vcc, 3, v23
s_nop 1
v_cndmask_b32 v79, 0, v24, vcc
buffer_store_dwordx4 v[36:39], v9, s[4:7], s3 offen offset:0 sc0 sc1
buffer_store_dwordx4 v[36:39], v9, s[4:7], s3 offen offset:1024 sc0 sc1
buffer_store_dwordx4 v[36:39], v9, s[4:7], s3 offen offset:2048 sc0 sc1
buffer_store_dwordx4 v[36:39], v9, s[4:7], s3 offen offset:3072 sc0 sc1
s_lshl_b32 s56, s32, 10
s_cmp_ge_u32 s32, 9
s_cselect_b32 s56, 268435456, s56
s_add_u32 s57, s56, 8388608
s_add_u32 s56, s56, 294912
s_waitcnt vmcnt(9)
v_or_b32 v12, 1, v12
buffer_store_dwordx4 v[12:15], v1, s[4:7], s56 offen sc0 sc1
buffer_store_dwordx4 v[12:15], v1, s[4:7], s57 offen sc0 sc1
s_getreg_b32 s56, hwreg(HW_REG_XCC_ID)
s_and_b32 s56, s56, 15
s_mul_i32 s57, s56, s56
s_lshl_b32 s57, s57, 18
s_lshl_b32 s56, s56, 8
s_add_u32 s57, s57, s56
s_add_u32 s58, s57, 1
s_lshl_b32 s101, s32, 7
s_add_u32 s101, s101, 327680
v_mov_b32 v24, 0
s_add_u32 s56, s54, 0
s_mov_b32 m0, 28672
s_nop 0
buffer_load_dwordx4 v26, s[12:15], s56 offen lds
s_add_u32 s56, s54, 16384
s_mov_b32 m0, 29696
s_nop 0
buffer_load_dwordx4 v26, s[12:15], s56 offen lds
s_add_u32 s56, s54, 32768
s_mov_b32 m0, 30720
s_nop 0
buffer_load_dwordx4 v27, s[12:15], s56 offen lds
s_add_u32 s56, s54, 49152
s_mov_b32 m0, 31744
s_nop 0
buffer_load_dwordx4 v27, s[12:15], s56 offen lds
s_add_u32 s56, s54, 524288
s_mov_b32 m0, 32768
s_nop 0
buffer_load_dwordx4 v26, s[12:15], s56 offen lds
s_add_u32 s56, s54, 540672
s_mov_b32 m0, 33792
s_nop 0
buffer_load_dwordx4 v26, s[12:15], s56 offen lds
s_add_u32 s56, s54, 557056
s_mov_b32 m0, 34816
s_nop 0
buffer_load_dwordx4 v27, s[12:15], s56 offen lds
s_add_u32 s56, s54, 573440
s_mov_b32 m0, 35840
s_nop 0
buffer_load_dwordx4 v27, s[12:15], s56 offen lds
v_and_b32 v23, 3, v20
v_lshrrev_b32 v24, 2, v20
v_mul_u32_u24 v29, 1152, v24
v_lshl_add_u32 v29, v23, 4, v29
v_lshrrev_b32 v24, 2, v21
v_and_b32 v25, 1, v22
v_lshlrev_b32 v31, 10, v25
v_lshrrev_b32 v25, 1, v22
v_lshl_add_u32 v31, v25, 8, v31
v_and_b32 v25, 1, v24
v_lshl_add_u32 v31, v25, 6, v31
v_lshrrev_b32 v25, 1, v24
v_lshl_add_u32 v31, v25, 3, v31
v_lshl_add_u32 v31, v23, 4, v31
v_add_u32 v31, 16384, v31
s_add_u32 s56, s55, 1024
s_mov_b32 m0, 49152
s_nop 0
buffer_load_dwordx4 v29, s[20:23], s56 offen lds
s_add_u32 s56, s55, 19456
s_mov_b32 m0, 50176
s_nop 0
buffer_load_dwordx4 v29, s[20:23], s56 offen lds
s_add_u32 s56, s55, 37888
s_mov_b32 m0, 51200
s_nop 0
buffer_load_dwordx4 v29, s[20:23], s56 offen lds
s_add_u32 s56, s55, 56320
s_mov_b32 m0, 52224
s_nop 0
buffer_load_dwordx4 v29, s[20:23], s56 offen lds
s_add_u32 s56, s55, 74752
s_mov_b32 m0, 53248
s_nop 0
buffer_load_dwordx4 v29, s[20:23], s56 offen lds
s_add_u32 s56, s55, 93184
s_mov_b32 m0, 54272
s_nop 0
buffer_load_dwordx4 v29, s[20:23], s56 offen lds
s_add_u32 s56, s55, 111616
s_mov_b32 m0, 55296
s_nop 0
buffer_load_dwordx4 v29, s[20:23], s56 offen lds
s_add_u32 s56, s55, 130048
s_mov_b32 m0, 56320
s_nop 0
buffer_load_dwordx4 v29, s[20:23], s56 offen lds
v_mov_b32 v24, 0
s_barrier
ds_read_b64_tr_b16 v[80:81], v44 offset:20480
ds_read_b64_tr_b16 v[82:83], v44 offset:21504
ds_read_b64_tr_b16 v[84:85], v46 offset:20480
ds_read_b64_tr_b16 v[86:87], v46 offset:21504
ds_read_b64_tr_b16 v[88:89], v45 offset:20480
ds_read_b64_tr_b16 v[90:91], v45 offset:21504
ds_read_b64_tr_b16 v[92:93], v47 offset:20480
ds_read_b64_tr_b16 v[94:95], v47 offset:21504
s_waitcnt lgkmcnt(0)
s_barrier
s_add_u32 s56, s54, 1048576
s_mov_b32 m0, 36864
s_nop 0
buffer_load_dwordx4 v26, s[12:15], s56 offen lds
s_add_u32 s56, s54, 1064960
s_mov_b32 m0, 37888
s_nop 0
buffer_load_dwordx4 v26, s[12:15], s56 offen lds
s_add_u32 s56, s54, 1081344
s_mov_b32 m0, 38912
s_nop 0
buffer_load_dwordx4 v27, s[12:15], s56 offen lds
s_add_u32 s56, s54, 1097728
s_mov_b32 m0, 39936
s_nop 0
buffer_load_dwordx4 v27, s[12:15], s56 offen lds
ds_read_b64_tr_b16 v[96:97], v44 offset:24576
ds_read_b64_tr_b16 v[98:99], v44 offset:25600
ds_read_b64_tr_b16 v[100:101], v46 offset:24576
ds_read_b64_tr_b16 v[102:103], v46 offset:25600
ds_read_b64_tr_b16 v[104:105], v45 offset:24576
ds_read_b64_tr_b16 v[106:107], v45 offset:25600
ds_read_b64_tr_b16 v[108:109], v47 offset:24576
ds_read_b64_tr_b16 v[110:111], v47 offset:25600
s_waitcnt lgkmcnt(0)
s_barrier
s_add_u32 s56, s54, 1572864
s_mov_b32 m0, 40960
s_nop 0
buffer_load_dwordx4 v26, s[12:15], s56 offen lds
s_add_u32 s56, s54, 1589248
s_mov_b32 m0, 41984
s_nop 0
buffer_load_dwordx4 v26, s[12:15], s56 offen lds
s_add_u32 s56, s54, 1605632
s_mov_b32 m0, 43008
s_nop 0
buffer_load_dwordx4 v27, s[12:15], s56 offen lds
s_add_u32 s56, s54, 1622016
s_mov_b32 m0, 44032
s_nop 0
buffer_load_dwordx4 v27, s[12:15], s56 offen lds
ds_read_b64_tr_b16 v[112:113], v44 offset:28672
ds_read_b64_tr_b16 v[114:115], v44 offset:29696
ds_read_b64_tr_b16 v[116:117], v46 offset:28672
ds_read_b64_tr_b16 v[118:119], v46 offset:29696
ds_read_b64_tr_b16 v[120:121], v45 offset:28672
ds_read_b64_tr_b16 v[122:123], v45 offset:29696
ds_read_b64_tr_b16 v[124:125], v47 offset:28672
ds_read_b64_tr_b16 v[126:127], v47 offset:29696
s_waitcnt lgkmcnt(0)
s_barrier
s_add_u32 s56, s54, 2097152
s_mov_b32 m0, 45056
s_nop 0
buffer_load_dwordx4 v26, s[12:15], s56 offen lds
s_add_u32 s56, s54, 2113536
s_mov_b32 m0, 46080
s_nop 0
buffer_load_dwordx4 v26, s[12:15], s56 offen lds
s_add_u32 s56, s54, 2129920
s_mov_b32 m0, 47104
s_nop 0
buffer_load_dwordx4 v27, s[12:15], s56 offen lds
s_add_u32 s56, s54, 2146304
s_mov_b32 m0, 48128
s_nop 0
buffer_load_dwordx4 v27, s[12:15], s56 offen lds
ds_read_b64_tr_b16 v[128:129], v44 offset:0
ds_read_b64_tr_b16 v[130:131], v44 offset:1024
ds_read_b64_tr_b16 v[132:133], v46 offset:0
ds_read_b64_tr_b16 v[134:135], v46 offset:1024
ds_read_b64_tr_b16 v[136:137], v45 offset:0
ds_read_b64_tr_b16 v[138:139], v45 offset:1024
ds_read_b64_tr_b16 v[140:141], v47 offset:0
ds_read_b64_tr_b16 v[142:143], v47 offset:1024
s_waitcnt lgkmcnt(0)
s_barrier
s_add_u32 s56, s54, 3145728
s_mov_b32 m0, 16384
s_nop 0
buffer_load_dwordx4 v26, s[12:15], s56 offen lds
s_add_u32 s56, s54, 3162112
s_mov_b32 m0, 17408
s_nop 0
buffer_load_dwordx4 v26, s[12:15], s56 offen lds
s_add_u32 s56, s54, 3178496
s_mov_b32 m0, 18432
s_nop 0
buffer_load_dwordx4 v27, s[12:15], s56 offen lds
s_add_u32 s56, s54, 3194880
s_mov_b32 m0, 19456
s_nop 0
buffer_load_dwordx4 v27, s[12:15], s56 offen lds
ds_read_b64_tr_b16 v[144:145], v44 offset:4096
ds_read_b64_tr_b16 v[146:147], v44 offset:5120
ds_read_b64_tr_b16 v[148:149], v46 offset:4096
ds_read_b64_tr_b16 v[150:151], v46 offset:5120
ds_read_b64_tr_b16 v[152:153], v45 offset:4096
ds_read_b64_tr_b16 v[154:155], v45 offset:5120
ds_read_b64_tr_b16 v[156:157], v47 offset:4096
ds_read_b64_tr_b16 v[158:159], v47 offset:5120
s_waitcnt lgkmcnt(0)
s_barrier
s_add_u32 s56, s54, 3670016
s_mov_b32 m0, 20480
s_nop 0
buffer_load_dwordx4 v26, s[12:15], s56 offen lds
s_add_u32 s56, s54, 3686400
s_mov_b32 m0, 21504
s_nop 0
buffer_load_dwordx4 v26, s[12:15], s56 offen lds
s_add_u32 s56, s54, 3702784
s_mov_b32 m0, 22528
s_nop 0
buffer_load_dwordx4 v27, s[12:15], s56 offen lds
s_add_u32 s56, s54, 3719168
s_mov_b32 m0, 23552
s_nop 0
buffer_load_dwordx4 v27, s[12:15], s56 offen lds
ds_read_b64_tr_b16 v[160:161], v44 offset:8192
ds_read_b64_tr_b16 v[162:163], v44 offset:9216
ds_read_b64_tr_b16 v[164:165], v46 offset:8192
ds_read_b64_tr_b16 v[166:167], v46 offset:9216
ds_read_b64_tr_b16 v[168:169], v45 offset:8192
ds_read_b64_tr_b16 v[170:171], v45 offset:9216
ds_read_b64_tr_b16 v[172:173], v47 offset:8192
ds_read_b64_tr_b16 v[174:175], v47 offset:9216
s_waitcnt lgkmcnt(0)
s_waitcnt vmcnt(32)
s_barrier
s_add_u32 s56, s54, 4194304
s_mov_b32 m0, 24576
s_nop 0
buffer_load_dwordx4 v26, s[12:15], s56 offen lds
s_add_u32 s56, s54, 4210688
s_mov_b32 m0, 25600
s_nop 0
buffer_load_dwordx4 v26, s[12:15], s56 offen lds
s_add_u32 s56, s54, 4227072
s_mov_b32 m0, 26624
s_nop 0
buffer_load_dwordx4 v27, s[12:15], s56 offen lds
s_add_u32 s56, s54, 4243456
s_mov_b32 m0, 27648
s_nop 0
buffer_load_dwordx4 v27, s[12:15], s56 offen lds
ds_read_b64_tr_b16 v[176:177], v44 offset:12288
ds_read_b64_tr_b16 v[178:179], v44 offset:13312
ds_read_b64_tr_b16 v[180:181], v46 offset:12288
ds_read_b64_tr_b16 v[182:183], v46 offset:13312
ds_read_b64_tr_b16 v[184:185], v45 offset:12288
ds_read_b64_tr_b16 v[186:187], v45 offset:13312
ds_read_b64_tr_b16 v[188:189], v47 offset:12288
ds_read_b64_tr_b16 v[190:191], v47 offset:13312
v_mov_b32 v23, s58
s_mov_b64 exec, 1
buffer_atomic_add v23, v24, s[28:31], 0 offen sc1
s_mov_b64 exec, -1
s_waitcnt lgkmcnt(0)
s_waitcnt vmcnt(33)
s_barrier
s_add_u32 s56, s54, 0
s_mov_b32 m0, 28672
s_nop 0
buffer_load_dwordx4 v26, s[16:19], s56 offen lds
s_add_u32 s56, s54, 16384
s_mov_b32 m0, 29696
s_nop 0
buffer_load_dwordx4 v26, s[16:19], s56 offen lds
s_add_u32 s56, s54, 32768
s_mov_b32 m0, 30720
s_nop 0
buffer_load_dwordx4 v27, s[16:19], s56 offen lds
s_add_u32 s56, s54, 49152
s_mov_b32 m0, 31744
s_nop 0
buffer_load_dwordx4 v27, s[16:19], s56 offen lds
ds_read_b64_tr_b16 v[192:193], v44 offset:16384
ds_read_b64_tr_b16 v[194:195], v44 offset:17408
ds_read_b64_tr_b16 v[196:197], v46 offset:16384
ds_read_b64_tr_b16 v[198:199], v46 offset:17408
ds_read_b64_tr_b16 v[200:201], v45 offset:16384
ds_read_b64_tr_b16 v[202:203], v45 offset:17408
ds_read_b64_tr_b16 v[204:205], v47 offset:16384
ds_read_b64_tr_b16 v[206:207], v47 offset:17408
s_waitcnt lgkmcnt(0)
s_waitcnt vmcnt(25)
s_barrier
s_add_u32 s56, s54, 524288
s_mov_b32 m0, 32768
s_nop 0
buffer_load_dwordx4 v26, s[16:19], s56 offen lds
s_add_u32 s56, s54, 540672
s_mov_b32 m0, 33792
s_nop 0
buffer_load_dwordx4 v26, s[16:19], s56 offen lds
s_add_u32 s56, s54, 557056
s_mov_b32 m0, 34816
s_nop 0
buffer_load_dwordx4 v27, s[16:19], s56 offen lds
s_add_u32 s56, s54, 573440
s_mov_b32 m0, 35840
s_nop 0
buffer_load_dwordx4 v27, s[16:19], s56 offen lds
ds_read_b64_tr_b16 v[208:209], v44 offset:20480
ds_read_b64_tr_b16 v[210:211], v44 offset:21504
ds_read_b64_tr_b16 v[212:213], v46 offset:20480
ds_read_b64_tr_b16 v[214:215], v46 offset:21504
ds_read_b64_tr_b16 v[216:217], v45 offset:20480
ds_read_b64_tr_b16 v[218:219], v45 offset:21504
ds_read_b64_tr_b16 v[220:221], v47 offset:20480
ds_read_b64_tr_b16 v[222:223], v47 offset:21504
s_waitcnt lgkmcnt(0)
s_waitcnt vmcnt(25)
s_barrier
s_add_u32 s56, s54, 1048576
s_mov_b32 m0, 36864
s_nop 0
buffer_load_dwordx4 v26, s[16:19], s56 offen lds
s_add_u32 s56, s54, 1064960
s_mov_b32 m0, 37888
s_nop 0
buffer_load_dwordx4 v26, s[16:19], s56 offen lds
s_add_u32 s56, s54, 1081344
s_mov_b32 m0, 38912
s_nop 0
buffer_load_dwordx4 v27, s[16:19], s56 offen lds
s_add_u32 s56, s54, 1097728
s_mov_b32 m0, 39936
s_nop 0
buffer_load_dwordx4 v27, s[16:19], s56 offen lds
ds_read_b64_tr_b16 v[224:225], v44 offset:24576
ds_read_b64_tr_b16 v[226:227], v44 offset:25600
ds_read_b64_tr_b16 v[228:229], v46 offset:24576
ds_read_b64_tr_b16 v[230:231], v46 offset:25600
ds_read_b64_tr_b16 v[232:233], v45 offset:24576
ds_read_b64_tr_b16 v[234:235], v45 offset:25600
ds_read_b64_tr_b16 v[236:237], v47 offset:24576
ds_read_b64_tr_b16 v[238:239], v47 offset:25600
ds_read_b64_tr_b16 v[60:61], v31 offset:32768
ds_read_b64_tr_b16 v[62:63], v31 offset:32896
ds_read_b64_tr_b16 v[64:65], v31 offset:33280
ds_read_b64_tr_b16 v[66:67], v31 offset:33408
ds_read_b64_tr_b16 v[68:69], v31 offset:34816
ds_read_b64_tr_b16 v[70:71], v31 offset:34944
ds_read_b64_tr_b16 v[72:73], v31 offset:35328
ds_read_b64_tr_b16 v[74:75], v31 offset:35456
s_waitcnt lgkmcnt(0)
ds_write_b128 v2, v[60:63] offset:32768
ds_write_b128 v2, v[64:67] offset:33792
ds_write_b128 v2, v[68:71] offset:34816
ds_write_b128 v2, v[72:75] offset:35840
s_waitcnt lgkmcnt(0)
s_waitcnt vmcnt(25)
s_barrier
s_add_u32 s56, s54, 1572864
s_mov_b32 m0, 40960
s_nop 0
buffer_load_dwordx4 v26, s[16:19], s56 offen lds
s_add_u32 s56, s54, 1589248
s_mov_b32 m0, 41984
s_nop 0
buffer_load_dwordx4 v26, s[16:19], s56 offen lds
s_add_u32 s56, s54, 1605632
s_mov_b32 m0, 43008
s_nop 0
buffer_load_dwordx4 v27, s[16:19], s56 offen lds
s_add_u32 s56, s54, 1622016
s_mov_b32 m0, 44032
s_nop 0
buffer_load_dwordx4 v27, s[16:19], s56 offen lds
ds_read_b64_tr_b16 v[240:241], v44 offset:28672
ds_read_b64_tr_b16 v[242:243], v44 offset:29696
ds_read_b64_tr_b16 v[244:245], v46 offset:28672
ds_read_b64_tr_b16 v[246:247], v46 offset:29696
ds_read_b64_tr_b16 v[248:249], v45 offset:28672
ds_read_b64_tr_b16 v[250:251], v45 offset:29696
ds_read_b64_tr_b16 v[252:253], v47 offset:28672
ds_read_b64_tr_b16 v[254:255], v47 offset:29696
ds_read_b64_tr_b16 v[60:61], v31 offset:36864
ds_read_b64_tr_b16 v[62:63], v31 offset:36992
ds_read_b64_tr_b16 v[64:65], v31 offset:37376
ds_read_b64_tr_b16 v[66:67], v31 offset:37504
ds_read_b64_tr_b16 v[68:69], v31 offset:38912
ds_read_b64_tr_b16 v[70:71], v31 offset:39040
ds_read_b64_tr_b16 v[72:73], v31 offset:39424
ds_read_b64_tr_b16 v[74:75], v31 offset:39552
s_waitcnt lgkmcnt(0)
ds_write_b128 v2, v[60:63] offset:36864
ds_write_b128 v2, v[64:67] offset:37888
ds_write_b128 v2, v[68:71] offset:38912
ds_write_b128 v2, v[72:75] offset:39936
s_waitcnt lgkmcnt(0)
s_waitcnt vmcnt(25)
s_barrier
s_add_u32 s56, s54, 2097152
s_mov_b32 m0, 45056
s_nop 0
buffer_load_dwordx4 v26, s[16:19], s56 offen lds
s_add_u32 s56, s54, 2113536
s_mov_b32 m0, 46080
s_nop 0
buffer_load_dwordx4 v26, s[16:19], s56 offen lds
s_add_u32 s56, s54, 2129920
s_mov_b32 m0, 47104
s_nop 0
buffer_load_dwordx4 v27, s[16:19], s56 offen lds
s_add_u32 s56, s54, 2146304
s_mov_b32 m0, 48128
s_nop 0
buffer_load_dwordx4 v27, s[16:19], s56 offen lds
ds_read_b64_tr_b16 a[0:1], v44 offset:0
ds_read_b64_tr_b16 a[2:3], v44 offset:1024
ds_read_b64_tr_b16 a[4:5], v46 offset:0
ds_read_b64_tr_b16 a[6:7], v46 offset:1024
ds_read_b64_tr_b16 a[8:9], v45 offset:0
ds_read_b64_tr_b16 a[10:11], v45 offset:1024
ds_read_b64_tr_b16 a[12:13], v47 offset:0
ds_read_b64_tr_b16 a[14:15], v47 offset:1024
s_waitcnt lgkmcnt(0)
s_waitcnt vmcnt(25)
s_barrier
s_add_u32 s56, s54, 2621440
s_mov_b32 m0, 16384
s_nop 0
buffer_load_dwordx4 v26, s[16:19], s56 offen lds
s_add_u32 s56, s54, 2637824
s_mov_b32 m0, 17408
s_nop 0
buffer_load_dwordx4 v26, s[16:19], s56 offen lds
s_add_u32 s56, s54, 2654208
s_mov_b32 m0, 18432
s_nop 0
buffer_load_dwordx4 v27, s[16:19], s56 offen lds
s_add_u32 s56, s54, 2670592
s_mov_b32 m0, 19456
s_nop 0
buffer_load_dwordx4 v27, s[16:19], s56 offen lds
ds_read_b64_tr_b16 a[16:17], v44 offset:4096
ds_read_b64_tr_b16 a[18:19], v44 offset:5120
ds_read_b64_tr_b16 a[20:21], v46 offset:4096
ds_read_b64_tr_b16 a[22:23], v46 offset:5120
ds_read_b64_tr_b16 a[24:25], v45 offset:4096
ds_read_b64_tr_b16 a[26:27], v45 offset:5120
ds_read_b64_tr_b16 a[28:29], v47 offset:4096
ds_read_b64_tr_b16 a[30:31], v47 offset:5120
s_waitcnt lgkmcnt(0)
s_waitcnt vmcnt(25)
s_barrier
s_add_u32 s56, s54, 3145728
s_mov_b32 m0, 20480
s_nop 0
buffer_load_dwordx4 v26, s[16:19], s56 offen lds
s_add_u32 s56, s54, 3162112
s_mov_b32 m0, 21504
s_nop 0
buffer_load_dwordx4 v26, s[16:19], s56 offen lds
s_add_u32 s56, s54, 3178496
s_mov_b32 m0, 22528
s_nop 0
buffer_load_dwordx4 v27, s[16:19], s56 offen lds
s_add_u32 s56, s54, 3194880
s_mov_b32 m0, 23552
s_nop 0
buffer_load_dwordx4 v27, s[16:19], s56 offen lds
ds_read_b64_tr_b16 a[32:33], v44 offset:8192
ds_read_b64_tr_b16 a[34:35], v44 offset:9216
ds_read_b64_tr_b16 a[36:37], v46 offset:8192
ds_read_b64_tr_b16 a[38:39], v46 offset:9216
ds_read_b64_tr_b16 a[40:41], v45 offset:8192
ds_read_b64_tr_b16 a[42:43], v45 offset:9216
ds_read_b64_tr_b16 a[44:45], v47 offset:8192
ds_read_b64_tr_b16 a[46:47], v47 offset:9216
s_waitcnt lgkmcnt(0)
s_waitcnt vmcnt(24)
s_barrier
s_add_u32 s56, s54, 3670016
s_mov_b32 m0, 24576
s_nop 0
buffer_load_dwordx4 v26, s[16:19], s56 offen lds
s_add_u32 s56, s54, 3686400
s_mov_b32 m0, 25600
s_nop 0
buffer_load_dwordx4 v26, s[16:19], s56 offen lds
s_add_u32 s56, s54, 3702784
s_mov_b32 m0, 26624
s_nop 0
buffer_load_dwordx4 v27, s[16:19], s56 offen lds
s_add_u32 s56, s54, 3719168
s_mov_b32 m0, 27648
s_nop 0
buffer_load_dwordx4 v27, s[16:19], s56 offen lds
ds_read_b64_tr_b16 a[48:49], v44 offset:12288
ds_read_b64_tr_b16 a[50:51], v44 offset:13312
ds_read_b64_tr_b16 a[52:53], v46 offset:12288
ds_read_b64_tr_b16 a[54:55], v46 offset:13312
ds_read_b64_tr_b16 a[56:57], v45 offset:12288
ds_read_b64_tr_b16 a[58:59], v45 offset:13312
ds_read_b64_tr_b16 a[60:61], v47 offset:12288
ds_read_b64_tr_b16 a[62:63], v47 offset:13312
s_waitcnt lgkmcnt(0)
s_waitcnt vmcnt(24)
s_barrier
s_add_u32 s56, s55, 73728
s_mov_b32 m0, 28672
s_nop 0
buffer_load_dwordx4 v28, s[20:23], s56 offen lds
s_add_u32 s56, s55, 76032
s_mov_b32 m0, 29696
s_nop 0
buffer_load_dwordx4 v28, s[20:23], s56 offen lds
s_add_u32 s56, s55, 82944
s_mov_b32 m0, 30720
s_nop 0
buffer_load_dwordx4 v28, s[20:23], s56 offen lds
s_add_u32 s56, s55, 85248
s_mov_b32 m0, 31744
s_nop 0
buffer_load_dwordx4 v28, s[20:23], s56 offen lds
ds_read_b64_tr_b16 a[64:65], v44 offset:16384
ds_read_b64_tr_b16 a[66:67], v44 offset:17408
ds_read_b64_tr_b16 a[68:69], v46 offset:16384
ds_read_b64_tr_b16 a[70:71], v46 offset:17408
ds_read_b64_tr_b16 a[72:73], v45 offset:16384
ds_read_b64_tr_b16 a[74:75], v45 offset:17408
ds_read_b64_tr_b16 a[76:77], v47 offset:16384
ds_read_b64_tr_b16 a[78:79], v47 offset:17408
s_waitcnt lgkmcnt(0)
s_waitcnt vmcnt(24)
s_barrier
s_add_u32 s56, s55, 73984
s_mov_b32 m0, 32768
s_nop 0
buffer_load_dwordx4 v28, s[20:23], s56 offen lds
s_add_u32 s56, s55, 76288
s_mov_b32 m0, 33792
s_nop 0
buffer_load_dwordx4 v28, s[20:23], s56 offen lds
s_add_u32 s56, s55, 83200
s_mov_b32 m0, 34816
s_nop 0
buffer_load_dwordx4 v28, s[20:23], s56 offen lds
s_add_u32 s56, s55, 85504
s_mov_b32 m0, 35840
s_nop 0
buffer_load_dwordx4 v28, s[20:23], s56 offen lds
ds_read_b64_tr_b16 a[80:81], v44 offset:20480
ds_read_b64_tr_b16 a[82:83], v44 offset:21504
ds_read_b64_tr_b16 a[84:85], v46 offset:20480
ds_read_b64_tr_b16 a[86:87], v46 offset:21504
ds_read_b64_tr_b16 a[88:89], v45 offset:20480
ds_read_b64_tr_b16 a[90:91], v45 offset:21504
ds_read_b64_tr_b16 a[92:93], v47 offset:20480
ds_read_b64_tr_b16 a[94:95], v47 offset:21504
s_waitcnt lgkmcnt(0)
s_waitcnt vmcnt(24)
s_barrier
s_add_u32 s56, s55, 74240
s_mov_b32 m0, 36864
s_nop 0
buffer_load_dwordx4 v28, s[20:23], s56 offen lds
s_add_u32 s56, s55, 76544
s_mov_b32 m0, 37888
s_nop 0
buffer_load_dwordx4 v28, s[20:23], s56 offen lds
s_add_u32 s56, s55, 83456
s_mov_b32 m0, 38912
s_nop 0
buffer_load_dwordx4 v28, s[20:23], s56 offen lds
s_add_u32 s56, s55, 85760
s_mov_b32 m0, 39936
s_nop 0
buffer_load_dwordx4 v28, s[20:23], s56 offen lds
ds_read_b64_tr_b16 a[96:97], v44 offset:24576
ds_read_b64_tr_b16 a[98:99], v44 offset:25600
ds_read_b64_tr_b16 a[100:101], v46 offset:24576
ds_read_b64_tr_b16 a[102:103], v46 offset:25600
ds_read_b64_tr_b16 a[104:105], v45 offset:24576
ds_read_b64_tr_b16 a[106:107], v45 offset:25600
ds_read_b64_tr_b16 a[108:109], v47 offset:24576
ds_read_b64_tr_b16 a[110:111], v47 offset:25600
s_waitcnt lgkmcnt(0)
s_waitcnt vmcnt(24)
s_barrier
s_add_u32 s56, s55, 74496
s_mov_b32 m0, 40960
s_nop 0
buffer_load_dwordx4 v28, s[20:23], s56 offen lds
s_add_u32 s56, s55, 76800
s_mov_b32 m0, 41984
s_nop 0
buffer_load_dwordx4 v28, s[20:23], s56 offen lds
s_add_u32 s56, s55, 83712
s_mov_b32 m0, 43008
s_nop 0
buffer_load_dwordx4 v28, s[20:23], s56 offen lds
s_add_u32 s56, s55, 86016
s_mov_b32 m0, 44032
s_nop 0
buffer_load_dwordx4 v28, s[20:23], s56 offen lds
ds_read_b64_tr_b16 a[112:113], v44 offset:28672
ds_read_b64_tr_b16 a[114:115], v44 offset:29696
ds_read_b64_tr_b16 a[116:117], v46 offset:28672
ds_read_b64_tr_b16 a[118:119], v46 offset:29696
ds_read_b64_tr_b16 a[120:121], v45 offset:28672
ds_read_b64_tr_b16 a[122:123], v45 offset:29696
ds_read_b64_tr_b16 a[124:125], v47 offset:28672
ds_read_b64_tr_b16 a[126:127], v47 offset:29696
s_waitcnt lgkmcnt(0)
s_waitcnt vmcnt(24)
s_barrier
s_add_u32 s56, s55, 0
s_mov_b32 m0, 45056
s_nop 0
buffer_load_dwordx4 v28, s[20:23], s56 offen lds
s_add_u32 s56, s55, 2304
s_mov_b32 m0, 46080
s_nop 0
buffer_load_dwordx4 v28, s[20:23], s56 offen lds
s_add_u32 s56, s55, 9216
s_mov_b32 m0, 47104
s_nop 0
buffer_load_dwordx4 v28, s[20:23], s56 offen lds
s_add_u32 s56, s55, 11520
s_mov_b32 m0, 48128
s_nop 0
buffer_load_dwordx4 v28, s[20:23], s56 offen lds
ds_read_b64_tr_b16 a[128:129], v44 offset:0
ds_read_b64_tr_b16 a[130:131], v44 offset:1024
ds_read_b64_tr_b16 a[132:133], v46 offset:0
ds_read_b64_tr_b16 a[134:135], v46 offset:1024
ds_read_b64_tr_b16 a[136:137], v45 offset:0
ds_read_b64_tr_b16 a[138:139], v45 offset:1024
ds_read_b64_tr_b16 a[140:141], v47 offset:0
ds_read_b64_tr_b16 a[142:143], v47 offset:1024
buffer_load_dword v32, v24, s[28:31], 0 offen sc0 sc1
s_waitcnt lgkmcnt(0)
s_waitcnt vmcnt(25)
s_barrier
s_add_u32 s56, s54, 0
s_mov_b32 m0, 16384
s_nop 0
buffer_load_dwordx4 v26, s[8:11], s56 offen lds
s_add_u32 s56, s54, 16384
s_mov_b32 m0, 17408
s_nop 0
buffer_load_dwordx4 v26, s[8:11], s56 offen lds
s_add_u32 s56, s54, 32768
s_mov_b32 m0, 18432
s_nop 0
buffer_load_dwordx4 v27, s[8:11], s56 offen lds
s_add_u32 s56, s54, 49152
s_mov_b32 m0, 19456
s_nop 0
buffer_load_dwordx4 v27, s[8:11], s56 offen lds
ds_read_b64_tr_b16 a[144:145], v44 offset:4096
ds_read_b64_tr_b16 a[146:147], v44 offset:5120
ds_read_b64_tr_b16 a[148:149], v46 offset:4096
ds_read_b64_tr_b16 a[150:151], v46 offset:5120
ds_read_b64_tr_b16 a[152:153], v45 offset:4096
ds_read_b64_tr_b16 a[154:155], v45 offset:5120
ds_read_b64_tr_b16 a[156:157], v47 offset:4096
ds_read_b64_tr_b16 a[158:159], v47 offset:5120
s_waitcnt lgkmcnt(0)
s_waitcnt vmcnt(25)
s_barrier
s_add_u32 s56, s54, 1572864
s_mov_b32 m0, 20480
s_nop 0
buffer_load_dwordx4 v26, s[8:11], s56 offen lds
s_add_u32 s56, s54, 1589248
s_mov_b32 m0, 21504
s_nop 0
buffer_load_dwordx4 v26, s[8:11], s56 offen lds
s_add_u32 s56, s54, 1605632
s_mov_b32 m0, 22528
s_nop 0
buffer_load_dwordx4 v27, s[8:11], s56 offen lds
s_add_u32 s56, s54, 1622016
s_mov_b32 m0, 23552
s_nop 0
buffer_load_dwordx4 v27, s[8:11], s56 offen lds
ds_read_b64_tr_b16 a[160:161], v44 offset:8192
ds_read_b64_tr_b16 a[162:163], v44 offset:9216
ds_read_b64_tr_b16 a[164:165], v46 offset:8192
ds_read_b64_tr_b16 a[166:167], v46 offset:9216
ds_read_b64_tr_b16 a[168:169], v45 offset:8192
ds_read_b64_tr_b16 a[170:171], v45 offset:9216
ds_read_b64_tr_b16 a[172:173], v47 offset:8192
ds_read_b64_tr_b16 a[174:175], v47 offset:9216
s_waitcnt lgkmcnt(0)
s_waitcnt vmcnt(25)
s_barrier
s_add_u32 s56, s54, 2097152
s_mov_b32 m0, 24576
s_nop 0
buffer_load_dwordx4 v26, s[8:11], s56 offen lds
s_add_u32 s56, s54, 2113536
s_mov_b32 m0, 25600
s_nop 0
buffer_load_dwordx4 v26, s[8:11], s56 offen lds
s_add_u32 s56, s54, 2129920
s_mov_b32 m0, 26624
s_nop 0
buffer_load_dwordx4 v27, s[8:11], s56 offen lds
s_add_u32 s56, s54, 2146304
s_mov_b32 m0, 27648
s_nop 0
buffer_load_dwordx4 v27, s[8:11], s56 offen lds
ds_read_b64_tr_b16 a[184:185], v48 offset:12288
ds_read_b64_tr_b16 a[186:187], v48 offset:13312
ds_read_b64_tr_b16 a[188:189], v48 offset:14336
ds_read_b64_tr_b16 a[190:191], v48 offset:15360
ds_read_b64_tr_b16 a[200:201], v49 offset:12288
ds_read_b64_tr_b16 a[202:203], v49 offset:13312
ds_read_b64_tr_b16 a[204:205], v49 offset:14336
ds_read_b64_tr_b16 a[206:207], v49 offset:15360
s_waitcnt lgkmcnt(0)
s_waitcnt vmcnt(25)
s_barrier
s_add_u32 s56, s54, 2621440
s_mov_b32 m0, 28672
s_nop 0
buffer_load_dwordx4 v26, s[12:15], s56 offen lds
s_add_u32 s56, s54, 2637824
s_mov_b32 m0, 29696
s_nop 0
buffer_load_dwordx4 v26, s[12:15], s56 offen lds
s_add_u32 s56, s54, 2654208
s_mov_b32 m0, 30720
s_nop 0
buffer_load_dwordx4 v27, s[12:15], s56 offen lds
s_add_u32 s56, s54, 2670592
s_mov_b32 m0, 31744
s_nop 0
buffer_load_dwordx4 v27, s[12:15], s56 offen lds
ds_read_b64_tr_b16 a[208:209], v48 offset:16384
ds_read_b64_tr_b16 a[210:211], v48 offset:17408
ds_read_b64_tr_b16 a[212:213], v48 offset:18432
ds_read_b64_tr_b16 a[214:215], v48 offset:19456
ds_read_b64_tr_b16 a[216:217], v49 offset:16384
ds_read_b64_tr_b16 a[218:219], v49 offset:17408
ds_read_b64_tr_b16 a[220:221], v49 offset:18432
ds_read_b64_tr_b16 a[222:223], v49 offset:19456
s_waitcnt lgkmcnt(0)
s_waitcnt vmcnt(25)
s_barrier
s_add_u32 s56, s54, 4194304
s_mov_b32 m0, 32768
s_nop 0
buffer_load_dwordx4 v26, s[16:19], s56 offen lds
s_add_u32 s56, s54, 4210688
s_mov_b32 m0, 33792
s_nop 0
buffer_load_dwordx4 v26, s[16:19], s56 offen lds
s_add_u32 s56, s54, 4227072
s_mov_b32 m0, 34816
s_nop 0
buffer_load_dwordx4 v27, s[16:19], s56 offen lds
s_add_u32 s56, s54, 4243456
s_mov_b32 m0, 35840
s_nop 0
buffer_load_dwordx4 v27, s[16:19], s56 offen lds
ds_read_b64_tr_b16 a[224:225], v48 offset:20480
ds_read_b64_tr_b16 a[226:227], v48 offset:21504
ds_read_b64_tr_b16 a[228:229], v48 offset:22528
ds_read_b64_tr_b16 a[230:231], v48 offset:23552
ds_read_b64_tr_b16 a[232:233], v49 offset:20480
ds_read_b64_tr_b16 a[234:235], v49 offset:21504
ds_read_b64_tr_b16 a[236:237], v49 offset:22528
ds_read_b64_tr_b16 a[238:239], v49 offset:23552
s_waitcnt lgkmcnt(0)
s_waitcnt vmcnt(25)
s_barrier
s_add_u32 s56, s55, 256
s_mov_b32 m0, 36864
s_nop 0
buffer_load_dwordx4 v28, s[20:23], s56 offen lds
s_add_u32 s56, s55, 2560
s_mov_b32 m0, 37888
s_nop 0
buffer_load_dwordx4 v28, s[20:23], s56 offen lds
s_add_u32 s56, s55, 9472
s_mov_b32 m0, 38912
s_nop 0
buffer_load_dwordx4 v28, s[20:23], s56 offen lds
s_add_u32 s56, s55, 11776
s_mov_b32 m0, 39936
s_nop 0
buffer_load_dwordx4 v28, s[20:23], s56 offen lds
ds_read_b64_tr_b16 a[240:241], v48 offset:24576
ds_read_b64_tr_b16 a[242:243], v48 offset:25600
ds_read_b64_tr_b16 a[244:245], v48 offset:26624
ds_read_b64_tr_b16 a[246:247], v48 offset:27648
ds_read_b64_tr_b16 a[248:249], v49 offset:24576
ds_read_b64_tr_b16 a[250:251], v49 offset:25600
ds_read_b64_tr_b16 a[252:253], v49 offset:26624
ds_read_b64_tr_b16 a[254:255], v49 offset:27648
s_waitcnt lgkmcnt(0)
s_waitcnt vmcnt(25)
s_barrier
s_add_u32 s56, s55, 512
s_mov_b32 m0, 40960
s_nop 0
buffer_load_dwordx4 v28, s[20:23], s56 offen lds
s_add_u32 s56, s55, 2816
s_mov_b32 m0, 41984
s_nop 0
buffer_load_dwordx4 v28, s[20:23], s56 offen lds
s_add_u32 s56, s55, 9728
s_mov_b32 m0, 43008
s_nop 0
buffer_load_dwordx4 v28, s[20:23], s56 offen lds
s_add_u32 s56, s55, 12032
s_mov_b32 m0, 44032
s_nop 0
buffer_load_dwordx4 v28, s[20:23], s56 offen lds
ds_read_b64_tr_b16 a[176:177], v48 offset:28672
ds_read_b64_tr_b16 a[178:179], v48 offset:29696
ds_read_b64_tr_b16 a[180:181], v48 offset:30720
ds_read_b64_tr_b16 a[182:183], v48 offset:31744
ds_read_b64_tr_b16 a[192:193], v49 offset:28672
ds_read_b64_tr_b16 a[194:195], v49 offset:29696
ds_read_b64_tr_b16 a[196:197], v49 offset:30720
ds_read_b64_tr_b16 a[198:199], v49 offset:31744
s_waitcnt lgkmcnt(0)
s_waitcnt vmcnt(24)
s_barrier
s_add_u32 s56, s55, 768
s_mov_b32 m0, 45056
s_nop 0
buffer_load_dwordx4 v28, s[20:23], s56 offen lds
s_add_u32 s56, s55, 3072
s_mov_b32 m0, 46080
s_nop 0
buffer_load_dwordx4 v28, s[20:23], s56 offen lds
s_add_u32 s56, s55, 9984
s_mov_b32 m0, 47104
s_nop 0
buffer_load_dwordx4 v28, s[20:23], s56 offen lds
s_add_u32 s56, s55, 12288
s_mov_b32 m0, 48128
s_nop 0
buffer_load_dwordx4 v28, s[20:23], s56 offen lds
ds_read_b64_tr_b16 v[60:61], v44 offset:0
ds_read_b64_tr_b16 v[62:63], v44 offset:1024
ds_read_b64_tr_b16 v[64:65], v46 offset:0
ds_read_b64_tr_b16 v[66:67], v46 offset:1024
ds_read_b64_tr_b16 v[68:69], v45 offset:0
ds_read_b64_tr_b16 v[70:71], v45 offset:1024
ds_read_b64_tr_b16 v[72:73], v47 offset:0
ds_read_b64_tr_b16 v[74:75], v47 offset:1024
s_waitcnt lgkmcnt(0)
s_waitcnt vmcnt(24)
s_barrier
ds_write_b128 v2, v[60:63] offset:0
ds_write_b128 v2, v[64:67] offset:1024
ds_write_b128 v2, v[68:71] offset:2048
ds_write_b128 v2, v[72:75] offset:3072
ds_read_b64_tr_b16 v[60:61], v44 offset:4096
ds_read_b64_tr_b16 v[62:63], v44 offset:5120
ds_read_b64_tr_b16 v[64:65], v46 offset:4096
ds_read_b64_tr_b16 v[66:67], v46 offset:5120
ds_read_b64_tr_b16 v[68:69], v45 offset:4096
ds_read_b64_tr_b16 v[70:71], v45 offset:5120
ds_read_b64_tr_b16 v[72:73], v47 offset:4096
ds_read_b64_tr_b16 v[74:75], v47 offset:5120
L_rdv_w0r:
v_readfirstlane_b32 s38, v32
s_nop 0
s_and_b32 s57, s38, 0xff
s_cmp_lg_u32 s57, 32
s_cbranch_scc1 L_rdv2_w0r
s_waitcnt lgkmcnt(0)
s_waitcnt vmcnt(20)
s_barrier
ds_write_b128 v2, v[60:63] offset:4096
ds_write_b128 v2, v[64:67] offset:5120
ds_write_b128 v2, v[68:71] offset:6144
ds_write_b128 v2, v[72:75] offset:7168
ds_read_b64_tr_b16 v[60:61], v44 offset:8192
ds_read_b64_tr_b16 v[62:63], v44 offset:9216
ds_read_b64_tr_b16 v[64:65], v46 offset:8192
ds_read_b64_tr_b16 v[66:67], v46 offset:9216
ds_read_b64_tr_b16 v[68:69], v45 offset:8192
ds_read_b64_tr_b16 v[70:71], v45 offset:9216
ds_read_b64_tr_b16 v[72:73], v47 offset:8192
ds_read_b64_tr_b16 v[74:75], v47 offset:9216
buffer_load_dwordx4 v[12:15], v9, s[4:7], s37 offen offset:0
buffer_load_dwordx4 v[16:19], v9, s[4:7], s37 offen offset:1024
buffer_load_dwordx4 v[52:55], v1, s[4:7], s37 offen offset:2048
buffer_load_dwordx4 v[56:59], v1, s[4:7], s37 offen offset:3072
s_mov_b32 m0, 1024
s_nop 0
buffer_load_dwordx4 v1, s[4:7], s47 offen offset:0 sc1 lds
buffer_load_dword v33, v1, s[4:7], s3 offen offset:0 sc1
buffer_load_dword v33, v1, s[4:7], s3 offen offset:1024 sc1
buffer_load_dword v33, v1, s[4:7], s3 offen offset:2048 sc1
buffer_load_dword v33, v1, s[4:7], s3 offen offset:3072 sc1
s_waitcnt lgkmcnt(0)
s_waitcnt vmcnt(25)
s_barrier
ds_write_b128 v2, v[60:63] offset:8192
ds_write_b128 v2, v[64:67] offset:9216
ds_write_b128 v2, v[68:71] offset:10240
ds_write_b128 v2, v[72:75] offset:11264
ds_read_b64_tr_b16 v[60:61], v44 offset:12288
ds_read_b64_tr_b16 v[62:63], v44 offset:13312
ds_read_b64_tr_b16 v[64:65], v46 offset:12288
ds_read_b64_tr_b16 v[66:67], v46 offset:13312
ds_read_b64_tr_b16 v[68:69], v45 offset:12288
ds_read_b64_tr_b16 v[70:71], v45 offset:13312
ds_read_b64_tr_b16 v[72:73], v47 offset:12288
ds_read_b64_tr_b16 v[74:75], v47 offset:13312
s_waitcnt lgkmcnt(0)
s_waitcnt vmcnt(21)
s_barrier
ds_write_b128 v2, v[60:63] offset:12288
ds_write_b128 v2, v[64:67] offset:13312
ds_write_b128 v2, v[68:71] offset:14336
ds_write_b128 v2, v[72:75] offset:15360
ds_read_b64_tr_b16 v[60:61], v44 offset:16384
ds_read_b64_tr_b16 v[62:63], v44 offset:17408
ds_read_b64_tr_b16 v[64:65], v46 offset:16384
ds_read_b64_tr_b16 v[66:67], v46 offset:17408
ds_read_b64_tr_b16 v[68:69], v45 offset:16384
ds_read_b64_tr_b16 v[70:71], v45 offset:17408
ds_read_b64_tr_b16 v[72:73], v47 offset:16384
ds_read_b64_tr_b16 v[74:75], v47 offset:17408
s_waitcnt lgkmcnt(0)
s_waitcnt vmcnt(17)
s_barrier
ds_write_b128 v2, v[60:63] offset:16384
ds_write_b128 v2, v[64:67] offset:17408
ds_write_b128 v2, v[68:71] offset:18432
ds_write_b128 v2, v[72:75] offset:19456
ds_read_b64_tr_b16 v[60:61], v48 offset:20480
ds_read_b64_tr_b16 v[62:63], v48 offset:21504
ds_read_b64_tr_b16 v[64:65], v48 offset:22528
ds_read_b64_tr_b16 v[66:67], v48 offset:23552
ds_read_b64_tr_b16 v[68:69], v49 offset:20480
ds_read_b64_tr_b16 v[70:71], v49 offset:21504
ds_read_b64_tr_b16 v[72:73], v49 offset:22528
ds_read_b64_tr_b16 v[74:75], v49 offset:23552
s_waitcnt lgkmcnt(0)
s_waitcnt vmcnt(13)
s_barrier
ds_write_b128 v2, v[60:63] offset:20480
ds_write_b128 v2, v[64:67] offset:21504
ds_write_b128 v2, v[68:71] offset:22528
ds_write_b128 v2, v[72:75] offset:23552
ds_read_b64_tr_b16 v[60:61], v48 offset:24576
ds_read_b64_tr_b16 v[62:63], v48 offset:25600
ds_read_b64_tr_b16 v[64:65], v48 offset:26624
ds_read_b64_tr_b16 v[66:67], v48 offset:27648
ds_read_b64_tr_b16 v[68:69], v49 offset:24576
ds_read_b64_tr_b16 v[70:71], v49 offset:25600
ds_read_b64_tr_b16 v[72:73], v49 offset:26624
ds_read_b64_tr_b16 v[74:75], v49 offset:27648
s_waitcnt lgkmcnt(0)
s_waitcnt vmcnt(9)
s_barrier
ds_write_b128 v2, v[60:63] offset:24576
ds_write_b128 v2, v[64:67] offset:25600
ds_write_b128 v2, v[68:71] offset:26624
ds_write_b128 v2, v[72:75] offset:27648
ds_read_b64_tr_b16 v[60:61], v48 offset:28672
ds_read_b64_tr_b16 v[62:63], v48 offset:29696
ds_read_b64_tr_b16 v[64:65], v48 offset:30720
ds_read_b64_tr_b16 v[66:67], v48 offset:31744
ds_read_b64_tr_b16 v[68:69], v49 offset:28672
ds_read_b64_tr_b16 v[70:71], v49 offset:29696
ds_read_b64_tr_b16 v[72:73], v49 offset:30720
ds_read_b64_tr_b16 v[74:75], v49 offset:31744
s_waitcnt lgkmcnt(0)
s_barrier
ds_write_b128 v2, v[60:63] offset:28672
ds_write_b128 v2, v[64:67] offset:29696
ds_write_b128 v2, v[68:71] offset:30720
ds_write_b128 v2, v[72:75] offset:31744
s_lshl_b32 s57, s58, 5
s_mov_b32 s0, 0x3f003f00
s_mov_b32 s1, 0x3f003f00
s_mov_b32 s58, 304128
s_cmp_eq_u32 s38, s57
s_mov_b32 s56, 0x33333333
s_mov_b32 s57, 0x33333333
s_mov_b32 s2, 0x21800000
s_mov_b32 s55, -24
s_cbranch_scc0 L_slow_w0r
v_mov_b64 v[20:21], 0
v_mov_b64 v[22:23], 0
v_mov_b64 v[24:25], 0
v_mov_b64 v[26:27], 0
v_mov_b64 v[28:29], 0
v_mov_b64 v[30:31], 0
v_mov_b64 v[32:33], 0
v_mov_b64 v[34:35], 0
v_mov_b64 v[36:37], 0
v_mov_b64 v[38:39], 0
v_mov_b64 v[40:41], 0
v_mov_b64 v[42:43], 0
ds_read_b128 v[44:47], v2 offset:0
ds_read_b128 v[48:51], v2 offset:1024
v_bfe_u32 v77, v1, 6, 1
v_lshl_add_u32 v77, v77, 3, v1
v_lshlrev_b32 v77, 1, v77
v_lshlrev_b32 v78, 3, v1
s_mov_b32 s38, 0
v_and_b32 v6, 0x70, v1
ds_write_b32 v6, v20 offset:512
s_waitcnt vmcnt(0) lgkmcnt(0)
s_branch L_top_w0rf
L_done_w0rf:
s_mul_i32 s40, s34, 10240
s_add_u32 s40, s40, 8093696
buffer_store_dword v11, v10, s[4:7], s40 offen sc0 sc1
s_waitcnt vmcnt(0) lgkmcnt(0)
s_endpgm
L_rdv2_w0r:
buffer_load_dword v32, v24, s[28:31], 0 offen sc0 sc1
s_sub_u32 s41, s41, 1
s_cbranch_scc1 L_exit
s_waitcnt vmcnt(0)
s_branch L_rdv_w0r
L_ra0_w0rf:
s_mov_b32 m0, 1024
s_nop 0
buffer_load_dwordx4 v1, s[4:7], s47 offen offset:0 sc1 lds
buffer_load_dwordx4 v1, s[4:7], s47 offen offset:1024 sc1 lds
buffer_load_dwordx4 v1, s[4:7], s47 offen offset:2048 sc1 lds
buffer_load_dwordx4 v1, s[4:7], s47 offen offset:3072 sc1 lds
s_sub_u32 s41, s41, 1
s_cbranch_scc1 L_exit
ds_read_b128 v[44:47], v2 offset:0
ds_read_b128 v[48:51], v2 offset:1024
v_mov_b64 v[20:21], 0
v_mov_b64 v[22:23], 0
v_mov_b64 v[24:25], 0
v_mov_b64 v[26:27], 0
v_mov_b64 v[28:29], 0
v_mov_b64 v[30:31], 0
v_mov_b64 v[32:33], 0
v_mov_b64 v[34:35], 0
v_mov_b64 v[36:37], 0
v_mov_b64 v[38:39], 0
v_mov_b64 v[40:41], 0
v_mov_b64 v[42:43], 0
s_waitcnt vmcnt(0)
ds_read_b128 v[60:63], v1 offset:1024
ds_read_b128 v[64:67], v1 offset:2048
ds_read_b128 v[68:71], v1 offset:3072
ds_read_b128 v[72:75], v1 offset:4096
s_branch L_s0_w0rf
L_ra1_w0rf:
L_ra2_w0rf:
s_waitcnt lgkmcnt(0)
s_barrier
s_mov_b32 m0, 5120
s_nop 0
buffer_load_dwordx4 v1, s[4:7], s48 offen offset:0 sc1 lds
s_mov_b32 m0, 9216
s_nop 0
buffer_load_dwordx4 v1, s[4:7], s49 offen offset:0 sc1 lds
s_sub_u32 s41, s41, 1
s_cbranch_scc1 L_exit
s_waitcnt vmcnt(0)
s_barrier
ds_read_b128 v[76:79], v1 offset:5120
ds_read_b128 v[60:63], v1 offset:6144
ds_read_b128 v[64:67], v1 offset:7168
ds_read_b128 v[68:71], v1 offset:8192
ds_read_b128 v[72:75], v1 offset:9216
s_waitcnt lgkmcnt(0)
v_bitop3_b32 v6, v76, v60, s35 bitop3:0x7e
v_bitop3_b32 v6, v6, v64, s35 bitop3:0xf6
v_bitop3_b32 v6, v6, v68, s35 bitop3:0xf6
v_bitop3_b32 v6, v6, v72, s35 bitop3:0xf6
v_and_b32 v6, 1, v6
v_cmp_ne_u32 vcc, 0, v6

s_cbranch_vccnz L_ra2_w0rf
s_branch L_a1_w0rf
L_mx_w0rf:
s_waitcnt lgkmcnt(0)
v_max3_f32 v30, v12, v13, v28
v_max_f32 v30, v30, v29
v_mov_b32 v31, v30
s_nop 1
v_permlane16_swap_b32 v30, v31
v_max_f32 v30, v30, v31
v_mov_b32 v31, v30
s_nop 1
v_permlane32_swap_b32 v30, v31
v_max_f32 v30, v30, v31
ds_write_b32 v1, v30 offset:10240
s_waitcnt lgkmcnt(0)
s_barrier
ds_read_b128 v[32:35], v1 offset:10240
s_waitcnt lgkmcnt(0)
v_max3_f32 v32, v32, v33, v34
v_max_f32 v32, v32, v35
v_sub_f32 v14, v12, v32
v_sub_f32 v15, v13, v32
v_sub_f32 v30, v28, v32
v_sub_f32 v31, v29, v32
v_exp_f32 v14, v14
v_exp_f32 v15, v15
v_exp_f32 v30, v30
v_exp_f32 v31, v31
v_cvt_pk_bf16_f32 v14, v14, v15
v_cvt_pk_bf16_f32 v30, v30, v31
ds_write_b32 v5, v14 offset:14368
v_cndmask_b32_e64 v26, 0, v30, s[56:57]
v_cndmask_b32_e64 v27, 0, v30, s[56:57]
v_mov_b64 v[76:77], s[52:53]
v_mov_b64 v[78:79], s[52:53]
v_mov_b32_dpp v24, v26 quad_perm:[2,3,0,1] row_mask:0xf bank_mask:0xf
v_mov_b32_dpp v25, v26 quad_perm:[2,3,0,1] row_mask:0xf bank_mask:0xf
s_waitcnt lgkmcnt(0)
s_barrier
v_mov_b64 v[14:15], s[0:1]
ds_read_b128 v[16:19], v1 offset:14368
ds_read_b128 v[36:39], v1 offset:14336
s_waitcnt lgkmcnt(0)
v_mfma_f32_16x16x32_bf16 v[32:35], v[76:79], v[16:19], 0
v_mfma_f32_16x16x32_bf16 v[20:23], v[52:55], v[16:19], 0
v_mfma_f32_16x16x32_bf16 v[20:23], v[56:59], v[36:39], v[20:23]
v_mfma_f32_16x16x16_bf16 v[32:35], v[14:15], v[26:27], v[32:35]
v_mfma_f32_16x16x32_bf16 v[20:23], v[40:43], v[24:27], v[20:23]
s_nop 3
v_rcp_f32 v33, v32
s_nop 2
v_mul_f32_dpp v20, v33, v20 quad_perm:[0,1,0,1] row_mask:0xf bank_mask:0xf
v_mul_f32_dpp v21, v33, v21 quad_perm:[0,1,0,1] row_mask:0xf bank_mask:0xf
v_mul_f32_dpp v22, v33, v22 quad_perm:[0,1,0,1] row_mask:0xf bank_mask:0xf
v_mul_f32_dpp v23, v33, v23 quad_perm:[0,1,0,1] row_mask:0xf bank_mask:0xf
v_cvt_pk_bf16_f32 v20, v20, v21
v_cvt_pk_bf16_f32 v21, v22, v23
ds_write_b64 v6, v[20:21] offset:5120
v_mov_b32_dpp v16, v20 quad_perm:[0,1,0,1] row_mask:0xf bank_mask:0xf
v_mov_b32_dpp v17, v21 quad_perm:[0,1,0,1] row_mask:0xf bank_mask:0xf
v_mov_b32_dpp v18, v20 quad_perm:[2,3,2,3] row_mask:0xf bank_mask:0xf
v_mov_b32_dpp v19, v21 quad_perm:[2,3,2,3] row_mask:0xf bank_mask:0xf
v_mov_b64 v[76:77], 0
v_mov_b64 v[78:79], 0
v_mov_b64 v[36:37], 0
v_mov_b64 v[38:39], 0
v_mov_b64 v[24:25], 0
v_mov_b64 v[26:27], 0
v_mov_b64 v[32:33], 0
v_mov_b64 v[34:35], 0
s_waitcnt lgkmcnt(0)
s_branch L_mxb_w0rf

L_rr_w0rf:
buffer_load_dwordx4 v[60:63], v9, s[4:7], s3 offen offset:0 sc1
buffer_load_dwordx4 v[64:67], v9, s[4:7], s3 offen offset:1024 sc1
buffer_load_dwordx4 v[68:71], v9, s[4:7], s3 offen offset:2048 sc1
buffer_load_dwordx4 v[72:75], v9, s[4:7], s3 offen offset:3072 sc1
s_mov_b32 s38, 1
s_sub_u32 s41, s41, 1
s_cbranch_scc1 L_exit
s_waitcnt vmcnt(0)
s_branch L_r_w0rf
L_slow_w0r:
v_mov_b64 v[20:21], 0
v_mov_b64 v[22:23], 0
v_mov_b64 v[24:25], 0
v_mov_b64 v[26:27], 0
v_mov_b64 v[28:29], 0
v_mov_b64 v[30:31], 0
v_mov_b64 v[32:33], 0
v_mov_b64 v[34:35], 0
v_mov_b64 v[36:37], 0
v_mov_b64 v[38:39], 0
v_mov_b64 v[40:41], 0
v_mov_b64 v[42:43], 0
ds_read_b128 v[44:47], v2 offset:0
ds_read_b128 v[48:51], v2 offset:1024
v_bfe_u32 v77, v1, 6, 1
v_lshl_add_u32 v77, v77, 3, v1
v_lshlrev_b32 v77, 1, v77
v_lshlrev_b32 v78, 3, v1
s_mov_b32 s38, 0
v_and_b32 v6, 0x70, v1
ds_write_b32 v6, v20 offset:512
s_waitcnt vmcnt(0) lgkmcnt(0)
s_branch L_top_w0rs
L_done_w0rs:
s_mul_i32 s40, s34, 10240
s_add_u32 s40, s40, 8093696
buffer_store_dword v11, v10, s[4:7], s40 offen sc0 sc1
s_waitcnt vmcnt(0) lgkmcnt(0)
s_endpgm
L_ra0_w0rs:
s_mov_b32 m0, 1024
s_nop 0
buffer_load_dwordx4 v1, s[4:7], s47 offen offset:0 sc0 sc1 lds
buffer_load_dwordx4 v1, s[4:7], s47 offen offset:1024 sc0 sc1 lds
buffer_load_dwordx4 v1, s[4:7], s47 offen offset:2048 sc0 sc1 lds
buffer_load_dwordx4 v1, s[4:7], s47 offen offset:3072 sc0 sc1 lds
s_sub_u32 s41, s41, 1
s_cbranch_scc1 L_exit
ds_read_b128 v[44:47], v2 offset:0
ds_read_b128 v[48:51], v2 offset:1024
v_mov_b64 v[20:21], 0
v_mov_b64 v[22:23], 0
v_mov_b64 v[24:25], 0
v_mov_b64 v[26:27], 0
v_mov_b64 v[28:29], 0
v_mov_b64 v[30:31], 0
v_mov_b64 v[32:33], 0
v_mov_b64 v[34:35], 0
v_mov_b64 v[36:37], 0
v_mov_b64 v[38:39], 0
v_mov_b64 v[40:41], 0
v_mov_b64 v[42:43], 0
s_waitcnt vmcnt(0)
ds_read_b128 v[60:63], v1 offset:1024
ds_read_b128 v[64:67], v1 offset:2048
ds_read_b128 v[68:71], v1 offset:3072
ds_read_b128 v[72:75], v1 offset:4096
s_branch L_s0_w0rs
L_ra1_w0rs:
L_ra2_w0rs:
s_waitcnt lgkmcnt(0)
s_barrier
s_mov_b32 m0, 5120
s_nop 0
buffer_load_dwordx4 v1, s[4:7], s48 offen offset:0 sc0 sc1 lds
s_mov_b32 m0, 9216
s_nop 0
buffer_load_dwordx4 v1, s[4:7], s49 offen offset:0 sc0 sc1 lds
s_sub_u32 s41, s41, 1
s_cbranch_scc1 L_exit
s_waitcnt vmcnt(0)
s_barrier
ds_read_b128 v[76:79], v1 offset:5120
ds_read_b128 v[60:63], v1 offset:6144
ds_read_b128 v[64:67], v1 offset:7168
ds_read_b128 v[68:71], v1 offset:8192
ds_read_b128 v[72:75], v1 offset:9216
s_waitcnt lgkmcnt(0)
v_bitop3_b32 v6, v76, v60, s35 bitop3:0x7e
v_bitop3_b32 v6, v6, v64, s35 bitop3:0xf6
v_bitop3_b32 v6, v6, v68, s35 bitop3:0xf6
v_bitop3_b32 v6, v6, v72, s35 bitop3:0xf6
v_and_b32 v6, 1, v6
v_cmp_ne_u32 vcc, 0, v6

s_cbranch_vccnz L_ra2_w0rs
s_branch L_a1_w0rs
L_mx_w0rs:
s_waitcnt lgkmcnt(0)
v_max3_f32 v30, v12, v13, v28
v_max_f32 v30, v30, v29
v_mov_b32 v31, v30
s_nop 1
v_permlane16_swap_b32 v30, v31
v_max_f32 v30, v30, v31
v_mov_b32 v31, v30
s_nop 1
v_permlane32_swap_b32 v30, v31
v_max_f32 v30, v30, v31
ds_write_b32 v1, v30 offset:10240
s_waitcnt lgkmcnt(0)
s_barrier
ds_read_b128 v[32:35], v1 offset:10240
s_waitcnt lgkmcnt(0)
v_max3_f32 v32, v32, v33, v34
v_max_f32 v32, v32, v35
v_sub_f32 v14, v12, v32
v_sub_f32 v15, v13, v32
v_sub_f32 v30, v28, v32
v_sub_f32 v31, v29, v32
v_exp_f32 v14, v14
v_exp_f32 v15, v15
v_exp_f32 v30, v30
v_exp_f32 v31, v31
v_cvt_pk_bf16_f32 v14, v14, v15
v_cvt_pk_bf16_f32 v30, v30, v31
ds_write_b32 v5, v14 offset:14368
v_cndmask_b32_e64 v26, 0, v30, s[56:57]
v_cndmask_b32_e64 v27, 0, v30, s[56:57]
v_mov_b64 v[76:77], s[52:53]
v_mov_b64 v[78:79], s[52:53]
v_mov_b32_dpp v24, v26 quad_perm:[2,3,0,1] row_mask:0xf bank_mask:0xf
v_mov_b32_dpp v25, v26 quad_perm:[2,3,0,1] row_mask:0xf bank_mask:0xf
s_waitcnt lgkmcnt(0)
s_barrier
v_mov_b64 v[14:15], s[0:1]
ds_read_b128 v[16:19], v1 offset:14368
ds_read_b128 v[36:39], v1 offset:14336
s_waitcnt lgkmcnt(0)
v_mfma_f32_16x16x32_bf16 v[32:35], v[76:79], v[16:19], 0
v_mfma_f32_16x16x32_bf16 v[20:23], v[52:55], v[16:19], 0
v_mfma_f32_16x16x32_bf16 v[20:23], v[56:59], v[36:39], v[20:23]
v_mfma_f32_16x16x16_bf16 v[32:35], v[14:15], v[26:27], v[32:35]
v_mfma_f32_16x16x32_bf16 v[20:23], v[40:43], v[24:27], v[20:23]
s_nop 3
v_rcp_f32 v33, v32
s_nop 2
v_mul_f32_dpp v20, v33, v20 quad_perm:[0,1,0,1] row_mask:0xf bank_mask:0xf
v_mul_f32_dpp v21, v33, v21 quad_perm:[0,1,0,1] row_mask:0xf bank_mask:0xf
v_mul_f32_dpp v22, v33, v22 quad_perm:[0,1,0,1] row_mask:0xf bank_mask:0xf
v_mul_f32_dpp v23, v33, v23 quad_perm:[0,1,0,1] row_mask:0xf bank_mask:0xf
v_cvt_pk_bf16_f32 v20, v20, v21
v_cvt_pk_bf16_f32 v21, v22, v23
ds_write_b64 v6, v[20:21] offset:5120
v_mov_b32_dpp v16, v20 quad_perm:[0,1,0,1] row_mask:0xf bank_mask:0xf
v_mov_b32_dpp v17, v21 quad_perm:[0,1,0,1] row_mask:0xf bank_mask:0xf
v_mov_b32_dpp v18, v20 quad_perm:[2,3,2,3] row_mask:0xf bank_mask:0xf
v_mov_b32_dpp v19, v21 quad_perm:[2,3,2,3] row_mask:0xf bank_mask:0xf
v_mov_b64 v[76:77], 0
v_mov_b64 v[78:79], 0
v_mov_b64 v[36:37], 0
v_mov_b64 v[38:39], 0
v_mov_b64 v[24:25], 0
v_mov_b64 v[26:27], 0
v_mov_b64 v[32:33], 0
v_mov_b64 v[34:35], 0
s_waitcnt lgkmcnt(0)
s_branch L_mxb_w0rs

L_rr_w0rs:
buffer_load_dwordx4 v[60:63], v9, s[4:7], s3 offen offset:0 sc0 sc1
buffer_load_dwordx4 v[64:67], v9, s[4:7], s3 offen offset:1024 sc0 sc1
buffer_load_dwordx4 v[68:71], v9, s[4:7], s3 offen offset:2048 sc0 sc1
buffer_load_dwordx4 v[72:75], v9, s[4:7], s3 offen offset:3072 sc0 sc1
s_mov_b32 s38, 1
s_sub_u32 s41, s41, 1
s_cbranch_scc1 L_exit
s_waitcnt vmcnt(0)
s_branch L_r_w0rs
L_pro_w1r:
v_and_b32 v20, 63, v0
v_lshlrev_b32 v1, 4, v20
v_add_u32 v2, 57344, v1
v_and_b32 v23, 1, v22
v_lshl_add_u32 v23, v24, 4, v23
v_mul_u32_u24 v23, 1152, v23
v_lshlrev_b32 v28, 2, v22
v_xor_b32 v28, v28, v21
v_lshl_add_u32 v28, v28, 4, v23
s_mul_i32 s55, s32, 147456
s_waitcnt lgkmcnt(0)
v_and_b32 v23, 1, v22
v_lshrrev_b32 v24, 2, v21
v_lshl_add_u32 v23, v23, 2, v24
v_lshlrev_b32 v23, 1, v23
v_bfe_u32 v44, v21, 1, 1
v_add_u32 v44, 4, v44
v_xor_b32 v44, v44, v23
v_lshlrev_b32 v44, 4, v44
v_lshl_add_u32 v44, v24, 8, v44
v_and_b32 v23, 1, v22
v_lshl_add_u32 v44, v23, 11, v44
v_and_b32 v23, 1, v21
v_lshl_add_u32 v44, v23, 3, v44
v_lshrrev_b32 v23, 1, v22
v_mul_u32_u24 v23, 40960, v23
v_add_u32 v23, 16384, v23
v_add_u32 v44, v44, v23
v_and_b32 v23, 1, v22
v_lshrrev_b32 v24, 2, v21
v_lshl_add_u32 v23, v23, 2, v24
v_lshlrev_b32 v23, 1, v23
v_bfe_u32 v45, v21, 1, 1
v_add_u32 v45, 6, v45
v_xor_b32 v45, v45, v23
v_lshlrev_b32 v45, 4, v45
v_lshl_add_u32 v45, v24, 8, v45
v_and_b32 v23, 1, v22
v_lshl_add_u32 v45, v23, 11, v45
v_and_b32 v23, 1, v21
v_lshl_add_u32 v45, v23, 3, v45
v_lshrrev_b32 v23, 1, v22
v_mul_u32_u24 v23, 40960, v23
v_add_u32 v23, 16384, v23
v_add_u32 v45, v45, v23
v_and_b32 v23, 1, v22
v_lshrrev_b32 v24, 2, v21
v_lshl_add_u32 v23, v23, 2, v24
v_lshlrev_b32 v23, 1, v23
v_bfe_u32 v46, v21, 1, 1
v_add_u32 v46, 4, v46
v_xor_b32 v46, v46, v23
v_lshlrev_b32 v46, 4, v46
v_lshl_add_u32 v46, v24, 8, v46
v_and_b32 v23, 1, v22
v_lshl_add_u32 v46, v23, 11, v46
v_and_b32 v23, 1, v21
v_lshl_add_u32 v46, v23, 3, v46
v_lshrrev_b32 v23, 1, v22
v_mul_u32_u24 v23, 32768, v23
v_add_u32 v23, 98304, v23
v_add_u32 v46, v46, v23
v_and_b32 v23, 1, v22
v_lshrrev_b32 v24, 2, v21
v_lshl_add_u32 v23, v23, 2, v24
v_lshlrev_b32 v23, 1, v23
v_bfe_u32 v47, v21, 1, 1
v_add_u32 v47, 6, v47
v_xor_b32 v47, v47, v23
v_lshlrev_b32 v47, 4, v47
v_lshl_add_u32 v47, v24, 8, v47
v_and_b32 v23, 1, v22
v_lshl_add_u32 v47, v23, 11, v47
v_and_b32 v23, 1, v21
v_lshl_add_u32 v47, v23, 3, v47
v_lshrrev_b32 v23, 1, v22
v_mul_u32_u24 v23, 32768, v23
v_add_u32 v23, 98304, v23
v_add_u32 v47, v47, v23
v_and_b32 v23, 1, v22
v_bfe_u32 v24, v21, 2, 1
v_lshl_add_u32 v23, v23, 1, v24
v_xor_b32 v24, 1, v23
v_lshlrev_b32 v24, 6, v24
v_lshl_add_u32 v48, v23, 8, v24
v_and_b32 v23, 3, v21
v_lshl_add_u32 v48, v23, 4, v48
v_and_b32 v23, 8, v21
v_add_u32 v48, v48, v23
v_lshrrev_b32 v23, 1, v22
v_mul_u32_u24 v23, 40960, v23
v_add_u32 v23, 16384, v23
v_add_u32 v48, v48, v23
v_and_b32 v23, 1, v22
v_bfe_u32 v24, v21, 2, 1
v_lshl_add_u32 v23, v23, 1, v24
v_xor_b32 v24, 1, v23
v_lshlrev_b32 v24, 6, v24
v_lshl_add_u32 v49, v23, 8, v24
v_and_b32 v23, 3, v21
v_lshl_add_u32 v49, v23, 4, v49
v_and_b32 v23, 8, v21
v_add_u32 v49, v49, v23
v_lshrrev_b32 v23, 1, v22
v_mul_u32_u24 v23, 32768, v23
v_add_u32 v23, 98304, v23
v_add_u32 v49, v49, v23
v_bfe_u32 v23, v21, 1, 1
v_mul_u32_u24 v23, 0xaaaa, v23
v_add_u32 v0, 0x4444, v23
v_lshlrev_b32 v3, 3, v20
v_lshrrev_b32 v25, 5, v20
v_lshlrev_b32 v25, 6, v25
v_xor_b32 v3, v3, v25
v_lshrrev_b32 v25, 2, v20
v_and_b32 v4, 3, v21
v_lshl_add_u32 v4, v4, 4, v25
v_lshlrev_b32 v4, 3, v4
v_bfe_u32 v25, v21, 1, 1
v_lshlrev_b32 v23, 6, v25
v_xor_b32 v4, v4, v23
v_lshlrev_b32 v5, 4, v21
v_lshl_add_u32 v5, v22, 2, v5
v_mul_u32_u24 v23, 768, v25
v_add_u32 v5, v5, v23
v_lshlrev_b32 v9, 8, v22
v_lshl_add_u32 v9, v25, 6, v9
v_bfe_u32 v23, v21, 3, 1
v_lshl_add_u32 v9, v23, 7, v9
v_bfe_u32 v23, v21, 2, 1
v_lshl_add_u32 v9, v23, 5, v9
v_and_b32 v23, 1, v21
v_lshl_add_u32 v9, v23, 4, v9
v_lshrrev_b32 v23, 1, v22
v_and_b32 v24, 1, v22
v_and_b32 v25, 7, v21
v_lshrrev_b32 v7, 3, v21
v_lshl_add_u32 v8, v7, 1, v23
v_lshlrev_b32 v8, 12, v8
v_lshl_add_u32 v8, v24, 7, v8
v_and_b32 v25, 4, v21
v_lshl_add_u32 v8, v25, 3, v8
v_and_b32 v25, 1, v21
v_lshl_add_u32 v8, v25, 4, v8
v_bfe_u32 v25, v21, 1, 1
v_lshl_add_u32 v8, v25, 3, v8
s_lshr_b32 s56, s32, 1
s_lshl_b32 s56, s56, 8
s_and_b32 s57, s32, 1
s_lshl_b32 s57, s57, 6
s_add_u32 s56, s56, s57
s_add_u32 s56, s56, 16384
v_add_u32 v8, s56, v8
v_and_b32 v7, 0x3d0, v1
s_mov_b32 s42, 0
s_mov_b32 s43, 65536
s_mov_b32 s44, 131072
s_mov_b32 s45, 196608
s_mov_b32 s46, 262144
s_mov_b32 s47, 294912
s_mov_b32 s48, 299008
s_mov_b32 s49, 303104
s_mov_b32 s50, 0x3e0293ee
s_mov_b32 s51, 0x3e0293ee
s_mov_b32 s52, 0x3f803f80
s_mov_b32 s53, 0x3f803f80
v_lshlrev_b32 v11, 2, v21
s_mov_b32 s34, 0
s_mov_b32 s35, -1
s_mov_b32 s36, 0
s_mov_b32 s41, 300000
s_lshl_b32 s37, s32, 14
s_add_u32 s39, s37, 17309696
s_add_u32 s37, s37, 16781312
s_mov_b32 s40, 8749056
v_mov_b64 v[36:37], 0
v_mov_b64 v[38:39], 0
ds_write_b128 v1, v[36:39] offset:15360
s_lshl_b32 s56, s32, 1
s_add_u32 s56, s56, 0
s_cmp_eq_u32 s56, 0
s_cselect_b32 s56, 64, s56
s_mul_i32 s56, s56, 10240
s_add_u32 s56, s56, 8392704
s_add_u32 s57, s56, 4096
v_mov_b32 v40, 0
v_mov_b32 v41, 0
v_mov_b32 v42, 0
v_mov_b32 v43, 0
buffer_store_dwordx4 v[40:43], v1, s[4:7], s56 offen offset:0 sc0 sc1
buffer_store_dwordx4 v[40:43], v1, s[4:7], s56 offen offset:1024 sc0 sc1
buffer_store_dwordx4 v[40:43], v1, s[4:7], s56 offen offset:2048 sc0 sc1
buffer_store_dwordx4 v[40:43], v1, s[4:7], s56 offen offset:3072 sc0 sc1
buffer_store_dwordx4 v[40:43], v1, s[4:7], s57 offen offset:0 sc0 sc1
s_add_u32 s56, s32, 32
s_lshl_b32 s3, s56, 12
v_and_b32 v23, 1, v21
v_bfe_u32 v24, v21, 2, 1
v_bfe_u32 v25, v21, 1, 1
s_lshl_b32 s57, s56, 7
s_add_u32 s57, s57, 294912
v_and_b32 v10, 7, v21
v_lshlrev_b32 v10, 2, v10
v_lshl_add_u32 v10, v22, 5, v10
v_add_u32 v10, s57, v10
s_lshl_b32 s33, s56, 2
s_add_u32 s33, s33, 304128
v_mov_b32 v30, -1
s_mov_b64 exec, 1
buffer_store_dword v30, v1, s[4:7], s33 offen sc0 sc1
s_mov_b64 exec, -1
v_lshl_add_u32 v23, v23, 1, v24
v_lshlrev_b32 v25, 4, v25
v_mov_b32 v24, 0x3f80
v_lshlrev_b32 v24, v25, v24
v_cmp_eq_u32 vcc, 0, v23
s_nop 1
v_cndmask_b32 v76, 0, v24, vcc
v_cmp_eq_u32 vcc, 1, v23
s_nop 1
v_cndmask_b32 v77, 0, v24, vcc
v_cmp_eq_u32 vcc, 2, v23
s_nop 1
v_cndmask_b32 v78, 0, v24, vcc
v_cmp_eq_u32 vcc, 3, v23
s_nop 1
v_cndmask_b32 v79, 0, v24, vcc
buffer_store_dwordx4 v[36:39], v9, s[4:7], s3 offen offset:0 sc0 sc1
buffer_store_dwordx4 v[36:39], v9, s[4:7], s3 offen offset:1024 sc0 sc1
buffer_store_dwordx4 v[36:39], v9, s[4:7], s3 offen offset:2048 sc0 sc1
buffer_store_dwordx4 v[36:39], v9, s[4:7], s3 offen offset:3072 sc0 sc1
s_getreg_b32 s56, hwreg(HW_REG_XCC_ID)
s_and_b32 s56, s56, 15
s_mul_i32 s57, s56, s56
s_lshl_b32 s57, s57, 18
s_lshl_b32 s56, s56, 8
s_add_u32 s57, s57, s56
s_add_u32 s58, s57, 1
s_lshl_b32 s101, s32, 7
s_add_u32 s101, s101, 327680
v_mov_b32 v24, 0
s_add_u32 s56, s54, 131072
s_mov_b32 m0, 69632
s_nop 0
buffer_load_dwordx4 v26, s[12:15], s56 offen lds
s_add_u32 s56, s54, 147456
s_mov_b32 m0, 70656
s_nop 0
buffer_load_dwordx4 v26, s[12:15], s56 offen lds
s_add_u32 s56, s54, 163840
s_mov_b32 m0, 71680
s_nop 0
buffer_load_dwordx4 v27, s[12:15], s56 offen lds
s_add_u32 s56, s54, 180224
s_mov_b32 m0, 72704
s_nop 0
buffer_load_dwordx4 v27, s[12:15], s56 offen lds
s_add_u32 s56, s54, 655360
s_mov_b32 m0, 73728
s_nop 0
buffer_load_dwordx4 v26, s[12:15], s56 offen lds
s_add_u32 s56, s54, 671744
s_mov_b32 m0, 74752
s_nop 0
buffer_load_dwordx4 v26, s[12:15], s56 offen lds
s_add_u32 s56, s54, 688128
s_mov_b32 m0, 75776
s_nop 0
buffer_load_dwordx4 v27, s[12:15], s56 offen lds
s_add_u32 s56, s54, 704512
s_mov_b32 m0, 76800
s_nop 0
buffer_load_dwordx4 v27, s[12:15], s56 offen lds
v_and_b32 v23, 3, v20
v_lshrrev_b32 v24, 2, v20
v_mul_u32_u24 v29, 1152, v24
v_lshl_add_u32 v29, v23, 4, v29
v_lshrrev_b32 v24, 2, v21
v_and_b32 v25, 1, v22
v_lshlrev_b32 v31, 10, v25
v_lshrrev_b32 v25, 1, v22
v_lshl_add_u32 v31, v25, 8, v31
v_and_b32 v25, 1, v24
v_lshl_add_u32 v31, v25, 6, v31
v_lshrrev_b32 v25, 1, v24
v_lshl_add_u32 v31, v25, 3, v31
v_lshl_add_u32 v31, v23, 4, v31
v_add_u32 v31, 57344, v31
s_add_u32 s56, s55, 1088
s_mov_b32 m0, 90112
s_nop 0
buffer_load_dwordx4 v29, s[20:23], s56 offen lds
s_add_u32 s56, s55, 19520
s_mov_b32 m0, 91136
s_nop 0
buffer_load_dwordx4 v29, s[20:23], s56 offen lds
s_add_u32 s56, s55, 37952
s_mov_b32 m0, 92160
s_nop 0
buffer_load_dwordx4 v29, s[20:23], s56 offen lds
s_add_u32 s56, s55, 56384
s_mov_b32 m0, 93184
s_nop 0
buffer_load_dwordx4 v29, s[20:23], s56 offen lds
s_add_u32 s56, s55, 74816
s_mov_b32 m0, 94208
s_nop 0
buffer_load_dwordx4 v29, s[20:23], s56 offen lds
s_add_u32 s56, s55, 93248
s_mov_b32 m0, 95232
s_nop 0
buffer_load_dwordx4 v29, s[20:23], s56 offen lds
s_add_u32 s56, s55, 111680
s_mov_b32 m0, 96256
s_nop 0
buffer_load_dwordx4 v29, s[20:23], s56 offen lds
s_add_u32 s56, s55, 130112
s_mov_b32 m0, 97280
s_nop 0
buffer_load_dwordx4 v29, s[20:23], s56 offen lds
v_mov_b32 v24, 0
s_waitcnt vmcnt(46)
s_barrier
ds_read_b64_tr_b16 v[80:81], v44 offset:20480
ds_read_b64_tr_b16 v[82:83], v44 offset:21504
ds_read_b64_tr_b16 v[84:85], v46 offset:20480
ds_read_b64_tr_b16 v[86:87], v46 offset:21504
ds_read_b64_tr_b16 v[88:89], v45 offset:20480
ds_read_b64_tr_b16 v[90:91], v45 offset:21504
ds_read_b64_tr_b16 v[92:93], v47 offset:20480
ds_read_b64_tr_b16 v[94:95], v47 offset:21504
s_waitcnt lgkmcnt(0)
s_waitcnt vmcnt(42)
s_barrier
s_add_u32 s56, s54, 1179648
s_mov_b32 m0, 77824
s_nop 0
buffer_load_dwordx4 v26, s[12:15], s56 offen lds
s_add_u32 s56, s54, 1196032
s_mov_b32 m0, 78848
s_nop 0
buffer_load_dwordx4 v26, s[12:15], s56 offen lds
s_add_u32 s56, s54, 1212416
s_mov_b32 m0, 79872
s_nop 0
buffer_load_dwordx4 v27, s[12:15], s56 offen lds
s_add_u32 s56, s54, 1228800
s_mov_b32 m0, 80896
s_nop 0
buffer_load_dwordx4 v27, s[12:15], s56 offen lds
ds_read_b64_tr_b16 v[96:97], v44 offset:24576
ds_read_b64_tr_b16 v[98:99], v44 offset:25600
ds_read_b64_tr_b16 v[100:101], v46 offset:24576
ds_read_b64_tr_b16 v[102:103], v46 offset:25600
ds_read_b64_tr_b16 v[104:105], v45 offset:24576
ds_read_b64_tr_b16 v[106:107], v45 offset:25600
ds_read_b64_tr_b16 v[108:109], v47 offset:24576
ds_read_b64_tr_b16 v[110:111], v47 offset:25600
s_waitcnt lgkmcnt(0)
s_waitcnt vmcnt(42)
s_barrier
s_add_u32 s56, s54, 1703936
s_mov_b32 m0, 81920
s_nop 0
buffer_load_dwordx4 v26, s[12:15], s56 offen lds
s_add_u32 s56, s54, 1720320
s_mov_b32 m0, 82944
s_nop 0
buffer_load_dwordx4 v26, s[12:15], s56 offen lds
s_add_u32 s56, s54, 1736704
s_mov_b32 m0, 83968
s_nop 0
buffer_load_dwordx4 v27, s[12:15], s56 offen lds
s_add_u32 s56, s54, 1753088
s_mov_b32 m0, 84992
s_nop 0
buffer_load_dwordx4 v27, s[12:15], s56 offen lds
ds_read_b64_tr_b16 v[112:113], v44 offset:28672
ds_read_b64_tr_b16 v[114:115], v44 offset:29696
ds_read_b64_tr_b16 v[116:117], v46 offset:28672
ds_read_b64_tr_b16 v[118:119], v46 offset:29696
ds_read_b64_tr_b16 v[120:121], v45 offset:28672
ds_read_b64_tr_b16 v[122:123], v45 offset:29696
ds_read_b64_tr_b16 v[124:125], v47 offset:28672
ds_read_b64_tr_b16 v[126:127], v47 offset:29696
s_waitcnt lgkmcnt(0)
s_waitcnt vmcnt(42)
s_barrier
s_add_u32 s56, s54, 2228224
s_mov_b32 m0, 86016
s_nop 0
buffer_load_dwordx4 v26, s[12:15], s56 offen lds
s_add_u32 s56, s54, 2244608
s_mov_b32 m0, 87040
s_nop 0
buffer_load_dwordx4 v26, s[12:15], s56 offen lds
s_add_u32 s56, s54, 2260992
s_mov_b32 m0, 88064
s_nop 0
buffer_load_dwordx4 v27, s[12:15], s56 offen lds
s_add_u32 s56, s54, 2277376
s_mov_b32 m0, 89088
s_nop 0
buffer_load_dwordx4 v27, s[12:15], s56 offen lds
ds_read_b64_tr_b16 v[128:129], v44 offset:0
ds_read_b64_tr_b16 v[130:131], v44 offset:1024
ds_read_b64_tr_b16 v[132:133], v46 offset:0
ds_read_b64_tr_b16 v[134:135], v46 offset:1024
ds_read_b64_tr_b16 v[136:137], v45 offset:0
ds_read_b64_tr_b16 v[138:139], v45 offset:1024
ds_read_b64_tr_b16 v[140:141], v47 offset:0
ds_read_b64_tr_b16 v[142:143], v47 offset:1024
s_waitcnt lgkmcnt(0)
s_waitcnt vmcnt(42)
s_barrier
s_add_u32 s56, s54, 3276800
s_mov_b32 m0, 57344
s_nop 0
buffer_load_dwordx4 v26, s[12:15], s56 offen lds
s_add_u32 s56, s54, 3293184
s_mov_b32 m0, 58368
s_nop 0
buffer_load_dwordx4 v26, s[12:15], s56 offen lds
s_add_u32 s56, s54, 3309568
s_mov_b32 m0, 59392
s_nop 0
buffer_load_dwordx4 v27, s[12:15], s56 offen lds
s_add_u32 s56, s54, 3325952
s_mov_b32 m0, 60416
s_nop 0
buffer_load_dwordx4 v27, s[12:15], s56 offen lds
ds_read_b64_tr_b16 v[144:145], v44 offset:4096
ds_read_b64_tr_b16 v[146:147], v44 offset:5120
ds_read_b64_tr_b16 v[148:149], v46 offset:4096
ds_read_b64_tr_b16 v[150:151], v46 offset:5120
ds_read_b64_tr_b16 v[152:153], v45 offset:4096
ds_read_b64_tr_b16 v[154:155], v45 offset:5120
ds_read_b64_tr_b16 v[156:157], v47 offset:4096
ds_read_b64_tr_b16 v[158:159], v47 offset:5120
s_waitcnt lgkmcnt(0)
s_waitcnt vmcnt(42)
s_barrier
s_add_u32 s56, s54, 3801088
s_mov_b32 m0, 61440
s_nop 0
buffer_load_dwordx4 v26, s[12:15], s56 offen lds
s_add_u32 s56, s54, 3817472
s_mov_b32 m0, 62464
s_nop 0
buffer_load_dwordx4 v26, s[12:15], s56 offen lds
s_add_u32 s56, s54, 3833856
s_mov_b32 m0, 63488
s_nop 0
buffer_load_dwordx4 v27, s[12:15], s56 offen lds
s_add_u32 s56, s54, 3850240
s_mov_b32 m0, 64512
s_nop 0
buffer_load_dwordx4 v27, s[12:15], s56 offen lds
ds_read_b64_tr_b16 v[160:161], v44 offset:8192
ds_read_b64_tr_b16 v[162:163], v44 offset:9216
ds_read_b64_tr_b16 v[164:165], v46 offset:8192
ds_read_b64_tr_b16 v[166:167], v46 offset:9216
ds_read_b64_tr_b16 v[168:169], v45 offset:8192
ds_read_b64_tr_b16 v[170:171], v45 offset:9216
ds_read_b64_tr_b16 v[172:173], v47 offset:8192
ds_read_b64_tr_b16 v[174:175], v47 offset:9216
s_waitcnt lgkmcnt(0)
s_waitcnt vmcnt(32)
s_barrier
s_add_u32 s56, s54, 4325376
s_mov_b32 m0, 65536
s_nop 0
buffer_load_dwordx4 v26, s[12:15], s56 offen lds
s_add_u32 s56, s54, 4341760
s_mov_b32 m0, 66560
s_nop 0
buffer_load_dwordx4 v26, s[12:15], s56 offen lds
s_add_u32 s56, s54, 4358144
s_mov_b32 m0, 67584
s_nop 0
buffer_load_dwordx4 v27, s[12:15], s56 offen lds
s_add_u32 s56, s54, 4374528
s_mov_b32 m0, 68608
s_nop 0
buffer_load_dwordx4 v27, s[12:15], s56 offen lds
ds_read_b64_tr_b16 v[176:177], v44 offset:12288
ds_read_b64_tr_b16 v[178:179], v44 offset:13312
ds_read_b64_tr_b16 v[180:181], v46 offset:12288
ds_read_b64_tr_b16 v[182:183], v46 offset:13312
ds_read_b64_tr_b16 v[184:185], v45 offset:12288
ds_read_b64_tr_b16 v[186:187], v45 offset:13312
ds_read_b64_tr_b16 v[188:189], v47 offset:12288
ds_read_b64_tr_b16 v[190:191], v47 offset:13312
s_waitcnt lgkmcnt(0)
s_waitcnt vmcnt(32)
s_barrier
s_add_u32 s56, s54, 131072
s_mov_b32 m0, 69632
s_nop 0
buffer_load_dwordx4 v26, s[16:19], s56 offen lds
s_add_u32 s56, s54, 147456
s_mov_b32 m0, 70656
s_nop 0
buffer_load_dwordx4 v26, s[16:19], s56 offen lds
s_add_u32 s56, s54, 163840
s_mov_b32 m0, 71680
s_nop 0
buffer_load_dwordx4 v27, s[16:19], s56 offen lds
s_add_u32 s56, s54, 180224
s_mov_b32 m0, 72704
s_nop 0
buffer_load_dwordx4 v27, s[16:19], s56 offen lds
ds_read_b64_tr_b16 v[192:193], v44 offset:16384
ds_read_b64_tr_b16 v[194:195], v44 offset:17408
ds_read_b64_tr_b16 v[196:197], v46 offset:16384
ds_read_b64_tr_b16 v[198:199], v46 offset:17408
ds_read_b64_tr_b16 v[200:201], v45 offset:16384
ds_read_b64_tr_b16 v[202:203], v45 offset:17408
ds_read_b64_tr_b16 v[204:205], v47 offset:16384
ds_read_b64_tr_b16 v[206:207], v47 offset:17408
s_waitcnt lgkmcnt(0)
s_waitcnt vmcnt(24)
s_barrier
s_add_u32 s56, s54, 655360
s_mov_b32 m0, 73728
s_nop 0
buffer_load_dwordx4 v26, s[16:19], s56 offen lds
s_add_u32 s56, s54, 671744
s_mov_b32 m0, 74752
s_nop 0
buffer_load_dwordx4 v26, s[16:19], s56 offen lds
s_add_u32 s56, s54, 688128
s_mov_b32 m0, 75776
s_nop 0
buffer_load_dwordx4 v27, s[16:19], s56 offen lds
s_add_u32 s56, s54, 704512
s_mov_b32 m0, 76800
s_nop 0
buffer_load_dwordx4 v27, s[16:19], s56 offen lds
ds_read_b64_tr_b16 v[208:209], v44 offset:20480
ds_read_b64_tr_b16 v[210:211], v44 offset:21504
ds_read_b64_tr_b16 v[212:213], v46 offset:20480
ds_read_b64_tr_b16 v[214:215], v46 offset:21504
ds_read_b64_tr_b16 v[216:217], v45 offset:20480
ds_read_b64_tr_b16 v[218:219], v45 offset:21504
ds_read_b64_tr_b16 v[220:221], v47 offset:20480
ds_read_b64_tr_b16 v[222:223], v47 offset:21504
s_waitcnt lgkmcnt(0)
s_waitcnt vmcnt(24)
s_barrier
s_add_u32 s56, s54, 1179648
s_mov_b32 m0, 77824
s_nop 0
buffer_load_dwordx4 v26, s[16:19], s56 offen lds
s_add_u32 s56, s54, 1196032
s_mov_b32 m0, 78848
s_nop 0
buffer_load_dwordx4 v26, s[16:19], s56 offen lds
s_add_u32 s56, s54, 1212416
s_mov_b32 m0, 79872
s_nop 0
buffer_load_dwordx4 v27, s[16:19], s56 offen lds
s_add_u32 s56, s54, 1228800
s_mov_b32 m0, 80896
s_nop 0
buffer_load_dwordx4 v27, s[16:19], s56 offen lds
ds_read_b64_tr_b16 v[224:225], v44 offset:24576
ds_read_b64_tr_b16 v[226:227], v44 offset:25600
ds_read_b64_tr_b16 v[228:229], v46 offset:24576
ds_read_b64_tr_b16 v[230:231], v46 offset:25600
ds_read_b64_tr_b16 v[232:233], v45 offset:24576
ds_read_b64_tr_b16 v[234:235], v45 offset:25600
ds_read_b64_tr_b16 v[236:237], v47 offset:24576
ds_read_b64_tr_b16 v[238:239], v47 offset:25600
ds_read_b64_tr_b16 v[60:61], v31 offset:32768
ds_read_b64_tr_b16 v[62:63], v31 offset:32896
ds_read_b64_tr_b16 v[64:65], v31 offset:33280
ds_read_b64_tr_b16 v[66:67], v31 offset:33408
ds_read_b64_tr_b16 v[68:69], v31 offset:34816
ds_read_b64_tr_b16 v[70:71], v31 offset:34944
ds_read_b64_tr_b16 v[72:73], v31 offset:35328
ds_read_b64_tr_b16 v[74:75], v31 offset:35456
s_waitcnt lgkmcnt(0)
ds_write_b128 v2, v[60:63] offset:32768
ds_write_b128 v2, v[64:67] offset:33792
ds_write_b128 v2, v[68:71] offset:34816
ds_write_b128 v2, v[72:75] offset:35840
s_waitcnt lgkmcnt(0)
s_waitcnt vmcnt(24)
s_barrier
s_add_u32 s56, s54, 1703936
s_mov_b32 m0, 81920
s_nop 0
buffer_load_dwordx4 v26, s[16:19], s56 offen lds
s_add_u32 s56, s54, 1720320
s_mov_b32 m0, 82944
s_nop 0
buffer_load_dwordx4 v26, s[16:19], s56 offen lds
s_add_u32 s56, s54, 1736704
s_mov_b32 m0, 83968
s_nop 0
buffer_load_dwordx4 v27, s[16:19], s56 offen lds
s_add_u32 s56, s54, 1753088
s_mov_b32 m0, 84992
s_nop 0
buffer_load_dwordx4 v27, s[16:19], s56 offen lds
ds_read_b64_tr_b16 v[240:241], v44 offset:28672
ds_read_b64_tr_b16 v[242:243], v44 offset:29696
ds_read_b64_tr_b16 v[244:245], v46 offset:28672
ds_read_b64_tr_b16 v[246:247], v46 offset:29696
ds_read_b64_tr_b16 v[248:249], v45 offset:28672
ds_read_b64_tr_b16 v[250:251], v45 offset:29696
ds_read_b64_tr_b16 v[252:253], v47 offset:28672
ds_read_b64_tr_b16 v[254:255], v47 offset:29696
ds_read_b64_tr_b16 v[60:61], v31 offset:36864
ds_read_b64_tr_b16 v[62:63], v31 offset:36992
ds_read_b64_tr_b16 v[64:65], v31 offset:37376
ds_read_b64_tr_b16 v[66:67], v31 offset:37504
ds_read_b64_tr_b16 v[68:69], v31 offset:38912
ds_read_b64_tr_b16 v[70:71], v31 offset:39040
ds_read_b64_tr_b16 v[72:73], v31 offset:39424
ds_read_b64_tr_b16 v[74:75], v31 offset:39552
s_waitcnt lgkmcnt(0)
ds_write_b128 v2, v[60:63] offset:36864
ds_write_b128 v2, v[64:67] offset:37888
ds_write_b128 v2, v[68:71] offset:38912
ds_write_b128 v2, v[72:75] offset:39936
s_waitcnt lgkmcnt(0)
s_waitcnt vmcnt(24)
s_barrier
s_add_u32 s56, s54, 2228224
s_mov_b32 m0, 86016
s_nop 0
buffer_load_dwordx4 v26, s[16:19], s56 offen lds
s_add_u32 s56, s54, 2244608
s_mov_b32 m0, 87040
s_nop 0
buffer_load_dwordx4 v26, s[16:19], s56 offen lds
s_add_u32 s56, s54, 2260992
s_mov_b32 m0, 88064
s_nop 0
buffer_load_dwordx4 v27, s[16:19], s56 offen lds
s_add_u32 s56, s54, 2277376
s_mov_b32 m0, 89088
s_nop 0
buffer_load_dwordx4 v27, s[16:19], s56 offen lds
ds_read_b64_tr_b16 a[0:1], v44 offset:0
ds_read_b64_tr_b16 a[2:3], v44 offset:1024
ds_read_b64_tr_b16 a[4:5], v46 offset:0
ds_read_b64_tr_b16 a[6:7], v46 offset:1024
ds_read_b64_tr_b16 a[8:9], v45 offset:0
ds_read_b64_tr_b16 a[10:11], v45 offset:1024
ds_read_b64_tr_b16 a[12:13], v47 offset:0
ds_read_b64_tr_b16 a[14:15], v47 offset:1024
s_waitcnt lgkmcnt(0)
s_waitcnt vmcnt(24)
s_barrier
s_add_u32 s56, s54, 2752512
s_mov_b32 m0, 57344
s_nop 0
buffer_load_dwordx4 v26, s[16:19], s56 offen lds
s_add_u32 s56, s54, 2768896
s_mov_b32 m0, 58368
s_nop 0
buffer_load_dwordx4 v26, s[16:19], s56 offen lds
s_add_u32 s56, s54, 2785280
s_mov_b32 m0, 59392
s_nop 0
buffer_load_dwordx4 v27, s[16:19], s56 offen lds
s_add_u32 s56, s54, 2801664
s_mov_b32 m0, 60416
s_nop 0
buffer_load_dwordx4 v27, s[16:19], s56 offen lds
ds_read_b64_tr_b16 a[16:17], v44 offset:4096
ds_read_b64_tr_b16 a[18:19], v44 offset:5120
ds_read_b64_tr_b16 a[20:21], v46 offset:4096
ds_read_b64_tr_b16 a[22:23], v46 offset:5120
ds_read_b64_tr_b16 a[24:25], v45 offset:4096
ds_read_b64_tr_b16 a[26:27], v45 offset:5120
ds_read_b64_tr_b16 a[28:29], v47 offset:4096
ds_read_b64_tr_b16 a[30:31], v47 offset:5120
s_waitcnt lgkmcnt(0)
s_waitcnt vmcnt(24)
s_barrier
s_add_u32 s56, s54, 3276800
s_mov_b32 m0, 61440
s_nop 0
buffer_load_dwordx4 v26, s[16:19], s56 offen lds
s_add_u32 s56, s54, 3293184
s_mov_b32 m0, 62464
s_nop 0
buffer_load_dwordx4 v26, s[16:19], s56 offen lds
s_add_u32 s56, s54, 3309568
s_mov_b32 m0, 63488
s_nop 0
buffer_load_dwordx4 v27, s[16:19], s56 offen lds
s_add_u32 s56, s54, 3325952
s_mov_b32 m0, 64512
s_nop 0
buffer_load_dwordx4 v27, s[16:19], s56 offen lds
ds_read_b64_tr_b16 a[32:33], v44 offset:8192
ds_read_b64_tr_b16 a[34:35], v44 offset:9216
ds_read_b64_tr_b16 a[36:37], v46 offset:8192
ds_read_b64_tr_b16 a[38:39], v46 offset:9216
ds_read_b64_tr_b16 a[40:41], v45 offset:8192
ds_read_b64_tr_b16 a[42:43], v45 offset:9216
ds_read_b64_tr_b16 a[44:45], v47 offset:8192
ds_read_b64_tr_b16 a[46:47], v47 offset:9216
s_waitcnt lgkmcnt(0)
s_waitcnt vmcnt(24)
s_barrier
s_add_u32 s56, s54, 3801088
s_mov_b32 m0, 65536
s_nop 0
buffer_load_dwordx4 v26, s[16:19], s56 offen lds
s_add_u32 s56, s54, 3817472
s_mov_b32 m0, 66560
s_nop 0
buffer_load_dwordx4 v26, s[16:19], s56 offen lds
s_add_u32 s56, s54, 3833856
s_mov_b32 m0, 67584
s_nop 0
buffer_load_dwordx4 v27, s[16:19], s56 offen lds
s_add_u32 s56, s54, 3850240
s_mov_b32 m0, 68608
s_nop 0
buffer_load_dwordx4 v27, s[16:19], s56 offen lds
ds_read_b64_tr_b16 a[48:49], v44 offset:12288
ds_read_b64_tr_b16 a[50:51], v44 offset:13312
ds_read_b64_tr_b16 a[52:53], v46 offset:12288
ds_read_b64_tr_b16 a[54:55], v46 offset:13312
ds_read_b64_tr_b16 a[56:57], v45 offset:12288
ds_read_b64_tr_b16 a[58:59], v45 offset:13312
ds_read_b64_tr_b16 a[60:61], v47 offset:12288
ds_read_b64_tr_b16 a[62:63], v47 offset:13312
s_waitcnt lgkmcnt(0)
s_waitcnt vmcnt(24)
s_barrier
s_add_u32 s56, s55, 78336
s_mov_b32 m0, 69632
s_nop 0
buffer_load_dwordx4 v28, s[20:23], s56 offen lds
s_add_u32 s56, s55, 80640
s_mov_b32 m0, 70656
s_nop 0
buffer_load_dwordx4 v28, s[20:23], s56 offen lds
s_add_u32 s56, s55, 87552
s_mov_b32 m0, 71680
s_nop 0
buffer_load_dwordx4 v28, s[20:23], s56 offen lds
s_add_u32 s56, s55, 89856
s_mov_b32 m0, 72704
s_nop 0
buffer_load_dwordx4 v28, s[20:23], s56 offen lds
ds_read_b64_tr_b16 a[64:65], v44 offset:16384
ds_read_b64_tr_b16 a[66:67], v44 offset:17408
ds_read_b64_tr_b16 a[68:69], v46 offset:16384
ds_read_b64_tr_b16 a[70:71], v46 offset:17408
ds_read_b64_tr_b16 a[72:73], v45 offset:16384
ds_read_b64_tr_b16 a[74:75], v45 offset:17408
ds_read_b64_tr_b16 a[76:77], v47 offset:16384
ds_read_b64_tr_b16 a[78:79], v47 offset:17408
s_waitcnt lgkmcnt(0)
s_waitcnt vmcnt(24)
s_barrier
s_add_u32 s56, s55, 78592
s_mov_b32 m0, 73728
s_nop 0
buffer_load_dwordx4 v28, s[20:23], s56 offen lds
s_add_u32 s56, s55, 80896
s_mov_b32 m0, 74752
s_nop 0
buffer_load_dwordx4 v28, s[20:23], s56 offen lds
s_add_u32 s56, s55, 87808
s_mov_b32 m0, 75776
s_nop 0
buffer_load_dwordx4 v28, s[20:23], s56 offen lds
s_add_u32 s56, s55, 90112
s_mov_b32 m0, 76800
s_nop 0
buffer_load_dwordx4 v28, s[20:23], s56 offen lds
ds_read_b64_tr_b16 a[80:81], v44 offset:20480
ds_read_b64_tr_b16 a[82:83], v44 offset:21504
ds_read_b64_tr_b16 a[84:85], v46 offset:20480
ds_read_b64_tr_b16 a[86:87], v46 offset:21504
ds_read_b64_tr_b16 a[88:89], v45 offset:20480
ds_read_b64_tr_b16 a[90:91], v45 offset:21504
ds_read_b64_tr_b16 a[92:93], v47 offset:20480
ds_read_b64_tr_b16 a[94:95], v47 offset:21504
s_waitcnt lgkmcnt(0)
s_waitcnt vmcnt(24)
s_barrier
s_add_u32 s56, s55, 78848
s_mov_b32 m0, 77824
s_nop 0
buffer_load_dwordx4 v28, s[20:23], s56 offen lds
s_add_u32 s56, s55, 81152
s_mov_b32 m0, 78848
s_nop 0
buffer_load_dwordx4 v28, s[20:23], s56 offen lds
s_add_u32 s56, s55, 88064
s_mov_b32 m0, 79872
s_nop 0
buffer_load_dwordx4 v28, s[20:23], s56 offen lds
s_add_u32 s56, s55, 90368
s_mov_b32 m0, 80896
s_nop 0
buffer_load_dwordx4 v28, s[20:23], s56 offen lds
ds_read_b64_tr_b16 a[96:97], v44 offset:24576
ds_read_b64_tr_b16 a[98:99], v44 offset:25600
ds_read_b64_tr_b16 a[100:101], v46 offset:24576
ds_read_b64_tr_b16 a[102:103], v46 offset:25600
ds_read_b64_tr_b16 a[104:105], v45 offset:24576
ds_read_b64_tr_b16 a[106:107], v45 offset:25600
ds_read_b64_tr_b16 a[108:109], v47 offset:24576
ds_read_b64_tr_b16 a[110:111], v47 offset:25600
s_waitcnt lgkmcnt(0)
s_waitcnt vmcnt(24)
s_barrier
s_add_u32 s56, s55, 79104
s_mov_b32 m0, 81920
s_nop 0
buffer_load_dwordx4 v28, s[20:23], s56 offen lds
s_add_u32 s56, s55, 81408
s_mov_b32 m0, 82944
s_nop 0
buffer_load_dwordx4 v28, s[20:23], s56 offen lds
s_add_u32 s56, s55, 88320
s_mov_b32 m0, 83968
s_nop 0
buffer_load_dwordx4 v28, s[20:23], s56 offen lds
s_add_u32 s56, s55, 90624
s_mov_b32 m0, 84992
s_nop 0
buffer_load_dwordx4 v28, s[20:23], s56 offen lds
ds_read_b64_tr_b16 a[112:113], v44 offset:28672
ds_read_b64_tr_b16 a[114:115], v44 offset:29696
ds_read_b64_tr_b16 a[116:117], v46 offset:28672
ds_read_b64_tr_b16 a[118:119], v46 offset:29696
ds_read_b64_tr_b16 a[120:121], v45 offset:28672
ds_read_b64_tr_b16 a[122:123], v45 offset:29696
ds_read_b64_tr_b16 a[124:125], v47 offset:28672
ds_read_b64_tr_b16 a[126:127], v47 offset:29696
s_waitcnt lgkmcnt(0)
s_waitcnt vmcnt(24)
s_barrier
s_add_u32 s56, s55, 4608
s_mov_b32 m0, 86016
s_nop 0
buffer_load_dwordx4 v28, s[20:23], s56 offen lds
s_add_u32 s56, s55, 6912
s_mov_b32 m0, 87040
s_nop 0
buffer_load_dwordx4 v28, s[20:23], s56 offen lds
s_add_u32 s56, s55, 13824
s_mov_b32 m0, 88064
s_nop 0
buffer_load_dwordx4 v28, s[20:23], s56 offen lds
s_add_u32 s56, s55, 16128
s_mov_b32 m0, 89088
s_nop 0
buffer_load_dwordx4 v28, s[20:23], s56 offen lds
ds_read_b64_tr_b16 a[128:129], v44 offset:0
ds_read_b64_tr_b16 a[130:131], v44 offset:1024
ds_read_b64_tr_b16 a[132:133], v46 offset:0
ds_read_b64_tr_b16 a[134:135], v46 offset:1024
ds_read_b64_tr_b16 a[136:137], v45 offset:0
ds_read_b64_tr_b16 a[138:139], v45 offset:1024
ds_read_b64_tr_b16 a[140:141], v47 offset:0
ds_read_b64_tr_b16 a[142:143], v47 offset:1024
buffer_load_dword v32, v24, s[28:31], 0 offen sc0 sc1
s_waitcnt lgkmcnt(0)
s_waitcnt vmcnt(25)
s_barrier
s_add_u32 s56, s54, 131072
s_mov_b32 m0, 57344
s_nop 0
buffer_load_dwordx4 v26, s[8:11], s56 offen lds
s_add_u32 s56, s54, 147456
s_mov_b32 m0, 58368
s_nop 0
buffer_load_dwordx4 v26, s[8:11], s56 offen lds
s_add_u32 s56, s54, 163840
s_mov_b32 m0, 59392
s_nop 0
buffer_load_dwordx4 v27, s[8:11], s56 offen lds
s_add_u32 s56, s54, 180224
s_mov_b32 m0, 60416
s_nop 0
buffer_load_dwordx4 v27, s[8:11], s56 offen lds
ds_read_b64_tr_b16 a[144:145], v44 offset:4096
ds_read_b64_tr_b16 a[146:147], v44 offset:5120
ds_read_b64_tr_b16 a[148:149], v46 offset:4096
ds_read_b64_tr_b16 a[150:151], v46 offset:5120
ds_read_b64_tr_b16 a[152:153], v45 offset:4096
ds_read_b64_tr_b16 a[154:155], v45 offset:5120
ds_read_b64_tr_b16 a[156:157], v47 offset:4096
ds_read_b64_tr_b16 a[158:159], v47 offset:5120
s_waitcnt lgkmcnt(0)
s_waitcnt vmcnt(25)
s_barrier
s_add_u32 s56, s54, 1703936
s_mov_b32 m0, 61440
s_nop 0
buffer_load_dwordx4 v26, s[8:11], s56 offen lds
s_add_u32 s56, s54, 1720320
s_mov_b32 m0, 62464
s_nop 0
buffer_load_dwordx4 v26, s[8:11], s56 offen lds
s_add_u32 s56, s54, 1736704
s_mov_b32 m0, 63488
s_nop 0
buffer_load_dwordx4 v27, s[8:11], s56 offen lds
s_add_u32 s56, s54, 1753088
s_mov_b32 m0, 64512
s_nop 0
buffer_load_dwordx4 v27, s[8:11], s56 offen lds
ds_read_b64_tr_b16 a[160:161], v44 offset:8192
ds_read_b64_tr_b16 a[162:163], v44 offset:9216
ds_read_b64_tr_b16 a[164:165], v46 offset:8192
ds_read_b64_tr_b16 a[166:167], v46 offset:9216
ds_read_b64_tr_b16 a[168:169], v45 offset:8192
ds_read_b64_tr_b16 a[170:171], v45 offset:9216
ds_read_b64_tr_b16 a[172:173], v47 offset:8192
ds_read_b64_tr_b16 a[174:175], v47 offset:9216
s_waitcnt lgkmcnt(0)
s_waitcnt vmcnt(25)
s_barrier
s_add_u32 s56, s54, 2228224
s_mov_b32 m0, 65536
s_nop 0
buffer_load_dwordx4 v26, s[8:11], s56 offen lds
s_add_u32 s56, s54, 2244608
s_mov_b32 m0, 66560
s_nop 0
buffer_load_dwordx4 v26, s[8:11], s56 offen lds
s_add_u32 s56, s54, 2260992
s_mov_b32 m0, 67584
s_nop 0
buffer_load_dwordx4 v27, s[8:11], s56 offen lds
s_add_u32 s56, s54, 2277376
s_mov_b32 m0, 68608
s_nop 0
buffer_load_dwordx4 v27, s[8:11], s56 offen lds
ds_read_b64_tr_b16 a[200:201], v48 offset:12288
ds_read_b64_tr_b16 a[202:203], v48 offset:13312
ds_read_b64_tr_b16 a[204:205], v48 offset:14336
ds_read_b64_tr_b16 a[206:207], v48 offset:15360
ds_read_b64_tr_b16 a[184:185], v49 offset:12288
ds_read_b64_tr_b16 a[186:187], v49 offset:13312
ds_read_b64_tr_b16 a[188:189], v49 offset:14336
ds_read_b64_tr_b16 a[190:191], v49 offset:15360
s_waitcnt lgkmcnt(0)
s_waitcnt vmcnt(25)
s_barrier
s_add_u32 s56, s54, 2752512
s_mov_b32 m0, 69632
s_nop 0
buffer_load_dwordx4 v26, s[12:15], s56 offen lds
s_add_u32 s56, s54, 2768896
s_mov_b32 m0, 70656
s_nop 0
buffer_load_dwordx4 v26, s[12:15], s56 offen lds
s_add_u32 s56, s54, 2785280
s_mov_b32 m0, 71680
s_nop 0
buffer_load_dwordx4 v27, s[12:15], s56 offen lds
s_add_u32 s56, s54, 2801664
s_mov_b32 m0, 72704
s_nop 0
buffer_load_dwordx4 v27, s[12:15], s56 offen lds
ds_read_b64_tr_b16 a[216:217], v48 offset:16384
ds_read_b64_tr_b16 a[218:219], v48 offset:17408
ds_read_b64_tr_b16 a[220:221], v48 offset:18432
ds_read_b64_tr_b16 a[222:223], v48 offset:19456
ds_read_b64_tr_b16 a[208:209], v49 offset:16384
ds_read_b64_tr_b16 a[210:211], v49 offset:17408
ds_read_b64_tr_b16 a[212:213], v49 offset:18432
ds_read_b64_tr_b16 a[214:215], v49 offset:19456
s_waitcnt lgkmcnt(0)
s_waitcnt vmcnt(25)
s_barrier
s_add_u32 s56, s54, 4325376
s_mov_b32 m0, 73728
s_nop 0
buffer_load_dwordx4 v26, s[16:19], s56 offen lds
s_add_u32 s56, s54, 4341760
s_mov_b32 m0, 74752
s_nop 0
buffer_load_dwordx4 v26, s[16:19], s56 offen lds
s_add_u32 s56, s54, 4358144
s_mov_b32 m0, 75776
s_nop 0
buffer_load_dwordx4 v27, s[16:19], s56 offen lds
s_add_u32 s56, s54, 4374528
s_mov_b32 m0, 76800
s_nop 0
buffer_load_dwordx4 v27, s[16:19], s56 offen lds
ds_read_b64_tr_b16 a[232:233], v48 offset:20480
ds_read_b64_tr_b16 a[234:235], v48 offset:21504
ds_read_b64_tr_b16 a[236:237], v48 offset:22528
ds_read_b64_tr_b16 a[238:239], v48 offset:23552
ds_read_b64_tr_b16 a[224:225], v49 offset:20480
ds_read_b64_tr_b16 a[226:227], v49 offset:21504
ds_read_b64_tr_b16 a[228:229], v49 offset:22528
ds_read_b64_tr_b16 a[230:231], v49 offset:23552
s_waitcnt lgkmcnt(0)
s_waitcnt vmcnt(25)
s_barrier
s_add_u32 s56, s55, 4864
s_mov_b32 m0, 77824
s_nop 0
buffer_load_dwordx4 v28, s[20:23], s56 offen lds
s_add_u32 s56, s55, 7168
s_mov_b32 m0, 78848
s_nop 0
buffer_load_dwordx4 v28, s[20:23], s56 offen lds
s_add_u32 s56, s55, 14080
s_mov_b32 m0, 79872
s_nop 0
buffer_load_dwordx4 v28, s[20:23], s56 offen lds
s_add_u32 s56, s55, 16384
s_mov_b32 m0, 80896
s_nop 0
buffer_load_dwordx4 v28, s[20:23], s56 offen lds
ds_read_b64_tr_b16 a[248:249], v48 offset:24576
ds_read_b64_tr_b16 a[250:251], v48 offset:25600
ds_read_b64_tr_b16 a[252:253], v48 offset:26624
ds_read_b64_tr_b16 a[254:255], v48 offset:27648
ds_read_b64_tr_b16 a[240:241], v49 offset:24576
ds_read_b64_tr_b16 a[242:243], v49 offset:25600
ds_read_b64_tr_b16 a[244:245], v49 offset:26624
ds_read_b64_tr_b16 a[246:247], v49 offset:27648
s_waitcnt lgkmcnt(0)
s_waitcnt vmcnt(25)
s_barrier
s_add_u32 s56, s55, 5120
s_mov_b32 m0, 81920
s_nop 0
buffer_load_dwordx4 v28, s[20:23], s56 offen lds
s_add_u32 s56, s55, 7424
s_mov_b32 m0, 82944
s_nop 0
buffer_load_dwordx4 v28, s[20:23], s56 offen lds
s_add_u32 s56, s55, 14336
s_mov_b32 m0, 83968
s_nop 0
buffer_load_dwordx4 v28, s[20:23], s56 offen lds
s_add_u32 s56, s55, 16640
s_mov_b32 m0, 84992
s_nop 0
buffer_load_dwordx4 v28, s[20:23], s56 offen lds
ds_read_b64_tr_b16 a[192:193], v48 offset:28672
ds_read_b64_tr_b16 a[194:195], v48 offset:29696
ds_read_b64_tr_b16 a[196:197], v48 offset:30720
ds_read_b64_tr_b16 a[198:199], v48 offset:31744
ds_read_b64_tr_b16 a[176:177], v49 offset:28672
ds_read_b64_tr_b16 a[178:179], v49 offset:29696
ds_read_b64_tr_b16 a[180:181], v49 offset:30720
ds_read_b64_tr_b16 a[182:183], v49 offset:31744
s_waitcnt lgkmcnt(0)
s_waitcnt vmcnt(24)
s_barrier
s_add_u32 s56, s55, 5376
s_mov_b32 m0, 86016
s_nop 0
buffer_load_dwordx4 v28, s[20:23], s56 offen lds
s_add_u32 s56, s55, 7680
s_mov_b32 m0, 87040
s_nop 0
buffer_load_dwordx4 v28, s[20:23], s56 offen lds
s_add_u32 s56, s55, 14592
s_mov_b32 m0, 88064
s_nop 0
buffer_load_dwordx4 v28, s[20:23], s56 offen lds
s_add_u32 s56, s55, 16896
s_mov_b32 m0, 89088
s_nop 0
buffer_load_dwordx4 v28, s[20:23], s56 offen lds
ds_read_b64_tr_b16 v[60:61], v44 offset:0
ds_read_b64_tr_b16 v[62:63], v44 offset:1024
ds_read_b64_tr_b16 v[64:65], v46 offset:0
ds_read_b64_tr_b16 v[66:67], v46 offset:1024
ds_read_b64_tr_b16 v[68:69], v45 offset:0
ds_read_b64_tr_b16 v[70:71], v45 offset:1024
ds_read_b64_tr_b16 v[72:73], v47 offset:0
ds_read_b64_tr_b16 v[74:75], v47 offset:1024
s_waitcnt lgkmcnt(0)
s_waitcnt vmcnt(24)
s_barrier
ds_write_b128 v2, v[60:63] offset:0
ds_write_b128 v2, v[64:67] offset:1024
ds_write_b128 v2, v[68:71] offset:2048
ds_write_b128 v2, v[72:75] offset:3072
ds_read_b64_tr_b16 v[60:61], v44 offset:4096
ds_read_b64_tr_b16 v[62:63], v44 offset:5120
ds_read_b64_tr_b16 v[64:65], v46 offset:4096
ds_read_b64_tr_b16 v[66:67], v46 offset:5120
ds_read_b64_tr_b16 v[68:69], v45 offset:4096
ds_read_b64_tr_b16 v[70:71], v45 offset:5120
ds_read_b64_tr_b16 v[72:73], v47 offset:4096
ds_read_b64_tr_b16 v[74:75], v47 offset:5120
L_rdv_w1r:
v_readfirstlane_b32 s38, v32
s_nop 0
s_and_b32 s57, s38, 0xff
s_cmp_lg_u32 s57, 32
s_cbranch_scc1 L_rdv2_w1r
s_waitcnt lgkmcnt(0)
s_waitcnt vmcnt(20)
s_barrier
ds_write_b128 v2, v[60:63] offset:4096
ds_write_b128 v2, v[64:67] offset:5120
ds_write_b128 v2, v[68:71] offset:6144
ds_write_b128 v2, v[72:75] offset:7168
ds_read_b64_tr_b16 v[60:61], v44 offset:8192
ds_read_b64_tr_b16 v[62:63], v44 offset:9216
ds_read_b64_tr_b16 v[64:65], v46 offset:8192
ds_read_b64_tr_b16 v[66:67], v46 offset:9216
ds_read_b64_tr_b16 v[68:69], v45 offset:8192
ds_read_b64_tr_b16 v[70:71], v45 offset:9216
ds_read_b64_tr_b16 v[72:73], v47 offset:8192
ds_read_b64_tr_b16 v[74:75], v47 offset:9216
buffer_load_dwordx4 v[12:15], v9, s[4:7], s37 offen offset:0
buffer_load_dwordx4 v[16:19], v9, s[4:7], s37 offen offset:1024
buffer_load_dwordx4 v[52:55], v1, s[4:7], s37 offen offset:2048
buffer_load_dwordx4 v[56:59], v1, s[4:7], s37 offen offset:3072
s_mov_b32 m0, 1024
s_nop 0
buffer_load_dwordx4 v1, s[4:7], s47 offen offset:1024 sc1 lds
buffer_load_dword v33, v1, s[4:7], s3 offen offset:0 sc1
buffer_load_dword v33, v1, s[4:7], s3 offen offset:1024 sc1
buffer_load_dword v33, v1, s[4:7], s3 offen offset:2048 sc1
buffer_load_dword v33, v1, s[4:7], s3 offen offset:3072 sc1
s_waitcnt lgkmcnt(0)
s_waitcnt vmcnt(25)
s_barrier
ds_write_b128 v2, v[60:63] offset:8192
ds_write_b128 v2, v[64:67] offset:9216
ds_write_b128 v2, v[68:71] offset:10240
ds_write_b128 v2, v[72:75] offset:11264
ds_read_b64_tr_b16 v[60:61], v44 offset:12288
ds_read_b64_tr_b16 v[62:63], v44 offset:13312
ds_read_b64_tr_b16 v[64:65], v46 offset:12288
ds_read_b64_tr_b16 v[66:67], v46 offset:13312
ds_read_b64_tr_b16 v[68:69], v45 offset:12288
ds_read_b64_tr_b16 v[70:71], v45 offset:13312
ds_read_b64_tr_b16 v[72:73], v47 offset:12288
ds_read_b64_tr_b16 v[74:75], v47 offset:13312
s_waitcnt lgkmcnt(0)
s_waitcnt vmcnt(21)
s_barrier
ds_write_b128 v2, v[60:63] offset:12288
ds_write_b128 v2, v[64:67] offset:13312
ds_write_b128 v2, v[68:71] offset:14336
ds_write_b128 v2, v[72:75] offset:15360
ds_read_b64_tr_b16 v[60:61], v44 offset:16384
ds_read_b64_tr_b16 v[62:63], v44 offset:17408
ds_read_b64_tr_b16 v[64:65], v46 offset:16384
ds_read_b64_tr_b16 v[66:67], v46 offset:17408
ds_read_b64_tr_b16 v[68:69], v45 offset:16384
ds_read_b64_tr_b16 v[70:71], v45 offset:17408
ds_read_b64_tr_b16 v[72:73], v47 offset:16384
ds_read_b64_tr_b16 v[74:75], v47 offset:17408
s_waitcnt lgkmcnt(0)
s_waitcnt vmcnt(17)
s_barrier
ds_write_b128 v2, v[60:63] offset:16384
ds_write_b128 v2, v[64:67] offset:17408
ds_write_b128 v2, v[68:71] offset:18432
ds_write_b128 v2, v[72:75] offset:19456
ds_read_b64_tr_b16 v[60:61], v48 offset:20480
ds_read_b64_tr_b16 v[62:63], v48 offset:21504
ds_read_b64_tr_b16 v[64:65], v48 offset:22528
ds_read_b64_tr_b16 v[66:67], v48 offset:23552
ds_read_b64_tr_b16 v[68:69], v49 offset:20480
ds_read_b64_tr_b16 v[70:71], v49 offset:21504
ds_read_b64_tr_b16 v[72:73], v49 offset:22528
ds_read_b64_tr_b16 v[74:75], v49 offset:23552
s_waitcnt lgkmcnt(0)
s_waitcnt vmcnt(13)
s_barrier
ds_write_b128 v2, v[60:63] offset:20480
ds_write_b128 v2, v[64:67] offset:21504
ds_write_b128 v2, v[68:71] offset:22528
ds_write_b128 v2, v[72:75] offset:23552
ds_read_b64_tr_b16 v[60:61], v48 offset:24576
ds_read_b64_tr_b16 v[62:63], v48 offset:25600
ds_read_b64_tr_b16 v[64:65], v48 offset:26624
ds_read_b64_tr_b16 v[66:67], v48 offset:27648
ds_read_b64_tr_b16 v[68:69], v49 offset:24576
ds_read_b64_tr_b16 v[70:71], v49 offset:25600
ds_read_b64_tr_b16 v[72:73], v49 offset:26624
ds_read_b64_tr_b16 v[74:75], v49 offset:27648
s_waitcnt lgkmcnt(0)
s_waitcnt vmcnt(9)
s_barrier
ds_write_b128 v2, v[60:63] offset:24576
ds_write_b128 v2, v[64:67] offset:25600
ds_write_b128 v2, v[68:71] offset:26624
ds_write_b128 v2, v[72:75] offset:27648
ds_read_b64_tr_b16 v[60:61], v48 offset:28672
ds_read_b64_tr_b16 v[62:63], v48 offset:29696
ds_read_b64_tr_b16 v[64:65], v48 offset:30720
ds_read_b64_tr_b16 v[66:67], v48 offset:31744
ds_read_b64_tr_b16 v[68:69], v49 offset:28672
ds_read_b64_tr_b16 v[70:71], v49 offset:29696
ds_read_b64_tr_b16 v[72:73], v49 offset:30720
ds_read_b64_tr_b16 v[74:75], v49 offset:31744
s_waitcnt lgkmcnt(0)
s_barrier
ds_write_b128 v2, v[60:63] offset:28672
ds_write_b128 v2, v[64:67] offset:29696
ds_write_b128 v2, v[68:71] offset:30720
ds_write_b128 v2, v[72:75] offset:31744
s_lshl_b32 s57, s58, 5
s_mov_b32 s0, 0x3f003f00
s_mov_b32 s1, 0x3f003f00
s_mov_b32 s58, 304128
s_cmp_eq_u32 s38, s57
s_mov_b32 s56, 0x33333333
s_mov_b32 s57, 0x33333333
s_mov_b32 s2, 0x21800000
s_mov_b32 s55, -24
s_cbranch_scc0 L_slow_w1r
v_mov_b64 v[20:21], 0
v_mov_b64 v[22:23], 0
v_mov_b64 v[24:25], 0
v_mov_b64 v[26:27], 0
v_mov_b64 v[28:29], 0
v_mov_b64 v[30:31], 0
v_mov_b64 v[32:33], 0
v_mov_b64 v[34:35], 0
v_mov_b64 v[36:37], 0
v_mov_b64 v[38:39], 0
v_mov_b64 v[40:41], 0
v_mov_b64 v[42:43], 0
ds_read_b128 v[44:47], v2 offset:0
ds_read_b128 v[48:51], v2 offset:1024
v_bfe_u32 v77, v1, 6, 1
v_lshl_add_u32 v77, v77, 3, v1
v_lshlrev_b32 v77, 1, v77
v_lshlrev_b32 v78, 3, v1
s_mov_b32 s38, 0
v_and_b32 v6, 0x70, v1
ds_write_b32 v6, v20 offset:516
s_waitcnt vmcnt(0) lgkmcnt(0)
s_branch L_top_w1rf
L_done_w1rf:
s_mul_i32 s40, s34, 10240
s_add_u32 s40, s40, 8093696
buffer_store_dword v11, v10, s[4:7], s40 offen sc0 sc1
s_waitcnt vmcnt(0) lgkmcnt(0)
s_endpgm
L_rdv2_w1r:
buffer_load_dword v32, v24, s[28:31], 0 offen sc0 sc1
s_sub_u32 s41, s41, 1
s_cbranch_scc1 L_exit
s_waitcnt vmcnt(0)
s_branch L_rdv_w1r
L_ra0_w1rf:
s_mov_b32 m0, 1024
s_nop 0
buffer_load_dwordx4 v1, s[4:7], s47 offen offset:0 sc1 lds
buffer_load_dwordx4 v1, s[4:7], s47 offen offset:1024 sc1 lds
buffer_load_dwordx4 v1, s[4:7], s47 offen offset:2048 sc1 lds
buffer_load_dwordx4 v1, s[4:7], s47 offen offset:3072 sc1 lds
s_sub_u32 s41, s41, 1
s_cbranch_scc1 L_exit
ds_read_b128 v[44:47], v2 offset:0
ds_read_b128 v[48:51], v2 offset:1024
v_mov_b64 v[20:21], 0
v_mov_b64 v[22:23], 0
v_mov_b64 v[24:25], 0
v_mov_b64 v[26:27], 0
v_mov_b64 v[28:29], 0
v_mov_b64 v[30:31], 0
v_mov_b64 v[32:33], 0
v_mov_b64 v[34:35], 0
v_mov_b64 v[36:37], 0
v_mov_b64 v[38:39], 0
v_mov_b64 v[40:41], 0
v_mov_b64 v[42:43], 0
s_waitcnt vmcnt(0)
ds_read_b128 v[60:63], v1 offset:1024
ds_read_b128 v[64:67], v1 offset:2048
ds_read_b128 v[68:71], v1 offset:3072
ds_read_b128 v[72:75], v1 offset:4096
s_branch L_s0_w1rf
L_ra1_w1rf:
L_ra2_w1rf:
s_waitcnt lgkmcnt(0)
s_barrier
s_mov_b32 m0, 5120
s_nop 0
buffer_load_dwordx4 v1, s[4:7], s48 offen offset:1024 sc1 lds
s_sub_u32 s41, s41, 1
s_cbranch_scc1 L_exit
s_waitcnt vmcnt(0)
s_barrier
ds_read_b128 v[76:79], v1 offset:5120
ds_read_b128 v[60:63], v1 offset:6144
ds_read_b128 v[64:67], v1 offset:7168
ds_read_b128 v[68:71], v1 offset:8192
ds_read_b128 v[72:75], v1 offset:9216
s_waitcnt lgkmcnt(0)
v_bitop3_b32 v6, v76, v60, s35 bitop3:0x7e
v_bitop3_b32 v6, v6, v64, s35 bitop3:0xf6
v_bitop3_b32 v6, v6, v68, s35 bitop3:0xf6
v_bitop3_b32 v6, v6, v72, s35 bitop3:0xf6
v_and_b32 v6, 1, v6
v_cmp_ne_u32 vcc, 0, v6

s_cbranch_vccnz L_ra2_w1rf
s_branch L_a1_w1rf
L_mx_w1rf:
s_waitcnt lgkmcnt(0)
v_max3_f32 v30, v12, v13, v28
v_max_f32 v30, v30, v29
v_mov_b32 v31, v30
s_nop 1
v_permlane16_swap_b32 v30, v31
v_max_f32 v30, v30, v31
v_mov_b32 v31, v30
s_nop 1
v_permlane32_swap_b32 v30, v31
v_max_f32 v30, v30, v31
ds_write_b32 v1, v30 offset:10244
s_waitcnt lgkmcnt(0)
s_barrier
ds_read_b128 v[32:35], v1 offset:10240
s_waitcnt lgkmcnt(0)
v_max3_f32 v32, v32, v33, v34
v_max_f32 v32, v32, v35
v_sub_f32 v14, v12, v32
v_sub_f32 v15, v13, v32
v_sub_f32 v30, v28, v32
v_sub_f32 v31, v29, v32
v_exp_f32 v14, v14
v_exp_f32 v15, v15
v_exp_f32 v30, v30
v_exp_f32 v31, v31
v_cvt_pk_bf16_f32 v14, v14, v15
v_cvt_pk_bf16_f32 v30, v30, v31
ds_write_b32 v5, v14 offset:14624
v_cndmask_b32_e64 v26, 0, v30, s[56:57]
v_cndmask_b32_e64 v27, 0, v30, s[56:57]
v_mov_b64 v[76:77], s[52:53]
v_mov_b64 v[78:79], s[52:53]
v_mov_b32_dpp v24, v26 quad_perm:[2,3,0,1] row_mask:0xf bank_mask:0xf
v_mov_b32_dpp v25, v26 quad_perm:[2,3,0,1] row_mask:0xf bank_mask:0xf
s_waitcnt lgkmcnt(0)
s_barrier
v_mov_b64 v[14:15], s[0:1]
ds_read_b128 v[16:19], v1 offset:14368
ds_read_b128 v[36:39], v1 offset:14336
s_waitcnt lgkmcnt(0)
v_mfma_f32_16x16x32_bf16 v[32:35], v[76:79], v[16:19], 0
v_mfma_f32_16x16x32_bf16 v[20:23], v[52:55], v[16:19], 0
v_mfma_f32_16x16x32_bf16 v[20:23], v[56:59], v[36:39], v[20:23]
v_mfma_f32_16x16x16_bf16 v[32:35], v[14:15], v[26:27], v[32:35]
v_mfma_f32_16x16x32_bf16 v[20:23], v[40:43], v[24:27], v[20:23]
s_nop 3
v_rcp_f32 v33, v32
s_nop 2
v_mul_f32_dpp v20, v33, v20 quad_perm:[0,1,0,1] row_mask:0xf bank_mask:0xf
v_mul_f32_dpp v21, v33, v21 quad_perm:[0,1,0,1] row_mask:0xf bank_mask:0xf
v_mul_f32_dpp v22, v33, v22 quad_perm:[0,1,0,1] row_mask:0xf bank_mask:0xf
v_mul_f32_dpp v23, v33, v23 quad_perm:[0,1,0,1] row_mask:0xf bank_mask:0xf
v_cvt_pk_bf16_f32 v20, v20, v21
v_cvt_pk_bf16_f32 v21, v22, v23
ds_write_b64 v6, v[20:21] offset:6144
v_mov_b32_dpp v16, v20 quad_perm:[0,1,0,1] row_mask:0xf bank_mask:0xf
v_mov_b32_dpp v17, v21 quad_perm:[0,1,0,1] row_mask:0xf bank_mask:0xf
v_mov_b32_dpp v18, v20 quad_perm:[2,3,2,3] row_mask:0xf bank_mask:0xf
v_mov_b32_dpp v19, v21 quad_perm:[2,3,2,3] row_mask:0xf bank_mask:0xf
v_mov_b64 v[76:77], 0
v_mov_b64 v[78:79], 0
v_mov_b64 v[36:37], 0
v_mov_b64 v[38:39], 0
v_mov_b64 v[24:25], 0
v_mov_b64 v[26:27], 0
v_mov_b64 v[32:33], 0
v_mov_b64 v[34:35], 0
s_waitcnt lgkmcnt(0)
s_branch L_mxb_w1rf

L_rr_w1rf:
buffer_load_dwordx4 v[60:63], v9, s[4:7], s3 offen offset:0 sc1
buffer_load_dwordx4 v[64:67], v9, s[4:7], s3 offen offset:1024 sc1
buffer_load_dwordx4 v[68:71], v9, s[4:7], s3 offen offset:2048 sc1
buffer_load_dwordx4 v[72:75], v9, s[4:7], s3 offen offset:3072 sc1
s_mov_b32 s38, 1
s_sub_u32 s41, s41, 1
s_cbranch_scc1 L_exit
s_waitcnt vmcnt(0)
s_branch L_r_w1rf
L_slow_w1r:
v_mov_b64 v[20:21], 0
v_mov_b64 v[22:23], 0
v_mov_b64 v[24:25], 0
v_mov_b64 v[26:27], 0
v_mov_b64 v[28:29], 0
v_mov_b64 v[30:31], 0
v_mov_b64 v[32:33], 0
v_mov_b64 v[34:35], 0
v_mov_b64 v[36:37], 0
v_mov_b64 v[38:39], 0
v_mov_b64 v[40:41], 0
v_mov_b64 v[42:43], 0
ds_read_b128 v[44:47], v2 offset:0
ds_read_b128 v[48:51], v2 offset:1024
v_bfe_u32 v77, v1, 6, 1
v_lshl_add_u32 v77, v77, 3, v1
v_lshlrev_b32 v77, 1, v77
v_lshlrev_b32 v78, 3, v1
s_mov_b32 s38, 0
v_and_b32 v6, 0x70, v1
ds_write_b32 v6, v20 offset:516
s_waitcnt vmcnt(0) lgkmcnt(0)
s_branch L_top_w1rs
L_done_w1rs:
s_mul_i32 s40, s34, 10240
s_add_u32 s40, s40, 8093696
buffer_store_dword v11, v10, s[4:7], s40 offen sc0 sc1
s_waitcnt vmcnt(0) lgkmcnt(0)
s_endpgm
L_ra0_w1rs:
s_mov_b32 m0, 1024
s_nop 0
buffer_load_dwordx4 v1, s[4:7], s47 offen offset:0 sc0 sc1 lds
buffer_load_dwordx4 v1, s[4:7], s47 offen offset:1024 sc0 sc1 lds
buffer_load_dwordx4 v1, s[4:7], s47 offen offset:2048 sc0 sc1 lds
buffer_load_dwordx4 v1, s[4:7], s47 offen offset:3072 sc0 sc1 lds
s_sub_u32 s41, s41, 1
s_cbranch_scc1 L_exit
ds_read_b128 v[44:47], v2 offset:0
ds_read_b128 v[48:51], v2 offset:1024
v_mov_b64 v[20:21], 0
v_mov_b64 v[22:23], 0
v_mov_b64 v[24:25], 0
v_mov_b64 v[26:27], 0
v_mov_b64 v[28:29], 0
v_mov_b64 v[30:31], 0
v_mov_b64 v[32:33], 0
v_mov_b64 v[34:35], 0
v_mov_b64 v[36:37], 0
v_mov_b64 v[38:39], 0
v_mov_b64 v[40:41], 0
v_mov_b64 v[42:43], 0
s_waitcnt vmcnt(0)
ds_read_b128 v[60:63], v1 offset:1024
ds_read_b128 v[64:67], v1 offset:2048
ds_read_b128 v[68:71], v1 offset:3072
ds_read_b128 v[72:75], v1 offset:4096
s_branch L_s0_w1rs
L_ra1_w1rs:
L_ra2_w1rs:
s_waitcnt lgkmcnt(0)
s_barrier
s_mov_b32 m0, 5120
s_nop 0
buffer_load_dwordx4 v1, s[4:7], s48 offen offset:1024 sc0 sc1 lds
s_sub_u32 s41, s41, 1
s_cbranch_scc1 L_exit
s_waitcnt vmcnt(0)
s_barrier
ds_read_b128 v[76:79], v1 offset:5120
ds_read_b128 v[60:63], v1 offset:6144
ds_read_b128 v[64:67], v1 offset:7168
ds_read_b128 v[68:71], v1 offset:8192
ds_read_b128 v[72:75], v1 offset:9216
s_waitcnt lgkmcnt(0)
v_bitop3_b32 v6, v76, v60, s35 bitop3:0x7e
v_bitop3_b32 v6, v6, v64, s35 bitop3:0xf6
v_bitop3_b32 v6, v6, v68, s35 bitop3:0xf6
v_bitop3_b32 v6, v6, v72, s35 bitop3:0xf6
v_and_b32 v6, 1, v6
v_cmp_ne_u32 vcc, 0, v6

s_cbranch_vccnz L_ra2_w1rs
s_branch L_a1_w1rs
L_mx_w1rs:
s_waitcnt lgkmcnt(0)
v_max3_f32 v30, v12, v13, v28
v_max_f32 v30, v30, v29
v_mov_b32 v31, v30
s_nop 1
v_permlane16_swap_b32 v30, v31
v_max_f32 v30, v30, v31
v_mov_b32 v31, v30
s_nop 1
v_permlane32_swap_b32 v30, v31
v_max_f32 v30, v30, v31
ds_write_b32 v1, v30 offset:10244
s_waitcnt lgkmcnt(0)
s_barrier
ds_read_b128 v[32:35], v1 offset:10240
s_waitcnt lgkmcnt(0)
v_max3_f32 v32, v32, v33, v34
v_max_f32 v32, v32, v35
v_sub_f32 v14, v12, v32
v_sub_f32 v15, v13, v32
v_sub_f32 v30, v28, v32
v_sub_f32 v31, v29, v32
v_exp_f32 v14, v14
v_exp_f32 v15, v15
v_exp_f32 v30, v30
v_exp_f32 v31, v31
v_cvt_pk_bf16_f32 v14, v14, v15
v_cvt_pk_bf16_f32 v30, v30, v31
ds_write_b32 v5, v14 offset:14624
v_cndmask_b32_e64 v26, 0, v30, s[56:57]
v_cndmask_b32_e64 v27, 0, v30, s[56:57]
v_mov_b64 v[76:77], s[52:53]
v_mov_b64 v[78:79], s[52:53]
v_mov_b32_dpp v24, v26 quad_perm:[2,3,0,1] row_mask:0xf bank_mask:0xf
v_mov_b32_dpp v25, v26 quad_perm:[2,3,0,1] row_mask:0xf bank_mask:0xf
s_waitcnt lgkmcnt(0)
s_barrier
v_mov_b64 v[14:15], s[0:1]
ds_read_b128 v[16:19], v1 offset:14368
ds_read_b128 v[36:39], v1 offset:14336
s_waitcnt lgkmcnt(0)
v_mfma_f32_16x16x32_bf16 v[32:35], v[76:79], v[16:19], 0
v_mfma_f32_16x16x32_bf16 v[20:23], v[52:55], v[16:19], 0
v_mfma_f32_16x16x32_bf16 v[20:23], v[56:59], v[36:39], v[20:23]
v_mfma_f32_16x16x16_bf16 v[32:35], v[14:15], v[26:27], v[32:35]
v_mfma_f32_16x16x32_bf16 v[20:23], v[40:43], v[24:27], v[20:23]
s_nop 3
v_rcp_f32 v33, v32
s_nop 2
v_mul_f32_dpp v20, v33, v20 quad_perm:[0,1,0,1] row_mask:0xf bank_mask:0xf
v_mul_f32_dpp v21, v33, v21 quad_perm:[0,1,0,1] row_mask:0xf bank_mask:0xf
v_mul_f32_dpp v22, v33, v22 quad_perm:[0,1,0,1] row_mask:0xf bank_mask:0xf
v_mul_f32_dpp v23, v33, v23 quad_perm:[0,1,0,1] row_mask:0xf bank_mask:0xf
v_cvt_pk_bf16_f32 v20, v20, v21
v_cvt_pk_bf16_f32 v21, v22, v23
ds_write_b64 v6, v[20:21] offset:6144
v_mov_b32_dpp v16, v20 quad_perm:[0,1,0,1] row_mask:0xf bank_mask:0xf
v_mov_b32_dpp v17, v21 quad_perm:[0,1,0,1] row_mask:0xf bank_mask:0xf
v_mov_b32_dpp v18, v20 quad_perm:[2,3,2,3] row_mask:0xf bank_mask:0xf
v_mov_b32_dpp v19, v21 quad_perm:[2,3,2,3] row_mask:0xf bank_mask:0xf
v_mov_b64 v[76:77], 0
v_mov_b64 v[78:79], 0
v_mov_b64 v[36:37], 0
v_mov_b64 v[38:39], 0
v_mov_b64 v[24:25], 0
v_mov_b64 v[26:27], 0
v_mov_b64 v[32:33], 0
v_mov_b64 v[34:35], 0
s_waitcnt lgkmcnt(0)
s_branch L_mxb_w1rs

L_rr_w1rs:
buffer_load_dwordx4 v[60:63], v9, s[4:7], s3 offen offset:0 sc0 sc1
buffer_load_dwordx4 v[64:67], v9, s[4:7], s3 offen offset:1024 sc0 sc1
buffer_load_dwordx4 v[68:71], v9, s[4:7], s3 offen offset:2048 sc0 sc1
buffer_load_dwordx4 v[72:75], v9, s[4:7], s3 offen offset:3072 sc0 sc1
s_mov_b32 s38, 1
s_sub_u32 s41, s41, 1
s_cbranch_scc1 L_exit
s_waitcnt vmcnt(0)
s_branch L_r_w1rs
.p2align 6
L_ex_w0f:
s_add_u32 s34, s34, 1
s_not_b32 s35, s35
s_not_b32 s36, s36
s_add_u32 s37, s37, 524288
s_add_u32 s39, s39, 524288
v_mov_b64 v[20:21], 0
v_mov_b64 v[22:23], 0
v_mov_b64 v[24:25], 0
v_mov_b64 v[26:27], 0
v_mov_b64 v[28:29], 0
v_mov_b64 v[30:31], 0
v_mov_b64 v[32:33], 0
v_mov_b64 v[34:35], 0
v_mov_b64 v[36:37], 0
v_mov_b64 v[38:39], 0
v_mov_b64 v[40:41], 0
v_mov_b64 v[42:43], 0
ds_read_b128 v[44:47], v2 offset:0
ds_read_b128 v[48:51], v2 offset:1024
v_bfe_u32 v77, v1, 6, 1
v_lshl_add_u32 v77, v77, 3, v1
v_lshlrev_b32 v77, 1, v77
v_lshlrev_b32 v78, 3, v1
v_and_b32 v6, 0x70, v1
v_mov_b32 v76, s34
ds_write_b32 v6, v76 offset:512
s_barrier
s_cmp_eq_u32 s34, 63
s_cbranch_scc1 L_done_w0f
L_top_w0f:
s_barrier
ds_read_b128 v[60:63], v1 offset:1024
s_mov_b32 m0, 5120
s_nop 0
buffer_load_dwordx4 v1, s[4:7], s48 offen offset:0 sc1 lds
s_barrier
ds_read_b128 v[64:67], v1 offset:2048
ds_read_b128 v[68:71], v1 offset:3072
ds_read_b128 v[72:75], v1 offset:4096
L_s0_w0f:
s_waitcnt lgkmcnt(3)
v_smfmac_f32_16x16x64_bf16 v[32:35], v[60:63], v[184:191], v0
v_smfmac_f32_16x16x64_bf16 v[20:23], v[60:63], v[44:51], v0
v_smfmac_f32_16x16x64_bf16 v[36:39], v[60:63], a[48:55], v0
buffer_load_dwordx4 v[12:15], v9, s[4:7], s37 offen offset:0
v_smfmac_f32_16x16x64_bf16 v[28:31], v[60:63], v[176:183], v0
buffer_load_dwordx4 v[16:19], v9, s[4:7], s37 offen offset:1024
v_smfmac_f32_16x16x64_bf16 v[40:43], v[60:63], a[56:63], v0
s_waitcnt lgkmcnt(2)
v_smfmac_f32_16x16x64_bf16 v[28:31], v[64:67], v[192:199], v0
ds_read_b128 v[48:51], v2 offset:3072
v_smfmac_f32_16x16x64_bf16 v[20:23], v[64:67], v[80:87], v0
ds_read_b128 v[44:47], v2 offset:2048
v_smfmac_f32_16x16x64_bf16 v[32:35], v[64:67], v[200:207], v0
buffer_load_dwordx4 v[52:55], v1, s[4:7], s37 offen offset:2048
v_bitop3_b32 v6, v60, v64, s35 bitop3:0x7e
s_waitcnt lgkmcnt(2)
v_bitop3_b32 v76, v68, v72, s35 bitop3:0x7e
v_bitop3_b32 v6, v6, v76, 1 bitop3:0xa8
v_smfmac_f32_16x16x64_bf16 v[24:27], v[64:67], v[88:95], v0
s_waitcnt lgkmcnt(0)
v_smfmac_f32_16x16x64_bf16 v[24:27], v[60:63], v[44:51], v0
buffer_load_dwordx4 v[56:59], v1, s[4:7], s37 offen offset:3072
v_smfmac_f32_16x16x64_bf16 v[40:43], v[64:67], a[72:79], v0
v_smfmac_f32_16x16x64_bf16 v[36:39], v[64:67], a[64:71], v0
ds_read_b128 v[44:47], v2 offset:4096
v_cmp_ne_u32 vcc, 0, v6
v_smfmac_f32_16x16x64_bf16 v[20:23], v[68:71], v[96:103], v0
ds_read_b128 v[48:51], v2 offset:5120
v_smfmac_f32_16x16x64_bf16 v[24:27], v[68:71], v[104:111], v0
s_cbranch_vccnz L_ra0_w0f
s_waitcnt vmcnt(4)
s_barrier
ds_read_b32 v6, v77 offset:8192
v_smfmac_f32_16x16x64_bf16 v[28:31], v[68:71], v[208:215], v0
s_mov_b32 m0, 0
ds_read_b128 v[60:63], v1 offset:6144
s_waitcnt lgkmcnt(2)
v_smfmac_f32_16x16x64_bf16 v[20:23], v[72:75], v[44:51], v0
buffer_load_dword v78, s[4:7], s39 offen lds
ds_read_b128 v[76:79], v1 offset:5120
v_smfmac_f32_16x16x64_bf16 v[28:31], v[72:75], v[224:231], v0
ds_read_b128 v[64:67], v1 offset:7168
ds_read_b128 v[44:47], v2 offset:6144
v_smfmac_f32_16x16x64_bf16 v[32:35], v[68:71], v[216:223], v0
v_smfmac_f32_16x16x64_bf16 v[36:39], v[68:71], a[80:87], v0
ds_read_b128 v[48:51], v2 offset:7168
s_waitcnt lgkmcnt(4)
v_bitop3_b32 v6, v6, v60, s35 bitop3:0x7e
v_smfmac_f32_16x16x64_bf16 v[40:43], v[68:71], a[88:95], v0
ds_read_b128 v[68:71], v1 offset:8192
v_smfmac_f32_16x16x64_bf16 v[32:35], v[72:75], v[232:239], v0
s_waitcnt lgkmcnt(3)
v_bitop3_b32 v6, v6, v64, s35 bitop3:0xf6
v_bitop3_b32 v6, v6, v76, s35 bitop3:0xf6
v_and_b32 v6, 1, v6
s_waitcnt lgkmcnt(1)
v_smfmac_f32_16x16x64_bf16 v[24:27], v[72:75], v[44:51], v0
ds_read_b128 v[44:47], v2 offset:8192
v_cmp_ne_u32 vcc, 0, v6
v_smfmac_f32_16x16x64_bf16 v[36:39], v[72:75], a[96:103], v0
ds_read_b128 v[48:51], v2 offset:9216
v_smfmac_f32_16x16x64_bf16 v[40:43], v[72:75], a[104:111], v0
ds_read_b128 v[72:75], v1 offset:9216
s_cbranch_vccnz L_ra1_w0f
L_a1_w0f:
v_smfmac_f32_16x16x64_bf16 v[20:23], v[60:63], v[112:119], v0
v_smfmac_f32_16x16x64_bf16 v[20:23], v[64:67], v[128:135], v0
s_waitcnt lgkmcnt(1)
v_smfmac_f32_16x16x64_bf16 v[20:23], v[76:79], v[44:51], v0
ds_read_b128 v[48:51], v2 offset:11264
v_bfe_u32 v6, v1, 5, 1
v_mad_i32_i24 v6, v6, s55, v1
v_smfmac_f32_16x16x64_bf16 v[20:23], v[68:71], v[144:151], v0
s_waitcnt lgkmcnt(1)
v_smfmac_f32_16x16x64_bf16 v[20:23], v[72:75], v[160:167], v0
ds_read_b128 v[44:47], v2 offset:10240
v_smfmac_f32_16x16x64_bf16 v[24:27], v[60:63], v[120:127], v0
v_smfmac_f32_16x16x64_bf16 v[24:27], v[64:67], v[136:143], v0
v_smfmac_f32_16x16x64_bf16 v[24:27], v[68:71], v[152:159], v0
v_add_f32 v21, v21, v23
v_smfmac_f32_16x16x64_bf16 v[24:27], v[72:75], v[168:175], v0
s_waitcnt lgkmcnt(0)
v_smfmac_f32_16x16x64_bf16 v[24:27], v[76:79], v[44:51], v0
ds_read_b128 v[44:47], v2 offset:12288
v_add_f32 v20, v20, v22
v_cvt_pk_bf16_f32 v22, v20, v21
v_smfmac_f32_16x16x64_bf16 v[28:31], v[76:79], v[240:247], v0
v_smfmac_f32_16x16x64_bf16 v[28:31], v[64:67], a[0:7], v0
ds_read_b128 v[48:51], v2 offset:13312
v_add_f32 v25, v25, v27
v_add_f32 v24, v24, v26
v_cvt_pk_bf16_f32 v23, v24, v25
v_smfmac_f32_16x16x64_bf16 v[28:31], v[72:75], a[32:39], v0
ds_write_b64 v3, v[22:23] offset:10240
v_smfmac_f32_16x16x64_bf16 v[28:31], v[68:71], a[16:23], v0
s_waitcnt vmcnt(1)
v_smfmac_f32_16x16x64_bf16 v[32:35], v[76:79], v[248:255], v0
s_waitcnt lgkmcnt(1)
v_smfmac_f32_16x16x64_bf16 v[28:31], v[60:63], v[44:51], v0
ds_read_b128 v[44:47], v2 offset:14336
ds_read_b128 v[48:51], v2 offset:15360
v_smfmac_f32_16x16x64_bf16 v[32:35], v[64:67], a[8:15], v0
s_waitcnt lgkmcnt(2)
s_barrier
ds_read_b64_tr_b16 v[20:21], v4 offset:10240
v_smfmac_f32_16x16x64_bf16 v[32:35], v[68:71], a[24:31], v0
ds_read_b64_tr_b16 v[22:23], v4 offset:10752
v_add_f32 v29, v29, v31
v_smfmac_f32_16x16x64_bf16 v[32:35], v[72:75], a[40:47], v0
ds_read_b64_tr_b16 v[24:25], v4 offset:11264
ds_read_b64_tr_b16 v[26:27], v4 offset:11776
s_waitcnt lgkmcnt(4)
v_smfmac_f32_16x16x64_bf16 v[32:35], v[60:63], v[44:51], v0
ds_read_b128 v[48:51], v2 offset:19456
s_waitcnt lgkmcnt(3)
v_mfma_f32_16x16x32_bf16 v[12:15], v[12:15], v[20:23], 0
ds_read_b128 v[44:47], v2 offset:18432
v_add_f32 v28, v28, v30
s_waitcnt lgkmcnt(2)
v_mfma_f32_16x16x32_bf16 v[12:15], v[16:19], v[24:27], v[12:15]
v_add_f32 v32, v32, v34
v_add_f32 v33, v33, v35
v_cvt_pk_bf16_f32 v31, v32, v33
v_cvt_pk_bf16_f32 v30, v28, v29
v_smfmac_f32_16x16x64_bf16 v[36:39], v[76:79], a[112:119], v0
ds_write_b64 v3, v[30:31] offset:12288
v_add_f32_dpp v12, v14, v12 quad_perm:[2,3,0,1] row_mask:0xf bank_mask:0xf
v_exp_f32 v14, v12
v_add_f32_dpp v13, v15, v13 quad_perm:[2,3,0,1] row_mask:0xf bank_mask:0xf
v_exp_f32 v15, v13
s_nop 0
v_cvt_pk_bf16_f32 v14, v14, v15
v_smfmac_f32_16x16x64_bf16 v[40:43], v[76:79], a[120:127], v0
ds_write_b32 v5, v14 offset:14368
s_waitcnt lgkmcnt(2)
v_smfmac_f32_16x16x64_bf16 v[40:43], v[72:75], v[44:51], v0
ds_read_b128 v[44:47], v2 offset:16384
s_waitcnt lgkmcnt(2)
s_barrier
ds_read_b64_tr_b16 v[28:29], v4 offset:12288
v_smfmac_f32_16x16x64_bf16 v[36:39], v[60:63], a[128:135], v0
ds_read_b64_tr_b16 v[30:31], v4 offset:12800
ds_read_b64_tr_b16 v[32:33], v4 offset:13312
v_smfmac_f32_16x16x64_bf16 v[40:43], v[60:63], a[136:143], v0
ds_read_b64_tr_b16 v[34:35], v4 offset:13824
v_mov_b64 v[76:77], s[52:53]
s_waitcnt lgkmcnt(2)
v_mfma_f32_16x16x32_bf16 v[28:31], v[28:31], v[20:23], 0
s_barrier
ds_read_b128 v[16:19], v1 offset:14368
s_waitcnt lgkmcnt(1)
v_mfma_f32_16x16x32_bf16 v[28:31], v[32:35], v[24:27], v[28:31]
ds_read_b128 v[60:63], v1 offset:14336
v_mov_b64 v[14:15], s[0:1]
v_smfmac_f32_16x16x64_bf16 v[40:43], v[64:67], a[152:159], v0
ds_read_b128 v[48:51], v2 offset:17408
v_mov_b64 v[78:79], s[52:53]
v_smfmac_f32_16x16x64_bf16 v[40:43], v[68:71], a[168:175], v0
v_add_f32_dpp v28, v30, v28 quad_perm:[2,3,0,1] row_mask:0xf bank_mask:0xf
v_smfmac_f32_16x16x64_bf16 v[36:39], v[64:67], a[144:151], v0
ds_read_b128 v[64:67], v2 offset:25600
v_add_f32_dpp v29, v31, v29 quad_perm:[2,3,0,1] row_mask:0xf bank_mask:0xf
s_waitcnt lgkmcnt(1)
v_smfmac_f32_16x16x64_bf16 v[36:39], v[72:75], v[44:51], v0
ds_read_b128 v[72:75], v2 offset:29696
v_mul_f32 v28, s50, v28
v_smfmac_f32_16x16x64_bf16 v[36:39], v[68:71], a[160:167], v0
ds_read_b128 v[68:71], v2 offset:28672
v_cvt_pk_bf16_f32 v40, v40, v41
v_mfma_f32_16x16x32_bf16 v[32:35], v[76:79], v[16:19], 0
v_exp_f32 v30, v28
ds_read_b128 v[44:47], v2 offset:20480
v_mfma_f32_16x16x32_bf16 v[20:23], v[52:55], v[16:19], 0
v_mul_f32 v29, s50, v29
v_cvt_pk_bf16_f32 v41, v42, v43
v_cvt_pk_bf16_f32 v43, v38, v39
v_mov_b64 v[76:77], 0
v_exp_f32 v31, v29
v_mfma_f32_16x16x32_bf16 v[20:23], v[56:59], v[60:63], v[20:23]
v_cvt_pk_bf16_f32 v30, v30, v31
v_cndmask_b32_e64 v26, 0, v30, s[56:57]
v_cndmask_b32_e64 v27, 0, v30, s[56:57]
s_nop 0
v_mov_b32_dpp v24, v26 quad_perm:[2,3,0,1] row_mask:0xf bank_mask:0xf
v_mfma_f32_16x16x16_bf16 v[32:35], v[14:15], v[26:27], v[32:35]
v_mov_b32_dpp v25, v26 quad_perm:[2,3,0,1] row_mask:0xf bank_mask:0xf
v_cvt_pk_bf16_f32 v42, v36, v37
s_nop 1
v_mfma_f32_16x16x32_bf16 v[20:23], v[40:43], v[24:27], v[20:23]
ds_read_b128 v[60:63], v2 offset:24576
ds_read_b128 v[48:51], v2 offset:21504
v_mov_b64 v[78:79], 0
v_rcp_f32 v33, v32
v_mov_b64 v[36:37], 0
v_min_f32 v32, v32, v33
v_cmp_nlt_f32 vcc, s2, v32
v_mul_f32_dpp v23, v33, v23 quad_perm:[0,1,0,1] row_mask:0xf bank_mask:0xf
v_mul_f32_dpp v21, v33, v21 quad_perm:[0,1,0,1] row_mask:0xf bank_mask:0xf
v_mul_f32_dpp v22, v33, v22 quad_perm:[0,1,0,1] row_mask:0xf bank_mask:0xf
v_mul_f32_dpp v20, v33, v20 quad_perm:[0,1,0,1] row_mask:0xf bank_mask:0xf
v_cvt_pk_bf16_f32 v20, v20, v21
v_cvt_pk_bf16_f32 v21, v22, v23
ds_write_b64 v6, v[20:21] offset:5120
s_and_b64 vcc, vcc, s[56:57]
s_cbranch_scc1 L_mx_w0f
L_mxb_w0f:
v_mov_b64 v[38:39], 0
v_mov_b32_dpp v19, v21 quad_perm:[2,3,2,3] row_mask:0xf bank_mask:0xf
v_mov_b32_dpp v16, v20 quad_perm:[0,1,0,1] row_mask:0xf bank_mask:0xf
v_mov_b32_dpp v18, v20 quad_perm:[2,3,2,3] row_mask:0xf bank_mask:0xf
v_mov_b32_dpp v17, v21 quad_perm:[0,1,0,1] row_mask:0xf bank_mask:0xf
v_mov_b64 v[24:25], 0
v_mov_b64 v[26:27], 0
v_smfmac_f32_16x16x64_bf16 v[76:79], v[16:19], a[176:183], v0
s_waitcnt lgkmcnt(0)
s_barrier
v_mov_b64 v[32:33], 0
ds_read_b128 v[12:15], v7 offset:7168
ds_read_b128 v[52:55], v7 offset:6144
v_smfmac_f32_16x16x64_bf16 v[36:39], v[16:19], v[44:51], v0
ds_read_b128 v[48:51], v2 offset:23552
ds_read_b128 v[56:59], v7 offset:8192
v_mov_b64 v[30:31], 0
v_mov_b64 v[34:35], 0
v_smfmac_f32_16x16x64_bf16 v[24:27], v[16:19], v[60:67], v0
ds_read_b128 v[44:47], v2 offset:22528
v_smfmac_f32_16x16x64_bf16 v[32:35], v[16:19], v[68:75], v0
ds_read_b128 v[68:71], v2 offset:30720
s_waitcnt lgkmcnt(5)
v_smfmac_f32_16x16x64_bf16 v[76:79], v[12:15], a[184:191], v0
ds_read_b128 v[60:63], v2 offset:26624
s_waitcnt lgkmcnt(5)
v_smfmac_f32_16x16x64_bf16 v[76:79], v[52:55], a[192:199], v0
ds_read_b128 v[64:67], v2 offset:27648
s_waitcnt lgkmcnt(4)
v_smfmac_f32_16x16x64_bf16 v[76:79], v[56:59], a[200:207], v0
v_mov_b64 v[28:29], 0
v_smfmac_f32_16x16x64_bf16 v[36:39], v[12:15], a[208:215], v0
ds_read_b128 v[72:75], v2 offset:31744
s_waitcnt lgkmcnt(4)
v_smfmac_f32_16x16x64_bf16 v[36:39], v[52:55], v[44:51], v0
ds_read_b128 v[44:47], v2 offset:32768
v_cvt_pk_bf16_f32 v77, v77, v79
v_cvt_pk_bf16_f32 v76, v76, v78
v_bfi_b32 v76, 1, s35, v76
v_smfmac_f32_16x16x64_bf16 v[36:39], v[56:59], a[216:223], v0
v_smfmac_f32_16x16x64_bf16 v[24:27], v[12:15], a[224:231], v0
buffer_store_dwordx2 v[76:77], v8, s[4:7], s42 offen
s_waitcnt lgkmcnt(2)
v_smfmac_f32_16x16x64_bf16 v[24:27], v[52:55], v[60:67], v0
ds_read_b128 v[48:51], v2 offset:33792
ds_read_b128 v[60:63], v2 offset:36864
v_cvt_pk_bf16_f32 v36, v36, v38
v_bfi_b32 v36, 1, s35, v36
v_cvt_pk_bf16_f32 v37, v37, v39
v_smfmac_f32_16x16x64_bf16 v[24:27], v[56:59], a[232:239], v0
buffer_store_dwordx2 v[36:37], v8, s[4:7], s43 offen
ds_read_b128 v[64:67], v2 offset:37888
v_smfmac_f32_16x16x64_bf16 v[32:35], v[12:15], a[240:247], v0
ds_read_b128 v[40:43], v2 offset:35840
s_waitcnt lgkmcnt(5)
v_smfmac_f32_16x16x64_bf16 v[32:35], v[52:55], v[68:75], v0
ds_read_b128 v[72:75], v2 offset:39936
ds_read_b128 v[36:39], v2 offset:34816
v_cvt_pk_bf16_f32 v25, v25, v27
v_cvt_pk_bf16_f32 v24, v24, v26
v_bfi_b32 v24, 1, s35, v24
buffer_store_dwordx2 v[24:25], v8, s[4:7], s44 offen
v_smfmac_f32_16x16x64_bf16 v[32:35], v[56:59], a[248:255], v0
ds_read_b128 v[68:71], v2 offset:38912
s_waitcnt lgkmcnt(6)
v_smfmac_f32_16x16x64_bf16 v[28:31], v[16:19], v[44:51], v0
s_nop 3
v_cvt_pk_bf16_f32 v33, v33, v35
v_cvt_pk_bf16_f32 v32, v32, v34
v_bfi_b32 v32, 1, s35, v32
buffer_store_dwordx2 v[32:33], v8, s[4:7], s45 offen
s_waitcnt lgkmcnt(1)
v_smfmac_f32_16x16x64_bf16 v[28:31], v[52:55], v[36:43], v0
v_smfmac_f32_16x16x64_bf16 v[28:31], v[12:15], v[60:67], v0
s_waitcnt lgkmcnt(0)
v_smfmac_f32_16x16x64_bf16 v[28:31], v[56:59], v[68:75], v0
s_nop 7
v_cvt_pk_bf16_f32 v28, v28, v30
v_bfi_b32 v28, 1, s35, v28
v_cvt_pk_bf16_f32 v29, v29, v31
buffer_store_dwordx2 v[28:29], v8, s[4:7], s46 offen
s_branch L_ex_w0f
.p2align 6
L_ex_w0rf:
v_and_b32 v6, 0x70, v1
ds_read_b128 v[76:79], v6 offset:256
v_bfe_u32 v11, v1, 4, 2
v_lshrrev_b32_e64 v11, v11, 1
v_mov_b64 v[20:21], 0
v_mov_b64 v[22:23], 0
v_mov_b64 v[24:25], 0
v_mov_b64 v[26:27], 0
v_mov_b64 v[28:29], 0
v_mov_b64 v[30:31], 0
v_mov_b64 v[32:33], 0
v_mov_b64 v[34:35], 0
s_barrier
s_waitcnt vmcnt(0)
s_add_u32 s34, s34, 1
s_not_b32 s35, s35
s_not_b32 s36, s36
s_add_u32 s37, s37, 524288
s_add_u32 s39, s39, 524288
s_mul_i32 s40, s34, 10240
s_add_u32 s40, s40, 8093696
ds_read_b128 v[44:47], v2 offset:0
ds_read_b128 v[48:51], v2 offset:1024
buffer_load_dwordx4 v[60:63], v9, s[4:7], s3 offen offset:0 sc1
buffer_load_dwordx4 v[64:67], v9, s[4:7], s3 offen offset:1024 sc1
buffer_load_dwordx4 v[68:71], v9, s[4:7], s3 offen offset:2048 sc1
buffer_load_dwordx4 v[72:75], v9, s[4:7], s3 offen offset:3072 sc1
s_waitcnt lgkmcnt(2)
s_waitcnt vmcnt(3)
L_r_w0rf:
v_mfma_f32_16x16x32_bf16 v[36:39], v[60:63], v[76:79], 0
s_waitcnt vmcnt(2)
v_mfma_f32_16x16x32_bf16 v[36:39], v[64:67], v[76:79], v[36:39]
v_bitop3_b32 v40, v60, v64, s36 bitop3:0x7e
s_waitcnt vmcnt(1)
v_mfma_f32_16x16x32_bf16 v[36:39], v[68:71], v[76:79], v[36:39]
s_waitcnt vmcnt(0)
v_mfma_f32_16x16x32_bf16 v[36:39], v[72:75], v[76:79], v[36:39]
v_bitop3_b32 v41, v68, v72, s36 bitop3:0x7e
v_bitop3_b32 v40, v40, v41, 1 bitop3:0xa8
v_cmp_ne_u32 vcc, 0, v40
v_nop
v_nop
v_nop
v_nop
v_nop
v_pk_add_f32 v[36:37], v[36:37], v[38:39]
v_cvt_pk_bf16_f32 v40, v36, v37
v_bfi_b32 v40, v11, s35, v40
s_cbranch_vccnz L_rr_w0rf
buffer_store_dword v40, v10, s[4:7], 0 offen
s_cmp_eq_u32 s34, 63
v_mov_b32 v11, v40
s_cbranch_scc1 L_done_w0rf
v_and_b32 v6, 0x70, v1
v_mov_b32 v76, s34
ds_write_b32 v6, v76 offset:512
v_mov_b64 v[36:37], 0
v_mov_b64 v[38:39], 0
v_mov_b64 v[40:41], 0
v_mov_b64 v[42:43], 0
v_bfe_u32 v77, v1, 6, 1
v_lshl_add_u32 v77, v77, 3, v1
v_lshlrev_b32 v77, 1, v77
v_lshlrev_b32 v78, 3, v1
L_top_w0rf:
s_barrier
ds_read_b128 v[60:63], v1 offset:1024
s_mov_b32 m0, 5120
s_nop 0
buffer_load_dwordx4 v1, s[4:7], s48 offen offset:0 sc1 lds
s_barrier
ds_read_b128 v[64:67], v1 offset:2048
ds_read_b128 v[68:71], v1 offset:3072
ds_read_b128 v[72:75], v1 offset:4096
L_s0_w0rf:
s_waitcnt lgkmcnt(3)
v_smfmac_f32_16x16x64_bf16 v[32:35], v[60:63], v[184:191], v0
v_smfmac_f32_16x16x64_bf16 v[20:23], v[60:63], v[44:51], v0
v_smfmac_f32_16x16x64_bf16 v[36:39], v[60:63], a[48:55], v0
buffer_load_dwordx4 v[12:15], v9, s[4:7], s37 offen offset:0
v_smfmac_f32_16x16x64_bf16 v[28:31], v[60:63], v[176:183], v0
buffer_load_dwordx4 v[16:19], v9, s[4:7], s37 offen offset:1024
v_smfmac_f32_16x16x64_bf16 v[40:43], v[60:63], a[56:63], v0
s_waitcnt lgkmcnt(2)
v_smfmac_f32_16x16x64_bf16 v[28:31], v[64:67], v[192:199], v0
ds_read_b128 v[48:51], v2 offset:3072
v_smfmac_f32_16x16x64_bf16 v[20:23], v[64:67], v[80:87], v0
ds_read_b128 v[44:47], v2 offset:2048
v_smfmac_f32_16x16x64_bf16 v[32:35], v[64:67], v[200:207], v0
buffer_load_dwordx4 v[52:55], v1, s[4:7], s37 offen offset:2048
v_bitop3_b32 v6, v60, v64, s35 bitop3:0x7e
s_waitcnt lgkmcnt(2)
v_bitop3_b32 v76, v68, v72, s35 bitop3:0x7e
v_bitop3_b32 v6, v6, v76, 1 bitop3:0xa8
v_smfmac_f32_16x16x64_bf16 v[24:27], v[64:67], v[88:95], v0
s_waitcnt lgkmcnt(0)
v_smfmac_f32_16x16x64_bf16 v[24:27], v[60:63], v[44:51], v0
buffer_load_dwordx4 v[56:59], v1, s[4:7], s37 offen offset:3072
v_smfmac_f32_16x16x64_bf16 v[40:43], v[64:67], a[72:79], v0
v_smfmac_f32_16x16x64_bf16 v[36:39], v[64:67], a[64:71], v0
ds_read_b128 v[44:47], v2 offset:4096
v_cmp_ne_u32 vcc, 0, v6
v_smfmac_f32_16x16x64_bf16 v[20:23], v[68:71], v[96:103], v0
ds_read_b128 v[48:51], v2 offset:5120
v_smfmac_f32_16x16x64_bf16 v[24:27], v[68:71], v[104:111], v0
s_cbranch_vccnz L_ra0_w0rf
s_waitcnt vmcnt(4)
s_barrier
ds_read_b32 v6, v77 offset:8192
v_smfmac_f32_16x16x64_bf16 v[28:31], v[68:71], v[208:215], v0
s_mov_b32 m0, 0
ds_read_b128 v[60:63], v1 offset:6144
buffer_store_dword v11, v10, s[4:7], s40 offen sc0 sc1
s_waitcnt lgkmcnt(2)
v_smfmac_f32_16x16x64_bf16 v[20:23], v[72:75], v[44:51], v0
buffer_load_dword v78, s[4:7], s39 offen lds
ds_read_b128 v[76:79], v1 offset:5120
v_smfmac_f32_16x16x64_bf16 v[28:31], v[72:75], v[224:231], v0
ds_read_b128 v[64:67], v1 offset:7168
ds_read_b128 v[44:47], v2 offset:6144
v_smfmac_f32_16x16x64_bf16 v[32:35], v[68:71], v[216:223], v0
v_smfmac_f32_16x16x64_bf16 v[36:39], v[68:71], a[80:87], v0
ds_read_b128 v[48:51], v2 offset:7168
s_waitcnt lgkmcnt(4)
v_bitop3_b32 v6, v6, v60, s35 bitop3:0x7e
v_smfmac_f32_16x16x64_bf16 v[40:43], v[68:71], a[88:95], v0
ds_read_b128 v[68:71], v1 offset:8192
v_smfmac_f32_16x16x64_bf16 v[32:35], v[72:75], v[232:239], v0
s_waitcnt lgkmcnt(3)
v_bitop3_b32 v6, v6, v64, s35 bitop3:0xf6
v_bitop3_b32 v6, v6, v76, s35 bitop3:0xf6
v_and_b32 v6, 1, v6
s_waitcnt lgkmcnt(1)
v_smfmac_f32_16x16x64_bf16 v[24:27], v[72:75], v[44:51], v0
ds_read_b128 v[44:47], v2 offset:8192
v_cmp_ne_u32 vcc, 0, v6
v_smfmac_f32_16x16x64_bf16 v[36:39], v[72:75], a[96:103], v0
ds_read_b128 v[48:51], v2 offset:9216
v_smfmac_f32_16x16x64_bf16 v[40:43], v[72:75], a[104:111], v0
ds_read_b128 v[72:75], v1 offset:9216
s_cbranch_vccnz L_ra1_w0rf
L_a1_w0rf:
v_smfmac_f32_16x16x64_bf16 v[20:23], v[60:63], v[112:119], v0
v_smfmac_f32_16x16x64_bf16 v[20:23], v[64:67], v[128:135], v0
s_waitcnt lgkmcnt(1)
v_smfmac_f32_16x16x64_bf16 v[20:23], v[76:79], v[44:51], v0
ds_read_b128 v[48:51], v2 offset:11264
v_bfe_u32 v6, v1, 5, 1
v_mad_i32_i24 v6, v6, s55, v1
v_smfmac_f32_16x16x64_bf16 v[20:23], v[68:71], v[144:151], v0
s_waitcnt lgkmcnt(1)
v_smfmac_f32_16x16x64_bf16 v[20:23], v[72:75], v[160:167], v0
ds_read_b128 v[44:47], v2 offset:10240
v_smfmac_f32_16x16x64_bf16 v[24:27], v[60:63], v[120:127], v0
v_smfmac_f32_16x16x64_bf16 v[24:27], v[64:67], v[136:143], v0
v_smfmac_f32_16x16x64_bf16 v[24:27], v[68:71], v[152:159], v0
v_add_f32 v21, v21, v23
v_smfmac_f32_16x16x64_bf16 v[24:27], v[72:75], v[168:175], v0
s_waitcnt lgkmcnt(0)
v_smfmac_f32_16x16x64_bf16 v[24:27], v[76:79], v[44:51], v0
ds_read_b128 v[44:47], v2 offset:12288
v_add_f32 v20, v20, v22
v_cvt_pk_bf16_f32 v22, v20, v21
v_smfmac_f32_16x16x64_bf16 v[28:31], v[76:79], v[240:247], v0
v_smfmac_f32_16x16x64_bf16 v[28:31], v[64:67], a[0:7], v0
ds_read_b128 v[48:51], v2 offset:13312
v_add_f32 v25, v25, v27
v_add_f32 v24, v24, v26
v_cvt_pk_bf16_f32 v23, v24, v25
v_smfmac_f32_16x16x64_bf16 v[28:31], v[72:75], a[32:39], v0
ds_write_b64 v3, v[22:23] offset:10240
v_smfmac_f32_16x16x64_bf16 v[28:31], v[68:71], a[16:23], v0
s_waitcnt vmcnt(2)
v_smfmac_f32_16x16x64_bf16 v[32:35], v[76:79], v[248:255], v0
s_waitcnt lgkmcnt(1)
v_smfmac_f32_16x16x64_bf16 v[28:31], v[60:63], v[44:51], v0
ds_read_b128 v[44:47], v2 offset:14336
ds_read_b128 v[48:51], v2 offset:15360
v_smfmac_f32_16x16x64_bf16 v[32:35], v[64:67], a[8:15], v0
s_waitcnt lgkmcnt(2)
s_barrier
ds_read_b64_tr_b16 v[20:21], v4 offset:10240
v_smfmac_f32_16x16x64_bf16 v[32:35], v[68:71], a[24:31], v0
ds_read_b64_tr_b16 v[22:23], v4 offset:10752
v_add_f32 v29, v29, v31
v_smfmac_f32_16x16x64_bf16 v[32:35], v[72:75], a[40:47], v0
ds_read_b64_tr_b16 v[24:25], v4 offset:11264
ds_read_b64_tr_b16 v[26:27], v4 offset:11776
s_waitcnt lgkmcnt(4)
v_smfmac_f32_16x16x64_bf16 v[32:35], v[60:63], v[44:51], v0
ds_read_b128 v[48:51], v2 offset:19456
s_waitcnt lgkmcnt(3)
v_mfma_f32_16x16x32_bf16 v[12:15], v[12:15], v[20:23], 0
ds_read_b128 v[44:47], v2 offset:18432
v_add_f32 v28, v28, v30
s_waitcnt lgkmcnt(2)
v_mfma_f32_16x16x32_bf16 v[12:15], v[16:19], v[24:27], v[12:15]
v_add_f32 v32, v32, v34
v_add_f32 v33, v33, v35
v_cvt_pk_bf16_f32 v31, v32, v33
v_cvt_pk_bf16_f32 v30, v28, v29
v_smfmac_f32_16x16x64_bf16 v[36:39], v[76:79], a[112:119], v0
ds_write_b64 v3, v[30:31] offset:12288
v_add_f32_dpp v12, v14, v12 quad_perm:[2,3,0,1] row_mask:0xf bank_mask:0xf
v_exp_f32 v14, v12
v_add_f32_dpp v13, v15, v13 quad_perm:[2,3,0,1] row_mask:0xf bank_mask:0xf
v_exp_f32 v15, v13
s_nop 0
v_cvt_pk_bf16_f32 v14, v14, v15
v_smfmac_f32_16x16x64_bf16 v[40:43], v[76:79], a[120:127], v0
ds_write_b32 v5, v14 offset:14368
s_waitcnt lgkmcnt(2)
v_smfmac_f32_16x16x64_bf16 v[40:43], v[72:75], v[44:51], v0
ds_read_b128 v[44:47], v2 offset:16384
s_waitcnt lgkmcnt(2)
s_barrier
ds_read_b64_tr_b16 v[28:29], v4 offset:12288
v_smfmac_f32_16x16x64_bf16 v[36:39], v[60:63], a[128:135], v0
ds_read_b64_tr_b16 v[30:31], v4 offset:12800
ds_read_b64_tr_b16 v[32:33], v4 offset:13312
v_smfmac_f32_16x16x64_bf16 v[40:43], v[60:63], a[136:143], v0
ds_read_b64_tr_b16 v[34:35], v4 offset:13824
v_mov_b64 v[76:77], s[52:53]
s_waitcnt lgkmcnt(2)
v_mfma_f32_16x16x32_bf16 v[28:31], v[28:31], v[20:23], 0
s_barrier
ds_read_b128 v[16:19], v1 offset:14368
s_waitcnt lgkmcnt(1)
v_mfma_f32_16x16x32_bf16 v[28:31], v[32:35], v[24:27], v[28:31]
ds_read_b128 v[60:63], v1 offset:14336
v_mov_b64 v[14:15], s[0:1]
v_smfmac_f32_16x16x64_bf16 v[40:43], v[64:67], a[152:159], v0
ds_read_b128 v[48:51], v2 offset:17408
v_mov_b64 v[78:79], s[52:53]
v_smfmac_f32_16x16x64_bf16 v[40:43], v[68:71], a[168:175], v0
v_add_f32_dpp v28, v30, v28 quad_perm:[2,3,0,1] row_mask:0xf bank_mask:0xf
v_smfmac_f32_16x16x64_bf16 v[36:39], v[64:67], a[144:151], v0
ds_read_b128 v[64:67], v2 offset:25600
v_add_f32_dpp v29, v31, v29 quad_perm:[2,3,0,1] row_mask:0xf bank_mask:0xf
s_waitcnt lgkmcnt(1)
v_smfmac_f32_16x16x64_bf16 v[36:39], v[72:75], v[44:51], v0
ds_read_b128 v[72:75], v2 offset:29696
v_mul_f32 v28, s50, v28
v_smfmac_f32_16x16x64_bf16 v[36:39], v[68:71], a[160:167], v0
ds_read_b128 v[68:71], v2 offset:28672
v_cvt_pk_bf16_f32 v40, v40, v41
v_mfma_f32_16x16x32_bf16 v[32:35], v[76:79], v[16:19], 0
v_exp_f32 v30, v28
ds_read_b128 v[44:47], v2 offset:20480
v_mfma_f32_16x16x32_bf16 v[20:23], v[52:55], v[16:19], 0
v_mul_f32 v29, s50, v29
v_cvt_pk_bf16_f32 v41, v42, v43
v_cvt_pk_bf16_f32 v43, v38, v39
v_mov_b64 v[76:77], 0
v_exp_f32 v31, v29
v_mfma_f32_16x16x32_bf16 v[20:23], v[56:59], v[60:63], v[20:23]
v_cvt_pk_bf16_f32 v30, v30, v31
v_cndmask_b32_e64 v26, 0, v30, s[56:57]
v_cndmask_b32_e64 v27, 0, v30, s[56:57]
s_nop 0
v_mov_b32_dpp v24, v26 quad_perm:[2,3,0,1] row_mask:0xf bank_mask:0xf
v_mfma_f32_16x16x16_bf16 v[32:35], v[14:15], v[26:27], v[32:35]
v_mov_b32_dpp v25, v26 quad_perm:[2,3,0,1] row_mask:0xf bank_mask:0xf
v_cvt_pk_bf16_f32 v42, v36, v37
s_nop 1
v_mfma_f32_16x16x32_bf16 v[20:23], v[40:43], v[24:27], v[20:23]
ds_read_b128 v[60:63], v2 offset:24576
ds_read_b128 v[48:51], v2 offset:21504
v_mov_b64 v[78:79], 0
v_rcp_f32 v33, v32
v_mov_b64 v[36:37], 0
v_min_f32 v32, v32, v33
v_cmp_nlt_f32 vcc, s2, v32
v_mul_f32_dpp v23, v33, v23 quad_perm:[0,1,0,1] row_mask:0xf bank_mask:0xf
v_mul_f32_dpp v21, v33, v21 quad_perm:[0,1,0,1] row_mask:0xf bank_mask:0xf
v_mul_f32_dpp v22, v33, v22 quad_perm:[0,1,0,1] row_mask:0xf bank_mask:0xf
v_mul_f32_dpp v20, v33, v20 quad_perm:[0,1,0,1] row_mask:0xf bank_mask:0xf
v_cvt_pk_bf16_f32 v20, v20, v21
v_cvt_pk_bf16_f32 v21, v22, v23
ds_write_b64 v6, v[20:21] offset:5120
s_and_b64 vcc, vcc, s[56:57]
s_cbranch_scc1 L_mx_w0rf
L_mxb_w0rf:
v_mov_b64 v[38:39], 0
v_mov_b32_dpp v19, v21 quad_perm:[2,3,2,3] row_mask:0xf bank_mask:0xf
v_mov_b32_dpp v16, v20 quad_perm:[0,1,0,1] row_mask:0xf bank_mask:0xf
v_mov_b32_dpp v18, v20 quad_perm:[2,3,2,3] row_mask:0xf bank_mask:0xf
v_mov_b32_dpp v17, v21 quad_perm:[0,1,0,1] row_mask:0xf bank_mask:0xf
v_mov_b64 v[24:25], 0
v_mov_b64 v[26:27], 0
v_smfmac_f32_16x16x64_bf16 v[76:79], v[16:19], a[176:183], v0
s_waitcnt lgkmcnt(0)
s_barrier
v_mov_b64 v[32:33], 0
ds_read_b128 v[12:15], v7 offset:7168
ds_read_b128 v[52:55], v7 offset:6144
v_smfmac_f32_16x16x64_bf16 v[36:39], v[16:19], v[44:51], v0
ds_read_b128 v[48:51], v2 offset:23552
ds_read_b128 v[56:59], v7 offset:8192
v_mov_b64 v[30:31], 0
v_mov_b64 v[34:35], 0
v_smfmac_f32_16x16x64_bf16 v[24:27], v[16:19], v[60:67], v0
ds_read_b128 v[44:47], v2 offset:22528
v_smfmac_f32_16x16x64_bf16 v[32:35], v[16:19], v[68:75], v0
ds_read_b128 v[68:71], v2 offset:30720
s_waitcnt lgkmcnt(5)
v_smfmac_f32_16x16x64_bf16 v[76:79], v[12:15], a[184:191], v0
ds_read_b128 v[60:63], v2 offset:26624
s_waitcnt lgkmcnt(5)
v_smfmac_f32_16x16x64_bf16 v[76:79], v[52:55], a[192:199], v0
ds_read_b128 v[64:67], v2 offset:27648
s_waitcnt lgkmcnt(4)
v_smfmac_f32_16x16x64_bf16 v[76:79], v[56:59], a[200:207], v0
v_mov_b64 v[28:29], 0
v_smfmac_f32_16x16x64_bf16 v[36:39], v[12:15], a[208:215], v0
ds_read_b128 v[72:75], v2 offset:31744
s_waitcnt lgkmcnt(4)
v_smfmac_f32_16x16x64_bf16 v[36:39], v[52:55], v[44:51], v0
ds_read_b128 v[44:47], v2 offset:32768
v_cvt_pk_bf16_f32 v77, v77, v79
v_cvt_pk_bf16_f32 v76, v76, v78
v_bfi_b32 v76, 1, s35, v76
v_smfmac_f32_16x16x64_bf16 v[36:39], v[56:59], a[216:223], v0
v_smfmac_f32_16x16x64_bf16 v[24:27], v[12:15], a[224:231], v0
buffer_store_dwordx2 v[76:77], v8, s[4:7], s42 offen
s_waitcnt lgkmcnt(2)
v_smfmac_f32_16x16x64_bf16 v[24:27], v[52:55], v[60:67], v0
ds_read_b128 v[48:51], v2 offset:33792
ds_read_b128 v[60:63], v2 offset:36864
v_cvt_pk_bf16_f32 v36, v36, v38
v_bfi_b32 v36, 1, s35, v36
v_cvt_pk_bf16_f32 v37, v37, v39
v_smfmac_f32_16x16x64_bf16 v[24:27], v[56:59], a[232:239], v0
buffer_store_dwordx2 v[36:37], v8, s[4:7], s43 offen
ds_read_b128 v[64:67], v2 offset:37888
v_smfmac_f32_16x16x64_bf16 v[32:35], v[12:15], a[240:247], v0
ds_read_b128 v[40:43], v2 offset:35840
s_waitcnt lgkmcnt(5)
v_smfmac_f32_16x16x64_bf16 v[32:35], v[52:55], v[68:75], v0
ds_read_b128 v[72:75], v2 offset:39936
ds_read_b128 v[36:39], v2 offset:34816
v_cvt_pk_bf16_f32 v25, v25, v27
v_cvt_pk_bf16_f32 v24, v24, v26
v_bfi_b32 v24, 1, s35, v24
buffer_store_dwordx2 v[24:25], v8, s[4:7], s44 offen
v_smfmac_f32_16x16x64_bf16 v[32:35], v[56:59], a[248:255], v0
ds_read_b128 v[68:71], v2 offset:38912
s_waitcnt lgkmcnt(6)
v_smfmac_f32_16x16x64_bf16 v[28:31], v[16:19], v[44:51], v0
s_nop 3
v_cvt_pk_bf16_f32 v33, v33, v35
v_cvt_pk_bf16_f32 v32, v32, v34
v_bfi_b32 v32, 1, s35, v32
buffer_store_dwordx2 v[32:33], v8, s[4:7], s45 offen
s_waitcnt lgkmcnt(1)
v_smfmac_f32_16x16x64_bf16 v[28:31], v[52:55], v[36:43], v0
v_smfmac_f32_16x16x64_bf16 v[28:31], v[12:15], v[60:67], v0
s_waitcnt lgkmcnt(0)
v_smfmac_f32_16x16x64_bf16 v[28:31], v[56:59], v[68:75], v0
s_nop 7
v_cvt_pk_bf16_f32 v28, v28, v30
v_bfi_b32 v28, 1, s35, v28
v_cvt_pk_bf16_f32 v29, v29, v31
buffer_store_dwordx2 v[28:29], v8, s[4:7], s46 offen
s_branch L_ex_w0rf
.p2align 6
L_ex_w1rf:
v_and_b32 v6, 0x70, v1
ds_read_b128 v[76:79], v6 offset:256
v_bfe_u32 v11, v1, 4, 2
v_lshrrev_b32_e64 v11, v11, 1
v_mov_b64 v[20:21], 0
v_mov_b64 v[22:23], 0
v_mov_b64 v[24:25], 0
v_mov_b64 v[26:27], 0
v_mov_b64 v[28:29], 0
v_mov_b64 v[30:31], 0
v_mov_b64 v[32:33], 0
v_mov_b64 v[34:35], 0
ds_read_b128 v[44:47], v2 offset:0
ds_read_b128 v[48:51], v2 offset:1024
s_barrier
s_waitcnt vmcnt(1)
s_add_u32 s34, s34, 1
s_not_b32 s35, s35
s_not_b32 s36, s36
s_add_u32 s37, s37, 524288
s_mul_i32 s40, s34, 10240
s_add_u32 s40, s40, 8093696
buffer_load_dwordx4 v[60:63], v9, s[4:7], s3 offen offset:0 sc1
buffer_load_dwordx4 v[64:67], v9, s[4:7], s3 offen offset:1024 sc1
buffer_load_dwordx4 v[68:71], v9, s[4:7], s3 offen offset:2048 sc1
buffer_load_dwordx4 v[72:75], v9, s[4:7], s3 offen offset:3072 sc1
s_waitcnt lgkmcnt(2)
s_waitcnt vmcnt(3)
L_r_w1rf:
v_mfma_f32_16x16x32_bf16 v[36:39], v[60:63], v[76:79], 0
s_waitcnt vmcnt(2)
v_mfma_f32_16x16x32_bf16 v[36:39], v[64:67], v[76:79], v[36:39]
v_bitop3_b32 v40, v60, v64, s36 bitop3:0x7e
s_waitcnt vmcnt(1)
v_mfma_f32_16x16x32_bf16 v[36:39], v[68:71], v[76:79], v[36:39]
s_waitcnt vmcnt(0)
v_mfma_f32_16x16x32_bf16 v[36:39], v[72:75], v[76:79], v[36:39]
v_bitop3_b32 v41, v68, v72, s36 bitop3:0x7e
v_bitop3_b32 v40, v40, v41, 1 bitop3:0xa8
v_cmp_ne_u32 vcc, 0, v40
v_nop
v_nop
v_nop
v_nop
v_nop
v_pk_add_f32 v[36:37], v[36:37], v[38:39]
v_cvt_pk_bf16_f32 v40, v36, v37
v_bfi_b32 v40, v11, s35, v40
s_cbranch_vccnz L_rr_w1rf
buffer_store_dword v40, v10, s[4:7], 0 offen
s_cmp_eq_u32 s34, 63
v_mov_b32 v11, v40
s_cbranch_scc1 L_done_w1rf
v_and_b32 v6, 0x70, v1
v_mov_b32 v76, s34
ds_write_b32 v6, v76 offset:516
v_mov_b64 v[36:37], 0
v_mov_b64 v[38:39], 0
v_mov_b64 v[40:41], 0
v_mov_b64 v[42:43], 0
v_bfe_u32 v77, v1, 6, 1
v_lshl_add_u32 v77, v77, 3, v1
v_lshlrev_b32 v77, 1, v77
v_lshlrev_b32 v78, 3, v1
L_top_w1rf:
s_barrier
ds_read_b128 v[60:63], v1 offset:1024
s_mov_b32 m0, 5120
s_nop 0
buffer_load_dwordx4 v1, s[4:7], s48 offen offset:1024 sc1 lds
s_barrier
ds_read_b128 v[64:67], v1 offset:2048
ds_read_b128 v[68:71], v1 offset:3072
ds_read_b128 v[72:75], v1 offset:4096
L_s0_w1rf:
s_waitcnt lgkmcnt(3)
v_smfmac_f32_16x16x64_bf16 v[32:35], v[60:63], v[184:191], v0
v_smfmac_f32_16x16x64_bf16 v[20:23], v[60:63], v[44:51], v0
v_smfmac_f32_16x16x64_bf16 v[36:39], v[60:63], a[48:55], v0
s_waitcnt lgkmcnt(2)
v_smfmac_f32_16x16x64_bf16 v[28:31], v[64:67], v[192:199], v0
v_smfmac_f32_16x16x64_bf16 v[28:31], v[60:63], v[176:183], v0
buffer_load_dwordx4 v[12:15], v9, s[4:7], s37 offen offset:0
ds_read_b128 v[48:51], v2 offset:3072
ds_read_b128 v[44:47], v2 offset:2048
v_smfmac_f32_16x16x64_bf16 v[20:23], v[64:67], v[80:87], v0
buffer_load_dwordx4 v[16:19], v9, s[4:7], s37 offen offset:1024
v_smfmac_f32_16x16x64_bf16 v[32:35], v[64:67], v[200:207], v0
v_smfmac_f32_16x16x64_bf16 v[40:43], v[60:63], a[56:63], v0
v_bitop3_b32 v6, v60, v64, s35 bitop3:0x7e
v_smfmac_f32_16x16x64_bf16 v[24:27], v[64:67], v[88:95], v0
buffer_load_dwordx4 v[52:55], v1, s[4:7], s37 offen offset:2048
s_waitcnt lgkmcnt(0)
v_smfmac_f32_16x16x64_bf16 v[24:27], v[60:63], v[44:51], v0
v_bitop3_b32 v76, v68, v72, s35 bitop3:0x7e
v_smfmac_f32_16x16x64_bf16 v[36:39], v[64:67], a[64:71], v0
v_bitop3_b32 v6, v6, v76, 1 bitop3:0xa8
v_smfmac_f32_16x16x64_bf16 v[40:43], v[64:67], a[72:79], v0
buffer_load_dwordx4 v[56:59], v1, s[4:7], s37 offen offset:3072
ds_read_b128 v[44:47], v2 offset:4096
v_cmp_ne_u32 vcc, 0, v6
v_smfmac_f32_16x16x64_bf16 v[20:23], v[68:71], v[96:103], v0
ds_read_b128 v[48:51], v2 offset:5120
v_smfmac_f32_16x16x64_bf16 v[24:27], v[68:71], v[104:111], v0
s_cbranch_vccnz L_ra0_w1rf
s_waitcnt vmcnt(4)
s_barrier
ds_read_b32 v6, v77 offset:8192
v_smfmac_f32_16x16x64_bf16 v[28:31], v[68:71], v[208:215], v0
ds_read_b128 v[60:63], v1 offset:6144
s_waitcnt lgkmcnt(2)
v_smfmac_f32_16x16x64_bf16 v[20:23], v[72:75], v[44:51], v0
ds_read_b128 v[76:79], v1 offset:5120
ds_read_b128 v[44:47], v2 offset:6144
buffer_store_dword v11, v10, s[4:7], s40 offen sc0 sc1
v_smfmac_f32_16x16x64_bf16 v[28:31], v[72:75], v[224:231], v0
ds_read_b128 v[64:67], v1 offset:7168
v_smfmac_f32_16x16x64_bf16 v[36:39], v[68:71], a[80:87], v0
v_smfmac_f32_16x16x64_bf16 v[32:35], v[68:71], v[216:223], v0
ds_read_b128 v[48:51], v2 offset:7168
s_waitcnt lgkmcnt(4)
v_bitop3_b32 v6, v6, v60, s35 bitop3:0x7e
v_smfmac_f32_16x16x64_bf16 v[40:43], v[68:71], a[88:95], v0
ds_read_b128 v[68:71], v1 offset:8192
v_smfmac_f32_16x16x64_bf16 v[32:35], v[72:75], v[232:239], v0
s_waitcnt lgkmcnt(2)
v_bitop3_b32 v6, v6, v64, s35 bitop3:0xf6
v_bitop3_b32 v6, v6, v76, s35 bitop3:0xf6
v_and_b32 v6, 1, v6
s_waitcnt lgkmcnt(1)
v_smfmac_f32_16x16x64_bf16 v[24:27], v[72:75], v[44:51], v0
ds_read_b128 v[44:47], v2 offset:8192
v_cmp_ne_u32 vcc, 0, v6
v_smfmac_f32_16x16x64_bf16 v[36:39], v[72:75], a[96:103], v0
ds_read_b128 v[48:51], v2 offset:9216
v_smfmac_f32_16x16x64_bf16 v[40:43], v[72:75], a[104:111], v0
ds_read_b128 v[72:75], v1 offset:9216
s_cbranch_vccnz L_ra1_w1rf
L_a1_w1rf:
v_smfmac_f32_16x16x64_bf16 v[20:23], v[60:63], v[112:119], v0
v_smfmac_f32_16x16x64_bf16 v[20:23], v[64:67], v[128:135], v0
s_waitcnt lgkmcnt(1)
v_smfmac_f32_16x16x64_bf16 v[20:23], v[76:79], v[44:51], v0
ds_read_b128 v[48:51], v2 offset:11264
s_waitcnt lgkmcnt(1)
v_smfmac_f32_16x16x64_bf16 v[20:23], v[72:75], v[160:167], v0
v_bfe_u32 v6, v1, 5, 1
v_mad_i32_i24 v6, v6, s55, v1
v_smfmac_f32_16x16x64_bf16 v[20:23], v[68:71], v[144:151], v0
ds_read_b128 v[44:47], v2 offset:10240
v_smfmac_f32_16x16x64_bf16 v[24:27], v[60:63], v[120:127], v0
v_smfmac_f32_16x16x64_bf16 v[24:27], v[64:67], v[136:143], v0
v_smfmac_f32_16x16x64_bf16 v[24:27], v[68:71], v[152:159], v0
v_add_f32 v21, v21, v23
v_smfmac_f32_16x16x64_bf16 v[24:27], v[72:75], v[168:175], v0
s_waitcnt lgkmcnt(0)
v_smfmac_f32_16x16x64_bf16 v[24:27], v[76:79], v[44:51], v0
ds_read_b128 v[44:47], v2 offset:12288
v_add_f32 v20, v20, v22
v_cvt_pk_bf16_f32 v22, v20, v21
v_smfmac_f32_16x16x64_bf16 v[28:31], v[76:79], v[240:247], v0
ds_read_b128 v[48:51], v2 offset:13312
v_smfmac_f32_16x16x64_bf16 v[28:31], v[64:67], a[0:7], v0
v_add_f32 v25, v25, v27
v_add_f32 v24, v24, v26
v_cvt_pk_bf16_f32 v23, v24, v25
v_smfmac_f32_16x16x64_bf16 v[28:31], v[72:75], a[32:39], v0
ds_write_b64 v3, v[22:23] offset:10752
v_smfmac_f32_16x16x64_bf16 v[28:31], v[68:71], a[16:23], v0
v_smfmac_f32_16x16x64_bf16 v[32:35], v[76:79], v[248:255], v0
s_waitcnt vmcnt(1)
s_waitcnt lgkmcnt(1)
v_smfmac_f32_16x16x64_bf16 v[28:31], v[60:63], v[44:51], v0
ds_read_b128 v[44:47], v2 offset:14336
ds_read_b128 v[48:51], v2 offset:15360
v_smfmac_f32_16x16x64_bf16 v[32:35], v[64:67], a[8:15], v0
s_waitcnt lgkmcnt(2)
s_barrier
v_smfmac_f32_16x16x64_bf16 v[32:35], v[68:71], a[24:31], v0
ds_read_b64_tr_b16 v[20:21], v4 offset:10240
ds_read_b64_tr_b16 v[22:23], v4 offset:10752
v_add_f32 v29, v29, v31
v_smfmac_f32_16x16x64_bf16 v[32:35], v[72:75], a[40:47], v0
ds_read_b64_tr_b16 v[24:25], v4 offset:11264
ds_read_b64_tr_b16 v[26:27], v4 offset:11776
s_waitcnt lgkmcnt(4)
v_smfmac_f32_16x16x64_bf16 v[32:35], v[60:63], v[44:51], v0
ds_read_b128 v[48:51], v2 offset:19456
s_waitcnt lgkmcnt(3)
v_mfma_f32_16x16x32_bf16 v[12:15], v[12:15], v[20:23], 0
ds_read_b128 v[44:47], v2 offset:18432
v_add_f32 v28, v28, v30
s_waitcnt lgkmcnt(2)
v_mfma_f32_16x16x32_bf16 v[12:15], v[16:19], v[24:27], v[12:15]
v_add_f32 v32, v32, v34
v_add_f32 v33, v33, v35
v_cvt_pk_bf16_f32 v30, v28, v29
v_cvt_pk_bf16_f32 v31, v32, v33
v_smfmac_f32_16x16x64_bf16 v[36:39], v[76:79], a[112:119], v0
ds_write_b64 v3, v[30:31] offset:12800
v_add_f32_dpp v12, v14, v12 quad_perm:[2,3,0,1] row_mask:0xf bank_mask:0xf
v_exp_f32 v14, v12
v_add_f32_dpp v13, v15, v13 quad_perm:[2,3,0,1] row_mask:0xf bank_mask:0xf
v_exp_f32 v15, v13
s_nop 0
v_cvt_pk_bf16_f32 v14, v14, v15
v_smfmac_f32_16x16x64_bf16 v[40:43], v[76:79], a[120:127], v0
ds_write_b32 v5, v14 offset:14624
s_waitcnt lgkmcnt(1)
s_barrier
ds_read_b64_tr_b16 v[28:29], v4 offset:12288
v_smfmac_f32_16x16x64_bf16 v[36:39], v[60:63], a[128:135], v0
ds_read_b64_tr_b16 v[30:31], v4 offset:12800
ds_read_b64_tr_b16 v[32:33], v4 offset:13312
v_smfmac_f32_16x16x64_bf16 v[40:43], v[60:63], a[136:143], v0
ds_read_b64_tr_b16 v[34:35], v4 offset:13824
v_mov_b64 v[76:77], s[52:53]
v_smfmac_f32_16x16x64_bf16 v[40:43], v[72:75], v[44:51], v0
ds_read_b128 v[44:47], v2 offset:16384
s_waitcnt lgkmcnt(3)
v_mfma_f32_16x16x32_bf16 v[28:31], v[28:31], v[20:23], 0
s_barrier
ds_read_b128 v[16:19], v1 offset:14368
s_waitcnt lgkmcnt(2)
v_mfma_f32_16x16x32_bf16 v[28:31], v[32:35], v[24:27], v[28:31]
ds_read_b128 v[60:63], v1 offset:14336
v_mov_b64 v[14:15], s[0:1]
v_smfmac_f32_16x16x64_bf16 v[40:43], v[64:67], a[152:159], v0
ds_read_b128 v[48:51], v2 offset:17408
v_mov_b64 v[78:79], s[52:53]
v_smfmac_f32_16x16x64_bf16 v[40:43], v[68:71], a[168:175], v0
v_add_f32_dpp v28, v30, v28 quad_perm:[2,3,0,1] row_mask:0xf bank_mask:0xf
v_smfmac_f32_16x16x64_bf16 v[36:39], v[64:67], a[144:151], v0
ds_read_b128 v[64:67], v2 offset:27648
v_mul_f32 v28, s50, v28
v_add_f32_dpp v29, v31, v29 quad_perm:[2,3,0,1] row_mask:0xf bank_mask:0xf
v_smfmac_f32_16x16x64_bf16 v[36:39], v[68:71], a[160:167], v0
ds_read_b128 v[68:71], v2 offset:30720
s_waitcnt lgkmcnt(2)
v_smfmac_f32_16x16x64_bf16 v[36:39], v[72:75], v[44:51], v0
ds_read_b128 v[72:75], v2 offset:31744
v_mul_f32 v29, s50, v29
v_cvt_pk_bf16_f32 v40, v40, v41
v_mfma_f32_16x16x32_bf16 v[32:35], v[76:79], v[16:19], 0
v_exp_f32 v30, v28
ds_read_b128 v[44:47], v2 offset:22528
v_mfma_f32_16x16x32_bf16 v[20:23], v[52:55], v[16:19], 0
v_exp_f32 v31, v29
v_mov_b64 v[76:77], 0
v_mfma_f32_16x16x32_bf16 v[20:23], v[56:59], v[60:63], v[20:23]
v_cvt_pk_bf16_f32 v41, v42, v43
v_cvt_pk_bf16_f32 v43, v38, v39
v_cvt_pk_bf16_f32 v30, v30, v31
v_cndmask_b32_e64 v26, 0, v30, s[56:57]
v_cndmask_b32_e64 v27, 0, v30, s[56:57]
s_nop 0
v_mov_b32_dpp v24, v26 quad_perm:[2,3,0,1] row_mask:0xf bank_mask:0xf
v_mfma_f32_16x16x16_bf16 v[32:35], v[14:15], v[26:27], v[32:35]
v_cvt_pk_bf16_f32 v42, v36, v37
v_mov_b32_dpp v25, v26 quad_perm:[2,3,0,1] row_mask:0xf bank_mask:0xf
s_nop 1
v_mfma_f32_16x16x32_bf16 v[20:23], v[40:43], v[24:27], v[20:23]
ds_read_b128 v[48:51], v2 offset:23552
ds_read_b128 v[60:63], v2 offset:26624
v_mov_b64 v[78:79], 0
v_rcp_f32 v33, v32
v_mov_b64 v[36:37], 0
v_min_f32 v32, v32, v33
v_cmp_nlt_f32 vcc, s2, v32
v_mul_f32_dpp v23, v33, v23 quad_perm:[0,1,0,1] row_mask:0xf bank_mask:0xf
v_mul_f32_dpp v21, v33, v21 quad_perm:[0,1,0,1] row_mask:0xf bank_mask:0xf
v_mul_f32_dpp v22, v33, v22 quad_perm:[0,1,0,1] row_mask:0xf bank_mask:0xf
v_mul_f32_dpp v20, v33, v20 quad_perm:[0,1,0,1] row_mask:0xf bank_mask:0xf
v_cvt_pk_bf16_f32 v20, v20, v21
v_cvt_pk_bf16_f32 v21, v22, v23
ds_write_b64 v6, v[20:21] offset:6144
s_and_b64 vcc, vcc, s[56:57]
v_mov_b32_dpp v19, v21 quad_perm:[2,3,2,3] row_mask:0xf bank_mask:0xf
s_cbranch_scc1 L_mx_w1rf
L_mxb_w1rf:
v_mov_b32_dpp v16, v20 quad_perm:[0,1,0,1] row_mask:0xf bank_mask:0xf
v_mov_b32_dpp v17, v21 quad_perm:[0,1,0,1] row_mask:0xf bank_mask:0xf
v_mov_b64 v[38:39], 0
v_mov_b32_dpp v18, v20 quad_perm:[2,3,2,3] row_mask:0xf bank_mask:0xf
v_mov_b64 v[26:27], 0
v_mov_b64 v[24:25], 0
v_smfmac_f32_16x16x64_bf16 v[76:79], v[16:19], a[176:183], v0
s_waitcnt lgkmcnt(0)
s_barrier
ds_read_b128 v[12:15], v7 offset:8192
v_mov_b64 v[32:33], 0
ds_read_b128 v[52:55], v7 offset:5120
v_smfmac_f32_16x16x64_bf16 v[36:39], v[16:19], v[44:51], v0
ds_read_b128 v[48:51], v2 offset:21504
ds_read_b128 v[44:47], v2 offset:20480
ds_read_b128 v[56:59], v7 offset:7168
v_mov_b64 v[30:31], 0
v_mov_b64 v[34:35], 0
v_smfmac_f32_16x16x64_bf16 v[24:27], v[16:19], v[60:67], v0
v_smfmac_f32_16x16x64_bf16 v[32:35], v[16:19], v[68:75], v0
ds_read_b128 v[68:71], v2 offset:28672
s_waitcnt lgkmcnt(5)
v_smfmac_f32_16x16x64_bf16 v[76:79], v[12:15], a[184:191], v0
ds_read_b128 v[60:63], v2 offset:24576
s_waitcnt lgkmcnt(5)
v_smfmac_f32_16x16x64_bf16 v[76:79], v[52:55], a[192:199], v0
ds_read_b128 v[64:67], v2 offset:25600
s_waitcnt lgkmcnt(3)
v_smfmac_f32_16x16x64_bf16 v[76:79], v[56:59], a[200:207], v0
v_mov_b64 v[28:29], 0
v_smfmac_f32_16x16x64_bf16 v[36:39], v[12:15], a[208:215], v0
ds_read_b128 v[72:75], v2 offset:29696
v_smfmac_f32_16x16x64_bf16 v[36:39], v[52:55], v[44:51], v0
ds_read_b128 v[44:47], v2 offset:34816
v_cvt_pk_bf16_f32 v77, v77, v79
v_cvt_pk_bf16_f32 v76, v76, v78
v_bfi_b32 v76, 1, s35, v76
v_smfmac_f32_16x16x64_bf16 v[36:39], v[56:59], a[216:223], v0
buffer_store_dwordx2 v[76:77], v8, s[4:7], s42 offen
ds_read_b128 v[48:51], v2 offset:35840
v_smfmac_f32_16x16x64_bf16 v[24:27], v[12:15], a[224:231], v0
s_waitcnt lgkmcnt(3)
v_smfmac_f32_16x16x64_bf16 v[24:27], v[52:55], v[60:67], v0
ds_read_b128 v[60:63], v2 offset:38912
v_cvt_pk_bf16_f32 v37, v37, v39
v_cvt_pk_bf16_f32 v36, v36, v38
v_bfi_b32 v36, 1, s35, v36
v_smfmac_f32_16x16x64_bf16 v[24:27], v[56:59], a[232:239], v0
buffer_store_dwordx2 v[36:37], v8, s[4:7], s43 offen
ds_read_b128 v[64:67], v2 offset:39936
ds_read_b128 v[40:43], v2 offset:33792
v_smfmac_f32_16x16x64_bf16 v[32:35], v[12:15], a[240:247], v0
s_waitcnt lgkmcnt(5)
v_smfmac_f32_16x16x64_bf16 v[32:35], v[52:55], v[68:75], v0
ds_read_b128 v[72:75], v2 offset:37888
ds_read_b128 v[36:39], v2 offset:32768
v_cvt_pk_bf16_f32 v25, v25, v27
v_cvt_pk_bf16_f32 v24, v24, v26
v_bfi_b32 v24, 1, s35, v24
buffer_store_dwordx2 v[24:25], v8, s[4:7], s44 offen
v_smfmac_f32_16x16x64_bf16 v[32:35], v[56:59], a[248:255], v0
ds_read_b128 v[68:71], v2 offset:36864
s_waitcnt lgkmcnt(6)
v_smfmac_f32_16x16x64_bf16 v[28:31], v[16:19], v[44:51], v0
s_nop 3
v_cvt_pk_bf16_f32 v33, v33, v35
v_cvt_pk_bf16_f32 v32, v32, v34
v_bfi_b32 v32, 1, s35, v32
buffer_store_dwordx2 v[32:33], v8, s[4:7], s45 offen
s_waitcnt lgkmcnt(1)
v_smfmac_f32_16x16x64_bf16 v[28:31], v[52:55], v[36:43], v0
v_smfmac_f32_16x16x64_bf16 v[28:31], v[12:15], v[60:67], v0
s_waitcnt lgkmcnt(0)
v_smfmac_f32_16x16x64_bf16 v[28:31], v[56:59], v[68:75], v0
s_nop 7
v_cvt_pk_bf16_f32 v28, v28, v30
v_bfi_b32 v28, 1, s35, v28
v_cvt_pk_bf16_f32 v29, v29, v31
buffer_store_dwordx2 v[28:29], v8, s[4:7], s46 offen
s_branch L_ex_w1rf
.p2align 6
L_ex_w2rf:
s_add_u32 s34, s34, 1
s_not_b32 s35, s35
s_not_b32 s36, s36
v_and_b32 v6, 0x70, v1
ds_read_b128 v[76:79], v6 offset:256
v_bfe_u32 v11, v1, 4, 2
v_lshrrev_b32_e64 v11, v11, 1
v_bfe_u32 v6, v1, 2, 7
v_mov_b32 v42, s35
s_add_u32 s37, s37, 524288
s_mul_i32 s40, s34, 10240
s_add_u32 s40, s40, 8093696
s_waitcnt vmcnt(1)
buffer_load_dwordx4 v[60:63], v9, s[4:7], s3 offen offset:0 sc1
buffer_load_dwordx4 v[64:67], v9, s[4:7], s3 offen offset:1024 sc1
buffer_load_dwordx4 v[68:71], v9, s[4:7], s3 offen offset:2048 sc1
buffer_load_dwordx4 v[72:75], v9, s[4:7], s3 offen offset:3072 sc1
s_barrier
s_waitcnt lgkmcnt(0)
s_waitcnt vmcnt(3)
L_r_w2rf:
v_mfma_f32_16x16x32_bf16 v[36:39], v[60:63], v[76:79], 0
s_waitcnt vmcnt(2)
v_mfma_f32_16x16x32_bf16 v[36:39], v[64:67], v[76:79], v[36:39]
v_bitop3_b32 v40, v60, v64, s36 bitop3:0x7e
s_waitcnt vmcnt(1)
v_mfma_f32_16x16x32_bf16 v[36:39], v[68:71], v[76:79], v[36:39]
s_waitcnt vmcnt(0)
v_mfma_f32_16x16x32_bf16 v[36:39], v[72:75], v[76:79], v[36:39]
v_bitop3_b32 v41, v68, v72, s36 bitop3:0x7e
v_bitop3_b32 v40, v40, v41, 1 bitop3:0xa8
v_cmp_ne_u32 vcc, 0, v40
v_nop
v_nop
v_nop
v_nop
v_nop
v_pk_add_f32 v[36:37], v[36:37], v[38:39]
v_cvt_pk_bf16_f32 v40, v36, v37
v_bfi_b32 v40, v11, s35, v40
s_cbranch_vccnz L_rr_w2rf
buffer_store_dword v40, v10, s[4:7], 0 offen
s_cmp_eq_u32 s34, 63
v_mov_b32 v11, v40
s_cbranch_scc1 L_done_w2rf
s_cmp_lg_u32 s38, 0
s_cbranch_scc1 L_lw_w2rf
L_lwb_w2rf:
s_mov_b64 exec, 1
buffer_store_dword v42, v1, s[4:7], s33 offen
s_mov_b64 exec, -1
v_mov_b64 v[20:21], 0
v_mov_b64 v[22:23], 0
v_mov_b64 v[24:25], 0
v_mov_b64 v[26:27], 0
v_mov_b64 v[28:29], 0
v_mov_b64 v[30:31], 0
v_mov_b64 v[32:33], 0
v_mov_b64 v[34:35], 0
v_mov_b64 v[36:37], 0
v_mov_b64 v[38:39], 0
v_mov_b64 v[40:41], 0
v_mov_b64 v[42:43], 0
v_bfe_u32 v77, v1, 6, 1
v_lshl_add_u32 v77, v77, 3, v1
v_lshlrev_b32 v77, 1, v77
v_lshlrev_b32 v78, 3, v1
ds_read_b128 v[44:47], v2 offset:0
ds_read_b128 v[48:51], v2 offset:1024
v_mov_b32 v79, s36
L_sp_w2rf:
buffer_load_dword v79, v6, s[4:7], s58 offen sc1
s_sub_u32 s41, s41, 1
s_cbranch_scc1 L_exit
s_mov_b32 m0, 1024
s_nop 0
buffer_load_dwordx4 v1, s[4:7], s47 offen offset:0 sc1 lds
buffer_load_dwordx4 v1, s[4:7], s47 offen offset:1024 sc1 lds
buffer_load_dwordx4 v1, s[4:7], s47 offen offset:2048 sc1 lds
buffer_load_dwordx4 v1, s[4:7], s47 offen offset:3072 sc1 lds
s_waitcnt vmcnt(9)
v_cmp_ne_u32 vcc, s35, v79
s_cbranch_vccnz L_sp_w2rf
L_top_w2rf:
s_waitcnt vmcnt(8)
s_barrier
ds_read_b128 v[60:63], v1 offset:1024
s_mov_b32 m0, 5120
s_nop 0
buffer_load_dwordx4 v1, s[4:7], s48 offen offset:2048 sc1 lds
s_waitcnt vmcnt(6)
s_barrier
ds_read_b128 v[64:67], v1 offset:2048
ds_read_b128 v[68:71], v1 offset:3072
ds_read_b128 v[72:75], v1 offset:4096
L_s0_w2rf:
s_waitcnt lgkmcnt(3)
v_smfmac_f32_16x16x64_bf16 v[32:35], v[60:63], v[184:191], v0
v_smfmac_f32_16x16x64_bf16 v[36:39], v[60:63], a[48:55], v0
v_smfmac_f32_16x16x64_bf16 v[20:23], v[60:63], v[44:51], v0
ds_read_b128 v[48:51], v2 offset:3072
v_smfmac_f32_16x16x64_bf16 v[28:31], v[60:63], v[176:183], v0
buffer_load_dwordx4 v[12:15], v9, s[4:7], s37 offen offset:0
v_smfmac_f32_16x16x64_bf16 v[40:43], v[60:63], a[56:63], v0
s_waitcnt lgkmcnt(3)
v_smfmac_f32_16x16x64_bf16 v[28:31], v[64:67], v[192:199], v0
ds_read_b128 v[44:47], v2 offset:2048
v_smfmac_f32_16x16x64_bf16 v[20:23], v[64:67], v[80:87], v0
buffer_load_dwordx4 v[16:19], v9, s[4:7], s37 offen offset:1024
v_smfmac_f32_16x16x64_bf16 v[32:35], v[64:67], v[200:207], v0
v_bitop3_b32 v6, v60, v64, s35 bitop3:0x7e
s_waitcnt lgkmcnt(2)
v_bitop3_b32 v76, v68, v72, s35 bitop3:0x7e
v_smfmac_f32_16x16x64_bf16 v[24:27], v[64:67], v[88:95], v0
buffer_load_dwordx4 v[52:55], v1, s[4:7], s37 offen offset:2048
s_waitcnt lgkmcnt(0)
v_smfmac_f32_16x16x64_bf16 v[24:27], v[60:63], v[44:51], v0
v_smfmac_f32_16x16x64_bf16 v[36:39], v[64:67], a[64:71], v0
v_bitop3_b32 v6, v6, v76, 1 bitop3:0xa8
v_smfmac_f32_16x16x64_bf16 v[40:43], v[64:67], a[72:79], v0
ds_read_b128 v[44:47], v2 offset:4096
v_cmp_ne_u32 vcc, 0, v6
v_smfmac_f32_16x16x64_bf16 v[20:23], v[68:71], v[96:103], v0
buffer_load_dwordx4 v[56:59], v1, s[4:7], s37 offen offset:3072
ds_read_b128 v[48:51], v2 offset:5120
v_smfmac_f32_16x16x64_bf16 v[24:27], v[68:71], v[104:111], v0
s_cbranch_vccnz L_ra0_w2rf
s_waitcnt vmcnt(4)
s_barrier
ds_read_b32 v6, v77 offset:8192
v_smfmac_f32_16x16x64_bf16 v[28:31], v[68:71], v[208:215], v0
ds_read_b128 v[60:63], v1 offset:6144
ds_read_b128 v[64:67], v1 offset:7168
s_waitcnt lgkmcnt(3)
v_smfmac_f32_16x16x64_bf16 v[20:23], v[72:75], v[44:51], v0
ds_read_b128 v[76:79], v1 offset:5120
ds_read_b128 v[44:47], v2 offset:6144
buffer_store_dword v11, v10, s[4:7], s40 offen sc0 sc1
v_smfmac_f32_16x16x64_bf16 v[28:31], v[72:75], v[224:231], v0
v_smfmac_f32_16x16x64_bf16 v[32:35], v[68:71], v[216:223], v0
v_smfmac_f32_16x16x64_bf16 v[36:39], v[68:71], a[80:87], v0
ds_read_b128 v[48:51], v2 offset:7168
s_waitcnt lgkmcnt(4)
v_bitop3_b32 v6, v6, v60, s35 bitop3:0x7e
v_smfmac_f32_16x16x64_bf16 v[40:43], v[68:71], a[88:95], v0
ds_read_b128 v[68:71], v1 offset:8192
v_smfmac_f32_16x16x64_bf16 v[32:35], v[72:75], v[232:239], v0
s_waitcnt lgkmcnt(4)
v_bitop3_b32 v6, v6, v64, s35 bitop3:0xf6
s_waitcnt lgkmcnt(3)
v_bitop3_b32 v6, v6, v76, s35 bitop3:0xf6
v_and_b32 v6, 1, v6
s_waitcnt lgkmcnt(1)
v_smfmac_f32_16x16x64_bf16 v[24:27], v[72:75], v[44:51], v0
ds_read_b128 v[44:47], v2 offset:8192
v_cmp_ne_u32 vcc, 0, v6
v_smfmac_f32_16x16x64_bf16 v[36:39], v[72:75], a[96:103], v0
ds_read_b128 v[48:51], v2 offset:9216
v_smfmac_f32_16x16x64_bf16 v[40:43], v[72:75], a[104:111], v0
ds_read_b128 v[72:75], v1 offset:9216
s_cbranch_vccnz L_ra1_w2rf
L_a1_w2rf:
v_smfmac_f32_16x16x64_bf16 v[20:23], v[60:63], v[112:119], v0
v_smfmac_f32_16x16x64_bf16 v[20:23], v[64:67], v[128:135], v0
s_waitcnt lgkmcnt(1)
v_smfmac_f32_16x16x64_bf16 v[20:23], v[76:79], v[44:51], v0
ds_read_b128 v[48:51], v2 offset:11264
v_bfe_u32 v6, v1, 5, 1
v_mad_i32_i24 v6, v6, s55, v1
v_smfmac_f32_16x16x64_bf16 v[20:23], v[68:71], v[144:151], v0
s_waitcnt lgkmcnt(1)
v_smfmac_f32_16x16x64_bf16 v[20:23], v[72:75], v[160:167], v0
ds_read_b128 v[44:47], v2 offset:10240
v_smfmac_f32_16x16x64_bf16 v[24:27], v[60:63], v[120:127], v0
v_smfmac_f32_16x16x64_bf16 v[24:27], v[64:67], v[136:143], v0
v_smfmac_f32_16x16x64_bf16 v[24:27], v[68:71], v[152:159], v0
v_add_f32 v21, v21, v23
v_smfmac_f32_16x16x64_bf16 v[24:27], v[72:75], v[168:175], v0
s_waitcnt lgkmcnt(0)
v_smfmac_f32_16x16x64_bf16 v[24:27], v[76:79], v[44:51], v0
ds_read_b128 v[44:47], v2 offset:12288
v_add_f32 v20, v20, v22
v_cvt_pk_bf16_f32 v22, v20, v21
v_smfmac_f32_16x16x64_bf16 v[28:31], v[76:79], v[240:247], v0
ds_read_b128 v[48:51], v2 offset:13312
v_smfmac_f32_16x16x64_bf16 v[28:31], v[64:67], a[0:7], v0
v_add_f32 v25, v25, v27
v_add_f32 v24, v24, v26
v_cvt_pk_bf16_f32 v23, v24, v25
v_smfmac_f32_16x16x64_bf16 v[28:31], v[72:75], a[32:39], v0
ds_write_b64 v3, v[22:23] offset:11264
v_smfmac_f32_16x16x64_bf16 v[32:35], v[76:79], v[248:255], v0
s_waitcnt lgkmcnt(1)
v_smfmac_f32_16x16x64_bf16 v[28:31], v[60:63], v[44:51], v0
ds_read_b128 v[48:51], v2 offset:15360
v_smfmac_f32_16x16x64_bf16 v[28:31], v[68:71], a[16:23], v0
ds_read_b128 v[44:47], v2 offset:14336
s_waitcnt vmcnt(1)
v_smfmac_f32_16x16x64_bf16 v[32:35], v[64:67], a[8:15], v0
s_waitcnt lgkmcnt(2)
s_barrier
ds_read_b64_tr_b16 v[20:21], v4 offset:10240
v_smfmac_f32_16x16x64_bf16 v[32:35], v[68:71], a[24:31], v0
ds_read_b64_tr_b16 v[22:23], v4 offset:10752
v_add_f32 v29, v29, v31
v_smfmac_f32_16x16x64_bf16 v[32:35], v[72:75], a[40:47], v0
ds_read_b64_tr_b16 v[24:25], v4 offset:11264
ds_read_b64_tr_b16 v[26:27], v4 offset:11776
s_waitcnt lgkmcnt(4)
v_smfmac_f32_16x16x64_bf16 v[32:35], v[60:63], v[44:51], v0
ds_read_b128 v[48:51], v2 offset:19456
s_waitcnt lgkmcnt(3)
v_mfma_f32_16x16x32_bf16 v[12:15], v[12:15], v[20:23], 0
ds_read_b128 v[44:47], v2 offset:18432
v_add_f32 v28, v28, v30
s_waitcnt lgkmcnt(2)
v_mfma_f32_16x16x32_bf16 v[12:15], v[16:19], v[24:27], v[12:15]
v_add_f32 v33, v33, v35
v_add_f32 v32, v32, v34
v_cvt_pk_bf16_f32 v30, v28, v29
v_cvt_pk_bf16_f32 v31, v32, v33
v_smfmac_f32_16x16x64_bf16 v[36:39], v[76:79], a[112:119], v0
ds_write_b64 v3, v[30:31] offset:13312
v_add_f32_dpp v12, v14, v12 quad_perm:[2,3,0,1] row_mask:0xf bank_mask:0xf
v_exp_f32 v14, v12
v_add_f32_dpp v13, v15, v13 quad_perm:[2,3,0,1] row_mask:0xf bank_mask:0xf
v_exp_f32 v15, v13
s_nop 0
v_cvt_pk_bf16_f32 v14, v14, v15
v_smfmac_f32_16x16x64_bf16 v[40:43], v[76:79], a[120:127], v0
ds_write_b32 v5, v14 offset:14880
s_waitcnt lgkmcnt(2)
v_smfmac_f32_16x16x64_bf16 v[40:43], v[72:75], v[44:51], v0
ds_read_b128 v[44:47], v2 offset:16384
s_waitcnt lgkmcnt(2)
s_barrier
ds_read_b64_tr_b16 v[28:29], v4 offset:12288
v_smfmac_f32_16x16x64_bf16 v[36:39], v[60:63], a[128:135], v0
ds_read_b64_tr_b16 v[30:31], v4 offset:12800
ds_read_b64_tr_b16 v[32:33], v4 offset:13312
v_smfmac_f32_16x16x64_bf16 v[40:43], v[60:63], a[136:143], v0
ds_read_b64_tr_b16 v[34:35], v4 offset:13824
v_mov_b64 v[76:77], s[52:53]
s_waitcnt lgkmcnt(2)
v_mfma_f32_16x16x32_bf16 v[28:31], v[28:31], v[20:23], 0
s_barrier
ds_read_b128 v[16:19], v1 offset:14368
s_waitcnt lgkmcnt(1)
v_mfma_f32_16x16x32_bf16 v[28:31], v[32:35], v[24:27], v[28:31]
ds_read_b128 v[60:63], v1 offset:14336
v_mov_b64 v[14:15], s[0:1]
v_smfmac_f32_16x16x64_bf16 v[40:43], v[64:67], a[152:159], v0
ds_read_b128 v[48:51], v2 offset:17408
v_mov_b64 v[78:79], s[52:53]
v_smfmac_f32_16x16x64_bf16 v[40:43], v[68:71], a[168:175], v0
v_add_f32_dpp v28, v30, v28 quad_perm:[2,3,0,1] row_mask:0xf bank_mask:0xf
v_mul_f32 v28, s50, v28
v_smfmac_f32_16x16x64_bf16 v[36:39], v[64:67], a[144:151], v0
ds_read_b128 v[64:67], v2 offset:23552
v_add_f32_dpp v29, v31, v29 quad_perm:[2,3,0,1] row_mask:0xf bank_mask:0xf
v_smfmac_f32_16x16x64_bf16 v[36:39], v[68:71], a[160:167], v0
ds_read_b128 v[68:71], v2 offset:24576
s_waitcnt lgkmcnt(2)
v_smfmac_f32_16x16x64_bf16 v[36:39], v[72:75], v[44:51], v0
ds_read_b128 v[72:75], v2 offset:25600
v_cvt_pk_bf16_f32 v40, v40, v41
v_mfma_f32_16x16x32_bf16 v[32:35], v[76:79], v[16:19], 0
ds_read_b128 v[44:47], v2 offset:20480
v_mul_f32 v29, s50, v29
v_exp_f32 v30, v28
v_mfma_f32_16x16x32_bf16 v[20:23], v[52:55], v[16:19], 0
v_exp_f32 v31, v29
v_cvt_pk_bf16_f32 v41, v42, v43
v_cvt_pk_bf16_f32 v43, v38, v39
v_mov_b64 v[76:77], 0
v_mfma_f32_16x16x32_bf16 v[20:23], v[56:59], v[60:63], v[20:23]
v_cvt_pk_bf16_f32 v30, v30, v31
v_cndmask_b32_e64 v26, 0, v30, s[56:57]
v_cndmask_b32_e64 v27, 0, v30, s[56:57]
s_nop 0
v_mov_b32_dpp v24, v26 quad_perm:[2,3,0,1] row_mask:0xf bank_mask:0xf
v_mfma_f32_16x16x16_bf16 v[32:35], v[14:15], v[26:27], v[32:35]
v_cvt_pk_bf16_f32 v42, v36, v37
v_mov_b32_dpp v25, v26 quad_perm:[2,3,0,1] row_mask:0xf bank_mask:0xf
s_nop 1
v_mfma_f32_16x16x32_bf16 v[20:23], v[40:43], v[24:27], v[20:23]
ds_read_b128 v[60:63], v2 offset:22528
ds_read_b128 v[48:51], v2 offset:21504
v_rcp_f32 v33, v32
v_mov_b64 v[36:37], 0
v_mov_b64 v[78:79], 0
v_min_f32 v32, v32, v33
v_cmp_nlt_f32 vcc, s2, v32
v_mul_f32_dpp v23, v33, v23 quad_perm:[0,1,0,1] row_mask:0xf bank_mask:0xf
v_mul_f32_dpp v21, v33, v21 quad_perm:[0,1,0,1] row_mask:0xf bank_mask:0xf
v_mul_f32_dpp v22, v33, v22 quad_perm:[0,1,0,1] row_mask:0xf bank_mask:0xf
v_mul_f32_dpp v20, v33, v20 quad_perm:[0,1,0,1] row_mask:0xf bank_mask:0xf
v_cvt_pk_bf16_f32 v20, v20, v21
v_cvt_pk_bf16_f32 v21, v22, v23
ds_write_b64 v6, v[20:21] offset:7168
s_and_b64 vcc, vcc, s[56:57]
v_mov_b32_dpp v16, v20 quad_perm:[0,1,0,1] row_mask:0xf bank_mask:0xf
v_mov_b32_dpp v19, v21 quad_perm:[2,3,2,3] row_mask:0xf bank_mask:0xf
s_cbranch_scc1 L_mx_w2rf
L_mxb_w2rf:
v_mov_b32_dpp v18, v20 quad_perm:[2,3,2,3] row_mask:0xf bank_mask:0xf
v_mov_b64 v[38:39], 0
v_mov_b32_dpp v17, v21 quad_perm:[0,1,0,1] row_mask:0xf bank_mask:0xf
v_mov_b64 v[26:27], 0
v_mov_b64 v[24:25], 0
v_mov_b64 v[32:33], 0
v_smfmac_f32_16x16x64_bf16 v[76:79], v[16:19], a[176:183], v0
s_waitcnt lgkmcnt(0)
s_barrier
ds_read_b128 v[12:15], v7 offset:5120
ds_read_b128 v[52:55], v7 offset:8192
v_smfmac_f32_16x16x64_bf16 v[36:39], v[16:19], a[184:191], v0
ds_read_b128 v[56:59], v7 offset:6144
v_mov_b64 v[34:35], 0
v_smfmac_f32_16x16x64_bf16 v[24:27], v[16:19], a[192:199], v0
v_smfmac_f32_16x16x64_bf16 v[32:35], v[16:19], a[200:207], v0
s_waitcnt lgkmcnt(2)
v_smfmac_f32_16x16x64_bf16 v[76:79], v[12:15], a[208:215], v0
s_waitcnt lgkmcnt(1)
v_smfmac_f32_16x16x64_bf16 v[76:79], v[52:55], a[216:223], v0
s_waitcnt lgkmcnt(0)
v_smfmac_f32_16x16x64_bf16 v[76:79], v[56:59], a[224:231], v0
v_smfmac_f32_16x16x64_bf16 v[36:39], v[12:15], v[44:51], v0
ds_read_b128 v[48:51], v2 offset:27648
ds_read_b128 v[44:47], v2 offset:26624
v_smfmac_f32_16x16x64_bf16 v[36:39], v[52:55], a[232:239], v0
v_cvt_pk_bf16_f32 v77, v77, v79
v_cvt_pk_bf16_f32 v76, v76, v78
v_bfi_b32 v76, 1, s35, v76
v_smfmac_f32_16x16x64_bf16 v[36:39], v[56:59], v[60:67], v0
buffer_store_dwordx2 v[76:77], v8, s[4:7], s42 offen
ds_read_b128 v[60:63], v2 offset:28672
v_smfmac_f32_16x16x64_bf16 v[24:27], v[12:15], v[68:75], v0
ds_read_b128 v[64:67], v2 offset:29696
v_smfmac_f32_16x16x64_bf16 v[24:27], v[52:55], a[240:247], v0
ds_read_b128 v[68:71], v2 offset:30720
v_cvt_pk_bf16_f32 v36, v36, v38
v_bfi_b32 v36, 1, s35, v36
v_cvt_pk_bf16_f32 v37, v37, v39
s_waitcnt lgkmcnt(3)
v_smfmac_f32_16x16x64_bf16 v[24:27], v[56:59], v[44:51], v0
buffer_store_dwordx2 v[36:37], v8, s[4:7], s43 offen
ds_read_b128 v[72:75], v2 offset:31744
v_smfmac_f32_16x16x64_bf16 v[32:35], v[52:55], a[248:255], v0
s_waitcnt lgkmcnt(2)
v_smfmac_f32_16x16x64_bf16 v[32:35], v[12:15], v[60:67], v0
v_cvt_pk_bf16_f32 v25, v25, v27
v_cvt_pk_bf16_f32 v24, v24, v26
v_bfi_b32 v24, 1, s35, v24
buffer_store_dwordx2 v[24:25], v8, s[4:7], s44 offen
s_waitcnt lgkmcnt(0)
v_smfmac_f32_16x16x64_bf16 v[32:35], v[56:59], v[68:75], v0
s_nop 7
v_cvt_pk_bf16_f32 v33, v33, v35
v_cvt_pk_bf16_f32 v32, v32, v34
v_bfi_b32 v32, 1, s35, v32
buffer_store_dwordx2 v[32:33], v8, s[4:7], s45 offen
s_branch L_ex_w2rf
.p2align 6
L_ex_w3f:
s_add_u32 s34, s34, 1
s_not_b32 s35, s35
s_not_b32 s36, s36
s_add_u32 s37, s37, 524288
s_add_u32 s39, s39, 524288
v_mov_b64 v[20:21], 0
v_mov_b64 v[22:23], 0
v_mov_b64 v[24:25], 0
v_mov_b64 v[26:27], 0
v_mov_b64 v[28:29], 0
v_mov_b64 v[30:31], 0
v_mov_b64 v[32:33], 0
v_mov_b64 v[34:35], 0
v_mov_b64 v[36:37], 0
v_mov_b64 v[38:39], 0
v_mov_b64 v[40:41], 0
v_mov_b64 v[42:43], 0
ds_read_b128 v[44:47], v2 offset:0
ds_read_b128 v[48:51], v2 offset:1024
v_bfe_u32 v77, v1, 6, 1
v_lshl_add_u32 v77, v77, 3, v1
v_lshlrev_b32 v77, 1, v77
v_lshlrev_b32 v78, 3, v1
s_barrier
s_cmp_eq_u32 s34, 63
s_cbranch_scc1 L_done_w3f
s_add_u32 s100, s34, 1
s_lshr_b32 s100, s100, 2
s_waitcnt vmcnt(4)
L_evb_w3f:
v_max_u32 v10, v10, v11
v_bfe_u32 v11, v1, 2, 6
v_cmp_ge_u32 vcc, s100, v10
s_cbranch_vccnz L_ev_w3f
s_add_u32 s100, s34, 4
s_lshr_b32 s100, s100, 2
s_min_u32 s100, s100, 15
v_cmp_ge_u32 vcc, s100, v10
s_nop 0
s_cmp_eq_u64 vcc, 0
s_cselect_b32 s3, 268435456, s101
L_top_w3f:
s_barrier
ds_read_b128 v[60:63], v1 offset:1024
s_mov_b32 m0, 5120
s_nop 0
buffer_load_dwordx4 v1, s[4:7], s48 offen offset:3072 sc1 lds
s_barrier
ds_read_b128 v[64:67], v1 offset:2048
ds_read_b128 v[68:71], v1 offset:3072
ds_read_b128 v[72:75], v1 offset:4096
L_s0_w3f:
s_waitcnt lgkmcnt(3)
v_smfmac_f32_16x16x64_bf16 v[32:35], v[60:63], v[184:191], v0
s_mov_b32 m0, 9216
s_nop 0
buffer_load_dwordx4 v1, s[4:7], s49 offen offset:0 sc1 lds
v_smfmac_f32_16x16x64_bf16 v[20:23], v[60:63], v[44:51], v0
v_smfmac_f32_16x16x64_bf16 v[28:31], v[60:63], v[176:183], v0
s_waitcnt lgkmcnt(2)
v_smfmac_f32_16x16x64_bf16 v[28:31], v[64:67], v[192:199], v0
ds_read_b128 v[48:51], v2 offset:3072
v_smfmac_f32_16x16x64_bf16 v[36:39], v[60:63], a[48:55], v0
ds_read_b128 v[44:47], v2 offset:2048
v_smfmac_f32_16x16x64_bf16 v[40:43], v[60:63], a[56:63], v0
buffer_load_dwordx4 v[12:15], v9, s[4:7], s37 offen offset:0
v_smfmac_f32_16x16x64_bf16 v[24:27], v[64:67], v[88:95], v0
v_smfmac_f32_16x16x64_bf16 v[20:23], v[64:67], v[80:87], v0
v_bitop3_b32 v6, v60, v64, s35 bitop3:0x7e
v_smfmac_f32_16x16x64_bf16 v[32:35], v[64:67], v[200:207], v0
buffer_load_dwordx4 v[16:19], v9, s[4:7], s37 offen offset:1024
s_waitcnt lgkmcnt(0)
v_smfmac_f32_16x16x64_bf16 v[24:27], v[60:63], v[44:51], v0
v_bitop3_b32 v76, v68, v72, s35 bitop3:0x7e
v_bitop3_b32 v6, v6, v76, 1 bitop3:0xa8
v_smfmac_f32_16x16x64_bf16 v[36:39], v[64:67], a[64:71], v0
v_cmp_ne_u32 vcc, 0, v6
v_smfmac_f32_16x16x64_bf16 v[40:43], v[64:67], a[72:79], v0
buffer_load_dwordx4 v[52:55], v1, s[4:7], s37 offen offset:2048
ds_read_b128 v[44:47], v2 offset:4096
v_smfmac_f32_16x16x64_bf16 v[20:23], v[68:71], v[96:103], v0
ds_read_b128 v[48:51], v2 offset:5120
buffer_load_dwordx4 v[56:59], v1, s[4:7], s37 offen offset:3072
s_mov_b32 m0, 0
v_smfmac_f32_16x16x64_bf16 v[24:27], v[68:71], v[104:111], v0
s_cbranch_vccnz L_ra0_w3f
s_waitcnt vmcnt(4)
s_barrier
ds_read_b32 v6, v77 offset:8192
v_smfmac_f32_16x16x64_bf16 v[28:31], v[68:71], v[208:215], v0
buffer_load_dword v78, s[4:7], s39 offen lds
buffer_load_dword v11, v11, s[4:7], s3 offen sc1
v_smfmac_f32_16x16x64_bf16 v[36:39], v[68:71], a[80:87], v0
ds_read_b128 v[60:63], v1 offset:6144
v_smfmac_f32_16x16x64_bf16 v[28:31], v[72:75], v[224:231], v0
ds_read_b128 v[76:79], v1 offset:5120
s_waitcnt lgkmcnt(3)
v_smfmac_f32_16x16x64_bf16 v[20:23], v[72:75], v[44:51], v0
ds_read_b128 v[64:67], v1 offset:7168
v_smfmac_f32_16x16x64_bf16 v[32:35], v[68:71], v[216:223], v0
ds_read_b128 v[44:47], v2 offset:6144
v_smfmac_f32_16x16x64_bf16 v[40:43], v[68:71], a[88:95], v0
ds_read_b128 v[48:51], v2 offset:7168
s_waitcnt lgkmcnt(4)
v_bitop3_b32 v6, v6, v60, s35 bitop3:0x7e
ds_read_b128 v[68:71], v1 offset:8192
v_smfmac_f32_16x16x64_bf16 v[32:35], v[72:75], v[232:239], v0
s_waitcnt lgkmcnt(3)
v_bitop3_b32 v6, v6, v64, s35 bitop3:0xf6
v_bitop3_b32 v6, v6, v76, s35 bitop3:0xf6
v_and_b32 v6, 1, v6
s_waitcnt lgkmcnt(1)
v_smfmac_f32_16x16x64_bf16 v[24:27], v[72:75], v[44:51], v0
ds_read_b128 v[44:47], v2 offset:8192
v_cmp_ne_u32 vcc, 0, v6
v_smfmac_f32_16x16x64_bf16 v[36:39], v[72:75], a[96:103], v0
ds_read_b128 v[48:51], v2 offset:9216
v_smfmac_f32_16x16x64_bf16 v[40:43], v[72:75], a[104:111], v0
ds_read_b128 v[72:75], v1 offset:9216
s_cbranch_vccnz L_ra1_w3f
L_a1_w3f:
v_smfmac_f32_16x16x64_bf16 v[20:23], v[60:63], v[112:119], v0
v_smfmac_f32_16x16x64_bf16 v[20:23], v[64:67], v[128:135], v0
s_waitcnt lgkmcnt(1)
v_smfmac_f32_16x16x64_bf16 v[20:23], v[76:79], v[44:51], v0
ds_read_b128 v[48:51], v2 offset:11264
v_bfe_u32 v6, v1, 5, 1
v_mad_i32_i24 v6, v6, s55, v1
v_smfmac_f32_16x16x64_bf16 v[20:23], v[68:71], v[144:151], v0
s_waitcnt lgkmcnt(1)
v_smfmac_f32_16x16x64_bf16 v[20:23], v[72:75], v[160:167], v0
v_smfmac_f32_16x16x64_bf16 v[24:27], v[60:63], v[120:127], v0
ds_read_b128 v[44:47], v2 offset:10240
v_smfmac_f32_16x16x64_bf16 v[24:27], v[64:67], v[136:143], v0
v_smfmac_f32_16x16x64_bf16 v[24:27], v[68:71], v[152:159], v0
v_add_f32 v21, v21, v23
v_smfmac_f32_16x16x64_bf16 v[24:27], v[72:75], v[168:175], v0
s_waitcnt lgkmcnt(0)
v_smfmac_f32_16x16x64_bf16 v[24:27], v[76:79], v[44:51], v0
ds_read_b128 v[44:47], v2 offset:12288
v_add_f32 v20, v20, v22
v_cvt_pk_bf16_f32 v22, v20, v21
v_smfmac_f32_16x16x64_bf16 v[28:31], v[76:79], v[240:247], v0
ds_read_b128 v[48:51], v2 offset:13312
v_smfmac_f32_16x16x64_bf16 v[28:31], v[64:67], a[0:7], v0
v_add_f32 v25, v25, v27
v_add_f32 v24, v24, v26
v_cvt_pk_bf16_f32 v23, v24, v25
v_smfmac_f32_16x16x64_bf16 v[28:31], v[72:75], a[32:39], v0
ds_write_b64 v3, v[22:23] offset:11776
v_smfmac_f32_16x16x64_bf16 v[32:35], v[76:79], v[248:255], v0
s_waitcnt lgkmcnt(1)
v_smfmac_f32_16x16x64_bf16 v[28:31], v[60:63], v[44:51], v0
ds_read_b128 v[48:51], v2 offset:15360
v_smfmac_f32_16x16x64_bf16 v[28:31], v[68:71], a[16:23], v0
ds_read_b128 v[44:47], v2 offset:14336
s_waitcnt vmcnt(2)
v_smfmac_f32_16x16x64_bf16 v[32:35], v[64:67], a[8:15], v0
s_waitcnt lgkmcnt(2)
s_barrier
v_smfmac_f32_16x16x64_bf16 v[32:35], v[68:71], a[24:31], v0
ds_read_b64_tr_b16 v[20:21], v4 offset:10240
ds_read_b64_tr_b16 v[22:23], v4 offset:10752
v_add_f32 v29, v29, v31
v_smfmac_f32_16x16x64_bf16 v[32:35], v[72:75], a[40:47], v0
ds_read_b64_tr_b16 v[24:25], v4 offset:11264
ds_read_b64_tr_b16 v[26:27], v4 offset:11776
s_waitcnt lgkmcnt(4)
v_smfmac_f32_16x16x64_bf16 v[32:35], v[60:63], v[44:51], v0
ds_read_b128 v[48:51], v2 offset:19456
s_waitcnt lgkmcnt(3)
v_mfma_f32_16x16x32_bf16 v[12:15], v[12:15], v[20:23], 0
ds_read_b128 v[44:47], v2 offset:18432
v_add_f32 v28, v28, v30
s_waitcnt lgkmcnt(2)
v_mfma_f32_16x16x32_bf16 v[12:15], v[16:19], v[24:27], v[12:15]
v_add_f32 v32, v32, v34
v_add_f32 v33, v33, v35
v_cvt_pk_bf16_f32 v30, v28, v29
v_cvt_pk_bf16_f32 v31, v32, v33
v_smfmac_f32_16x16x64_bf16 v[36:39], v[76:79], a[112:119], v0
ds_write_b64 v3, v[30:31] offset:13824
v_add_f32_dpp v12, v14, v12 quad_perm:[2,3,0,1] row_mask:0xf bank_mask:0xf
v_exp_f32 v14, v12
v_add_f32_dpp v13, v15, v13 quad_perm:[2,3,0,1] row_mask:0xf bank_mask:0xf
v_exp_f32 v15, v13
s_nop 0
v_cvt_pk_bf16_f32 v14, v14, v15
v_smfmac_f32_16x16x64_bf16 v[40:43], v[76:79], a[120:127], v0
ds_write_b32 v5, v14 offset:15136
s_waitcnt lgkmcnt(1)
s_barrier
ds_read_b64_tr_b16 v[28:29], v4 offset:12288
v_smfmac_f32_16x16x64_bf16 v[36:39], v[60:63], a[128:135], v0
ds_read_b64_tr_b16 v[30:31], v4 offset:12800
ds_read_b64_tr_b16 v[32:33], v4 offset:13312
v_smfmac_f32_16x16x64_bf16 v[40:43], v[60:63], a[136:143], v0
ds_read_b64_tr_b16 v[34:35], v4 offset:13824
v_mov_b64 v[76:77], s[52:53]
v_smfmac_f32_16x16x64_bf16 v[40:43], v[72:75], v[44:51], v0
ds_read_b128 v[44:47], v2 offset:16384
s_waitcnt lgkmcnt(3)
v_mfma_f32_16x16x32_bf16 v[28:31], v[28:31], v[20:23], 0
s_barrier
ds_read_b128 v[16:19], v1 offset:14368
s_waitcnt lgkmcnt(2)
v_mfma_f32_16x16x32_bf16 v[28:31], v[32:35], v[24:27], v[28:31]
ds_read_b128 v[60:63], v1 offset:14336
v_mov_b64 v[14:15], s[0:1]
v_smfmac_f32_16x16x64_bf16 v[40:43], v[64:67], a[152:159], v0
ds_read_b128 v[48:51], v2 offset:17408
v_mov_b64 v[78:79], s[52:53]
v_smfmac_f32_16x16x64_bf16 v[40:43], v[68:71], a[168:175], v0
v_add_f32_dpp v28, v30, v28 quad_perm:[2,3,0,1] row_mask:0xf bank_mask:0xf
v_mul_f32 v28, s50, v28
v_smfmac_f32_16x16x64_bf16 v[36:39], v[64:67], a[144:151], v0
ds_read_b128 v[64:67], v2 offset:21504
v_add_f32_dpp v29, v31, v29 quad_perm:[2,3,0,1] row_mask:0xf bank_mask:0xf
v_smfmac_f32_16x16x64_bf16 v[36:39], v[68:71], a[160:167], v0
ds_read_b128 v[68:71], v2 offset:26624
s_waitcnt lgkmcnt(2)
v_smfmac_f32_16x16x64_bf16 v[36:39], v[72:75], v[44:51], v0
ds_read_b128 v[72:75], v2 offset:27648
v_cvt_pk_bf16_f32 v40, v40, v41
v_exp_f32 v30, v28
v_mfma_f32_16x16x32_bf16 v[32:35], v[76:79], v[16:19], 0
ds_read_b128 v[44:47], v2 offset:22528
v_mul_f32 v29, s50, v29
v_mfma_f32_16x16x32_bf16 v[20:23], v[52:55], v[16:19], 0
v_exp_f32 v31, v29
v_mfma_f32_16x16x32_bf16 v[20:23], v[56:59], v[60:63], v[20:23]
v_cvt_pk_bf16_f32 v41, v42, v43
v_cvt_pk_bf16_f32 v30, v30, v31
v_cndmask_b32_e64 v26, 0, v30, s[56:57]
v_cvt_pk_bf16_f32 v43, v38, v39
v_cndmask_b32_e64 v27, 0, v30, s[56:57]
v_mov_b32_dpp v24, v26 quad_perm:[2,3,0,1] row_mask:0xf bank_mask:0xf
v_mov_b64 v[76:77], 0
v_mfma_f32_16x16x16_bf16 v[32:35], v[14:15], v[26:27], v[32:35]
v_cvt_pk_bf16_f32 v42, v36, v37
v_mov_b32_dpp v25, v26 quad_perm:[2,3,0,1] row_mask:0xf bank_mask:0xf
s_nop 1
v_mfma_f32_16x16x32_bf16 v[20:23], v[40:43], v[24:27], v[20:23]
ds_read_b128 v[48:51], v2 offset:23552
s_nop 0
v_rcp_f32 v33, v32
ds_read_b128 v[60:63], v2 offset:20480
v_mov_b64 v[36:37], 0
v_min_f32 v32, v32, v33
v_cmp_nlt_f32 vcc, s2, v32
v_mov_b64 v[78:79], 0
v_mul_f32_dpp v23, v33, v23 quad_perm:[0,1,0,1] row_mask:0xf bank_mask:0xf
v_mul_f32_dpp v21, v33, v21 quad_perm:[0,1,0,1] row_mask:0xf bank_mask:0xf
v_mul_f32_dpp v22, v33, v22 quad_perm:[0,1,0,1] row_mask:0xf bank_mask:0xf
v_mul_f32_dpp v20, v33, v20 quad_perm:[0,1,0,1] row_mask:0xf bank_mask:0xf
v_cvt_pk_bf16_f32 v20, v20, v21
v_cvt_pk_bf16_f32 v21, v22, v23
ds_write_b64 v6, v[20:21] offset:8192
s_and_b64 vcc, vcc, s[56:57]
v_mov_b64 v[38:39], 0
s_cbranch_scc1 L_mx_w3f
L_mxb_w3f:
v_mov_b32_dpp v16, v20 quad_perm:[0,1,0,1] row_mask:0xf bank_mask:0xf
v_mov_b32_dpp v19, v21 quad_perm:[2,3,2,3] row_mask:0xf bank_mask:0xf
v_mov_b64 v[24:25], 0
v_mov_b32_dpp v18, v20 quad_perm:[2,3,2,3] row_mask:0xf bank_mask:0xf
v_mov_b32_dpp v17, v21 quad_perm:[0,1,0,1] row_mask:0xf bank_mask:0xf
v_mov_b64 v[26:27], 0
v_mov_b64 v[32:33], 0
v_smfmac_f32_16x16x64_bf16 v[76:79], v[16:19], a[176:183], v0
s_waitcnt lgkmcnt(0)
s_barrier
ds_read_b128 v[12:15], v7 offset:6144
ds_read_b128 v[52:55], v7 offset:7168
v_smfmac_f32_16x16x64_bf16 v[36:39], v[16:19], a[184:191], v0
ds_read_b128 v[56:59], v7 offset:5120
v_mov_b64 v[34:35], 0
s_nop 1
v_smfmac_f32_16x16x64_bf16 v[32:35], v[16:19], a[200:207], v0
v_smfmac_f32_16x16x64_bf16 v[24:27], v[16:19], a[192:199], v0
s_waitcnt lgkmcnt(2)
v_smfmac_f32_16x16x64_bf16 v[76:79], v[12:15], a[208:215], v0
s_waitcnt lgkmcnt(1)
v_smfmac_f32_16x16x64_bf16 v[76:79], v[52:55], a[216:223], v0
s_waitcnt lgkmcnt(0)
v_smfmac_f32_16x16x64_bf16 v[76:79], v[56:59], a[224:231], v0
v_smfmac_f32_16x16x64_bf16 v[36:39], v[12:15], v[44:51], v0
ds_read_b128 v[48:51], v2 offset:25600
ds_read_b128 v[44:47], v2 offset:24576
v_smfmac_f32_16x16x64_bf16 v[36:39], v[52:55], a[232:239], v0
v_cvt_pk_bf16_f32 v77, v77, v79
v_cvt_pk_bf16_f32 v76, v76, v78
v_bfi_b32 v76, 1, s35, v76
v_smfmac_f32_16x16x64_bf16 v[36:39], v[56:59], v[60:67], v0
buffer_store_dwordx2 v[76:77], v8, s[4:7], s42 offen
ds_read_b128 v[60:63], v2 offset:30720
v_smfmac_f32_16x16x64_bf16 v[24:27], v[12:15], v[68:75], v0
ds_read_b128 v[64:67], v2 offset:31744
v_smfmac_f32_16x16x64_bf16 v[24:27], v[52:55], a[240:247], v0
ds_read_b128 v[68:71], v2 offset:28672
v_cvt_pk_bf16_f32 v36, v36, v38
v_bfi_b32 v36, 1, s35, v36
v_cvt_pk_bf16_f32 v37, v37, v39
s_waitcnt lgkmcnt(3)
v_smfmac_f32_16x16x64_bf16 v[24:27], v[56:59], v[44:51], v0
buffer_store_dwordx2 v[36:37], v8, s[4:7], s43 offen
ds_read_b128 v[72:75], v2 offset:29696
s_nop 5
v_cvt_pk_bf16_f32 v25, v25, v27
v_cvt_pk_bf16_f32 v24, v24, v26
v_bfi_b32 v24, 1, s35, v24
v_smfmac_f32_16x16x64_bf16 v[32:35], v[52:55], a[248:255], v0
s_waitcnt lgkmcnt(2)
v_smfmac_f32_16x16x64_bf16 v[32:35], v[12:15], v[60:67], v0
buffer_store_dwordx2 v[24:25], v8, s[4:7], s44 offen
s_waitcnt lgkmcnt(0)
v_smfmac_f32_16x16x64_bf16 v[32:35], v[56:59], v[68:75], v0
s_nop 7
v_cvt_pk_bf16_f32 v33, v33, v35
v_cvt_pk_bf16_f32 v32, v32, v34
v_bfi_b32 v32, 1, s35, v32
buffer_store_dwordx2 v[32:33], v8, s[4:7], s45 offen
s_branch L_ex_w3f
.p2align 6
L_ex_w0s:
s_add_u32 s34, s34, 1
s_not_b32 s35, s35
s_not_b32 s36, s36
s_add_u32 s37, s37, 524288
s_add_u32 s39, s39, 524288
v_mov_b64 v[20:21], 0
v_mov_b64 v[22:23], 0
v_mov_b64 v[24:25], 0
v_mov_b64 v[26:27], 0
v_mov_b64 v[28:29], 0
v_mov_b64 v[30:31], 0
v_mov_b64 v[32:33], 0
v_mov_b64 v[34:35], 0
v_mov_b64 v[36:37], 0
v_mov_b64 v[38:39], 0
v_mov_b64 v[40:41], 0
v_mov_b64 v[42:43], 0
ds_read_b128 v[44:47], v2 offset:0
ds_read_b128 v[48:51], v2 offset:1024
v_bfe_u32 v77, v1, 6, 1
v_lshl_add_u32 v77, v77, 3, v1
v_lshlrev_b32 v77, 1, v77
v_lshlrev_b32 v78, 3, v1
v_and_b32 v6, 0x70, v1
v_mov_b32 v76, s34
ds_write_b32 v6, v76 offset:512
s_barrier
s_cmp_eq_u32 s34, 63
s_cbranch_scc1 L_done_w0s
L_top_w0s:
s_barrier
ds_read_b128 v[60:63], v1 offset:1024
s_mov_b32 m0, 5120
s_nop 0
buffer_load_dwordx4 v1, s[4:7], s48 offen offset:0 sc0 sc1 lds
s_barrier
ds_read_b128 v[64:67], v1 offset:2048
ds_read_b128 v[68:71], v1 offset:3072
ds_read_b128 v[72:75], v1 offset:4096
L_s0_w0s:
s_waitcnt lgkmcnt(3)
v_smfmac_f32_16x16x64_bf16 v[32:35], v[60:63], v[184:191], v0
v_smfmac_f32_16x16x64_bf16 v[20:23], v[60:63], v[44:51], v0
v_smfmac_f32_16x16x64_bf16 v[36:39], v[60:63], a[48:55], v0
buffer_load_dwordx4 v[12:15], v9, s[4:7], s37 offen offset:0
v_smfmac_f32_16x16x64_bf16 v[28:31], v[60:63], v[176:183], v0
buffer_load_dwordx4 v[16:19], v9, s[4:7], s37 offen offset:1024
v_smfmac_f32_16x16x64_bf16 v[40:43], v[60:63], a[56:63], v0
s_waitcnt lgkmcnt(2)
v_smfmac_f32_16x16x64_bf16 v[28:31], v[64:67], v[192:199], v0
ds_read_b128 v[48:51], v2 offset:3072
v_smfmac_f32_16x16x64_bf16 v[20:23], v[64:67], v[80:87], v0
ds_read_b128 v[44:47], v2 offset:2048
v_smfmac_f32_16x16x64_bf16 v[32:35], v[64:67], v[200:207], v0
buffer_load_dwordx4 v[52:55], v1, s[4:7], s37 offen offset:2048
v_bitop3_b32 v6, v60, v64, s35 bitop3:0x7e
s_waitcnt lgkmcnt(2)
v_bitop3_b32 v76, v68, v72, s35 bitop3:0x7e
v_bitop3_b32 v6, v6, v76, 1 bitop3:0xa8
v_smfmac_f32_16x16x64_bf16 v[24:27], v[64:67], v[88:95], v0
s_waitcnt lgkmcnt(0)
v_smfmac_f32_16x16x64_bf16 v[24:27], v[60:63], v[44:51], v0
buffer_load_dwordx4 v[56:59], v1, s[4:7], s37 offen offset:3072
v_smfmac_f32_16x16x64_bf16 v[40:43], v[64:67], a[72:79], v0
v_smfmac_f32_16x16x64_bf16 v[36:39], v[64:67], a[64:71], v0
ds_read_b128 v[44:47], v2 offset:4096
v_cmp_ne_u32 vcc, 0, v6
v_smfmac_f32_16x16x64_bf16 v[20:23], v[68:71], v[96:103], v0
ds_read_b128 v[48:51], v2 offset:5120
v_smfmac_f32_16x16x64_bf16 v[24:27], v[68:71], v[104:111], v0
s_cbranch_vccnz L_ra0_w0s
s_waitcnt vmcnt(4)
s_barrier
ds_read_b32 v6, v77 offset:8192
v_smfmac_f32_16x16x64_bf16 v[28:31], v[68:71], v[208:215], v0
s_mov_b32 m0, 0
ds_read_b128 v[60:63], v1 offset:6144
s_waitcnt lgkmcnt(2)
v_smfmac_f32_16x16x64_bf16 v[20:23], v[72:75], v[44:51], v0
buffer_load_dword v78, s[4:7], s39 offen lds
ds_read_b128 v[76:79], v1 offset:5120
v_smfmac_f32_16x16x64_bf16 v[28:31], v[72:75], v[224:231], v0
ds_read_b128 v[64:67], v1 offset:7168
ds_read_b128 v[44:47], v2 offset:6144
v_smfmac_f32_16x16x64_bf16 v[32:35], v[68:71], v[216:223], v0
v_smfmac_f32_16x16x64_bf16 v[36:39], v[68:71], a[80:87], v0
ds_read_b128 v[48:51], v2 offset:7168
s_waitcnt lgkmcnt(4)
v_bitop3_b32 v6, v6, v60, s35 bitop3:0x7e
v_smfmac_f32_16x16x64_bf16 v[40:43], v[68:71], a[88:95], v0
ds_read_b128 v[68:71], v1 offset:8192
v_smfmac_f32_16x16x64_bf16 v[32:35], v[72:75], v[232:239], v0
s_waitcnt lgkmcnt(3)
v_bitop3_b32 v6, v6, v64, s35 bitop3:0xf6
v_bitop3_b32 v6, v6, v76, s35 bitop3:0xf6
v_and_b32 v6, 1, v6
s_waitcnt lgkmcnt(1)
v_smfmac_f32_16x16x64_bf16 v[24:27], v[72:75], v[44:51], v0
ds_read_b128 v[44:47], v2 offset:8192
v_cmp_ne_u32 vcc, 0, v6
v_smfmac_f32_16x16x64_bf16 v[36:39], v[72:75], a[96:103], v0
ds_read_b128 v[48:51], v2 offset:9216
v_smfmac_f32_16x16x64_bf16 v[40:43], v[72:75], a[104:111], v0
ds_read_b128 v[72:75], v1 offset:9216
s_cbranch_vccnz L_ra1_w0s
L_a1_w0s:
v_smfmac_f32_16x16x64_bf16 v[20:23], v[60:63], v[112:119], v0
v_smfmac_f32_16x16x64_bf16 v[20:23], v[64:67], v[128:135], v0
s_waitcnt lgkmcnt(1)
v_smfmac_f32_16x16x64_bf16 v[20:23], v[76:79], v[44:51], v0
ds_read_b128 v[48:51], v2 offset:11264
v_bfe_u32 v6, v1, 5, 1
v_mad_i32_i24 v6, v6, s55, v1
v_smfmac_f32_16x16x64_bf16 v[20:23], v[68:71], v[144:151], v0
s_waitcnt lgkmcnt(1)
v_smfmac_f32_16x16x64_bf16 v[20:23], v[72:75], v[160:167], v0
ds_read_b128 v[44:47], v2 offset:10240
v_smfmac_f32_16x16x64_bf16 v[24:27], v[60:63], v[120:127], v0
v_smfmac_f32_16x16x64_bf16 v[24:27], v[64:67], v[136:143], v0
v_smfmac_f32_16x16x64_bf16 v[24:27], v[68:71], v[152:159], v0
v_add_f32 v21, v21, v23
v_smfmac_f32_16x16x64_bf16 v[24:27], v[72:75], v[168:175], v0
s_waitcnt lgkmcnt(0)
v_smfmac_f32_16x16x64_bf16 v[24:27], v[76:79], v[44:51], v0
ds_read_b128 v[44:47], v2 offset:12288
v_add_f32 v20, v20, v22
v_cvt_pk_bf16_f32 v22, v20, v21
v_smfmac_f32_16x16x64_bf16 v[28:31], v[76:79], v[240:247], v0
v_smfmac_f32_16x16x64_bf16 v[28:31], v[64:67], a[0:7], v0
ds_read_b128 v[48:51], v2 offset:13312
v_add_f32 v25, v25, v27
v_add_f32 v24, v24, v26
v_cvt_pk_bf16_f32 v23, v24, v25
v_smfmac_f32_16x16x64_bf16 v[28:31], v[72:75], a[32:39], v0
ds_write_b64 v3, v[22:23] offset:10240
v_smfmac_f32_16x16x64_bf16 v[28:31], v[68:71], a[16:23], v0
s_waitcnt vmcnt(1)
v_smfmac_f32_16x16x64_bf16 v[32:35], v[76:79], v[248:255], v0
s_waitcnt lgkmcnt(1)
v_smfmac_f32_16x16x64_bf16 v[28:31], v[60:63], v[44:51], v0
ds_read_b128 v[44:47], v2 offset:14336
ds_read_b128 v[48:51], v2 offset:15360
v_smfmac_f32_16x16x64_bf16 v[32:35], v[64:67], a[8:15], v0
s_waitcnt lgkmcnt(2)
s_barrier
ds_read_b64_tr_b16 v[20:21], v4 offset:10240
v_smfmac_f32_16x16x64_bf16 v[32:35], v[68:71], a[24:31], v0
ds_read_b64_tr_b16 v[22:23], v4 offset:10752
v_add_f32 v29, v29, v31
v_smfmac_f32_16x16x64_bf16 v[32:35], v[72:75], a[40:47], v0
ds_read_b64_tr_b16 v[24:25], v4 offset:11264
ds_read_b64_tr_b16 v[26:27], v4 offset:11776
s_waitcnt lgkmcnt(4)
v_smfmac_f32_16x16x64_bf16 v[32:35], v[60:63], v[44:51], v0
ds_read_b128 v[48:51], v2 offset:19456
s_waitcnt lgkmcnt(3)
v_mfma_f32_16x16x32_bf16 v[12:15], v[12:15], v[20:23], 0
ds_read_b128 v[44:47], v2 offset:18432
v_add_f32 v28, v28, v30
s_waitcnt lgkmcnt(2)
v_mfma_f32_16x16x32_bf16 v[12:15], v[16:19], v[24:27], v[12:15]
v_add_f32 v32, v32, v34
v_add_f32 v33, v33, v35
v_cvt_pk_bf16_f32 v31, v32, v33
v_cvt_pk_bf16_f32 v30, v28, v29
v_smfmac_f32_16x16x64_bf16 v[36:39], v[76:79], a[112:119], v0
ds_write_b64 v3, v[30:31] offset:12288
v_add_f32_dpp v12, v14, v12 quad_perm:[2,3,0,1] row_mask:0xf bank_mask:0xf
v_exp_f32 v14, v12
v_add_f32_dpp v13, v15, v13 quad_perm:[2,3,0,1] row_mask:0xf bank_mask:0xf
v_exp_f32 v15, v13
s_nop 0
v_cvt_pk_bf16_f32 v14, v14, v15
v_smfmac_f32_16x16x64_bf16 v[40:43], v[76:79], a[120:127], v0
ds_write_b32 v5, v14 offset:14368
s_waitcnt lgkmcnt(2)
v_smfmac_f32_16x16x64_bf16 v[40:43], v[72:75], v[44:51], v0
ds_read_b128 v[44:47], v2 offset:16384
s_waitcnt lgkmcnt(2)
s_barrier
ds_read_b64_tr_b16 v[28:29], v4 offset:12288
v_smfmac_f32_16x16x64_bf16 v[36:39], v[60:63], a[128:135], v0
ds_read_b64_tr_b16 v[30:31], v4 offset:12800
ds_read_b64_tr_b16 v[32:33], v4 offset:13312
v_smfmac_f32_16x16x64_bf16 v[40:43], v[60:63], a[136:143], v0
ds_read_b64_tr_b16 v[34:35], v4 offset:13824
v_mov_b64 v[76:77], s[52:53]
s_waitcnt lgkmcnt(2)
v_mfma_f32_16x16x32_bf16 v[28:31], v[28:31], v[20:23], 0
s_barrier
ds_read_b128 v[16:19], v1 offset:14368
s_waitcnt lgkmcnt(1)
v_mfma_f32_16x16x32_bf16 v[28:31], v[32:35], v[24:27], v[28:31]
ds_read_b128 v[60:63], v1 offset:14336
v_mov_b64 v[14:15], s[0:1]
v_smfmac_f32_16x16x64_bf16 v[40:43], v[64:67], a[152:159], v0
ds_read_b128 v[48:51], v2 offset:17408
v_mov_b64 v[78:79], s[52:53]
v_smfmac_f32_16x16x64_bf16 v[40:43], v[68:71], a[168:175], v0
v_add_f32_dpp v28, v30, v28 quad_perm:[2,3,0,1] row_mask:0xf bank_mask:0xf
v_smfmac_f32_16x16x64_bf16 v[36:39], v[64:67], a[144:151], v0
ds_read_b128 v[64:67], v2 offset:25600
v_add_f32_dpp v29, v31, v29 quad_perm:[2,3,0,1] row_mask:0xf bank_mask:0xf
s_waitcnt lgkmcnt(1)
v_smfmac_f32_16x16x64_bf16 v[36:39], v[72:75], v[44:51], v0
ds_read_b128 v[72:75], v2 offset:29696
v_mul_f32 v28, s50, v28
v_smfmac_f32_16x16x64_bf16 v[36:39], v[68:71], a[160:167], v0
ds_read_b128 v[68:71], v2 offset:28672
v_cvt_pk_bf16_f32 v40, v40, v41
v_mfma_f32_16x16x32_bf16 v[32:35], v[76:79], v[16:19], 0
v_exp_f32 v30, v28
ds_read_b128 v[44:47], v2 offset:20480
v_mfma_f32_16x16x32_bf16 v[20:23], v[52:55], v[16:19], 0
v_mul_f32 v29, s50, v29
v_cvt_pk_bf16_f32 v41, v42, v43
v_cvt_pk_bf16_f32 v43, v38, v39
v_mov_b64 v[76:77], 0
v_exp_f32 v31, v29
v_mfma_f32_16x16x32_bf16 v[20:23], v[56:59], v[60:63], v[20:23]
v_cvt_pk_bf16_f32 v30, v30, v31
v_cndmask_b32_e64 v26, 0, v30, s[56:57]
v_cndmask_b32_e64 v27, 0, v30, s[56:57]
s_nop 0
v_mov_b32_dpp v24, v26 quad_perm:[2,3,0,1] row_mask:0xf bank_mask:0xf
v_mfma_f32_16x16x16_bf16 v[32:35], v[14:15], v[26:27], v[32:35]
v_mov_b32_dpp v25, v26 quad_perm:[2,3,0,1] row_mask:0xf bank_mask:0xf
v_cvt_pk_bf16_f32 v42, v36, v37
s_nop 1
v_mfma_f32_16x16x32_bf16 v[20:23], v[40:43], v[24:27], v[20:23]
ds_read_b128 v[60:63], v2 offset:24576
ds_read_b128 v[48:51], v2 offset:21504
v_mov_b64 v[78:79], 0
v_rcp_f32 v33, v32
v_mov_b64 v[36:37], 0
v_min_f32 v32, v32, v33
v_cmp_nlt_f32 vcc, s2, v32
v_mul_f32_dpp v23, v33, v23 quad_perm:[0,1,0,1] row_mask:0xf bank_mask:0xf
v_mul_f32_dpp v21, v33, v21 quad_perm:[0,1,0,1] row_mask:0xf bank_mask:0xf
v_mul_f32_dpp v22, v33, v22 quad_perm:[0,1,0,1] row_mask:0xf bank_mask:0xf
v_mul_f32_dpp v20, v33, v20 quad_perm:[0,1,0,1] row_mask:0xf bank_mask:0xf
v_cvt_pk_bf16_f32 v20, v20, v21
v_cvt_pk_bf16_f32 v21, v22, v23
ds_write_b64 v6, v[20:21] offset:5120
s_and_b64 vcc, vcc, s[56:57]
s_cbranch_scc1 L_mx_w0s
L_mxb_w0s:
v_mov_b64 v[38:39], 0
v_mov_b32_dpp v19, v21 quad_perm:[2,3,2,3] row_mask:0xf bank_mask:0xf
v_mov_b32_dpp v16, v20 quad_perm:[0,1,0,1] row_mask:0xf bank_mask:0xf
v_mov_b32_dpp v18, v20 quad_perm:[2,3,2,3] row_mask:0xf bank_mask:0xf
v_mov_b32_dpp v17, v21 quad_perm:[0,1,0,1] row_mask:0xf bank_mask:0xf
v_mov_b64 v[24:25], 0
v_mov_b64 v[26:27], 0
v_smfmac_f32_16x16x64_bf16 v[76:79], v[16:19], a[176:183], v0
s_waitcnt lgkmcnt(0)
s_barrier
v_mov_b64 v[32:33], 0
ds_read_b128 v[12:15], v7 offset:7168
ds_read_b128 v[52:55], v7 offset:6144
v_smfmac_f32_16x16x64_bf16 v[36:39], v[16:19], v[44:51], v0
ds_read_b128 v[48:51], v2 offset:23552
ds_read_b128 v[56:59], v7 offset:8192
v_mov_b64 v[30:31], 0
v_mov_b64 v[34:35], 0
v_smfmac_f32_16x16x64_bf16 v[24:27], v[16:19], v[60:67], v0
ds_read_b128 v[44:47], v2 offset:22528
v_smfmac_f32_16x16x64_bf16 v[32:35], v[16:19], v[68:75], v0
ds_read_b128 v[68:71], v2 offset:30720
s_waitcnt lgkmcnt(5)
v_smfmac_f32_16x16x64_bf16 v[76:79], v[12:15], a[184:191], v0
ds_read_b128 v[60:63], v2 offset:26624
s_waitcnt lgkmcnt(5)
v_smfmac_f32_16x16x64_bf16 v[76:79], v[52:55], a[192:199], v0
ds_read_b128 v[64:67], v2 offset:27648
s_waitcnt lgkmcnt(4)
v_smfmac_f32_16x16x64_bf16 v[76:79], v[56:59], a[200:207], v0
v_mov_b64 v[28:29], 0
v_smfmac_f32_16x16x64_bf16 v[36:39], v[12:15], a[208:215], v0
ds_read_b128 v[72:75], v2 offset:31744
s_waitcnt lgkmcnt(4)
v_smfmac_f32_16x16x64_bf16 v[36:39], v[52:55], v[44:51], v0
ds_read_b128 v[44:47], v2 offset:32768
v_cvt_pk_bf16_f32 v77, v77, v79
v_cvt_pk_bf16_f32 v76, v76, v78
v_bfi_b32 v76, 1, s35, v76
v_smfmac_f32_16x16x64_bf16 v[36:39], v[56:59], a[216:223], v0
v_smfmac_f32_16x16x64_bf16 v[24:27], v[12:15], a[224:231], v0
buffer_store_dwordx2 v[76:77], v8, s[4:7], s42 offen sc0 sc1
s_waitcnt lgkmcnt(2)
v_smfmac_f32_16x16x64_bf16 v[24:27], v[52:55], v[60:67], v0
ds_read_b128 v[48:51], v2 offset:33792
ds_read_b128 v[60:63], v2 offset:36864
v_cvt_pk_bf16_f32 v36, v36, v38
v_bfi_b32 v36, 1, s35, v36
v_cvt_pk_bf16_f32 v37, v37, v39
v_smfmac_f32_16x16x64_bf16 v[24:27], v[56:59], a[232:239], v0
buffer_store_dwordx2 v[36:37], v8, s[4:7], s43 offen sc0 sc1
ds_read_b128 v[64:67], v2 offset:37888
v_smfmac_f32_16x16x64_bf16 v[32:35], v[12:15], a[240:247], v0
ds_read_b128 v[40:43], v2 offset:35840
s_waitcnt lgkmcnt(5)
v_smfmac_f32_16x16x64_bf16 v[32:35], v[52:55], v[68:75], v0
ds_read_b128 v[72:75], v2 offset:39936
ds_read_b128 v[36:39], v2 offset:34816
v_cvt_pk_bf16_f32 v25, v25, v27
v_cvt_pk_bf16_f32 v24, v24, v26
v_bfi_b32 v24, 1, s35, v24
buffer_store_dwordx2 v[24:25], v8, s[4:7], s44 offen sc0 sc1
v_smfmac_f32_16x16x64_bf16 v[32:35], v[56:59], a[248:255], v0
ds_read_b128 v[68:71], v2 offset:38912
s_waitcnt lgkmcnt(6)
v_smfmac_f32_16x16x64_bf16 v[28:31], v[16:19], v[44:51], v0
s_nop 3
v_cvt_pk_bf16_f32 v33, v33, v35
v_cvt_pk_bf16_f32 v32, v32, v34
v_bfi_b32 v32, 1, s35, v32
buffer_store_dwordx2 v[32:33], v8, s[4:7], s45 offen sc0 sc1
s_waitcnt lgkmcnt(1)
v_smfmac_f32_16x16x64_bf16 v[28:31], v[52:55], v[36:43], v0
v_smfmac_f32_16x16x64_bf16 v[28:31], v[12:15], v[60:67], v0
s_waitcnt lgkmcnt(0)
v_smfmac_f32_16x16x64_bf16 v[28:31], v[56:59], v[68:75], v0
s_nop 7
v_cvt_pk_bf16_f32 v28, v28, v30
v_bfi_b32 v28, 1, s35, v28
v_cvt_pk_bf16_f32 v29, v29, v31
buffer_store_dwordx2 v[28:29], v8, s[4:7], s46 offen sc0 sc1
s_branch L_ex_w0s
.p2align 6
L_ex_w0rs:
v_and_b32 v6, 0x70, v1
ds_read_b128 v[76:79], v6 offset:256
v_bfe_u32 v11, v1, 4, 2
v_lshrrev_b32_e64 v11, v11, 1
v_mov_b64 v[20:21], 0
v_mov_b64 v[22:23], 0
v_mov_b64 v[24:25], 0
v_mov_b64 v[26:27], 0
v_mov_b64 v[28:29], 0
v_mov_b64 v[30:31], 0
v_mov_b64 v[32:33], 0
v_mov_b64 v[34:35], 0
s_barrier
s_waitcnt vmcnt(0)
s_add_u32 s34, s34, 1
s_not_b32 s35, s35
s_not_b32 s36, s36
s_add_u32 s37, s37, 524288
s_add_u32 s39, s39, 524288
s_mul_i32 s40, s34, 10240
s_add_u32 s40, s40, 8093696
ds_read_b128 v[44:47], v2 offset:0
ds_read_b128 v[48:51], v2 offset:1024
buffer_load_dwordx4 v[60:63], v9, s[4:7], s3 offen offset:0 sc0 sc1
buffer_load_dwordx4 v[64:67], v9, s[4:7], s3 offen offset:1024 sc0 sc1
buffer_load_dwordx4 v[68:71], v9, s[4:7], s3 offen offset:2048 sc0 sc1
buffer_load_dwordx4 v[72:75], v9, s[4:7], s3 offen offset:3072 sc0 sc1
s_waitcnt lgkmcnt(2)
s_waitcnt vmcnt(3)
L_r_w0rs:
v_mfma_f32_16x16x32_bf16 v[36:39], v[60:63], v[76:79], 0
s_waitcnt vmcnt(2)
v_mfma_f32_16x16x32_bf16 v[36:39], v[64:67], v[76:79], v[36:39]
v_bitop3_b32 v40, v60, v64, s36 bitop3:0x7e
s_waitcnt vmcnt(1)
v_mfma_f32_16x16x32_bf16 v[36:39], v[68:71], v[76:79], v[36:39]
s_waitcnt vmcnt(0)
v_mfma_f32_16x16x32_bf16 v[36:39], v[72:75], v[76:79], v[36:39]
v_bitop3_b32 v41, v68, v72, s36 bitop3:0x7e
v_bitop3_b32 v40, v40, v41, 1 bitop3:0xa8
v_cmp_ne_u32 vcc, 0, v40
v_nop
v_nop
v_nop
v_nop
v_nop
v_pk_add_f32 v[36:37], v[36:37], v[38:39]
v_cvt_pk_bf16_f32 v40, v36, v37
v_bfi_b32 v40, v11, s35, v40
s_cbranch_vccnz L_rr_w0rs
buffer_store_dword v40, v10, s[4:7], 0 offen sc0 sc1
s_cmp_eq_u32 s34, 63
v_mov_b32 v11, v40
s_cbranch_scc1 L_done_w0rs
v_and_b32 v6, 0x70, v1
v_mov_b32 v76, s34
ds_write_b32 v6, v76 offset:512
v_mov_b64 v[36:37], 0
v_mov_b64 v[38:39], 0
v_mov_b64 v[40:41], 0
v_mov_b64 v[42:43], 0
v_bfe_u32 v77, v1, 6, 1
v_lshl_add_u32 v77, v77, 3, v1
v_lshlrev_b32 v77, 1, v77
v_lshlrev_b32 v78, 3, v1
L_top_w0rs:
s_barrier
ds_read_b128 v[60:63], v1 offset:1024
s_mov_b32 m0, 5120
s_nop 0
buffer_load_dwordx4 v1, s[4:7], s48 offen offset:0 sc0 sc1 lds
s_barrier
ds_read_b128 v[64:67], v1 offset:2048
ds_read_b128 v[68:71], v1 offset:3072
ds_read_b128 v[72:75], v1 offset:4096
L_s0_w0rs:
s_waitcnt lgkmcnt(3)
v_smfmac_f32_16x16x64_bf16 v[32:35], v[60:63], v[184:191], v0
v_smfmac_f32_16x16x64_bf16 v[20:23], v[60:63], v[44:51], v0
v_smfmac_f32_16x16x64_bf16 v[36:39], v[60:63], a[48:55], v0
buffer_load_dwordx4 v[12:15], v9, s[4:7], s37 offen offset:0
v_smfmac_f32_16x16x64_bf16 v[28:31], v[60:63], v[176:183], v0
buffer_load_dwordx4 v[16:19], v9, s[4:7], s37 offen offset:1024
v_smfmac_f32_16x16x64_bf16 v[40:43], v[60:63], a[56:63], v0
s_waitcnt lgkmcnt(2)
v_smfmac_f32_16x16x64_bf16 v[28:31], v[64:67], v[192:199], v0
ds_read_b128 v[48:51], v2 offset:3072
v_smfmac_f32_16x16x64_bf16 v[20:23], v[64:67], v[80:87], v0
ds_read_b128 v[44:47], v2 offset:2048
v_smfmac_f32_16x16x64_bf16 v[32:35], v[64:67], v[200:207], v0
buffer_load_dwordx4 v[52:55], v1, s[4:7], s37 offen offset:2048
v_bitop3_b32 v6, v60, v64, s35 bitop3:0x7e
s_waitcnt lgkmcnt(2)
v_bitop3_b32 v76, v68, v72, s35 bitop3:0x7e
v_bitop3_b32 v6, v6, v76, 1 bitop3:0xa8
v_smfmac_f32_16x16x64_bf16 v[24:27], v[64:67], v[88:95], v0
s_waitcnt lgkmcnt(0)
v_smfmac_f32_16x16x64_bf16 v[24:27], v[60:63], v[44:51], v0
buffer_load_dwordx4 v[56:59], v1, s[4:7], s37 offen offset:3072
v_smfmac_f32_16x16x64_bf16 v[40:43], v[64:67], a[72:79], v0
v_smfmac_f32_16x16x64_bf16 v[36:39], v[64:67], a[64:71], v0
ds_read_b128 v[44:47], v2 offset:4096
v_cmp_ne_u32 vcc, 0, v6
v_smfmac_f32_16x16x64_bf16 v[20:23], v[68:71], v[96:103], v0
ds_read_b128 v[48:51], v2 offset:5120
v_smfmac_f32_16x16x64_bf16 v[24:27], v[68:71], v[104:111], v0
s_cbranch_vccnz L_ra0_w0rs
s_waitcnt vmcnt(4)
s_barrier
ds_read_b32 v6, v77 offset:8192
v_smfmac_f32_16x16x64_bf16 v[28:31], v[68:71], v[208:215], v0
s_mov_b32 m0, 0
ds_read_b128 v[60:63], v1 offset:6144
buffer_store_dword v11, v10, s[4:7], s40 offen sc0 sc1
s_waitcnt lgkmcnt(2)
v_smfmac_f32_16x16x64_bf16 v[20:23], v[72:75], v[44:51], v0
buffer_load_dword v78, s[4:7], s39 offen lds
ds_read_b128 v[76:79], v1 offset:5120
v_smfmac_f32_16x16x64_bf16 v[28:31], v[72:75], v[224:231], v0
ds_read_b128 v[64:67], v1 offset:7168
ds_read_b128 v[44:47], v2 offset:6144
v_smfmac_f32_16x16x64_bf16 v[32:35], v[68:71], v[216:223], v0
v_smfmac_f32_16x16x64_bf16 v[36:39], v[68:71], a[80:87], v0
ds_read_b128 v[48:51], v2 offset:7168
s_waitcnt lgkmcnt(4)
v_bitop3_b32 v6, v6, v60, s35 bitop3:0x7e
v_smfmac_f32_16x16x64_bf16 v[40:43], v[68:71], a[88:95], v0
ds_read_b128 v[68:71], v1 offset:8192
v_smfmac_f32_16x16x64_bf16 v[32:35], v[72:75], v[232:239], v0
s_waitcnt lgkmcnt(3)
v_bitop3_b32 v6, v6, v64, s35 bitop3:0xf6
v_bitop3_b32 v6, v6, v76, s35 bitop3:0xf6
v_and_b32 v6, 1, v6
s_waitcnt lgkmcnt(1)
v_smfmac_f32_16x16x64_bf16 v[24:27], v[72:75], v[44:51], v0
ds_read_b128 v[44:47], v2 offset:8192
v_cmp_ne_u32 vcc, 0, v6
v_smfmac_f32_16x16x64_bf16 v[36:39], v[72:75], a[96:103], v0
ds_read_b128 v[48:51], v2 offset:9216
v_smfmac_f32_16x16x64_bf16 v[40:43], v[72:75], a[104:111], v0
ds_read_b128 v[72:75], v1 offset:9216
s_cbranch_vccnz L_ra1_w0rs
L_a1_w0rs:
v_smfmac_f32_16x16x64_bf16 v[20:23], v[60:63], v[112:119], v0
v_smfmac_f32_16x16x64_bf16 v[20:23], v[64:67], v[128:135], v0
s_waitcnt lgkmcnt(1)
v_smfmac_f32_16x16x64_bf16 v[20:23], v[76:79], v[44:51], v0
ds_read_b128 v[48:51], v2 offset:11264
v_bfe_u32 v6, v1, 5, 1
v_mad_i32_i24 v6, v6, s55, v1
v_smfmac_f32_16x16x64_bf16 v[20:23], v[68:71], v[144:151], v0
s_waitcnt lgkmcnt(1)
v_smfmac_f32_16x16x64_bf16 v[20:23], v[72:75], v[160:167], v0
ds_read_b128 v[44:47], v2 offset:10240
v_smfmac_f32_16x16x64_bf16 v[24:27], v[60:63], v[120:127], v0
v_smfmac_f32_16x16x64_bf16 v[24:27], v[64:67], v[136:143], v0
v_smfmac_f32_16x16x64_bf16 v[24:27], v[68:71], v[152:159], v0
v_add_f32 v21, v21, v23
v_smfmac_f32_16x16x64_bf16 v[24:27], v[72:75], v[168:175], v0
s_waitcnt lgkmcnt(0)
v_smfmac_f32_16x16x64_bf16 v[24:27], v[76:79], v[44:51], v0
ds_read_b128 v[44:47], v2 offset:12288
v_add_f32 v20, v20, v22
v_cvt_pk_bf16_f32 v22, v20, v21
v_smfmac_f32_16x16x64_bf16 v[28:31], v[76:79], v[240:247], v0
v_smfmac_f32_16x16x64_bf16 v[28:31], v[64:67], a[0:7], v0
ds_read_b128 v[48:51], v2 offset:13312
v_add_f32 v25, v25, v27
v_add_f32 v24, v24, v26
v_cvt_pk_bf16_f32 v23, v24, v25
v_smfmac_f32_16x16x64_bf16 v[28:31], v[72:75], a[32:39], v0
ds_write_b64 v3, v[22:23] offset:10240
v_smfmac_f32_16x16x64_bf16 v[28:31], v[68:71], a[16:23], v0
s_waitcnt vmcnt(2)
v_smfmac_f32_16x16x64_bf16 v[32:35], v[76:79], v[248:255], v0
s_waitcnt lgkmcnt(1)
v_smfmac_f32_16x16x64_bf16 v[28:31], v[60:63], v[44:51], v0
ds_read_b128 v[44:47], v2 offset:14336
ds_read_b128 v[48:51], v2 offset:15360
v_smfmac_f32_16x16x64_bf16 v[32:35], v[64:67], a[8:15], v0
s_waitcnt lgkmcnt(2)
s_barrier
ds_read_b64_tr_b16 v[20:21], v4 offset:10240
v_smfmac_f32_16x16x64_bf16 v[32:35], v[68:71], a[24:31], v0
ds_read_b64_tr_b16 v[22:23], v4 offset:10752
v_add_f32 v29, v29, v31
v_smfmac_f32_16x16x64_bf16 v[32:35], v[72:75], a[40:47], v0
ds_read_b64_tr_b16 v[24:25], v4 offset:11264
ds_read_b64_tr_b16 v[26:27], v4 offset:11776
s_waitcnt lgkmcnt(4)
v_smfmac_f32_16x16x64_bf16 v[32:35], v[60:63], v[44:51], v0
ds_read_b128 v[48:51], v2 offset:19456
s_waitcnt lgkmcnt(3)
v_mfma_f32_16x16x32_bf16 v[12:15], v[12:15], v[20:23], 0
ds_read_b128 v[44:47], v2 offset:18432
v_add_f32 v28, v28, v30
s_waitcnt lgkmcnt(2)
v_mfma_f32_16x16x32_bf16 v[12:15], v[16:19], v[24:27], v[12:15]
v_add_f32 v32, v32, v34
v_add_f32 v33, v33, v35
v_cvt_pk_bf16_f32 v31, v32, v33
v_cvt_pk_bf16_f32 v30, v28, v29
v_smfmac_f32_16x16x64_bf16 v[36:39], v[76:79], a[112:119], v0
ds_write_b64 v3, v[30:31] offset:12288
v_add_f32_dpp v12, v14, v12 quad_perm:[2,3,0,1] row_mask:0xf bank_mask:0xf
v_exp_f32 v14, v12
v_add_f32_dpp v13, v15, v13 quad_perm:[2,3,0,1] row_mask:0xf bank_mask:0xf
v_exp_f32 v15, v13
s_nop 0
v_cvt_pk_bf16_f32 v14, v14, v15
v_smfmac_f32_16x16x64_bf16 v[40:43], v[76:79], a[120:127], v0
ds_write_b32 v5, v14 offset:14368
s_waitcnt lgkmcnt(2)
v_smfmac_f32_16x16x64_bf16 v[40:43], v[72:75], v[44:51], v0
ds_read_b128 v[44:47], v2 offset:16384
s_waitcnt lgkmcnt(2)
s_barrier
ds_read_b64_tr_b16 v[28:29], v4 offset:12288
v_smfmac_f32_16x16x64_bf16 v[36:39], v[60:63], a[128:135], v0
ds_read_b64_tr_b16 v[30:31], v4 offset:12800
ds_read_b64_tr_b16 v[32:33], v4 offset:13312
v_smfmac_f32_16x16x64_bf16 v[40:43], v[60:63], a[136:143], v0
ds_read_b64_tr_b16 v[34:35], v4 offset:13824
v_mov_b64 v[76:77], s[52:53]
s_waitcnt lgkmcnt(2)
v_mfma_f32_16x16x32_bf16 v[28:31], v[28:31], v[20:23], 0
s_barrier
ds_read_b128 v[16:19], v1 offset:14368
s_waitcnt lgkmcnt(1)
v_mfma_f32_16x16x32_bf16 v[28:31], v[32:35], v[24:27], v[28:31]
ds_read_b128 v[60:63], v1 offset:14336
v_mov_b64 v[14:15], s[0:1]
v_smfmac_f32_16x16x64_bf16 v[40:43], v[64:67], a[152:159], v0
ds_read_b128 v[48:51], v2 offset:17408
v_mov_b64 v[78:79], s[52:53]
v_smfmac_f32_16x16x64_bf16 v[40:43], v[68:71], a[168:175], v0
v_add_f32_dpp v28, v30, v28 quad_perm:[2,3,0,1] row_mask:0xf bank_mask:0xf
v_smfmac_f32_16x16x64_bf16 v[36:39], v[64:67], a[144:151], v0
ds_read_b128 v[64:67], v2 offset:25600
v_add_f32_dpp v29, v31, v29 quad_perm:[2,3,0,1] row_mask:0xf bank_mask:0xf
s_waitcnt lgkmcnt(1)
v_smfmac_f32_16x16x64_bf16 v[36:39], v[72:75], v[44:51], v0
ds_read_b128 v[72:75], v2 offset:29696
v_mul_f32 v28, s50, v28
v_smfmac_f32_16x16x64_bf16 v[36:39], v[68:71], a[160:167], v0
ds_read_b128 v[68:71], v2 offset:28672
v_cvt_pk_bf16_f32 v40, v40, v41
v_mfma_f32_16x16x32_bf16 v[32:35], v[76:79], v[16:19], 0
v_exp_f32 v30, v28
ds_read_b128 v[44:47], v2 offset:20480
v_mfma_f32_16x16x32_bf16 v[20:23], v[52:55], v[16:19], 0
v_mul_f32 v29, s50, v29
v_cvt_pk_bf16_f32 v41, v42, v43
v_cvt_pk_bf16_f32 v43, v38, v39
v_mov_b64 v[76:77], 0
v_exp_f32 v31, v29
v_mfma_f32_16x16x32_bf16 v[20:23], v[56:59], v[60:63], v[20:23]
v_cvt_pk_bf16_f32 v30, v30, v31
v_cndmask_b32_e64 v26, 0, v30, s[56:57]
v_cndmask_b32_e64 v27, 0, v30, s[56:57]
s_nop 0
v_mov_b32_dpp v24, v26 quad_perm:[2,3,0,1] row_mask:0xf bank_mask:0xf
v_mfma_f32_16x16x16_bf16 v[32:35], v[14:15], v[26:27], v[32:35]
v_mov_b32_dpp v25, v26 quad_perm:[2,3,0,1] row_mask:0xf bank_mask:0xf
v_cvt_pk_bf16_f32 v42, v36, v37
s_nop 1
v_mfma_f32_16x16x32_bf16 v[20:23], v[40:43], v[24:27], v[20:23]
ds_read_b128 v[60:63], v2 offset:24576
ds_read_b128 v[48:51], v2 offset:21504
v_mov_b64 v[78:79], 0
v_rcp_f32 v33, v32
v_mov_b64 v[36:37], 0
v_min_f32 v32, v32, v33
v_cmp_nlt_f32 vcc, s2, v32
v_mul_f32_dpp v23, v33, v23 quad_perm:[0,1,0,1] row_mask:0xf bank_mask:0xf
v_mul_f32_dpp v21, v33, v21 quad_perm:[0,1,0,1] row_mask:0xf bank_mask:0xf
v_mul_f32_dpp v22, v33, v22 quad_perm:[0,1,0,1] row_mask:0xf bank_mask:0xf
v_mul_f32_dpp v20, v33, v20 quad_perm:[0,1,0,1] row_mask:0xf bank_mask:0xf
v_cvt_pk_bf16_f32 v20, v20, v21
v_cvt_pk_bf16_f32 v21, v22, v23
ds_write_b64 v6, v[20:21] offset:5120
s_and_b64 vcc, vcc, s[56:57]
s_cbranch_scc1 L_mx_w0rs
L_mxb_w0rs:
v_mov_b64 v[38:39], 0
v_mov_b32_dpp v19, v21 quad_perm:[2,3,2,3] row_mask:0xf bank_mask:0xf
v_mov_b32_dpp v16, v20 quad_perm:[0,1,0,1] row_mask:0xf bank_mask:0xf
v_mov_b32_dpp v18, v20 quad_perm:[2,3,2,3] row_mask:0xf bank_mask:0xf
v_mov_b32_dpp v17, v21 quad_perm:[0,1,0,1] row_mask:0xf bank_mask:0xf
v_mov_b64 v[24:25], 0
v_mov_b64 v[26:27], 0
v_smfmac_f32_16x16x64_bf16 v[76:79], v[16:19], a[176:183], v0
s_waitcnt lgkmcnt(0)
s_barrier
v_mov_b64 v[32:33], 0
ds_read_b128 v[12:15], v7 offset:7168
ds_read_b128 v[52:55], v7 offset:6144
v_smfmac_f32_16x16x64_bf16 v[36:39], v[16:19], v[44:51], v0
ds_read_b128 v[48:51], v2 offset:23552
ds_read_b128 v[56:59], v7 offset:8192
v_mov_b64 v[30:31], 0
v_mov_b64 v[34:35], 0
v_smfmac_f32_16x16x64_bf16 v[24:27], v[16:19], v[60:67], v0
ds_read_b128 v[44:47], v2 offset:22528
v_smfmac_f32_16x16x64_bf16 v[32:35], v[16:19], v[68:75], v0
ds_read_b128 v[68:71], v2 offset:30720
s_waitcnt lgkmcnt(5)
v_smfmac_f32_16x16x64_bf16 v[76:79], v[12:15], a[184:191], v0
ds_read_b128 v[60:63], v2 offset:26624
s_waitcnt lgkmcnt(5)
v_smfmac_f32_16x16x64_bf16 v[76:79], v[52:55], a[192:199], v0
ds_read_b128 v[64:67], v2 offset:27648
s_waitcnt lgkmcnt(4)
v_smfmac_f32_16x16x64_bf16 v[76:79], v[56:59], a[200:207], v0
v_mov_b64 v[28:29], 0
v_smfmac_f32_16x16x64_bf16 v[36:39], v[12:15], a[208:215], v0
ds_read_b128 v[72:75], v2 offset:31744
s_waitcnt lgkmcnt(4)
v_smfmac_f32_16x16x64_bf16 v[36:39], v[52:55], v[44:51], v0
ds_read_b128 v[44:47], v2 offset:32768
v_cvt_pk_bf16_f32 v77, v77, v79
v_cvt_pk_bf16_f32 v76, v76, v78
v_bfi_b32 v76, 1, s35, v76
v_smfmac_f32_16x16x64_bf16 v[36:39], v[56:59], a[216:223], v0
v_smfmac_f32_16x16x64_bf16 v[24:27], v[12:15], a[224:231], v0
buffer_store_dwordx2 v[76:77], v8, s[4:7], s42 offen sc0 sc1
s_waitcnt lgkmcnt(2)
v_smfmac_f32_16x16x64_bf16 v[24:27], v[52:55], v[60:67], v0
ds_read_b128 v[48:51], v2 offset:33792
ds_read_b128 v[60:63], v2 offset:36864
v_cvt_pk_bf16_f32 v36, v36, v38
v_bfi_b32 v36, 1, s35, v36
v_cvt_pk_bf16_f32 v37, v37, v39
v_smfmac_f32_16x16x64_bf16 v[24:27], v[56:59], a[232:239], v0
buffer_store_dwordx2 v[36:37], v8, s[4:7], s43 offen sc0 sc1
ds_read_b128 v[64:67], v2 offset:37888
v_smfmac_f32_16x16x64_bf16 v[32:35], v[12:15], a[240:247], v0
ds_read_b128 v[40:43], v2 offset:35840
s_waitcnt lgkmcnt(5)
v_smfmac_f32_16x16x64_bf16 v[32:35], v[52:55], v[68:75], v0
ds_read_b128 v[72:75], v2 offset:39936
ds_read_b128 v[36:39], v2 offset:34816
v_cvt_pk_bf16_f32 v25, v25, v27
v_cvt_pk_bf16_f32 v24, v24, v26
v_bfi_b32 v24, 1, s35, v24
buffer_store_dwordx2 v[24:25], v8, s[4:7], s44 offen sc0 sc1
v_smfmac_f32_16x16x64_bf16 v[32:35], v[56:59], a[248:255], v0
ds_read_b128 v[68:71], v2 offset:38912
s_waitcnt lgkmcnt(6)
v_smfmac_f32_16x16x64_bf16 v[28:31], v[16:19], v[44:51], v0
s_nop 3
v_cvt_pk_bf16_f32 v33, v33, v35
v_cvt_pk_bf16_f32 v32, v32, v34
v_bfi_b32 v32, 1, s35, v32
buffer_store_dwordx2 v[32:33], v8, s[4:7], s45 offen sc0 sc1
s_waitcnt lgkmcnt(1)
v_smfmac_f32_16x16x64_bf16 v[28:31], v[52:55], v[36:43], v0
v_smfmac_f32_16x16x64_bf16 v[28:31], v[12:15], v[60:67], v0
s_waitcnt lgkmcnt(0)
v_smfmac_f32_16x16x64_bf16 v[28:31], v[56:59], v[68:75], v0
s_nop 7
v_cvt_pk_bf16_f32 v28, v28, v30
v_bfi_b32 v28, 1, s35, v28
v_cvt_pk_bf16_f32 v29, v29, v31
buffer_store_dwordx2 v[28:29], v8, s[4:7], s46 offen sc0 sc1
s_branch L_ex_w0rs
.p2align 6
L_ex_w1rs:
v_and_b32 v6, 0x70, v1
ds_read_b128 v[76:79], v6 offset:256
v_bfe_u32 v11, v1, 4, 2
v_lshrrev_b32_e64 v11, v11, 1
v_mov_b64 v[20:21], 0
v_mov_b64 v[22:23], 0
v_mov_b64 v[24:25], 0
v_mov_b64 v[26:27], 0
v_mov_b64 v[28:29], 0
v_mov_b64 v[30:31], 0
v_mov_b64 v[32:33], 0
v_mov_b64 v[34:35], 0
ds_read_b128 v[44:47], v2 offset:0
ds_read_b128 v[48:51], v2 offset:1024
s_barrier
s_waitcnt vmcnt(1)
s_add_u32 s34, s34, 1
s_not_b32 s35, s35
s_not_b32 s36, s36
s_add_u32 s37, s37, 524288
s_mul_i32 s40, s34, 10240
s_add_u32 s40, s40, 8093696
buffer_load_dwordx4 v[60:63], v9, s[4:7], s3 offen offset:0 sc0 sc1
buffer_load_dwordx4 v[64:67], v9, s[4:7], s3 offen offset:1024 sc0 sc1
buffer_load_dwordx4 v[68:71], v9, s[4:7], s3 offen offset:2048 sc0 sc1
buffer_load_dwordx4 v[72:75], v9, s[4:7], s3 offen offset:3072 sc0 sc1
s_waitcnt lgkmcnt(2)
s_waitcnt vmcnt(3)
L_r_w1rs:
v_mfma_f32_16x16x32_bf16 v[36:39], v[60:63], v[76:79], 0
s_waitcnt vmcnt(2)
v_mfma_f32_16x16x32_bf16 v[36:39], v[64:67], v[76:79], v[36:39]
v_bitop3_b32 v40, v60, v64, s36 bitop3:0x7e
s_waitcnt vmcnt(1)
v_mfma_f32_16x16x32_bf16 v[36:39], v[68:71], v[76:79], v[36:39]
s_waitcnt vmcnt(0)
v_mfma_f32_16x16x32_bf16 v[36:39], v[72:75], v[76:79], v[36:39]
v_bitop3_b32 v41, v68, v72, s36 bitop3:0x7e
v_bitop3_b32 v40, v40, v41, 1 bitop3:0xa8
v_cmp_ne_u32 vcc, 0, v40
v_nop
v_nop
v_nop
v_nop
v_nop
v_pk_add_f32 v[36:37], v[36:37], v[38:39]
v_cvt_pk_bf16_f32 v40, v36, v37
v_bfi_b32 v40, v11, s35, v40
s_cbranch_vccnz L_rr_w1rs
buffer_store_dword v40, v10, s[4:7], 0 offen sc0 sc1
s_cmp_eq_u32 s34, 63
v_mov_b32 v11, v40
s_cbranch_scc1 L_done_w1rs
v_and_b32 v6, 0x70, v1
v_mov_b32 v76, s34
ds_write_b32 v6, v76 offset:516
v_mov_b64 v[36:37], 0
v_mov_b64 v[38:39], 0
v_mov_b64 v[40:41], 0
v_mov_b64 v[42:43], 0
v_bfe_u32 v77, v1, 6, 1
v_lshl_add_u32 v77, v77, 3, v1
v_lshlrev_b32 v77, 1, v77
v_lshlrev_b32 v78, 3, v1
L_top_w1rs:
s_barrier
ds_read_b128 v[60:63], v1 offset:1024
s_mov_b32 m0, 5120
s_nop 0
buffer_load_dwordx4 v1, s[4:7], s48 offen offset:1024 sc0 sc1 lds
s_barrier
ds_read_b128 v[64:67], v1 offset:2048
ds_read_b128 v[68:71], v1 offset:3072
ds_read_b128 v[72:75], v1 offset:4096
L_s0_w1rs:
s_waitcnt lgkmcnt(3)
v_smfmac_f32_16x16x64_bf16 v[32:35], v[60:63], v[184:191], v0
v_smfmac_f32_16x16x64_bf16 v[20:23], v[60:63], v[44:51], v0
v_smfmac_f32_16x16x64_bf16 v[36:39], v[60:63], a[48:55], v0
s_waitcnt lgkmcnt(2)
v_smfmac_f32_16x16x64_bf16 v[28:31], v[64:67], v[192:199], v0
v_smfmac_f32_16x16x64_bf16 v[28:31], v[60:63], v[176:183], v0
buffer_load_dwordx4 v[12:15], v9, s[4:7], s37 offen offset:0
ds_read_b128 v[48:51], v2 offset:3072
ds_read_b128 v[44:47], v2 offset:2048
v_smfmac_f32_16x16x64_bf16 v[20:23], v[64:67], v[80:87], v0
buffer_load_dwordx4 v[16:19], v9, s[4:7], s37 offen offset:1024
v_smfmac_f32_16x16x64_bf16 v[32:35], v[64:67], v[200:207], v0
v_smfmac_f32_16x16x64_bf16 v[40:43], v[60:63], a[56:63], v0
v_bitop3_b32 v6, v60, v64, s35 bitop3:0x7e
v_smfmac_f32_16x16x64_bf16 v[24:27], v[64:67], v[88:95], v0
buffer_load_dwordx4 v[52:55], v1, s[4:7], s37 offen offset:2048
s_waitcnt lgkmcnt(0)
v_smfmac_f32_16x16x64_bf16 v[24:27], v[60:63], v[44:51], v0
v_bitop3_b32 v76, v68, v72, s35 bitop3:0x7e
v_smfmac_f32_16x16x64_bf16 v[36:39], v[64:67], a[64:71], v0
v_bitop3_b32 v6, v6, v76, 1 bitop3:0xa8
v_smfmac_f32_16x16x64_bf16 v[40:43], v[64:67], a[72:79], v0
buffer_load_dwordx4 v[56:59], v1, s[4:7], s37 offen offset:3072
ds_read_b128 v[44:47], v2 offset:4096
v_cmp_ne_u32 vcc, 0, v6
v_smfmac_f32_16x16x64_bf16 v[20:23], v[68:71], v[96:103], v0
ds_read_b128 v[48:51], v2 offset:5120
v_smfmac_f32_16x16x64_bf16 v[24:27], v[68:71], v[104:111], v0
s_cbranch_vccnz L_ra0_w1rs
s_waitcnt vmcnt(4)
s_barrier
ds_read_b32 v6, v77 offset:8192
v_smfmac_f32_16x16x64_bf16 v[28:31], v[68:71], v[208:215], v0
ds_read_b128 v[60:63], v1 offset:6144
s_waitcnt lgkmcnt(2)
v_smfmac_f32_16x16x64_bf16 v[20:23], v[72:75], v[44:51], v0
ds_read_b128 v[76:79], v1 offset:5120
ds_read_b128 v[44:47], v2 offset:6144
buffer_store_dword v11, v10, s[4:7], s40 offen sc0 sc1
v_smfmac_f32_16x16x64_bf16 v[28:31], v[72:75], v[224:231], v0
ds_read_b128 v[64:67], v1 offset:7168
v_smfmac_f32_16x16x64_bf16 v[36:39], v[68:71], a[80:87], v0
v_smfmac_f32_16x16x64_bf16 v[32:35], v[68:71], v[216:223], v0
ds_read_b128 v[48:51], v2 offset:7168
s_waitcnt lgkmcnt(4)
v_bitop3_b32 v6, v6, v60, s35 bitop3:0x7e
v_smfmac_f32_16x16x64_bf16 v[40:43], v[68:71], a[88:95], v0
ds_read_b128 v[68:71], v1 offset:8192
v_smfmac_f32_16x16x64_bf16 v[32:35], v[72:75], v[232:239], v0
s_waitcnt lgkmcnt(2)
v_bitop3_b32 v6, v6, v64, s35 bitop3:0xf6
v_bitop3_b32 v6, v6, v76, s35 bitop3:0xf6
v_and_b32 v6, 1, v6
s_waitcnt lgkmcnt(1)
v_smfmac_f32_16x16x64_bf16 v[24:27], v[72:75], v[44:51], v0
ds_read_b128 v[44:47], v2 offset:8192
v_cmp_ne_u32 vcc, 0, v6
v_smfmac_f32_16x16x64_bf16 v[36:39], v[72:75], a[96:103], v0
ds_read_b128 v[48:51], v2 offset:9216
v_smfmac_f32_16x16x64_bf16 v[40:43], v[72:75], a[104:111], v0
ds_read_b128 v[72:75], v1 offset:9216
s_cbranch_vccnz L_ra1_w1rs
L_a1_w1rs:
v_smfmac_f32_16x16x64_bf16 v[20:23], v[60:63], v[112:119], v0
v_smfmac_f32_16x16x64_bf16 v[20:23], v[64:67], v[128:135], v0
s_waitcnt lgkmcnt(1)
v_smfmac_f32_16x16x64_bf16 v[20:23], v[76:79], v[44:51], v0
ds_read_b128 v[48:51], v2 offset:11264
s_waitcnt lgkmcnt(1)
v_smfmac_f32_16x16x64_bf16 v[20:23], v[72:75], v[160:167], v0
v_bfe_u32 v6, v1, 5, 1
v_mad_i32_i24 v6, v6, s55, v1
v_smfmac_f32_16x16x64_bf16 v[20:23], v[68:71], v[144:151], v0
ds_read_b128 v[44:47], v2 offset:10240
v_smfmac_f32_16x16x64_bf16 v[24:27], v[60:63], v[120:127], v0
v_smfmac_f32_16x16x64_bf16 v[24:27], v[64:67], v[136:143], v0
v_smfmac_f32_16x16x64_bf16 v[24:27], v[68:71], v[152:159], v0
v_add_f32 v21, v21, v23
v_smfmac_f32_16x16x64_bf16 v[24:27], v[72:75], v[168:175], v0
s_waitcnt lgkmcnt(0)
v_smfmac_f32_16x16x64_bf16 v[24:27], v[76:79], v[44:51], v0
ds_read_b128 v[44:47], v2 offset:12288
v_add_f32 v20, v20, v22
v_cvt_pk_bf16_f32 v22, v20, v21
v_smfmac_f32_16x16x64_bf16 v[28:31], v[76:79], v[240:247], v0
ds_read_b128 v[48:51], v2 offset:13312
v_smfmac_f32_16x16x64_bf16 v[28:31], v[64:67], a[0:7], v0
v_add_f32 v25, v25, v27
v_add_f32 v24, v24, v26
v_cvt_pk_bf16_f32 v23, v24, v25
v_smfmac_f32_16x16x64_bf16 v[28:31], v[72:75], a[32:39], v0
ds_write_b64 v3, v[22:23] offset:10752
v_smfmac_f32_16x16x64_bf16 v[28:31], v[68:71], a[16:23], v0
v_smfmac_f32_16x16x64_bf16 v[32:35], v[76:79], v[248:255], v0
s_waitcnt vmcnt(1)
s_waitcnt lgkmcnt(1)
v_smfmac_f32_16x16x64_bf16 v[28:31], v[60:63], v[44:51], v0
ds_read_b128 v[44:47], v2 offset:14336
ds_read_b128 v[48:51], v2 offset:15360
v_smfmac_f32_16x16x64_bf16 v[32:35], v[64:67], a[8:15], v0
s_waitcnt lgkmcnt(2)
s_barrier
v_smfmac_f32_16x16x64_bf16 v[32:35], v[68:71], a[24:31], v0
ds_read_b64_tr_b16 v[20:21], v4 offset:10240
ds_read_b64_tr_b16 v[22:23], v4 offset:10752
v_add_f32 v29, v29, v31
v_smfmac_f32_16x16x64_bf16 v[32:35], v[72:75], a[40:47], v0
ds_read_b64_tr_b16 v[24:25], v4 offset:11264
ds_read_b64_tr_b16 v[26:27], v4 offset:11776
s_waitcnt lgkmcnt(4)
v_smfmac_f32_16x16x64_bf16 v[32:35], v[60:63], v[44:51], v0
ds_read_b128 v[48:51], v2 offset:19456
s_waitcnt lgkmcnt(3)
v_mfma_f32_16x16x32_bf16 v[12:15], v[12:15], v[20:23], 0
ds_read_b128 v[44:47], v2 offset:18432
v_add_f32 v28, v28, v30
s_waitcnt lgkmcnt(2)
v_mfma_f32_16x16x32_bf16 v[12:15], v[16:19], v[24:27], v[12:15]
v_add_f32 v32, v32, v34
v_add_f32 v33, v33, v35
v_cvt_pk_bf16_f32 v30, v28, v29
v_cvt_pk_bf16_f32 v31, v32, v33
v_smfmac_f32_16x16x64_bf16 v[36:39], v[76:79], a[112:119], v0
ds_write_b64 v3, v[30:31] offset:12800
v_add_f32_dpp v12, v14, v12 quad_perm:[2,3,0,1] row_mask:0xf bank_mask:0xf
v_exp_f32 v14, v12
v_add_f32_dpp v13, v15, v13 quad_perm:[2,3,0,1] row_mask:0xf bank_mask:0xf
v_exp_f32 v15, v13
s_nop 0
v_cvt_pk_bf16_f32 v14, v14, v15
v_smfmac_f32_16x16x64_bf16 v[40:43], v[76:79], a[120:127], v0
ds_write_b32 v5, v14 offset:14624
s_waitcnt lgkmcnt(1)
s_barrier
ds_read_b64_tr_b16 v[28:29], v4 offset:12288
v_smfmac_f32_16x16x64_bf16 v[36:39], v[60:63], a[128:135], v0
ds_read_b64_tr_b16 v[30:31], v4 offset:12800
ds_read_b64_tr_b16 v[32:33], v4 offset:13312
v_smfmac_f32_16x16x64_bf16 v[40:43], v[60:63], a[136:143], v0
ds_read_b64_tr_b16 v[34:35], v4 offset:13824
v_mov_b64 v[76:77], s[52:53]
v_smfmac_f32_16x16x64_bf16 v[40:43], v[72:75], v[44:51], v0
ds_read_b128 v[44:47], v2 offset:16384
s_waitcnt lgkmcnt(3)
v_mfma_f32_16x16x32_bf16 v[28:31], v[28:31], v[20:23], 0
s_barrier
ds_read_b128 v[16:19], v1 offset:14368
s_waitcnt lgkmcnt(2)
v_mfma_f32_16x16x32_bf16 v[28:31], v[32:35], v[24:27], v[28:31]
ds_read_b128 v[60:63], v1 offset:14336
v_mov_b64 v[14:15], s[0:1]
v_smfmac_f32_16x16x64_bf16 v[40:43], v[64:67], a[152:159], v0
ds_read_b128 v[48:51], v2 offset:17408
v_mov_b64 v[78:79], s[52:53]
v_smfmac_f32_16x16x64_bf16 v[40:43], v[68:71], a[168:175], v0
v_add_f32_dpp v28, v30, v28 quad_perm:[2,3,0,1] row_mask:0xf bank_mask:0xf
v_smfmac_f32_16x16x64_bf16 v[36:39], v[64:67], a[144:151], v0
ds_read_b128 v[64:67], v2 offset:27648
v_mul_f32 v28, s50, v28
v_add_f32_dpp v29, v31, v29 quad_perm:[2,3,0,1] row_mask:0xf bank_mask:0xf
v_smfmac_f32_16x16x64_bf16 v[36:39], v[68:71], a[160:167], v0
ds_read_b128 v[68:71], v2 offset:30720
s_waitcnt lgkmcnt(2)
v_smfmac_f32_16x16x64_bf16 v[36:39], v[72:75], v[44:51], v0
ds_read_b128 v[72:75], v2 offset:31744
v_mul_f32 v29, s50, v29
v_cvt_pk_bf16_f32 v40, v40, v41
v_mfma_f32_16x16x32_bf16 v[32:35], v[76:79], v[16:19], 0
v_exp_f32 v30, v28
ds_read_b128 v[44:47], v2 offset:22528
v_mfma_f32_16x16x32_bf16 v[20:23], v[52:55], v[16:19], 0
v_exp_f32 v31, v29
v_mov_b64 v[76:77], 0
v_mfma_f32_16x16x32_bf16 v[20:23], v[56:59], v[60:63], v[20:23]
v_cvt_pk_bf16_f32 v41, v42, v43
v_cvt_pk_bf16_f32 v43, v38, v39
v_cvt_pk_bf16_f32 v30, v30, v31
v_cndmask_b32_e64 v26, 0, v30, s[56:57]
v_cndmask_b32_e64 v27, 0, v30, s[56:57]
s_nop 0
v_mov_b32_dpp v24, v26 quad_perm:[2,3,0,1] row_mask:0xf bank_mask:0xf
v_mfma_f32_16x16x16_bf16 v[32:35], v[14:15], v[26:27], v[32:35]
v_cvt_pk_bf16_f32 v42, v36, v37
v_mov_b32_dpp v25, v26 quad_perm:[2,3,0,1] row_mask:0xf bank_mask:0xf
s_nop 1
v_mfma_f32_16x16x32_bf16 v[20:23], v[40:43], v[24:27], v[20:23]
ds_read_b128 v[48:51], v2 offset:23552
ds_read_b128 v[60:63], v2 offset:26624
v_mov_b64 v[78:79], 0
v_rcp_f32 v33, v32
v_mov_b64 v[36:37], 0
v_min_f32 v32, v32, v33
v_cmp_nlt_f32 vcc, s2, v32
v_mul_f32_dpp v23, v33, v23 quad_perm:[0,1,0,1] row_mask:0xf bank_mask:0xf
v_mul_f32_dpp v21, v33, v21 quad_perm:[0,1,0,1] row_mask:0xf bank_mask:0xf
v_mul_f32_dpp v22, v33, v22 quad_perm:[0,1,0,1] row_mask:0xf bank_mask:0xf
v_mul_f32_dpp v20, v33, v20 quad_perm:[0,1,0,1] row_mask:0xf bank_mask:0xf
v_cvt_pk_bf16_f32 v20, v20, v21
v_cvt_pk_bf16_f32 v21, v22, v23
ds_write_b64 v6, v[20:21] offset:6144
s_and_b64 vcc, vcc, s[56:57]
v_mov_b32_dpp v19, v21 quad_perm:[2,3,2,3] row_mask:0xf bank_mask:0xf
s_cbranch_scc1 L_mx_w1rs
L_mxb_w1rs:
v_mov_b32_dpp v16, v20 quad_perm:[0,1,0,1] row_mask:0xf bank_mask:0xf
v_mov_b32_dpp v17, v21 quad_perm:[0,1,0,1] row_mask:0xf bank_mask:0xf
v_mov_b64 v[38:39], 0
v_mov_b32_dpp v18, v20 quad_perm:[2,3,2,3] row_mask:0xf bank_mask:0xf
v_mov_b64 v[26:27], 0
v_mov_b64 v[24:25], 0
v_smfmac_f32_16x16x64_bf16 v[76:79], v[16:19], a[176:183], v0
s_waitcnt lgkmcnt(0)
s_barrier
ds_read_b128 v[12:15], v7 offset:8192
v_mov_b64 v[32:33], 0
ds_read_b128 v[52:55], v7 offset:5120
v_smfmac_f32_16x16x64_bf16 v[36:39], v[16:19], v[44:51], v0
ds_read_b128 v[48:51], v2 offset:21504
ds_read_b128 v[44:47], v2 offset:20480
ds_read_b128 v[56:59], v7 offset:7168
v_mov_b64 v[30:31], 0
v_mov_b64 v[34:35], 0
v_smfmac_f32_16x16x64_bf16 v[24:27], v[16:19], v[60:67], v0
v_smfmac_f32_16x16x64_bf16 v[32:35], v[16:19], v[68:75], v0
ds_read_b128 v[68:71], v2 offset:28672
s_waitcnt lgkmcnt(5)
v_smfmac_f32_16x16x64_bf16 v[76:79], v[12:15], a[184:191], v0
ds_read_b128 v[60:63], v2 offset:24576
s_waitcnt lgkmcnt(5)
v_smfmac_f32_16x16x64_bf16 v[76:79], v[52:55], a[192:199], v0
ds_read_b128 v[64:67], v2 offset:25600
s_waitcnt lgkmcnt(3)
v_smfmac_f32_16x16x64_bf16 v[76:79], v[56:59], a[200:207], v0
v_mov_b64 v[28:29], 0
v_smfmac_f32_16x16x64_bf16 v[36:39], v[12:15], a[208:215], v0
ds_read_b128 v[72:75], v2 offset:29696
v_smfmac_f32_16x16x64_bf16 v[36:39], v[52:55], v[44:51], v0
ds_read_b128 v[44:47], v2 offset:34816
v_cvt_pk_bf16_f32 v77, v77, v79
v_cvt_pk_bf16_f32 v76, v76, v78
v_bfi_b32 v76, 1, s35, v76
v_smfmac_f32_16x16x64_bf16 v[36:39], v[56:59], a[216:223], v0
buffer_store_dwordx2 v[76:77], v8, s[4:7], s42 offen sc0 sc1
ds_read_b128 v[48:51], v2 offset:35840
v_smfmac_f32_16x16x64_bf16 v[24:27], v[12:15], a[224:231], v0
s_waitcnt lgkmcnt(3)
v_smfmac_f32_16x16x64_bf16 v[24:27], v[52:55], v[60:67], v0
ds_read_b128 v[60:63], v2 offset:38912
v_cvt_pk_bf16_f32 v37, v37, v39
v_cvt_pk_bf16_f32 v36, v36, v38
v_bfi_b32 v36, 1, s35, v36
v_smfmac_f32_16x16x64_bf16 v[24:27], v[56:59], a[232:239], v0
buffer_store_dwordx2 v[36:37], v8, s[4:7], s43 offen sc0 sc1
ds_read_b128 v[64:67], v2 offset:39936
ds_read_b128 v[40:43], v2 offset:33792
v_smfmac_f32_16x16x64_bf16 v[32:35], v[12:15], a[240:247], v0
s_waitcnt lgkmcnt(5)
v_smfmac_f32_16x16x64_bf16 v[32:35], v[52:55], v[68:75], v0
ds_read_b128 v[72:75], v2 offset:37888
ds_read_b128 v[36:39], v2 offset:32768
v_cvt_pk_bf16_f32 v25, v25, v27
v_cvt_pk_bf16_f32 v24, v24, v26
v_bfi_b32 v24, 1, s35, v24
buffer_store_dwordx2 v[24:25], v8, s[4:7], s44 offen sc0 sc1
v_smfmac_f32_16x16x64_bf16 v[32:35], v[56:59], a[248:255], v0
ds_read_b128 v[68:71], v2 offset:36864
s_waitcnt lgkmcnt(6)
v_smfmac_f32_16x16x64_bf16 v[28:31], v[16:19], v[44:51], v0
s_nop 3
v_cvt_pk_bf16_f32 v33, v33, v35
v_cvt_pk_bf16_f32 v32, v32, v34
v_bfi_b32 v32, 1, s35, v32
buffer_store_dwordx2 v[32:33], v8, s[4:7], s45 offen sc0 sc1
s_waitcnt lgkmcnt(1)
v_smfmac_f32_16x16x64_bf16 v[28:31], v[52:55], v[36:43], v0
v_smfmac_f32_16x16x64_bf16 v[28:31], v[12:15], v[60:67], v0
s_waitcnt lgkmcnt(0)
v_smfmac_f32_16x16x64_bf16 v[28:31], v[56:59], v[68:75], v0
s_nop 7
v_cvt_pk_bf16_f32 v28, v28, v30
v_bfi_b32 v28, 1, s35, v28
v_cvt_pk_bf16_f32 v29, v29, v31
buffer_store_dwordx2 v[28:29], v8, s[4:7], s46 offen sc0 sc1
s_branch L_ex_w1rs
.p2align 6
L_ex_w2rs:
s_add_u32 s34, s34, 1
s_not_b32 s35, s35
s_not_b32 s36, s36
v_and_b32 v6, 0x70, v1
ds_read_b128 v[76:79], v6 offset:256
v_bfe_u32 v11, v1, 4, 2
v_lshrrev_b32_e64 v11, v11, 1
v_bfe_u32 v6, v1, 2, 7
v_mov_b32 v42, s35
s_add_u32 s37, s37, 524288
s_mul_i32 s40, s34, 10240
s_add_u32 s40, s40, 8093696
s_waitcnt vmcnt(1)
buffer_load_dwordx4 v[60:63], v9, s[4:7], s3 offen offset:0 sc0 sc1
buffer_load_dwordx4 v[64:67], v9, s[4:7], s3 offen offset:1024 sc0 sc1
buffer_load_dwordx4 v[68:71], v9, s[4:7], s3 offen offset:2048 sc0 sc1
buffer_load_dwordx4 v[72:75], v9, s[4:7], s3 offen offset:3072 sc0 sc1
s_barrier
s_waitcnt lgkmcnt(0)
s_waitcnt vmcnt(3)
L_r_w2rs:
v_mfma_f32_16x16x32_bf16 v[36:39], v[60:63], v[76:79], 0
s_waitcnt vmcnt(2)
v_mfma_f32_16x16x32_bf16 v[36:39], v[64:67], v[76:79], v[36:39]
v_bitop3_b32 v40, v60, v64, s36 bitop3:0x7e
s_waitcnt vmcnt(1)
v_mfma_f32_16x16x32_bf16 v[36:39], v[68:71], v[76:79], v[36:39]
s_waitcnt vmcnt(0)
v_mfma_f32_16x16x32_bf16 v[36:39], v[72:75], v[76:79], v[36:39]
v_bitop3_b32 v41, v68, v72, s36 bitop3:0x7e
v_bitop3_b32 v40, v40, v41, 1 bitop3:0xa8
v_cmp_ne_u32 vcc, 0, v40
v_nop
v_nop
v_nop
v_nop
v_nop
v_pk_add_f32 v[36:37], v[36:37], v[38:39]
v_cvt_pk_bf16_f32 v40, v36, v37
v_bfi_b32 v40, v11, s35, v40
s_cbranch_vccnz L_rr_w2rs
buffer_store_dword v40, v10, s[4:7], 0 offen sc0 sc1
s_cmp_eq_u32 s34, 63
v_mov_b32 v11, v40
s_cbranch_scc1 L_done_w2rs
s_cmp_lg_u32 s38, 0
s_cbranch_scc1 L_lw_w2rs
L_lwb_w2rs:
s_mov_b64 exec, 1
buffer_store_dword v42, v1, s[4:7], s33 offen sc0 sc1
s_mov_b64 exec, -1
v_mov_b64 v[20:21], 0
v_mov_b64 v[22:23], 0
v_mov_b64 v[24:25], 0
v_mov_b64 v[26:27], 0
v_mov_b64 v[28:29], 0
v_mov_b64 v[30:31], 0
v_mov_b64 v[32:33], 0
v_mov_b64 v[34:35], 0
v_mov_b64 v[36:37], 0
v_mov_b64 v[38:39], 0
v_mov_b64 v[40:41], 0
v_mov_b64 v[42:43], 0
v_bfe_u32 v77, v1, 6, 1
v_lshl_add_u32 v77, v77, 3, v1
v_lshlrev_b32 v77, 1, v77
v_lshlrev_b32 v78, 3, v1
ds_read_b128 v[44:47], v2 offset:0
ds_read_b128 v[48:51], v2 offset:1024
v_mov_b32 v79, s36
L_sp_w2rs:
buffer_load_dword v79, v6, s[4:7], s58 offen sc0 sc1
s_sub_u32 s41, s41, 1
s_cbranch_scc1 L_exit
s_mov_b32 m0, 1024
s_nop 0
buffer_load_dwordx4 v1, s[4:7], s47 offen offset:0 sc0 sc1 lds
buffer_load_dwordx4 v1, s[4:7], s47 offen offset:1024 sc0 sc1 lds
buffer_load_dwordx4 v1, s[4:7], s47 offen offset:2048 sc0 sc1 lds
buffer_load_dwordx4 v1, s[4:7], s47 offen offset:3072 sc0 sc1 lds
s_waitcnt vmcnt(4)
v_cmp_ne_u32 vcc, s35, v79
s_cbranch_vccnz L_sp_w2rs
L_top_w2rs:
s_waitcnt vmcnt(3)
s_barrier
ds_read_b128 v[60:63], v1 offset:1024
s_mov_b32 m0, 5120
s_nop 0
buffer_load_dwordx4 v1, s[4:7], s48 offen offset:2048 sc0 sc1 lds
s_waitcnt vmcnt(1)
s_barrier
ds_read_b128 v[64:67], v1 offset:2048
ds_read_b128 v[68:71], v1 offset:3072
ds_read_b128 v[72:75], v1 offset:4096
L_s0_w2rs:
s_waitcnt lgkmcnt(3)
v_smfmac_f32_16x16x64_bf16 v[32:35], v[60:63], v[184:191], v0
v_smfmac_f32_16x16x64_bf16 v[36:39], v[60:63], a[48:55], v0
v_smfmac_f32_16x16x64_bf16 v[20:23], v[60:63], v[44:51], v0
ds_read_b128 v[48:51], v2 offset:3072
v_smfmac_f32_16x16x64_bf16 v[28:31], v[60:63], v[176:183], v0
buffer_load_dwordx4 v[12:15], v9, s[4:7], s37 offen offset:0
v_smfmac_f32_16x16x64_bf16 v[40:43], v[60:63], a[56:63], v0
s_waitcnt lgkmcnt(3)
v_smfmac_f32_16x16x64_bf16 v[28:31], v[64:67], v[192:199], v0
ds_read_b128 v[44:47], v2 offset:2048
v_smfmac_f32_16x16x64_bf16 v[20:23], v[64:67], v[80:87], v0
buffer_load_dwordx4 v[16:19], v9, s[4:7], s37 offen offset:1024
v_smfmac_f32_16x16x64_bf16 v[32:35], v[64:67], v[200:207], v0
v_bitop3_b32 v6, v60, v64, s35 bitop3:0x7e
s_waitcnt lgkmcnt(2)
v_bitop3_b32 v76, v68, v72, s35 bitop3:0x7e
v_smfmac_f32_16x16x64_bf16 v[24:27], v[64:67], v[88:95], v0
buffer_load_dwordx4 v[52:55], v1, s[4:7], s37 offen offset:2048
s_waitcnt lgkmcnt(0)
v_smfmac_f32_16x16x64_bf16 v[24:27], v[60:63], v[44:51], v0
v_smfmac_f32_16x16x64_bf16 v[36:39], v[64:67], a[64:71], v0
v_bitop3_b32 v6, v6, v76, 1 bitop3:0xa8
v_smfmac_f32_16x16x64_bf16 v[40:43], v[64:67], a[72:79], v0
ds_read_b128 v[44:47], v2 offset:4096
v_cmp_ne_u32 vcc, 0, v6
v_smfmac_f32_16x16x64_bf16 v[20:23], v[68:71], v[96:103], v0
buffer_load_dwordx4 v[56:59], v1, s[4:7], s37 offen offset:3072
ds_read_b128 v[48:51], v2 offset:5120
v_smfmac_f32_16x16x64_bf16 v[24:27], v[68:71], v[104:111], v0
s_cbranch_vccnz L_ra0_w2rs
s_waitcnt vmcnt(4)
s_barrier
ds_read_b32 v6, v77 offset:8192
v_smfmac_f32_16x16x64_bf16 v[28:31], v[68:71], v[208:215], v0
ds_read_b128 v[60:63], v1 offset:6144
ds_read_b128 v[64:67], v1 offset:7168
s_waitcnt lgkmcnt(3)
v_smfmac_f32_16x16x64_bf16 v[20:23], v[72:75], v[44:51], v0
ds_read_b128 v[76:79], v1 offset:5120
ds_read_b128 v[44:47], v2 offset:6144
buffer_store_dword v11, v10, s[4:7], s40 offen sc0 sc1
v_smfmac_f32_16x16x64_bf16 v[28:31], v[72:75], v[224:231], v0
v_smfmac_f32_16x16x64_bf16 v[32:35], v[68:71], v[216:223], v0
v_smfmac_f32_16x16x64_bf16 v[36:39], v[68:71], a[80:87], v0
ds_read_b128 v[48:51], v2 offset:7168
s_waitcnt lgkmcnt(4)
v_bitop3_b32 v6, v6, v60, s35 bitop3:0x7e
v_smfmac_f32_16x16x64_bf16 v[40:43], v[68:71], a[88:95], v0
ds_read_b128 v[68:71], v1 offset:8192
v_smfmac_f32_16x16x64_bf16 v[32:35], v[72:75], v[232:239], v0
s_waitcnt lgkmcnt(4)
v_bitop3_b32 v6, v6, v64, s35 bitop3:0xf6
s_waitcnt lgkmcnt(3)
v_bitop3_b32 v6, v6, v76, s35 bitop3:0xf6
v_and_b32 v6, 1, v6
s_waitcnt lgkmcnt(1)
v_smfmac_f32_16x16x64_bf16 v[24:27], v[72:75], v[44:51], v0
ds_read_b128 v[44:47], v2 offset:8192
v_cmp_ne_u32 vcc, 0, v6
v_smfmac_f32_16x16x64_bf16 v[36:39], v[72:75], a[96:103], v0
ds_read_b128 v[48:51], v2 offset:9216
v_smfmac_f32_16x16x64_bf16 v[40:43], v[72:75], a[104:111], v0
ds_read_b128 v[72:75], v1 offset:9216
s_cbranch_vccnz L_ra1_w2rs
L_a1_w2rs:
v_smfmac_f32_16x16x64_bf16 v[20:23], v[60:63], v[112:119], v0
v_smfmac_f32_16x16x64_bf16 v[20:23], v[64:67], v[128:135], v0
s_waitcnt lgkmcnt(1)
v_smfmac_f32_16x16x64_bf16 v[20:23], v[76:79], v[44:51], v0
ds_read_b128 v[48:51], v2 offset:11264
v_bfe_u32 v6, v1, 5, 1
v_mad_i32_i24 v6, v6, s55, v1
v_smfmac_f32_16x16x64_bf16 v[20:23], v[68:71], v[144:151], v0
s_waitcnt lgkmcnt(1)
v_smfmac_f32_16x16x64_bf16 v[20:23], v[72:75], v[160:167], v0
ds_read_b128 v[44:47], v2 offset:10240
v_smfmac_f32_16x16x64_bf16 v[24:27], v[60:63], v[120:127], v0
v_smfmac_f32_16x16x64_bf16 v[24:27], v[64:67], v[136:143], v0
v_smfmac_f32_16x16x64_bf16 v[24:27], v[68:71], v[152:159], v0
v_add_f32 v21, v21, v23
v_smfmac_f32_16x16x64_bf16 v[24:27], v[72:75], v[168:175], v0
s_waitcnt lgkmcnt(0)
v_smfmac_f32_16x16x64_bf16 v[24:27], v[76:79], v[44:51], v0
ds_read_b128 v[44:47], v2 offset:12288
v_add_f32 v20, v20, v22
v_cvt_pk_bf16_f32 v22, v20, v21
v_smfmac_f32_16x16x64_bf16 v[28:31], v[76:79], v[240:247], v0
ds_read_b128 v[48:51], v2 offset:13312
v_smfmac_f32_16x16x64_bf16 v[28:31], v[64:67], a[0:7], v0
v_add_f32 v25, v25, v27
v_add_f32 v24, v24, v26
v_cvt_pk_bf16_f32 v23, v24, v25
v_smfmac_f32_16x16x64_bf16 v[28:31], v[72:75], a[32:39], v0
ds_write_b64 v3, v[22:23] offset:11264
v_smfmac_f32_16x16x64_bf16 v[32:35], v[76:79], v[248:255], v0
s_waitcnt lgkmcnt(1)
v_smfmac_f32_16x16x64_bf16 v[28:31], v[60:63], v[44:51], v0
ds_read_b128 v[48:51], v2 offset:15360
v_smfmac_f32_16x16x64_bf16 v[28:31], v[68:71], a[16:23], v0
ds_read_b128 v[44:47], v2 offset:14336
s_waitcnt vmcnt(1)
v_smfmac_f32_16x16x64_bf16 v[32:35], v[64:67], a[8:15], v0
s_waitcnt lgkmcnt(2)
s_barrier
ds_read_b64_tr_b16 v[20:21], v4 offset:10240
v_smfmac_f32_16x16x64_bf16 v[32:35], v[68:71], a[24:31], v0
ds_read_b64_tr_b16 v[22:23], v4 offset:10752
v_add_f32 v29, v29, v31
v_smfmac_f32_16x16x64_bf16 v[32:35], v[72:75], a[40:47], v0
ds_read_b64_tr_b16 v[24:25], v4 offset:11264
ds_read_b64_tr_b16 v[26:27], v4 offset:11776
s_waitcnt lgkmcnt(4)
v_smfmac_f32_16x16x64_bf16 v[32:35], v[60:63], v[44:51], v0
ds_read_b128 v[48:51], v2 offset:19456
s_waitcnt lgkmcnt(3)
v_mfma_f32_16x16x32_bf16 v[12:15], v[12:15], v[20:23], 0
ds_read_b128 v[44:47], v2 offset:18432
v_add_f32 v28, v28, v30
s_waitcnt lgkmcnt(2)
v_mfma_f32_16x16x32_bf16 v[12:15], v[16:19], v[24:27], v[12:15]
v_add_f32 v33, v33, v35
v_add_f32 v32, v32, v34
v_cvt_pk_bf16_f32 v30, v28, v29
v_cvt_pk_bf16_f32 v31, v32, v33
v_smfmac_f32_16x16x64_bf16 v[36:39], v[76:79], a[112:119], v0
ds_write_b64 v3, v[30:31] offset:13312
v_add_f32_dpp v12, v14, v12 quad_perm:[2,3,0,1] row_mask:0xf bank_mask:0xf
v_exp_f32 v14, v12
v_add_f32_dpp v13, v15, v13 quad_perm:[2,3,0,1] row_mask:0xf bank_mask:0xf
v_exp_f32 v15, v13
s_nop 0
v_cvt_pk_bf16_f32 v14, v14, v15
v_smfmac_f32_16x16x64_bf16 v[40:43], v[76:79], a[120:127], v0
ds_write_b32 v5, v14 offset:14880
s_waitcnt lgkmcnt(2)
v_smfmac_f32_16x16x64_bf16 v[40:43], v[72:75], v[44:51], v0
ds_read_b128 v[44:47], v2 offset:16384
s_waitcnt lgkmcnt(2)
s_barrier
ds_read_b64_tr_b16 v[28:29], v4 offset:12288
v_smfmac_f32_16x16x64_bf16 v[36:39], v[60:63], a[128:135], v0
ds_read_b64_tr_b16 v[30:31], v4 offset:12800
ds_read_b64_tr_b16 v[32:33], v4 offset:13312
v_smfmac_f32_16x16x64_bf16 v[40:43], v[60:63], a[136:143], v0
ds_read_b64_tr_b16 v[34:35], v4 offset:13824
v_mov_b64 v[76:77], s[52:53]
s_waitcnt lgkmcnt(2)
v_mfma_f32_16x16x32_bf16 v[28:31], v[28:31], v[20:23], 0
s_barrier
ds_read_b128 v[16:19], v1 offset:14368
s_waitcnt lgkmcnt(1)
v_mfma_f32_16x16x32_bf16 v[28:31], v[32:35], v[24:27], v[28:31]
ds_read_b128 v[60:63], v1 offset:14336
v_mov_b64 v[14:15], s[0:1]
v_smfmac_f32_16x16x64_bf16 v[40:43], v[64:67], a[152:159], v0
ds_read_b128 v[48:51], v2 offset:17408
v_mov_b64 v[78:79], s[52:53]
v_smfmac_f32_16x16x64_bf16 v[40:43], v[68:71], a[168:175], v0
v_add_f32_dpp v28, v30, v28 quad_perm:[2,3,0,1] row_mask:0xf bank_mask:0xf
v_mul_f32 v28, s50, v28
v_smfmac_f32_16x16x64_bf16 v[36:39], v[64:67], a[144:151], v0
ds_read_b128 v[64:67], v2 offset:23552
v_add_f32_dpp v29, v31, v29 quad_perm:[2,3,0,1] row_mask:0xf bank_mask:0xf
v_smfmac_f32_16x16x64_bf16 v[36:39], v[68:71], a[160:167], v0
ds_read_b128 v[68:71], v2 offset:24576
s_waitcnt lgkmcnt(2)
v_smfmac_f32_16x16x64_bf16 v[36:39], v[72:75], v[44:51], v0
ds_read_b128 v[72:75], v2 offset:25600
v_cvt_pk_bf16_f32 v40, v40, v41
v_mfma_f32_16x16x32_bf16 v[32:35], v[76:79], v[16:19], 0
ds_read_b128 v[44:47], v2 offset:20480
v_mul_f32 v29, s50, v29
v_exp_f32 v30, v28
v_mfma_f32_16x16x32_bf16 v[20:23], v[52:55], v[16:19], 0
v_exp_f32 v31, v29
v_cvt_pk_bf16_f32 v41, v42, v43
v_cvt_pk_bf16_f32 v43, v38, v39
v_mov_b64 v[76:77], 0
v_mfma_f32_16x16x32_bf16 v[20:23], v[56:59], v[60:63], v[20:23]
v_cvt_pk_bf16_f32 v30, v30, v31
v_cndmask_b32_e64 v26, 0, v30, s[56:57]
v_cndmask_b32_e64 v27, 0, v30, s[56:57]
s_nop 0
v_mov_b32_dpp v24, v26 quad_perm:[2,3,0,1] row_mask:0xf bank_mask:0xf
v_mfma_f32_16x16x16_bf16 v[32:35], v[14:15], v[26:27], v[32:35]
v_cvt_pk_bf16_f32 v42, v36, v37
v_mov_b32_dpp v25, v26 quad_perm:[2,3,0,1] row_mask:0xf bank_mask:0xf
s_nop 1
v_mfma_f32_16x16x32_bf16 v[20:23], v[40:43], v[24:27], v[20:23]
ds_read_b128 v[60:63], v2 offset:22528
ds_read_b128 v[48:51], v2 offset:21504
v_rcp_f32 v33, v32
v_mov_b64 v[36:37], 0
v_mov_b64 v[78:79], 0
v_min_f32 v32, v32, v33
v_cmp_nlt_f32 vcc, s2, v32
v_mul_f32_dpp v23, v33, v23 quad_perm:[0,1,0,1] row_mask:0xf bank_mask:0xf
v_mul_f32_dpp v21, v33, v21 quad_perm:[0,1,0,1] row_mask:0xf bank_mask:0xf
v_mul_f32_dpp v22, v33, v22 quad_perm:[0,1,0,1] row_mask:0xf bank_mask:0xf
v_mul_f32_dpp v20, v33, v20 quad_perm:[0,1,0,1] row_mask:0xf bank_mask:0xf
v_cvt_pk_bf16_f32 v20, v20, v21
v_cvt_pk_bf16_f32 v21, v22, v23
ds_write_b64 v6, v[20:21] offset:7168
s_and_b64 vcc, vcc, s[56:57]
v_mov_b32_dpp v16, v20 quad_perm:[0,1,0,1] row_mask:0xf bank_mask:0xf
v_mov_b32_dpp v19, v21 quad_perm:[2,3,2,3] row_mask:0xf bank_mask:0xf
s_cbranch_scc1 L_mx_w2rs
L_mxb_w2rs:
v_mov_b32_dpp v18, v20 quad_perm:[2,3,2,3] row_mask:0xf bank_mask:0xf
v_mov_b64 v[38:39], 0
v_mov_b32_dpp v17, v21 quad_perm:[0,1,0,1] row_mask:0xf bank_mask:0xf
v_mov_b64 v[26:27], 0
v_mov_b64 v[24:25], 0
v_mov_b64 v[32:33], 0
v_smfmac_f32_16x16x64_bf16 v[76:79], v[16:19], a[176:183], v0
s_waitcnt lgkmcnt(0)
s_barrier
ds_read_b128 v[12:15], v7 offset:5120
ds_read_b128 v[52:55], v7 offset:8192
v_smfmac_f32_16x16x64_bf16 v[36:39], v[16:19], a[184:191], v0
ds_read_b128 v[56:59], v7 offset:6144
v_mov_b64 v[34:35], 0
v_smfmac_f32_16x16x64_bf16 v[24:27], v[16:19], a[192:199], v0
v_smfmac_f32_16x16x64_bf16 v[32:35], v[16:19], a[200:207], v0
s_waitcnt lgkmcnt(2)
v_smfmac_f32_16x16x64_bf16 v[76:79], v[12:15], a[208:215], v0
s_waitcnt lgkmcnt(1)
v_smfmac_f32_16x16x64_bf16 v[76:79], v[52:55], a[216:223], v0
s_waitcnt lgkmcnt(0)
v_smfmac_f32_16x16x64_bf16 v[76:79], v[56:59], a[224:231], v0
v_smfmac_f32_16x16x64_bf16 v[36:39], v[12:15], v[44:51], v0
ds_read_b128 v[48:51], v2 offset:27648
ds_read_b128 v[44:47], v2 offset:26624
v_smfmac_f32_16x16x64_bf16 v[36:39], v[52:55], a[232:239], v0
v_cvt_pk_bf16_f32 v77, v77, v79
v_cvt_pk_bf16_f32 v76, v76, v78
v_bfi_b32 v76, 1, s35, v76
v_smfmac_f32_16x16x64_bf16 v[36:39], v[56:59], v[60:67], v0
buffer_store_dwordx2 v[76:77], v8, s[4:7], s42 offen sc0 sc1
ds_read_b128 v[60:63], v2 offset:28672
v_smfmac_f32_16x16x64_bf16 v[24:27], v[12:15], v[68:75], v0
ds_read_b128 v[64:67], v2 offset:29696
v_smfmac_f32_16x16x64_bf16 v[24:27], v[52:55], a[240:247], v0
ds_read_b128 v[68:71], v2 offset:30720
v_cvt_pk_bf16_f32 v36, v36, v38
v_bfi_b32 v36, 1, s35, v36
v_cvt_pk_bf16_f32 v37, v37, v39
s_waitcnt lgkmcnt(3)
v_smfmac_f32_16x16x64_bf16 v[24:27], v[56:59], v[44:51], v0
buffer_store_dwordx2 v[36:37], v8, s[4:7], s43 offen sc0 sc1
ds_read_b128 v[72:75], v2 offset:31744
v_smfmac_f32_16x16x64_bf16 v[32:35], v[52:55], a[248:255], v0
s_waitcnt lgkmcnt(2)
v_smfmac_f32_16x16x64_bf16 v[32:35], v[12:15], v[60:67], v0
v_cvt_pk_bf16_f32 v25, v25, v27
v_cvt_pk_bf16_f32 v24, v24, v26
v_bfi_b32 v24, 1, s35, v24
buffer_store_dwordx2 v[24:25], v8, s[4:7], s44 offen sc0 sc1
s_waitcnt lgkmcnt(0)
v_smfmac_f32_16x16x64_bf16 v[32:35], v[56:59], v[68:75], v0
s_nop 7
v_cvt_pk_bf16_f32 v33, v33, v35
v_cvt_pk_bf16_f32 v32, v32, v34
v_bfi_b32 v32, 1, s35, v32
buffer_store_dwordx2 v[32:33], v8, s[4:7], s45 offen sc0 sc1
s_branch L_ex_w2rs
.p2align 6
L_ex_w3s:
s_add_u32 s34, s34, 1
s_not_b32 s35, s35
s_not_b32 s36, s36
s_add_u32 s37, s37, 524288
s_add_u32 s39, s39, 524288
v_mov_b64 v[20:21], 0
v_mov_b64 v[22:23], 0
v_mov_b64 v[24:25], 0
v_mov_b64 v[26:27], 0
v_mov_b64 v[28:29], 0
v_mov_b64 v[30:31], 0
v_mov_b64 v[32:33], 0
v_mov_b64 v[34:35], 0
v_mov_b64 v[36:37], 0
v_mov_b64 v[38:39], 0
v_mov_b64 v[40:41], 0
v_mov_b64 v[42:43], 0
ds_read_b128 v[44:47], v2 offset:0
ds_read_b128 v[48:51], v2 offset:1024
v_bfe_u32 v77, v1, 6, 1
v_lshl_add_u32 v77, v77, 3, v1
v_lshlrev_b32 v77, 1, v77
v_lshlrev_b32 v78, 3, v1
s_barrier
s_cmp_eq_u32 s34, 63
s_cbranch_scc1 L_done_w3s
s_add_u32 s100, s34, 1
s_lshr_b32 s100, s100, 2
s_waitcnt vmcnt(4)
L_evb_w3s:
v_max_u32 v10, v10, v11
v_bfe_u32 v11, v1, 2, 6
v_cmp_ge_u32 vcc, s100, v10
s_cbranch_vccnz L_ev_w3s
s_add_u32 s100, s34, 4
s_lshr_b32 s100, s100, 2
s_min_u32 s100, s100, 15
v_cmp_ge_u32 vcc, s100, v10
s_nop 0
s_cmp_eq_u64 vcc, 0
s_cselect_b32 s3, 268435456, s101
L_top_w3s:
s_barrier
ds_read_b128 v[60:63], v1 offset:1024
s_mov_b32 m0, 5120
s_nop 0
buffer_load_dwordx4 v1, s[4:7], s48 offen offset:3072 sc0 sc1 lds
s_barrier
ds_read_b128 v[64:67], v1 offset:2048
ds_read_b128 v[68:71], v1 offset:3072
ds_read_b128 v[72:75], v1 offset:4096
L_s0_w3s:
s_waitcnt lgkmcnt(3)
v_smfmac_f32_16x16x64_bf16 v[32:35], v[60:63], v[184:191], v0
s_mov_b32 m0, 9216
s_nop 0
buffer_load_dwordx4 v1, s[4:7], s49 offen offset:0 sc0 sc1 lds
v_smfmac_f32_16x16x64_bf16 v[20:23], v[60:63], v[44:51], v0
v_smfmac_f32_16x16x64_bf16 v[28:31], v[60:63], v[176:183], v0
s_waitcnt lgkmcnt(2)
v_smfmac_f32_16x16x64_bf16 v[28:31], v[64:67], v[192:199], v0
ds_read_b128 v[48:51], v2 offset:3072
v_smfmac_f32_16x16x64_bf16 v[36:39], v[60:63], a[48:55], v0
ds_read_b128 v[44:47], v2 offset:2048
v_smfmac_f32_16x16x64_bf16 v[40:43], v[60:63], a[56:63], v0
buffer_load_dwordx4 v[12:15], v9, s[4:7], s37 offen offset:0
v_smfmac_f32_16x16x64_bf16 v[24:27], v[64:67], v[88:95], v0
v_smfmac_f32_16x16x64_bf16 v[20:23], v[64:67], v[80:87], v0
v_bitop3_b32 v6, v60, v64, s35 bitop3:0x7e
v_smfmac_f32_16x16x64_bf16 v[32:35], v[64:67], v[200:207], v0
buffer_load_dwordx4 v[16:19], v9, s[4:7], s37 offen offset:1024
s_waitcnt lgkmcnt(0)
v_smfmac_f32_16x16x64_bf16 v[24:27], v[60:63], v[44:51], v0
v_bitop3_b32 v76, v68, v72, s35 bitop3:0x7e
v_bitop3_b32 v6, v6, v76, 1 bitop3:0xa8
v_smfmac_f32_16x16x64_bf16 v[36:39], v[64:67], a[64:71], v0
v_cmp_ne_u32 vcc, 0, v6
v_smfmac_f32_16x16x64_bf16 v[40:43], v[64:67], a[72:79], v0
buffer_load_dwordx4 v[52:55], v1, s[4:7], s37 offen offset:2048
ds_read_b128 v[44:47], v2 offset:4096
v_smfmac_f32_16x16x64_bf16 v[20:23], v[68:71], v[96:103], v0
ds_read_b128 v[48:51], v2 offset:5120
buffer_load_dwordx4 v[56:59], v1, s[4:7], s37 offen offset:3072
s_mov_b32 m0, 0
v_smfmac_f32_16x16x64_bf16 v[24:27], v[68:71], v[104:111], v0
s_cbranch_vccnz L_ra0_w3s
s_waitcnt vmcnt(4)
s_barrier
ds_read_b32 v6, v77 offset:8192
v_smfmac_f32_16x16x64_bf16 v[28:31], v[68:71], v[208:215], v0
buffer_load_dword v78, s[4:7], s39 offen lds
buffer_load_dword v11, v11, s[4:7], s3 offen sc1
v_smfmac_f32_16x16x64_bf16 v[36:39], v[68:71], a[80:87], v0
ds_read_b128 v[60:63], v1 offset:6144
v_smfmac_f32_16x16x64_bf16 v[28:31], v[72:75], v[224:231], v0
ds_read_b128 v[76:79], v1 offset:5120
s_waitcnt lgkmcnt(3)
v_smfmac_f32_16x16x64_bf16 v[20:23], v[72:75], v[44:51], v0
ds_read_b128 v[64:67], v1 offset:7168
v_smfmac_f32_16x16x64_bf16 v[32:35], v[68:71], v[216:223], v0
ds_read_b128 v[44:47], v2 offset:6144
v_smfmac_f32_16x16x64_bf16 v[40:43], v[68:71], a[88:95], v0
ds_read_b128 v[48:51], v2 offset:7168
s_waitcnt lgkmcnt(4)
v_bitop3_b32 v6, v6, v60, s35 bitop3:0x7e
ds_read_b128 v[68:71], v1 offset:8192
v_smfmac_f32_16x16x64_bf16 v[32:35], v[72:75], v[232:239], v0
s_waitcnt lgkmcnt(3)
v_bitop3_b32 v6, v6, v64, s35 bitop3:0xf6
v_bitop3_b32 v6, v6, v76, s35 bitop3:0xf6
v_and_b32 v6, 1, v6
s_waitcnt lgkmcnt(1)
v_smfmac_f32_16x16x64_bf16 v[24:27], v[72:75], v[44:51], v0
ds_read_b128 v[44:47], v2 offset:8192
v_cmp_ne_u32 vcc, 0, v6
v_smfmac_f32_16x16x64_bf16 v[36:39], v[72:75], a[96:103], v0
ds_read_b128 v[48:51], v2 offset:9216
v_smfmac_f32_16x16x64_bf16 v[40:43], v[72:75], a[104:111], v0
ds_read_b128 v[72:75], v1 offset:9216
s_cbranch_vccnz L_ra1_w3s
L_a1_w3s:
v_smfmac_f32_16x16x64_bf16 v[20:23], v[60:63], v[112:119], v0
v_smfmac_f32_16x16x64_bf16 v[20:23], v[64:67], v[128:135], v0
s_waitcnt lgkmcnt(1)
v_smfmac_f32_16x16x64_bf16 v[20:23], v[76:79], v[44:51], v0
ds_read_b128 v[48:51], v2 offset:11264
v_bfe_u32 v6, v1, 5, 1
v_mad_i32_i24 v6, v6, s55, v1
v_smfmac_f32_16x16x64_bf16 v[20:23], v[68:71], v[144:151], v0
s_waitcnt lgkmcnt(1)
v_smfmac_f32_16x16x64_bf16 v[20:23], v[72:75], v[160:167], v0
v_smfmac_f32_16x16x64_bf16 v[24:27], v[60:63], v[120:127], v0
ds_read_b128 v[44:47], v2 offset:10240
v_smfmac_f32_16x16x64_bf16 v[24:27], v[64:67], v[136:143], v0
v_smfmac_f32_16x16x64_bf16 v[24:27], v[68:71], v[152:159], v0
v_add_f32 v21, v21, v23
v_smfmac_f32_16x16x64_bf16 v[24:27], v[72:75], v[168:175], v0
s_waitcnt lgkmcnt(0)
v_smfmac_f32_16x16x64_bf16 v[24:27], v[76:79], v[44:51], v0
ds_read_b128 v[44:47], v2 offset:12288
v_add_f32 v20, v20, v22
v_cvt_pk_bf16_f32 v22, v20, v21
v_smfmac_f32_16x16x64_bf16 v[28:31], v[76:79], v[240:247], v0
ds_read_b128 v[48:51], v2 offset:13312
v_smfmac_f32_16x16x64_bf16 v[28:31], v[64:67], a[0:7], v0
v_add_f32 v25, v25, v27
v_add_f32 v24, v24, v26
v_cvt_pk_bf16_f32 v23, v24, v25
v_smfmac_f32_16x16x64_bf16 v[28:31], v[72:75], a[32:39], v0
ds_write_b64 v3, v[22:23] offset:11776
v_smfmac_f32_16x16x64_bf16 v[32:35], v[76:79], v[248:255], v0
s_waitcnt lgkmcnt(1)
v_smfmac_f32_16x16x64_bf16 v[28:31], v[60:63], v[44:51], v0
ds_read_b128 v[48:51], v2 offset:15360
v_smfmac_f32_16x16x64_bf16 v[28:31], v[68:71], a[16:23], v0
ds_read_b128 v[44:47], v2 offset:14336
s_waitcnt vmcnt(2)
v_smfmac_f32_16x16x64_bf16 v[32:35], v[64:67], a[8:15], v0
s_waitcnt lgkmcnt(2)
s_barrier
v_smfmac_f32_16x16x64_bf16 v[32:35], v[68:71], a[24:31], v0
ds_read_b64_tr_b16 v[20:21], v4 offset:10240
ds_read_b64_tr_b16 v[22:23], v4 offset:10752
v_add_f32 v29, v29, v31
v_smfmac_f32_16x16x64_bf16 v[32:35], v[72:75], a[40:47], v0
ds_read_b64_tr_b16 v[24:25], v4 offset:11264
ds_read_b64_tr_b16 v[26:27], v4 offset:11776
s_waitcnt lgkmcnt(4)
v_smfmac_f32_16x16x64_bf16 v[32:35], v[60:63], v[44:51], v0
ds_read_b128 v[48:51], v2 offset:19456
s_waitcnt lgkmcnt(3)
v_mfma_f32_16x16x32_bf16 v[12:15], v[12:15], v[20:23], 0
ds_read_b128 v[44:47], v2 offset:18432
v_add_f32 v28, v28, v30
s_waitcnt lgkmcnt(2)
v_mfma_f32_16x16x32_bf16 v[12:15], v[16:19], v[24:27], v[12:15]
v_add_f32 v32, v32, v34
v_add_f32 v33, v33, v35
v_cvt_pk_bf16_f32 v30, v28, v29
v_cvt_pk_bf16_f32 v31, v32, v33
v_smfmac_f32_16x16x64_bf16 v[36:39], v[76:79], a[112:119], v0
ds_write_b64 v3, v[30:31] offset:13824
v_add_f32_dpp v12, v14, v12 quad_perm:[2,3,0,1] row_mask:0xf bank_mask:0xf
v_exp_f32 v14, v12
v_add_f32_dpp v13, v15, v13 quad_perm:[2,3,0,1] row_mask:0xf bank_mask:0xf
v_exp_f32 v15, v13
s_nop 0
v_cvt_pk_bf16_f32 v14, v14, v15
v_smfmac_f32_16x16x64_bf16 v[40:43], v[76:79], a[120:127], v0
ds_write_b32 v5, v14 offset:15136
s_waitcnt lgkmcnt(1)
s_barrier
ds_read_b64_tr_b16 v[28:29], v4 offset:12288
v_smfmac_f32_16x16x64_bf16 v[36:39], v[60:63], a[128:135], v0
ds_read_b64_tr_b16 v[30:31], v4 offset:12800
ds_read_b64_tr_b16 v[32:33], v4 offset:13312
v_smfmac_f32_16x16x64_bf16 v[40:43], v[60:63], a[136:143], v0
ds_read_b64_tr_b16 v[34:35], v4 offset:13824
v_mov_b64 v[76:77], s[52:53]
v_smfmac_f32_16x16x64_bf16 v[40:43], v[72:75], v[44:51], v0
ds_read_b128 v[44:47], v2 offset:16384
s_waitcnt lgkmcnt(3)
v_mfma_f32_16x16x32_bf16 v[28:31], v[28:31], v[20:23], 0
s_barrier
ds_read_b128 v[16:19], v1 offset:14368
s_waitcnt lgkmcnt(2)
v_mfma_f32_16x16x32_bf16 v[28:31], v[32:35], v[24:27], v[28:31]
ds_read_b128 v[60:63], v1 offset:14336
v_mov_b64 v[14:15], s[0:1]
v_smfmac_f32_16x16x64_bf16 v[40:43], v[64:67], a[152:159], v0
ds_read_b128 v[48:51], v2 offset:17408
v_mov_b64 v[78:79], s[52:53]
v_smfmac_f32_16x16x64_bf16 v[40:43], v[68:71], a[168:175], v0
v_add_f32_dpp v28, v30, v28 quad_perm:[2,3,0,1] row_mask:0xf bank_mask:0xf
v_mul_f32 v28, s50, v28
v_smfmac_f32_16x16x64_bf16 v[36:39], v[64:67], a[144:151], v0
ds_read_b128 v[64:67], v2 offset:21504
v_add_f32_dpp v29, v31, v29 quad_perm:[2,3,0,1] row_mask:0xf bank_mask:0xf
v_smfmac_f32_16x16x64_bf16 v[36:39], v[68:71], a[160:167], v0
ds_read_b128 v[68:71], v2 offset:26624
s_waitcnt lgkmcnt(2)
v_smfmac_f32_16x16x64_bf16 v[36:39], v[72:75], v[44:51], v0
ds_read_b128 v[72:75], v2 offset:27648
v_cvt_pk_bf16_f32 v40, v40, v41
v_exp_f32 v30, v28
v_mfma_f32_16x16x32_bf16 v[32:35], v[76:79], v[16:19], 0
ds_read_b128 v[44:47], v2 offset:22528
v_mul_f32 v29, s50, v29
v_mfma_f32_16x16x32_bf16 v[20:23], v[52:55], v[16:19], 0
v_exp_f32 v31, v29
v_mfma_f32_16x16x32_bf16 v[20:23], v[56:59], v[60:63], v[20:23]
v_cvt_pk_bf16_f32 v41, v42, v43
v_cvt_pk_bf16_f32 v30, v30, v31
v_cndmask_b32_e64 v26, 0, v30, s[56:57]
v_cvt_pk_bf16_f32 v43, v38, v39
v_cndmask_b32_e64 v27, 0, v30, s[56:57]
v_mov_b32_dpp v24, v26 quad_perm:[2,3,0,1] row_mask:0xf bank_mask:0xf
v_mov_b64 v[76:77], 0
v_mfma_f32_16x16x16_bf16 v[32:35], v[14:15], v[26:27], v[32:35]
v_cvt_pk_bf16_f32 v42, v36, v37
v_mov_b32_dpp v25, v26 quad_perm:[2,3,0,1] row_mask:0xf bank_mask:0xf
s_nop 1
v_mfma_f32_16x16x32_bf16 v[20:23], v[40:43], v[24:27], v[20:23]
ds_read_b128 v[48:51], v2 offset:23552
s_nop 0
v_rcp_f32 v33, v32
ds_read_b128 v[60:63], v2 offset:20480
v_mov_b64 v[36:37], 0
v_min_f32 v32, v32, v33
v_cmp_nlt_f32 vcc, s2, v32
v_mov_b64 v[78:79], 0
v_mul_f32_dpp v23, v33, v23 quad_perm:[0,1,0,1] row_mask:0xf bank_mask:0xf
v_mul_f32_dpp v21, v33, v21 quad_perm:[0,1,0,1] row_mask:0xf bank_mask:0xf
v_mul_f32_dpp v22, v33, v22 quad_perm:[0,1,0,1] row_mask:0xf bank_mask:0xf
v_mul_f32_dpp v20, v33, v20 quad_perm:[0,1,0,1] row_mask:0xf bank_mask:0xf
v_cvt_pk_bf16_f32 v20, v20, v21
v_cvt_pk_bf16_f32 v21, v22, v23
ds_write_b64 v6, v[20:21] offset:8192
s_and_b64 vcc, vcc, s[56:57]
v_mov_b64 v[38:39], 0
s_cbranch_scc1 L_mx_w3s
L_mxb_w3s:
v_mov_b32_dpp v16, v20 quad_perm:[0,1,0,1] row_mask:0xf bank_mask:0xf
v_mov_b32_dpp v19, v21 quad_perm:[2,3,2,3] row_mask:0xf bank_mask:0xf
v_mov_b64 v[24:25], 0
v_mov_b32_dpp v18, v20 quad_perm:[2,3,2,3] row_mask:0xf bank_mask:0xf
v_mov_b32_dpp v17, v21 quad_perm:[0,1,0,1] row_mask:0xf bank_mask:0xf
v_mov_b64 v[26:27], 0
v_mov_b64 v[32:33], 0
v_smfmac_f32_16x16x64_bf16 v[76:79], v[16:19], a[176:183], v0
s_waitcnt lgkmcnt(0)
s_barrier
ds_read_b128 v[12:15], v7 offset:6144
ds_read_b128 v[52:55], v7 offset:7168
v_smfmac_f32_16x16x64_bf16 v[36:39], v[16:19], a[184:191], v0
ds_read_b128 v[56:59], v7 offset:5120
v_mov_b64 v[34:35], 0
s_nop 1
v_smfmac_f32_16x16x64_bf16 v[32:35], v[16:19], a[200:207], v0
v_smfmac_f32_16x16x64_bf16 v[24:27], v[16:19], a[192:199], v0
s_waitcnt lgkmcnt(2)
v_smfmac_f32_16x16x64_bf16 v[76:79], v[12:15], a[208:215], v0
s_waitcnt lgkmcnt(1)
v_smfmac_f32_16x16x64_bf16 v[76:79], v[52:55], a[216:223], v0
s_waitcnt lgkmcnt(0)
v_smfmac_f32_16x16x64_bf16 v[76:79], v[56:59], a[224:231], v0
v_smfmac_f32_16x16x64_bf16 v[36:39], v[12:15], v[44:51], v0
ds_read_b128 v[48:51], v2 offset:25600
ds_read_b128 v[44:47], v2 offset:24576
v_smfmac_f32_16x16x64_bf16 v[36:39], v[52:55], a[232:239], v0
v_cvt_pk_bf16_f32 v77, v77, v79
v_cvt_pk_bf16_f32 v76, v76, v78
v_bfi_b32 v76, 1, s35, v76
v_smfmac_f32_16x16x64_bf16 v[36:39], v[56:59], v[60:67], v0
buffer_store_dwordx2 v[76:77], v8, s[4:7], s42 offen sc0 sc1
ds_read_b128 v[60:63], v2 offset:30720
v_smfmac_f32_16x16x64_bf16 v[24:27], v[12:15], v[68:75], v0
ds_read_b128 v[64:67], v2 offset:31744
v_smfmac_f32_16x16x64_bf16 v[24:27], v[52:55], a[240:247], v0
ds_read_b128 v[68:71], v2 offset:28672
v_cvt_pk_bf16_f32 v36, v36, v38
v_bfi_b32 v36, 1, s35, v36
v_cvt_pk_bf16_f32 v37, v37, v39
s_waitcnt lgkmcnt(3)
v_smfmac_f32_16x16x64_bf16 v[24:27], v[56:59], v[44:51], v0
buffer_store_dwordx2 v[36:37], v8, s[4:7], s43 offen sc0 sc1
ds_read_b128 v[72:75], v2 offset:29696
s_nop 5
v_cvt_pk_bf16_f32 v25, v25, v27
v_cvt_pk_bf16_f32 v24, v24, v26
v_bfi_b32 v24, 1, s35, v24
v_smfmac_f32_16x16x64_bf16 v[32:35], v[52:55], a[248:255], v0
s_waitcnt lgkmcnt(2)
v_smfmac_f32_16x16x64_bf16 v[32:35], v[12:15], v[60:67], v0
buffer_store_dwordx2 v[24:25], v8, s[4:7], s44 offen sc0 sc1
s_waitcnt lgkmcnt(0)
v_smfmac_f32_16x16x64_bf16 v[32:35], v[56:59], v[68:75], v0
s_nop 7
v_cvt_pk_bf16_f32 v33, v33, v35
v_cvt_pk_bf16_f32 v32, v32, v34
v_bfi_b32 v32, 1, s35, v32
buffer_store_dwordx2 v[32:33], v8, s[4:7], s45 offen sc0 sc1
s_branch L_ex_w3s
L_pro_w2r:
v_and_b32 v20, 63, v0
v_lshlrev_b32 v1, 4, v20
v_add_u32 v2, 98304, v1
v_and_b32 v23, 1, v22
v_lshl_add_u32 v23, v24, 4, v23
v_mul_u32_u24 v23, 1152, v23
v_lshlrev_b32 v28, 2, v22
v_xor_b32 v28, v28, v21
v_lshl_add_u32 v28, v28, 4, v23
s_mul_i32 s55, s32, 147456
s_waitcnt lgkmcnt(0)
v_and_b32 v23, 1, v22
v_lshrrev_b32 v24, 2, v21
v_lshl_add_u32 v23, v23, 2, v24
v_lshlrev_b32 v23, 1, v23
v_bfe_u32 v44, v21, 1, 1
v_add_u32 v44, 8, v44
v_xor_b32 v44, v44, v23
v_lshlrev_b32 v44, 4, v44
v_lshl_add_u32 v44, v24, 8, v44
v_and_b32 v23, 1, v22
v_lshl_add_u32 v44, v23, 11, v44
v_and_b32 v23, 1, v21
v_lshl_add_u32 v44, v23, 3, v44
v_lshrrev_b32 v23, 1, v22
v_mul_u32_u24 v23, 40960, v23
v_add_u32 v23, 16384, v23
v_add_u32 v44, v44, v23
v_and_b32 v23, 1, v22
v_lshrrev_b32 v24, 2, v21
v_lshl_add_u32 v23, v23, 2, v24
v_lshlrev_b32 v23, 1, v23
v_bfe_u32 v45, v21, 1, 1
v_add_u32 v45, 10, v45
v_xor_b32 v45, v45, v23
v_lshlrev_b32 v45, 4, v45
v_lshl_add_u32 v45, v24, 8, v45
v_and_b32 v23, 1, v22
v_lshl_add_u32 v45, v23, 11, v45
v_and_b32 v23, 1, v21
v_lshl_add_u32 v45, v23, 3, v45
v_lshrrev_b32 v23, 1, v22
v_mul_u32_u24 v23, 40960, v23
v_add_u32 v23, 16384, v23
v_add_u32 v45, v45, v23
v_and_b32 v23, 1, v22
v_lshrrev_b32 v24, 2, v21
v_lshl_add_u32 v23, v23, 2, v24
v_lshlrev_b32 v23, 1, v23
v_bfe_u32 v46, v21, 1, 1
v_add_u32 v46, 8, v46
v_xor_b32 v46, v46, v23
v_lshlrev_b32 v46, 4, v46
v_lshl_add_u32 v46, v24, 8, v46
v_and_b32 v23, 1, v22
v_lshl_add_u32 v46, v23, 11, v46
v_and_b32 v23, 1, v21
v_lshl_add_u32 v46, v23, 3, v46
v_lshrrev_b32 v23, 1, v22
v_mul_u32_u24 v23, 32768, v23
v_add_u32 v23, 98304, v23
v_add_u32 v46, v46, v23
v_and_b32 v23, 1, v22
v_lshrrev_b32 v24, 2, v21
v_lshl_add_u32 v23, v23, 2, v24
v_lshlrev_b32 v23, 1, v23
v_bfe_u32 v47, v21, 1, 1
v_add_u32 v47, 10, v47
v_xor_b32 v47, v47, v23
v_lshlrev_b32 v47, 4, v47
v_lshl_add_u32 v47, v24, 8, v47
v_and_b32 v23, 1, v22
v_lshl_add_u32 v47, v23, 11, v47
v_and_b32 v23, 1, v21
v_lshl_add_u32 v47, v23, 3, v47
v_lshrrev_b32 v23, 1, v22
v_mul_u32_u24 v23, 32768, v23
v_add_u32 v23, 98304, v23
v_add_u32 v47, v47, v23
v_and_b32 v23, 1, v22
v_bfe_u32 v24, v21, 2, 1
v_lshl_add_u32 v23, v23, 1, v24
v_xor_b32 v24, 2, v23
v_lshlrev_b32 v24, 6, v24
v_lshl_add_u32 v48, v23, 8, v24
v_and_b32 v23, 3, v21
v_lshl_add_u32 v48, v23, 4, v48
v_and_b32 v23, 8, v21
v_add_u32 v48, v48, v23
v_lshrrev_b32 v23, 1, v22
v_mul_u32_u24 v23, 40960, v23
v_add_u32 v23, 16384, v23
v_add_u32 v48, v48, v23
v_and_b32 v23, 1, v22
v_bfe_u32 v24, v21, 2, 1
v_lshl_add_u32 v23, v23, 1, v24
v_xor_b32 v24, 2, v23
v_lshlrev_b32 v24, 6, v24
v_lshl_add_u32 v49, v23, 8, v24
v_and_b32 v23, 3, v21
v_lshl_add_u32 v49, v23, 4, v49
v_and_b32 v23, 8, v21
v_add_u32 v49, v49, v23
v_lshrrev_b32 v23, 1, v22
v_mul_u32_u24 v23, 32768, v23
v_add_u32 v23, 98304, v23
v_add_u32 v49, v49, v23
v_bfe_u32 v23, v21, 1, 1
v_mul_u32_u24 v23, 0xaaaa, v23
v_add_u32 v0, 0x4444, v23
v_lshlrev_b32 v3, 3, v20
v_lshrrev_b32 v25, 5, v20
v_lshlrev_b32 v25, 6, v25
v_xor_b32 v3, v3, v25
v_lshrrev_b32 v25, 2, v20
v_and_b32 v4, 3, v21
v_lshl_add_u32 v4, v4, 4, v25
v_lshlrev_b32 v4, 3, v4
v_bfe_u32 v25, v21, 1, 1
v_lshlrev_b32 v23, 6, v25
v_xor_b32 v4, v4, v23
v_lshlrev_b32 v5, 4, v21
v_lshl_add_u32 v5, v22, 2, v5
v_mul_u32_u24 v23, 512, v25
v_add_u32 v5, v5, v23
v_lshlrev_b32 v9, 8, v22
v_lshl_add_u32 v9, v25, 6, v9
v_bfe_u32 v23, v21, 3, 1
v_lshl_add_u32 v9, v23, 7, v9
v_bfe_u32 v23, v21, 2, 1
v_lshl_add_u32 v9, v23, 5, v9
v_and_b32 v23, 1, v21
v_lshl_add_u32 v9, v23, 4, v9
v_lshrrev_b32 v23, 1, v22
v_and_b32 v24, 1, v22
v_and_b32 v25, 7, v21
v_lshrrev_b32 v7, 3, v21
v_lshl_add_u32 v8, v7, 1, v23
v_lshlrev_b32 v8, 12, v8
v_lshl_add_u32 v8, v24, 7, v8
v_and_b32 v25, 4, v21
v_lshl_add_u32 v8, v25, 3, v8
v_and_b32 v25, 1, v21
v_lshl_add_u32 v8, v25, 4, v8
v_bfe_u32 v25, v21, 1, 1
v_lshl_add_u32 v8, v25, 3, v8
s_lshr_b32 s56, s32, 1
s_lshl_b32 s56, s56, 8
s_and_b32 s57, s32, 1
s_lshl_b32 s57, s57, 6
s_add_u32 s56, s56, s57
s_add_u32 s56, s56, 32768
v_add_u32 v8, s56, v8
v_and_b32 v7, 0x3d0, v1
s_mov_b32 s42, 0
s_mov_b32 s43, 65536
s_mov_b32 s44, 131072
s_mov_b32 s45, 196608
s_mov_b32 s46, 262144
s_mov_b32 s47, 294912
s_mov_b32 s48, 299008
s_mov_b32 s49, 303104
s_mov_b32 s50, 0x3e0293ee
s_mov_b32 s51, 0x3e0293ee
s_mov_b32 s52, 0x3f803f80
s_mov_b32 s53, 0x3f803f80
v_lshlrev_b32 v11, 2, v21
s_mov_b32 s34, 0
s_mov_b32 s35, -1
s_mov_b32 s36, 0
s_mov_b32 s41, 300000
s_lshl_b32 s37, s32, 14
s_add_u32 s39, s37, 17301504
s_add_u32 s37, s37, 16785408
s_mov_b32 s40, 8749056
v_mov_b64 v[36:37], 0
v_mov_b64 v[38:39], 0
s_lshl_b32 s56, s32, 1
s_add_u32 s56, s56, 1
s_cmp_eq_u32 s56, 0
s_cselect_b32 s56, 64, s56
s_mul_i32 s56, s56, 10240
s_add_u32 s56, s56, 8388608
s_add_u32 s57, s56, 4096
v_mov_b32 v40, 1
v_mov_b32 v41, 1
v_mov_b32 v42, 1
v_mov_b32 v43, 1
buffer_store_dwordx4 v[40:43], v1, s[4:7], s56 offen offset:0 sc0 sc1
buffer_store_dwordx4 v[40:43], v1, s[4:7], s56 offen offset:1024 sc0 sc1
buffer_store_dwordx4 v[40:43], v1, s[4:7], s56 offen offset:2048 sc0 sc1
buffer_store_dwordx4 v[40:43], v1, s[4:7], s56 offen offset:3072 sc0 sc1
s_add_u32 s56, s32, 0
s_lshl_b32 s3, s56, 12
v_and_b32 v23, 1, v21
v_bfe_u32 v24, v21, 2, 1
v_bfe_u32 v25, v21, 1, 1
s_lshl_b32 s57, s56, 7
s_add_u32 s57, s57, 294912
v_and_b32 v10, 7, v21
v_lshlrev_b32 v10, 2, v10
v_lshl_add_u32 v10, v22, 5, v10
v_add_u32 v10, s57, v10
s_lshl_b32 s33, s56, 2
s_add_u32 s33, s33, 304128
v_mov_b32 v30, -1
s_mov_b64 exec, 1
buffer_store_dword v30, v1, s[4:7], s33 offen sc0 sc1
s_mov_b64 exec, -1
v_lshl_add_u32 v23, v23, 1, v24
v_lshlrev_b32 v25, 4, v25
v_mov_b32 v24, 0x3f80
v_lshlrev_b32 v24, v25, v24
v_cmp_eq_u32 vcc, 0, v23
s_nop 1
v_cndmask_b32 v76, 0, v24, vcc
v_cmp_eq_u32 vcc, 1, v23
s_nop 1
v_cndmask_b32 v77, 0, v24, vcc
v_cmp_eq_u32 vcc, 2, v23
s_nop 1
v_cndmask_b32 v78, 0, v24, vcc
v_cmp_eq_u32 vcc, 3, v23
s_nop 1
v_cndmask_b32 v79, 0, v24, vcc
v_and_b32 v23, 0x70, v1
ds_write_b128 v23, v[76:79] offset:256
buffer_store_dwordx4 v[36:39], v9, s[4:7], s3 offen offset:0 sc0 sc1
buffer_store_dwordx4 v[36:39], v9, s[4:7], s3 offen offset:1024 sc0 sc1
buffer_store_dwordx4 v[36:39], v9, s[4:7], s3 offen offset:2048 sc0 sc1
buffer_store_dwordx4 v[36:39], v9, s[4:7], s3 offen offset:3072 sc0 sc1
s_getreg_b32 s56, hwreg(HW_REG_XCC_ID)
s_and_b32 s56, s56, 15
s_mul_i32 s57, s56, s56
s_lshl_b32 s57, s57, 18
s_lshl_b32 s56, s56, 8
s_add_u32 s57, s57, s56
s_add_u32 s58, s57, 1
s_lshl_b32 s101, s32, 7
s_add_u32 s101, s101, 327680
v_mov_b32 v24, 0
s_add_u32 s56, s54, 262144
s_mov_b32 m0, 110592
s_nop 0
buffer_load_dwordx4 v26, s[12:15], s56 offen lds
s_add_u32 s56, s54, 278528
s_mov_b32 m0, 111616
s_nop 0
buffer_load_dwordx4 v26, s[12:15], s56 offen lds
s_add_u32 s56, s54, 294912
s_mov_b32 m0, 112640
s_nop 0
buffer_load_dwordx4 v27, s[12:15], s56 offen lds
s_add_u32 s56, s54, 311296
s_mov_b32 m0, 113664
s_nop 0
buffer_load_dwordx4 v27, s[12:15], s56 offen lds
s_add_u32 s56, s54, 786432
s_mov_b32 m0, 114688
s_nop 0
buffer_load_dwordx4 v26, s[12:15], s56 offen lds
s_add_u32 s56, s54, 802816
s_mov_b32 m0, 115712
s_nop 0
buffer_load_dwordx4 v26, s[12:15], s56 offen lds
s_add_u32 s56, s54, 819200
s_mov_b32 m0, 116736
s_nop 0
buffer_load_dwordx4 v27, s[12:15], s56 offen lds
s_add_u32 s56, s54, 835584
s_mov_b32 m0, 117760
s_nop 0
buffer_load_dwordx4 v27, s[12:15], s56 offen lds
v_mov_b32 v24, 0
s_waitcnt vmcnt(37)
s_barrier
ds_read_b64_tr_b16 v[80:81], v44 offset:20480
ds_read_b64_tr_b16 v[82:83], v44 offset:21504
ds_read_b64_tr_b16 v[84:85], v46 offset:20480
ds_read_b64_tr_b16 v[86:87], v46 offset:21504
ds_read_b64_tr_b16 v[88:89], v45 offset:20480
ds_read_b64_tr_b16 v[90:91], v45 offset:21504
ds_read_b64_tr_b16 v[92:93], v47 offset:20480
ds_read_b64_tr_b16 v[94:95], v47 offset:21504
s_waitcnt lgkmcnt(0)
s_waitcnt vmcnt(33)
s_barrier
s_add_u32 s56, s54, 1310720
s_mov_b32 m0, 118784
s_nop 0
buffer_load_dwordx4 v26, s[12:15], s56 offen lds
s_add_u32 s56, s54, 1327104
s_mov_b32 m0, 119808
s_nop 0
buffer_load_dwordx4 v26, s[12:15], s56 offen lds
s_add_u32 s56, s54, 1343488
s_mov_b32 m0, 120832
s_nop 0
buffer_load_dwordx4 v27, s[12:15], s56 offen lds
s_add_u32 s56, s54, 1359872
s_mov_b32 m0, 121856
s_nop 0
buffer_load_dwordx4 v27, s[12:15], s56 offen lds
ds_read_b64_tr_b16 v[96:97], v44 offset:24576
ds_read_b64_tr_b16 v[98:99], v44 offset:25600
ds_read_b64_tr_b16 v[100:101], v46 offset:24576
ds_read_b64_tr_b16 v[102:103], v46 offset:25600
ds_read_b64_tr_b16 v[104:105], v45 offset:24576
ds_read_b64_tr_b16 v[106:107], v45 offset:25600
ds_read_b64_tr_b16 v[108:109], v47 offset:24576
ds_read_b64_tr_b16 v[110:111], v47 offset:25600
s_waitcnt lgkmcnt(0)
s_waitcnt vmcnt(33)
s_barrier
s_add_u32 s56, s54, 1835008
s_mov_b32 m0, 122880
s_nop 0
buffer_load_dwordx4 v26, s[12:15], s56 offen lds
s_add_u32 s56, s54, 1851392
s_mov_b32 m0, 123904
s_nop 0
buffer_load_dwordx4 v26, s[12:15], s56 offen lds
s_add_u32 s56, s54, 1867776
s_mov_b32 m0, 124928
s_nop 0
buffer_load_dwordx4 v27, s[12:15], s56 offen lds
s_add_u32 s56, s54, 1884160
s_mov_b32 m0, 125952
s_nop 0
buffer_load_dwordx4 v27, s[12:15], s56 offen lds
ds_read_b64_tr_b16 v[112:113], v44 offset:28672
ds_read_b64_tr_b16 v[114:115], v44 offset:29696
ds_read_b64_tr_b16 v[116:117], v46 offset:28672
ds_read_b64_tr_b16 v[118:119], v46 offset:29696
ds_read_b64_tr_b16 v[120:121], v45 offset:28672
ds_read_b64_tr_b16 v[122:123], v45 offset:29696
ds_read_b64_tr_b16 v[124:125], v47 offset:28672
ds_read_b64_tr_b16 v[126:127], v47 offset:29696
s_waitcnt lgkmcnt(0)
s_waitcnt vmcnt(33)
s_barrier
s_add_u32 s56, s54, 2359296
s_mov_b32 m0, 126976
s_nop 0
buffer_load_dwordx4 v26, s[12:15], s56 offen lds
s_add_u32 s56, s54, 2375680
s_mov_b32 m0, 128000
s_nop 0
buffer_load_dwordx4 v26, s[12:15], s56 offen lds
s_add_u32 s56, s54, 2392064
s_mov_b32 m0, 129024
s_nop 0
buffer_load_dwordx4 v27, s[12:15], s56 offen lds
s_add_u32 s56, s54, 2408448
s_mov_b32 m0, 130048
s_nop 0
buffer_load_dwordx4 v27, s[12:15], s56 offen lds
ds_read_b64_tr_b16 v[128:129], v44 offset:0
ds_read_b64_tr_b16 v[130:131], v44 offset:1024
ds_read_b64_tr_b16 v[132:133], v46 offset:0
ds_read_b64_tr_b16 v[134:135], v46 offset:1024
ds_read_b64_tr_b16 v[136:137], v45 offset:0
ds_read_b64_tr_b16 v[138:139], v45 offset:1024
ds_read_b64_tr_b16 v[140:141], v47 offset:0
ds_read_b64_tr_b16 v[142:143], v47 offset:1024
s_waitcnt lgkmcnt(0)
s_waitcnt vmcnt(33)
s_barrier
s_add_u32 s56, s54, 3407872
s_mov_b32 m0, 98304
s_nop 0
buffer_load_dwordx4 v26, s[12:15], s56 offen lds
s_add_u32 s56, s54, 3424256
s_mov_b32 m0, 99328
s_nop 0
buffer_load_dwordx4 v26, s[12:15], s56 offen lds
s_add_u32 s56, s54, 3440640
s_mov_b32 m0, 100352
s_nop 0
buffer_load_dwordx4 v27, s[12:15], s56 offen lds
s_add_u32 s56, s54, 3457024
s_mov_b32 m0, 101376
s_nop 0
buffer_load_dwordx4 v27, s[12:15], s56 offen lds
ds_read_b64_tr_b16 v[144:145], v44 offset:4096
ds_read_b64_tr_b16 v[146:147], v44 offset:5120
ds_read_b64_tr_b16 v[148:149], v46 offset:4096
ds_read_b64_tr_b16 v[150:151], v46 offset:5120
ds_read_b64_tr_b16 v[152:153], v45 offset:4096
ds_read_b64_tr_b16 v[154:155], v45 offset:5120
ds_read_b64_tr_b16 v[156:157], v47 offset:4096
ds_read_b64_tr_b16 v[158:159], v47 offset:5120
s_waitcnt lgkmcnt(0)
s_waitcnt vmcnt(33)
s_barrier
s_add_u32 s56, s54, 3932160
s_mov_b32 m0, 102400
s_nop 0
buffer_load_dwordx4 v26, s[12:15], s56 offen lds
s_add_u32 s56, s54, 3948544
s_mov_b32 m0, 103424
s_nop 0
buffer_load_dwordx4 v26, s[12:15], s56 offen lds
s_add_u32 s56, s54, 3964928
s_mov_b32 m0, 104448
s_nop 0
buffer_load_dwordx4 v27, s[12:15], s56 offen lds
s_add_u32 s56, s54, 3981312
s_mov_b32 m0, 105472
s_nop 0
buffer_load_dwordx4 v27, s[12:15], s56 offen lds
ds_read_b64_tr_b16 v[160:161], v44 offset:8192
ds_read_b64_tr_b16 v[162:163], v44 offset:9216
ds_read_b64_tr_b16 v[164:165], v46 offset:8192
ds_read_b64_tr_b16 v[166:167], v46 offset:9216
ds_read_b64_tr_b16 v[168:169], v45 offset:8192
ds_read_b64_tr_b16 v[170:171], v45 offset:9216
ds_read_b64_tr_b16 v[172:173], v47 offset:8192
ds_read_b64_tr_b16 v[174:175], v47 offset:9216
s_waitcnt lgkmcnt(0)
s_waitcnt vmcnt(24)
s_barrier
s_add_u32 s56, s54, 4456448
s_mov_b32 m0, 106496
s_nop 0
buffer_load_dwordx4 v26, s[12:15], s56 offen lds
s_add_u32 s56, s54, 4472832
s_mov_b32 m0, 107520
s_nop 0
buffer_load_dwordx4 v26, s[12:15], s56 offen lds
s_add_u32 s56, s54, 4489216
s_mov_b32 m0, 108544
s_nop 0
buffer_load_dwordx4 v27, s[12:15], s56 offen lds
s_add_u32 s56, s54, 4505600
s_mov_b32 m0, 109568
s_nop 0
buffer_load_dwordx4 v27, s[12:15], s56 offen lds
ds_read_b64_tr_b16 v[176:177], v44 offset:12288
ds_read_b64_tr_b16 v[178:179], v44 offset:13312
ds_read_b64_tr_b16 v[180:181], v46 offset:12288
ds_read_b64_tr_b16 v[182:183], v46 offset:13312
ds_read_b64_tr_b16 v[184:185], v45 offset:12288
ds_read_b64_tr_b16 v[186:187], v45 offset:13312
ds_read_b64_tr_b16 v[188:189], v47 offset:12288
ds_read_b64_tr_b16 v[190:191], v47 offset:13312
s_waitcnt lgkmcnt(0)
s_waitcnt vmcnt(24)
s_barrier
s_add_u32 s56, s54, 262144
s_mov_b32 m0, 110592
s_nop 0
buffer_load_dwordx4 v26, s[16:19], s56 offen lds
s_add_u32 s56, s54, 278528
s_mov_b32 m0, 111616
s_nop 0
buffer_load_dwordx4 v26, s[16:19], s56 offen lds
s_add_u32 s56, s54, 294912
s_mov_b32 m0, 112640
s_nop 0
buffer_load_dwordx4 v27, s[16:19], s56 offen lds
s_add_u32 s56, s54, 311296
s_mov_b32 m0, 113664
s_nop 0
buffer_load_dwordx4 v27, s[16:19], s56 offen lds
ds_read_b64_tr_b16 v[192:193], v44 offset:16384
ds_read_b64_tr_b16 v[194:195], v44 offset:17408
ds_read_b64_tr_b16 v[196:197], v46 offset:16384
ds_read_b64_tr_b16 v[198:199], v46 offset:17408
ds_read_b64_tr_b16 v[200:201], v45 offset:16384
ds_read_b64_tr_b16 v[202:203], v45 offset:17408
ds_read_b64_tr_b16 v[204:205], v47 offset:16384
ds_read_b64_tr_b16 v[206:207], v47 offset:17408
s_waitcnt lgkmcnt(0)
s_waitcnt vmcnt(24)
s_barrier
s_add_u32 s56, s54, 786432
s_mov_b32 m0, 114688
s_nop 0
buffer_load_dwordx4 v26, s[16:19], s56 offen lds
s_add_u32 s56, s54, 802816
s_mov_b32 m0, 115712
s_nop 0
buffer_load_dwordx4 v26, s[16:19], s56 offen lds
s_add_u32 s56, s54, 819200
s_mov_b32 m0, 116736
s_nop 0
buffer_load_dwordx4 v27, s[16:19], s56 offen lds
s_add_u32 s56, s54, 835584
s_mov_b32 m0, 117760
s_nop 0
buffer_load_dwordx4 v27, s[16:19], s56 offen lds
ds_read_b64_tr_b16 v[208:209], v44 offset:20480
ds_read_b64_tr_b16 v[210:211], v44 offset:21504
ds_read_b64_tr_b16 v[212:213], v46 offset:20480
ds_read_b64_tr_b16 v[214:215], v46 offset:21504
ds_read_b64_tr_b16 v[216:217], v45 offset:20480
ds_read_b64_tr_b16 v[218:219], v45 offset:21504
ds_read_b64_tr_b16 v[220:221], v47 offset:20480
ds_read_b64_tr_b16 v[222:223], v47 offset:21504
s_waitcnt lgkmcnt(0)
s_waitcnt vmcnt(24)
s_barrier
s_add_u32 s56, s54, 1310720
s_mov_b32 m0, 118784
s_nop 0
buffer_load_dwordx4 v26, s[16:19], s56 offen lds
s_add_u32 s56, s54, 1327104
s_mov_b32 m0, 119808
s_nop 0
buffer_load_dwordx4 v26, s[16:19], s56 offen lds
s_add_u32 s56, s54, 1343488
s_mov_b32 m0, 120832
s_nop 0
buffer_load_dwordx4 v27, s[16:19], s56 offen lds
s_add_u32 s56, s54, 1359872
s_mov_b32 m0, 121856
s_nop 0
buffer_load_dwordx4 v27, s[16:19], s56 offen lds
ds_read_b64_tr_b16 v[224:225], v44 offset:24576
ds_read_b64_tr_b16 v[226:227], v44 offset:25600
ds_read_b64_tr_b16 v[228:229], v46 offset:24576
ds_read_b64_tr_b16 v[230:231], v46 offset:25600
ds_read_b64_tr_b16 v[232:233], v45 offset:24576
ds_read_b64_tr_b16 v[234:235], v45 offset:25600
ds_read_b64_tr_b16 v[236:237], v47 offset:24576
ds_read_b64_tr_b16 v[238:239], v47 offset:25600
s_waitcnt lgkmcnt(0)
s_waitcnt vmcnt(24)
s_barrier
s_add_u32 s56, s54, 1835008
s_mov_b32 m0, 122880
s_nop 0
buffer_load_dwordx4 v26, s[16:19], s56 offen lds
s_add_u32 s56, s54, 1851392
s_mov_b32 m0, 123904
s_nop 0
buffer_load_dwordx4 v26, s[16:19], s56 offen lds
s_add_u32 s56, s54, 1867776
s_mov_b32 m0, 124928
s_nop 0
buffer_load_dwordx4 v27, s[16:19], s56 offen lds
s_add_u32 s56, s54, 1884160
s_mov_b32 m0, 125952
s_nop 0
buffer_load_dwordx4 v27, s[16:19], s56 offen lds
ds_read_b64_tr_b16 v[240:241], v44 offset:28672
ds_read_b64_tr_b16 v[242:243], v44 offset:29696
ds_read_b64_tr_b16 v[244:245], v46 offset:28672
ds_read_b64_tr_b16 v[246:247], v46 offset:29696
ds_read_b64_tr_b16 v[248:249], v45 offset:28672
ds_read_b64_tr_b16 v[250:251], v45 offset:29696
ds_read_b64_tr_b16 v[252:253], v47 offset:28672
ds_read_b64_tr_b16 v[254:255], v47 offset:29696
s_waitcnt lgkmcnt(0)
s_waitcnt vmcnt(24)
s_barrier
s_add_u32 s56, s54, 2359296
s_mov_b32 m0, 126976
s_nop 0
buffer_load_dwordx4 v26, s[16:19], s56 offen lds
s_add_u32 s56, s54, 2375680
s_mov_b32 m0, 128000
s_nop 0
buffer_load_dwordx4 v26, s[16:19], s56 offen lds
s_add_u32 s56, s54, 2392064
s_mov_b32 m0, 129024
s_nop 0
buffer_load_dwordx4 v27, s[16:19], s56 offen lds
s_add_u32 s56, s54, 2408448
s_mov_b32 m0, 130048
s_nop 0
buffer_load_dwordx4 v27, s[16:19], s56 offen lds
ds_read_b64_tr_b16 a[0:1], v44 offset:0
ds_read_b64_tr_b16 a[2:3], v44 offset:1024
ds_read_b64_tr_b16 a[4:5], v46 offset:0
ds_read_b64_tr_b16 a[6:7], v46 offset:1024
ds_read_b64_tr_b16 a[8:9], v45 offset:0
ds_read_b64_tr_b16 a[10:11], v45 offset:1024
ds_read_b64_tr_b16 a[12:13], v47 offset:0
ds_read_b64_tr_b16 a[14:15], v47 offset:1024
s_waitcnt lgkmcnt(0)
s_waitcnt vmcnt(24)
s_barrier
s_add_u32 s56, s54, 2883584
s_mov_b32 m0, 98304
s_nop 0
buffer_load_dwordx4 v26, s[16:19], s56 offen lds
s_add_u32 s56, s54, 2899968
s_mov_b32 m0, 99328
s_nop 0
buffer_load_dwordx4 v26, s[16:19], s56 offen lds
s_add_u32 s56, s54, 2916352
s_mov_b32 m0, 100352
s_nop 0
buffer_load_dwordx4 v27, s[16:19], s56 offen lds
s_add_u32 s56, s54, 2932736
s_mov_b32 m0, 101376
s_nop 0
buffer_load_dwordx4 v27, s[16:19], s56 offen lds
ds_read_b64_tr_b16 a[16:17], v44 offset:4096
ds_read_b64_tr_b16 a[18:19], v44 offset:5120
ds_read_b64_tr_b16 a[20:21], v46 offset:4096
ds_read_b64_tr_b16 a[22:23], v46 offset:5120
ds_read_b64_tr_b16 a[24:25], v45 offset:4096
ds_read_b64_tr_b16 a[26:27], v45 offset:5120
ds_read_b64_tr_b16 a[28:29], v47 offset:4096
ds_read_b64_tr_b16 a[30:31], v47 offset:5120
s_waitcnt lgkmcnt(0)
s_waitcnt vmcnt(24)
s_barrier
s_add_u32 s56, s54, 3407872
s_mov_b32 m0, 102400
s_nop 0
buffer_load_dwordx4 v26, s[16:19], s56 offen lds
s_add_u32 s56, s54, 3424256
s_mov_b32 m0, 103424
s_nop 0
buffer_load_dwordx4 v26, s[16:19], s56 offen lds
s_add_u32 s56, s54, 3440640
s_mov_b32 m0, 104448
s_nop 0
buffer_load_dwordx4 v27, s[16:19], s56 offen lds
s_add_u32 s56, s54, 3457024
s_mov_b32 m0, 105472
s_nop 0
buffer_load_dwordx4 v27, s[16:19], s56 offen lds
ds_read_b64_tr_b16 a[32:33], v44 offset:8192
ds_read_b64_tr_b16 a[34:35], v44 offset:9216
ds_read_b64_tr_b16 a[36:37], v46 offset:8192
ds_read_b64_tr_b16 a[38:39], v46 offset:9216
ds_read_b64_tr_b16 a[40:41], v45 offset:8192
ds_read_b64_tr_b16 a[42:43], v45 offset:9216
ds_read_b64_tr_b16 a[44:45], v47 offset:8192
ds_read_b64_tr_b16 a[46:47], v47 offset:9216
s_waitcnt lgkmcnt(0)
s_waitcnt vmcnt(24)
s_barrier
s_add_u32 s56, s54, 3932160
s_mov_b32 m0, 106496
s_nop 0
buffer_load_dwordx4 v26, s[16:19], s56 offen lds
s_add_u32 s56, s54, 3948544
s_mov_b32 m0, 107520
s_nop 0
buffer_load_dwordx4 v26, s[16:19], s56 offen lds
s_add_u32 s56, s54, 3964928
s_mov_b32 m0, 108544
s_nop 0
buffer_load_dwordx4 v27, s[16:19], s56 offen lds
s_add_u32 s56, s54, 3981312
s_mov_b32 m0, 109568
s_nop 0
buffer_load_dwordx4 v27, s[16:19], s56 offen lds
ds_read_b64_tr_b16 a[48:49], v44 offset:12288
ds_read_b64_tr_b16 a[50:51], v44 offset:13312
ds_read_b64_tr_b16 a[52:53], v46 offset:12288
ds_read_b64_tr_b16 a[54:55], v46 offset:13312
ds_read_b64_tr_b16 a[56:57], v45 offset:12288
ds_read_b64_tr_b16 a[58:59], v45 offset:13312
ds_read_b64_tr_b16 a[60:61], v47 offset:12288
ds_read_b64_tr_b16 a[62:63], v47 offset:13312
s_waitcnt lgkmcnt(0)
s_waitcnt vmcnt(24)
s_barrier
s_add_u32 s56, s55, 110592
s_mov_b32 m0, 110592
s_nop 0
buffer_load_dwordx4 v28, s[20:23], s56 offen lds
s_add_u32 s56, s55, 112896
s_mov_b32 m0, 111616
s_nop 0
buffer_load_dwordx4 v28, s[20:23], s56 offen lds
s_add_u32 s56, s55, 119808
s_mov_b32 m0, 112640
s_nop 0
buffer_load_dwordx4 v28, s[20:23], s56 offen lds
s_add_u32 s56, s55, 122112
s_mov_b32 m0, 113664
s_nop 0
buffer_load_dwordx4 v28, s[20:23], s56 offen lds
ds_read_b64_tr_b16 a[64:65], v44 offset:16384
ds_read_b64_tr_b16 a[66:67], v44 offset:17408
ds_read_b64_tr_b16 a[68:69], v46 offset:16384
ds_read_b64_tr_b16 a[70:71], v46 offset:17408
ds_read_b64_tr_b16 a[72:73], v45 offset:16384
ds_read_b64_tr_b16 a[74:75], v45 offset:17408
ds_read_b64_tr_b16 a[76:77], v47 offset:16384
ds_read_b64_tr_b16 a[78:79], v47 offset:17408
s_waitcnt lgkmcnt(0)
s_waitcnt vmcnt(24)
s_barrier
s_add_u32 s56, s55, 110848
s_mov_b32 m0, 114688
s_nop 0
buffer_load_dwordx4 v28, s[20:23], s56 offen lds
s_add_u32 s56, s55, 113152
s_mov_b32 m0, 115712
s_nop 0
buffer_load_dwordx4 v28, s[20:23], s56 offen lds
s_add_u32 s56, s55, 120064
s_mov_b32 m0, 116736
s_nop 0
buffer_load_dwordx4 v28, s[20:23], s56 offen lds
s_add_u32 s56, s55, 122368
s_mov_b32 m0, 117760
s_nop 0
buffer_load_dwordx4 v28, s[20:23], s56 offen lds
ds_read_b64_tr_b16 a[80:81], v44 offset:20480
ds_read_b64_tr_b16 a[82:83], v44 offset:21504
ds_read_b64_tr_b16 a[84:85], v46 offset:20480
ds_read_b64_tr_b16 a[86:87], v46 offset:21504
ds_read_b64_tr_b16 a[88:89], v45 offset:20480
ds_read_b64_tr_b16 a[90:91], v45 offset:21504
ds_read_b64_tr_b16 a[92:93], v47 offset:20480
ds_read_b64_tr_b16 a[94:95], v47 offset:21504
s_waitcnt lgkmcnt(0)
s_waitcnt vmcnt(24)
s_barrier
s_add_u32 s56, s55, 111104
s_mov_b32 m0, 118784
s_nop 0
buffer_load_dwordx4 v28, s[20:23], s56 offen lds
s_add_u32 s56, s55, 113408
s_mov_b32 m0, 119808
s_nop 0
buffer_load_dwordx4 v28, s[20:23], s56 offen lds
s_add_u32 s56, s55, 120320
s_mov_b32 m0, 120832
s_nop 0
buffer_load_dwordx4 v28, s[20:23], s56 offen lds
s_add_u32 s56, s55, 122624
s_mov_b32 m0, 121856
s_nop 0
buffer_load_dwordx4 v28, s[20:23], s56 offen lds
ds_read_b64_tr_b16 a[96:97], v44 offset:24576
ds_read_b64_tr_b16 a[98:99], v44 offset:25600
ds_read_b64_tr_b16 a[100:101], v46 offset:24576
ds_read_b64_tr_b16 a[102:103], v46 offset:25600
ds_read_b64_tr_b16 a[104:105], v45 offset:24576
ds_read_b64_tr_b16 a[106:107], v45 offset:25600
ds_read_b64_tr_b16 a[108:109], v47 offset:24576
ds_read_b64_tr_b16 a[110:111], v47 offset:25600
s_waitcnt lgkmcnt(0)
s_waitcnt vmcnt(24)
s_barrier
s_add_u32 s56, s55, 111360
s_mov_b32 m0, 122880
s_nop 0
buffer_load_dwordx4 v28, s[20:23], s56 offen lds
s_add_u32 s56, s55, 113664
s_mov_b32 m0, 123904
s_nop 0
buffer_load_dwordx4 v28, s[20:23], s56 offen lds
s_add_u32 s56, s55, 120576
s_mov_b32 m0, 124928
s_nop 0
buffer_load_dwordx4 v28, s[20:23], s56 offen lds
s_add_u32 s56, s55, 122880
s_mov_b32 m0, 125952
s_nop 0
buffer_load_dwordx4 v28, s[20:23], s56 offen lds
ds_read_b64_tr_b16 a[112:113], v44 offset:28672
ds_read_b64_tr_b16 a[114:115], v44 offset:29696
ds_read_b64_tr_b16 a[116:117], v46 offset:28672
ds_read_b64_tr_b16 a[118:119], v46 offset:29696
ds_read_b64_tr_b16 a[120:121], v45 offset:28672
ds_read_b64_tr_b16 a[122:123], v45 offset:29696
ds_read_b64_tr_b16 a[124:125], v47 offset:28672
ds_read_b64_tr_b16 a[126:127], v47 offset:29696
s_waitcnt lgkmcnt(0)
s_waitcnt vmcnt(24)
s_barrier
s_add_u32 s56, s55, 36864
s_mov_b32 m0, 126976
s_nop 0
buffer_load_dwordx4 v28, s[20:23], s56 offen lds
s_add_u32 s56, s55, 39168
s_mov_b32 m0, 128000
s_nop 0
buffer_load_dwordx4 v28, s[20:23], s56 offen lds
s_add_u32 s56, s55, 46080
s_mov_b32 m0, 129024
s_nop 0
buffer_load_dwordx4 v28, s[20:23], s56 offen lds
s_add_u32 s56, s55, 48384
s_mov_b32 m0, 130048
s_nop 0
buffer_load_dwordx4 v28, s[20:23], s56 offen lds
ds_read_b64_tr_b16 a[128:129], v44 offset:0
ds_read_b64_tr_b16 a[130:131], v44 offset:1024
ds_read_b64_tr_b16 a[132:133], v46 offset:0
ds_read_b64_tr_b16 a[134:135], v46 offset:1024
ds_read_b64_tr_b16 a[136:137], v45 offset:0
ds_read_b64_tr_b16 a[138:139], v45 offset:1024
ds_read_b64_tr_b16 a[140:141], v47 offset:0
ds_read_b64_tr_b16 a[142:143], v47 offset:1024
buffer_load_dword v32, v24, s[28:31], 0 offen sc0 sc1
s_waitcnt lgkmcnt(0)
s_waitcnt vmcnt(25)
s_barrier
s_add_u32 s56, s54, 262144
s_mov_b32 m0, 98304
s_nop 0
buffer_load_dwordx4 v26, s[8:11], s56 offen lds
s_add_u32 s56, s54, 278528
s_mov_b32 m0, 99328
s_nop 0
buffer_load_dwordx4 v26, s[8:11], s56 offen lds
s_add_u32 s56, s54, 294912
s_mov_b32 m0, 100352
s_nop 0
buffer_load_dwordx4 v27, s[8:11], s56 offen lds
s_add_u32 s56, s54, 311296
s_mov_b32 m0, 101376
s_nop 0
buffer_load_dwordx4 v27, s[8:11], s56 offen lds
ds_read_b64_tr_b16 a[144:145], v44 offset:4096
ds_read_b64_tr_b16 a[146:147], v44 offset:5120
ds_read_b64_tr_b16 a[148:149], v46 offset:4096
ds_read_b64_tr_b16 a[150:151], v46 offset:5120
ds_read_b64_tr_b16 a[152:153], v45 offset:4096
ds_read_b64_tr_b16 a[154:155], v45 offset:5120
ds_read_b64_tr_b16 a[156:157], v47 offset:4096
ds_read_b64_tr_b16 a[158:159], v47 offset:5120
s_waitcnt lgkmcnt(0)
s_waitcnt vmcnt(25)
s_barrier
s_add_u32 s56, s54, 1835008
s_mov_b32 m0, 102400
s_nop 0
buffer_load_dwordx4 v26, s[8:11], s56 offen lds
s_add_u32 s56, s54, 1851392
s_mov_b32 m0, 103424
s_nop 0
buffer_load_dwordx4 v26, s[8:11], s56 offen lds
s_add_u32 s56, s54, 1867776
s_mov_b32 m0, 104448
s_nop 0
buffer_load_dwordx4 v27, s[8:11], s56 offen lds
s_add_u32 s56, s54, 1884160
s_mov_b32 m0, 105472
s_nop 0
buffer_load_dwordx4 v27, s[8:11], s56 offen lds
ds_read_b64_tr_b16 a[160:161], v44 offset:8192
ds_read_b64_tr_b16 a[162:163], v44 offset:9216
ds_read_b64_tr_b16 a[164:165], v46 offset:8192
ds_read_b64_tr_b16 a[166:167], v46 offset:9216
ds_read_b64_tr_b16 a[168:169], v45 offset:8192
ds_read_b64_tr_b16 a[170:171], v45 offset:9216
ds_read_b64_tr_b16 a[172:173], v47 offset:8192
ds_read_b64_tr_b16 a[174:175], v47 offset:9216
s_waitcnt lgkmcnt(0)
s_waitcnt vmcnt(25)
s_barrier
s_add_u32 s56, s54, 2359296
s_mov_b32 m0, 106496
s_nop 0
buffer_load_dwordx4 v26, s[8:11], s56 offen lds
s_add_u32 s56, s54, 2375680
s_mov_b32 m0, 107520
s_nop 0
buffer_load_dwordx4 v26, s[8:11], s56 offen lds
s_add_u32 s56, s54, 2392064
s_mov_b32 m0, 108544
s_nop 0
buffer_load_dwordx4 v27, s[8:11], s56 offen lds
s_add_u32 s56, s54, 2408448
s_mov_b32 m0, 109568
s_nop 0
buffer_load_dwordx4 v27, s[8:11], s56 offen lds
ds_read_b64_tr_b16 a[176:177], v48 offset:12288
ds_read_b64_tr_b16 a[178:179], v48 offset:13312
ds_read_b64_tr_b16 a[180:181], v48 offset:14336
ds_read_b64_tr_b16 a[182:183], v48 offset:15360
ds_read_b64_tr_b16 a[216:217], v49 offset:12288
ds_read_b64_tr_b16 a[218:219], v49 offset:13312
ds_read_b64_tr_b16 a[220:221], v49 offset:14336
ds_read_b64_tr_b16 a[222:223], v49 offset:15360
s_waitcnt lgkmcnt(0)
s_waitcnt vmcnt(25)
s_barrier
s_add_u32 s56, s54, 2883584
s_mov_b32 m0, 110592
s_nop 0
buffer_load_dwordx4 v26, s[12:15], s56 offen lds
s_add_u32 s56, s54, 2899968
s_mov_b32 m0, 111616
s_nop 0
buffer_load_dwordx4 v26, s[12:15], s56 offen lds
s_add_u32 s56, s54, 2916352
s_mov_b32 m0, 112640
s_nop 0
buffer_load_dwordx4 v27, s[12:15], s56 offen lds
s_add_u32 s56, s54, 2932736
s_mov_b32 m0, 113664
s_nop 0
buffer_load_dwordx4 v27, s[12:15], s56 offen lds
ds_read_b64_tr_b16 a[184:185], v48 offset:16384
ds_read_b64_tr_b16 a[186:187], v48 offset:17408
ds_read_b64_tr_b16 a[188:189], v48 offset:18432
ds_read_b64_tr_b16 a[190:191], v48 offset:19456
ds_read_b64_tr_b16 a[232:233], v49 offset:16384
ds_read_b64_tr_b16 a[234:235], v49 offset:17408
ds_read_b64_tr_b16 a[236:237], v49 offset:18432
ds_read_b64_tr_b16 a[238:239], v49 offset:19456
s_waitcnt lgkmcnt(0)
s_waitcnt vmcnt(25)
s_barrier
s_add_u32 s56, s54, 4456448
s_mov_b32 m0, 114688
s_nop 0
buffer_load_dwordx4 v26, s[16:19], s56 offen lds
s_add_u32 s56, s54, 4472832
s_mov_b32 m0, 115712
s_nop 0
buffer_load_dwordx4 v26, s[16:19], s56 offen lds
s_add_u32 s56, s54, 4489216
s_mov_b32 m0, 116736
s_nop 0
buffer_load_dwordx4 v27, s[16:19], s56 offen lds
s_add_u32 s56, s54, 4505600
s_mov_b32 m0, 117760
s_nop 0
buffer_load_dwordx4 v27, s[16:19], s56 offen lds
ds_read_b64_tr_b16 a[192:193], v48 offset:20480
ds_read_b64_tr_b16 a[194:195], v48 offset:21504
ds_read_b64_tr_b16 a[196:197], v48 offset:22528
ds_read_b64_tr_b16 a[198:199], v48 offset:23552
ds_read_b64_tr_b16 a[240:241], v49 offset:20480
ds_read_b64_tr_b16 a[242:243], v49 offset:21504
ds_read_b64_tr_b16 a[244:245], v49 offset:22528
ds_read_b64_tr_b16 a[246:247], v49 offset:23552
s_waitcnt lgkmcnt(0)
s_waitcnt vmcnt(25)
s_barrier
s_add_u32 s56, s55, 37120
s_mov_b32 m0, 118784
s_nop 0
buffer_load_dwordx4 v28, s[20:23], s56 offen lds
s_add_u32 s56, s55, 39424
s_mov_b32 m0, 119808
s_nop 0
buffer_load_dwordx4 v28, s[20:23], s56 offen lds
s_add_u32 s56, s55, 46336
s_mov_b32 m0, 120832
s_nop 0
buffer_load_dwordx4 v28, s[20:23], s56 offen lds
s_add_u32 s56, s55, 48640
s_mov_b32 m0, 121856
s_nop 0
buffer_load_dwordx4 v28, s[20:23], s56 offen lds
ds_read_b64_tr_b16 a[200:201], v48 offset:24576
ds_read_b64_tr_b16 a[202:203], v48 offset:25600
ds_read_b64_tr_b16 a[204:205], v48 offset:26624
ds_read_b64_tr_b16 a[206:207], v48 offset:27648
ds_read_b64_tr_b16 a[248:249], v49 offset:24576
ds_read_b64_tr_b16 a[250:251], v49 offset:25600
ds_read_b64_tr_b16 a[252:253], v49 offset:26624
ds_read_b64_tr_b16 a[254:255], v49 offset:27648
s_waitcnt lgkmcnt(0)
s_waitcnt vmcnt(25)
s_barrier
s_add_u32 s56, s55, 37376
s_mov_b32 m0, 122880
s_nop 0
buffer_load_dwordx4 v28, s[20:23], s56 offen lds
s_add_u32 s56, s55, 39680
s_mov_b32 m0, 123904
s_nop 0
buffer_load_dwordx4 v28, s[20:23], s56 offen lds
s_add_u32 s56, s55, 46592
s_mov_b32 m0, 124928
s_nop 0
buffer_load_dwordx4 v28, s[20:23], s56 offen lds
s_add_u32 s56, s55, 48896
s_mov_b32 m0, 125952
s_nop 0
buffer_load_dwordx4 v28, s[20:23], s56 offen lds
ds_read_b64_tr_b16 a[208:209], v48 offset:28672
ds_read_b64_tr_b16 a[210:211], v48 offset:29696
ds_read_b64_tr_b16 a[212:213], v48 offset:30720
ds_read_b64_tr_b16 a[214:215], v48 offset:31744
ds_read_b64_tr_b16 a[224:225], v49 offset:28672
ds_read_b64_tr_b16 a[226:227], v49 offset:29696
ds_read_b64_tr_b16 a[228:229], v49 offset:30720
ds_read_b64_tr_b16 a[230:231], v49 offset:31744
s_waitcnt lgkmcnt(0)
s_waitcnt vmcnt(24)
s_barrier
s_add_u32 s56, s55, 37632
s_mov_b32 m0, 126976
s_nop 0
buffer_load_dwordx4 v28, s[20:23], s56 offen lds
s_add_u32 s56, s55, 39936
s_mov_b32 m0, 128000
s_nop 0
buffer_load_dwordx4 v28, s[20:23], s56 offen lds
s_add_u32 s56, s55, 46848
s_mov_b32 m0, 129024
s_nop 0
buffer_load_dwordx4 v28, s[20:23], s56 offen lds
s_add_u32 s56, s55, 49152
s_mov_b32 m0, 130048
s_nop 0
buffer_load_dwordx4 v28, s[20:23], s56 offen lds
ds_read_b64_tr_b16 v[60:61], v44 offset:0
ds_read_b64_tr_b16 v[62:63], v44 offset:1024
ds_read_b64_tr_b16 v[64:65], v46 offset:0
ds_read_b64_tr_b16 v[66:67], v46 offset:1024
ds_read_b64_tr_b16 v[68:69], v45 offset:0
ds_read_b64_tr_b16 v[70:71], v45 offset:1024
ds_read_b64_tr_b16 v[72:73], v47 offset:0
ds_read_b64_tr_b16 v[74:75], v47 offset:1024
s_waitcnt lgkmcnt(0)
s_waitcnt vmcnt(24)
s_barrier
ds_write_b128 v2, v[60:63] offset:0
ds_write_b128 v2, v[64:67] offset:1024
ds_write_b128 v2, v[68:71] offset:2048
ds_write_b128 v2, v[72:75] offset:3072
ds_read_b64_tr_b16 v[60:61], v44 offset:4096
ds_read_b64_tr_b16 v[62:63], v44 offset:5120
ds_read_b64_tr_b16 v[64:65], v46 offset:4096
ds_read_b64_tr_b16 v[66:67], v46 offset:5120
ds_read_b64_tr_b16 v[68:69], v45 offset:4096
ds_read_b64_tr_b16 v[70:71], v45 offset:5120
ds_read_b64_tr_b16 v[72:73], v47 offset:4096
ds_read_b64_tr_b16 v[74:75], v47 offset:5120
L_rdv_w2r:
v_readfirstlane_b32 s38, v32
s_nop 0
s_and_b32 s57, s38, 0xff
s_cmp_lg_u32 s57, 32
s_cbranch_scc1 L_rdv2_w2r
s_waitcnt lgkmcnt(0)
s_waitcnt vmcnt(20)
s_barrier
ds_write_b128 v2, v[60:63] offset:4096
ds_write_b128 v2, v[64:67] offset:5120
ds_write_b128 v2, v[68:71] offset:6144
ds_write_b128 v2, v[72:75] offset:7168
ds_read_b64_tr_b16 v[60:61], v44 offset:8192
ds_read_b64_tr_b16 v[62:63], v44 offset:9216
ds_read_b64_tr_b16 v[64:65], v46 offset:8192
ds_read_b64_tr_b16 v[66:67], v46 offset:9216
ds_read_b64_tr_b16 v[68:69], v45 offset:8192
ds_read_b64_tr_b16 v[70:71], v45 offset:9216
ds_read_b64_tr_b16 v[72:73], v47 offset:8192
ds_read_b64_tr_b16 v[74:75], v47 offset:9216
buffer_load_dwordx4 v[12:15], v9, s[4:7], s37 offen offset:0
buffer_load_dwordx4 v[16:19], v9, s[4:7], s37 offen offset:1024
buffer_load_dwordx4 v[52:55], v1, s[4:7], s37 offen offset:2048
buffer_load_dwordx4 v[56:59], v1, s[4:7], s37 offen offset:3072
s_mov_b32 m0, 1024
s_nop 0
buffer_load_dwordx4 v1, s[4:7], s47 offen offset:2048 sc1 lds
s_mov_b32 s56, 304128
buffer_load_dword v33, v24, s[4:7], s56 offen sc1
buffer_load_dword v33, v1, s[4:7], s3 offen offset:0 sc1
buffer_load_dword v33, v1, s[4:7], s3 offen offset:1024 sc1
buffer_load_dword v33, v1, s[4:7], s3 offen offset:2048 sc1
buffer_load_dword v33, v1, s[4:7], s3 offen offset:3072 sc1
s_waitcnt lgkmcnt(0)
s_waitcnt vmcnt(26)
s_barrier
ds_write_b128 v2, v[60:63] offset:8192
ds_write_b128 v2, v[64:67] offset:9216
ds_write_b128 v2, v[68:71] offset:10240
ds_write_b128 v2, v[72:75] offset:11264
ds_read_b64_tr_b16 v[60:61], v44 offset:12288
ds_read_b64_tr_b16 v[62:63], v44 offset:13312
ds_read_b64_tr_b16 v[64:65], v46 offset:12288
ds_read_b64_tr_b16 v[66:67], v46 offset:13312
ds_read_b64_tr_b16 v[68:69], v45 offset:12288
ds_read_b64_tr_b16 v[70:71], v45 offset:13312
ds_read_b64_tr_b16 v[72:73], v47 offset:12288
ds_read_b64_tr_b16 v[74:75], v47 offset:13312
s_waitcnt lgkmcnt(0)
s_waitcnt vmcnt(22)
s_barrier
ds_write_b128 v2, v[60:63] offset:12288
ds_write_b128 v2, v[64:67] offset:13312
ds_write_b128 v2, v[68:71] offset:14336
ds_write_b128 v2, v[72:75] offset:15360
ds_read_b64_tr_b16 v[60:61], v44 offset:16384
ds_read_b64_tr_b16 v[62:63], v44 offset:17408
ds_read_b64_tr_b16 v[64:65], v46 offset:16384
ds_read_b64_tr_b16 v[66:67], v46 offset:17408
ds_read_b64_tr_b16 v[68:69], v45 offset:16384
ds_read_b64_tr_b16 v[70:71], v45 offset:17408
ds_read_b64_tr_b16 v[72:73], v47 offset:16384
ds_read_b64_tr_b16 v[74:75], v47 offset:17408
s_waitcnt lgkmcnt(0)
s_waitcnt vmcnt(18)
s_barrier
ds_write_b128 v2, v[60:63] offset:16384
ds_write_b128 v2, v[64:67] offset:17408
ds_write_b128 v2, v[68:71] offset:18432
ds_write_b128 v2, v[72:75] offset:19456
ds_read_b64_tr_b16 v[60:61], v48 offset:20480
ds_read_b64_tr_b16 v[62:63], v48 offset:21504
ds_read_b64_tr_b16 v[64:65], v48 offset:22528
ds_read_b64_tr_b16 v[66:67], v48 offset:23552
ds_read_b64_tr_b16 v[68:69], v49 offset:20480
ds_read_b64_tr_b16 v[70:71], v49 offset:21504
ds_read_b64_tr_b16 v[72:73], v49 offset:22528
ds_read_b64_tr_b16 v[74:75], v49 offset:23552
s_waitcnt lgkmcnt(0)
s_waitcnt vmcnt(14)
s_barrier
ds_write_b128 v2, v[60:63] offset:20480
ds_write_b128 v2, v[64:67] offset:21504
ds_write_b128 v2, v[68:71] offset:22528
ds_write_b128 v2, v[72:75] offset:23552
ds_read_b64_tr_b16 v[60:61], v48 offset:24576
ds_read_b64_tr_b16 v[62:63], v48 offset:25600
ds_read_b64_tr_b16 v[64:65], v48 offset:26624
ds_read_b64_tr_b16 v[66:67], v48 offset:27648
ds_read_b64_tr_b16 v[68:69], v49 offset:24576
ds_read_b64_tr_b16 v[70:71], v49 offset:25600
ds_read_b64_tr_b16 v[72:73], v49 offset:26624
ds_read_b64_tr_b16 v[74:75], v49 offset:27648
s_waitcnt lgkmcnt(0)
s_waitcnt vmcnt(10)
s_barrier
ds_write_b128 v2, v[60:63] offset:24576
ds_write_b128 v2, v[64:67] offset:25600
ds_write_b128 v2, v[68:71] offset:26624
ds_write_b128 v2, v[72:75] offset:27648
ds_read_b64_tr_b16 v[60:61], v48 offset:28672
ds_read_b64_tr_b16 v[62:63], v48 offset:29696
ds_read_b64_tr_b16 v[64:65], v48 offset:30720
ds_read_b64_tr_b16 v[66:67], v48 offset:31744
ds_read_b64_tr_b16 v[68:69], v49 offset:28672
ds_read_b64_tr_b16 v[70:71], v49 offset:29696
ds_read_b64_tr_b16 v[72:73], v49 offset:30720
ds_read_b64_tr_b16 v[74:75], v49 offset:31744
s_waitcnt lgkmcnt(0)
s_barrier
ds_write_b128 v2, v[60:63] offset:28672
ds_write_b128 v2, v[64:67] offset:29696
ds_write_b128 v2, v[68:71] offset:30720
ds_write_b128 v2, v[72:75] offset:31744
s_lshl_b32 s57, s58, 5
s_mov_b32 s0, 0x3f003f00
s_mov_b32 s1, 0x3f003f00
s_mov_b32 s58, 304128
s_cmp_eq_u32 s38, s57
s_mov_b32 s56, 0x33333333
s_mov_b32 s57, 0x33333333
s_mov_b32 s2, 0x21800000
s_mov_b32 s55, -24
s_cbranch_scc0 L_slow_w2r
v_mov_b64 v[20:21], 0
v_mov_b64 v[22:23], 0
v_mov_b64 v[24:25], 0
v_mov_b64 v[26:27], 0
v_mov_b64 v[28:29], 0
v_mov_b64 v[30:31], 0
v_mov_b64 v[32:33], 0
v_mov_b64 v[34:35], 0
v_mov_b64 v[36:37], 0
v_mov_b64 v[38:39], 0
v_mov_b64 v[40:41], 0
v_mov_b64 v[42:43], 0
ds_read_b128 v[44:47], v2 offset:0
ds_read_b128 v[48:51], v2 offset:1024
v_bfe_u32 v77, v1, 6, 1
v_lshl_add_u32 v77, v77, 3, v1
v_lshlrev_b32 v77, 1, v77
v_lshlrev_b32 v78, 3, v1
s_mov_b32 s38, 0
s_waitcnt vmcnt(0) lgkmcnt(0)
s_branch L_top_w2rf
L_done_w2rf:
s_mul_i32 s40, s34, 10240
s_add_u32 s40, s40, 8093696
buffer_store_dword v11, v10, s[4:7], s40 offen sc0 sc1
s_waitcnt vmcnt(0) lgkmcnt(0)
s_endpgm
L_rdv2_w2r:
buffer_load_dword v32, v24, s[28:31], 0 offen sc0 sc1
s_sub_u32 s41, s41, 1
s_cbranch_scc1 L_exit
s_waitcnt vmcnt(0)
s_branch L_rdv_w2r
L_ra0_w2rf:
s_mov_b32 m0, 1024
s_nop 0
buffer_load_dwordx4 v1, s[4:7], s47 offen offset:0 sc1 lds
buffer_load_dwordx4 v1, s[4:7], s47 offen offset:1024 sc1 lds
buffer_load_dwordx4 v1, s[4:7], s47 offen offset:2048 sc1 lds
buffer_load_dwordx4 v1, s[4:7], s47 offen offset:3072 sc1 lds
s_sub_u32 s41, s41, 1
s_cbranch_scc1 L_exit
ds_read_b128 v[44:47], v2 offset:0
ds_read_b128 v[48:51], v2 offset:1024
v_mov_b64 v[20:21], 0
v_mov_b64 v[22:23], 0
v_mov_b64 v[24:25], 0
v_mov_b64 v[26:27], 0
v_mov_b64 v[28:29], 0
v_mov_b64 v[30:31], 0
v_mov_b64 v[32:33], 0
v_mov_b64 v[34:35], 0
v_mov_b64 v[36:37], 0
v_mov_b64 v[38:39], 0
v_mov_b64 v[40:41], 0
v_mov_b64 v[42:43], 0
s_waitcnt vmcnt(0)
ds_read_b128 v[60:63], v1 offset:1024
ds_read_b128 v[64:67], v1 offset:2048
ds_read_b128 v[68:71], v1 offset:3072
ds_read_b128 v[72:75], v1 offset:4096
s_branch L_s0_w2rf
L_ra1_w2rf:
L_ra2_w2rf:
s_waitcnt lgkmcnt(0)
s_barrier
s_mov_b32 m0, 5120
s_nop 0
buffer_load_dwordx4 v1, s[4:7], s48 offen offset:2048 sc1 lds
s_sub_u32 s41, s41, 1
s_cbranch_scc1 L_exit
s_waitcnt vmcnt(0)
s_barrier
ds_read_b128 v[76:79], v1 offset:5120
ds_read_b128 v[60:63], v1 offset:6144
ds_read_b128 v[64:67], v1 offset:7168
ds_read_b128 v[68:71], v1 offset:8192
ds_read_b128 v[72:75], v1 offset:9216
s_waitcnt lgkmcnt(0)
v_bitop3_b32 v6, v76, v60, s35 bitop3:0x7e
v_bitop3_b32 v6, v6, v64, s35 bitop3:0xf6
v_bitop3_b32 v6, v6, v68, s35 bitop3:0xf6
v_bitop3_b32 v6, v6, v72, s35 bitop3:0xf6
v_and_b32 v6, 1, v6
v_cmp_ne_u32 vcc, 0, v6

s_cbranch_vccnz L_ra2_w2rf
s_branch L_a1_w2rf
L_mx_w2rf:
s_waitcnt lgkmcnt(0)
v_max3_f32 v30, v12, v13, v28
v_max_f32 v30, v30, v29
v_mov_b32 v31, v30
s_nop 1
v_permlane16_swap_b32 v30, v31
v_max_f32 v30, v30, v31
v_mov_b32 v31, v30
s_nop 1
v_permlane32_swap_b32 v30, v31
v_max_f32 v30, v30, v31
ds_write_b32 v1, v30 offset:10248
s_waitcnt lgkmcnt(0)
s_barrier
ds_read_b128 v[32:35], v1 offset:10240
s_waitcnt lgkmcnt(0)
v_max3_f32 v32, v32, v33, v34
v_max_f32 v32, v32, v35
v_sub_f32 v14, v12, v32
v_sub_f32 v15, v13, v32
v_sub_f32 v30, v28, v32
v_sub_f32 v31, v29, v32
v_exp_f32 v14, v14
v_exp_f32 v15, v15
v_exp_f32 v30, v30
v_exp_f32 v31, v31
v_cvt_pk_bf16_f32 v14, v14, v15
v_cvt_pk_bf16_f32 v30, v30, v31
ds_write_b32 v5, v14 offset:14880
v_cndmask_b32_e64 v26, 0, v30, s[56:57]
v_cndmask_b32_e64 v27, 0, v30, s[56:57]
v_mov_b64 v[76:77], s[52:53]
v_mov_b64 v[78:79], s[52:53]
v_mov_b32_dpp v24, v26 quad_perm:[2,3,0,1] row_mask:0xf bank_mask:0xf
v_mov_b32_dpp v25, v26 quad_perm:[2,3,0,1] row_mask:0xf bank_mask:0xf
s_waitcnt lgkmcnt(0)
s_barrier
v_mov_b64 v[14:15], s[0:1]
ds_read_b128 v[16:19], v1 offset:14368
ds_read_b128 v[36:39], v1 offset:14336
s_waitcnt lgkmcnt(0)
v_mfma_f32_16x16x32_bf16 v[32:35], v[76:79], v[16:19], 0
v_mfma_f32_16x16x32_bf16 v[20:23], v[52:55], v[16:19], 0
v_mfma_f32_16x16x32_bf16 v[20:23], v[56:59], v[36:39], v[20:23]
v_mfma_f32_16x16x16_bf16 v[32:35], v[14:15], v[26:27], v[32:35]
v_mfma_f32_16x16x32_bf16 v[20:23], v[40:43], v[24:27], v[20:23]
s_nop 3
v_rcp_f32 v33, v32
s_nop 2
v_mul_f32_dpp v20, v33, v20 quad_perm:[0,1,0,1] row_mask:0xf bank_mask:0xf
v_mul_f32_dpp v21, v33, v21 quad_perm:[0,1,0,1] row_mask:0xf bank_mask:0xf
v_mul_f32_dpp v22, v33, v22 quad_perm:[0,1,0,1] row_mask:0xf bank_mask:0xf
v_mul_f32_dpp v23, v33, v23 quad_perm:[0,1,0,1] row_mask:0xf bank_mask:0xf
v_cvt_pk_bf16_f32 v20, v20, v21
v_cvt_pk_bf16_f32 v21, v22, v23
ds_write_b64 v6, v[20:21] offset:7168
v_mov_b32_dpp v16, v20 quad_perm:[0,1,0,1] row_mask:0xf bank_mask:0xf
v_mov_b32_dpp v17, v21 quad_perm:[0,1,0,1] row_mask:0xf bank_mask:0xf
v_mov_b32_dpp v18, v20 quad_perm:[2,3,2,3] row_mask:0xf bank_mask:0xf
v_mov_b32_dpp v19, v21 quad_perm:[2,3,2,3] row_mask:0xf bank_mask:0xf
v_mov_b64 v[76:77], 0
v_mov_b64 v[78:79], 0
v_mov_b64 v[36:37], 0
v_mov_b64 v[38:39], 0
v_mov_b64 v[24:25], 0
v_mov_b64 v[26:27], 0
v_mov_b64 v[32:33], 0
v_mov_b64 v[34:35], 0
s_waitcnt lgkmcnt(0)
s_branch L_mxb_w2rf

L_rr_w2rf:
buffer_load_dwordx4 v[60:63], v9, s[4:7], s3 offen offset:0 sc1
buffer_load_dwordx4 v[64:67], v9, s[4:7], s3 offen offset:1024 sc1
buffer_load_dwordx4 v[68:71], v9, s[4:7], s3 offen offset:2048 sc1
buffer_load_dwordx4 v[72:75], v9, s[4:7], s3 offen offset:3072 sc1
s_mov_b32 s38, 1
s_sub_u32 s41, s41, 1
s_cbranch_scc1 L_exit
s_waitcnt vmcnt(0)
s_branch L_r_w2rf
L_lw_w2rf:
v_and_b32 v60, 0x70, v1
ds_read_b64 v[62:63], v60 offset:512
s_sub_u32 s41, s41, 1
s_cbranch_scc1 L_exit
s_waitcnt lgkmcnt(0)
v_min_u32 v62, v62, v63
v_cmp_ne_u32 vcc, s34, v62
s_cbranch_vccnz L_lw_w2rf
s_mov_b32 s38, 0
s_branch L_lwb_w2rf
L_slow_w2r:
v_mov_b64 v[20:21], 0
v_mov_b64 v[22:23], 0
v_mov_b64 v[24:25], 0
v_mov_b64 v[26:27], 0
v_mov_b64 v[28:29], 0
v_mov_b64 v[30:31], 0
v_mov_b64 v[32:33], 0
v_mov_b64 v[34:35], 0
v_mov_b64 v[36:37], 0
v_mov_b64 v[38:39], 0
v_mov_b64 v[40:41], 0
v_mov_b64 v[42:43], 0
ds_read_b128 v[44:47], v2 offset:0
ds_read_b128 v[48:51], v2 offset:1024
v_bfe_u32 v77, v1, 6, 1
v_lshl_add_u32 v77, v77, 3, v1
v_lshlrev_b32 v77, 1, v77
v_lshlrev_b32 v78, 3, v1
s_mov_b32 s38, 0
s_waitcnt vmcnt(0) lgkmcnt(0)
s_branch L_top_w2rs
L_done_w2rs:
s_mul_i32 s40, s34, 10240
s_add_u32 s40, s40, 8093696
buffer_store_dword v11, v10, s[4:7], s40 offen sc0 sc1
s_waitcnt vmcnt(0) lgkmcnt(0)
s_endpgm
L_ra0_w2rs:
s_mov_b32 m0, 1024
s_nop 0
buffer_load_dwordx4 v1, s[4:7], s47 offen offset:0 sc0 sc1 lds
buffer_load_dwordx4 v1, s[4:7], s47 offen offset:1024 sc0 sc1 lds
buffer_load_dwordx4 v1, s[4:7], s47 offen offset:2048 sc0 sc1 lds
buffer_load_dwordx4 v1, s[4:7], s47 offen offset:3072 sc0 sc1 lds
s_sub_u32 s41, s41, 1
s_cbranch_scc1 L_exit
ds_read_b128 v[44:47], v2 offset:0
ds_read_b128 v[48:51], v2 offset:1024
v_mov_b64 v[20:21], 0
v_mov_b64 v[22:23], 0
v_mov_b64 v[24:25], 0
v_mov_b64 v[26:27], 0
v_mov_b64 v[28:29], 0
v_mov_b64 v[30:31], 0
v_mov_b64 v[32:33], 0
v_mov_b64 v[34:35], 0
v_mov_b64 v[36:37], 0
v_mov_b64 v[38:39], 0
v_mov_b64 v[40:41], 0
v_mov_b64 v[42:43], 0
s_waitcnt vmcnt(0)
ds_read_b128 v[60:63], v1 offset:1024
ds_read_b128 v[64:67], v1 offset:2048
ds_read_b128 v[68:71], v1 offset:3072
ds_read_b128 v[72:75], v1 offset:4096
s_branch L_s0_w2rs
L_ra1_w2rs:
L_ra2_w2rs:
s_waitcnt lgkmcnt(0)
s_barrier
s_mov_b32 m0, 5120
s_nop 0
buffer_load_dwordx4 v1, s[4:7], s48 offen offset:2048 sc0 sc1 lds
s_sub_u32 s41, s41, 1
s_cbranch_scc1 L_exit
s_waitcnt vmcnt(0)
s_barrier
ds_read_b128 v[76:79], v1 offset:5120
ds_read_b128 v[60:63], v1 offset:6144
ds_read_b128 v[64:67], v1 offset:7168
ds_read_b128 v[68:71], v1 offset:8192
ds_read_b128 v[72:75], v1 offset:9216
s_waitcnt lgkmcnt(0)
v_bitop3_b32 v6, v76, v60, s35 bitop3:0x7e
v_bitop3_b32 v6, v6, v64, s35 bitop3:0xf6
v_bitop3_b32 v6, v6, v68, s35 bitop3:0xf6
v_bitop3_b32 v6, v6, v72, s35 bitop3:0xf6
v_and_b32 v6, 1, v6
v_cmp_ne_u32 vcc, 0, v6

s_cbranch_vccnz L_ra2_w2rs
s_branch L_a1_w2rs
L_mx_w2rs:
s_waitcnt lgkmcnt(0)
v_max3_f32 v30, v12, v13, v28
v_max_f32 v30, v30, v29
v_mov_b32 v31, v30
s_nop 1
v_permlane16_swap_b32 v30, v31
v_max_f32 v30, v30, v31
v_mov_b32 v31, v30
s_nop 1
v_permlane32_swap_b32 v30, v31
v_max_f32 v30, v30, v31
ds_write_b32 v1, v30 offset:10248
s_waitcnt lgkmcnt(0)
s_barrier
ds_read_b128 v[32:35], v1 offset:10240
s_waitcnt lgkmcnt(0)
v_max3_f32 v32, v32, v33, v34
v_max_f32 v32, v32, v35
v_sub_f32 v14, v12, v32
v_sub_f32 v15, v13, v32
v_sub_f32 v30, v28, v32
v_sub_f32 v31, v29, v32
v_exp_f32 v14, v14
v_exp_f32 v15, v15
v_exp_f32 v30, v30
v_exp_f32 v31, v31
v_cvt_pk_bf16_f32 v14, v14, v15
v_cvt_pk_bf16_f32 v30, v30, v31
ds_write_b32 v5, v14 offset:14880
v_cndmask_b32_e64 v26, 0, v30, s[56:57]
v_cndmask_b32_e64 v27, 0, v30, s[56:57]
v_mov_b64 v[76:77], s[52:53]
v_mov_b64 v[78:79], s[52:53]
v_mov_b32_dpp v24, v26 quad_perm:[2,3,0,1] row_mask:0xf bank_mask:0xf
v_mov_b32_dpp v25, v26 quad_perm:[2,3,0,1] row_mask:0xf bank_mask:0xf
s_waitcnt lgkmcnt(0)
s_barrier
v_mov_b64 v[14:15], s[0:1]
ds_read_b128 v[16:19], v1 offset:14368
ds_read_b128 v[36:39], v1 offset:14336
s_waitcnt lgkmcnt(0)
v_mfma_f32_16x16x32_bf16 v[32:35], v[76:79], v[16:19], 0
v_mfma_f32_16x16x32_bf16 v[20:23], v[52:55], v[16:19], 0
v_mfma_f32_16x16x32_bf16 v[20:23], v[56:59], v[36:39], v[20:23]
v_mfma_f32_16x16x16_bf16 v[32:35], v[14:15], v[26:27], v[32:35]
v_mfma_f32_16x16x32_bf16 v[20:23], v[40:43], v[24:27], v[20:23]
s_nop 3
v_rcp_f32 v33, v32
s_nop 2
v_mul_f32_dpp v20, v33, v20 quad_perm:[0,1,0,1] row_mask:0xf bank_mask:0xf
v_mul_f32_dpp v21, v33, v21 quad_perm:[0,1,0,1] row_mask:0xf bank_mask:0xf
v_mul_f32_dpp v22, v33, v22 quad_perm:[0,1,0,1] row_mask:0xf bank_mask:0xf
v_mul_f32_dpp v23, v33, v23 quad_perm:[0,1,0,1] row_mask:0xf bank_mask:0xf
v_cvt_pk_bf16_f32 v20, v20, v21
v_cvt_pk_bf16_f32 v21, v22, v23
ds_write_b64 v6, v[20:21] offset:7168
v_mov_b32_dpp v16, v20 quad_perm:[0,1,0,1] row_mask:0xf bank_mask:0xf
v_mov_b32_dpp v17, v21 quad_perm:[0,1,0,1] row_mask:0xf bank_mask:0xf
v_mov_b32_dpp v18, v20 quad_perm:[2,3,2,3] row_mask:0xf bank_mask:0xf
v_mov_b32_dpp v19, v21 quad_perm:[2,3,2,3] row_mask:0xf bank_mask:0xf
v_mov_b64 v[76:77], 0
v_mov_b64 v[78:79], 0
v_mov_b64 v[36:37], 0
v_mov_b64 v[38:39], 0
v_mov_b64 v[24:25], 0
v_mov_b64 v[26:27], 0
v_mov_b64 v[32:33], 0
v_mov_b64 v[34:35], 0
s_waitcnt lgkmcnt(0)
s_branch L_mxb_w2rs

L_rr_w2rs:
buffer_load_dwordx4 v[60:63], v9, s[4:7], s3 offen offset:0 sc0 sc1
buffer_load_dwordx4 v[64:67], v9, s[4:7], s3 offen offset:1024 sc0 sc1
buffer_load_dwordx4 v[68:71], v9, s[4:7], s3 offen offset:2048 sc0 sc1
buffer_load_dwordx4 v[72:75], v9, s[4:7], s3 offen offset:3072 sc0 sc1
s_mov_b32 s38, 1
s_sub_u32 s41, s41, 1
s_cbranch_scc1 L_exit
s_waitcnt vmcnt(0)
s_branch L_r_w2rs
L_lw_w2rs:
v_and_b32 v60, 0x70, v1
ds_read_b64 v[62:63], v60 offset:512
s_sub_u32 s41, s41, 1
s_cbranch_scc1 L_exit
s_waitcnt lgkmcnt(0)
v_min_u32 v62, v62, v63
v_cmp_ne_u32 vcc, s34, v62
s_cbranch_vccnz L_lw_w2rs
s_mov_b32 s38, 0
s_branch L_lwb_w2rs
L_pro_w3:
v_and_b32 v20, 63, v0
v_lshlrev_b32 v1, 4, v20
v_add_u32 v2, 131072, v1
v_and_b32 v23, 1, v22
v_lshl_add_u32 v23, v24, 4, v23
v_mul_u32_u24 v23, 1152, v23
v_lshlrev_b32 v28, 2, v22
v_xor_b32 v28, v28, v21
v_lshl_add_u32 v28, v28, 4, v23
s_mul_i32 s55, s32, 147456
s_waitcnt lgkmcnt(0)
v_and_b32 v23, 1, v22
v_lshrrev_b32 v24, 2, v21
v_lshl_add_u32 v23, v23, 2, v24
v_lshlrev_b32 v23, 1, v23
v_bfe_u32 v44, v21, 1, 1
v_add_u32 v44, 12, v44
v_xor_b32 v44, v44, v23
v_lshlrev_b32 v44, 4, v44
v_lshl_add_u32 v44, v24, 8, v44
v_and_b32 v23, 1, v22
v_lshl_add_u32 v44, v23, 11, v44
v_and_b32 v23, 1, v21
v_lshl_add_u32 v44, v23, 3, v44
v_lshrrev_b32 v23, 1, v22
v_mul_u32_u24 v23, 40960, v23
v_add_u32 v23, 16384, v23
v_add_u32 v44, v44, v23
v_and_b32 v23, 1, v22
v_lshrrev_b32 v24, 2, v21
v_lshl_add_u32 v23, v23, 2, v24
v_lshlrev_b32 v23, 1, v23
v_bfe_u32 v45, v21, 1, 1
v_add_u32 v45, 14, v45
v_xor_b32 v45, v45, v23
v_lshlrev_b32 v45, 4, v45
v_lshl_add_u32 v45, v24, 8, v45
v_and_b32 v23, 1, v22
v_lshl_add_u32 v45, v23, 11, v45
v_and_b32 v23, 1, v21
v_lshl_add_u32 v45, v23, 3, v45
v_lshrrev_b32 v23, 1, v22
v_mul_u32_u24 v23, 40960, v23
v_add_u32 v23, 16384, v23
v_add_u32 v45, v45, v23
v_and_b32 v23, 1, v22
v_lshrrev_b32 v24, 2, v21
v_lshl_add_u32 v23, v23, 2, v24
v_lshlrev_b32 v23, 1, v23
v_bfe_u32 v46, v21, 1, 1
v_add_u32 v46, 12, v46
v_xor_b32 v46, v46, v23
v_lshlrev_b32 v46, 4, v46
v_lshl_add_u32 v46, v24, 8, v46
v_and_b32 v23, 1, v22
v_lshl_add_u32 v46, v23, 11, v46
v_and_b32 v23, 1, v21
v_lshl_add_u32 v46, v23, 3, v46
v_lshrrev_b32 v23, 1, v22
v_mul_u32_u24 v23, 32768, v23
v_add_u32 v23, 98304, v23
v_add_u32 v46, v46, v23
v_and_b32 v23, 1, v22
v_lshrrev_b32 v24, 2, v21
v_lshl_add_u32 v23, v23, 2, v24
v_lshlrev_b32 v23, 1, v23
v_bfe_u32 v47, v21, 1, 1
v_add_u32 v47, 14, v47
v_xor_b32 v47, v47, v23
v_lshlrev_b32 v47, 4, v47
v_lshl_add_u32 v47, v24, 8, v47
v_and_b32 v23, 1, v22
v_lshl_add_u32 v47, v23, 11, v47
v_and_b32 v23, 1, v21
v_lshl_add_u32 v47, v23, 3, v47
v_lshrrev_b32 v23, 1, v22
v_mul_u32_u24 v23, 32768, v23
v_add_u32 v23, 98304, v23
v_add_u32 v47, v47, v23
v_and_b32 v23, 1, v22
v_bfe_u32 v24, v21, 2, 1
v_lshl_add_u32 v23, v23, 1, v24
v_xor_b32 v24, 3, v23
v_lshlrev_b32 v24, 6, v24
v_lshl_add_u32 v48, v23, 8, v24
v_and_b32 v23, 3, v21
v_lshl_add_u32 v48, v23, 4, v48
v_and_b32 v23, 8, v21
v_add_u32 v48, v48, v23
v_lshrrev_b32 v23, 1, v22
v_mul_u32_u24 v23, 40960, v23
v_add_u32 v23, 16384, v23
v_add_u32 v48, v48, v23
v_and_b32 v23, 1, v22
v_bfe_u32 v24, v21, 2, 1
v_lshl_add_u32 v23, v23, 1, v24
v_xor_b32 v24, 3, v23
v_lshlrev_b32 v24, 6, v24
v_lshl_add_u32 v49, v23, 8, v24
v_and_b32 v23, 3, v21
v_lshl_add_u32 v49, v23, 4, v49
v_and_b32 v23, 8, v21
v_add_u32 v49, v49, v23
v_lshrrev_b32 v23, 1, v22
v_mul_u32_u24 v23, 32768, v23
v_add_u32 v23, 98304, v23
v_add_u32 v49, v49, v23
v_bfe_u32 v23, v21, 1, 1
v_mul_u32_u24 v23, 0xaaaa, v23
v_add_u32 v0, 0x4444, v23
v_lshlrev_b32 v3, 3, v20
v_lshrrev_b32 v25, 5, v20
v_lshlrev_b32 v25, 6, v25
v_xor_b32 v3, v3, v25
v_lshrrev_b32 v25, 2, v20
v_and_b32 v4, 3, v21
v_lshl_add_u32 v4, v4, 4, v25
v_lshlrev_b32 v4, 3, v4
v_bfe_u32 v25, v21, 1, 1
v_lshlrev_b32 v23, 6, v25
v_xor_b32 v4, v4, v23
v_lshlrev_b32 v5, 4, v21
v_lshl_add_u32 v5, v22, 2, v5
v_mul_u32_u24 v23, 256, v25
v_add_u32 v5, v5, v23
v_lshlrev_b32 v9, 8, v22
v_lshl_add_u32 v9, v25, 6, v9
v_bfe_u32 v23, v21, 3, 1
v_lshl_add_u32 v9, v23, 7, v9
v_bfe_u32 v23, v21, 2, 1
v_lshl_add_u32 v9, v23, 5, v9
v_and_b32 v23, 1, v21
v_lshl_add_u32 v9, v23, 4, v9
v_lshrrev_b32 v23, 1, v22
v_and_b32 v24, 1, v22
v_and_b32 v25, 7, v21
v_lshrrev_b32 v7, 3, v21
v_lshl_add_u32 v8, v7, 1, v23
v_lshlrev_b32 v8, 12, v8
v_lshl_add_u32 v8, v24, 7, v8
v_and_b32 v25, 4, v21
v_lshl_add_u32 v8, v25, 3, v8
v_and_b32 v25, 1, v21
v_lshl_add_u32 v8, v25, 4, v8
v_bfe_u32 v25, v21, 1, 1
v_lshl_add_u32 v8, v25, 3, v8
s_lshr_b32 s56, s32, 1
s_lshl_b32 s56, s56, 8
s_and_b32 s57, s32, 1
s_lshl_b32 s57, s57, 6
s_add_u32 s56, s56, s57
s_add_u32 s56, s56, 49152
v_add_u32 v8, s56, v8
v_and_b32 v7, 0x3d0, v1
s_mov_b32 s42, 0
s_mov_b32 s43, 65536
s_mov_b32 s44, 131072
s_mov_b32 s45, 196608
s_mov_b32 s46, 262144
s_mov_b32 s47, 294912
s_mov_b32 s48, 299008
s_mov_b32 s49, 303104
s_mov_b32 s50, 0x3e0293ee
s_mov_b32 s51, 0x3e0293ee
s_mov_b32 s52, 0x3f803f80
s_mov_b32 s53, 0x3f803f80
v_lshlrev_b32 v11, 2, v21
s_mov_b32 s34, 0
s_mov_b32 s35, -1
s_mov_b32 s36, 0
s_mov_b32 s41, 300000
s_lshl_b32 s37, s32, 14
s_add_u32 s39, s37, 17309696
s_add_u32 s37, s37, 16789504
s_mov_b32 s40, 8749056
v_mov_b64 v[36:37], 0
v_mov_b64 v[38:39], 0
s_lshl_b32 s56, s32, 1
s_add_u32 s56, s56, 1
s_cmp_eq_u32 s56, 0
s_cselect_b32 s56, 64, s56
s_mul_i32 s56, s56, 10240
s_add_u32 s56, s56, 8392704
s_add_u32 s57, s56, 4096
v_mov_b32 v40, 1
v_mov_b32 v41, 1
v_mov_b32 v42, 1
v_mov_b32 v43, 1
buffer_store_dwordx4 v[40:43], v1, s[4:7], s56 offen offset:0 sc0 sc1
buffer_store_dwordx4 v[40:43], v1, s[4:7], s56 offen offset:1024 sc0 sc1
buffer_store_dwordx4 v[40:43], v1, s[4:7], s56 offen offset:2048 sc0 sc1
buffer_store_dwordx4 v[40:43], v1, s[4:7], s56 offen offset:3072 sc0 sc1
buffer_store_dwordx4 v[40:43], v1, s[4:7], s57 offen offset:0 sc0 sc1
s_lshl_b32 s56, s32, 10
s_add_u32 s56, s56, 327680
buffer_store_dwordx4 v[36:39], v1, s[4:7], s56 offen sc0 sc1
s_getreg_b32 s56, hwreg(HW_REG_XCC_ID)
s_and_b32 s56, s56, 15
s_mul_i32 s57, s56, s56
s_lshl_b32 s57, s57, 18
s_lshl_b32 s56, s56, 8
s_add_u32 s57, s57, s56
s_add_u32 s58, s57, 1
s_lshl_b32 s101, s32, 7
s_add_u32 s101, s101, 327680
v_mov_b32 v24, 0
s_mov_b32 s3, s101
v_mov_b32 v10, 0
s_add_u32 s56, s54, 393216
s_mov_b32 m0, 143360
s_nop 0
buffer_load_dwordx4 v26, s[12:15], s56 offen lds
s_add_u32 s56, s54, 409600
s_mov_b32 m0, 144384
s_nop 0
buffer_load_dwordx4 v26, s[12:15], s56 offen lds
s_add_u32 s56, s54, 425984
s_mov_b32 m0, 145408
s_nop 0
buffer_load_dwordx4 v27, s[12:15], s56 offen lds
s_add_u32 s56, s54, 442368
s_mov_b32 m0, 146432
s_nop 0
buffer_load_dwordx4 v27, s[12:15], s56 offen lds
s_add_u32 s56, s54, 917504
s_mov_b32 m0, 147456
s_nop 0
buffer_load_dwordx4 v26, s[12:15], s56 offen lds
s_add_u32 s56, s54, 933888
s_mov_b32 m0, 148480
s_nop 0
buffer_load_dwordx4 v26, s[12:15], s56 offen lds
s_add_u32 s56, s54, 950272
s_mov_b32 m0, 149504
s_nop 0
buffer_load_dwordx4 v27, s[12:15], s56 offen lds
s_add_u32 s56, s54, 966656
s_mov_b32 m0, 150528
s_nop 0
buffer_load_dwordx4 v27, s[12:15], s56 offen lds
v_mov_b32 v24, 0
s_waitcnt vmcnt(34)
s_barrier
ds_read_b64_tr_b16 v[80:81], v44 offset:20480
ds_read_b64_tr_b16 v[82:83], v44 offset:21504
ds_read_b64_tr_b16 v[84:85], v46 offset:20480
ds_read_b64_tr_b16 v[86:87], v46 offset:21504
ds_read_b64_tr_b16 v[88:89], v45 offset:20480
ds_read_b64_tr_b16 v[90:91], v45 offset:21504
ds_read_b64_tr_b16 v[92:93], v47 offset:20480
ds_read_b64_tr_b16 v[94:95], v47 offset:21504
s_waitcnt lgkmcnt(0)
s_waitcnt vmcnt(30)
s_barrier
s_add_u32 s56, s54, 1441792
s_mov_b32 m0, 151552
s_nop 0
buffer_load_dwordx4 v26, s[12:15], s56 offen lds
s_add_u32 s56, s54, 1458176
s_mov_b32 m0, 152576
s_nop 0
buffer_load_dwordx4 v26, s[12:15], s56 offen lds
s_add_u32 s56, s54, 1474560
s_mov_b32 m0, 153600
s_nop 0
buffer_load_dwordx4 v27, s[12:15], s56 offen lds
s_add_u32 s56, s54, 1490944
s_mov_b32 m0, 154624
s_nop 0
buffer_load_dwordx4 v27, s[12:15], s56 offen lds
ds_read_b64_tr_b16 v[96:97], v44 offset:24576
ds_read_b64_tr_b16 v[98:99], v44 offset:25600
ds_read_b64_tr_b16 v[100:101], v46 offset:24576
ds_read_b64_tr_b16 v[102:103], v46 offset:25600
ds_read_b64_tr_b16 v[104:105], v45 offset:24576
ds_read_b64_tr_b16 v[106:107], v45 offset:25600
ds_read_b64_tr_b16 v[108:109], v47 offset:24576
ds_read_b64_tr_b16 v[110:111], v47 offset:25600
s_waitcnt lgkmcnt(0)
s_waitcnt vmcnt(30)
s_barrier
s_add_u32 s56, s54, 1966080
s_mov_b32 m0, 155648
s_nop 0
buffer_load_dwordx4 v26, s[12:15], s56 offen lds
s_add_u32 s56, s54, 1982464
s_mov_b32 m0, 156672
s_nop 0
buffer_load_dwordx4 v26, s[12:15], s56 offen lds
s_add_u32 s56, s54, 1998848
s_mov_b32 m0, 157696
s_nop 0
buffer_load_dwordx4 v27, s[12:15], s56 offen lds
s_add_u32 s56, s54, 2015232
s_mov_b32 m0, 158720
s_nop 0
buffer_load_dwordx4 v27, s[12:15], s56 offen lds
ds_read_b64_tr_b16 v[112:113], v44 offset:28672
ds_read_b64_tr_b16 v[114:115], v44 offset:29696
ds_read_b64_tr_b16 v[116:117], v46 offset:28672
ds_read_b64_tr_b16 v[118:119], v46 offset:29696
ds_read_b64_tr_b16 v[120:121], v45 offset:28672
ds_read_b64_tr_b16 v[122:123], v45 offset:29696
ds_read_b64_tr_b16 v[124:125], v47 offset:28672
ds_read_b64_tr_b16 v[126:127], v47 offset:29696
s_waitcnt lgkmcnt(0)
s_waitcnt vmcnt(30)
s_barrier
s_add_u32 s56, s54, 2490368
s_mov_b32 m0, 159744
s_nop 0
buffer_load_dwordx4 v26, s[12:15], s56 offen lds
s_add_u32 s56, s54, 2506752
s_mov_b32 m0, 160768
s_nop 0
buffer_load_dwordx4 v26, s[12:15], s56 offen lds
s_add_u32 s56, s54, 2523136
s_mov_b32 m0, 161792
s_nop 0
buffer_load_dwordx4 v27, s[12:15], s56 offen lds
s_add_u32 s56, s54, 2539520
s_mov_b32 m0, 162816
s_nop 0
buffer_load_dwordx4 v27, s[12:15], s56 offen lds
ds_read_b64_tr_b16 v[128:129], v44 offset:0
ds_read_b64_tr_b16 v[130:131], v44 offset:1024
ds_read_b64_tr_b16 v[132:133], v46 offset:0
ds_read_b64_tr_b16 v[134:135], v46 offset:1024
ds_read_b64_tr_b16 v[136:137], v45 offset:0
ds_read_b64_tr_b16 v[138:139], v45 offset:1024
ds_read_b64_tr_b16 v[140:141], v47 offset:0
ds_read_b64_tr_b16 v[142:143], v47 offset:1024
s_waitcnt lgkmcnt(0)
s_waitcnt vmcnt(30)
s_barrier
s_add_u32 s56, s54, 3538944
s_mov_b32 m0, 131072
s_nop 0
buffer_load_dwordx4 v26, s[12:15], s56 offen lds
s_add_u32 s56, s54, 3555328
s_mov_b32 m0, 132096
s_nop 0
buffer_load_dwordx4 v26, s[12:15], s56 offen lds
s_add_u32 s56, s54, 3571712
s_mov_b32 m0, 133120
s_nop 0
buffer_load_dwordx4 v27, s[12:15], s56 offen lds
s_add_u32 s56, s54, 3588096
s_mov_b32 m0, 134144
s_nop 0
buffer_load_dwordx4 v27, s[12:15], s56 offen lds
ds_read_b64_tr_b16 v[144:145], v44 offset:4096
ds_read_b64_tr_b16 v[146:147], v44 offset:5120
ds_read_b64_tr_b16 v[148:149], v46 offset:4096
ds_read_b64_tr_b16 v[150:151], v46 offset:5120
ds_read_b64_tr_b16 v[152:153], v45 offset:4096
ds_read_b64_tr_b16 v[154:155], v45 offset:5120
ds_read_b64_tr_b16 v[156:157], v47 offset:4096
ds_read_b64_tr_b16 v[158:159], v47 offset:5120
s_waitcnt lgkmcnt(0)
s_waitcnt vmcnt(30)
s_barrier
s_add_u32 s56, s54, 4063232
s_mov_b32 m0, 135168
s_nop 0
buffer_load_dwordx4 v26, s[12:15], s56 offen lds
s_add_u32 s56, s54, 4079616
s_mov_b32 m0, 136192
s_nop 0
buffer_load_dwordx4 v26, s[12:15], s56 offen lds
s_add_u32 s56, s54, 4096000
s_mov_b32 m0, 137216
s_nop 0
buffer_load_dwordx4 v27, s[12:15], s56 offen lds
s_add_u32 s56, s54, 4112384
s_mov_b32 m0, 138240
s_nop 0
buffer_load_dwordx4 v27, s[12:15], s56 offen lds
ds_read_b64_tr_b16 v[160:161], v44 offset:8192
ds_read_b64_tr_b16 v[162:163], v44 offset:9216
ds_read_b64_tr_b16 v[164:165], v46 offset:8192
ds_read_b64_tr_b16 v[166:167], v46 offset:9216
ds_read_b64_tr_b16 v[168:169], v45 offset:8192
ds_read_b64_tr_b16 v[170:171], v45 offset:9216
ds_read_b64_tr_b16 v[172:173], v47 offset:8192
ds_read_b64_tr_b16 v[174:175], v47 offset:9216
s_waitcnt lgkmcnt(0)
s_waitcnt vmcnt(24)
s_barrier
s_add_u32 s56, s54, 4587520
s_mov_b32 m0, 139264
s_nop 0
buffer_load_dwordx4 v26, s[12:15], s56 offen lds
s_add_u32 s56, s54, 4603904
s_mov_b32 m0, 140288
s_nop 0
buffer_load_dwordx4 v26, s[12:15], s56 offen lds
s_add_u32 s56, s54, 4620288
s_mov_b32 m0, 141312
s_nop 0
buffer_load_dwordx4 v27, s[12:15], s56 offen lds
s_add_u32 s56, s54, 4636672
s_mov_b32 m0, 142336
s_nop 0
buffer_load_dwordx4 v27, s[12:15], s56 offen lds
ds_read_b64_tr_b16 v[176:177], v44 offset:12288
ds_read_b64_tr_b16 v[178:179], v44 offset:13312
ds_read_b64_tr_b16 v[180:181], v46 offset:12288
ds_read_b64_tr_b16 v[182:183], v46 offset:13312
ds_read_b64_tr_b16 v[184:185], v45 offset:12288
ds_read_b64_tr_b16 v[186:187], v45 offset:13312
ds_read_b64_tr_b16 v[188:189], v47 offset:12288
ds_read_b64_tr_b16 v[190:191], v47 offset:13312
s_waitcnt lgkmcnt(0)
s_waitcnt vmcnt(24)
s_barrier
s_add_u32 s56, s54, 393216
s_mov_b32 m0, 143360
s_nop 0
buffer_load_dwordx4 v26, s[16:19], s56 offen lds
s_add_u32 s56, s54, 409600
s_mov_b32 m0, 144384
s_nop 0
buffer_load_dwordx4 v26, s[16:19], s56 offen lds
s_add_u32 s56, s54, 425984
s_mov_b32 m0, 145408
s_nop 0
buffer_load_dwordx4 v27, s[16:19], s56 offen lds
s_add_u32 s56, s54, 442368
s_mov_b32 m0, 146432
s_nop 0
buffer_load_dwordx4 v27, s[16:19], s56 offen lds
ds_read_b64_tr_b16 v[192:193], v44 offset:16384
ds_read_b64_tr_b16 v[194:195], v44 offset:17408
ds_read_b64_tr_b16 v[196:197], v46 offset:16384
ds_read_b64_tr_b16 v[198:199], v46 offset:17408
ds_read_b64_tr_b16 v[200:201], v45 offset:16384
ds_read_b64_tr_b16 v[202:203], v45 offset:17408
ds_read_b64_tr_b16 v[204:205], v47 offset:16384
ds_read_b64_tr_b16 v[206:207], v47 offset:17408
s_waitcnt lgkmcnt(0)
s_waitcnt vmcnt(24)
s_barrier
s_add_u32 s56, s54, 917504
s_mov_b32 m0, 147456
s_nop 0
buffer_load_dwordx4 v26, s[16:19], s56 offen lds
s_add_u32 s56, s54, 933888
s_mov_b32 m0, 148480
s_nop 0
buffer_load_dwordx4 v26, s[16:19], s56 offen lds
s_add_u32 s56, s54, 950272
s_mov_b32 m0, 149504
s_nop 0
buffer_load_dwordx4 v27, s[16:19], s56 offen lds
s_add_u32 s56, s54, 966656
s_mov_b32 m0, 150528
s_nop 0
buffer_load_dwordx4 v27, s[16:19], s56 offen lds
ds_read_b64_tr_b16 v[208:209], v44 offset:20480
ds_read_b64_tr_b16 v[210:211], v44 offset:21504
ds_read_b64_tr_b16 v[212:213], v46 offset:20480
ds_read_b64_tr_b16 v[214:215], v46 offset:21504
ds_read_b64_tr_b16 v[216:217], v45 offset:20480
ds_read_b64_tr_b16 v[218:219], v45 offset:21504
ds_read_b64_tr_b16 v[220:221], v47 offset:20480
ds_read_b64_tr_b16 v[222:223], v47 offset:21504
s_waitcnt lgkmcnt(0)
s_waitcnt vmcnt(24)
s_barrier
s_add_u32 s56, s54, 1441792
s_mov_b32 m0, 151552
s_nop 0
buffer_load_dwordx4 v26, s[16:19], s56 offen lds
s_add_u32 s56, s54, 1458176
s_mov_b32 m0, 152576
s_nop 0
buffer_load_dwordx4 v26, s[16:19], s56 offen lds
s_add_u32 s56, s54, 1474560
s_mov_b32 m0, 153600
s_nop 0
buffer_load_dwordx4 v27, s[16:19], s56 offen lds
s_add_u32 s56, s54, 1490944
s_mov_b32 m0, 154624
s_nop 0
buffer_load_dwordx4 v27, s[16:19], s56 offen lds
ds_read_b64_tr_b16 v[224:225], v44 offset:24576
ds_read_b64_tr_b16 v[226:227], v44 offset:25600
ds_read_b64_tr_b16 v[228:229], v46 offset:24576
ds_read_b64_tr_b16 v[230:231], v46 offset:25600
ds_read_b64_tr_b16 v[232:233], v45 offset:24576
ds_read_b64_tr_b16 v[234:235], v45 offset:25600
ds_read_b64_tr_b16 v[236:237], v47 offset:24576
ds_read_b64_tr_b16 v[238:239], v47 offset:25600
s_waitcnt lgkmcnt(0)
s_waitcnt vmcnt(24)
s_barrier
s_add_u32 s56, s54, 1966080
s_mov_b32 m0, 155648
s_nop 0
buffer_load_dwordx4 v26, s[16:19], s56 offen lds
s_add_u32 s56, s54, 1982464
s_mov_b32 m0, 156672
s_nop 0
buffer_load_dwordx4 v26, s[16:19], s56 offen lds
s_add_u32 s56, s54, 1998848
s_mov_b32 m0, 157696
s_nop 0
buffer_load_dwordx4 v27, s[16:19], s56 offen lds
s_add_u32 s56, s54, 2015232
s_mov_b32 m0, 158720
s_nop 0
buffer_load_dwordx4 v27, s[16:19], s56 offen lds
ds_read_b64_tr_b16 v[240:241], v44 offset:28672
ds_read_b64_tr_b16 v[242:243], v44 offset:29696
ds_read_b64_tr_b16 v[244:245], v46 offset:28672
ds_read_b64_tr_b16 v[246:247], v46 offset:29696
ds_read_b64_tr_b16 v[248:249], v45 offset:28672
ds_read_b64_tr_b16 v[250:251], v45 offset:29696
ds_read_b64_tr_b16 v[252:253], v47 offset:28672
ds_read_b64_tr_b16 v[254:255], v47 offset:29696
s_waitcnt lgkmcnt(0)
s_waitcnt vmcnt(24)
s_barrier
s_add_u32 s56, s54, 2490368
s_mov_b32 m0, 159744
s_nop 0
buffer_load_dwordx4 v26, s[16:19], s56 offen lds
s_add_u32 s56, s54, 2506752
s_mov_b32 m0, 160768
s_nop 0
buffer_load_dwordx4 v26, s[16:19], s56 offen lds
s_add_u32 s56, s54, 2523136
s_mov_b32 m0, 161792
s_nop 0
buffer_load_dwordx4 v27, s[16:19], s56 offen lds
s_add_u32 s56, s54, 2539520
s_mov_b32 m0, 162816
s_nop 0
buffer_load_dwordx4 v27, s[16:19], s56 offen lds
ds_read_b64_tr_b16 a[0:1], v44 offset:0
ds_read_b64_tr_b16 a[2:3], v44 offset:1024
ds_read_b64_tr_b16 a[4:5], v46 offset:0
ds_read_b64_tr_b16 a[6:7], v46 offset:1024
ds_read_b64_tr_b16 a[8:9], v45 offset:0
ds_read_b64_tr_b16 a[10:11], v45 offset:1024
ds_read_b64_tr_b16 a[12:13], v47 offset:0
ds_read_b64_tr_b16 a[14:15], v47 offset:1024
s_waitcnt lgkmcnt(0)
s_waitcnt vmcnt(24)
s_barrier
s_add_u32 s56, s54, 3014656
s_mov_b32 m0, 131072
s_nop 0
buffer_load_dwordx4 v26, s[16:19], s56 offen lds
s_add_u32 s56, s54, 3031040
s_mov_b32 m0, 132096
s_nop 0
buffer_load_dwordx4 v26, s[16:19], s56 offen lds
s_add_u32 s56, s54, 3047424
s_mov_b32 m0, 133120
s_nop 0
buffer_load_dwordx4 v27, s[16:19], s56 offen lds
s_add_u32 s56, s54, 3063808
s_mov_b32 m0, 134144
s_nop 0
buffer_load_dwordx4 v27, s[16:19], s56 offen lds
ds_read_b64_tr_b16 a[16:17], v44 offset:4096
ds_read_b64_tr_b16 a[18:19], v44 offset:5120
ds_read_b64_tr_b16 a[20:21], v46 offset:4096
ds_read_b64_tr_b16 a[22:23], v46 offset:5120
ds_read_b64_tr_b16 a[24:25], v45 offset:4096
ds_read_b64_tr_b16 a[26:27], v45 offset:5120
ds_read_b64_tr_b16 a[28:29], v47 offset:4096
ds_read_b64_tr_b16 a[30:31], v47 offset:5120
s_waitcnt lgkmcnt(0)
s_waitcnt vmcnt(24)
s_barrier
s_add_u32 s56, s54, 3538944
s_mov_b32 m0, 135168
s_nop 0
buffer_load_dwordx4 v26, s[16:19], s56 offen lds
s_add_u32 s56, s54, 3555328
s_mov_b32 m0, 136192
s_nop 0
buffer_load_dwordx4 v26, s[16:19], s56 offen lds
s_add_u32 s56, s54, 3571712
s_mov_b32 m0, 137216
s_nop 0
buffer_load_dwordx4 v27, s[16:19], s56 offen lds
s_add_u32 s56, s54, 3588096
s_mov_b32 m0, 138240
s_nop 0
buffer_load_dwordx4 v27, s[16:19], s56 offen lds
ds_read_b64_tr_b16 a[32:33], v44 offset:8192
ds_read_b64_tr_b16 a[34:35], v44 offset:9216
ds_read_b64_tr_b16 a[36:37], v46 offset:8192
ds_read_b64_tr_b16 a[38:39], v46 offset:9216
ds_read_b64_tr_b16 a[40:41], v45 offset:8192
ds_read_b64_tr_b16 a[42:43], v45 offset:9216
ds_read_b64_tr_b16 a[44:45], v47 offset:8192
ds_read_b64_tr_b16 a[46:47], v47 offset:9216
s_waitcnt lgkmcnt(0)
s_waitcnt vmcnt(24)
s_barrier
s_add_u32 s56, s54, 4063232
s_mov_b32 m0, 139264
s_nop 0
buffer_load_dwordx4 v26, s[16:19], s56 offen lds
s_add_u32 s56, s54, 4079616
s_mov_b32 m0, 140288
s_nop 0
buffer_load_dwordx4 v26, s[16:19], s56 offen lds
s_add_u32 s56, s54, 4096000
s_mov_b32 m0, 141312
s_nop 0
buffer_load_dwordx4 v27, s[16:19], s56 offen lds
s_add_u32 s56, s54, 4112384
s_mov_b32 m0, 142336
s_nop 0
buffer_load_dwordx4 v27, s[16:19], s56 offen lds
ds_read_b64_tr_b16 a[48:49], v44 offset:12288
ds_read_b64_tr_b16 a[50:51], v44 offset:13312
ds_read_b64_tr_b16 a[52:53], v46 offset:12288
ds_read_b64_tr_b16 a[54:55], v46 offset:13312
ds_read_b64_tr_b16 a[56:57], v45 offset:12288
ds_read_b64_tr_b16 a[58:59], v45 offset:13312
ds_read_b64_tr_b16 a[60:61], v47 offset:12288
ds_read_b64_tr_b16 a[62:63], v47 offset:13312
s_waitcnt lgkmcnt(0)
s_waitcnt vmcnt(24)
s_barrier
s_add_u32 s56, s55, 115200
s_mov_b32 m0, 143360
s_nop 0
buffer_load_dwordx4 v28, s[20:23], s56 offen lds
s_add_u32 s56, s55, 117504
s_mov_b32 m0, 144384
s_nop 0
buffer_load_dwordx4 v28, s[20:23], s56 offen lds
s_add_u32 s56, s55, 124416
s_mov_b32 m0, 145408
s_nop 0
buffer_load_dwordx4 v28, s[20:23], s56 offen lds
s_add_u32 s56, s55, 126720
s_mov_b32 m0, 146432
s_nop 0
buffer_load_dwordx4 v28, s[20:23], s56 offen lds
ds_read_b64_tr_b16 a[64:65], v44 offset:16384
ds_read_b64_tr_b16 a[66:67], v44 offset:17408
ds_read_b64_tr_b16 a[68:69], v46 offset:16384
ds_read_b64_tr_b16 a[70:71], v46 offset:17408
ds_read_b64_tr_b16 a[72:73], v45 offset:16384
ds_read_b64_tr_b16 a[74:75], v45 offset:17408
ds_read_b64_tr_b16 a[76:77], v47 offset:16384
ds_read_b64_tr_b16 a[78:79], v47 offset:17408
s_waitcnt lgkmcnt(0)
s_waitcnt vmcnt(24)
s_barrier
s_add_u32 s56, s55, 115456
s_mov_b32 m0, 147456
s_nop 0
buffer_load_dwordx4 v28, s[20:23], s56 offen lds
s_add_u32 s56, s55, 117760
s_mov_b32 m0, 148480
s_nop 0
buffer_load_dwordx4 v28, s[20:23], s56 offen lds
s_add_u32 s56, s55, 124672
s_mov_b32 m0, 149504
s_nop 0
buffer_load_dwordx4 v28, s[20:23], s56 offen lds
s_add_u32 s56, s55, 126976
s_mov_b32 m0, 150528
s_nop 0
buffer_load_dwordx4 v28, s[20:23], s56 offen lds
ds_read_b64_tr_b16 a[80:81], v44 offset:20480
ds_read_b64_tr_b16 a[82:83], v44 offset:21504
ds_read_b64_tr_b16 a[84:85], v46 offset:20480
ds_read_b64_tr_b16 a[86:87], v46 offset:21504
ds_read_b64_tr_b16 a[88:89], v45 offset:20480
ds_read_b64_tr_b16 a[90:91], v45 offset:21504
ds_read_b64_tr_b16 a[92:93], v47 offset:20480
ds_read_b64_tr_b16 a[94:95], v47 offset:21504
s_waitcnt lgkmcnt(0)
s_waitcnt vmcnt(24)
s_barrier
s_add_u32 s56, s55, 115712
s_mov_b32 m0, 151552
s_nop 0
buffer_load_dwordx4 v28, s[20:23], s56 offen lds
s_add_u32 s56, s55, 118016
s_mov_b32 m0, 152576
s_nop 0
buffer_load_dwordx4 v28, s[20:23], s56 offen lds
s_add_u32 s56, s55, 124928
s_mov_b32 m0, 153600
s_nop 0
buffer_load_dwordx4 v28, s[20:23], s56 offen lds
s_add_u32 s56, s55, 127232
s_mov_b32 m0, 154624
s_nop 0
buffer_load_dwordx4 v28, s[20:23], s56 offen lds
ds_read_b64_tr_b16 a[96:97], v44 offset:24576
ds_read_b64_tr_b16 a[98:99], v44 offset:25600
ds_read_b64_tr_b16 a[100:101], v46 offset:24576
ds_read_b64_tr_b16 a[102:103], v46 offset:25600
ds_read_b64_tr_b16 a[104:105], v45 offset:24576
ds_read_b64_tr_b16 a[106:107], v45 offset:25600
ds_read_b64_tr_b16 a[108:109], v47 offset:24576
ds_read_b64_tr_b16 a[110:111], v47 offset:25600
s_waitcnt lgkmcnt(0)
s_waitcnt vmcnt(24)
s_barrier
s_add_u32 s56, s55, 115968
s_mov_b32 m0, 155648
s_nop 0
buffer_load_dwordx4 v28, s[20:23], s56 offen lds
s_add_u32 s56, s55, 118272
s_mov_b32 m0, 156672
s_nop 0
buffer_load_dwordx4 v28, s[20:23], s56 offen lds
s_add_u32 s56, s55, 125184
s_mov_b32 m0, 157696
s_nop 0
buffer_load_dwordx4 v28, s[20:23], s56 offen lds
s_add_u32 s56, s55, 127488
s_mov_b32 m0, 158720
s_nop 0
buffer_load_dwordx4 v28, s[20:23], s56 offen lds
ds_read_b64_tr_b16 a[112:113], v44 offset:28672
ds_read_b64_tr_b16 a[114:115], v44 offset:29696
ds_read_b64_tr_b16 a[116:117], v46 offset:28672
ds_read_b64_tr_b16 a[118:119], v46 offset:29696
ds_read_b64_tr_b16 a[120:121], v45 offset:28672
ds_read_b64_tr_b16 a[122:123], v45 offset:29696
ds_read_b64_tr_b16 a[124:125], v47 offset:28672
ds_read_b64_tr_b16 a[126:127], v47 offset:29696
s_waitcnt lgkmcnt(0)
s_waitcnt vmcnt(24)
s_barrier
s_add_u32 s56, s55, 41472
s_mov_b32 m0, 159744
s_nop 0
buffer_load_dwordx4 v28, s[20:23], s56 offen lds
s_add_u32 s56, s55, 43776
s_mov_b32 m0, 160768
s_nop 0
buffer_load_dwordx4 v28, s[20:23], s56 offen lds
s_add_u32 s56, s55, 50688
s_mov_b32 m0, 161792
s_nop 0
buffer_load_dwordx4 v28, s[20:23], s56 offen lds
s_add_u32 s56, s55, 52992
s_mov_b32 m0, 162816
s_nop 0
buffer_load_dwordx4 v28, s[20:23], s56 offen lds
ds_read_b64_tr_b16 a[128:129], v44 offset:0
ds_read_b64_tr_b16 a[130:131], v44 offset:1024
ds_read_b64_tr_b16 a[132:133], v46 offset:0
ds_read_b64_tr_b16 a[134:135], v46 offset:1024
ds_read_b64_tr_b16 a[136:137], v45 offset:0
ds_read_b64_tr_b16 a[138:139], v45 offset:1024
ds_read_b64_tr_b16 a[140:141], v47 offset:0
ds_read_b64_tr_b16 a[142:143], v47 offset:1024
buffer_load_dword v32, v24, s[28:31], 0 offen sc0 sc1
s_waitcnt lgkmcnt(0)
s_waitcnt vmcnt(25)
s_barrier
s_add_u32 s56, s54, 393216
s_mov_b32 m0, 131072
s_nop 0
buffer_load_dwordx4 v26, s[8:11], s56 offen lds
s_add_u32 s56, s54, 409600
s_mov_b32 m0, 132096
s_nop 0
buffer_load_dwordx4 v26, s[8:11], s56 offen lds
s_add_u32 s56, s54, 425984
s_mov_b32 m0, 133120
s_nop 0
buffer_load_dwordx4 v27, s[8:11], s56 offen lds
s_add_u32 s56, s54, 442368
s_mov_b32 m0, 134144
s_nop 0
buffer_load_dwordx4 v27, s[8:11], s56 offen lds
ds_read_b64_tr_b16 a[144:145], v44 offset:4096
ds_read_b64_tr_b16 a[146:147], v44 offset:5120
ds_read_b64_tr_b16 a[148:149], v46 offset:4096
ds_read_b64_tr_b16 a[150:151], v46 offset:5120
ds_read_b64_tr_b16 a[152:153], v45 offset:4096
ds_read_b64_tr_b16 a[154:155], v45 offset:5120
ds_read_b64_tr_b16 a[156:157], v47 offset:4096
ds_read_b64_tr_b16 a[158:159], v47 offset:5120
s_waitcnt lgkmcnt(0)
s_waitcnt vmcnt(25)
s_barrier
s_add_u32 s56, s54, 1966080
s_mov_b32 m0, 135168
s_nop 0
buffer_load_dwordx4 v26, s[8:11], s56 offen lds
s_add_u32 s56, s54, 1982464
s_mov_b32 m0, 136192
s_nop 0
buffer_load_dwordx4 v26, s[8:11], s56 offen lds
s_add_u32 s56, s54, 1998848
s_mov_b32 m0, 137216
s_nop 0
buffer_load_dwordx4 v27, s[8:11], s56 offen lds
s_add_u32 s56, s54, 2015232
s_mov_b32 m0, 138240
s_nop 0
buffer_load_dwordx4 v27, s[8:11], s56 offen lds
ds_read_b64_tr_b16 a[160:161], v44 offset:8192
ds_read_b64_tr_b16 a[162:163], v44 offset:9216
ds_read_b64_tr_b16 a[164:165], v46 offset:8192
ds_read_b64_tr_b16 a[166:167], v46 offset:9216
ds_read_b64_tr_b16 a[168:169], v45 offset:8192
ds_read_b64_tr_b16 a[170:171], v45 offset:9216
ds_read_b64_tr_b16 a[172:173], v47 offset:8192
ds_read_b64_tr_b16 a[174:175], v47 offset:9216
s_waitcnt lgkmcnt(0)
s_waitcnt vmcnt(25)
s_barrier
s_add_u32 s56, s54, 2490368
s_mov_b32 m0, 139264
s_nop 0
buffer_load_dwordx4 v26, s[8:11], s56 offen lds
s_add_u32 s56, s54, 2506752
s_mov_b32 m0, 140288
s_nop 0
buffer_load_dwordx4 v26, s[8:11], s56 offen lds
s_add_u32 s56, s54, 2523136
s_mov_b32 m0, 141312
s_nop 0
buffer_load_dwordx4 v27, s[8:11], s56 offen lds
s_add_u32 s56, s54, 2539520
s_mov_b32 m0, 142336
s_nop 0
buffer_load_dwordx4 v27, s[8:11], s56 offen lds
ds_read_b64_tr_b16 a[216:217], v48 offset:12288
ds_read_b64_tr_b16 a[218:219], v48 offset:13312
ds_read_b64_tr_b16 a[220:221], v48 offset:14336
ds_read_b64_tr_b16 a[222:223], v48 offset:15360
ds_read_b64_tr_b16 a[176:177], v49 offset:12288
ds_read_b64_tr_b16 a[178:179], v49 offset:13312
ds_read_b64_tr_b16 a[180:181], v49 offset:14336
ds_read_b64_tr_b16 a[182:183], v49 offset:15360
s_waitcnt lgkmcnt(0)
s_waitcnt vmcnt(25)
s_barrier
s_add_u32 s56, s54, 3014656
s_mov_b32 m0, 143360
s_nop 0
buffer_load_dwordx4 v26, s[12:15], s56 offen lds
s_add_u32 s56, s54, 3031040
s_mov_b32 m0, 144384
s_nop 0
buffer_load_dwordx4 v26, s[12:15], s56 offen lds
s_add_u32 s56, s54, 3047424
s_mov_b32 m0, 145408
s_nop 0
buffer_load_dwordx4 v27, s[12:15], s56 offen lds
s_add_u32 s56, s54, 3063808
s_mov_b32 m0, 146432
s_nop 0
buffer_load_dwordx4 v27, s[12:15], s56 offen lds
ds_read_b64_tr_b16 a[232:233], v48 offset:16384
ds_read_b64_tr_b16 a[234:235], v48 offset:17408
ds_read_b64_tr_b16 a[236:237], v48 offset:18432
ds_read_b64_tr_b16 a[238:239], v48 offset:19456
ds_read_b64_tr_b16 a[184:185], v49 offset:16384
ds_read_b64_tr_b16 a[186:187], v49 offset:17408
ds_read_b64_tr_b16 a[188:189], v49 offset:18432
ds_read_b64_tr_b16 a[190:191], v49 offset:19456
s_waitcnt lgkmcnt(0)
s_waitcnt vmcnt(25)
s_barrier
s_add_u32 s56, s54, 4587520
s_mov_b32 m0, 147456
s_nop 0
buffer_load_dwordx4 v26, s[16:19], s56 offen lds
s_add_u32 s56, s54, 4603904
s_mov_b32 m0, 148480
s_nop 0
buffer_load_dwordx4 v26, s[16:19], s56 offen lds
s_add_u32 s56, s54, 4620288
s_mov_b32 m0, 149504
s_nop 0
buffer_load_dwordx4 v27, s[16:19], s56 offen lds
s_add_u32 s56, s54, 4636672
s_mov_b32 m0, 150528
s_nop 0
buffer_load_dwordx4 v27, s[16:19], s56 offen lds
ds_read_b64_tr_b16 a[240:241], v48 offset:20480
ds_read_b64_tr_b16 a[242:243], v48 offset:21504
ds_read_b64_tr_b16 a[244:245], v48 offset:22528
ds_read_b64_tr_b16 a[246:247], v48 offset:23552
ds_read_b64_tr_b16 a[192:193], v49 offset:20480
ds_read_b64_tr_b16 a[194:195], v49 offset:21504
ds_read_b64_tr_b16 a[196:197], v49 offset:22528
ds_read_b64_tr_b16 a[198:199], v49 offset:23552
s_waitcnt lgkmcnt(0)
s_waitcnt vmcnt(25)
s_barrier
s_add_u32 s56, s55, 41728
s_mov_b32 m0, 151552
s_nop 0
buffer_load_dwordx4 v28, s[20:23], s56 offen lds
s_add_u32 s56, s55, 44032
s_mov_b32 m0, 152576
s_nop 0
buffer_load_dwordx4 v28, s[20:23], s56 offen lds
s_add_u32 s56, s55, 50944
s_mov_b32 m0, 153600
s_nop 0
buffer_load_dwordx4 v28, s[20:23], s56 offen lds
s_add_u32 s56, s55, 53248
s_mov_b32 m0, 154624
s_nop 0
buffer_load_dwordx4 v28, s[20:23], s56 offen lds
ds_read_b64_tr_b16 a[248:249], v48 offset:24576
ds_read_b64_tr_b16 a[250:251], v48 offset:25600
ds_read_b64_tr_b16 a[252:253], v48 offset:26624
ds_read_b64_tr_b16 a[254:255], v48 offset:27648
ds_read_b64_tr_b16 a[200:201], v49 offset:24576
ds_read_b64_tr_b16 a[202:203], v49 offset:25600
ds_read_b64_tr_b16 a[204:205], v49 offset:26624
ds_read_b64_tr_b16 a[206:207], v49 offset:27648
s_waitcnt lgkmcnt(0)
s_waitcnt vmcnt(25)
s_barrier
s_add_u32 s56, s55, 41984
s_mov_b32 m0, 155648
s_nop 0
buffer_load_dwordx4 v28, s[20:23], s56 offen lds
s_add_u32 s56, s55, 44288
s_mov_b32 m0, 156672
s_nop 0
buffer_load_dwordx4 v28, s[20:23], s56 offen lds
s_add_u32 s56, s55, 51200
s_mov_b32 m0, 157696
s_nop 0
buffer_load_dwordx4 v28, s[20:23], s56 offen lds
s_add_u32 s56, s55, 53504
s_mov_b32 m0, 158720
s_nop 0
buffer_load_dwordx4 v28, s[20:23], s56 offen lds
ds_read_b64_tr_b16 a[224:225], v48 offset:28672
ds_read_b64_tr_b16 a[226:227], v48 offset:29696
ds_read_b64_tr_b16 a[228:229], v48 offset:30720
ds_read_b64_tr_b16 a[230:231], v48 offset:31744
ds_read_b64_tr_b16 a[208:209], v49 offset:28672
ds_read_b64_tr_b16 a[210:211], v49 offset:29696
ds_read_b64_tr_b16 a[212:213], v49 offset:30720
ds_read_b64_tr_b16 a[214:215], v49 offset:31744
s_waitcnt lgkmcnt(0)
s_waitcnt vmcnt(24)
s_barrier
s_add_u32 s56, s55, 42240
s_mov_b32 m0, 159744
s_nop 0
buffer_load_dwordx4 v28, s[20:23], s56 offen lds
s_add_u32 s56, s55, 44544
s_mov_b32 m0, 160768
s_nop 0
buffer_load_dwordx4 v28, s[20:23], s56 offen lds
s_add_u32 s56, s55, 51456
s_mov_b32 m0, 161792
s_nop 0
buffer_load_dwordx4 v28, s[20:23], s56 offen lds
s_add_u32 s56, s55, 53760
s_mov_b32 m0, 162816
s_nop 0
buffer_load_dwordx4 v28, s[20:23], s56 offen lds
ds_read_b64_tr_b16 v[60:61], v44 offset:0
ds_read_b64_tr_b16 v[62:63], v44 offset:1024
ds_read_b64_tr_b16 v[64:65], v46 offset:0
ds_read_b64_tr_b16 v[66:67], v46 offset:1024
ds_read_b64_tr_b16 v[68:69], v45 offset:0
ds_read_b64_tr_b16 v[70:71], v45 offset:1024
ds_read_b64_tr_b16 v[72:73], v47 offset:0
ds_read_b64_tr_b16 v[74:75], v47 offset:1024
s_waitcnt lgkmcnt(0)
s_waitcnt vmcnt(24)
s_barrier
ds_write_b128 v2, v[60:63] offset:0
ds_write_b128 v2, v[64:67] offset:1024
ds_write_b128 v2, v[68:71] offset:2048
ds_write_b128 v2, v[72:75] offset:3072
ds_read_b64_tr_b16 v[60:61], v44 offset:4096
ds_read_b64_tr_b16 v[62:63], v44 offset:5120
ds_read_b64_tr_b16 v[64:65], v46 offset:4096
ds_read_b64_tr_b16 v[66:67], v46 offset:5120
ds_read_b64_tr_b16 v[68:69], v45 offset:4096
ds_read_b64_tr_b16 v[70:71], v45 offset:5120
ds_read_b64_tr_b16 v[72:73], v47 offset:4096
ds_read_b64_tr_b16 v[74:75], v47 offset:5120
L_rdv_w3:
v_readfirstlane_b32 s38, v32
s_nop 0
s_and_b32 s57, s38, 0xff
s_cmp_lg_u32 s57, 32
s_cbranch_scc1 L_rdv2_w3
L_kvw_w3p:
s_load_dwordx16 s[64:79], s[4:5], s101 glc
s_sub_u32 s41, s41, 1
s_cbranch_scc1 L_exit
s_waitcnt lgkmcnt(0)
s_min_u32 s64, s64, s65
s_min_u32 s64, s64, s66
s_min_u32 s64, s64, s67
s_min_u32 s64, s64, s68
s_min_u32 s64, s64, s69
s_min_u32 s64, s64, s70
s_min_u32 s64, s64, s71
s_min_u32 s64, s64, s72
s_min_u32 s64, s64, s73
s_min_u32 s64, s64, s74
s_min_u32 s64, s64, s75
s_min_u32 s64, s64, s76
s_min_u32 s64, s64, s77
s_min_u32 s64, s64, s78
s_min_u32 s64, s64, s79
s_lshl_b32 s100, s64, 2
s_sub_u32 s100, s100, 1
s_cmp_ge_i32 s34, s100
s_cbranch_scc1 L_kvw_w3p
s_waitcnt lgkmcnt(0)
s_waitcnt vmcnt(20)
s_barrier
ds_write_b128 v2, v[60:63] offset:4096
ds_write_b128 v2, v[64:67] offset:5120
ds_write_b128 v2, v[68:71] offset:6144
ds_write_b128 v2, v[72:75] offset:7168
ds_read_b64_tr_b16 v[60:61], v44 offset:8192
ds_read_b64_tr_b16 v[62:63], v44 offset:9216
ds_read_b64_tr_b16 v[64:65], v46 offset:8192
ds_read_b64_tr_b16 v[66:67], v46 offset:9216
ds_read_b64_tr_b16 v[68:69], v45 offset:8192
ds_read_b64_tr_b16 v[70:71], v45 offset:9216
ds_read_b64_tr_b16 v[72:73], v47 offset:8192
ds_read_b64_tr_b16 v[74:75], v47 offset:9216
buffer_load_dwordx4 v[12:15], v9, s[4:7], s37 offen offset:0
buffer_load_dwordx4 v[16:19], v9, s[4:7], s37 offen offset:1024
buffer_load_dwordx4 v[52:55], v1, s[4:7], s37 offen offset:2048
buffer_load_dwordx4 v[56:59], v1, s[4:7], s37 offen offset:3072
s_mov_b32 m0, 1024
s_nop 0
buffer_load_dwordx4 v1, s[4:7], s47 offen offset:3072 sc1 lds
s_waitcnt lgkmcnt(0)
s_waitcnt vmcnt(21)
s_barrier
ds_write_b128 v2, v[60:63] offset:8192
ds_write_b128 v2, v[64:67] offset:9216
ds_write_b128 v2, v[68:71] offset:10240
ds_write_b128 v2, v[72:75] offset:11264
ds_read_b64_tr_b16 v[60:61], v44 offset:12288
ds_read_b64_tr_b16 v[62:63], v44 offset:13312
ds_read_b64_tr_b16 v[64:65], v46 offset:12288
ds_read_b64_tr_b16 v[66:67], v46 offset:13312
ds_read_b64_tr_b16 v[68:69], v45 offset:12288
ds_read_b64_tr_b16 v[70:71], v45 offset:13312
ds_read_b64_tr_b16 v[72:73], v47 offset:12288
ds_read_b64_tr_b16 v[74:75], v47 offset:13312
s_waitcnt lgkmcnt(0)
s_waitcnt vmcnt(17)
s_barrier
ds_write_b128 v2, v[60:63] offset:12288
ds_write_b128 v2, v[64:67] offset:13312
ds_write_b128 v2, v[68:71] offset:14336
ds_write_b128 v2, v[72:75] offset:15360
ds_read_b64_tr_b16 v[60:61], v44 offset:16384
ds_read_b64_tr_b16 v[62:63], v44 offset:17408
ds_read_b64_tr_b16 v[64:65], v46 offset:16384
ds_read_b64_tr_b16 v[66:67], v46 offset:17408
ds_read_b64_tr_b16 v[68:69], v45 offset:16384
ds_read_b64_tr_b16 v[70:71], v45 offset:17408
ds_read_b64_tr_b16 v[72:73], v47 offset:16384
ds_read_b64_tr_b16 v[74:75], v47 offset:17408
s_waitcnt lgkmcnt(0)
s_waitcnt vmcnt(13)
s_barrier
ds_write_b128 v2, v[60:63] offset:16384
ds_write_b128 v2, v[64:67] offset:17408
ds_write_b128 v2, v[68:71] offset:18432
ds_write_b128 v2, v[72:75] offset:19456
ds_read_b64_tr_b16 v[60:61], v48 offset:20480
ds_read_b64_tr_b16 v[62:63], v48 offset:21504
ds_read_b64_tr_b16 v[64:65], v48 offset:22528
ds_read_b64_tr_b16 v[66:67], v48 offset:23552
ds_read_b64_tr_b16 v[68:69], v49 offset:20480
ds_read_b64_tr_b16 v[70:71], v49 offset:21504
ds_read_b64_tr_b16 v[72:73], v49 offset:22528
ds_read_b64_tr_b16 v[74:75], v49 offset:23552
s_waitcnt lgkmcnt(0)
s_waitcnt vmcnt(9)
s_barrier
ds_write_b128 v2, v[60:63] offset:20480
ds_write_b128 v2, v[64:67] offset:21504
ds_write_b128 v2, v[68:71] offset:22528
ds_write_b128 v2, v[72:75] offset:23552
ds_read_b64_tr_b16 v[60:61], v48 offset:24576
ds_read_b64_tr_b16 v[62:63], v48 offset:25600
ds_read_b64_tr_b16 v[64:65], v48 offset:26624
ds_read_b64_tr_b16 v[66:67], v48 offset:27648
ds_read_b64_tr_b16 v[68:69], v49 offset:24576
ds_read_b64_tr_b16 v[70:71], v49 offset:25600
ds_read_b64_tr_b16 v[72:73], v49 offset:26624
ds_read_b64_tr_b16 v[74:75], v49 offset:27648
s_waitcnt lgkmcnt(0)
s_waitcnt vmcnt(5)
s_barrier
ds_write_b128 v2, v[60:63] offset:24576
ds_write_b128 v2, v[64:67] offset:25600
ds_write_b128 v2, v[68:71] offset:26624
ds_write_b128 v2, v[72:75] offset:27648
ds_read_b64_tr_b16 v[60:61], v48 offset:28672
ds_read_b64_tr_b16 v[62:63], v48 offset:29696
ds_read_b64_tr_b16 v[64:65], v48 offset:30720
ds_read_b64_tr_b16 v[66:67], v48 offset:31744
ds_read_b64_tr_b16 v[68:69], v49 offset:28672
ds_read_b64_tr_b16 v[70:71], v49 offset:29696
ds_read_b64_tr_b16 v[72:73], v49 offset:30720
ds_read_b64_tr_b16 v[74:75], v49 offset:31744
s_waitcnt lgkmcnt(0)
s_barrier
ds_write_b128 v2, v[60:63] offset:28672
ds_write_b128 v2, v[64:67] offset:29696
ds_write_b128 v2, v[68:71] offset:30720
ds_write_b128 v2, v[72:75] offset:31744
s_lshl_b32 s57, s58, 5
s_mov_b32 s0, 0x3f003f00
s_mov_b32 s1, 0x3f003f00
s_mov_b32 s58, 304128
s_cmp_eq_u32 s38, s57
s_mov_b32 s56, 0x33333333
s_mov_b32 s57, 0x33333333
s_mov_b32 s2, 0x21800000
s_mov_b32 s55, -24
s_cbranch_scc0 L_slow_w3
v_mov_b64 v[20:21], 0
v_mov_b64 v[22:23], 0
v_mov_b64 v[24:25], 0
v_mov_b64 v[26:27], 0
v_mov_b64 v[28:29], 0
v_mov_b64 v[30:31], 0
v_mov_b64 v[32:33], 0
v_mov_b64 v[34:35], 0
v_mov_b64 v[36:37], 0
v_mov_b64 v[38:39], 0
v_mov_b64 v[40:41], 0
v_mov_b64 v[42:43], 0
ds_read_b128 v[44:47], v2 offset:0
ds_read_b128 v[48:51], v2 offset:1024
v_bfe_u32 v77, v1, 6, 1
v_lshl_add_u32 v77, v77, 3, v1
v_lshlrev_b32 v77, 1, v77
v_lshlrev_b32 v78, 3, v1
s_mov_b32 s38, 0
s_waitcnt vmcnt(0) lgkmcnt(0)
s_branch L_top_w3f
L_done_w3f:
s_waitcnt vmcnt(0) lgkmcnt(0)
s_endpgm
L_rdv2_w3:
buffer_load_dword v32, v24, s[28:31], 0 offen sc0 sc1
s_sub_u32 s41, s41, 1
s_cbranch_scc1 L_exit
s_waitcnt vmcnt(0)
s_branch L_rdv_w3
L_ra0_w3f:
s_mov_b32 m0, 1024
s_nop 0
buffer_load_dwordx4 v1, s[4:7], s47 offen offset:0 sc1 lds
buffer_load_dwordx4 v1, s[4:7], s47 offen offset:1024 sc1 lds
buffer_load_dwordx4 v1, s[4:7], s47 offen offset:2048 sc1 lds
buffer_load_dwordx4 v1, s[4:7], s47 offen offset:3072 sc1 lds
s_sub_u32 s41, s41, 1
s_cbranch_scc1 L_exit
ds_read_b128 v[44:47], v2 offset:0
ds_read_b128 v[48:51], v2 offset:1024
v_mov_b64 v[20:21], 0
v_mov_b64 v[22:23], 0
v_mov_b64 v[24:25], 0
v_mov_b64 v[26:27], 0
v_mov_b64 v[28:29], 0
v_mov_b64 v[30:31], 0
v_mov_b64 v[32:33], 0
v_mov_b64 v[34:35], 0
v_mov_b64 v[36:37], 0
v_mov_b64 v[38:39], 0
v_mov_b64 v[40:41], 0
v_mov_b64 v[42:43], 0
s_waitcnt vmcnt(0)
ds_read_b128 v[60:63], v1 offset:1024
ds_read_b128 v[64:67], v1 offset:2048
ds_read_b128 v[68:71], v1 offset:3072
ds_read_b128 v[72:75], v1 offset:4096
s_branch L_s0_w3f
L_ra1_w3f:
L_ra2_w3f:
s_waitcnt lgkmcnt(0)
s_barrier
s_mov_b32 m0, 5120
s_nop 0
buffer_load_dwordx4 v1, s[4:7], s48 offen offset:3072 sc1 lds
s_sub_u32 s41, s41, 1
s_cbranch_scc1 L_exit
s_waitcnt vmcnt(0)
s_barrier
ds_read_b128 v[76:79], v1 offset:5120
ds_read_b128 v[60:63], v1 offset:6144
ds_read_b128 v[64:67], v1 offset:7168
ds_read_b128 v[68:71], v1 offset:8192
ds_read_b128 v[72:75], v1 offset:9216
s_waitcnt lgkmcnt(0)
v_bitop3_b32 v6, v76, v60, s35 bitop3:0x7e
v_bitop3_b32 v6, v6, v64, s35 bitop3:0xf6
v_bitop3_b32 v6, v6, v68, s35 bitop3:0xf6
v_bitop3_b32 v6, v6, v72, s35 bitop3:0xf6
v_and_b32 v6, 1, v6
v_cmp_ne_u32 vcc, 0, v6

s_cbranch_vccnz L_ra2_w3f
s_branch L_a1_w3f
L_mx_w3f:
s_waitcnt lgkmcnt(0)
v_max3_f32 v30, v12, v13, v28
v_max_f32 v30, v30, v29
v_mov_b32 v31, v30
s_nop 1
v_permlane16_swap_b32 v30, v31
v_max_f32 v30, v30, v31
v_mov_b32 v31, v30
s_nop 1
v_permlane32_swap_b32 v30, v31
v_max_f32 v30, v30, v31
ds_write_b32 v1, v30 offset:10252
s_waitcnt lgkmcnt(0)
s_barrier
ds_read_b128 v[32:35], v1 offset:10240
s_waitcnt lgkmcnt(0)
v_max3_f32 v32, v32, v33, v34
v_max_f32 v32, v32, v35
v_sub_f32 v14, v12, v32
v_sub_f32 v15, v13, v32
v_sub_f32 v30, v28, v32
v_sub_f32 v31, v29, v32
v_exp_f32 v14, v14
v_exp_f32 v15, v15
v_exp_f32 v30, v30
v_exp_f32 v31, v31
v_cvt_pk_bf16_f32 v14, v14, v15
v_cvt_pk_bf16_f32 v30, v30, v31
ds_write_b32 v5, v14 offset:15136
v_cndmask_b32_e64 v26, 0, v30, s[56:57]
v_cndmask_b32_e64 v27, 0, v30, s[56:57]
v_mov_b64 v[76:77], s[52:53]
v_mov_b64 v[78:79], s[52:53]
v_mov_b32_dpp v24, v26 quad_perm:[2,3,0,1] row_mask:0xf bank_mask:0xf
v_mov_b32_dpp v25, v26 quad_perm:[2,3,0,1] row_mask:0xf bank_mask:0xf
s_waitcnt lgkmcnt(0)
s_barrier
v_mov_b64 v[14:15], s[0:1]
ds_read_b128 v[16:19], v1 offset:14368
ds_read_b128 v[36:39], v1 offset:14336
s_waitcnt lgkmcnt(0)
v_mfma_f32_16x16x32_bf16 v[32:35], v[76:79], v[16:19], 0
v_mfma_f32_16x16x32_bf16 v[20:23], v[52:55], v[16:19], 0
v_mfma_f32_16x16x32_bf16 v[20:23], v[56:59], v[36:39], v[20:23]
v_mfma_f32_16x16x16_bf16 v[32:35], v[14:15], v[26:27], v[32:35]
v_mfma_f32_16x16x32_bf16 v[20:23], v[40:43], v[24:27], v[20:23]
s_nop 3
v_rcp_f32 v33, v32
s_nop 2
v_mul_f32_dpp v20, v33, v20 quad_perm:[0,1,0,1] row_mask:0xf bank_mask:0xf
v_mul_f32_dpp v21, v33, v21 quad_perm:[0,1,0,1] row_mask:0xf bank_mask:0xf
v_mul_f32_dpp v22, v33, v22 quad_perm:[0,1,0,1] row_mask:0xf bank_mask:0xf
v_mul_f32_dpp v23, v33, v23 quad_perm:[0,1,0,1] row_mask:0xf bank_mask:0xf
v_cvt_pk_bf16_f32 v20, v20, v21
v_cvt_pk_bf16_f32 v21, v22, v23
ds_write_b64 v6, v[20:21] offset:8192
v_mov_b32_dpp v16, v20 quad_perm:[0,1,0,1] row_mask:0xf bank_mask:0xf
v_mov_b32_dpp v17, v21 quad_perm:[0,1,0,1] row_mask:0xf bank_mask:0xf
v_mov_b32_dpp v18, v20 quad_perm:[2,3,2,3] row_mask:0xf bank_mask:0xf
v_mov_b32_dpp v19, v21 quad_perm:[2,3,2,3] row_mask:0xf bank_mask:0xf
v_mov_b64 v[76:77], 0
v_mov_b64 v[78:79], 0
v_mov_b64 v[36:37], 0
v_mov_b64 v[38:39], 0
v_mov_b64 v[24:25], 0
v_mov_b64 v[26:27], 0
v_mov_b64 v[32:33], 0
v_mov_b64 v[34:35], 0
s_waitcnt lgkmcnt(0)
s_branch L_mxb_w3f

L_ev_w3f:
buffer_load_dword v11, v11, s[4:7], s101 offen sc0 sc1
s_sub_u32 s41, s41, 1
s_cbranch_scc1 L_exit
s_waitcnt vmcnt(0)
s_branch L_evb_w3f
L_slow_w3:
v_mov_b64 v[20:21], 0
v_mov_b64 v[22:23], 0
v_mov_b64 v[24:25], 0
v_mov_b64 v[26:27], 0
v_mov_b64 v[28:29], 0
v_mov_b64 v[30:31], 0
v_mov_b64 v[32:33], 0
v_mov_b64 v[34:35], 0
v_mov_b64 v[36:37], 0
v_mov_b64 v[38:39], 0
v_mov_b64 v[40:41], 0
v_mov_b64 v[42:43], 0
ds_read_b128 v[44:47], v2 offset:0
ds_read_b128 v[48:51], v2 offset:1024
v_bfe_u32 v77, v1, 6, 1
v_lshl_add_u32 v77, v77, 3, v1
v_lshlrev_b32 v77, 1, v77
v_lshlrev_b32 v78, 3, v1
s_mov_b32 s38, 0
s_waitcnt vmcnt(0) lgkmcnt(0)
s_branch L_top_w3s
L_done_w3s:
s_waitcnt vmcnt(0) lgkmcnt(0)
s_endpgm
L_ra0_w3s:
s_mov_b32 m0, 1024
s_nop 0
buffer_load_dwordx4 v1, s[4:7], s47 offen offset:0 sc0 sc1 lds
buffer_load_dwordx4 v1, s[4:7], s47 offen offset:1024 sc0 sc1 lds
buffer_load_dwordx4 v1, s[4:7], s47 offen offset:2048 sc0 sc1 lds
buffer_load_dwordx4 v1, s[4:7], s47 offen offset:3072 sc0 sc1 lds
s_sub_u32 s41, s41, 1
s_cbranch_scc1 L_exit
ds_read_b128 v[44:47], v2 offset:0
ds_read_b128 v[48:51], v2 offset:1024
v_mov_b64 v[20:21], 0
v_mov_b64 v[22:23], 0
v_mov_b64 v[24:25], 0
v_mov_b64 v[26:27], 0
v_mov_b64 v[28:29], 0
v_mov_b64 v[30:31], 0
v_mov_b64 v[32:33], 0
v_mov_b64 v[34:35], 0
v_mov_b64 v[36:37], 0
v_mov_b64 v[38:39], 0
v_mov_b64 v[40:41], 0
v_mov_b64 v[42:43], 0
s_waitcnt vmcnt(0)
ds_read_b128 v[60:63], v1 offset:1024
ds_read_b128 v[64:67], v1 offset:2048
ds_read_b128 v[68:71], v1 offset:3072
ds_read_b128 v[72:75], v1 offset:4096
s_branch L_s0_w3s
L_ra1_w3s:
L_ra2_w3s:
s_waitcnt lgkmcnt(0)
s_barrier
s_mov_b32 m0, 5120
s_nop 0
buffer_load_dwordx4 v1, s[4:7], s48 offen offset:3072 sc0 sc1 lds
s_sub_u32 s41, s41, 1
s_cbranch_scc1 L_exit
s_waitcnt vmcnt(0)
s_barrier
ds_read_b128 v[76:79], v1 offset:5120
ds_read_b128 v[60:63], v1 offset:6144
ds_read_b128 v[64:67], v1 offset:7168
ds_read_b128 v[68:71], v1 offset:8192
ds_read_b128 v[72:75], v1 offset:9216
s_waitcnt lgkmcnt(0)
v_bitop3_b32 v6, v76, v60, s35 bitop3:0x7e
v_bitop3_b32 v6, v6, v64, s35 bitop3:0xf6
v_bitop3_b32 v6, v6, v68, s35 bitop3:0xf6
v_bitop3_b32 v6, v6, v72, s35 bitop3:0xf6
v_and_b32 v6, 1, v6
v_cmp_ne_u32 vcc, 0, v6

s_cbranch_vccnz L_ra2_w3s
s_branch L_a1_w3s
L_mx_w3s:
s_waitcnt lgkmcnt(0)
v_max3_f32 v30, v12, v13, v28
v_max_f32 v30, v30, v29
v_mov_b32 v31, v30
s_nop 1
v_permlane16_swap_b32 v30, v31
v_max_f32 v30, v30, v31
v_mov_b32 v31, v30
s_nop 1
v_permlane32_swap_b32 v30, v31
v_max_f32 v30, v30, v31
ds_write_b32 v1, v30 offset:10252
s_waitcnt lgkmcnt(0)
s_barrier
ds_read_b128 v[32:35], v1 offset:10240
s_waitcnt lgkmcnt(0)
v_max3_f32 v32, v32, v33, v34
v_max_f32 v32, v32, v35
v_sub_f32 v14, v12, v32
v_sub_f32 v15, v13, v32
v_sub_f32 v30, v28, v32
v_sub_f32 v31, v29, v32
v_exp_f32 v14, v14
v_exp_f32 v15, v15
v_exp_f32 v30, v30
v_exp_f32 v31, v31
v_cvt_pk_bf16_f32 v14, v14, v15
v_cvt_pk_bf16_f32 v30, v30, v31
ds_write_b32 v5, v14 offset:15136
v_cndmask_b32_e64 v26, 0, v30, s[56:57]
v_cndmask_b32_e64 v27, 0, v30, s[56:57]
v_mov_b64 v[76:77], s[52:53]
v_mov_b64 v[78:79], s[52:53]
v_mov_b32_dpp v24, v26 quad_perm:[2,3,0,1] row_mask:0xf bank_mask:0xf
v_mov_b32_dpp v25, v26 quad_perm:[2,3,0,1] row_mask:0xf bank_mask:0xf
s_waitcnt lgkmcnt(0)
s_barrier
v_mov_b64 v[14:15], s[0:1]
ds_read_b128 v[16:19], v1 offset:14368
ds_read_b128 v[36:39], v1 offset:14336
s_waitcnt lgkmcnt(0)
v_mfma_f32_16x16x32_bf16 v[32:35], v[76:79], v[16:19], 0
v_mfma_f32_16x16x32_bf16 v[20:23], v[52:55], v[16:19], 0
v_mfma_f32_16x16x32_bf16 v[20:23], v[56:59], v[36:39], v[20:23]
v_mfma_f32_16x16x16_bf16 v[32:35], v[14:15], v[26:27], v[32:35]
v_mfma_f32_16x16x32_bf16 v[20:23], v[40:43], v[24:27], v[20:23]
s_nop 3
v_rcp_f32 v33, v32
s_nop 2
v_mul_f32_dpp v20, v33, v20 quad_perm:[0,1,0,1] row_mask:0xf bank_mask:0xf
v_mul_f32_dpp v21, v33, v21 quad_perm:[0,1,0,1] row_mask:0xf bank_mask:0xf
v_mul_f32_dpp v22, v33, v22 quad_perm:[0,1,0,1] row_mask:0xf bank_mask:0xf
v_mul_f32_dpp v23, v33, v23 quad_perm:[0,1,0,1] row_mask:0xf bank_mask:0xf
v_cvt_pk_bf16_f32 v20, v20, v21
v_cvt_pk_bf16_f32 v21, v22, v23
ds_write_b64 v6, v[20:21] offset:8192
v_mov_b32_dpp v16, v20 quad_perm:[0,1,0,1] row_mask:0xf bank_mask:0xf
v_mov_b32_dpp v17, v21 quad_perm:[0,1,0,1] row_mask:0xf bank_mask:0xf
v_mov_b32_dpp v18, v20 quad_perm:[2,3,2,3] row_mask:0xf bank_mask:0xf
v_mov_b32_dpp v19, v21 quad_perm:[2,3,2,3] row_mask:0xf bank_mask:0xf
v_mov_b64 v[76:77], 0
v_mov_b64 v[78:79], 0
v_mov_b64 v[36:37], 0
v_mov_b64 v[38:39], 0
v_mov_b64 v[24:25], 0
v_mov_b64 v[26:27], 0
v_mov_b64 v[32:33], 0
v_mov_b64 v[34:35], 0
s_waitcnt lgkmcnt(0)
s_branch L_mxb_w3s

L_ev_w3s:
buffer_load_dword v11, v11, s[4:7], s101 offen sc0 sc1
s_sub_u32 s41, s41, 1
s_cbranch_scc1 L_exit
s_waitcnt vmcnt(0)
s_branch L_evb_w3s
s_endpgm

.section .rodata,"a"
.p2align 6
.amdhsa_kernel gated_mix__sliding_local_dilated__memory_aug_recurrent_mem_tr__prompt_kernel
  .amdhsa_next_free_vgpr 512
  .amdhsa_next_free_sgpr 102
  .amdhsa_accum_offset 256
  .amdhsa_group_segment_fixed_size 0
  .amdhsa_kernarg_size 112
  .amdhsa_user_sgpr_count 2
  .amdhsa_user_sgpr_kernarg_segment_ptr 1
  .amdhsa_system_sgpr_workgroup_id_x 1
  .amdhsa_float_denorm_mode_32 3
.end_amdhsa_kernel
```
